```python
import torch

def _softmax(x, axis=-1):
    return torch.softmax(x, dim=axis)
def _gelu(x):
    return torch.nn.functional.gelu(x, approximate="tanh")
def _silu(x):
    return torch.nn.functional.silu(x)
def _sigmoid(x):
    return torch.sigmoid(x)
def _layernorm(x, axis=-1, eps=1e-5):
    m = x.mean(dim=axis, keepdim=True)
    v = x.var(dim=axis, keepdim=True, unbiased=False)
    return (x - m) / torch.sqrt(v + eps)
def _scatter_add(tgt, idx, src, axis=0):
    return tgt.clone().index_add_(axis, idx, src)
def _segment_sum(src, seg, n):
    out = torch.zeros((n,) + src.shape[1:], dtype=src.dtype)
    return out.index_add_(0, seg, src)
def _pad(x, pw):
    flat = tuple(v for pair in reversed(pw) for v in pair)
    return torch.nn.functional.pad(x, flat)

kernel_name = 'gated_mix__ssm_conv_s4__moe_arch_mod__prompt'

def setup_inputs():

    _w = (lambda a: (lambda t: t.to(torch.bfloat16) if t.is_floating_point() else t)(torch.as_tensor(a)))
    def _A_setup():
        B, L, D, N = 1, 2048, 576, 128
        A_re = -(lambda _x: torch.exp(torch.as_tensor(_x)))((lambda *s: torch.randn(*s, dtype=torch.bfloat16) * 3.2)(D, N))
        A_im = torch.pi * (lambda *s: torch.randn(*s, dtype=torch.bfloat16) * 0.05)(D, N)
        B_re = (lambda *s: torch.randn(*s, dtype=torch.bfloat16) * 0.2)(D, N)
        B_im = (lambda *s: torch.randn(*s, dtype=torch.bfloat16) * 0.2)(D, N)
        C_re = (lambda *s: torch.randn(*s, dtype=torch.bfloat16) * 0.2)(D, N)
        C_im = (lambda *s: torch.randn(*s, dtype=torch.bfloat16) * 0.2)(D, N)
        log_dt = (lambda *s: torch.randn(*s, dtype=torch.bfloat16) * 0.05)(D) * 0.5 - 4.0
        Dskip = (lambda *s: torch.randn(*s, dtype=torch.bfloat16) * 0.1)(D)
        return {
            "u": _w((lambda *s: torch.randn(*s, dtype=torch.bfloat16) * 0.05)(B, L, D)),
            "A_re": _w(A_re),
            "A_im": _w(A_im),
            "B_re": _w(B_re),
            "B_im": _w(B_im),
            "C_re": _w(C_re),
            "C_im": _w(C_im),
            "log_dt": _w(log_dt),
            "Dskip": _w(Dskip),
        }
    _A_in = _A_setup()

    def _B_setup():
        B, S, D, F, C = 1, 2048, 576, 4608, 8
        return {
            "x": _w((lambda *s: torch.randn(*s, dtype=torch.bfloat16) * 0.05)(B, S, D)),
            "w_r": _w((lambda *s: torch.randn(*s, dtype=torch.bfloat16) * 3.2)(D)),
            "w_gate": _w((lambda *s: torch.randn(*s, dtype=torch.bfloat16) * 0.1)(D, F)),
            "w_up": _w((lambda *s: torch.randn(*s, dtype=torch.bfloat16) * 0.1)(D, F)),
            "w_down": _w((lambda *s: torch.randn(*s, dtype=torch.bfloat16) * 0.1)(F, D)),
        }
    _B_in = _B_setup()

    return {
        "A_u": _A_in["u"],
        "A_A_re": _A_in["A_re"],
        "A_A_im": _A_in["A_im"],
        "A_B_re": _A_in["B_re"],
        "A_B_im": _A_in["B_im"],
        "A_C_re": _A_in["C_re"],
        "A_C_im": _A_in["C_im"],
        "A_log_dt": _A_in["log_dt"],
        "A_Dskip": _A_in["Dskip"],
        "B_x": _B_in["x"],
        "B_w_r": _B_in["w_r"],
        "B_w_gate": _B_in["w_gate"],
        "B_w_up": _B_in["w_up"],
        "B_w_down": _B_in["w_down"],
        "gate_w": _w((lambda *s: torch.randn(*s, dtype=torch.bfloat16) * 0.05)(576) * 16.0),
    }

def reference(A_u, A_A_re, A_A_im, A_B_re, A_B_im, A_C_re, A_C_im, A_log_dt, A_Dskip, B_x, B_w_r, B_w_gate, B_w_up, B_w_down, gate_w):
    def _A_ref(u, A_re, A_im, B_re, B_im, C_re, C_im, log_dt, Dskip):
        Bsz, L, D = u.shape
        dt = torch.exp(log_dt)[:, None]
        A = A_re + 1j * A_im
        Bc = B_re + 1j * B_im
        Cc = C_re + 1j * C_im
        logdA = dt * A
        dB = dt * Bc
        l = (lambda x, dt: x.to(dt))(torch.arange(L), A_re.dtype)
        P = torch.exp(logdA[:, :, None] * l[None, None, :])
        K = torch.einsum("dn,dnl,dn->dl", Cc, P, dB).real
        L2 = 2 * L
        Kp = _pad(K, ((0, 0), (0, L)))
        up = (lambda x, *d: x.permute(*d))(u, 0, 2, 1)
        up = _pad(up, ((0, 0), (0, 0), (0, L)))
        Kf = (lambda x, axes=(-2,-1): torch.fft.rfft2(x.float(), dim=axes))(Kp[:, None, :], axes=(-2, -1))
        Uf = (lambda x, axes=(-2,-1): torch.fft.rfft2(x.float(), dim=axes))(up[:, :, None, :], axes=(-2, -1))
        Yf = Uf * Kf[None, :, :, :]
        y = (lambda x, s, axes=(-2,-1): torch.fft.irfft2(x, s=s, dim=axes).to(torch.bfloat16))(Yf, (1, L2), axes=(-2, -1))[:, :, 0, :L]
        y = (lambda x, *d: x.permute(*d))(y, 0, 2, 1) + u * Dskip[None, None, :]
        return y

    def _B_ref(x, w_r, w_gate, w_up, w_down):
        B, S, D = x.shape
        C = 8
        r = x @ w_r
        idx = torch.argsort(-r, axis=-1)[:, :C]
        idx_e = (lambda x, n, axis: torch.repeat_interleave(x, n, dim=axis))(idx.reshape(B, C, 1), D, axis=2)
        x_sel = (lambda x, i, axis: torch.take_along_dim(x, i, dim=axis))(x, idx_e, axis=1)
        g = _silu(x_sel @ w_gate)
        u = x_sel @ w_up
        y = (g * u) @ w_down
        r_sel = _sigmoid((lambda x, i, axis: torch.take_along_dim(x, i, dim=axis))(r, idx, axis=1))
        y = y * r_sel.reshape(B, C, 1)
        b_off = (torch.arange(B) * S).reshape(B, 1)
        flat_idx = (idx + b_off).reshape(B * C)
        zero = (x * 0.0).reshape(B * S, D)
        upd = _scatter_add(zero, flat_idx, y.reshape(B * C, D), axis=0)
        return x + upd.reshape(B, S, D)

    x = A_u
    g = _sigmoid((x * gate_w).sum(-1, keepdims=True))
    a = _A_ref(x, A_A_re, A_A_im, A_B_re, A_B_im, A_C_re, A_C_im, A_log_dt, A_Dskip)
    b = _B_ref(x, B_w_r, B_w_gate, B_w_up, B_w_down)
    return g * a + (1 - g) * b
```

```asm
; @launch kernel=k1_kernel grid=(256,1,1) block=(768,1,1) lds=163840
.amdgcn_target "amdgcn-amd-amdhsa--gfx950"
.text
.p2align 8
.globl k1_kernel
.type k1_kernel,@function
k1_kernel:
    s_cmp_ge_u32 s2, 256
    s_cbranch_scc1 K_END
    s_load_dwordx16 s[16:31], s[0:1], 0
    s_load_dwordx16 s[32:47], s[0:1], 64
    s_load_dwordx4 s[48:51], s[0:1], 128
    v_lshrrev_b32 v1, 6, v0
    v_and_b32 v2, 63, v0
    v_readfirstlane_b32 s3, v1
    v_and_b32 v3, 15, v2
    v_lshrrev_b32 v4, 4, v2
    s_and_b32 s4, s2, 7
    s_lshr_b32 s5, s2, 3
    s_cmp_lg_u32 s3, 0
    s_cbranch_scc1 K_NOCPF
    s_getpc_b64 s[8:9]
    s_and_b32 s8, s8, 0xffffff00
    v_and_b32 v5, 7, v2
    v_lshl_add_u32 v5, s5, 3, v5
    v_lshlrev_b32 v5, 7, v5
    v_min_u32 v5, CODE_END-k1_kernel-4, v5
    global_load_dword v167, v5, s[8:9]
K_NOCPF:
    s_cmp_lt_u32 s2, 112
    s_cbranch_scc1 K_NC
    s_sub_u32 s101, s5, 14
    s_mul_i32 s6, s4, 18
    s_add_u32 s6, s6, s101
    s_cmp_lt_u32 s3, 8
    s_cbranch_scc1 CK_PRO
CU_PRO:
    s_sub_u32 s7, s3, 8
    s_lshl_b32 s8, s101, 2
    s_add_u32 s8, s8, s7
    s_min_u32 s8, s8, 63
    s_mul_i32 s8, s8, 36864
    s_lshl_b32 s9, s4, 7
    s_add_u32 s8, s8, s9
    v_lshrrev_b32 v5, 1, v2
    v_mul_u32_u24 v5, 1152, v5
    v_and_b32 v6, 1, v2
    v_lshl_add_u32 v5, v6, 7, v5
    v_add_u32 v7, s8, v5
    s_mul_i32 s8, s7, 294912
    s_lshl_b32 s9, s6, 3
    s_add_u32 s8, s8, s9
    v_mul_u32_u24 v5, 4608, v2
    v_add_u32 v5, s8, v5
    v_add_u32 v6, 1179648, v5
    v_mov_b32 v59, 0
    v_mov_b32 v57, 153600
    v_lshl_add_u32 v56, v2, 2, v57
    ds_write_b32 v56, v59
    s_waitcnt lgkmcnt(0)
    global_load_dword v60, v7, s[16:17]
    s_barrier
    global_load_dwordx2 v[8:9], v5, s[16:17] offset:0 sc1
    global_load_dwordx2 v[10:11], v5, s[16:17] offset:1152 sc1
    global_load_dwordx2 v[12:13], v5, s[16:17] offset:2304 sc1
    global_load_dwordx2 v[14:15], v5, s[16:17] offset:3456 sc1
    global_load_dwordx2 v[16:17], v6, s[16:17] offset:0 sc1
    global_load_dwordx2 v[18:19], v6, s[16:17] offset:1152 sc1
    global_load_dwordx2 v[20:21], v6, s[16:17] offset:2304 sc1
    global_load_dwordx2 v[22:23], v6, s[16:17] offset:3456 sc1
    s_branch CU_MAIN
CK_PRO:
    s_and_b32 s7, s3, 3
    s_lshr_b32 s12, s3, 2
    s_lshl_b32 s8, s6, 2
    s_add_u32 s8, s8, s7
    s_lshl_b32 s9, s8, 8
    v_lshl_add_u32 v6, v2, 2, s9
    s_lshl_b32 s10, s12, 7
    s_add_u32 s9, s9, s10
    v_lshl_add_u32 v5, v2, 1, s9
    s_lshl_b32 s8, s8, 1
    v_mov_b32 v7, s8
    v_mov_b32 v8, 0
    v_mov_b32 v9, 0
    v_mov_b32 v10, 0
    v_mov_b32 v11, 0
    v_mov_b32 v12, 0
    v_mov_b32 v13, 0
    v_mov_b32 v18, 0
    s_waitcnt lgkmcnt(0)
    global_load_short_d16_hi v18, v7, s[30:31]
    global_load_short_d16_hi v8, v5, s[18:19]
    global_load_short_d16_hi v9, v5, s[20:21]
    global_load_short_d16_hi v10, v5, s[22:23]
    global_load_short_d16_hi v11, v5, s[24:25]
    global_load_short_d16_hi v12, v5, s[26:27]
    global_load_short_d16_hi v13, v5, s[28:29]
    global_load_dword v14, v6, s[22:23]
    global_load_dword v15, v6, s[24:25]
    global_load_dword v16, v6, s[26:27]
    global_load_dword v17, v6, s[28:29]
    s_barrier
    s_branch CK_MAIN
K_NC:
    s_lshl_b32 s6, s2, 4
    s_lshl_b32 s7, s3, 2
    s_sub_u32 s7, s7, 32
    s_cmp_ge_u32 s3, 8
    s_cbranch_scc1 RT_PRO
    s_cmp_lt_u32 s2, 72
    s_cbranch_scc1 F_PRO
    s_cmp_lt_u32 s3, 6
    s_cbranch_scc1 HELPER
    s_cmp_lt_u32 s2, 80
    s_cbranch_scc1 HELPER
    s_add_u32 s7, s7, 24
    s_lshr_b32 s6, s6, 1
    s_add_u32 s6, s6, 1136
RT_PRO:
    s_add_u32 s6, s6, s7
    v_add_u32 v5, s6, v4
    v_lshlrev_b32 v6, 4, v3
    v_lshlrev_b32 v7, 3, v3
    v_mul_u32_u24 v9, 1152, v5
    v_add_u32 v8, v9, v6
    v_add_u32 v9, v9, v7
    v_mov_b32 v10, 0
    v_lshlrev_b32 v11, 2, v2
    v_add_u32 v11, 163520, v11
    ds_write_b32 v11, v10
    s_waitcnt lgkmcnt(0)
    s_load_dword s12, s[50:51], 0
    global_load_dwordx4 v[34:37], v6, s[36:37] offset:0
    global_load_dwordx4 v[38:41], v6, s[36:37] offset:256
    global_load_dwordx4 v[42:45], v6, s[36:37] offset:512
    global_load_dwordx4 v[46:49], v6, s[36:37] offset:768
    global_load_dwordx2 v[50:51], v7, s[36:37] offset:1024
    global_load_dwordx4 v[16:19], v8, s[16:17] offset:0
    global_load_dwordx4 v[20:23], v8, s[16:17] offset:256
    global_load_dwordx4 v[24:27], v8, s[16:17] offset:512
    global_load_dwordx4 v[28:31], v8, s[16:17] offset:768
    global_load_dwordx2 v[32:33], v9, s[16:17] offset:1024
    global_load_dwordx4 v[52:55], v6, s[44:45] offset:0
    global_load_dwordx4 v[56:59], v6, s[44:45] offset:256
    global_load_dwordx4 v[60:63], v6, s[44:45] offset:512
    global_load_dwordx4 v[64:67], v6, s[44:45] offset:768
    global_load_dwordx2 v[68:69], v7, s[44:45] offset:1024
    s_barrier
    s_branch RT_MAIN
F_PRO:
    s_mul_i32 s6, s4, 9
    s_add_u32 s6, s6, s5
    v_lshrrev_b32 v6, 3, v2
    v_and_b32 v7, 4, v6
    v_add_u32 v7, v6, v7
    v_mul_u32_u24 v5, 9216, v7
    v_and_b32 v7, 6, v6
    v_xor_b32 v7, v7, v2
    v_and_b32 v7, 7, v7
    v_lshl_add_u32 v5, v7, 4, v5
    s_and_b32 s8, s3, 1
    s_lshr_b32 s9, s3, 1
    s_lshl_b32 s9, s9, 2
    s_add_u32 s8, s8, s9
    s_mul_i32 s14, s8, 36864
    s_lshl_b32 s8, s6, 7
    s_add_u32 s14, s14, s8
    s_lshl_b32 s15, s3, 10
    s_mov_b32 s54, 5308416
    s_mov_b32 s55, 0x20000
    s_mov_b32 s58, 5308416
    s_mov_b32 s59, 0x20000
    s_waitcnt lgkmcnt(0)
    s_mov_b64 s[52:53], s[38:39]
    s_mov_b64 s[56:57], s[40:41]
    s_barrier
    s_branch F_MAIN
HELPER:
    s_sub_u32 s6, s5, 9
    s_mul_i32 s7, s3, 5
    s_add_u32 s6, s6, s7
    v_mul_u32_u24 v5, 9216, v2
    s_mul_i32 s7, s4, 1152
    v_add_u32 v5, s7, v5
    s_waitcnt lgkmcnt(0)
    s_barrier
    s_cmp_ge_u32 s3, 4
    s_cbranch_scc1 W_END
    s_cmp_lt_u32 s2, 80
    s_cselect_b32 s14, 1, 0
    s_cmp_lt_u32 s3, s14
    s_cbranch_scc1 HP_LOOP
HP_BAR:
    s_barrier
    s_mov_b32 s14, 0
HP_LOOP:
    s_cmp_ge_u32 s6, 36
    s_cbranch_scc1 W_END
    s_mul_i32 s8, s6, 7282
    s_lshr_b32 s8, s8, 16
    s_mul_i32 s9, s8, 9
    s_sub_u32 s9, s6, s9
    s_lshl_b32 s9, s9, 7
    s_bitcmp1_b32 s8, 0
    s_cselect_b32 s12, s40, s38
    s_cselect_b32 s13, s41, s39
    s_lshr_b32 s8, s8, 1
    s_add_u32 s8, s8, 3
    s_mul_i32 s8, s8, 589824
    s_add_u32 s8, s8, s9
    v_add_u32 v6, s8, v5
    global_load_dword v7, v6, s[12:13]
    s_add_u32 s6, s6, 20
    s_cmp_lg_u32 s14, 0
    s_cbranch_scc1 HP_BAR
    s_branch HP_LOOP
RT_MAIN:
    s_lshl_b32 s6, s2, 7
    s_add_u32 s6, s6, 4096
    s_cmp_lt_u32 s2, 80
    s_cselect_b32 s8, 15, 23
    v_min_u32 v14, s8, v2
    v_lshl_add_u32 v5, v14, 2, s6
    s_mov_b32 s8, 163520
    v_lshl_add_u32 v14, v14, 2, s8
    v_add_u32 v13, s7, v4
    v_lshl_add_u32 v13, v13, 2, s8
    s_mov_b32 s8, 0xffff
    s_mov_b32 s10, 0x00010001
    s_mov_b32 s11, 0x00010001
    v_mov_b32 v15, 0x3f803f80
    v_mov_b32 v12, 163456
    s_waitcnt lgkmcnt(0)
    s_add_u32 s12, s12, 1
    v_mov_b32 v11, s12
    ds_write_b64 v12, v[10:11]
    s_waitcnt vmcnt(5)
    v_dot2_f32_bf16 v12, v16, v34, 0
    v_dot2_f32_bf16 v12, v17, v35, v12
    v_dot2_f32_bf16 v12, v18, v36, v12
    v_dot2_f32_bf16 v12, v19, v37, v12
    v_dot2_f32_bf16 v12, v20, v38, v12
    v_dot2_f32_bf16 v12, v21, v39, v12
    v_dot2_f32_bf16 v12, v22, v40, v12
    v_dot2_f32_bf16 v12, v23, v41, v12
    v_dot2_f32_bf16 v12, v24, v42, v12
    v_dot2_f32_bf16 v12, v25, v43, v12
    v_dot2_f32_bf16 v12, v26, v44, v12
    v_dot2_f32_bf16 v12, v27, v45, v12
    v_dot2_f32_bf16 v12, v28, v46, v12
    v_dot2_f32_bf16 v12, v29, v47, v12
    v_dot2_f32_bf16 v12, v30, v48, v12
    v_dot2_f32_bf16 v12, v31, v49, v12
    v_dot2_f32_bf16 v12, v32, v50, v12
    v_dot2_f32_bf16 v12, v33, v51, v12
    s_nop 0
    s_nop 1
    v_add_f32_dpp v12, v12, v12 row_ror:8 row_mask:0xf bank_mask:0xf
    s_nop 1
    v_add_f32_dpp v12, v12, v12 row_ror:4 row_mask:0xf bank_mask:0xf
    s_nop 1
    v_add_f32_dpp v12, v12, v12 row_ror:2 row_mask:0xf bank_mask:0xf
    s_nop 1
    v_add_f32_dpp v12, v12, v12 row_ror:1 row_mask:0xf bank_mask:0xf
    v_cvt_pk_bf16_f32 v12, v12, v12
    v_ashrrev_i32 v9, 31, v12
    v_or_b32 v9, 0x80000000, v9
    v_xor_b32 v12, v12, v9
    s_waitcnt vmcnt(0)
    v_or_b32 v12, 1, v12
    s_mov_b64 exec, s[10:11]
    ds_write_b32 v13, v12 offset:0
    s_mov_b64 exec, -1
    s_cmp_lg_u32 s7, 0
    s_cbranch_scc1 RT_PK_X
    s_mov_b32 s9, 0
RT_PK:
    ds_read_b32 v12, v14 offset:0
    s_add_u32 s9, s9, 1
    s_waitcnt lgkmcnt(0)
    v_cmp_eq_u32 vcc, 0, v12
    s_cmp_ge_u32 s9, 0x40000
    s_cbranch_scc1 RT_PK_S
    s_cbranch_vccnz RT_PK
RT_PK_S:
    v_bfi_b32 v12, s8, v11, v12
    s_mov_b64 exec, 0xffffff
    global_store_dword v5, v12, s[50:51] sc1
    s_mov_b64 exec, -1
RT_PK_X:
    s_barrier
    s_or_b32 s9, s2, s7
    s_cmp_lg_u32 s9, 0
    s_cbranch_scc1 RT_NOT
    v_and_b32 v12, s8, v11
    v_or_b32 v12, 0x10000, v12
    global_store_dword v10, v12, s[48:49] offset:128 sc1
RT_NOT:
    v_and_b32 v34, 0xffff, v52
    v_and_b32 v52, 0xffff0000, v52
    v_and_b32 v35, 0xffff, v53
    v_and_b32 v53, 0xffff0000, v53
    v_and_b32 v36, 0xffff, v54
    v_and_b32 v54, 0xffff0000, v54
    v_and_b32 v37, 0xffff, v55
    v_and_b32 v55, 0xffff0000, v55
    v_and_b32 v38, 0xffff, v56
    v_and_b32 v56, 0xffff0000, v56
    v_and_b32 v39, 0xffff, v57
    v_and_b32 v57, 0xffff0000, v57
    v_dot2_f32_bf16 v70, v16, v34, 0
    v_dot2_f32_bf16 v71, v16, v52, 0
    v_dot2_f32_bf16 v72, v17, v35, 0
    v_dot2_f32_bf16 v73, v17, v53, 0
    v_dot2_f32_bf16 v74, v18, v36, 0
    v_dot2_f32_bf16 v75, v18, v54, 0
    v_dot2_f32_bf16 v76, v19, v37, 0
    v_dot2_f32_bf16 v77, v19, v55, 0
    v_dot2_f32_bf16 v78, v20, v38, 0
    v_dot2_f32_bf16 v79, v20, v56, 0
    v_dot2_f32_bf16 v80, v21, v39, 0
    v_dot2_f32_bf16 v81, v21, v57, 0
    s_nop 0
    v_cvt_pk_bf16_f32 v70, v70, v71
    v_cvt_pk_bf16_f32 v72, v72, v73
    v_cvt_pk_bf16_f32 v74, v74, v75
    v_cvt_pk_bf16_f32 v76, v76, v77
    v_cvt_pk_bf16_f32 v78, v78, v79
    v_cvt_pk_bf16_f32 v80, v80, v81
    v_dot2_f32_bf16 v12, v70, v15, 0
    v_dot2_f32_bf16 v12, v72, v15, v12
    v_dot2_f32_bf16 v12, v74, v15, v12
    v_dot2_f32_bf16 v12, v76, v15, v12
    v_dot2_f32_bf16 v12, v78, v15, v12
    v_dot2_f32_bf16 v12, v80, v15, v12
    v_and_b32 v40, 0xffff, v58
    v_and_b32 v58, 0xffff0000, v58
    v_and_b32 v41, 0xffff, v59
    v_and_b32 v59, 0xffff0000, v59
    v_and_b32 v42, 0xffff, v60
    v_and_b32 v60, 0xffff0000, v60
    v_and_b32 v43, 0xffff, v61
    v_and_b32 v61, 0xffff0000, v61
    v_and_b32 v44, 0xffff, v62
    v_and_b32 v62, 0xffff0000, v62
    v_and_b32 v45, 0xffff, v63
    v_and_b32 v63, 0xffff0000, v63
    v_dot2_f32_bf16 v70, v22, v40, 0
    v_dot2_f32_bf16 v71, v22, v58, 0
    v_dot2_f32_bf16 v72, v23, v41, 0
    v_dot2_f32_bf16 v73, v23, v59, 0
    v_dot2_f32_bf16 v74, v24, v42, 0
    v_dot2_f32_bf16 v75, v24, v60, 0
    v_dot2_f32_bf16 v76, v25, v43, 0
    v_dot2_f32_bf16 v77, v25, v61, 0
    v_dot2_f32_bf16 v78, v26, v44, 0
    v_dot2_f32_bf16 v79, v26, v62, 0
    v_dot2_f32_bf16 v80, v27, v45, 0
    v_dot2_f32_bf16 v81, v27, v63, 0
    s_nop 0
    v_cvt_pk_bf16_f32 v70, v70, v71
    v_cvt_pk_bf16_f32 v72, v72, v73
    v_cvt_pk_bf16_f32 v74, v74, v75
    v_cvt_pk_bf16_f32 v76, v76, v77
    v_cvt_pk_bf16_f32 v78, v78, v79
    v_cvt_pk_bf16_f32 v80, v80, v81
    v_dot2_f32_bf16 v12, v70, v15, v12
    v_dot2_f32_bf16 v12, v72, v15, v12
    v_dot2_f32_bf16 v12, v74, v15, v12
    v_dot2_f32_bf16 v12, v76, v15, v12
    v_dot2_f32_bf16 v12, v78, v15, v12
    v_dot2_f32_bf16 v12, v80, v15, v12
    v_and_b32 v46, 0xffff, v64
    v_and_b32 v64, 0xffff0000, v64
    v_and_b32 v47, 0xffff, v65
    v_and_b32 v65, 0xffff0000, v65
    v_and_b32 v48, 0xffff, v66
    v_and_b32 v66, 0xffff0000, v66
    v_and_b32 v49, 0xffff, v67
    v_and_b32 v67, 0xffff0000, v67
    v_and_b32 v50, 0xffff, v68
    v_and_b32 v68, 0xffff0000, v68
    v_and_b32 v51, 0xffff, v69
    v_and_b32 v69, 0xffff0000, v69
    v_dot2_f32_bf16 v70, v28, v46, 0
    v_dot2_f32_bf16 v71, v28, v64, 0
    v_dot2_f32_bf16 v72, v29, v47, 0
    v_dot2_f32_bf16 v73, v29, v65, 0
    v_dot2_f32_bf16 v74, v30, v48, 0
    v_dot2_f32_bf16 v75, v30, v66, 0
    v_dot2_f32_bf16 v76, v31, v49, 0
    v_dot2_f32_bf16 v77, v31, v67, 0
    v_dot2_f32_bf16 v78, v32, v50, 0
    v_dot2_f32_bf16 v79, v32, v68, 0
    v_dot2_f32_bf16 v80, v33, v51, 0
    v_dot2_f32_bf16 v81, v33, v69, 0
    s_nop 0
    v_cvt_pk_bf16_f32 v70, v70, v71
    v_cvt_pk_bf16_f32 v72, v72, v73
    v_cvt_pk_bf16_f32 v74, v74, v75
    v_cvt_pk_bf16_f32 v76, v76, v77
    v_cvt_pk_bf16_f32 v78, v78, v79
    v_cvt_pk_bf16_f32 v80, v80, v81
    v_dot2_f32_bf16 v12, v70, v15, v12
    v_dot2_f32_bf16 v12, v72, v15, v12
    v_dot2_f32_bf16 v12, v74, v15, v12
    v_dot2_f32_bf16 v12, v76, v15, v12
    v_dot2_f32_bf16 v12, v78, v15, v12
    v_dot2_f32_bf16 v12, v80, v15, v12
    v_add_u32 v5, 16384, v5
    s_nop 1
    v_add_f32_dpp v12, v12, v12 row_ror:8 row_mask:0xf bank_mask:0xf
    s_nop 1
    v_add_f32_dpp v12, v12, v12 row_ror:4 row_mask:0xf bank_mask:0xf
    s_nop 1
    v_add_f32_dpp v12, v12, v12 row_ror:2 row_mask:0xf bank_mask:0xf
    s_nop 1
    v_add_f32_dpp v12, v12, v12 row_ror:1 row_mask:0xf bank_mask:0xf
    v_cvt_pk_bf16_f32 v12, v12, v12
    v_and_b32 v12, 0xffff0000, v12
    v_mul_f32 v9, 0xbfb8aa3b, v12
    v_exp_f32 v9, v9
    s_nop 0
    v_add_f32 v9, 1.0, v9
    v_rcp_f32 v9, v9
    s_nop 0
    v_cvt_pk_bf16_f32 v12, v9, v9
    v_or_b32 v12, 1, v12
    s_mov_b64 exec, s[10:11]
    ds_write_b32 v13, v12 offset:128
    s_mov_b64 exec, -1
    s_cmp_lg_u32 s7, 0
    s_cbranch_scc1 RT_PG_X
    s_mov_b32 s9, 0
RT_PG:
    ds_read_b32 v12, v14 offset:128
    s_add_u32 s9, s9, 1
    s_waitcnt lgkmcnt(0)
    v_cmp_eq_u32 vcc, 0, v12
    s_cmp_ge_u32 s9, 0x40000
    s_cbranch_scc1 RT_PG_S
    s_cbranch_vccnz RT_PG
RT_PG_S:
    v_bfi_b32 v12, s8, v11, v12
    s_mov_b64 exec, 0xffffff
    global_store_dword v5, v12, s[50:51] sc1
    s_mov_b64 exec, -1
RT_PG_X:
    s_cmp_ge_u32 s2, 72
    s_cbranch_scc1 W_END
    s_cmp_lg_u32 s3, 8
    s_cbranch_scc1 W_END
    s_mul_i32 s6, s4, 9
    s_add_u32 s6, s6, s5
    v_mov_b32 v14, v11
    s_mov_b32 s60, s42
    s_mov_b32 s61, s43
    s_mov_b32 s62, 5308416
    s_mov_b32 s63, 0x20000
    s_barrier
    s_cmp_lg_u32 s2, 0
    s_cbranch_scc1 F_DOWN
    v_and_b32 v17, 7, v2
    v_lshlrev_b32 v17, 2, v17
    v_add_u32 v19, 163616, v17
    s_mov_b32 s9, 0
RT_SEL:
    ds_read_b32 v18, v19
    s_add_u32 s9, s9, 1
    s_waitcnt lgkmcnt(0)
    v_cmp_eq_u32 vcc, 0, v18
    s_cmp_ge_u32 s9, 0x40000
    s_cbranch_scc1 RT_SELP
    s_cbranch_vccnz RT_SEL
RT_SELP:
    s_mov_b64 exec, 0xff
    global_store_dword v17, v18, s[48:49] sc1
    s_mov_b64 exec, -1
    s_branch F_DOWN
F_MAIN:
    s_add_u32 m0, s15, 0
    s_add_u32 s8, s14, 0
    buffer_load_dwordx4 v5, s[52:55], s8 offen lds
    s_mov_b32 s60, s42
    s_mov_b32 s61, s43
    s_mov_b32 s62, 5308416
    s_mov_b32 s63, 0x20000
    s_mov_b32 s64, s16
    s_mov_b32 s65, s17
    s_mov_b32 s66, 2359296
    s_mov_b32 s67, 0x20000
    v_lshlrev_b32 v9, 4, v2
    v_lshlrev_b32 v10, 2, v2
    v_mov_b32 v11, 0
    v_lshlrev_b32 v13, 4, v2
    v_and_b32 v8, 0x3c0, v13
    v_add_u32 v8, v8, v13
    v_and_b32 v12, 0x3e0, v13
    v_mul_u32_u24 v12, 3, v12
    v_add_u32 v12, v12, v13
    v_add_u32 v12, 10304, v12
    s_lshl_b32 s8, s3, 11
    v_add_u32 v8, s8, v8
    s_cmp_eq_u32 s3, 7
    s_cselect_b64 vcc, -1, 0
    v_cndmask_b32 v8, v8, v12, vcc
    v_add_u32 v8, 4096, v8
    s_lshl_b32 s8, s3, 8
    s_sub_u32 s8, 0xfff, s8
    v_sub_u32 v20, s8, v10
    v_subrev_u32 v21, 1, v20
    v_subrev_u32 v22, 2, v20
    v_subrev_u32 v23, 3, v20
    v_mov_b32 v13, 163456
    s_lshl_b32 s8, s3, 5
    s_add_u32 s8, s8, 163200
    v_lshl_add_u32 v15, v4, 3, s8
    v_add_u32 v24, 163200, v10
    s_mov_b32 s76, 0xffff
    s_mov_b32 s10, 0x00010001
    s_mov_b32 s11, 0x00010001
    s_barrier
    ds_read_b32 v14, v13 offset:4
    s_add_u32 m0, s15, 73728
    s_add_u32 s8, s14, 0
    buffer_load_dwordx4 v5, s[56:59], s8 offen lds
    s_add_u32 m0, s15, 8192
    s_add_u32 s8, s14, 589824
    buffer_load_dwordx4 v5, s[52:55], s8 offen lds
    s_add_u32 m0, s15, 81920
    s_add_u32 s8, s14, 589824
    buffer_load_dwordx4 v5, s[56:59], s8 offen lds
    s_add_u32 m0, s15, 16384
    s_add_u32 s8, s14, 1179648
    buffer_load_dwordx4 v5, s[52:55], s8 offen lds
    s_mov_b32 s7, 0
    s_waitcnt lgkmcnt(0)
    s_waitcnt vmcnt(0)
F_POLL:
    global_load_dwordx4 v[16:19], v8, s[50:51] sc1
    s_add_u32 s7, s7, 1
    s_waitcnt vmcnt(0)
    v_xor_b32 v25, v16, v14
    v_bitop3_b32 v25, v25, v17, v14 bitop3:0xf6
    v_bitop3_b32 v25, v25, v18, v14 bitop3:0xf6
    v_bitop3_b32 v25, v25, v19, v14 bitop3:0xf6
    v_and_b32 v25, 0xffff, v25
    v_cmp_ne_u32 vcc, 0, v25
    s_cmp_ge_u32 s7, 16384
    s_cbranch_scc1 F_GOT
    s_cbranch_vccz F_GOT
    s_mov_b64 exec, vcc
    s_sleep 4
    s_branch F_POLL
F_GOT:
    s_mov_b64 exec, -1
    v_bfi_b32 v16, s76, v20, v16
    v_bfi_b32 v17, s76, v21, v17
    v_bfi_b32 v18, s76, v22, v18
    v_bfi_b32 v19, s76, v23, v19
    v_max_u32 v25, v16, v17
    v_min_u32 v26, v16, v17
    v_max3_u32 v20, v25, v18, v19
    v_med3_u32 v21, v25, v18, v19
    v_med3_u32 v22, v26, v18, v19
    v_max_u32 v21, v21, v26
    v_min_u32 v22, v22, v25
    v_max_u32_dpp v28, v20, v20 row_ror:8 row_mask:0xf bank_mask:0xf
    s_nop 1
    v_max_u32_dpp v28, v28, v28 row_ror:4 row_mask:0xf bank_mask:0xf
    s_nop 1
    v_max_u32_dpp v28, v28, v28 row_ror:2 row_mask:0xf bank_mask:0xf
    s_nop 1
    v_max_u32_dpp v28, v28, v28 row_ror:1 row_mask:0xf bank_mask:0xf
    v_cmp_eq_u32 vcc, v20, v28
    s_nop 1
    v_cndmask_b32 v20, v20, v21, vcc
    v_cndmask_b32 v21, v21, v22, vcc
    s_nop 0
    v_max_u32_dpp v29, v20, v20 row_ror:8 row_mask:0xf bank_mask:0xf
    s_nop 1
    v_max_u32_dpp v29, v29, v29 row_ror:4 row_mask:0xf bank_mask:0xf
    s_nop 1
    v_max_u32_dpp v29, v29, v29 row_ror:2 row_mask:0xf bank_mask:0xf
    s_nop 1
    v_max_u32_dpp v29, v29, v29 row_ror:1 row_mask:0xf bank_mask:0xf
    v_cmp_eq_u32 vcc, v20, v29
    s_nop 1
    v_cndmask_b32 v20, v20, v21, vcc
    s_nop 1
    v_max_u32_dpp v30, v20, v20 row_ror:8 row_mask:0xf bank_mask:0xf
    s_nop 1
    v_max_u32_dpp v30, v30, v30 row_ror:4 row_mask:0xf bank_mask:0xf
    s_nop 1
    v_max_u32_dpp v30, v30, v30 row_ror:2 row_mask:0xf bank_mask:0xf
    s_nop 1
    v_max_u32_dpp v30, v30, v30 row_ror:1 row_mask:0xf bank_mask:0xf
    s_mov_b64 exec, s[10:11]
    ds_write_b64 v15, v[28:29]
    ds_max_u32 v13, v30
    s_mov_b64 exec, -1
    v_readlane_b32 s77, v28, 0
    v_readlane_b32 s78, v29, 0
    v_readlane_b32 s79, v28, 16
    v_readlane_b32 s80, v29, 16
    v_readlane_b32 s81, v28, 32
    v_readlane_b32 s82, v29, 32
    v_readlane_b32 s83, v28, 48
    v_readlane_b32 s100, v29, 48
    s_add_u32 m0, s15, 90112
    s_add_u32 s8, s14, 1179648
    buffer_load_dwordx4 v5, s[56:59], s8 offen lds
    s_add_u32 m0, s15, 24576
    s_add_u32 s8, s14, 1769472
    buffer_load_dwordx4 v5, s[52:55], s8 offen lds
    s_add_u32 m0, s15, 98304
    s_add_u32 s8, s14, 1769472
    buffer_load_dwordx4 v5, s[56:59], s8 offen lds
    s_add_u32 m0, s15, 32768
    s_add_u32 s8, s14, 2359296
    buffer_load_dwordx4 v5, s[52:55], s8 offen lds
    s_waitcnt lgkmcnt(0)
    s_barrier
    ds_read_b32 v25, v24
    ds_read_b32 v26, v13
    s_or_b32 s8, s2, s3
    s_cmp_lg_u32 s8, 0
    s_cbranch_scc1 F_NOGEN
    global_store_dword v11, v14, s[50:51] sc1
F_NOGEN:
    s_waitcnt lgkmcnt(0)
    v_cmp_gt_u32 vcc, v25, v26
    v_cmp_lt_u32 s[18:19], s77, v25
    v_cmp_lt_u32 s[20:21], s78, v25
    v_cmp_lt_u32 s[22:23], s79, v25
    v_cmp_lt_u32 s[24:25], s80, v25
    v_cmp_lt_u32 s[26:27], s81, v25
    v_cmp_lt_u32 s[28:29], s82, v25
    v_cmp_lt_u32 s[30:31], s83, v25
    v_cmp_lt_u32 s[34:35], s100, v25
    s_bcnt1_i32_b64 s8, vcc
    s_cmp_lt_u32 s8, 8
    s_cbranch_scc1 F_SLOW
    s_bcnt1_i32_b64 s7, s[18:19]
    s_cmp_lt_u32 s7, 8
    s_cbranch_scc0 F_NW0
    s_and_b32 s8, s77, 0x7ff
    s_sub_u32 s8, 2047, s8
    s_mul_i32 s8, s8, 1152
    s_mul_i32 s9, s7, 1312
    s_add_u32 m0, s9, 147456
    s_lshl_b32 s9, s7, 2
    buffer_load_dwordx4 v9, s[64:67], s8 offen lds
    buffer_load_dword v10, s[64:67], s8 offen offset:1024 lds
    v_mov_b32 v12, s77
    v_add_u32 v17, s9, v13
    ds_write_b32 v17, v12 offset:160
F_NW0:
    s_bcnt1_i32_b64 s7, s[20:21]
    s_cmp_lt_u32 s7, 8
    s_cbranch_scc0 F_NW1
    s_and_b32 s8, s78, 0x7ff
    s_sub_u32 s8, 2047, s8
    s_mul_i32 s8, s8, 1152
    s_mul_i32 s9, s7, 1312
    s_add_u32 m0, s9, 147456
    s_lshl_b32 s9, s7, 2
    buffer_load_dwordx4 v9, s[64:67], s8 offen lds
    buffer_load_dword v10, s[64:67], s8 offen offset:1024 lds
    v_mov_b32 v12, s78
    v_add_u32 v17, s9, v13
    ds_write_b32 v17, v12 offset:160
F_NW1:
    s_bcnt1_i32_b64 s7, s[22:23]
    s_cmp_lt_u32 s7, 8
    s_cbranch_scc0 F_NW2
    s_and_b32 s8, s79, 0x7ff
    s_sub_u32 s8, 2047, s8
    s_mul_i32 s8, s8, 1152
    s_mul_i32 s9, s7, 1312
    s_add_u32 m0, s9, 147456
    s_lshl_b32 s9, s7, 2
    buffer_load_dwordx4 v9, s[64:67], s8 offen lds
    buffer_load_dword v10, s[64:67], s8 offen offset:1024 lds
    v_mov_b32 v12, s79
    v_add_u32 v17, s9, v13
    ds_write_b32 v17, v12 offset:160
F_NW2:
    s_bcnt1_i32_b64 s7, s[24:25]
    s_cmp_lt_u32 s7, 8
    s_cbranch_scc0 F_NW3
    s_and_b32 s8, s80, 0x7ff
    s_sub_u32 s8, 2047, s8
    s_mul_i32 s8, s8, 1152
    s_mul_i32 s9, s7, 1312
    s_add_u32 m0, s9, 147456
    s_lshl_b32 s9, s7, 2
    buffer_load_dwordx4 v9, s[64:67], s8 offen lds
    buffer_load_dword v10, s[64:67], s8 offen offset:1024 lds
    v_mov_b32 v12, s80
    v_add_u32 v17, s9, v13
    ds_write_b32 v17, v12 offset:160
F_NW3:
    s_bcnt1_i32_b64 s7, s[26:27]
    s_cmp_lt_u32 s7, 8
    s_cbranch_scc0 F_NW4
    s_and_b32 s8, s81, 0x7ff
    s_sub_u32 s8, 2047, s8
    s_mul_i32 s8, s8, 1152
    s_mul_i32 s9, s7, 1312
    s_add_u32 m0, s9, 147456
    s_lshl_b32 s9, s7, 2
    buffer_load_dwordx4 v9, s[64:67], s8 offen lds
    buffer_load_dword v10, s[64:67], s8 offen offset:1024 lds
    v_mov_b32 v12, s81
    v_add_u32 v17, s9, v13
    ds_write_b32 v17, v12 offset:160
F_NW4:
    s_bcnt1_i32_b64 s7, s[28:29]
    s_cmp_lt_u32 s7, 8
    s_cbranch_scc0 F_NW5
    s_and_b32 s8, s82, 0x7ff
    s_sub_u32 s8, 2047, s8
    s_mul_i32 s8, s8, 1152
    s_mul_i32 s9, s7, 1312
    s_add_u32 m0, s9, 147456
    s_lshl_b32 s9, s7, 2
    buffer_load_dwordx4 v9, s[64:67], s8 offen lds
    buffer_load_dword v10, s[64:67], s8 offen offset:1024 lds
    v_mov_b32 v12, s82
    v_add_u32 v17, s9, v13
    ds_write_b32 v17, v12 offset:160
F_NW5:
    s_bcnt1_i32_b64 s7, s[30:31]
    s_cmp_lt_u32 s7, 8
    s_cbranch_scc0 F_NW6
    s_and_b32 s8, s83, 0x7ff
    s_sub_u32 s8, 2047, s8
    s_mul_i32 s8, s8, 1152
    s_mul_i32 s9, s7, 1312
    s_add_u32 m0, s9, 147456
    s_lshl_b32 s9, s7, 2
    buffer_load_dwordx4 v9, s[64:67], s8 offen lds
    buffer_load_dword v10, s[64:67], s8 offen offset:1024 lds
    v_mov_b32 v12, s83
    v_add_u32 v17, s9, v13
    ds_write_b32 v17, v12 offset:160
F_NW6:
    s_bcnt1_i32_b64 s7, s[34:35]
    s_cmp_lt_u32 s7, 8
    s_cbranch_scc0 F_NW7
    s_and_b32 s8, s100, 0x7ff
    s_sub_u32 s8, 2047, s8
    s_mul_i32 s8, s8, 1152
    s_mul_i32 s9, s7, 1312
    s_add_u32 m0, s9, 147456
    s_lshl_b32 s9, s7, 2
    buffer_load_dwordx4 v9, s[64:67], s8 offen lds
    buffer_load_dword v10, s[64:67], s8 offen offset:1024 lds
    v_mov_b32 v12, s100
    v_add_u32 v17, s9, v13
    ds_write_b32 v17, v12 offset:160
F_NW7:
F_REST:
    s_add_u32 m0, s15, 106496
    s_add_u32 s8, s14, 2359296
    buffer_load_dwordx4 v5, s[56:59], s8 offen lds
    s_add_u32 m0, s15, 40960
    s_add_u32 s8, s14, 2949120
    buffer_load_dwordx4 v5, s[52:55], s8 offen lds
    s_add_u32 m0, s15, 114688
    s_add_u32 s8, s14, 2949120
    buffer_load_dwordx4 v5, s[56:59], s8 offen lds
    s_add_u32 m0, s15, 49152
    s_add_u32 s8, s14, 3538944
    buffer_load_dwordx4 v5, s[52:55], s8 offen lds
    s_add_u32 m0, s15, 122880
    s_add_u32 s8, s14, 3538944
    buffer_load_dwordx4 v5, s[56:59], s8 offen lds
    s_add_u32 m0, s15, 57344
    s_add_u32 s8, s14, 4128768
    buffer_load_dwordx4 v5, s[52:55], s8 offen lds
    s_add_u32 m0, s15, 131072
    s_add_u32 s8, s14, 4128768
    buffer_load_dwordx4 v5, s[56:59], s8 offen lds
    s_add_u32 m0, s15, 65536
    s_add_u32 s8, s14, 4718592
    buffer_load_dwordx4 v5, s[52:55], s8 offen lds
    s_add_u32 m0, s15, 139264
    s_add_u32 s8, s14, 4718592
    buffer_load_dwordx4 v5, s[56:59], s8 offen lds
F_DOWN:
    v_lshrrev_b32 v6, 3, v2
    v_mul_u32_u24 v6, 9216, v6
    v_and_b32 v7, 7, v2
    v_lshl_add_u32 v6, v7, 4, v6
    s_mul_i32 s8, s6, 73728
    s_lshl_b32 s9, s3, 7
    s_add_u32 s8, s8, s9
    s_add_u32 s9, s8, 4608
    s_mov_b64 s[80:81], s[8:9]
    v_mov_b32 v17, v6
    s_and_b32 s12, s3, 3
    s_lshr_b32 s13, s3, 2
    v_and_b32 v5, 1, v4
    v_bfe_u32 v6, v2, 2, 2
    v_lshl_add_u32 v5, v5, 2, v6
    v_lshrrev_b32 v6, 1, v5
    v_xor_b32 v6, s12, v6
    v_lshlrev_b32 v5, 7, v5
    v_lshl_add_u32 v5, v6, 5, v5
    v_and_b32 v6, 3, v2
    v_lshl_add_u32 v5, v6, 3, v5
    v_lshrrev_b32 v6, 1, v4
    v_lshl_add_u32 v5, v6, 11, v5
    s_mul_i32 s8, s13, 36864
    v_add_u32 v5, s8, v5
    v_add_u32 v6, 73728, v5
    v_mul_u32_u24 v8, 1312, v7
    v_lshl_add_u32 v8, v4, 4, v8
    s_mul_i32 s8, s13, 576
    s_add_u32 s8, s8, 147456
    v_add_u32 v8, s8, v8
    s_lshl_b32 s8, s3, 9
    s_add_u32 s8, s8, 157952
    v_lshl_add_u32 v9, v2, 3, s8
    s_xor_b32 s8, s3, 4
    s_lshl_b32 s8, s8, 9
    s_add_u32 s8, s8, 157952
    v_lshl_add_u32 v10, v2, 3, s8
    v_mul_u32_u24 v11, 144, v7
    v_add_u32 v11, 162048, v11
    v_lshrrev_b32 v12, 3, v3
    v_lshl_add_u32 v13, v4, 1, v12
    v_lshl_add_u32 v13, v13, 4, v11
    v_lshl_add_u32 v15, v4, 2, v12
    s_lshl_b32 s8, s12, 4
    s_lshl_b32 s9, s13, 1
    s_add_u32 s8, s8, s9
    v_add_u32 v15, s8, v15
    v_lshl_add_u32 v11, v15, 1, v11
    v_and_b32 v15, 1, v4
    v_lshlrev_b32 v15, 2, v15
    v_add_u32 v15, v15, v12
    v_lshrrev_b32 v16, 1, v4
    v_lshl_add_u32 v15, v15, 1, v16
    v_mul_u32_u24 v15, 9216, v15
    v_lshl_add_u32 v15, v7, 4, v15
    s_mul_i32 s8, s3, 147456
    s_lshl_b32 s9, s6, 7
    s_add_u32 s8, s8, s9
    s_add_u32 s8, s8, 40960
    v_add_u32 v15, s8, v15
    v_add_u32 v16, 36864, v15
    s_mov_b32 s10, 0xff00ff00
    s_mov_b32 s11, 0xff00ff00
    s_mov_b32 s76, 0x05040100
    s_mov_b32 s77, 0x07060302
    s_movk_i32 s78, 0xff
    s_waitcnt vmcnt(0) lgkmcnt(0)
    s_barrier
    s_cmp_ge_u32 s3, 8
    s_cbranch_scc1 F_W8
    ds_read_b128 v[128:131], v8 offset:0
    ds_read_b64_tr_b16 v[24:25], v5 offset:0
    ds_read_b64_tr_b16 v[26:27], v5 offset:1024
    ds_read_b64_tr_b16 v[28:29], v6 offset:0
    ds_read_b64_tr_b16 v[30:31], v6 offset:1024
    ds_read_b128 v[132:135], v8 offset:64
    ds_read_b64_tr_b16 v[32:33], v5 offset:4096
    ds_read_b64_tr_b16 v[34:35], v5 offset:5120
    ds_read_b64_tr_b16 v[36:37], v6 offset:4096
    ds_read_b64_tr_b16 v[38:39], v6 offset:5120
    ds_read_b128 v[136:139], v8 offset:128
    ds_read_b64_tr_b16 v[40:41], v5 offset:8192
    ds_read_b64_tr_b16 v[42:43], v5 offset:9216
    ds_read_b64_tr_b16 v[44:45], v6 offset:8192
    ds_read_b64_tr_b16 v[46:47], v6 offset:9216
    s_waitcnt lgkmcnt(10)
    v_mfma_f32_16x16x32_bf16 v[160:163], v[24:27], v[128:131], 0
    v_mfma_f32_16x16x32_bf16 v[164:167], v[28:31], v[128:131], 0
    ds_read_b128 v[140:143], v8 offset:192
    ds_read_b64_tr_b16 v[48:49], v5 offset:12288
    ds_read_b64_tr_b16 v[50:51], v5 offset:13312
    ds_read_b64_tr_b16 v[52:53], v6 offset:12288
    ds_read_b64_tr_b16 v[54:55], v6 offset:13312
    buffer_load_dwordx4 v[96:99], v17, s[60:63], s80 offen offset:0
    s_waitcnt lgkmcnt(10)
    v_mfma_f32_16x16x32_bf16 v[160:163], v[32:35], v[132:135], v[160:163]
    v_mfma_f32_16x16x32_bf16 v[164:167], v[36:39], v[132:135], v[164:167]
    ds_read_b128 v[144:147], v8 offset:256
    ds_read_b64_tr_b16 v[56:57], v5 offset:16384
    ds_read_b64_tr_b16 v[58:59], v5 offset:17408
    ds_read_b64_tr_b16 v[60:61], v6 offset:16384
    ds_read_b64_tr_b16 v[62:63], v6 offset:17408
    buffer_load_dwordx4 v[100:103], v17, s[60:63], s80 offen offset:1152
    s_waitcnt lgkmcnt(10)
    v_mfma_f32_16x16x32_bf16 v[160:163], v[40:43], v[136:139], v[160:163]
    v_mfma_f32_16x16x32_bf16 v[164:167], v[44:47], v[136:139], v[164:167]
    ds_read_b128 v[148:151], v8 offset:320
    ds_read_b64_tr_b16 v[64:65], v5 offset:20480
    ds_read_b64_tr_b16 v[66:67], v5 offset:21504
    ds_read_b64_tr_b16 v[68:69], v6 offset:20480
    ds_read_b64_tr_b16 v[70:71], v6 offset:21504
    buffer_load_dwordx4 v[104:107], v17, s[60:63], s80 offen offset:2304
    s_waitcnt lgkmcnt(10)
    v_mfma_f32_16x16x32_bf16 v[160:163], v[48:51], v[140:143], v[160:163]
    v_mfma_f32_16x16x32_bf16 v[164:167], v[52:55], v[140:143], v[164:167]
    ds_read_b128 v[152:155], v8 offset:384
    ds_read_b64_tr_b16 v[72:73], v5 offset:24576
    ds_read_b64_tr_b16 v[74:75], v5 offset:25600
    ds_read_b64_tr_b16 v[76:77], v6 offset:24576
    ds_read_b64_tr_b16 v[78:79], v6 offset:25600
    buffer_load_dwordx4 v[108:111], v17, s[60:63], s80 offen offset:3456
    s_waitcnt lgkmcnt(10)
    v_mfma_f32_16x16x32_bf16 v[160:163], v[56:59], v[144:147], v[160:163]
    v_mfma_f32_16x16x32_bf16 v[164:167], v[60:63], v[144:147], v[164:167]
    ds_read_b128 v[156:159], v8 offset:448
    ds_read_b64_tr_b16 v[80:81], v5 offset:28672
    ds_read_b64_tr_b16 v[82:83], v5 offset:29696
    ds_read_b64_tr_b16 v[84:85], v6 offset:28672
    ds_read_b64_tr_b16 v[86:87], v6 offset:29696
    buffer_load_dwordx4 v[112:115], v17, s[60:63], s81 offen offset:0
    s_waitcnt lgkmcnt(10)
    v_mfma_f32_16x16x32_bf16 v[160:163], v[64:67], v[148:151], v[160:163]
    v_mfma_f32_16x16x32_bf16 v[164:167], v[68:71], v[148:151], v[164:167]
    ds_read_b128 v[128:131], v8 offset:512
    ds_read_b64_tr_b16 v[88:89], v5 offset:32768
    ds_read_b64_tr_b16 v[90:91], v5 offset:33792
    ds_read_b64_tr_b16 v[92:93], v6 offset:32768
    ds_read_b64_tr_b16 v[94:95], v6 offset:33792
    buffer_load_dwordx4 v[116:119], v17, s[60:63], s81 offen offset:1152
    s_waitcnt lgkmcnt(10)
    v_mfma_f32_16x16x32_bf16 v[160:163], v[72:75], v[152:155], v[160:163]
    v_mfma_f32_16x16x32_bf16 v[164:167], v[76:79], v[152:155], v[164:167]
    buffer_load_dwordx4 v[120:123], v17, s[60:63], s81 offen offset:2304
    s_waitcnt lgkmcnt(5)
    v_mfma_f32_16x16x32_bf16 v[160:163], v[80:83], v[156:159], v[160:163]
    v_mfma_f32_16x16x32_bf16 v[164:167], v[84:87], v[156:159], v[164:167]
    buffer_load_dwordx4 v[124:127], v17, s[60:63], s81 offen offset:3456
    s_waitcnt lgkmcnt(0)
    v_mfma_f32_16x16x32_bf16 v[160:163], v[88:91], v[128:131], v[160:163]
    v_mfma_f32_16x16x32_bf16 v[164:167], v[92:95], v[128:131], v[164:167]
    s_cmp_eq_u32 s13, 0
    s_cselect_b64 vcc, -1, 0
    s_nop 5
    v_cndmask_b32 v24, v160, v161, s[10:11]
    v_cndmask_b32 v25, v162, v163, s[10:11]
    v_cndmask_b32 v26, v164, v165, s[10:11]
    v_cndmask_b32 v27, v166, v167, s[10:11]
    v_cndmask_b32 v28, v24, v25, vcc
    v_cndmask_b32 v29, v26, v27, vcc
    ds_write_b64 v9, v[28:29]
    v_cndmask_b32 v24, v25, v24, vcc
    v_cndmask_b32 v25, v27, v26, vcc
    s_waitcnt lgkmcnt(0)
    s_barrier
    ds_read_b64 v[28:29], v10
    s_waitcnt lgkmcnt(0)
    v_add_f32 v24, v24, v28
    v_add_f32 v25, v25, v29
    v_cvt_pk_bf16_f32 v24, v24, v25
    v_lshlrev_b32 v25, 16, v24
    v_mul_f32 v26, 0xbfb8aa3b, v25
    v_exp_f32 v26, v26
    v_and_b32 v24, 0xffff0000, v24
    v_add_f32 v26, 1.0, v26
    v_rcp_f32 v26, v26
    s_nop 0
    v_mul_f32 v25, v25, v26
    v_cvt_pk_bf16_f32 v25, v25, v25
    v_and_b32 v25, 0xffff0000, v25
    v_mul_f32 v24, v24, v25
    v_cvt_pk_bf16_f32 v24, v24, v24
    ds_write_b16 v11, v24
    s_branch F_H
F_W8:
    buffer_load_dwordx4 v[96:99], v17, s[60:63], s80 offen offset:0
    buffer_load_dwordx4 v[100:103], v17, s[60:63], s80 offen offset:1152
    buffer_load_dwordx4 v[104:107], v17, s[60:63], s80 offen offset:2304
    buffer_load_dwordx4 v[108:111], v17, s[60:63], s80 offen offset:3456
    buffer_load_dwordx4 v[112:115], v17, s[60:63], s81 offen offset:0
    buffer_load_dwordx4 v[116:119], v17, s[60:63], s81 offen offset:1152
    buffer_load_dwordx4 v[120:123], v17, s[60:63], s81 offen offset:2304
    buffer_load_dwordx4 v[124:127], v17, s[60:63], s81 offen offset:3456
    s_barrier
F_H:
    s_waitcnt vmcnt(0)
    v_perm_b32 v128, v100, v96, s76
    v_perm_b32 v129, v108, v104, s76
    v_perm_b32 v130, v116, v112, s76
    v_perm_b32 v131, v124, v120, s76
    v_perm_b32 v132, v100, v96, s77
    v_perm_b32 v133, v108, v104, s77
    v_perm_b32 v134, v116, v112, s77
    v_perm_b32 v135, v124, v120, s77
    v_perm_b32 v136, v101, v97, s76
    v_perm_b32 v137, v109, v105, s76
    v_perm_b32 v138, v117, v113, s76
    v_perm_b32 v139, v125, v121, s76
    v_perm_b32 v140, v101, v97, s77
    v_perm_b32 v141, v109, v105, s77
    v_perm_b32 v142, v117, v113, s77
    v_perm_b32 v143, v125, v121, s77
    v_perm_b32 v144, v102, v98, s76
    v_perm_b32 v145, v110, v106, s76
    v_perm_b32 v146, v118, v114, s76
    v_perm_b32 v147, v126, v122, s76
    v_perm_b32 v148, v102, v98, s77
    v_perm_b32 v149, v110, v106, s77
    v_perm_b32 v150, v118, v114, s77
    v_perm_b32 v151, v126, v122, s77
    v_perm_b32 v152, v103, v99, s76
    v_perm_b32 v153, v111, v107, s76
    v_perm_b32 v154, v119, v115, s76
    v_perm_b32 v155, v127, v123, s76
    v_perm_b32 v156, v103, v99, s77
    v_perm_b32 v157, v111, v107, s77
    v_perm_b32 v158, v119, v115, s77
    v_perm_b32 v159, v127, v123, s77
    s_waitcnt lgkmcnt(0)
    s_barrier
    ds_read_b128 v[24:27], v13
    s_waitcnt lgkmcnt(0)
    v_mfma_f32_16x16x32_bf16 v[32:35], v[128:131], v[24:27], 0
    v_mfma_f32_16x16x32_bf16 v[48:51], v[144:147], v[24:27], 0
    v_mfma_f32_16x16x32_bf16 v[36:39], v[132:135], v[24:27], 0
    v_mfma_f32_16x16x32_bf16 v[52:55], v[148:151], v[24:27], 0
    v_mfma_f32_16x16x32_bf16 v[40:43], v[136:139], v[24:27], 0
    v_mfma_f32_16x16x32_bf16 v[56:59], v[152:155], v[24:27], 0
    v_mfma_f32_16x16x32_bf16 v[44:47], v[140:143], v[24:27], 0
    v_mfma_f32_16x16x32_bf16 v[60:63], v[156:159], v[24:27], 0
    s_nop 1
    v_permlane32_swap_b32 v32, v48
    v_permlane32_swap_b32 v33, v49
    v_permlane32_swap_b32 v34, v50
    v_permlane32_swap_b32 v35, v51
    v_permlane32_swap_b32 v36, v52
    v_permlane32_swap_b32 v37, v53
    v_permlane32_swap_b32 v38, v54
    v_permlane32_swap_b32 v39, v55
    v_permlane32_swap_b32 v40, v56
    v_permlane32_swap_b32 v41, v57
    v_permlane32_swap_b32 v42, v58
    v_permlane32_swap_b32 v43, v59
    v_permlane32_swap_b32 v44, v60
    v_permlane32_swap_b32 v45, v61
    v_permlane32_swap_b32 v46, v62
    v_permlane32_swap_b32 v47, v63
    v_add_f32_dpp v64, v48, v32 row_ror:8 row_mask:0xf bank_mask:0x3
    v_add_f32_dpp v65, v52, v36 row_ror:8 row_mask:0xf bank_mask:0x3
    v_add_f32_dpp v66, v56, v40 row_ror:8 row_mask:0xf bank_mask:0x3
    v_add_f32_dpp v67, v60, v44 row_ror:8 row_mask:0xf bank_mask:0x3
    v_add_f32_dpp v64, v33, v49 row_ror:8 row_mask:0xf bank_mask:0xc
    v_add_f32_dpp v65, v37, v53 row_ror:8 row_mask:0xf bank_mask:0xc
    v_add_f32_dpp v66, v41, v57 row_ror:8 row_mask:0xf bank_mask:0xc
    v_add_f32_dpp v67, v45, v61 row_ror:8 row_mask:0xf bank_mask:0xc
    v_add_f32_dpp v68, v50, v34 row_ror:8 row_mask:0xf bank_mask:0x3
    v_add_f32_dpp v69, v54, v38 row_ror:8 row_mask:0xf bank_mask:0x3
    v_add_f32_dpp v70, v58, v42 row_ror:8 row_mask:0xf bank_mask:0x3
    v_add_f32_dpp v71, v62, v46 row_ror:8 row_mask:0xf bank_mask:0x3
    v_add_f32_dpp v68, v35, v51 row_ror:8 row_mask:0xf bank_mask:0xc
    v_add_f32_dpp v69, v39, v55 row_ror:8 row_mask:0xf bank_mask:0xc
    v_add_f32_dpp v70, v43, v59 row_ror:8 row_mask:0xf bank_mask:0xc
    v_add_f32_dpp v71, v47, v63 row_ror:8 row_mask:0xf bank_mask:0xc
    v_bfi_b32 v64, s78, v14, v64
    v_bfi_b32 v65, s78, v14, v65
    v_bfi_b32 v66, s78, v14, v66
    v_bfi_b32 v67, s78, v14, v67
    global_store_dwordx4 v15, v[64:67], s[50:51] sc1
    v_bfi_b32 v68, s78, v14, v68
    v_bfi_b32 v69, s78, v14, v69
    v_bfi_b32 v70, s78, v14, v70
    v_bfi_b32 v71, s78, v14, v71
    global_store_dwordx4 v16, v[68:71], s[50:51] sc1
    s_endpgm
F_SLOW:
    v_lshlrev_b32 v20, 4, v2
    v_and_b32 v8, 0x3c0, v20
    v_add_u32 v8, v8, v20
    v_and_b32 v21, 0x3e0, v20
    v_mul_u32_u24 v21, 3, v21
    v_add_u32 v21, v21, v20
    v_add_u32 v21, 10304, v21
    v_add_u32 v8, 8192, v8
    v_add_u32 v12, 8192, v8
    v_add_u32 v21, 2048, v21
    global_load_dwordx4 v[24:27], v8, s[50:51] offset:-4096 sc1
    global_load_dwordx4 v[28:31], v8, s[50:51] offset:-2048 sc1
    global_load_dwordx4 v[32:35], v8, s[50:51] offset:0 sc1
    global_load_dwordx4 v[36:39], v8, s[50:51] offset:2048 sc1
    global_load_dwordx4 v[40:43], v12, s[50:51] offset:-4096 sc1
    global_load_dwordx4 v[44:47], v12, s[50:51] offset:-2048 sc1
    global_load_dwordx4 v[48:51], v12, s[50:51] offset:0 sc1
    global_load_dwordx4 v[52:55], v21, s[50:51] offset:2048 sc1
    v_sub_u32 v20, 0xfff, v10
    s_waitcnt vmcnt(0)
    v_subrev_u32 v21, 0, v20
    v_bfi_b32 v24, s76, v21, v24
    v_subrev_u32 v21, 1, v20
    v_bfi_b32 v25, s76, v21, v25
    v_subrev_u32 v21, 2, v20
    v_bfi_b32 v26, s76, v21, v26
    v_subrev_u32 v21, 3, v20
    v_bfi_b32 v27, s76, v21, v27
    v_subrev_u32 v21, 256, v20
    v_bfi_b32 v28, s76, v21, v28
    v_subrev_u32 v21, 257, v20
    v_bfi_b32 v29, s76, v21, v29
    v_subrev_u32 v21, 258, v20
    v_bfi_b32 v30, s76, v21, v30
    v_subrev_u32 v21, 259, v20
    v_bfi_b32 v31, s76, v21, v31
    v_subrev_u32 v21, 512, v20
    v_bfi_b32 v32, s76, v21, v32
    v_subrev_u32 v21, 513, v20
    v_bfi_b32 v33, s76, v21, v33
    v_subrev_u32 v21, 514, v20
    v_bfi_b32 v34, s76, v21, v34
    v_subrev_u32 v21, 515, v20
    v_bfi_b32 v35, s76, v21, v35
    v_subrev_u32 v21, 768, v20
    v_bfi_b32 v36, s76, v21, v36
    v_subrev_u32 v21, 769, v20
    v_bfi_b32 v37, s76, v21, v37
    v_subrev_u32 v21, 770, v20
    v_bfi_b32 v38, s76, v21, v38
    v_subrev_u32 v21, 771, v20
    v_bfi_b32 v39, s76, v21, v39
    v_subrev_u32 v21, 1024, v20
    v_bfi_b32 v40, s76, v21, v40
    v_subrev_u32 v21, 1025, v20
    v_bfi_b32 v41, s76, v21, v41
    v_subrev_u32 v21, 1026, v20
    v_bfi_b32 v42, s76, v21, v42
    v_subrev_u32 v21, 1027, v20
    v_bfi_b32 v43, s76, v21, v43
    v_subrev_u32 v21, 1280, v20
    v_bfi_b32 v44, s76, v21, v44
    v_subrev_u32 v21, 1281, v20
    v_bfi_b32 v45, s76, v21, v45
    v_subrev_u32 v21, 1282, v20
    v_bfi_b32 v46, s76, v21, v46
    v_subrev_u32 v21, 1283, v20
    v_bfi_b32 v47, s76, v21, v47
    v_subrev_u32 v21, 1536, v20
    v_bfi_b32 v48, s76, v21, v48
    v_subrev_u32 v21, 1537, v20
    v_bfi_b32 v49, s76, v21, v49
    v_subrev_u32 v21, 1538, v20
    v_bfi_b32 v50, s76, v21, v50
    v_subrev_u32 v21, 1539, v20
    v_bfi_b32 v51, s76, v21, v51
    v_subrev_u32 v21, 1792, v20
    v_bfi_b32 v52, s76, v21, v52
    v_subrev_u32 v21, 1793, v20
    v_bfi_b32 v53, s76, v21, v53
    v_subrev_u32 v21, 1794, v20
    v_bfi_b32 v54, s76, v21, v54
    v_subrev_u32 v21, 1795, v20
    v_bfi_b32 v55, s76, v21, v55
    s_mov_b32 s77, 0
    s_mov_b32 s7, 0
F_SLOOP:
    v_subrev_u32 v56, s77, v24
    v_subrev_u32 v57, s77, v25
    v_subrev_u32 v58, s77, v26
    v_subrev_u32 v59, s77, v27
    v_subrev_u32 v60, s77, v28
    v_subrev_u32 v61, s77, v29
    v_subrev_u32 v62, s77, v30
    v_subrev_u32 v63, s77, v31
    v_subrev_u32 v64, s77, v32
    v_subrev_u32 v65, s77, v33
    v_subrev_u32 v66, s77, v34
    v_subrev_u32 v67, s77, v35
    v_subrev_u32 v68, s77, v36
    v_subrev_u32 v69, s77, v37
    v_subrev_u32 v70, s77, v38
    v_subrev_u32 v71, s77, v39
    v_subrev_u32 v72, s77, v40
    v_subrev_u32 v73, s77, v41
    v_subrev_u32 v74, s77, v42
    v_subrev_u32 v75, s77, v43
    v_subrev_u32 v76, s77, v44
    v_subrev_u32 v77, s77, v45
    v_subrev_u32 v78, s77, v46
    v_subrev_u32 v79, s77, v47
    v_subrev_u32 v80, s77, v48
    v_subrev_u32 v81, s77, v49
    v_subrev_u32 v82, s77, v50
    v_subrev_u32 v83, s77, v51
    v_subrev_u32 v84, s77, v52
    v_subrev_u32 v85, s77, v53
    v_subrev_u32 v86, s77, v54
    v_subrev_u32 v87, s77, v55
    v_max_u32 v56, v56, v57
    v_max3_u32 v56, v56, v58, v59
    v_max3_u32 v56, v56, v60, v61
    v_max3_u32 v56, v56, v62, v63
    v_max3_u32 v56, v56, v64, v65
    v_max3_u32 v56, v56, v66, v67
    v_max3_u32 v56, v56, v68, v69
    v_max3_u32 v56, v56, v70, v71
    v_max3_u32 v56, v56, v72, v73
    v_max3_u32 v56, v56, v74, v75
    v_max3_u32 v56, v56, v76, v77
    v_max3_u32 v56, v56, v78, v79
    v_max3_u32 v56, v56, v80, v81
    v_max3_u32 v56, v56, v82, v83
    v_max3_u32 v56, v56, v84, v85
    v_max3_u32 v56, v56, v86, v87
    s_nop 1
    v_max_u32_dpp v56, v56, v56 row_shr:1 row_mask:0xf bank_mask:0xf
    s_nop 1
    v_max_u32_dpp v56, v56, v56 row_shr:2 row_mask:0xf bank_mask:0xf
    s_nop 1
    v_max_u32_dpp v56, v56, v56 row_shr:4 row_mask:0xf bank_mask:0xf
    s_nop 1
    v_max_u32_dpp v56, v56, v56 row_shr:8 row_mask:0xf bank_mask:0xf
    s_nop 1
    v_max_u32_dpp v56, v56, v56 row_bcast:15 row_mask:0xa bank_mask:0xf
    s_nop 1
    v_max_u32_dpp v56, v56, v56 row_bcast:31 row_mask:0xc bank_mask:0xf
    s_nop 0
    v_readlane_b32 s8, v56, 63
    s_add_u32 s77, s77, s8
    s_add_u32 s7, s7, 1
    s_cmp_le_u32 s7, s3
    s_cbranch_scc1 F_SLOOP
    s_and_b32 s8, s77, 0x7ff
    s_sub_u32 s8, 2047, s8
    s_mul_i32 s8, s8, 1152
    s_mul_i32 s9, s3, 1312
    s_add_u32 m0, s9, 147456
    s_lshl_b32 s9, s3, 2
    buffer_load_dwordx4 v9, s[64:67], s8 offen lds
    buffer_load_dword v10, s[64:67], s8 offen offset:1024 lds
    v_mov_b32 v12, s77
    v_add_u32 v17, s9, v13
    ds_write_b32 v17, v12 offset:160
    s_branch F_REST
CK_MAIN:
    s_lshl_b32 s13, s7, 13
    s_add_u32 s13, s13, 120832
    s_lshr_b32 s14, s7, 1
    s_mul_i32 s14, s14, 60192
    s_and_b32 s8, s7, 1
    s_lshl_b32 s8, s8, 9
    s_add_u32 s14, s14, s8
    s_lshl_b32 s8, s12, 8
    s_add_u32 m0, s14, s8
    v_mov_b32 v124, 0
    v_mov_b32 v125, 0
    v_mov_b32 v126, 0
    v_mov_b32 v127, 0
    s_lshl_b32 s8, s12, 11
    s_add_u32 s8, s8, s13
    v_lshl_add_u32 v20, v2, 4, s8
    ds_write_b128 v20, v[124:127]
    ds_write_b128 v20, v[124:127] offset:1024
    v_mul_u32_u24 v128, 1056, v3
    v_lshl_add_u32 v128, v4, 4, v128
    v_add_u32 v128, s14, v128
    s_lshl_b32 s8, s3, 2
    s_add_u32 s9, s8, 153632
    v_mov_b32 v129, s9
    s_xor_b32 s8, s8, 16
    s_add_u32 s9, s8, 153632
    v_mov_b32 v130, s9
    v_mov_b32 v21, 0x3c00
    ds_write_addtid_b32 v21 offset:43296
    v_mov_b32 v22, 0x3fb8aa3b
    v_mov_b32 v23, 0x32a57060
    v_mov_b32 v24, 0x3fb8aa3b
    v_mov_b32 v25, 0x3e22f983
    s_mov_b32 s15, 0x7fff7fff
    s_cmp_eq_u32 s12, 0
    s_cbranch_scc1 CK_NOC
    v_lshlrev_b32 v74, 3, v4
    v_sub_u32 v74, v74, v3
    v_and_b32 v74, 0xffff, v74
    v_lshl_or_b32 v74, v74, 16, v74
    v_mov_b32 v75, 0x3c003c00
    s_mov_b32 s8, 0xfff0fff1
    v_pk_add_u16 v76, v74, s8
    s_mov_b32 s8, 0xfff2fff3
    v_pk_add_u16 v77, v74, s8
    s_mov_b32 s8, 0xfff4fff5
    v_pk_add_u16 v78, v74, s8
    s_mov_b32 s8, 0xfff6fff7
    v_pk_add_u16 v79, v74, s8
    v_pk_add_u16 v80, v76, 2 op_sel_hi:[1,0]
    v_pk_ashrrev_i16 v80, 15, v80 op_sel_hi:[0,1]
    v_pk_add_u16 v81, v77, 2 op_sel_hi:[1,0]
    v_pk_ashrrev_i16 v81, 15, v81 op_sel_hi:[0,1]
    v_pk_add_u16 v82, v78, 2 op_sel_hi:[1,0]
    v_pk_ashrrev_i16 v82, 15, v82 op_sel_hi:[0,1]
    v_pk_add_u16 v83, v79, 2 op_sel_hi:[1,0]
    v_pk_ashrrev_i16 v83, 15, v83 op_sel_hi:[0,1]
    v_pk_add_u16 v84, v76, 3 op_sel_hi:[1,0]
    v_pk_ashrrev_i16 v84, 15, v84 op_sel_hi:[0,1]
    v_pk_add_u16 v85, v77, 3 op_sel_hi:[1,0]
    v_pk_ashrrev_i16 v85, 15, v85 op_sel_hi:[0,1]
    v_pk_add_u16 v86, v78, 3 op_sel_hi:[1,0]
    v_pk_ashrrev_i16 v86, 15, v86 op_sel_hi:[0,1]
    v_pk_add_u16 v87, v79, 3 op_sel_hi:[1,0]
    v_pk_ashrrev_i16 v87, 15, v87 op_sel_hi:[0,1]
    v_pk_add_u16 v88, v76, 4 op_sel_hi:[1,0]
    v_pk_ashrrev_i16 v88, 15, v88 op_sel_hi:[0,1]
    v_pk_add_u16 v89, v77, 4 op_sel_hi:[1,0]
    v_pk_ashrrev_i16 v89, 15, v89 op_sel_hi:[0,1]
    v_pk_add_u16 v90, v78, 4 op_sel_hi:[1,0]
    v_pk_ashrrev_i16 v90, 15, v90 op_sel_hi:[0,1]
    v_pk_add_u16 v91, v79, 4 op_sel_hi:[1,0]
    v_pk_ashrrev_i16 v91, 15, v91 op_sel_hi:[0,1]
    v_pk_add_u16 v92, v76, 5 op_sel_hi:[1,0]
    v_pk_ashrrev_i16 v92, 15, v92 op_sel_hi:[0,1]
    v_pk_add_u16 v93, v77, 5 op_sel_hi:[1,0]
    v_pk_ashrrev_i16 v93, 15, v93 op_sel_hi:[0,1]
    v_pk_add_u16 v94, v78, 5 op_sel_hi:[1,0]
    v_pk_ashrrev_i16 v94, 15, v94 op_sel_hi:[0,1]
    v_pk_add_u16 v95, v79, 5 op_sel_hi:[1,0]
    v_pk_ashrrev_i16 v95, 15, v95 op_sel_hi:[0,1]
    v_pk_add_u16 v96, v76, 10 op_sel_hi:[1,0]
    v_pk_ashrrev_i16 v96, 15, v96 op_sel_hi:[0,1]
    v_pk_add_u16 v97, v77, 10 op_sel_hi:[1,0]
    v_pk_ashrrev_i16 v97, 15, v97 op_sel_hi:[0,1]
    v_pk_add_u16 v98, v78, 10 op_sel_hi:[1,0]
    v_pk_ashrrev_i16 v98, 15, v98 op_sel_hi:[0,1]
    v_pk_add_u16 v99, v79, 10 op_sel_hi:[1,0]
    v_pk_ashrrev_i16 v99, 15, v99 op_sel_hi:[0,1]
    v_pk_add_u16 v100, v76, 11 op_sel_hi:[1,0]
    v_pk_ashrrev_i16 v100, 15, v100 op_sel_hi:[0,1]
    v_pk_add_u16 v101, v77, 11 op_sel_hi:[1,0]
    v_pk_ashrrev_i16 v101, 15, v101 op_sel_hi:[0,1]
    v_pk_add_u16 v102, v78, 11 op_sel_hi:[1,0]
    v_pk_ashrrev_i16 v102, 15, v102 op_sel_hi:[0,1]
    v_pk_add_u16 v103, v79, 11 op_sel_hi:[1,0]
    v_pk_ashrrev_i16 v103, 15, v103 op_sel_hi:[0,1]
    v_pk_add_u16 v104, v76, 12 op_sel_hi:[1,0]
    v_pk_ashrrev_i16 v104, 15, v104 op_sel_hi:[0,1]
    v_pk_add_u16 v105, v77, 12 op_sel_hi:[1,0]
    v_pk_ashrrev_i16 v105, 15, v105 op_sel_hi:[0,1]
    v_pk_add_u16 v106, v78, 12 op_sel_hi:[1,0]
    v_pk_ashrrev_i16 v106, 15, v106 op_sel_hi:[0,1]
    v_pk_add_u16 v107, v79, 12 op_sel_hi:[1,0]
    v_pk_ashrrev_i16 v107, 15, v107 op_sel_hi:[0,1]
    v_bitop3_b32 v140, v80, v92, v75 bitop3:0x28
    v_bitop3_b32 v141, v81, v93, v75 bitop3:0x28
    v_bitop3_b32 v142, v82, v94, v75 bitop3:0x28
    v_bitop3_b32 v143, v83, v95, v75 bitop3:0x28
    v_bitop3_b32 v144, v92, v96, v75 bitop3:0x28
    v_bitop3_b32 v145, v93, v97, v75 bitop3:0x28
    v_bitop3_b32 v146, v94, v98, v75 bitop3:0x28
    v_bitop3_b32 v147, v95, v99, v75 bitop3:0x28
    v_bitop3_b32 v148, v88, v100, v75 bitop3:0x28
    v_bitop3_b32 v149, v89, v101, v75 bitop3:0x28
    v_bitop3_b32 v150, v90, v102, v75 bitop3:0x28
    v_bitop3_b32 v151, v91, v103, v75 bitop3:0x28
    v_bitop3_b32 v152, v84, v104, v75 bitop3:0x28
    v_bitop3_b32 v153, v85, v105, v75 bitop3:0x28
    v_bitop3_b32 v154, v86, v106, v75 bitop3:0x28
    v_bitop3_b32 v155, v87, v107, v75 bitop3:0x28
    v_xor_b32 v156, v80, v88
    v_xor_b32 v157, v81, v89
    v_xor_b32 v158, v82, v90
    v_xor_b32 v159, v83, v91
CK_NOC:
    s_waitcnt vmcnt(10)
    v_mul_f32 v19, v18, v22
    v_fma_f32 v22, v18, v22, -v19
    v_exp_f32 v19, v19
    v_fma_f32 v22, v18, v23, v22
    v_mul_f32 v22, 0x3f317218, v22
    v_fma_f32 v19, v19, v22, v19
    v_cvt_pk_bf16_f32 v19, v19, v19
    v_and_b32 v18, 0xffff0000, v19
    v_pk_mul_f32 v[24:25], v[24:25], v[18:19] op_sel_hi:[1,0]
    s_waitcnt vmcnt(0)
    v_and_b32 v14, s15, v14
    v_and_b32 v15, s15, v15
    v_and_b32 v16, s15, v16
    v_and_b32 v17, s15, v17
    v_pk_max_u16 v14, v14, v15
    v_pk_max_u16 v16, v16, v17
    v_lshlrev_b32 v15, 16, v14
    v_lshlrev_b32 v17, 16, v16
    v_pk_mul_f32 v[14:15], v[14:15], v[16:17]
    v_pk_mul_f32 v[8:9], v[8:9], v[24:25]
    v_max_f32 v14, v14, v15
    v_pk_mul_f32 v[10:11], v[10:11], v[18:19] op_sel_hi:[1,0]
    v_mul_f32 v14, v14, v18
    v_pk_mul_f32 v[66:67], v[12:13], v[10:11] op_sel:[1,1] op_sel_hi:[1,0]
    v_pk_fma_f32 v[56:57], v[12:13], v[10:11], v[66:67] op_sel:[0,0,0] op_sel_hi:[0,1,1] neg_lo:[0,0,1]
    v_max_u32_dpp v14, v14, v14 row_shr:1 row_mask:0xf bank_mask:0xf
    v_mul_f32 v60, 0x41000000, v8
    v_mul_f32 v61, 0xc1000000, v9
    v_max_u32_dpp v14, v14, v14 row_shr:2 row_mask:0xf bank_mask:0xf
    v_mul_f32 v62, 0x43000000, v8
    v_mul_f32 v63, 0x43000000, v9
    v_max_u32_dpp v14, v14, v14 row_shr:4 row_mask:0xf bank_mask:0xf
    v_fract_f32 v59, v9
    v_fract_f32 v61, v61
    v_max_u32_dpp v14, v14, v14 row_shr:8 row_mask:0xf bank_mask:0xf
    v_fract_f32 v63, v63
    v_exp_f32 v20, v8
    v_max_u32_dpp v14, v14, v14 row_bcast:15 row_mask:0xa bank_mask:0xf
    v_exp_f32 v22, v60
    v_exp_f32 v26, v62
    v_max_u32_dpp v14, v14, v14 row_bcast:31 row_mask:0xc bank_mask:0xf
    v_cos_f32 v60, v61
    v_readlane_b32 s8, v14, 63
    v_sin_f32 v61, v61
    v_cos_f32 v58, v59
    v_sin_f32 v59, v59
    v_cos_f32 v62, v63
    v_sin_f32 v63, v63
    s_lshr_b32 s8, s8, 23
    s_sub_i32 s8, 258, s8
    s_max_i32 s8, s8, 1
    s_min_i32 s8, s8, 253
    s_lshl_b32 s10, s8, 23
    v_pk_mul_f32 v[60:61], v[60:61], v[22:23] op_sel_hi:[1,0]
    v_pk_mul_f32 v[58:59], v[58:59], v[20:21] op_sel_hi:[1,0]
    v_pk_mul_f32 v[62:63], v[62:63], v[26:27] op_sel_hi:[1,0]
    v_pk_mul_f32 v[56:57], v[56:57], s[10:11] op_sel_hi:[1,0]
    v_cvt_pk_f16_f32 v70, v60, v61
    ds_write_addtid_b32 v70 offset:44352
    v_cvt_pk_f16_f32 v71, v56, v57
    ds_write_addtid_b32 v71 offset:42240
    v_pk_mul_f32 v[66:67], v[56:57], v[58:59] op_sel:[1,1] op_sel_hi:[1,0]
    v_pk_fma_f32 v[40:41], v[56:57], v[58:59], v[66:67] op_sel:[0,0,0] op_sel_hi:[0,1,1] neg_lo:[0,0,1]
    v_cvt_pk_f16_f32 v72, v40, v41
    ds_write_addtid_b32 v72 offset:0
    v_pk_mul_f32 v[66:67], v[40:41], v[58:59] op_sel:[1,1] op_sel_hi:[1,0]
    v_pk_fma_f32 v[42:43], v[40:41], v[58:59], v[66:67] op_sel:[0,0,0] op_sel_hi:[0,1,1] neg_lo:[0,0,1]
    v_cvt_pk_f16_f32 v73, v42, v43
    ds_write_addtid_b32 v73 offset:1056
    v_pk_mul_f32 v[66:67], v[42:43], v[58:59] op_sel:[1,1] op_sel_hi:[1,0]
    v_pk_fma_f32 v[44:45], v[42:43], v[58:59], v[66:67] op_sel:[0,0,0] op_sel_hi:[0,1,1] neg_lo:[0,0,1]
    v_cvt_pk_f16_f32 v70, v44, v45
    ds_write_addtid_b32 v70 offset:2112
    v_pk_mul_f32 v[66:67], v[44:45], v[58:59] op_sel:[1,1] op_sel_hi:[1,0]
    v_pk_fma_f32 v[46:47], v[44:45], v[58:59], v[66:67] op_sel:[0,0,0] op_sel_hi:[0,1,1] neg_lo:[0,0,1]
    v_cvt_pk_f16_f32 v71, v46, v47
    ds_write_addtid_b32 v71 offset:3168
    v_pk_mul_f32 v[66:67], v[46:47], v[58:59] op_sel:[1,1] op_sel_hi:[1,0]
    v_pk_fma_f32 v[48:49], v[46:47], v[58:59], v[66:67] op_sel:[0,0,0] op_sel_hi:[0,1,1] neg_lo:[0,0,1]
    v_cvt_pk_f16_f32 v72, v48, v49
    ds_write_addtid_b32 v72 offset:4224
    v_pk_mul_f32 v[66:67], v[48:49], v[58:59] op_sel:[1,1] op_sel_hi:[1,0]
    v_pk_fma_f32 v[50:51], v[48:49], v[58:59], v[66:67] op_sel:[0,0,0] op_sel_hi:[0,1,1] neg_lo:[0,0,1]
    v_cvt_pk_f16_f32 v73, v50, v51
    ds_write_addtid_b32 v73 offset:5280
    v_pk_mul_f32 v[66:67], v[50:51], v[58:59] op_sel:[1,1] op_sel_hi:[1,0]
    v_pk_fma_f32 v[52:53], v[50:51], v[58:59], v[66:67] op_sel:[0,0,0] op_sel_hi:[0,1,1] neg_lo:[0,0,1]
    v_cvt_pk_f16_f32 v70, v52, v53
    ds_write_addtid_b32 v70 offset:6336
    v_pk_mul_f32 v[66:67], v[52:53], v[58:59] op_sel:[1,1] op_sel_hi:[1,0]
    v_pk_fma_f32 v[54:55], v[52:53], v[58:59], v[66:67] op_sel:[0,0,0] op_sel_hi:[0,1,1] neg_lo:[0,0,1]
    v_cvt_pk_f16_f32 v71, v54, v55
    ds_write_addtid_b32 v71 offset:7392
    v_pk_mul_f32 v[66:67], v[40:41], v[62:63] op_sel:[1,1] op_sel_hi:[1,0]
    v_pk_fma_f32 v[40:41], v[40:41], v[62:63], v[66:67] op_sel:[0,0,0] op_sel_hi:[0,1,1] neg_lo:[0,0,1]
    v_cvt_pk_f16_f32 v72, v40, v41
    ds_write_addtid_b32 v72 offset:8448
    v_pk_mul_f32 v[66:67], v[42:43], v[62:63] op_sel:[1,1] op_sel_hi:[1,0]
    v_pk_fma_f32 v[42:43], v[42:43], v[62:63], v[66:67] op_sel:[0,0,0] op_sel_hi:[0,1,1] neg_lo:[0,0,1]
    v_cvt_pk_f16_f32 v73, v42, v43
    ds_write_addtid_b32 v73 offset:9504
    v_pk_mul_f32 v[66:67], v[44:45], v[62:63] op_sel:[1,1] op_sel_hi:[1,0]
    v_pk_fma_f32 v[44:45], v[44:45], v[62:63], v[66:67] op_sel:[0,0,0] op_sel_hi:[0,1,1] neg_lo:[0,0,1]
    v_cvt_pk_f16_f32 v70, v44, v45
    ds_write_addtid_b32 v70 offset:10560
    v_pk_mul_f32 v[66:67], v[46:47], v[62:63] op_sel:[1,1] op_sel_hi:[1,0]
    v_pk_fma_f32 v[46:47], v[46:47], v[62:63], v[66:67] op_sel:[0,0,0] op_sel_hi:[0,1,1] neg_lo:[0,0,1]
    v_cvt_pk_f16_f32 v71, v46, v47
    ds_write_addtid_b32 v71 offset:11616
    v_pk_mul_f32 v[66:67], v[48:49], v[62:63] op_sel:[1,1] op_sel_hi:[1,0]
    v_pk_fma_f32 v[48:49], v[48:49], v[62:63], v[66:67] op_sel:[0,0,0] op_sel_hi:[0,1,1] neg_lo:[0,0,1]
    v_cvt_pk_f16_f32 v72, v48, v49
    ds_write_addtid_b32 v72 offset:12672
    v_pk_mul_f32 v[66:67], v[50:51], v[62:63] op_sel:[1,1] op_sel_hi:[1,0]
    v_pk_fma_f32 v[50:51], v[50:51], v[62:63], v[66:67] op_sel:[0,0,0] op_sel_hi:[0,1,1] neg_lo:[0,0,1]
    v_cvt_pk_f16_f32 v73, v50, v51
    ds_write_addtid_b32 v73 offset:13728
    v_pk_mul_f32 v[66:67], v[52:53], v[62:63] op_sel:[1,1] op_sel_hi:[1,0]
    v_pk_fma_f32 v[52:53], v[52:53], v[62:63], v[66:67] op_sel:[0,0,0] op_sel_hi:[0,1,1] neg_lo:[0,0,1]
    v_cvt_pk_f16_f32 v70, v52, v53
    ds_write_addtid_b32 v70 offset:14784
    v_pk_mul_f32 v[66:67], v[54:55], v[62:63] op_sel:[1,1] op_sel_hi:[1,0]
    v_pk_fma_f32 v[54:55], v[54:55], v[62:63], v[66:67] op_sel:[0,0,0] op_sel_hi:[0,1,1] neg_lo:[0,0,1]
    v_cvt_pk_f16_f32 v71, v54, v55
    ds_write_addtid_b32 v71 offset:15840
    v_pk_mul_f32 v[66:67], v[42:43], v[62:63] op_sel:[1,1] op_sel_hi:[1,0]
    v_pk_fma_f32 v[42:43], v[42:43], v[62:63], v[66:67] op_sel:[0,0,0] op_sel_hi:[0,1,1] neg_lo:[0,0,1]
    v_cvt_pk_f16_f32 v72, v42, v43
    ds_write_addtid_b32 v72 offset:16896
    v_pk_mul_f32 v[66:67], v[46:47], v[62:63] op_sel:[1,1] op_sel_hi:[1,0]
    v_pk_fma_f32 v[46:47], v[46:47], v[62:63], v[66:67] op_sel:[0,0,0] op_sel_hi:[0,1,1] neg_lo:[0,0,1]
    v_cvt_pk_f16_f32 v73, v46, v47
    ds_write_addtid_b32 v73 offset:17952
    v_pk_mul_f32 v[66:67], v[50:51], v[62:63] op_sel:[1,1] op_sel_hi:[1,0]
    v_pk_fma_f32 v[50:51], v[50:51], v[62:63], v[66:67] op_sel:[0,0,0] op_sel_hi:[0,1,1] neg_lo:[0,0,1]
    v_cvt_pk_f16_f32 v70, v50, v51
    ds_write_addtid_b32 v70 offset:19008
    v_pk_mul_f32 v[66:67], v[54:55], v[62:63] op_sel:[1,1] op_sel_hi:[1,0]
    v_pk_fma_f32 v[54:55], v[54:55], v[62:63], v[66:67] op_sel:[0,0,0] op_sel_hi:[0,1,1] neg_lo:[0,0,1]
    v_cvt_pk_f16_f32 v71, v54, v55
    ds_write_addtid_b32 v71 offset:20064
    v_pk_mul_f32 v[66:67], v[42:43], v[62:63] op_sel:[1,1] op_sel_hi:[1,0]
    v_pk_fma_f32 v[42:43], v[42:43], v[62:63], v[66:67] op_sel:[0,0,0] op_sel_hi:[0,1,1] neg_lo:[0,0,1]
    v_cvt_pk_f16_f32 v72, v42, v43
    ds_write_addtid_b32 v72 offset:21120
    v_pk_mul_f32 v[66:67], v[46:47], v[62:63] op_sel:[1,1] op_sel_hi:[1,0]
    v_pk_fma_f32 v[46:47], v[46:47], v[62:63], v[66:67] op_sel:[0,0,0] op_sel_hi:[0,1,1] neg_lo:[0,0,1]
    v_cvt_pk_f16_f32 v73, v46, v47
    ds_write_addtid_b32 v73 offset:22176
    v_pk_mul_f32 v[66:67], v[50:51], v[62:63] op_sel:[1,1] op_sel_hi:[1,0]
    v_pk_fma_f32 v[50:51], v[50:51], v[62:63], v[66:67] op_sel:[0,0,0] op_sel_hi:[0,1,1] neg_lo:[0,0,1]
    v_cvt_pk_f16_f32 v70, v50, v51
    ds_write_addtid_b32 v70 offset:23232
    v_pk_mul_f32 v[66:67], v[54:55], v[62:63] op_sel:[1,1] op_sel_hi:[1,0]
    v_pk_fma_f32 v[54:55], v[54:55], v[62:63], v[66:67] op_sel:[0,0,0] op_sel_hi:[0,1,1] neg_lo:[0,0,1]
    v_cvt_pk_f16_f32 v71, v54, v55
    ds_write_addtid_b32 v71 offset:24288
    v_pk_mul_f32 v[66:67], v[46:47], v[62:63] op_sel:[1,1] op_sel_hi:[1,0]
    v_pk_fma_f32 v[46:47], v[46:47], v[62:63], v[66:67] op_sel:[0,0,0] op_sel_hi:[0,1,1] neg_lo:[0,0,1]
    v_cvt_pk_f16_f32 v72, v46, v47
    ds_write_addtid_b32 v72 offset:25344
    v_pk_mul_f32 v[66:67], v[54:55], v[62:63] op_sel:[1,1] op_sel_hi:[1,0]
    v_pk_fma_f32 v[54:55], v[54:55], v[62:63], v[66:67] op_sel:[0,0,0] op_sel_hi:[0,1,1] neg_lo:[0,0,1]
    v_cvt_pk_f16_f32 v73, v54, v55
    ds_write_addtid_b32 v73 offset:26400
    v_pk_mul_f32 v[66:67], v[46:47], v[62:63] op_sel:[1,1] op_sel_hi:[1,0]
    v_pk_fma_f32 v[46:47], v[46:47], v[62:63], v[66:67] op_sel:[0,0,0] op_sel_hi:[0,1,1] neg_lo:[0,0,1]
    v_cvt_pk_f16_f32 v70, v46, v47
    ds_write_addtid_b32 v70 offset:27456
    v_pk_mul_f32 v[66:67], v[54:55], v[62:63] op_sel:[1,1] op_sel_hi:[1,0]
    v_pk_fma_f32 v[54:55], v[54:55], v[62:63], v[66:67] op_sel:[0,0,0] op_sel_hi:[0,1,1] neg_lo:[0,0,1]
    v_cvt_pk_f16_f32 v71, v54, v55
    ds_write_addtid_b32 v71 offset:28512
    v_pk_mul_f32 v[66:67], v[46:47], v[62:63] op_sel:[1,1] op_sel_hi:[1,0]
    v_pk_fma_f32 v[46:47], v[46:47], v[62:63], v[66:67] op_sel:[0,0,0] op_sel_hi:[0,1,1] neg_lo:[0,0,1]
    v_cvt_pk_f16_f32 v72, v46, v47
    ds_write_addtid_b32 v72 offset:29568
    v_pk_mul_f32 v[66:67], v[54:55], v[62:63] op_sel:[1,1] op_sel_hi:[1,0]
    v_pk_fma_f32 v[54:55], v[54:55], v[62:63], v[66:67] op_sel:[0,0,0] op_sel_hi:[0,1,1] neg_lo:[0,0,1]
    v_cvt_pk_f16_f32 v73, v54, v55
    ds_write_addtid_b32 v73 offset:30624
    v_pk_mul_f32 v[66:67], v[46:47], v[62:63] op_sel:[1,1] op_sel_hi:[1,0]
    v_pk_fma_f32 v[46:47], v[46:47], v[62:63], v[66:67] op_sel:[0,0,0] op_sel_hi:[0,1,1] neg_lo:[0,0,1]
    v_cvt_pk_f16_f32 v70, v46, v47
    ds_write_addtid_b32 v70 offset:31680
    v_pk_mul_f32 v[66:67], v[54:55], v[62:63] op_sel:[1,1] op_sel_hi:[1,0]
    v_pk_fma_f32 v[54:55], v[54:55], v[62:63], v[66:67] op_sel:[0,0,0] op_sel_hi:[0,1,1] neg_lo:[0,0,1]
    v_cvt_pk_f16_f32 v71, v54, v55
    ds_write_addtid_b32 v71 offset:32736
    v_pk_mul_f32 v[66:67], v[54:55], v[62:63] op_sel:[1,1] op_sel_hi:[1,0]
    v_pk_fma_f32 v[54:55], v[54:55], v[62:63], v[66:67] op_sel:[0,0,0] op_sel_hi:[0,1,1] neg_lo:[0,0,1]
    v_cvt_pk_f16_f32 v72, v54, v55
    ds_write_addtid_b32 v72 offset:33792
    v_pk_mul_f32 v[66:67], v[54:55], v[62:63] op_sel:[1,1] op_sel_hi:[1,0]
    v_pk_fma_f32 v[54:55], v[54:55], v[62:63], v[66:67] op_sel:[0,0,0] op_sel_hi:[0,1,1] neg_lo:[0,0,1]
    v_cvt_pk_f16_f32 v73, v54, v55
    ds_write_addtid_b32 v73 offset:34848
    v_pk_mul_f32 v[66:67], v[54:55], v[62:63] op_sel:[1,1] op_sel_hi:[1,0]
    v_pk_fma_f32 v[54:55], v[54:55], v[62:63], v[66:67] op_sel:[0,0,0] op_sel_hi:[0,1,1] neg_lo:[0,0,1]
    v_cvt_pk_f16_f32 v70, v54, v55
    ds_write_addtid_b32 v70 offset:35904
    v_pk_mul_f32 v[66:67], v[54:55], v[62:63] op_sel:[1,1] op_sel_hi:[1,0]
    v_pk_fma_f32 v[54:55], v[54:55], v[62:63], v[66:67] op_sel:[0,0,0] op_sel_hi:[0,1,1] neg_lo:[0,0,1]
    v_cvt_pk_f16_f32 v71, v54, v55
    ds_write_addtid_b32 v71 offset:36960
    v_pk_mul_f32 v[66:67], v[54:55], v[62:63] op_sel:[1,1] op_sel_hi:[1,0]
    v_pk_fma_f32 v[54:55], v[54:55], v[62:63], v[66:67] op_sel:[0,0,0] op_sel_hi:[0,1,1] neg_lo:[0,0,1]
    v_cvt_pk_f16_f32 v72, v54, v55
    ds_write_addtid_b32 v72 offset:38016
    v_pk_mul_f32 v[66:67], v[54:55], v[62:63] op_sel:[1,1] op_sel_hi:[1,0]
    v_pk_fma_f32 v[54:55], v[54:55], v[62:63], v[66:67] op_sel:[0,0,0] op_sel_hi:[0,1,1] neg_lo:[0,0,1]
    v_cvt_pk_f16_f32 v73, v54, v55
    ds_write_addtid_b32 v73 offset:39072
    v_pk_mul_f32 v[66:67], v[54:55], v[62:63] op_sel:[1,1] op_sel_hi:[1,0]
    v_pk_fma_f32 v[54:55], v[54:55], v[62:63], v[66:67] op_sel:[0,0,0] op_sel_hi:[0,1,1] neg_lo:[0,0,1]
    v_cvt_pk_f16_f32 v70, v54, v55
    ds_write_addtid_b32 v70 offset:40128
    v_pk_mul_f32 v[66:67], v[54:55], v[62:63] op_sel:[1,1] op_sel_hi:[1,0]
    v_pk_fma_f32 v[54:55], v[54:55], v[62:63], v[66:67] op_sel:[0,0,0] op_sel_hi:[0,1,1] neg_lo:[0,0,1]
    v_cvt_pk_f16_f32 v71, v54, v55
    ds_write_addtid_b32 v71 offset:41184
    v_pk_mul_f32 v[66:67], v[60:61], v[60:61] op_sel:[1,1] op_sel_hi:[1,0]
    v_pk_fma_f32 v[64:65], v[60:61], v[60:61], v[66:67] op_sel:[0,0,0] op_sel_hi:[0,1,1] neg_lo:[0,0,1]
    v_cvt_pk_f16_f32 v72, v64, v65
    ds_write_addtid_b32 v72 offset:45408
    v_pk_mul_f32 v[66:67], v[64:65], v[60:61] op_sel:[1,1] op_sel_hi:[1,0]
    v_pk_fma_f32 v[64:65], v[64:65], v[60:61], v[66:67] op_sel:[0,0,0] op_sel_hi:[0,1,1] neg_lo:[0,0,1]
    v_cvt_pk_f16_f32 v73, v64, v65
    ds_write_addtid_b32 v73 offset:46464
    v_pk_mul_f32 v[66:67], v[64:65], v[60:61] op_sel:[1,1] op_sel_hi:[1,0]
    v_pk_fma_f32 v[64:65], v[64:65], v[60:61], v[66:67] op_sel:[0,0,0] op_sel_hi:[0,1,1] neg_lo:[0,0,1]
    v_cvt_pk_f16_f32 v70, v64, v65
    ds_write_addtid_b32 v70 offset:47520
    v_pk_mul_f32 v[66:67], v[64:65], v[60:61] op_sel:[1,1] op_sel_hi:[1,0]
    v_pk_fma_f32 v[64:65], v[64:65], v[60:61], v[66:67] op_sel:[0,0,0] op_sel_hi:[0,1,1] neg_lo:[0,0,1]
    v_cvt_pk_f16_f32 v71, v64, v65
    ds_write_addtid_b32 v71 offset:48576
    v_pk_mul_f32 v[66:67], v[64:65], v[60:61] op_sel:[1,1] op_sel_hi:[1,0]
    v_pk_fma_f32 v[64:65], v[64:65], v[60:61], v[66:67] op_sel:[0,0,0] op_sel_hi:[0,1,1] neg_lo:[0,0,1]
    v_cvt_pk_f16_f32 v72, v64, v65
    ds_write_addtid_b32 v72 offset:49632
    v_pk_mul_f32 v[66:67], v[64:65], v[60:61] op_sel:[1,1] op_sel_hi:[1,0]
    v_pk_fma_f32 v[64:65], v[64:65], v[60:61], v[66:67] op_sel:[0,0,0] op_sel_hi:[0,1,1] neg_lo:[0,0,1]
    v_cvt_pk_f16_f32 v73, v64, v65
    ds_write_addtid_b32 v73 offset:50688
    v_pk_mul_f32 v[66:67], v[64:65], v[60:61] op_sel:[1,1] op_sel_hi:[1,0]
    v_pk_fma_f32 v[64:65], v[64:65], v[60:61], v[66:67] op_sel:[0,0,0] op_sel_hi:[0,1,1] neg_lo:[0,0,1]
    v_cvt_pk_f16_f32 v70, v64, v65
    ds_write_addtid_b32 v70 offset:51744
    v_pk_mul_f32 v[66:67], v[64:65], v[60:61] op_sel:[1,1] op_sel_hi:[1,0]
    v_pk_fma_f32 v[64:65], v[64:65], v[60:61], v[66:67] op_sel:[0,0,0] op_sel_hi:[0,1,1] neg_lo:[0,0,1]
    v_cvt_pk_f16_f32 v71, v64, v65
    ds_write_addtid_b32 v71 offset:52800
    v_pk_mul_f32 v[66:67], v[64:65], v[60:61] op_sel:[1,1] op_sel_hi:[1,0]
    v_pk_fma_f32 v[64:65], v[64:65], v[60:61], v[66:67] op_sel:[0,0,0] op_sel_hi:[0,1,1] neg_lo:[0,0,1]
    v_cvt_pk_f16_f32 v72, v64, v65
    ds_write_addtid_b32 v72 offset:53856
    v_pk_mul_f32 v[66:67], v[64:65], v[60:61] op_sel:[1,1] op_sel_hi:[1,0]
    v_pk_fma_f32 v[64:65], v[64:65], v[60:61], v[66:67] op_sel:[0,0,0] op_sel_hi:[0,1,1] neg_lo:[0,0,1]
    v_cvt_pk_f16_f32 v73, v64, v65
    ds_write_addtid_b32 v73 offset:54912
    v_pk_mul_f32 v[66:67], v[64:65], v[60:61] op_sel:[1,1] op_sel_hi:[1,0]
    v_pk_fma_f32 v[64:65], v[64:65], v[60:61], v[66:67] op_sel:[0,0,0] op_sel_hi:[0,1,1] neg_lo:[0,0,1]
    v_cvt_pk_f16_f32 v70, v64, v65
    ds_write_addtid_b32 v70 offset:55968
    v_pk_mul_f32 v[66:67], v[64:65], v[60:61] op_sel:[1,1] op_sel_hi:[1,0]
    v_pk_fma_f32 v[64:65], v[64:65], v[60:61], v[66:67] op_sel:[0,0,0] op_sel_hi:[0,1,1] neg_lo:[0,0,1]
    v_cvt_pk_f16_f32 v71, v64, v65
    ds_write_addtid_b32 v71 offset:57024
    v_pk_mul_f32 v[66:67], v[64:65], v[60:61] op_sel:[1,1] op_sel_hi:[1,0]
    v_pk_fma_f32 v[64:65], v[64:65], v[60:61], v[66:67] op_sel:[0,0,0] op_sel_hi:[0,1,1] neg_lo:[0,0,1]
    v_cvt_pk_f16_f32 v72, v64, v65
    ds_write_addtid_b32 v72 offset:58080
    v_pk_mul_f32 v[66:67], v[64:65], v[60:61] op_sel:[1,1] op_sel_hi:[1,0]
    v_pk_fma_f32 v[64:65], v[64:65], v[60:61], v[66:67] op_sel:[0,0,0] op_sel_hi:[0,1,1] neg_lo:[0,0,1]
    v_cvt_pk_f16_f32 v73, v64, v65
    ds_write_addtid_b32 v73 offset:59136
CK_SKIP:
    ds_write_b32 v129, v129
    s_mov_b32 s9, 0
CK_PAIR:
    ds_read_b32 v8, v130
    s_add_u32 s9, s9, 1
    s_waitcnt lgkmcnt(0)
    v_cmp_eq_u32 vcc, 0, v8
    s_cmp_ge_u32 s9, 0x40000
    s_cbranch_scc1 CK_PAIRED
    s_cbranch_vccnz CK_PAIR
CK_PAIRED:
    s_cmp_eq_u32 s12, 0
    s_cbranch_scc0 CK_T1
    ds_read_b128 v[8:11], v128 offset:43296
    ds_read_b128 v[40:43], v128 offset:0
    ds_read_b128 v[12:15], v128 offset:43360
    ds_read_b128 v[44:47], v128 offset:64
    ds_read_b128 v[16:19], v128 offset:43424
    ds_read_b128 v[48:51], v128 offset:128
    ds_read_b128 v[20:23], v128 offset:43488
    ds_read_b128 v[52:55], v128 offset:192
    s_lshl_b32 s9, s7, 2
    s_add_u32 s9, s9, 153616
    v_mov_b32 v112, s9
    v_mov_b32 v113, s8
    ds_read_b128 v[24:27], v128 offset:43552
    ds_read_b128 v[56:59], v128 offset:256
    ds_read_b128 v[28:31], v128 offset:43616
    ds_read_b128 v[60:63], v128 offset:320
    ds_read_b128 v[32:35], v128 offset:43680
    ds_read_b128 v[64:67], v128 offset:384
    ds_read_b128 v[36:39], v128 offset:43744
    ds_read_b128 v[68:71], v128 offset:448
    v_lshrrev_b32 v114, 1, v4
    v_lshlrev_b32 v114, 8, v114
    v_lshl_add_u32 v114, v3, 4, v114
    v_and_b32 v115, 1, v4
    v_lshl_add_u32 v114, v115, 3, v114
    v_add_u32 v114, s13, v114
    v_lshlrev_b32 v115, 5, v3
    v_lshl_add_u32 v115, v4, 3, v115
    v_add_u32 v115, s13, v115
    v_mov_b32 v116, s13
    s_waitcnt lgkmcnt(14)
    v_mfma_f32_16x16x32_f16 v[104:107], v[40:43], v[8:11], 0
    ds_read_b128 v[72:75], v128 offset:33792
    s_waitcnt lgkmcnt(13)
    v_mfma_f32_16x16x32_f16 v[104:107], v[44:47], v[12:15], v[104:107]
    ds_read_b128 v[76:79], v128 offset:33856
    s_waitcnt lgkmcnt(12)
    v_mfma_f32_16x16x32_f16 v[104:107], v[48:51], v[16:19], v[104:107]
    ds_read_b128 v[80:83], v128 offset:33920
    s_waitcnt lgkmcnt(11)
    v_mfma_f32_16x16x32_f16 v[104:107], v[52:55], v[20:23], v[104:107]
    ds_read_b128 v[84:87], v128 offset:33984
    s_waitcnt lgkmcnt(10)
    v_mfma_f32_16x16x32_f16 v[104:107], v[56:59], v[24:27], v[104:107]
    ds_read_b128 v[88:91], v128 offset:34048
    s_waitcnt lgkmcnt(9)
    v_mfma_f32_16x16x32_f16 v[104:107], v[60:63], v[28:31], v[104:107]
    ds_read_b128 v[92:95], v128 offset:34112
    s_waitcnt lgkmcnt(8)
    v_mfma_f32_16x16x32_f16 v[104:107], v[64:67], v[32:35], v[104:107]
    ds_read_b128 v[96:99], v128 offset:34176
    s_waitcnt lgkmcnt(7)
    v_mfma_f32_16x16x32_f16 v[104:107], v[68:71], v[36:39], v[104:107]
    ds_read_b128 v[100:103], v128 offset:34240
    s_waitcnt lgkmcnt(7)
    v_mfma_f32_16x16x32_f16 v[108:111], v[8:11], v[72:75], 0
    s_waitcnt lgkmcnt(6)
    v_mfma_f32_16x16x32_f16 v[108:111], v[12:15], v[76:79], v[108:111]
    s_waitcnt lgkmcnt(5)
    v_mfma_f32_16x16x32_f16 v[108:111], v[16:19], v[80:83], v[108:111]
    s_waitcnt lgkmcnt(4)
    v_mfma_f32_16x16x32_f16 v[108:111], v[20:23], v[84:87], v[108:111]
    s_waitcnt lgkmcnt(3)
    v_mfma_f32_16x16x32_f16 v[108:111], v[24:27], v[88:91], v[108:111]
    s_waitcnt lgkmcnt(2)
    v_mfma_f32_16x16x32_f16 v[108:111], v[28:31], v[92:95], v[108:111]
    s_waitcnt lgkmcnt(1)
    v_mfma_f32_16x16x32_f16 v[108:111], v[32:35], v[96:99], v[108:111]
    s_waitcnt lgkmcnt(0)
    v_mfma_f32_16x16x32_f16 v[108:111], v[36:39], v[100:103], v[108:111]
    ds_write_b32 v112, v113
    v_cvt_pk_f16_f32 v118, v104, v105
    v_cvt_pk_f16_f32 v119, v106, v107
    v_cvt_pk_f16_f32 v120, v105, v106
    v_cvt_pk_f16_f32 v121, v107, v107
    ds_write_b16 v114, v121 offset:1256
    ds_write_b64 v114, v[120:121] offset:32
    ds_write_b64 v114, v[118:119] offset:1248
    ds_write_b16 v114, v118 offset:30
    v_cvt_pk_f16_f32 v118, v108, v109
    v_cvt_pk_f16_f32 v119, v110, v111
    s_mov_b32 s10, 0x00ff00ff
    s_mov_b32 s11, 0x00ff00ff
    s_mov_b64 exec, s[10:11]
    ds_write_b64 v115, v[118:119] offset:2912
    s_mov_b64 exec, 0x100
    ds_write_b16 v116, v118 offset:28
    ds_write_b16 v116, v118 offset:1246
    s_mov_b64 exec, -1
    s_mov_b32 s72, s13
    v_mov_b32 v8, 153600
    s_mov_b32 s9, 0
CK_ISSD:
    ds_read_b32 v9, v8 offset:64
    s_add_u32 s9, s9, 1
    s_waitcnt lgkmcnt(0)
    v_cmp_ne_u32 vcc, 4, v9
    s_cmp_ge_u32 s9, 0x40000
    s_cbranch_scc1 CK_ISSDD
    s_cbranch_vccz CK_ISSDD
    s_sleep 2
    s_branch CK_ISSD
CK_ISSDD:
    s_mul_i32 s14, s7, 18
    s_add_u32 s14, s14, s101
    s_cmp_ge_u32 s14, 72
    s_cbranch_scc1 CPF_DD
    v_mul_u32_u24 v140, 9216, v2
    s_mul_i32 s8, s4, 1152
    v_add_u32 v140, s8, v140
    s_mul_i32 s8, s14, 7282
    s_lshr_b32 s8, s8, 16
    s_mul_i32 s9, s8, 9
    s_sub_u32 s9, s14, s9
    s_lshl_b32 s9, s9, 7
    s_bitcmp1_b32 s8, 0
    s_cselect_b32 s12, s40, s38
    s_cselect_b32 s13, s41, s39
    s_lshr_b32 s8, s8, 1
    s_add_u32 s8, s8, 5
    s_mul_i32 s8, s8, 589824
    s_add_u32 s8, s8, s9
    v_add_u32 v141, s8, v140
    global_load_dword v142, v141, s[12:13]
    s_branch CPF_XD
CPF_DD:
    s_sub_u32 s14, s14, 72
    s_min_u32 s14, s14, 80
    s_mul_i32 s8, s4, 81
    s_add_u32 s8, s8, s14
    s_lshl_b32 s8, s8, 13
    v_lshl_add_u32 v141, v2, 7, s8
    global_load_dword v142, v141, s[42:43]
CPF_XD:
    s_mov_b32 s13, s72
    s_barrier
    v_and_b32 v5, 1, v3
    v_mul_u32_u24 v5, 1216, v5
    v_sub_u32 v5, 1264, v5
    v_lshrrev_b32 v6, 1, v3
    v_lshl_add_u32 v5, v6, 2, v5
    v_lshlrev_b32 v6, 4, v4
    v_sub_u32 v5, v5, v6
    v_add_u32 v5, s13, v5
    v_add_u32 v7, 576, v5
    ds_read2_b32 v[8:9], v5 offset0:3 offset1:2
    ds_read2_b32 v[10:11], v5 offset0:1 offset1:0
    ds_read2_b32 v[12:13], v5 offset0:19 offset1:18
    ds_read2_b32 v[14:15], v5 offset0:17 offset1:16
    ds_read2_b32 v[16:17], v5 offset0:35 offset1:34
    ds_read2_b32 v[18:19], v5 offset0:33 offset1:32
    ds_read2_b32 v[20:21], v5 offset0:51 offset1:50
    ds_read2_b32 v[22:23], v5 offset0:49 offset1:48
    ds_read2_b32 v[24:25], v5 offset0:67 offset1:66
    ds_read2_b32 v[26:27], v5 offset0:65 offset1:64
    ds_read2_b32 v[28:29], v5 offset0:83 offset1:82
    ds_read2_b32 v[30:31], v5 offset0:81 offset1:80
    ds_read2_b32 v[32:33], v5 offset0:99 offset1:98
    ds_read2_b32 v[34:35], v5 offset0:97 offset1:96
    ds_read2_b32 v[36:37], v5 offset0:115 offset1:114
    ds_read2_b32 v[38:39], v5 offset0:113 offset1:112
    ds_read2_b32 v[40:41], v5 offset0:131 offset1:130
    ds_read2_b32 v[42:43], v5 offset0:129 offset1:128
    ds_read2_b32 v[44:45], v7 offset0:3 offset1:2
    ds_read2_b32 v[46:47], v7 offset0:1 offset1:0
    ds_read2_b32 v[48:49], v7 offset0:19 offset1:18
    ds_read2_b32 v[50:51], v7 offset0:17 offset1:16
    ds_read2_b32 v[52:53], v7 offset0:35 offset1:34
    ds_read2_b32 v[54:55], v7 offset0:33 offset1:32
    ds_read2_b32 v[56:57], v7 offset0:51 offset1:50
    ds_read2_b32 v[58:59], v7 offset0:49 offset1:48
    ds_read2_b32 v[60:61], v7 offset0:67 offset1:66
    ds_read2_b32 v[62:63], v7 offset0:65 offset1:64
    ds_read2_b32 v[64:65], v7 offset0:83 offset1:82
    ds_read2_b32 v[66:67], v7 offset0:81 offset1:80
    ds_read2_b32 v[68:69], v7 offset0:99 offset1:98
    ds_read2_b32 v[70:71], v7 offset0:97 offset1:96
    ds_read2_b32 v[72:73], v7 offset0:115 offset1:114
    ds_read2_b32 v[74:75], v7 offset0:113 offset1:112
    v_lshl_add_u32 v6, v3, 5, v6
    v_add_u32 v6, 3616, v6
    v_add_u32 v6, s13, v6
    v_mul_u32_u24 v124, 320, v4
    v_lshl_add_u32 v124, v3, 4, v124
    s_mul_i32 s8, s7, 20480
    v_add_u32 v124, s8, v124
    s_lshl_b32 s8, s3, 2
    s_add_u32 s8, s8, 124032
    v_mov_b32 v125, s8
    v_mov_b32 v126, 1
    s_waitcnt lgkmcnt(0)
    s_barrier
    ds_read_b128 v[76:79], v6 offset:0
    ds_read_b128 v[80:83], v6 offset:64
    ds_read_b128 v[84:87], v6 offset:128
    ds_read_b128 v[88:91], v6 offset:192
    ds_read_b128 v[92:95], v6 offset:256
    ds_read_b128 v[96:99], v6 offset:320
    ds_read_b128 v[100:103], v6 offset:384
    s_waitcnt lgkmcnt(6)
    v_mfma_f32_16x16x32_f16 v[108:111], v[36:39], v[76:79], 0
    v_mfma_f32_16x16x32_f16 v[112:115], v[68:71], v[76:79], 0
    ds_read_b128 v[104:107], v6 offset:448
    s_waitcnt lgkmcnt(6)
    v_mfma_f32_16x16x32_f16 v[108:111], v[32:35], v[80:83], v[108:111]
    v_mfma_f32_16x16x32_f16 v[112:115], v[64:67], v[80:83], v[112:115]
    ds_read_b128 v[76:79], v6 offset:512
    s_waitcnt lgkmcnt(6)
    v_mfma_f32_16x16x32_f16 v[108:111], v[28:31], v[84:87], v[108:111]
    v_mfma_f32_16x16x32_f16 v[112:115], v[60:63], v[84:87], v[112:115]
    ds_read_b128 v[80:83], v6 offset:576
    s_waitcnt lgkmcnt(6)
    v_mfma_f32_16x16x32_f16 v[108:111], v[24:27], v[88:91], v[108:111]
    v_mfma_f32_16x16x32_f16 v[112:115], v[56:59], v[88:91], v[112:115]
    ds_read_b128 v[84:87], v6 offset:640
    s_waitcnt lgkmcnt(6)
    v_mfma_f32_16x16x32_f16 v[108:111], v[20:23], v[92:95], v[108:111]
    v_mfma_f32_16x16x32_f16 v[112:115], v[52:55], v[92:95], v[112:115]
    ds_read_b128 v[88:91], v6 offset:704
    s_waitcnt lgkmcnt(6)
    v_mfma_f32_16x16x32_f16 v[108:111], v[16:19], v[96:99], v[108:111]
    v_mfma_f32_16x16x32_f16 v[112:115], v[48:51], v[96:99], v[112:115]
    ds_read_b128 v[92:95], v6 offset:768
    s_waitcnt lgkmcnt(6)
    v_mfma_f32_16x16x32_f16 v[108:111], v[12:15], v[100:103], v[108:111]
    v_mfma_f32_16x16x32_f16 v[112:115], v[44:47], v[100:103], v[112:115]
    ds_read_b128 v[96:99], v6 offset:832
    s_waitcnt lgkmcnt(6)
    v_mfma_f32_16x16x32_f16 v[108:111], v[8:11], v[104:107], v[108:111]
    v_mfma_f32_16x16x32_f16 v[112:115], v[40:43], v[104:107], v[112:115]
    v_mfma_f32_16x16x32_f16 v[116:119], v[72:75], v[104:107], 0
    ds_read_b128 v[100:103], v6 offset:896
    s_waitcnt lgkmcnt(6)
    v_mfma_f32_16x16x32_f16 v[112:115], v[36:39], v[76:79], v[112:115]
    v_mfma_f32_16x16x32_f16 v[116:119], v[68:71], v[76:79], v[116:119]
    ds_read_b128 v[104:107], v6 offset:960
    s_waitcnt lgkmcnt(6)
    v_mfma_f32_16x16x32_f16 v[112:115], v[32:35], v[80:83], v[112:115]
    v_mfma_f32_16x16x32_f16 v[116:119], v[64:67], v[80:83], v[116:119]
    ds_read_b128 v[76:79], v6 offset:1024
    s_waitcnt lgkmcnt(6)
    v_mfma_f32_16x16x32_f16 v[112:115], v[28:31], v[84:87], v[112:115]
    v_mfma_f32_16x16x32_f16 v[116:119], v[60:63], v[84:87], v[116:119]
    ds_read_b128 v[80:83], v6 offset:1088
    ds_write_b128 v124, v[108:111] offset:0
    ds_write_b32 v125, v126 offset:0
    s_waitcnt lgkmcnt(8)
    v_mfma_f32_16x16x32_f16 v[112:115], v[24:27], v[88:91], v[112:115]
    v_mfma_f32_16x16x32_f16 v[116:119], v[56:59], v[88:91], v[116:119]
    ds_read_b128 v[84:87], v6 offset:1152
    s_waitcnt lgkmcnt(8)
    v_mfma_f32_16x16x32_f16 v[112:115], v[20:23], v[92:95], v[112:115]
    v_mfma_f32_16x16x32_f16 v[116:119], v[52:55], v[92:95], v[116:119]
    ds_read_b128 v[88:91], v6 offset:1216
    s_waitcnt lgkmcnt(8)
    v_mfma_f32_16x16x32_f16 v[112:115], v[16:19], v[96:99], v[112:115]
    v_mfma_f32_16x16x32_f16 v[116:119], v[48:51], v[96:99], v[116:119]
    ds_read_b128 v[92:95], v6 offset:1280
    s_waitcnt lgkmcnt(8)
    v_mfma_f32_16x16x32_f16 v[112:115], v[12:15], v[100:103], v[112:115]
    v_mfma_f32_16x16x32_f16 v[116:119], v[44:47], v[100:103], v[116:119]
    ds_read_b128 v[96:99], v6 offset:1344
    s_waitcnt lgkmcnt(8)
    v_mfma_f32_16x16x32_f16 v[112:115], v[8:11], v[104:107], v[112:115]
    v_mfma_f32_16x16x32_f16 v[116:119], v[40:43], v[104:107], v[116:119]
    v_mfma_f32_16x16x32_f16 v[120:123], v[72:75], v[104:107], 0
    ds_read_b128 v[100:103], v6 offset:1408
    s_waitcnt lgkmcnt(8)
    v_mfma_f32_16x16x32_f16 v[116:119], v[36:39], v[76:79], v[116:119]
    v_mfma_f32_16x16x32_f16 v[120:123], v[68:71], v[76:79], v[120:123]
    ds_read_b128 v[104:107], v6 offset:1472
    s_waitcnt lgkmcnt(8)
    v_mfma_f32_16x16x32_f16 v[116:119], v[32:35], v[80:83], v[116:119]
    v_mfma_f32_16x16x32_f16 v[120:123], v[64:67], v[80:83], v[120:123]
    ds_read_b128 v[76:79], v6 offset:1536
    s_waitcnt lgkmcnt(6)
    v_mfma_f32_16x16x32_f16 v[116:119], v[28:31], v[84:87], v[116:119]
    v_mfma_f32_16x16x32_f16 v[120:123], v[60:63], v[84:87], v[120:123]
    ds_read_b128 v[80:83], v6 offset:1600
    ds_write_b128 v124, v[112:115] offset:1280
    ds_write_b32 v125, v126 offset:32
    s_waitcnt lgkmcnt(8)
    v_mfma_f32_16x16x32_f16 v[116:119], v[24:27], v[88:91], v[116:119]
    v_mfma_f32_16x16x32_f16 v[120:123], v[56:59], v[88:91], v[120:123]
    ds_read_b128 v[84:87], v6 offset:1664
    s_waitcnt lgkmcnt(8)
    v_mfma_f32_16x16x32_f16 v[116:119], v[20:23], v[92:95], v[116:119]
    v_mfma_f32_16x16x32_f16 v[120:123], v[52:55], v[92:95], v[120:123]
    ds_read_b128 v[88:91], v6 offset:1728
    s_waitcnt lgkmcnt(8)
    v_mfma_f32_16x16x32_f16 v[116:119], v[16:19], v[96:99], v[116:119]
    v_mfma_f32_16x16x32_f16 v[120:123], v[48:51], v[96:99], v[120:123]
    ds_read_b128 v[92:95], v6 offset:1792
    s_waitcnt lgkmcnt(8)
    v_mfma_f32_16x16x32_f16 v[116:119], v[12:15], v[100:103], v[116:119]
    v_mfma_f32_16x16x32_f16 v[120:123], v[44:47], v[100:103], v[120:123]
    ds_read_b128 v[96:99], v6 offset:1856
    s_waitcnt lgkmcnt(8)
    v_mfma_f32_16x16x32_f16 v[116:119], v[8:11], v[104:107], v[116:119]
    v_mfma_f32_16x16x32_f16 v[120:123], v[40:43], v[104:107], v[120:123]
    v_mfma_f32_16x16x32_f16 v[108:111], v[72:75], v[104:107], 0
    ds_read_b128 v[100:103], v6 offset:1920
    s_waitcnt lgkmcnt(8)
    v_mfma_f32_16x16x32_f16 v[120:123], v[36:39], v[76:79], v[120:123]
    v_mfma_f32_16x16x32_f16 v[108:111], v[68:71], v[76:79], v[108:111]
    ds_read_b128 v[104:107], v6 offset:1984
    s_waitcnt lgkmcnt(8)
    v_mfma_f32_16x16x32_f16 v[120:123], v[32:35], v[80:83], v[120:123]
    v_mfma_f32_16x16x32_f16 v[108:111], v[64:67], v[80:83], v[108:111]
    ds_read_b128 v[76:79], v6 offset:2048
    s_waitcnt lgkmcnt(6)
    v_mfma_f32_16x16x32_f16 v[120:123], v[28:31], v[84:87], v[120:123]
    v_mfma_f32_16x16x32_f16 v[108:111], v[60:63], v[84:87], v[108:111]
    ds_read_b128 v[80:83], v6 offset:2112
    ds_write_b128 v124, v[116:119] offset:2560
    ds_write_b32 v125, v126 offset:64
    s_waitcnt lgkmcnt(8)
    v_mfma_f32_16x16x32_f16 v[120:123], v[24:27], v[88:91], v[120:123]
    v_mfma_f32_16x16x32_f16 v[108:111], v[56:59], v[88:91], v[108:111]
    ds_read_b128 v[84:87], v6 offset:2176
    s_waitcnt lgkmcnt(8)
    v_mfma_f32_16x16x32_f16 v[120:123], v[20:23], v[92:95], v[120:123]
    v_mfma_f32_16x16x32_f16 v[108:111], v[52:55], v[92:95], v[108:111]
    ds_read_b128 v[88:91], v6 offset:2240
    s_waitcnt lgkmcnt(8)
    v_mfma_f32_16x16x32_f16 v[120:123], v[16:19], v[96:99], v[120:123]
    v_mfma_f32_16x16x32_f16 v[108:111], v[48:51], v[96:99], v[108:111]
    ds_read_b128 v[92:95], v6 offset:2304
    s_waitcnt lgkmcnt(8)
    v_mfma_f32_16x16x32_f16 v[120:123], v[12:15], v[100:103], v[120:123]
    v_mfma_f32_16x16x32_f16 v[108:111], v[44:47], v[100:103], v[108:111]
    ds_read_b128 v[96:99], v6 offset:2368
    s_waitcnt lgkmcnt(8)
    v_mfma_f32_16x16x32_f16 v[120:123], v[8:11], v[104:107], v[120:123]
    v_mfma_f32_16x16x32_f16 v[108:111], v[40:43], v[104:107], v[108:111]
    v_mfma_f32_16x16x32_f16 v[112:115], v[72:75], v[104:107], 0
    ds_read_b128 v[100:103], v6 offset:2432
    s_waitcnt lgkmcnt(8)
    v_mfma_f32_16x16x32_f16 v[108:111], v[36:39], v[76:79], v[108:111]
    v_mfma_f32_16x16x32_f16 v[112:115], v[68:71], v[76:79], v[112:115]
    ds_read_b128 v[104:107], v6 offset:2496
    s_waitcnt lgkmcnt(8)
    v_mfma_f32_16x16x32_f16 v[108:111], v[32:35], v[80:83], v[108:111]
    v_mfma_f32_16x16x32_f16 v[112:115], v[64:67], v[80:83], v[112:115]
    ds_read_b128 v[76:79], v6 offset:2560
    s_waitcnt lgkmcnt(6)
    v_mfma_f32_16x16x32_f16 v[108:111], v[28:31], v[84:87], v[108:111]
    v_mfma_f32_16x16x32_f16 v[112:115], v[60:63], v[84:87], v[112:115]
    ds_read_b128 v[80:83], v6 offset:2624
    ds_write_b128 v124, v[120:123] offset:3840
    ds_write_b32 v125, v126 offset:96
    s_waitcnt lgkmcnt(8)
    v_mfma_f32_16x16x32_f16 v[108:111], v[24:27], v[88:91], v[108:111]
    v_mfma_f32_16x16x32_f16 v[112:115], v[56:59], v[88:91], v[112:115]
    ds_read_b128 v[84:87], v6 offset:2688
    s_waitcnt lgkmcnt(8)
    v_mfma_f32_16x16x32_f16 v[108:111], v[20:23], v[92:95], v[108:111]
    v_mfma_f32_16x16x32_f16 v[112:115], v[52:55], v[92:95], v[112:115]
    ds_read_b128 v[88:91], v6 offset:2752
    s_waitcnt lgkmcnt(8)
    v_mfma_f32_16x16x32_f16 v[108:111], v[16:19], v[96:99], v[108:111]
    v_mfma_f32_16x16x32_f16 v[112:115], v[48:51], v[96:99], v[112:115]
    ds_read_b128 v[92:95], v6 offset:2816
    s_waitcnt lgkmcnt(8)
    v_mfma_f32_16x16x32_f16 v[108:111], v[12:15], v[100:103], v[108:111]
    v_mfma_f32_16x16x32_f16 v[112:115], v[44:47], v[100:103], v[112:115]
    ds_read_b128 v[96:99], v6 offset:2880
    s_waitcnt lgkmcnt(8)
    v_mfma_f32_16x16x32_f16 v[108:111], v[8:11], v[104:107], v[108:111]
    v_mfma_f32_16x16x32_f16 v[112:115], v[40:43], v[104:107], v[112:115]
    v_mfma_f32_16x16x32_f16 v[116:119], v[72:75], v[104:107], 0
    ds_read_b128 v[100:103], v6 offset:2944
    s_waitcnt lgkmcnt(8)
    v_mfma_f32_16x16x32_f16 v[112:115], v[36:39], v[76:79], v[112:115]
    v_mfma_f32_16x16x32_f16 v[116:119], v[68:71], v[76:79], v[116:119]
    ds_read_b128 v[104:107], v6 offset:3008
    s_waitcnt lgkmcnt(8)
    v_mfma_f32_16x16x32_f16 v[112:115], v[32:35], v[80:83], v[112:115]
    v_mfma_f32_16x16x32_f16 v[116:119], v[64:67], v[80:83], v[116:119]
    ds_read_b128 v[76:79], v6 offset:3072
    s_waitcnt lgkmcnt(6)
    v_mfma_f32_16x16x32_f16 v[112:115], v[28:31], v[84:87], v[112:115]
    v_mfma_f32_16x16x32_f16 v[116:119], v[60:63], v[84:87], v[116:119]
    ds_read_b128 v[80:83], v6 offset:3136
    ds_write_b128 v124, v[108:111] offset:5120
    ds_write_b32 v125, v126 offset:128
    s_waitcnt lgkmcnt(8)
    v_mfma_f32_16x16x32_f16 v[112:115], v[24:27], v[88:91], v[112:115]
    v_mfma_f32_16x16x32_f16 v[116:119], v[56:59], v[88:91], v[116:119]
    ds_read_b128 v[84:87], v6 offset:3200
    s_waitcnt lgkmcnt(8)
    v_mfma_f32_16x16x32_f16 v[112:115], v[20:23], v[92:95], v[112:115]
    v_mfma_f32_16x16x32_f16 v[116:119], v[52:55], v[92:95], v[116:119]
    ds_read_b128 v[88:91], v6 offset:3264
    s_waitcnt lgkmcnt(8)
    v_mfma_f32_16x16x32_f16 v[112:115], v[16:19], v[96:99], v[112:115]
    v_mfma_f32_16x16x32_f16 v[116:119], v[48:51], v[96:99], v[116:119]
    ds_read_b128 v[92:95], v6 offset:3328
    s_waitcnt lgkmcnt(8)
    v_mfma_f32_16x16x32_f16 v[112:115], v[12:15], v[100:103], v[112:115]
    v_mfma_f32_16x16x32_f16 v[116:119], v[44:47], v[100:103], v[116:119]
    ds_read_b128 v[96:99], v6 offset:3392
    s_waitcnt lgkmcnt(8)
    v_mfma_f32_16x16x32_f16 v[112:115], v[8:11], v[104:107], v[112:115]
    v_mfma_f32_16x16x32_f16 v[116:119], v[40:43], v[104:107], v[116:119]
    v_mfma_f32_16x16x32_f16 v[120:123], v[72:75], v[104:107], 0
    ds_read_b128 v[100:103], v6 offset:3456
    s_waitcnt lgkmcnt(8)
    v_mfma_f32_16x16x32_f16 v[116:119], v[36:39], v[76:79], v[116:119]
    v_mfma_f32_16x16x32_f16 v[120:123], v[68:71], v[76:79], v[120:123]
    ds_read_b128 v[104:107], v6 offset:3520
    s_waitcnt lgkmcnt(8)
    v_mfma_f32_16x16x32_f16 v[116:119], v[32:35], v[80:83], v[116:119]
    v_mfma_f32_16x16x32_f16 v[120:123], v[64:67], v[80:83], v[120:123]
    ds_read_b128 v[76:79], v6 offset:3584
    s_waitcnt lgkmcnt(6)
    v_mfma_f32_16x16x32_f16 v[116:119], v[28:31], v[84:87], v[116:119]
    v_mfma_f32_16x16x32_f16 v[120:123], v[60:63], v[84:87], v[120:123]
    ds_read_b128 v[80:83], v6 offset:3648
    ds_write_b128 v124, v[112:115] offset:6400
    ds_write_b32 v125, v126 offset:160
    s_waitcnt lgkmcnt(8)
    v_mfma_f32_16x16x32_f16 v[116:119], v[24:27], v[88:91], v[116:119]
    v_mfma_f32_16x16x32_f16 v[120:123], v[56:59], v[88:91], v[120:123]
    ds_read_b128 v[84:87], v6 offset:3712
    s_waitcnt lgkmcnt(8)
    v_mfma_f32_16x16x32_f16 v[116:119], v[20:23], v[92:95], v[116:119]
    v_mfma_f32_16x16x32_f16 v[120:123], v[52:55], v[92:95], v[120:123]
    ds_read_b128 v[88:91], v6 offset:3776
    s_waitcnt lgkmcnt(8)
    v_mfma_f32_16x16x32_f16 v[116:119], v[16:19], v[96:99], v[116:119]
    v_mfma_f32_16x16x32_f16 v[120:123], v[48:51], v[96:99], v[120:123]
    ds_read_b128 v[92:95], v6 offset:3840
    s_waitcnt lgkmcnt(8)
    v_mfma_f32_16x16x32_f16 v[116:119], v[12:15], v[100:103], v[116:119]
    v_mfma_f32_16x16x32_f16 v[120:123], v[44:47], v[100:103], v[120:123]
    ds_read_b128 v[96:99], v6 offset:3904
    s_waitcnt lgkmcnt(8)
    v_mfma_f32_16x16x32_f16 v[116:119], v[8:11], v[104:107], v[116:119]
    v_mfma_f32_16x16x32_f16 v[120:123], v[40:43], v[104:107], v[120:123]
    ds_read_b128 v[100:103], v6 offset:3968
    s_waitcnt lgkmcnt(8)
    v_mfma_f32_16x16x32_f16 v[120:123], v[36:39], v[76:79], v[120:123]
    ds_read_b128 v[104:107], v6 offset:4032
    s_waitcnt lgkmcnt(8)
    v_mfma_f32_16x16x32_f16 v[120:123], v[32:35], v[80:83], v[120:123]
    s_waitcnt lgkmcnt(5)
    v_mfma_f32_16x16x32_f16 v[120:123], v[28:31], v[84:87], v[120:123]
    ds_write_b128 v124, v[116:119] offset:7680
    ds_write_b32 v125, v126 offset:192
    s_waitcnt lgkmcnt(6)
    v_mfma_f32_16x16x32_f16 v[120:123], v[24:27], v[88:91], v[120:123]
    s_waitcnt lgkmcnt(5)
    v_mfma_f32_16x16x32_f16 v[120:123], v[20:23], v[92:95], v[120:123]
    s_waitcnt lgkmcnt(4)
    v_mfma_f32_16x16x32_f16 v[120:123], v[16:19], v[96:99], v[120:123]
    s_waitcnt lgkmcnt(3)
    v_mfma_f32_16x16x32_f16 v[120:123], v[12:15], v[100:103], v[120:123]
    s_waitcnt lgkmcnt(2)
    v_mfma_f32_16x16x32_f16 v[120:123], v[8:11], v[104:107], v[120:123]
    s_nop 7
    ds_write_b128 v124, v[120:123] offset:8960
    ds_write_b32 v125, v126 offset:224
    s_waitcnt lgkmcnt(0)
    s_endpgm
CK_T1:
    ds_read_b128 v[8:11], v128 offset:43296
    ds_read_b128 v[40:43], v128 offset:16896
    ds_read_b128 v[12:15], v128 offset:43360
    ds_read_b128 v[44:47], v128 offset:16960
    ds_read_b128 v[16:19], v128 offset:43424
    ds_read_b128 v[48:51], v128 offset:17024
    ds_read_b128 v[20:23], v128 offset:43488
    ds_read_b128 v[52:55], v128 offset:17088
    ds_read_b128 v[24:27], v128 offset:43552
    ds_read_b128 v[56:59], v128 offset:17152
    ds_read_b128 v[28:31], v128 offset:43616
    ds_read_b128 v[60:63], v128 offset:17216
    ds_read_b128 v[32:35], v128 offset:43680
    ds_read_b128 v[64:67], v128 offset:17280
    ds_read_b128 v[36:39], v128 offset:43744
    ds_read_b128 v[68:71], v128 offset:17344
    v_lshlrev_b32 v114, 8, v4
    v_lshl_add_u32 v114, v3, 4, v114
    v_add_u32 v114, s13, v114
    v_lshlrev_b32 v115, 7, v4
    v_lshl_add_u32 v115, v3, 2, v115
    v_add_u32 v115, s13, v115
    s_waitcnt lgkmcnt(14)
    v_mfma_f32_16x16x32_f16 v[104:107], v[40:43], v[8:11], 0
    s_waitcnt lgkmcnt(12)
    v_mfma_f32_16x16x32_f16 v[104:107], v[44:47], v[12:15], v[104:107]
    s_waitcnt lgkmcnt(10)
    v_mfma_f32_16x16x32_f16 v[104:107], v[48:51], v[16:19], v[104:107]
    s_waitcnt lgkmcnt(8)
    v_mfma_f32_16x16x32_f16 v[104:107], v[52:55], v[20:23], v[104:107]
    s_waitcnt lgkmcnt(6)
    v_mfma_f32_16x16x32_f16 v[104:107], v[56:59], v[24:27], v[104:107]
    s_waitcnt lgkmcnt(4)
    v_mfma_f32_16x16x32_f16 v[104:107], v[60:63], v[28:31], v[104:107]
    s_waitcnt lgkmcnt(2)
    v_mfma_f32_16x16x32_f16 v[104:107], v[64:67], v[32:35], v[104:107]
    s_waitcnt lgkmcnt(0)
    v_mfma_f32_16x16x32_f16 v[104:107], v[68:71], v[36:39], v[104:107]
    s_nop 7
    v_cvt_pk_f16_f32 v116, v104, v105
    v_cvt_pk_f16_f32 v117, v105, v105
    v_cvt_pk_f16_f32 v118, v106, v107
    v_cvt_pk_f16_f32 v119, v107, v107
    v_cvt_pk_f16_f32 v120, v105, v106
    s_mov_b32 exec_hi, 0
    ds_write_b16 v114, v119 offset:560
    v_add_u32 v121, 1728, v114
    ds_write_b128 v114, v[116:119] offset:544
    ds_write2_b32 v121, v119, v119 offset0:11 offset1:12
    ds_write2_b32 v121, v117, v120 offset0:9 offset1:10
    ds_write_b16 v121, v116 offset:34
    s_not_b64 exec, exec
    ds_write_b32 v115, v116 offset:2208
    ds_write_b32 v115, v118 offset:2272
    s_mov_b64 exec, -1
    s_waitcnt lgkmcnt(0)
    s_barrier
    v_lshlrev_b32 v5, 2, v4
    v_sub_u32 v5, v3, v5
    v_lshl_add_u32 v7, v5, 2, s13
    v_lshl_add_u32 v5, v5, 3, s13
    v_add_u32 v7, 2848, v7
    v_mov_b32 v6, s13
    ds_read_b32 v128, v6 offset:2716
    ds_read_b64 v[8:9], v5 offset:2464
    ds_read_b64 v[10:11], v5 offset:2456
    ds_read_b64 v[12:13], v5 offset:2448
    ds_read_b64 v[14:15], v5 offset:2440
    ds_read_b64 v[16:17], v5 offset:2592
    ds_read_b64 v[18:19], v5 offset:2584
    ds_read_b64 v[20:21], v5 offset:2576
    ds_read_b64 v[22:23], v5 offset:2568
    ds_read_b64 v[24:25], v5 offset:2720
    ds_read_b64 v[26:27], v5 offset:2712
    ds_read_b64 v[28:29], v5 offset:2704
    ds_read_b64 v[30:31], v5 offset:2696
    ds_read2_b32 v[32:33], v7 offset0:16 offset1:15
    ds_read2_b32 v[34:35], v7 offset0:14 offset1:13
    ds_read2_b32 v[36:37], v7 offset0:32 offset1:31
    ds_read2_b32 v[38:39], v7 offset0:30 offset1:29
    ds_read2_b32 v[40:41], v7 offset0:48 offset1:47
    ds_read2_b32 v[42:43], v7 offset0:46 offset1:45
    ds_read2_b32 v[44:45], v7 offset0:64 offset1:63
    ds_read2_b32 v[46:47], v7 offset0:62 offset1:61
    v_lshlrev_b32 v6, 4, v4
    v_lshl_add_u32 v6, v3, 5, v6
    v_add_u32 v6, 4048, v6
    v_add_u32 v6, s13, v6
    v_mul_u32_u24 v129, 320, v4
    v_lshl_add_u32 v129, v3, 4, v129
    s_mul_i32 s8, s7, 20480
    v_add_u32 v129, s8, v129
    s_lshl_b32 s8, s3, 2
    s_add_u32 s8, s8, 124032
    v_mov_b32 v130, s8
    v_mov_b32 v131, 1
    ds_write_b128 v129, v[124:127] offset:10240
    ds_write_b32 v130, v131 offset:0
    ds_write_b128 v129, v[124:127] offset:11520
    ds_write_b32 v130, v131 offset:32
    s_mov_b32 s8, 0x07060706
    s_waitcnt lgkmcnt(0)
    v_perm_b32 v128, v128, v128, s8
    v_and_b32 v156, v128, v156
    v_and_b32 v157, v128, v157
    v_and_b32 v158, v128, v158
    v_and_b32 v159, v128, v159
    s_setprio 2
    s_barrier
    ds_read_b128 v[48:51], v6 offset:16
    ds_read_b128 v[52:55], v6 offset:0
    ds_read_b128 v[56:59], v6 offset:528
    ds_read_b128 v[60:63], v6 offset:512
    s_waitcnt lgkmcnt(2)
    v_mfma_f32_16x16x32_f16 v[64:67], v[48:51], v[140:143], 0
    v_mfma_f32_16x16x32_f16 v[68:71], v[48:51], v[144:147], 0
    v_mfma_f32_16x16x32_f16 v[72:75], v[52:55], v[140:143], 0
    v_mfma_f32_16x16x32_f16 v[76:79], v[52:55], v[144:147], 0
    v_mfma_f32_16x16x32_f16 v[80:83], v[48:51], v[148:151], 0
    v_mfma_f32_16x16x32_f16 v[84:87], v[52:55], v[152:155], 0
    s_nop 5
    v_cvt_pk_f16_f32 v88, v64, v68
    v_cvt_pk_f16_f32 v89, v72, v76
    v_cvt_pk_f16_f32 v90, v65, v69
    v_cvt_pk_f16_f32 v91, v73, v77
    v_cvt_pk_f16_f32 v92, v66, v70
    v_cvt_pk_f16_f32 v93, v74, v78
    v_cvt_pk_f16_f32 v94, v67, v71
    v_cvt_pk_f16_f32 v95, v75, v79
    v_cvt_pk_f16_f32 v96, v80, v84
    v_cvt_pk_f16_f32 v97, v81, v85
    v_cvt_pk_f16_f32 v98, v82, v86
    v_cvt_pk_f16_f32 v99, v83, v87
    s_waitcnt lgkmcnt(0)
    v_mfma_f32_16x16x32_f16 v[64:67], v[56:59], v[140:143], 0
    v_mfma_f32_16x16x32_f16 v[68:71], v[56:59], v[144:147], 0
    v_mfma_f32_16x16x32_f16 v[72:75], v[60:63], v[140:143], 0
    v_mfma_f32_16x16x32_f16 v[76:79], v[60:63], v[144:147], 0
    v_mfma_f32_16x16x32_f16 v[80:83], v[56:59], v[148:151], 0
    v_mfma_f32_16x16x32_f16 v[84:87], v[60:63], v[152:155], 0
    v_mfma_f32_16x16x32_f16 v[100:103], v[88:91], v[8:11], 0
    v_mfma_f32_16x16x32_f16 v[100:103], v[92:95], v[12:15], v[100:103]
    v_mfma_f32_16x16x32_f16 v[104:107], v[88:91], v[16:19], 0
    v_mfma_f32_16x16x32_f16 v[104:107], v[92:95], v[20:23], v[104:107]
    v_mfma_f32_16x16x32_f16 v[108:111], v[88:91], v[24:27], 0
    v_mfma_f32_16x16x32_f16 v[108:111], v[92:95], v[28:31], v[108:111]
    v_mfma_f32_16x16x32_f16 v[108:111], v[156:159], v[48:51], v[108:111]
    v_mfma_f32_16x16x32_f16 v[108:111], v[96:99], v[32:35], v[108:111]
    v_mfma_f32_16x16x32_f16 v[112:115], v[96:99], v[36:39], 0
    v_mfma_f32_16x16x32_f16 v[116:119], v[96:99], v[40:43], 0
    v_mfma_f32_16x16x32_f16 v[120:123], v[96:99], v[44:47], 0
    ds_read_b128 v[48:51], v6 offset:1040
    ds_read_b128 v[52:55], v6 offset:1024
    ds_write_b128 v129, v[100:103] offset:12800
    ds_write_b32 v130, v131 offset:64
    v_cvt_pk_f16_f32 v88, v64, v68
    v_cvt_pk_f16_f32 v89, v72, v76
    v_cvt_pk_f16_f32 v90, v65, v69
    v_cvt_pk_f16_f32 v91, v73, v77
    v_cvt_pk_f16_f32 v92, v66, v70
    v_cvt_pk_f16_f32 v93, v74, v78
    v_cvt_pk_f16_f32 v94, v67, v71
    v_cvt_pk_f16_f32 v95, v75, v79
    v_cvt_pk_f16_f32 v96, v80, v84
    v_cvt_pk_f16_f32 v97, v81, v85
    v_cvt_pk_f16_f32 v98, v82, v86
    v_cvt_pk_f16_f32 v99, v83, v87
    s_waitcnt lgkmcnt(2)
    v_mfma_f32_16x16x32_f16 v[64:67], v[48:51], v[140:143], 0
    v_mfma_f32_16x16x32_f16 v[68:71], v[48:51], v[144:147], 0
    v_mfma_f32_16x16x32_f16 v[72:75], v[52:55], v[140:143], 0
    v_mfma_f32_16x16x32_f16 v[76:79], v[52:55], v[144:147], 0
    v_mfma_f32_16x16x32_f16 v[80:83], v[48:51], v[148:151], 0
    v_mfma_f32_16x16x32_f16 v[84:87], v[52:55], v[152:155], 0
    v_mfma_f32_16x16x32_f16 v[104:107], v[88:91], v[8:11], v[104:107]
    v_mfma_f32_16x16x32_f16 v[104:107], v[92:95], v[12:15], v[104:107]
    v_mfma_f32_16x16x32_f16 v[108:111], v[88:91], v[16:19], v[108:111]
    v_mfma_f32_16x16x32_f16 v[108:111], v[92:95], v[20:23], v[108:111]
    v_mfma_f32_16x16x32_f16 v[112:115], v[88:91], v[24:27], v[112:115]
    v_mfma_f32_16x16x32_f16 v[112:115], v[92:95], v[28:31], v[112:115]
    v_mfma_f32_16x16x32_f16 v[112:115], v[156:159], v[56:59], v[112:115]
    v_mfma_f32_16x16x32_f16 v[112:115], v[96:99], v[32:35], v[112:115]
    v_mfma_f32_16x16x32_f16 v[116:119], v[96:99], v[36:39], v[116:119]
    v_mfma_f32_16x16x32_f16 v[120:123], v[96:99], v[40:43], v[120:123]
    ds_read_b128 v[56:59], v6 offset:1552
    ds_read_b128 v[60:63], v6 offset:1536
    ds_write_b128 v129, v[104:107] offset:14080
    ds_write_b32 v130, v131 offset:96
    v_cvt_pk_f16_f32 v88, v64, v68
    v_cvt_pk_f16_f32 v89, v72, v76
    v_cvt_pk_f16_f32 v90, v65, v69
    v_cvt_pk_f16_f32 v91, v73, v77
    v_cvt_pk_f16_f32 v92, v66, v70
    v_cvt_pk_f16_f32 v93, v74, v78
    v_cvt_pk_f16_f32 v94, v67, v71
    v_cvt_pk_f16_f32 v95, v75, v79
    v_cvt_pk_f16_f32 v96, v80, v84
    v_cvt_pk_f16_f32 v97, v81, v85
    v_cvt_pk_f16_f32 v98, v82, v86
    v_cvt_pk_f16_f32 v99, v83, v87
    s_waitcnt lgkmcnt(2)
    v_mfma_f32_16x16x32_f16 v[64:67], v[56:59], v[140:143], 0
    v_mfma_f32_16x16x32_f16 v[68:71], v[56:59], v[144:147], 0
    v_mfma_f32_16x16x32_f16 v[72:75], v[60:63], v[140:143], 0
    v_mfma_f32_16x16x32_f16 v[76:79], v[60:63], v[144:147], 0
    v_mfma_f32_16x16x32_f16 v[80:83], v[56:59], v[148:151], 0
    v_mfma_f32_16x16x32_f16 v[84:87], v[60:63], v[152:155], 0
    v_mfma_f32_16x16x32_f16 v[108:111], v[88:91], v[8:11], v[108:111]
    v_mfma_f32_16x16x32_f16 v[108:111], v[92:95], v[12:15], v[108:111]
    v_mfma_f32_16x16x32_f16 v[112:115], v[88:91], v[16:19], v[112:115]
    v_mfma_f32_16x16x32_f16 v[112:115], v[92:95], v[20:23], v[112:115]
    v_mfma_f32_16x16x32_f16 v[116:119], v[88:91], v[24:27], v[116:119]
    v_mfma_f32_16x16x32_f16 v[116:119], v[92:95], v[28:31], v[116:119]
    v_mfma_f32_16x16x32_f16 v[116:119], v[156:159], v[48:51], v[116:119]
    v_mfma_f32_16x16x32_f16 v[116:119], v[96:99], v[32:35], v[116:119]
    v_mfma_f32_16x16x32_f16 v[120:123], v[96:99], v[36:39], v[120:123]
    ds_read_b128 v[48:51], v6 offset:2064
    ds_read_b128 v[52:55], v6 offset:2048
    ds_write_b128 v129, v[108:111] offset:15360
    ds_write_b32 v130, v131 offset:128
    v_cvt_pk_f16_f32 v88, v64, v68
    v_cvt_pk_f16_f32 v89, v72, v76
    v_cvt_pk_f16_f32 v90, v65, v69
    v_cvt_pk_f16_f32 v91, v73, v77
    v_cvt_pk_f16_f32 v92, v66, v70
    v_cvt_pk_f16_f32 v93, v74, v78
    v_cvt_pk_f16_f32 v94, v67, v71
    v_cvt_pk_f16_f32 v95, v75, v79
    v_cvt_pk_f16_f32 v96, v80, v84
    v_cvt_pk_f16_f32 v97, v81, v85
    v_cvt_pk_f16_f32 v98, v82, v86
    v_cvt_pk_f16_f32 v99, v83, v87
    s_waitcnt lgkmcnt(2)
    v_mfma_f32_16x16x32_f16 v[64:67], v[48:51], v[140:143], 0
    v_mfma_f32_16x16x32_f16 v[68:71], v[48:51], v[144:147], 0
    v_mfma_f32_16x16x32_f16 v[72:75], v[52:55], v[140:143], 0
    v_mfma_f32_16x16x32_f16 v[76:79], v[52:55], v[144:147], 0
    v_mfma_f32_16x16x32_f16 v[112:115], v[88:91], v[8:11], v[112:115]
    v_mfma_f32_16x16x32_f16 v[112:115], v[92:95], v[12:15], v[112:115]
    v_mfma_f32_16x16x32_f16 v[116:119], v[88:91], v[16:19], v[116:119]
    v_mfma_f32_16x16x32_f16 v[116:119], v[92:95], v[20:23], v[116:119]
    v_mfma_f32_16x16x32_f16 v[120:123], v[88:91], v[24:27], v[120:123]
    v_mfma_f32_16x16x32_f16 v[120:123], v[92:95], v[28:31], v[120:123]
    v_mfma_f32_16x16x32_f16 v[120:123], v[156:159], v[56:59], v[120:123]
    v_mfma_f32_16x16x32_f16 v[120:123], v[96:99], v[32:35], v[120:123]
    ds_read_b128 v[56:59], v6 offset:2576
    ds_read_b128 v[60:63], v6 offset:2560
    ds_write_b128 v129, v[112:115] offset:16640
    ds_write_b32 v130, v131 offset:160
    v_cvt_pk_f16_f32 v88, v64, v68
    v_cvt_pk_f16_f32 v89, v72, v76
    v_cvt_pk_f16_f32 v90, v65, v69
    v_cvt_pk_f16_f32 v91, v73, v77
    v_cvt_pk_f16_f32 v92, v66, v70
    v_cvt_pk_f16_f32 v93, v74, v78
    v_cvt_pk_f16_f32 v94, v67, v71
    v_cvt_pk_f16_f32 v95, v75, v79
    s_waitcnt lgkmcnt(2)
    v_mfma_f32_16x16x32_f16 v[64:67], v[56:59], v[140:143], 0
    v_mfma_f32_16x16x32_f16 v[68:71], v[56:59], v[144:147], 0
    v_mfma_f32_16x16x32_f16 v[72:75], v[60:63], v[140:143], 0
    v_mfma_f32_16x16x32_f16 v[76:79], v[60:63], v[144:147], 0
    v_mfma_f32_16x16x32_f16 v[116:119], v[88:91], v[8:11], v[116:119]
    v_mfma_f32_16x16x32_f16 v[116:119], v[92:95], v[12:15], v[116:119]
    v_mfma_f32_16x16x32_f16 v[120:123], v[88:91], v[16:19], v[120:123]
    v_mfma_f32_16x16x32_f16 v[120:123], v[92:95], v[20:23], v[120:123]
    s_nop 5
    ds_write_b128 v129, v[116:119] offset:17920
    ds_write_b32 v130, v131 offset:192
    v_cvt_pk_f16_f32 v88, v64, v68
    v_cvt_pk_f16_f32 v89, v72, v76
    v_cvt_pk_f16_f32 v90, v65, v69
    v_cvt_pk_f16_f32 v91, v73, v77
    v_cvt_pk_f16_f32 v92, v66, v70
    v_cvt_pk_f16_f32 v93, v74, v78
    v_cvt_pk_f16_f32 v94, v67, v71
    v_cvt_pk_f16_f32 v95, v75, v79
    s_nop 1
    v_mfma_f32_16x16x32_f16 v[120:123], v[88:91], v[8:11], v[120:123]
    v_mfma_f32_16x16x32_f16 v[120:123], v[92:95], v[12:15], v[120:123]
    s_nop 7
    ds_write_b128 v129, v[120:123] offset:19200
    ds_write_b32 v130, v131 offset:224
    s_cmp_eq_u32 s3, 4
    s_cbranch_scc1 FINAL
    s_waitcnt lgkmcnt(0)
    s_endpgm
CU_MAIN:
    s_load_dwordx2 s[52:53], s[32:33], s9
    v_mov_b32 v58, 1
    s_mov_b64 exec, 1
    ds_add_u32 v57, v58 offset:64
    s_mov_b64 exec, -1
    v_lshlrev_b32 v137, 4, v2
    v_and_b32 v7, 0x3c0, v137
    v_add_u32 v7, v7, v137
    v_and_b32 v138, 0x3e0, v137
    v_mul_u32_u24 v138, 3, v138
    v_add_u32 v138, v138, v137
    v_add_u32 v138, 10304, v138
    s_lshl_b32 s8, s7, 11
    s_add_u32 s8, s8, 20480
    v_add_u32 v7, s8, v7
    v_add_u32 v137, 8192, v7
    v_add_u32 v138, 20480, v138
    s_cmp_eq_u32 s7, 3
    s_cselect_b64 vcc, -1, 0
    v_cndmask_b32 v137, v137, v138, vcc
    v_and_b32 v56, 12, v3
    v_add_u32 v56, 153600, v56
    v_and_b32 v57, 3, v2
    v_lshlrev_b32 v57, 2, v57
    v_add_u32 v57, 153600, v57
    s_lshl_b32 s8, s7, 9
    s_add_u32 s8, s8, 124928
    v_lshl_add_u32 v58, v2, 3, s8
    s_mov_b32 s10, 0x11111111
    s_mov_b32 s11, 0x11111111
    s_waitcnt vmcnt(7)
    v_lshlrev_b32 v24, 16, v8
    v_and_b32 v28, 0xffff0000, v8
    v_lshlrev_b32 v32, 16, v9
    v_and_b32 v36, 0xffff0000, v9
    s_waitcnt vmcnt(6)
    v_lshlrev_b32 v25, 16, v10
    v_and_b32 v29, 0xffff0000, v10
    v_lshlrev_b32 v33, 16, v11
    v_and_b32 v37, 0xffff0000, v11
    v_max3_f32 v62, |v24|, |v25|, 0
    v_max3_f32 v63, |v28|, |v29|, 0
    v_max3_f32 v64, |v32|, |v33|, 0
    v_max3_f32 v65, |v36|, |v37|, 0
    s_waitcnt vmcnt(5)
    v_lshlrev_b32 v26, 16, v12
    v_and_b32 v30, 0xffff0000, v12
    v_lshlrev_b32 v34, 16, v13
    v_and_b32 v38, 0xffff0000, v13
    s_waitcnt vmcnt(4)
    v_lshlrev_b32 v27, 16, v14
    v_and_b32 v31, 0xffff0000, v14
    v_lshlrev_b32 v35, 16, v15
    v_and_b32 v39, 0xffff0000, v15
    v_max3_f32 v62, |v26|, |v27|, v62
    v_max3_f32 v63, |v30|, |v31|, v63
    v_max3_f32 v64, |v34|, |v35|, v64
    v_max3_f32 v65, |v38|, |v39|, v65
    s_waitcnt vmcnt(3)
    v_lshlrev_b32 v40, 16, v16
    v_and_b32 v44, 0xffff0000, v16
    v_lshlrev_b32 v48, 16, v17
    v_and_b32 v52, 0xffff0000, v17
    s_waitcnt vmcnt(2)
    v_lshlrev_b32 v41, 16, v18
    v_and_b32 v45, 0xffff0000, v18
    v_lshlrev_b32 v49, 16, v19
    v_and_b32 v53, 0xffff0000, v19
    v_max3_f32 v62, |v40|, |v41|, v62
    v_max3_f32 v63, |v44|, |v45|, v63
    v_max3_f32 v64, |v48|, |v49|, v64
    v_max3_f32 v65, |v52|, |v53|, v65
    s_waitcnt vmcnt(1)
    v_lshlrev_b32 v42, 16, v20
    v_and_b32 v46, 0xffff0000, v20
    v_lshlrev_b32 v50, 16, v21
    v_and_b32 v54, 0xffff0000, v21
    s_waitcnt vmcnt(0)
    v_lshlrev_b32 v43, 16, v22
    v_and_b32 v47, 0xffff0000, v22
    v_lshlrev_b32 v51, 16, v23
    v_and_b32 v55, 0xffff0000, v23
    v_max3_f32 v62, |v42|, |v43|, v62
    v_max3_f32 v63, |v46|, |v47|, v63
    v_max3_f32 v64, |v50|, |v51|, v64
    v_max3_f32 v65, |v54|, |v55|, v65
    v_max_u32_dpp v62, v62, v62 row_ror:4 row_mask:0xf bank_mask:0xf
    v_max_u32_dpp v63, v63, v63 row_ror:4 row_mask:0xf bank_mask:0xf
    v_max_u32_dpp v64, v64, v64 row_ror:4 row_mask:0xf bank_mask:0xf
    v_max_u32_dpp v65, v65, v65 row_ror:4 row_mask:0xf bank_mask:0xf
    v_max_u32_dpp v61, v62, v62 row_ror:8 row_mask:0xf bank_mask:0x1
    s_nop 1
    v_max_u32_dpp v61, v63, v63 row_ror:8 row_mask:0xf bank_mask:0x2
    s_nop 1
    v_max_u32_dpp v61, v64, v64 row_ror:8 row_mask:0xf bank_mask:0x4
    s_nop 1
    v_max_u32_dpp v61, v65, v65 row_ror:8 row_mask:0xf bank_mask:0x8
    s_nop 1
    v_max_u32_dpp v61, v61, v61 quad_perm:[1,0,3,2] row_mask:0xf bank_mask:0xf
    s_nop 1
    v_max_u32_dpp v61, v61, v61 quad_perm:[2,3,0,1] row_mask:0xf bank_mask:0xf
    s_mov_b64 exec, s[10:11]
    ds_max_u32 v56, v61
    s_mov_b64 exec, -1
    s_waitcnt lgkmcnt(0)
    s_barrier
    ds_read2_b32 v[62:63], v57 offset0:0 offset1:4
    s_waitcnt lgkmcnt(0)
    v_lshrrev_b32 v62, 23, v62
    v_sub_u32 v62, 265, v62
    v_min_i32 v62, 253, v62
    v_lshlrev_b32 v64, 23, v62
    v_add_u32 v62, v62, v63
    v_readlane_b32 s56, v64, 0
    v_readlane_b32 s57, v64, 1
    v_readlane_b32 s58, v64, 2
    v_readlane_b32 s59, v64, 3
    v_sub_u32 v62, 381, v62
    v_pk_mul_f32 v[66:67], v[24:25], s[56:57] op_sel_hi:[1,0]
    v_pk_mul_f32 v[68:69], v[26:27], s[56:57] op_sel_hi:[1,0]
    v_cvt_pk_f16_f32 v70, v67, v66
    v_cvt_pk_f16_f32 v71, v69, v68
    ds_write_b64 v58, v[70:71] offset:0
    v_pk_mul_f32 v[72:73], v[28:29], s[56:57] op_sel:[0,1] op_sel_hi:[1,1]
    v_pk_mul_f32 v[74:75], v[30:31], s[56:57] op_sel:[0,1] op_sel_hi:[1,1]
    v_cvt_pk_f16_f32 v76, v73, v72
    v_cvt_pk_f16_f32 v77, v75, v74
    ds_write_b64 v58, v[76:77] offset:8192
    v_pk_mul_f32 v[66:67], v[32:33], s[58:59] op_sel_hi:[1,0]
    v_pk_mul_f32 v[68:69], v[34:35], s[58:59] op_sel_hi:[1,0]
    v_cvt_pk_f16_f32 v70, v67, v66
    v_cvt_pk_f16_f32 v71, v69, v68
    ds_write_b64 v58, v[70:71] offset:16384
    v_pk_mul_f32 v[72:73], v[36:37], s[58:59] op_sel:[0,1] op_sel_hi:[1,1]
    v_pk_mul_f32 v[74:75], v[38:39], s[58:59] op_sel:[0,1] op_sel_hi:[1,1]
    v_cvt_pk_f16_f32 v76, v73, v72
    v_cvt_pk_f16_f32 v77, v75, v74
    ds_write_b64 v58, v[76:77] offset:24576
    v_pk_mul_f32 v[66:67], v[40:41], s[56:57] op_sel_hi:[1,0]
    v_pk_mul_f32 v[68:69], v[42:43], s[56:57] op_sel_hi:[1,0]
    v_cvt_pk_f16_f32 v70, v67, v66
    v_cvt_pk_f16_f32 v71, v69, v68
    ds_write_b64 v58, v[70:71] offset:2048
    v_pk_mul_f32 v[72:73], v[44:45], s[56:57] op_sel:[0,1] op_sel_hi:[1,1]
    v_pk_mul_f32 v[74:75], v[46:47], s[56:57] op_sel:[0,1] op_sel_hi:[1,1]
    v_cvt_pk_f16_f32 v76, v73, v72
    v_cvt_pk_f16_f32 v77, v75, v74
    ds_write_b64 v58, v[76:77] offset:10240
    v_pk_mul_f32 v[66:67], v[48:49], s[58:59] op_sel_hi:[1,0]
    v_pk_mul_f32 v[68:69], v[50:51], s[58:59] op_sel_hi:[1,0]
    v_cvt_pk_f16_f32 v70, v67, v66
    v_cvt_pk_f16_f32 v71, v69, v68
    ds_write_b64 v58, v[70:71] offset:18432
    v_pk_mul_f32 v[72:73], v[52:53], s[58:59] op_sel:[0,1] op_sel_hi:[1,1]
    v_pk_mul_f32 v[74:75], v[54:55], s[58:59] op_sel:[0,1] op_sel_hi:[1,1]
    v_cvt_pk_f16_f32 v76, v73, v72
    v_cvt_pk_f16_f32 v77, v75, v74
    ds_write_b64 v58, v[76:77] offset:26624
    s_waitcnt lgkmcnt(0)
    s_barrier
    global_load_dword v136, v59, s[48:49] offset:128 sc1
    global_load_dwordx4 v[128:131], v7, s[50:51] sc1
    global_load_dwordx4 v[132:135], v137, s[50:51] sc1
    s_add_u32 s15, s7, 4
    s_mul_i32 s14, s15, 18
    s_add_u32 s14, s14, s101
    s_cmp_ge_u32 s14, 72
    s_cbranch_scc1 CPF_DE0
    v_mul_u32_u24 v140, 9216, v2
    s_mul_i32 s8, s4, 1152
    v_add_u32 v140, s8, v140
    s_mul_i32 s8, s14, 7282
    s_lshr_b32 s8, s8, 16
    s_mul_i32 s9, s8, 9
    s_sub_u32 s9, s14, s9
    s_lshl_b32 s9, s9, 7
    s_bitcmp1_b32 s8, 0
    s_cselect_b32 s12, s40, s38
    s_cselect_b32 s13, s41, s39
    s_lshr_b32 s8, s8, 1
    s_add_u32 s8, s8, 5
    s_mul_i32 s8, s8, 589824
    s_add_u32 s8, s8, s9
    v_add_u32 v141, s8, v140
    global_load_dword v142, v141, s[12:13]
    s_branch CPF_XE0
CPF_DE0:
    s_sub_u32 s14, s14, 72
    s_min_u32 s14, s14, 80
    s_mul_i32 s8, s4, 81
    s_add_u32 s8, s8, s14
    s_lshl_b32 s8, s8, 13
    v_lshl_add_u32 v141, v2, 7, s8
    global_load_dword v142, v141, s[42:43]
CPF_XE0:
    s_add_u32 s15, s7, 8
    s_mul_i32 s14, s15, 18
    s_add_u32 s14, s14, s101
    s_cmp_ge_u32 s14, 72
    s_cbranch_scc1 CPF_DE1
    v_mul_u32_u24 v140, 9216, v2
    s_mul_i32 s8, s4, 1152
    v_add_u32 v140, s8, v140
    s_mul_i32 s8, s14, 7282
    s_lshr_b32 s8, s8, 16
    s_mul_i32 s9, s8, 9
    s_sub_u32 s9, s14, s9
    s_lshl_b32 s9, s9, 7
    s_bitcmp1_b32 s8, 0
    s_cselect_b32 s12, s40, s38
    s_cselect_b32 s13, s41, s39
    s_lshr_b32 s8, s8, 1
    s_add_u32 s8, s8, 5
    s_mul_i32 s8, s8, 589824
    s_add_u32 s8, s8, s9
    v_add_u32 v141, s8, v140
    global_load_dword v142, v141, s[12:13]
    s_branch CPF_XE1
CPF_DE1:
    s_sub_u32 s14, s14, 72
    s_min_u32 s14, s14, 80
    s_mul_i32 s8, s4, 81
    s_add_u32 s8, s8, s14
    s_lshl_b32 s8, s8, 13
    v_lshl_add_u32 v141, v2, 7, s8
    global_load_dword v142, v141, s[42:43]
CPF_XE1:
    v_max_i32 v62, 0, v62
    v_min_i32 v62, 254, v62
    v_lshlrev_b32 v62, 23, v62
    s_nop 0
    v_readlane_b32 s56, v62, 0
    v_readlane_b32 s57, v62, 1
    v_readlane_b32 s58, v62, 2
    v_readlane_b32 s59, v62, 3
    s_lshl_b32 s60, s52, 16
    s_and_b32 s61, s52, 0xffff0000
    s_lshl_b32 s62, s53, 16
    s_and_b32 s63, s53, 0xffff0000
    s_mov_b32 s12, 0
    s_waitcnt vmcnt(2)
    s_branch E_GCHK
E_GPOLL:
    global_load_dword v136, v59, s[48:49] offset:128 sc1
    global_load_dwordx4 v[128:131], v7, s[50:51] sc1
    global_load_dwordx4 v[132:135], v137, s[50:51] sc1
    s_add_u32 s12, s12, 1
    s_waitcnt vmcnt(0)
E_GCHK:
    v_lshrrev_b32 v61, 16, v136
    v_xor_b32 v61, 1, v61
    v_bitop3_b32 v61, v61, v128, v136 bitop3:0xf6
    v_bitop3_b32 v61, v61, v129, v136 bitop3:0xf6
    v_bitop3_b32 v61, v61, v130, v136 bitop3:0xf6
    v_bitop3_b32 v61, v61, v131, v136 bitop3:0xf6
    v_bitop3_b32 v61, v61, v132, v136 bitop3:0xf6
    v_bitop3_b32 v61, v61, v133, v136 bitop3:0xf6
    v_bitop3_b32 v61, v61, v134, v136 bitop3:0xf6
    v_bitop3_b32 v61, v61, v135, v136 bitop3:0xf6
    v_and_b32 v61, 0xffff, v61
    v_cmp_ne_u32 vcc, 0, v61
    s_cmp_ge_u32 s12, 16384
    s_cbranch_scc1 E_GOK
    s_cbranch_vccnz E_GPOLL
E_GOK:
    v_and_b32 v56, 3, v2
    v_mul_u32_u24 v56, 320, v56
    v_lshrrev_b32 v57, 2, v2
    v_lshl_add_u32 v56, v57, 4, v56
    s_mul_i32 s8, s7, 1280
    v_add_u32 v56, s8, v56
    v_add_u32 v57, 40960, v56
    v_and_b32 v58, 7, v2
    s_lshl_b32 s8, s7, 5
    s_add_u32 s8, s8, 124032
    v_lshl_add_u32 v58, v58, 2, s8
    v_mov_b32 v59, 0x3f803f80
    v_and_b32 v128, 0xffff0000, v128
    v_sub_f32 v16, 1.0, v128
    v_and_b32 v129, 0xffff0000, v129
    v_sub_f32 v17, 1.0, v129
    v_and_b32 v130, 0xffff0000, v130
    v_sub_f32 v18, 1.0, v130
    v_and_b32 v131, 0xffff0000, v131
    v_sub_f32 v19, 1.0, v131
    v_cvt_pk_bf16_f32 v20, v16, v17
    v_cvt_pk_bf16_f32 v21, v18, v19
    v_lshrrev_b32 v128, 16, v128
    v_lshrrev_b32 v130, 16, v130
    v_lshlrev_b32 v16, 16, v20
    v_and_b32 v17, 0xffff0000, v20
    v_lshlrev_b32 v18, 16, v21
    v_and_b32 v19, 0xffff0000, v21
    v_pk_mul_f32 v[64:65], v[24:25], s[60:61] op_sel_hi:[1,0]
    v_pk_mul_f32 v[80:81], v[24:25], v[16:17]
    v_pk_mul_f32 v[66:67], v[26:27], s[60:61] op_sel_hi:[1,0]
    v_pk_mul_f32 v[82:83], v[26:27], v[18:19]
    v_pk_mul_f32 v[68:69], v[28:29], s[60:61] op_sel:[0,1] op_sel_hi:[1,1]
    v_pk_mul_f32 v[84:85], v[28:29], v[16:17]
    v_pk_mul_f32 v[70:71], v[30:31], s[60:61] op_sel:[0,1] op_sel_hi:[1,1]
    v_pk_mul_f32 v[86:87], v[30:31], v[18:19]
    v_pk_mul_f32 v[72:73], v[32:33], s[62:63] op_sel_hi:[1,0]
    v_pk_mul_f32 v[88:89], v[32:33], v[16:17]
    v_pk_mul_f32 v[74:75], v[34:35], s[62:63] op_sel_hi:[1,0]
    v_pk_mul_f32 v[90:91], v[34:35], v[18:19]
    v_pk_mul_f32 v[76:77], v[36:37], s[62:63] op_sel:[0,1] op_sel_hi:[1,1]
    v_pk_mul_f32 v[92:93], v[36:37], v[16:17]
    v_pk_mul_f32 v[78:79], v[38:39], s[62:63] op_sel:[0,1] op_sel_hi:[1,1]
    v_pk_mul_f32 v[94:95], v[38:39], v[18:19]
    s_mov_b32 s12, 0
E_WAIT0:
    ds_read_b32 v60, v58 offset:0
    s_add_u32 s12, s12, 1
    s_waitcnt lgkmcnt(0)
    v_cmp_eq_u32 vcc, 0, v60
    s_cmp_ge_u32 s12, 0x40000
    s_cbranch_scc1 E_RDY0
    s_cbranch_vccz E_RDY0
    s_sleep 1
    s_branch E_WAIT0
E_RDY0:
    ds_read_b128 v[96:99], v56 offset:0
    ds_read_b128 v[112:115], v56 offset:10240
    ds_read_b128 v[100:103], v56 offset:20480
    ds_read_b128 v[116:119], v56 offset:30720
    ds_read_b128 v[104:107], v57 offset:0
    ds_read_b128 v[120:123], v57 offset:10240
    ds_read_b128 v[108:111], v57 offset:20480
    ds_read_b128 v[124:127], v57 offset:30720
    s_waitcnt lgkmcnt(6)
    v_pk_add_f32 v[96:97], v[96:97], v[112:113]
    v_pk_add_f32 v[98:99], v[98:99], v[114:115]
    v_pk_mul_f32 v[96:97], v[96:97], s[56:57] op_sel_hi:[1,0]
    v_pk_mul_f32 v[98:99], v[98:99], s[56:57] op_sel_hi:[1,0]
    v_cvt_pk_bf16_f32 v96, v96, v64
    v_cvt_pk_bf16_f32 v97, v97, v65
    v_cvt_pk_bf16_f32 v98, v98, v66
    v_cvt_pk_bf16_f32 v99, v99, v67
    v_dot2_f32_bf16 v96, v96, v59, 0
    v_dot2_f32_bf16 v97, v97, v59, 0
    v_dot2_f32_bf16 v98, v98, v59, 0
    v_dot2_f32_bf16 v99, v99, v59, 0
    s_waitcnt lgkmcnt(4)
    v_pk_add_f32 v[100:101], v[100:101], v[116:117]
    v_pk_add_f32 v[102:103], v[102:103], v[118:119]
    v_pk_mul_f32 v[100:101], v[100:101], s[56:57] op_sel:[0,1] op_sel_hi:[1,1]
    v_pk_mul_f32 v[102:103], v[102:103], s[56:57] op_sel:[0,1] op_sel_hi:[1,1]
    v_cvt_pk_bf16_f32 v100, v100, v68
    v_cvt_pk_bf16_f32 v101, v101, v69
    v_cvt_pk_bf16_f32 v102, v102, v70
    v_cvt_pk_bf16_f32 v103, v103, v71
    v_dot2_f32_bf16 v100, v100, v59, 0
    v_dot2_f32_bf16 v101, v101, v59, 0
    v_dot2_f32_bf16 v102, v102, v59, 0
    v_dot2_f32_bf16 v103, v103, v59, 0
    s_waitcnt lgkmcnt(2)
    v_pk_add_f32 v[104:105], v[104:105], v[120:121]
    v_pk_add_f32 v[106:107], v[106:107], v[122:123]
    v_pk_mul_f32 v[104:105], v[104:105], s[58:59] op_sel_hi:[1,0]
    v_pk_mul_f32 v[106:107], v[106:107], s[58:59] op_sel_hi:[1,0]
    v_cvt_pk_bf16_f32 v104, v104, v72
    v_cvt_pk_bf16_f32 v105, v105, v73
    v_cvt_pk_bf16_f32 v106, v106, v74
    v_cvt_pk_bf16_f32 v107, v107, v75
    v_dot2_f32_bf16 v104, v104, v59, 0
    v_dot2_f32_bf16 v105, v105, v59, 0
    v_dot2_f32_bf16 v106, v106, v59, 0
    v_dot2_f32_bf16 v107, v107, v59, 0
    s_waitcnt lgkmcnt(0)
    v_pk_add_f32 v[108:109], v[108:109], v[124:125]
    v_pk_add_f32 v[110:111], v[110:111], v[126:127]
    v_pk_mul_f32 v[108:109], v[108:109], s[58:59] op_sel:[0,1] op_sel_hi:[1,1]
    v_pk_mul_f32 v[110:111], v[110:111], s[58:59] op_sel:[0,1] op_sel_hi:[1,1]
    v_cvt_pk_bf16_f32 v108, v108, v76
    v_cvt_pk_bf16_f32 v109, v109, v77
    v_cvt_pk_bf16_f32 v110, v110, v78
    v_cvt_pk_bf16_f32 v111, v111, v79
    v_dot2_f32_bf16 v108, v108, v59, 0
    v_dot2_f32_bf16 v109, v109, v59, 0
    v_dot2_f32_bf16 v110, v110, v59, 0
    v_dot2_f32_bf16 v111, v111, v59, 0
    s_nop 0
    v_cvt_pk_bf16_f32 v112, v96, v97
    v_cvt_pk_bf16_f32 v113, v98, v99
    v_cvt_pk_bf16_f32 v114, v100, v101
    v_cvt_pk_bf16_f32 v115, v102, v103
    v_cvt_pk_bf16_f32 v116, v104, v105
    v_cvt_pk_bf16_f32 v117, v106, v107
    v_cvt_pk_bf16_f32 v118, v108, v109
    v_cvt_pk_bf16_f32 v119, v110, v111
    v_dot2_f32_bf16 v96, v112, v128, 0
    v_dot2_f32_bf16 v97, v112, v129, 0
    v_dot2_f32_bf16 v98, v113, v130, 0
    v_dot2_f32_bf16 v99, v113, v131, 0
    v_dot2_f32_bf16 v100, v114, v128, 0
    v_dot2_f32_bf16 v101, v114, v129, 0
    v_dot2_f32_bf16 v102, v115, v130, 0
    v_dot2_f32_bf16 v103, v115, v131, 0
    v_dot2_f32_bf16 v104, v116, v128, 0
    v_dot2_f32_bf16 v105, v116, v129, 0
    v_dot2_f32_bf16 v106, v117, v130, 0
    v_dot2_f32_bf16 v107, v117, v131, 0
    v_dot2_f32_bf16 v108, v118, v128, 0
    v_dot2_f32_bf16 v109, v118, v129, 0
    v_dot2_f32_bf16 v110, v119, v130, 0
    v_dot2_f32_bf16 v111, v119, v131, 0
    v_cvt_pk_bf16_f32 v96, v96, v80
    v_cvt_pk_bf16_f32 v97, v97, v81
    v_cvt_pk_bf16_f32 v98, v98, v82
    v_cvt_pk_bf16_f32 v99, v99, v83
    v_cvt_pk_bf16_f32 v100, v100, v84
    v_cvt_pk_bf16_f32 v101, v101, v85
    v_cvt_pk_bf16_f32 v102, v102, v86
    v_cvt_pk_bf16_f32 v103, v103, v87
    v_cvt_pk_bf16_f32 v104, v104, v88
    v_cvt_pk_bf16_f32 v105, v105, v89
    v_cvt_pk_bf16_f32 v106, v106, v90
    v_cvt_pk_bf16_f32 v107, v107, v91
    v_cvt_pk_bf16_f32 v108, v108, v92
    v_cvt_pk_bf16_f32 v109, v109, v93
    v_cvt_pk_bf16_f32 v110, v110, v94
    v_cvt_pk_bf16_f32 v111, v111, v95
    v_dot2_f32_bf16 v96, v96, v59, 0
    v_dot2_f32_bf16 v100, v100, v59, 0
    v_dot2_f32_bf16 v104, v104, v59, 0
    v_dot2_f32_bf16 v108, v108, v59, 0
    v_dot2_f32_bf16 v97, v97, v59, 0
    v_dot2_f32_bf16 v101, v101, v59, 0
    v_dot2_f32_bf16 v105, v105, v59, 0
    v_dot2_f32_bf16 v109, v109, v59, 0
    v_dot2_f32_bf16 v98, v98, v59, 0
    v_dot2_f32_bf16 v102, v102, v59, 0
    v_dot2_f32_bf16 v106, v106, v59, 0
    v_dot2_f32_bf16 v110, v110, v59, 0
    v_dot2_f32_bf16 v99, v99, v59, 0
    v_dot2_f32_bf16 v103, v103, v59, 0
    v_dot2_f32_bf16 v107, v107, v59, 0
    v_dot2_f32_bf16 v111, v111, v59, 0
    v_cvt_pk_bf16_f32 v112, v96, v100
    v_cvt_pk_bf16_f32 v113, v104, v108
    global_store_dwordx2 v5, v[112:113], s[46:47] offset:0
    v_cvt_pk_bf16_f32 v114, v97, v101
    v_cvt_pk_bf16_f32 v115, v105, v109
    global_store_dwordx2 v5, v[114:115], s[46:47] offset:1152
    v_cvt_pk_bf16_f32 v116, v98, v102
    v_cvt_pk_bf16_f32 v117, v106, v110
    global_store_dwordx2 v5, v[116:117], s[46:47] offset:2304
    s_nop 0
    v_cvt_pk_bf16_f32 v118, v99, v103
    v_cvt_pk_bf16_f32 v119, v107, v111
    global_store_dwordx2 v5, v[118:119], s[46:47] offset:3456
    v_and_b32 v132, 0xffff0000, v132
    v_sub_f32 v16, 1.0, v132
    v_and_b32 v133, 0xffff0000, v133
    v_sub_f32 v17, 1.0, v133
    v_and_b32 v134, 0xffff0000, v134
    v_sub_f32 v18, 1.0, v134
    v_and_b32 v135, 0xffff0000, v135
    v_sub_f32 v19, 1.0, v135
    v_cvt_pk_bf16_f32 v20, v16, v17
    v_cvt_pk_bf16_f32 v21, v18, v19
    v_lshrrev_b32 v132, 16, v132
    v_lshrrev_b32 v134, 16, v134
    v_lshlrev_b32 v16, 16, v20
    v_and_b32 v17, 0xffff0000, v20
    v_lshlrev_b32 v18, 16, v21
    v_and_b32 v19, 0xffff0000, v21
    v_pk_mul_f32 v[64:65], v[40:41], s[60:61] op_sel_hi:[1,0]
    v_pk_mul_f32 v[80:81], v[40:41], v[16:17]
    v_pk_mul_f32 v[66:67], v[42:43], s[60:61] op_sel_hi:[1,0]
    v_pk_mul_f32 v[82:83], v[42:43], v[18:19]
    v_pk_mul_f32 v[68:69], v[44:45], s[60:61] op_sel:[0,1] op_sel_hi:[1,1]
    v_pk_mul_f32 v[84:85], v[44:45], v[16:17]
    v_pk_mul_f32 v[70:71], v[46:47], s[60:61] op_sel:[0,1] op_sel_hi:[1,1]
    v_pk_mul_f32 v[86:87], v[46:47], v[18:19]
    v_pk_mul_f32 v[72:73], v[48:49], s[62:63] op_sel_hi:[1,0]
    v_pk_mul_f32 v[88:89], v[48:49], v[16:17]
    v_pk_mul_f32 v[74:75], v[50:51], s[62:63] op_sel_hi:[1,0]
    v_pk_mul_f32 v[90:91], v[50:51], v[18:19]
    v_pk_mul_f32 v[76:77], v[52:53], s[62:63] op_sel:[0,1] op_sel_hi:[1,1]
    v_pk_mul_f32 v[92:93], v[52:53], v[16:17]
    v_pk_mul_f32 v[78:79], v[54:55], s[62:63] op_sel:[0,1] op_sel_hi:[1,1]
    v_pk_mul_f32 v[94:95], v[54:55], v[18:19]
    s_mov_b32 s12, 0
E_WAIT1:
    ds_read_b32 v60, v58 offset:128
    s_add_u32 s12, s12, 1
    s_waitcnt lgkmcnt(0)
    v_cmp_eq_u32 vcc, 0, v60
    s_cmp_ge_u32 s12, 0x40000
    s_cbranch_scc1 E_RDY1
    s_cbranch_vccz E_RDY1
    s_sleep 1
    s_branch E_WAIT1
E_RDY1:
    ds_read_b128 v[96:99], v56 offset:5120
    ds_read_b128 v[112:115], v56 offset:15360
    ds_read_b128 v[100:103], v56 offset:25600
    ds_read_b128 v[116:119], v56 offset:35840
    ds_read_b128 v[104:107], v57 offset:5120
    ds_read_b128 v[120:123], v57 offset:15360
    ds_read_b128 v[108:111], v57 offset:25600
    ds_read_b128 v[124:127], v57 offset:35840
    s_waitcnt lgkmcnt(6)
    v_pk_add_f32 v[96:97], v[96:97], v[112:113]
    v_pk_add_f32 v[98:99], v[98:99], v[114:115]
    v_pk_mul_f32 v[96:97], v[96:97], s[56:57] op_sel_hi:[1,0]
    v_pk_mul_f32 v[98:99], v[98:99], s[56:57] op_sel_hi:[1,0]
    v_cvt_pk_bf16_f32 v96, v96, v64
    v_cvt_pk_bf16_f32 v97, v97, v65
    v_cvt_pk_bf16_f32 v98, v98, v66
    v_cvt_pk_bf16_f32 v99, v99, v67
    v_dot2_f32_bf16 v96, v96, v59, 0
    v_dot2_f32_bf16 v97, v97, v59, 0
    v_dot2_f32_bf16 v98, v98, v59, 0
    v_dot2_f32_bf16 v99, v99, v59, 0
    s_waitcnt lgkmcnt(4)
    v_pk_add_f32 v[100:101], v[100:101], v[116:117]
    v_pk_add_f32 v[102:103], v[102:103], v[118:119]
    v_pk_mul_f32 v[100:101], v[100:101], s[56:57] op_sel:[0,1] op_sel_hi:[1,1]
    v_pk_mul_f32 v[102:103], v[102:103], s[56:57] op_sel:[0,1] op_sel_hi:[1,1]
    v_cvt_pk_bf16_f32 v100, v100, v68
    v_cvt_pk_bf16_f32 v101, v101, v69
    v_cvt_pk_bf16_f32 v102, v102, v70
    v_cvt_pk_bf16_f32 v103, v103, v71
    v_dot2_f32_bf16 v100, v100, v59, 0
    v_dot2_f32_bf16 v101, v101, v59, 0
    v_dot2_f32_bf16 v102, v102, v59, 0
    v_dot2_f32_bf16 v103, v103, v59, 0
    s_waitcnt lgkmcnt(2)
    v_pk_add_f32 v[104:105], v[104:105], v[120:121]
    v_pk_add_f32 v[106:107], v[106:107], v[122:123]
    v_pk_mul_f32 v[104:105], v[104:105], s[58:59] op_sel_hi:[1,0]
    v_pk_mul_f32 v[106:107], v[106:107], s[58:59] op_sel_hi:[1,0]
    v_cvt_pk_bf16_f32 v104, v104, v72
    v_cvt_pk_bf16_f32 v105, v105, v73
    v_cvt_pk_bf16_f32 v106, v106, v74
    v_cvt_pk_bf16_f32 v107, v107, v75
    v_dot2_f32_bf16 v104, v104, v59, 0
    v_dot2_f32_bf16 v105, v105, v59, 0
    v_dot2_f32_bf16 v106, v106, v59, 0
    v_dot2_f32_bf16 v107, v107, v59, 0
    s_waitcnt lgkmcnt(0)
    v_pk_add_f32 v[108:109], v[108:109], v[124:125]
    v_pk_add_f32 v[110:111], v[110:111], v[126:127]
    v_pk_mul_f32 v[108:109], v[108:109], s[58:59] op_sel:[0,1] op_sel_hi:[1,1]
    v_pk_mul_f32 v[110:111], v[110:111], s[58:59] op_sel:[0,1] op_sel_hi:[1,1]
    v_cvt_pk_bf16_f32 v108, v108, v76
    v_cvt_pk_bf16_f32 v109, v109, v77
    v_cvt_pk_bf16_f32 v110, v110, v78
    v_cvt_pk_bf16_f32 v111, v111, v79
    v_dot2_f32_bf16 v108, v108, v59, 0
    v_dot2_f32_bf16 v109, v109, v59, 0
    v_dot2_f32_bf16 v110, v110, v59, 0
    v_dot2_f32_bf16 v111, v111, v59, 0
    s_nop 0
    v_cvt_pk_bf16_f32 v112, v96, v97
    v_cvt_pk_bf16_f32 v113, v98, v99
    v_cvt_pk_bf16_f32 v114, v100, v101
    v_cvt_pk_bf16_f32 v115, v102, v103
    v_cvt_pk_bf16_f32 v116, v104, v105
    v_cvt_pk_bf16_f32 v117, v106, v107
    v_cvt_pk_bf16_f32 v118, v108, v109
    v_cvt_pk_bf16_f32 v119, v110, v111
    v_dot2_f32_bf16 v96, v112, v132, 0
    v_dot2_f32_bf16 v97, v112, v133, 0
    v_dot2_f32_bf16 v98, v113, v134, 0
    v_dot2_f32_bf16 v99, v113, v135, 0
    v_dot2_f32_bf16 v100, v114, v132, 0
    v_dot2_f32_bf16 v101, v114, v133, 0
    v_dot2_f32_bf16 v102, v115, v134, 0
    v_dot2_f32_bf16 v103, v115, v135, 0
    v_dot2_f32_bf16 v104, v116, v132, 0
    v_dot2_f32_bf16 v105, v116, v133, 0
    v_dot2_f32_bf16 v106, v117, v134, 0
    v_dot2_f32_bf16 v107, v117, v135, 0
    v_dot2_f32_bf16 v108, v118, v132, 0
    v_dot2_f32_bf16 v109, v118, v133, 0
    v_dot2_f32_bf16 v110, v119, v134, 0
    v_dot2_f32_bf16 v111, v119, v135, 0
    v_cvt_pk_bf16_f32 v96, v96, v80
    v_cvt_pk_bf16_f32 v97, v97, v81
    v_cvt_pk_bf16_f32 v98, v98, v82
    v_cvt_pk_bf16_f32 v99, v99, v83
    v_cvt_pk_bf16_f32 v100, v100, v84
    v_cvt_pk_bf16_f32 v101, v101, v85
    v_cvt_pk_bf16_f32 v102, v102, v86
    v_cvt_pk_bf16_f32 v103, v103, v87
    v_cvt_pk_bf16_f32 v104, v104, v88
    v_cvt_pk_bf16_f32 v105, v105, v89
    v_cvt_pk_bf16_f32 v106, v106, v90
    v_cvt_pk_bf16_f32 v107, v107, v91
    v_cvt_pk_bf16_f32 v108, v108, v92
    v_cvt_pk_bf16_f32 v109, v109, v93
    v_cvt_pk_bf16_f32 v110, v110, v94
    v_cvt_pk_bf16_f32 v111, v111, v95
    v_dot2_f32_bf16 v96, v96, v59, 0
    v_dot2_f32_bf16 v100, v100, v59, 0
    v_dot2_f32_bf16 v104, v104, v59, 0
    v_dot2_f32_bf16 v108, v108, v59, 0
    v_dot2_f32_bf16 v97, v97, v59, 0
    v_dot2_f32_bf16 v101, v101, v59, 0
    v_dot2_f32_bf16 v105, v105, v59, 0
    v_dot2_f32_bf16 v109, v109, v59, 0
    v_dot2_f32_bf16 v98, v98, v59, 0
    v_dot2_f32_bf16 v102, v102, v59, 0
    v_dot2_f32_bf16 v106, v106, v59, 0
    v_dot2_f32_bf16 v110, v110, v59, 0
    v_dot2_f32_bf16 v99, v99, v59, 0
    v_dot2_f32_bf16 v103, v103, v59, 0
    v_dot2_f32_bf16 v107, v107, v59, 0
    v_dot2_f32_bf16 v111, v111, v59, 0
    v_cvt_pk_bf16_f32 v112, v96, v100
    v_cvt_pk_bf16_f32 v113, v104, v108
    global_store_dwordx2 v6, v[112:113], s[46:47] offset:0
    v_cvt_pk_bf16_f32 v114, v97, v101
    v_cvt_pk_bf16_f32 v115, v105, v109
    global_store_dwordx2 v6, v[114:115], s[46:47] offset:1152
    v_cvt_pk_bf16_f32 v116, v98, v102
    v_cvt_pk_bf16_f32 v117, v106, v110
    global_store_dwordx2 v6, v[116:117], s[46:47] offset:2304
    s_nop 0
    v_cvt_pk_bf16_f32 v118, v99, v103
    v_cvt_pk_bf16_f32 v119, v107, v111
    global_store_dwordx2 v6, v[118:119], s[46:47] offset:3456
    s_waitcnt vmcnt(0)
    s_endpgm
FINAL:
    v_and_b32 v5, 7, v2
    v_lshlrev_b32 v5, 2, v5
    v_mov_b32 v6, 0
    s_lshl_b32 s9, s6, 3
    s_load_dwordx2 s[52:53], s[32:33], s9
    s_mov_b32 s12, 0
FN_SEL:
    global_load_dword v8, v5, s[48:49] sc1
    global_load_dword v9, v6, s[48:49] offset:128 sc1
    s_add_u32 s12, s12, 1
    s_waitcnt vmcnt(0)
    v_min_u32 v10, v8, v9
    v_cmp_eq_u32 vcc, 0, v10
    s_cmp_ge_u32 s12, 16384
    s_cbranch_scc1 FN_SELOK
    s_cbranch_vccnz FN_SEL
FN_SELOK:
    v_not_b32 v10, v8
    v_and_b32 v10, 0x7ff, v10
    v_mul_u32_u24 v11, 1152, v10
    v_add_u32 v11, s9, v11
    global_load_dwordx2 v[12:13], v11, s[16:17]
    v_and_b32 v14, 0x7f0, v10
    v_add_lshl_u32 v14, v14, v10, 2
    v_and_b32 v16, 0xf8, v10
    v_mul_u32_u24 v16, 3, v16
    v_and_b32 v17, 0xff, v10
    v_add_lshl_u32 v16, v16, v17, 2
    v_cmp_le_u32 vcc, 0x700, v10
    v_add_u32 v16, 10304, v16
    s_nop 0
    v_cndmask_b32 v14, v14, v16, vcc
    v_add_u32 v14, 20480, v14
    s_mov_b32 s12, 0
FN_G:
    global_load_dword v15, v14, s[50:51] sc1
    s_add_u32 s12, s12, 1
    s_waitcnt vmcnt(0)
    v_xor_b32 v16, v15, v9
    v_and_b32 v16, 0xffff, v16
    v_cmp_ne_u32 vcc, 0, v16
    s_cmp_ge_u32 s12, 16384
    s_cbranch_scc1 FN_GOK
    s_cbranch_vccnz FN_G
FN_GOK:
    v_lshrrev_b32 v16, 8, v10
    v_mul_u32_u24 v16, 1280, v16
    v_and_b32 v17, 0xf0, v10
    v_add_u32 v16, v16, v17
    v_bfe_u32 v17, v10, 2, 2
    v_mul_u32_u24 v17, 320, v17
    v_add_u32 v16, v16, v17
    v_and_b32 v17, 3, v10
    v_lshl_add_u32 v16, v17, 2, v16
    v_add_u32 v17, 40960, v16
    v_add_u32 v18, 124256, v5
    v_mov_b32 v19, 153600
    ds_read_b128 v[36:39], v19
    ds_read_b128 v[44:47], v19 offset:16
    v_and_b32 v20, 0xffff0000, v8
    v_not_b32 v21, v20
    v_ashrrev_i32 v21, 31, v21
    v_and_b32 v21, 0x7fff0000, v21
    v_or_b32 v21, 0x80000000, v21
    v_xor_b32 v20, v20, v21
    v_mul_f32 v21, 0xbfb8aa3b, v20
    v_exp_f32 v21, v21
    s_nop 0
    v_add_f32 v21, 1.0, v21
    v_rcp_f32 v21, v21
    s_nop 0
    v_cvt_pk_bf16_f32 v20, v21, v21
    v_and_b32 v20, 0xffff0000, v20
    v_and_b32 v15, 0xffff0000, v15
    v_sub_f32 v21, 1.0, v15
    v_cvt_pk_bf16_f32 v21, v21, v21
    v_and_b32 v21, 0xffff0000, v21
    v_lshlrev_b32 v24, 16, v12
    v_and_b32 v25, 0xffff0000, v12
    v_lshlrev_b32 v26, 16, v13
    v_and_b32 v27, 0xffff0000, v13
    s_waitcnt lgkmcnt(0)
    v_lshrrev_b32 v36, 23, v36
    v_sub_u32 v36, 265, v36
    v_min_i32 v36, 253, v36
    v_add_u32 v36, v36, v44
    v_sub_u32 v36, 381, v36
    v_max_i32 v36, 0, v36
    v_min_i32 v36, 254, v36
    v_lshlrev_b32 v36, 23, v36
    v_lshrrev_b32 v37, 23, v37
    v_sub_u32 v37, 265, v37
    v_min_i32 v37, 253, v37
    v_add_u32 v37, v37, v45
    v_sub_u32 v37, 381, v37
    v_max_i32 v37, 0, v37
    v_min_i32 v37, 254, v37
    v_lshlrev_b32 v37, 23, v37
    v_lshrrev_b32 v38, 23, v38
    v_sub_u32 v38, 265, v38
    v_min_i32 v38, 253, v38
    v_add_u32 v38, v38, v46
    v_sub_u32 v38, 381, v38
    v_max_i32 v38, 0, v38
    v_min_i32 v38, 254, v38
    v_lshlrev_b32 v38, 23, v38
    v_lshrrev_b32 v39, 23, v39
    v_sub_u32 v39, 265, v39
    v_min_i32 v39, 253, v39
    v_add_u32 v39, v39, v47
    v_sub_u32 v39, 381, v39
    v_max_i32 v39, 0, v39
    v_min_i32 v39, 254, v39
    v_lshlrev_b32 v39, 23, v39
    s_mov_b32 s12, 0
FN_WAIT:
    ds_read_b32 v22, v18
    s_add_u32 s12, s12, 1
    s_waitcnt lgkmcnt(0)
    v_cmp_eq_u32 vcc, 0, v22
    s_cmp_ge_u32 s12, 0x40000
    s_cbranch_scc1 FN_RDY
    s_cbranch_vccz FN_RDY
    s_sleep 1
    s_branch FN_WAIT
FN_RDY:
    ds_read_b32 v28, v16 offset:0
    ds_read_b32 v32, v16 offset:10240
    ds_read_b32 v29, v16 offset:20480
    ds_read_b32 v33, v16 offset:30720
    ds_read_b32 v30, v17 offset:0
    ds_read_b32 v34, v17 offset:10240
    ds_read_b32 v31, v17 offset:20480
    ds_read_b32 v35, v17 offset:30720
    s_lshl_b32 s60, s52, 16
    s_and_b32 s61, s52, 0xffff0000
    s_lshl_b32 s62, s53, 16
    s_and_b32 s63, s53, 0xffff0000
    s_mul_i32 s8, s6, 9216
    s_add_u32 s8, s8, 45056
    v_lshl_add_u32 v22, v2, 4, s8
    v_add_u32 v23, 4096, v22
    s_waitcnt lgkmcnt(0)
    v_add_f32 v28, v28, v32
    v_mul_f32 v28, v28, v36
    v_mul_f32 v32, s60, v24
    v_add_f32 v29, v29, v33
    v_mul_f32 v29, v29, v37
    v_mul_f32 v33, s61, v25
    v_add_f32 v30, v30, v34
    v_mul_f32 v30, v30, v38
    v_mul_f32 v34, s62, v26
    v_add_f32 v31, v31, v35
    v_mul_f32 v31, v31, v39
    v_mul_f32 v35, s63, v27
    v_cvt_pk_bf16_f32 v40, v28, v29
    v_cvt_pk_bf16_f32 v41, v30, v31
    v_lshlrev_b32 v28, 16, v40
    v_and_b32 v29, 0xffff0000, v40
    v_lshlrev_b32 v30, 16, v41
    v_and_b32 v31, 0xffff0000, v41
    v_cvt_pk_bf16_f32 v40, v32, v33
    v_cvt_pk_bf16_f32 v41, v34, v35
    v_lshlrev_b32 v32, 16, v40
    v_and_b32 v33, 0xffff0000, v40
    v_lshlrev_b32 v34, 16, v41
    v_and_b32 v35, 0xffff0000, v41
    v_add_f32 v28, v28, v32
    v_add_f32 v29, v29, v33
    v_add_f32 v30, v30, v34
    v_add_f32 v31, v31, v35
    v_cvt_pk_bf16_f32 v40, v28, v29
    v_cvt_pk_bf16_f32 v41, v30, v31
    v_lshlrev_b32 v28, 16, v40
    v_and_b32 v29, 0xffff0000, v40
    v_lshlrev_b32 v30, 16, v41
    v_and_b32 v31, 0xffff0000, v41
    v_mul_f32 v28, v28, v15
    v_mul_f32 v29, v29, v15
    v_mul_f32 v30, v30, v15
    v_mul_f32 v31, v31, v15
    v_cvt_pk_bf16_f32 v40, v28, v29
    v_cvt_pk_bf16_f32 v41, v30, v31
    v_lshlrev_b32 v28, 16, v40
    v_and_b32 v29, 0xffff0000, v40
    v_lshlrev_b32 v30, 16, v41
    v_and_b32 v31, 0xffff0000, v41
    s_mov_b32 s12, 0
FN_P:
    global_load_dwordx4 v[48:51], v22, s[50:51] offset:-4096 sc1
    global_load_dwordx4 v[52:55], v22, s[50:51] offset:-3072 sc1
    global_load_dwordx4 v[56:59], v22, s[50:51] offset:-2048 sc1
    global_load_dwordx4 v[60:63], v22, s[50:51] offset:-1024 sc1
    global_load_dwordx4 v[64:67], v22, s[50:51] offset:0 sc1
    global_load_dwordx4 v[68:71], v22, s[50:51] offset:1024 sc1
    global_load_dwordx4 v[72:75], v22, s[50:51] offset:2048 sc1
    global_load_dwordx4 v[76:79], v22, s[50:51] offset:3072 sc1
    global_load_dwordx4 v[80:83], v23, s[50:51] offset:0 sc1
    s_add_u32 s12, s12, 1
    s_waitcnt vmcnt(8)
    v_xor_b32 v32, v48, v9
    v_bitop3_b32 v32, v32, v49, v9 bitop3:0xf6
    v_bitop3_b32 v32, v32, v50, v9 bitop3:0xf6
    v_bitop3_b32 v32, v32, v51, v9 bitop3:0xf6
    s_waitcnt vmcnt(7)
    v_bitop3_b32 v32, v32, v52, v9 bitop3:0xf6
    v_bitop3_b32 v32, v32, v53, v9 bitop3:0xf6
    v_bitop3_b32 v32, v32, v54, v9 bitop3:0xf6
    v_bitop3_b32 v32, v32, v55, v9 bitop3:0xf6
    v_pk_add_f32 v[48:49], v[48:49], v[52:53]
    v_pk_add_f32 v[50:51], v[50:51], v[54:55]
    s_waitcnt vmcnt(6)
    v_bitop3_b32 v32, v32, v56, v9 bitop3:0xf6
    v_bitop3_b32 v32, v32, v57, v9 bitop3:0xf6
    v_bitop3_b32 v32, v32, v58, v9 bitop3:0xf6
    v_bitop3_b32 v32, v32, v59, v9 bitop3:0xf6
    v_pk_add_f32 v[48:49], v[48:49], v[56:57]
    v_pk_add_f32 v[50:51], v[50:51], v[58:59]
    s_waitcnt vmcnt(5)
    v_bitop3_b32 v32, v32, v60, v9 bitop3:0xf6
    v_bitop3_b32 v32, v32, v61, v9 bitop3:0xf6
    v_bitop3_b32 v32, v32, v62, v9 bitop3:0xf6
    v_bitop3_b32 v32, v32, v63, v9 bitop3:0xf6
    v_pk_add_f32 v[48:49], v[48:49], v[60:61]
    v_pk_add_f32 v[50:51], v[50:51], v[62:63]
    s_waitcnt vmcnt(4)
    v_bitop3_b32 v32, v32, v64, v9 bitop3:0xf6
    v_bitop3_b32 v32, v32, v65, v9 bitop3:0xf6
    v_bitop3_b32 v32, v32, v66, v9 bitop3:0xf6
    v_bitop3_b32 v32, v32, v67, v9 bitop3:0xf6
    v_pk_add_f32 v[48:49], v[48:49], v[64:65]
    v_pk_add_f32 v[50:51], v[50:51], v[66:67]
    s_waitcnt vmcnt(3)
    v_bitop3_b32 v32, v32, v68, v9 bitop3:0xf6
    v_bitop3_b32 v32, v32, v69, v9 bitop3:0xf6
    v_bitop3_b32 v32, v32, v70, v9 bitop3:0xf6
    v_bitop3_b32 v32, v32, v71, v9 bitop3:0xf6
    v_pk_add_f32 v[48:49], v[48:49], v[68:69]
    v_pk_add_f32 v[50:51], v[50:51], v[70:71]
    s_waitcnt vmcnt(2)
    v_bitop3_b32 v32, v32, v72, v9 bitop3:0xf6
    v_bitop3_b32 v32, v32, v73, v9 bitop3:0xf6
    v_bitop3_b32 v32, v32, v74, v9 bitop3:0xf6
    v_bitop3_b32 v32, v32, v75, v9 bitop3:0xf6
    v_pk_add_f32 v[48:49], v[48:49], v[72:73]
    v_pk_add_f32 v[50:51], v[50:51], v[74:75]
    s_waitcnt vmcnt(1)
    v_bitop3_b32 v32, v32, v76, v9 bitop3:0xf6
    v_bitop3_b32 v32, v32, v77, v9 bitop3:0xf6
    v_bitop3_b32 v32, v32, v78, v9 bitop3:0xf6
    v_bitop3_b32 v32, v32, v79, v9 bitop3:0xf6
    v_pk_add_f32 v[48:49], v[48:49], v[76:77]
    v_pk_add_f32 v[50:51], v[50:51], v[78:79]
    s_waitcnt vmcnt(0)
    v_bitop3_b32 v32, v32, v80, v9 bitop3:0xf6
    v_bitop3_b32 v32, v32, v81, v9 bitop3:0xf6
    v_bitop3_b32 v32, v32, v82, v9 bitop3:0xf6
    v_bitop3_b32 v32, v32, v83, v9 bitop3:0xf6
    v_pk_add_f32 v[48:49], v[48:49], v[80:81]
    v_pk_add_f32 v[50:51], v[50:51], v[82:83]
    v_and_b32 v32, 0xff, v32
    v_cmp_ne_u32 vcc, 0, v32
    s_cmp_ge_u32 s12, 16384
    s_cbranch_scc1 FN_POK
    s_cbranch_vccnz FN_P
FN_POK:
    v_add_f32_dpp v48, v48, v48 row_ror:8 row_mask:0xf bank_mask:0xf
    v_add_f32_dpp v49, v49, v49 row_ror:8 row_mask:0xf bank_mask:0xf
    v_add_f32_dpp v50, v50, v50 row_ror:8 row_mask:0xf bank_mask:0xf
    v_add_f32_dpp v51, v51, v51 row_ror:8 row_mask:0xf bank_mask:0xf
    v_mov_b32 v52, v48
    v_mov_b32 v53, v49
    v_mov_b32 v54, v50
    v_mov_b32 v55, v51
    v_permlane16_swap_b32 v48, v52
    v_permlane16_swap_b32 v49, v53
    v_permlane16_swap_b32 v50, v54
    v_permlane16_swap_b32 v51, v55
    v_add_f32 v48, v48, v52
    v_add_f32 v49, v49, v53
    v_add_f32 v50, v50, v54
    v_add_f32 v51, v51, v55
    v_mov_b32 v52, v48
    v_mov_b32 v53, v49
    v_mov_b32 v54, v50
    v_mov_b32 v55, v51
    v_permlane32_swap_b32 v48, v52
    v_permlane32_swap_b32 v49, v53
    v_permlane32_swap_b32 v50, v54
    v_permlane32_swap_b32 v51, v55
    v_add_f32 v48, v48, v52
    v_add_f32 v49, v49, v53
    v_add_f32 v50, v50, v54
    v_add_f32 v51, v51, v55
    v_cvt_pk_bf16_f32 v40, v48, v49
    v_cvt_pk_bf16_f32 v41, v50, v51
    v_lshlrev_b32 v48, 16, v40
    v_and_b32 v49, 0xffff0000, v40
    v_lshlrev_b32 v50, 16, v41
    v_and_b32 v51, 0xffff0000, v41
    v_mul_f32 v48, v48, v20
    v_mul_f32 v49, v49, v20
    v_mul_f32 v50, v50, v20
    v_mul_f32 v51, v51, v20
    v_cvt_pk_bf16_f32 v40, v48, v49
    v_cvt_pk_bf16_f32 v41, v50, v51
    v_lshlrev_b32 v48, 16, v40
    v_and_b32 v49, 0xffff0000, v40
    v_lshlrev_b32 v50, 16, v41
    v_and_b32 v51, 0xffff0000, v41
    v_add_f32 v48, v48, v24
    v_add_f32 v49, v49, v25
    v_add_f32 v50, v50, v26
    v_add_f32 v51, v51, v27
    v_cvt_pk_bf16_f32 v40, v48, v49
    v_cvt_pk_bf16_f32 v41, v50, v51
    v_lshlrev_b32 v48, 16, v40
    v_and_b32 v49, 0xffff0000, v40
    v_lshlrev_b32 v50, 16, v41
    v_and_b32 v51, 0xffff0000, v41
    v_mul_f32 v48, v48, v21
    v_mul_f32 v49, v49, v21
    v_mul_f32 v50, v50, v21
    v_mul_f32 v51, v51, v21
    v_cvt_pk_bf16_f32 v40, v48, v49
    v_cvt_pk_bf16_f32 v41, v50, v51
    v_lshlrev_b32 v48, 16, v40
    v_and_b32 v49, 0xffff0000, v40
    v_lshlrev_b32 v50, 16, v41
    v_and_b32 v51, 0xffff0000, v41
    v_add_f32 v48, v48, v28
    v_add_f32 v49, v49, v29
    v_add_f32 v50, v50, v30
    v_add_f32 v51, v51, v31
    v_cvt_pk_bf16_f32 v40, v48, v49
    v_cvt_pk_bf16_f32 v41, v50, v51
    s_barrier
    s_mov_b64 exec, 0xff
    global_store_dwordx2 v11, v[40:41], s[46:47]
    s_endpgm
W_END:
    s_endpgm
K_END:
    s_endpgm
CODE_END:
.section .rodata,"a"
.p2align 6
.amdhsa_kernel k1_kernel
  .amdhsa_next_free_vgpr 168
  .amdhsa_next_free_sgpr 102
  .amdhsa_accum_offset 168
  .amdhsa_group_segment_fixed_size 0
  .amdhsa_kernarg_size 144
  .amdhsa_user_sgpr_count 2
  .amdhsa_user_sgpr_kernarg_segment_ptr 1
  .amdhsa_system_sgpr_workgroup_id_x 1
.end_amdhsa_kernel
```

```asm
; @launch kernel=k1_kernel grid=(256,1,1) block=(768,1,1) lds=163840
.amdgcn_target "amdgcn-amd-amdhsa--gfx950"
.text
.p2align 8
.globl k1_kernel
.type k1_kernel,@function
k1_kernel:
    s_cmp_ge_u32 s2, 256
    s_cbranch_scc1 K_END
    s_load_dwordx16 s[16:31], s[0:1], 0
    s_load_dwordx16 s[32:47], s[0:1], 64
    s_load_dwordx4 s[48:51], s[0:1], 128
    v_lshrrev_b32 v1, 6, v0
    v_and_b32 v2, 63, v0
    v_readfirstlane_b32 s3, v1
    v_and_b32 v3, 15, v2
    v_lshrrev_b32 v4, 4, v2
    s_and_b32 s4, s2, 7
    s_lshr_b32 s5, s2, 3
    s_cmp_lg_u32 s3, 0
    s_cbranch_scc1 K_NOCPF
    s_getpc_b64 s[8:9]
    s_and_b32 s8, s8, 0xffffff00
    v_and_b32 v5, 7, v2
    v_lshl_add_u32 v5, s5, 3, v5
    v_lshlrev_b32 v5, 7, v5
    v_min_u32 v5, CODE_END-k1_kernel-4, v5
    global_load_dword v167, v5, s[8:9]
K_NOCPF:
    s_cmp_lt_u32 s2, 112
    s_cbranch_scc1 K_NC
    s_sub_u32 s101, s5, 14
    s_mul_i32 s6, s4, 18
    s_add_u32 s6, s6, s101
    s_cmp_lt_u32 s3, 8
    s_cbranch_scc1 CK_PRO
CU_PRO:
    s_sub_u32 s7, s3, 8
    s_lshl_b32 s8, s101, 2
    s_add_u32 s8, s8, s7
    s_mul_i32 s10, s8, 57
    s_lshr_b32 s10, s10, 9
    s_mul_i32 s11, s10, 9
    s_sub_u32 s11, s8, s11
    s_sub_u32 s8, s8, s10
    s_mul_i32 s8, s8, 36864
    s_lshl_b32 s9, s4, 7
    s_add_u32 s8, s8, s9
    v_lshrrev_b32 v5, 1, v2
    v_mul_u32_u24 v5, 1152, v5
    v_and_b32 v6, 1, v2
    v_lshl_add_u32 v5, v6, 7, v5
    v_add_u32 v7, s8, v5
    s_and_b32 s15, s7, 2
    s_add_u32 s15, s15, s7
    s_mul_i32 s8, s15, 294912
    s_lshl_b32 s9, s6, 3
    s_add_u32 s8, s8, s9
    v_mul_u32_u24 v5, 4608, v2
    v_add_u32 v5, s8, v5
    v_add_u32 v6, 589824, v5
    v_mov_b32 v58, 0
    v_mov_b32 v59, 0
    v_mov_b32 v57, 155648
    v_lshl_add_u32 v56, v2, 3, v57
    ds_write_b64 v56, v[58:59]
    s_waitcnt lgkmcnt(0)
    s_barrier
    s_cmp_eq_u32 s7, 3
    s_cbranch_scc1 CU_C3A
CU_C3B:
    global_load_dword v60, v59, s[30:31]
    s_waitcnt vmcnt(0)
    s_cmp_eq_u32 s11, 8
    s_cbranch_scc1 CU_C3
    global_load_dword v60, v7, s[16:17]
CU_C3X:
    s_cmp_ge_u32 s7, 2
    s_cbranch_scc1 CU_MID
CU_LD:
    global_load_dwordx2 v[8:9], v5, s[16:17] offset:0 sc1
    global_load_dwordx2 v[10:11], v5, s[16:17] offset:1152 sc1
    global_load_dwordx2 v[12:13], v5, s[16:17] offset:2304 sc1
    global_load_dwordx2 v[14:15], v5, s[16:17] offset:3456 sc1
    global_load_dwordx2 v[16:17], v6, s[16:17] offset:0 sc1
    global_load_dwordx2 v[18:19], v6, s[16:17] offset:1152 sc1
    global_load_dwordx2 v[20:21], v6, s[16:17] offset:2304 sc1
    global_load_dwordx2 v[22:23], v6, s[16:17] offset:3456 sc1
    s_branch CU_MAIN
CK_PRO:
    s_and_b32 s7, s3, 3
    s_lshr_b32 s12, s3, 2
    s_lshl_b32 s8, s6, 2
    s_add_u32 s8, s8, s7
    s_lshl_b32 s9, s8, 8
    v_lshl_add_u32 v6, v2, 2, s9
    s_lshl_b32 s8, s8, 1
    v_mov_b32 v7, s8
    v_mov_b32 v18, 0
    s_waitcnt lgkmcnt(0)
    global_load_short_d16_hi v18, v7, s[30:31]
    global_load_dword v28, v6, s[18:19]
    global_load_dword v29, v6, s[20:21]
    global_load_dword v30, v6, s[22:23]
    global_load_dword v31, v6, s[24:25]
    global_load_dword v32, v6, s[26:27]
    global_load_dword v33, v6, s[28:29]
    s_barrier
    s_branch CK_MAIN
K_NC:
    s_lshl_b32 s6, s2, 4
    s_lshl_b32 s7, s3, 2
    s_sub_u32 s7, s7, 32
    s_cmp_ge_u32 s3, 8
    s_cbranch_scc1 RT_PRO
    s_cmp_lt_u32 s2, 72
    s_cbranch_scc1 F_PRO
    s_cmp_lt_u32 s3, 6
    s_cbranch_scc1 HELPER
    s_cmp_lt_u32 s2, 80
    s_cbranch_scc1 HELPER
    s_add_u32 s7, s7, 24
    s_lshr_b32 s6, s6, 1
    s_add_u32 s6, s6, 1136
RT_PRO:
    s_add_u32 s6, s6, s7
    v_add_u32 v5, s6, v4
    v_lshlrev_b32 v6, 4, v3
    v_lshlrev_b32 v7, 3, v3
    v_mul_u32_u24 v9, 1152, v5
    v_add_u32 v8, v9, v6
    v_add_u32 v9, v9, v7
    v_mov_b32 v10, 0
    v_lshlrev_b32 v11, 2, v2
    v_add_u32 v12, 163520, v11
    ds_write_b32 v12, v10
    v_and_b32 v11, 0x7c, v11
    v_lshlrev_b32 v12, 4, v2
    s_mul_i32 s13, s7, 640
    s_add_u32 s13, s13, 147456
    s_mov_b32 m0, s13
    s_waitcnt lgkmcnt(0)
    s_load_dword s12, s[50:51], 0
    global_load_lds_dwordx4 v12, s[36:37]
    global_load_lds_dword v11, s[36:37] offset:1024
    s_add_u32 m0, s13, 1280
    v_add_u32 v6, s13, v6
    global_load_lds_dwordx4 v12, s[44:45]
    global_load_lds_dword v11, s[44:45] offset:1024
    global_load_dwordx4 v[16:19], v8, s[16:17] offset:0
    global_load_dwordx4 v[20:23], v8, s[16:17] offset:256
    global_load_dwordx4 v[24:27], v8, s[16:17] offset:512
    global_load_dwordx4 v[28:31], v8, s[16:17] offset:768
    global_load_dwordx2 v[32:33], v9, s[16:17] offset:1024
    s_barrier
    s_branch RT_MAIN
F_PRO:
    s_mul_i32 s6, s4, 9
    s_add_u32 s6, s6, s5
    v_lshrrev_b32 v6, 3, v2
    v_and_b32 v7, 4, v6
    v_add_u32 v7, v6, v7
    v_mul_u32_u24 v5, 9216, v7
    v_and_b32 v7, 6, v6
    v_xor_b32 v7, v7, v2
    v_and_b32 v7, 7, v7
    v_lshl_add_u32 v5, v7, 4, v5
    s_and_b32 s8, s3, 1
    s_lshr_b32 s9, s3, 1
    s_lshl_b32 s9, s9, 2
    s_add_u32 s8, s8, s9
    s_mul_i32 s14, s8, 36864
    s_lshl_b32 s8, s6, 7
    s_add_u32 s14, s14, s8
    s_lshl_b32 s15, s3, 10
    s_mov_b32 s54, 5308416
    s_mov_b32 s55, 0x20000
    s_mov_b32 s58, 5308416
    s_mov_b32 s59, 0x20000
    s_waitcnt lgkmcnt(0)
    s_mov_b64 s[52:53], s[38:39]
    s_mov_b64 s[56:57], s[40:41]
    s_barrier
    s_branch F_MAIN
HELPER:
    s_lshl_b32 s6, s3, 2
    s_add_u32 s6, s6, s5
    s_sub_u32 s6, s6, 10
    v_mul_u32_u24 v5, 9216, v2
    s_mul_i32 s7, s4, 1152
    v_add_u32 v5, s7, v5
    s_waitcnt lgkmcnt(0)
    s_barrier
    s_cmp_lt_u32 s2, 80
    s_cbranch_scc1 SEL_MAIN
    s_cmp_ge_u32 s3, 4
    s_cbranch_scc1 W_END
    s_cmp_ge_u32 s3, 3
    s_cbranch_scc1 HP_BAR
    v_mov_b32 v8, 0
    global_load_dword v9, v8, s[36:37]
    s_waitcnt vmcnt(0)
    s_mul_i32 s8, s6, 7282
    s_lshr_b32 s8, s8, 16
    s_mul_i32 s9, s8, 9
    s_sub_u32 s9, s6, s9
    s_lshl_b32 s9, s9, 7
    s_bitcmp1_b32 s8, 0
    s_cselect_b32 s12, s40, s38
    s_cselect_b32 s13, s41, s39
    s_lshr_b32 s8, s8, 1
    s_add_u32 s8, s8, 6
    s_mul_i32 s8, s8, 589824
    s_add_u32 s8, s8, s9
    v_add_u32 v6, s8, v5
    global_load_dword v7, v6, s[12:13]
    s_add_u32 s6, s6, 16
HP_BAR:
    s_barrier
HP_LOOP:
    s_waitcnt vmcnt(0)
    s_cmp_ge_u32 s6, 54
    s_cbranch_scc1 HP_DN
    s_mul_i32 s8, s6, 7282
    s_lshr_b32 s8, s8, 16
    s_mul_i32 s9, s8, 9
    s_sub_u32 s9, s6, s9
    s_lshl_b32 s9, s9, 7
    s_bitcmp1_b32 s8, 0
    s_cselect_b32 s12, s40, s38
    s_cselect_b32 s13, s41, s39
    s_lshr_b32 s8, s8, 1
    s_add_u32 s8, s8, 6
    s_mul_i32 s8, s8, 589824
    s_add_u32 s8, s8, s9
    v_add_u32 v6, s8, v5
    global_load_dword v7, v6, s[12:13]
    s_add_u32 s6, s6, 16
    s_branch HP_LOOP
HP_DN:
    s_cmp_ge_u32 s6, 63
    s_cbranch_scc1 W_END
    s_mul_i32 s8, s4, 81
    s_add_u32 s8, s8, s6
    s_add_u32 s8, s8, 18
    s_lshl_b32 s8, s8, 13
    v_lshl_add_u32 v6, v2, 7, s8
    global_load_dword v7, v6, s[42:43]
    s_add_u32 s6, s6, 16
    s_branch HP_LOOP
RT_MAIN:
    s_lshl_b32 s6, s2, 7
    s_add_u32 s6, s6, 4096
    s_cmp_lt_u32 s2, 80
    s_cselect_b32 s8, 15, 23
    v_min_u32 v14, s8, v2
    v_lshl_add_u32 v5, v14, 2, s6
    s_mov_b32 s8, 163520
    v_lshl_add_u32 v14, v14, 2, s8
    v_add_u32 v13, s7, v4
    v_lshl_add_u32 v13, v13, 2, s8
    s_mov_b32 s8, 0xffff
    s_mov_b32 s10, 0x00010001
    s_mov_b32 s11, 0x00010001
    v_mov_b32 v15, 0x3f803f80
    v_mov_b32 v12, 163456
    s_waitcnt lgkmcnt(0)
    s_add_u32 s12, s12, 1
    v_mov_b32 v11, s12
    ds_write_b64 v12, v[10:11]
    v_add_u32 v7, s13, v7
    s_waitcnt vmcnt(5)
    ds_read_b128 v[52:55], v6 offset:1280
    ds_read_b128 v[56:59], v6 offset:1536
    ds_read_b128 v[60:63], v6 offset:1792
    ds_read_b128 v[64:67], v6 offset:2048
    ds_read_b64 v[68:69], v7 offset:2304
    ds_read_b128 v[34:37], v6 offset:0
    ds_read_b128 v[38:41], v6 offset:256
    ds_read_b128 v[42:45], v6 offset:512
    ds_read_b128 v[46:49], v6 offset:768
    ds_read_b64 v[50:51], v7 offset:1024
    s_waitcnt lgkmcnt(5)
    v_and_b32 v84, 0xffff, v52
    v_and_b32 v52, 0xffff0000, v52
    v_and_b32 v85, 0xffff, v53
    v_and_b32 v53, 0xffff0000, v53
    v_and_b32 v86, 0xffff, v54
    v_and_b32 v54, 0xffff0000, v54
    v_and_b32 v87, 0xffff, v55
    v_and_b32 v55, 0xffff0000, v55
    v_and_b32 v88, 0xffff, v56
    v_and_b32 v56, 0xffff0000, v56
    v_and_b32 v89, 0xffff, v57
    v_and_b32 v57, 0xffff0000, v57
    v_and_b32 v90, 0xffff, v58
    v_and_b32 v58, 0xffff0000, v58
    v_and_b32 v91, 0xffff, v59
    v_and_b32 v59, 0xffff0000, v59
    v_and_b32 v92, 0xffff, v60
    v_and_b32 v60, 0xffff0000, v60
    v_and_b32 v93, 0xffff, v61
    v_and_b32 v61, 0xffff0000, v61
    v_and_b32 v94, 0xffff, v62
    v_and_b32 v62, 0xffff0000, v62
    v_and_b32 v95, 0xffff, v63
    v_and_b32 v63, 0xffff0000, v63
    v_and_b32 v96, 0xffff, v64
    v_and_b32 v64, 0xffff0000, v64
    v_and_b32 v97, 0xffff, v65
    v_and_b32 v65, 0xffff0000, v65
    v_and_b32 v98, 0xffff, v66
    v_and_b32 v66, 0xffff0000, v66
    v_and_b32 v99, 0xffff, v67
    v_and_b32 v67, 0xffff0000, v67
    v_and_b32 v100, 0xffff, v68
    v_and_b32 v68, 0xffff0000, v68
    v_and_b32 v101, 0xffff, v69
    v_and_b32 v69, 0xffff0000, v69
    s_waitcnt vmcnt(0) lgkmcnt(0)
    v_dot2_f32_bf16 v12, v16, v34, 0
    v_dot2_f32_bf16 v12, v17, v35, v12
    v_dot2_f32_bf16 v12, v18, v36, v12
    v_dot2_f32_bf16 v12, v19, v37, v12
    v_dot2_f32_bf16 v12, v20, v38, v12
    v_dot2_f32_bf16 v12, v21, v39, v12
    v_dot2_f32_bf16 v12, v22, v40, v12
    v_dot2_f32_bf16 v12, v23, v41, v12
    v_dot2_f32_bf16 v12, v24, v42, v12
    v_dot2_f32_bf16 v12, v25, v43, v12
    v_dot2_f32_bf16 v12, v26, v44, v12
    v_dot2_f32_bf16 v12, v27, v45, v12
    v_dot2_f32_bf16 v12, v28, v46, v12
    v_dot2_f32_bf16 v12, v29, v47, v12
    v_dot2_f32_bf16 v12, v30, v48, v12
    v_dot2_f32_bf16 v12, v31, v49, v12
    v_dot2_f32_bf16 v12, v32, v50, v12
    v_dot2_f32_bf16 v12, v33, v51, v12
    s_nop 0
    s_nop 1
    v_add_f32_dpp v12, v12, v12 row_ror:8 row_mask:0xf bank_mask:0xf
    s_nop 1
    v_add_f32_dpp v12, v12, v12 row_ror:4 row_mask:0xf bank_mask:0xf
    s_nop 1
    v_add_f32_dpp v12, v12, v12 row_ror:2 row_mask:0xf bank_mask:0xf
    s_nop 1
    v_add_f32_dpp v12, v12, v12 row_ror:1 row_mask:0xf bank_mask:0xf
    v_cvt_pk_bf16_f32 v12, v12, v12
    v_ashrrev_i32 v9, 31, v12
    v_or_b32 v9, 0x80000000, v9
    v_xor_b32 v12, v12, v9
    v_or_b32 v12, 1, v12
    s_mov_b64 exec, s[10:11]
    ds_write_b32 v13, v12 offset:0
    s_mov_b64 exec, -1
    s_cmp_lg_u32 s7, 0
    s_cbranch_scc1 RT_PK_X
    s_mov_b32 s9, 0
RT_PK:
    ds_read_b32 v12, v14 offset:0
    s_add_u32 s9, s9, 1
    s_waitcnt lgkmcnt(0)
    v_cmp_eq_u32 vcc, 0, v12
    s_cmp_ge_u32 s9, 0x40000
    s_cbranch_scc1 RT_PK_S
    s_cbranch_vccnz RT_PK
RT_PK_S:
    v_bfi_b32 v12, s8, v11, v12
    s_mov_b64 exec, 0xffffff
    global_store_dword v5, v12, s[50:51] sc1
    s_mov_b64 exec, -1
RT_PK_X:
    s_or_b32 s9, s2, s7
    s_cmp_lg_u32 s9, 0
    s_cbranch_scc1 RT_NOT
    v_mov_b32 v8, v11
    v_mov_b32 v9, 1
    global_store_dwordx2 v10, v[8:9], s[48:49] sc1
RT_NOT:
    v_dot2_f32_bf16 v70, v16, v84, 0
    v_dot2_f32_bf16 v71, v16, v52, 0
    v_dot2_f32_bf16 v72, v17, v85, 0
    v_dot2_f32_bf16 v73, v17, v53, 0
    v_dot2_f32_bf16 v74, v18, v86, 0
    v_dot2_f32_bf16 v75, v18, v54, 0
    v_dot2_f32_bf16 v76, v19, v87, 0
    v_dot2_f32_bf16 v77, v19, v55, 0
    v_dot2_f32_bf16 v78, v20, v88, 0
    v_dot2_f32_bf16 v79, v20, v56, 0
    v_dot2_f32_bf16 v80, v21, v89, 0
    v_dot2_f32_bf16 v81, v21, v57, 0
    s_nop 0
    v_cvt_pk_bf16_f32 v70, v70, v71
    v_cvt_pk_bf16_f32 v72, v72, v73
    v_cvt_pk_bf16_f32 v74, v74, v75
    v_cvt_pk_bf16_f32 v76, v76, v77
    v_cvt_pk_bf16_f32 v78, v78, v79
    v_cvt_pk_bf16_f32 v80, v80, v81
    v_dot2_f32_bf16 v12, v70, v15, 0
    v_dot2_f32_bf16 v12, v72, v15, v12
    v_dot2_f32_bf16 v12, v74, v15, v12
    v_dot2_f32_bf16 v12, v76, v15, v12
    v_dot2_f32_bf16 v12, v78, v15, v12
    v_dot2_f32_bf16 v12, v80, v15, v12
    v_dot2_f32_bf16 v70, v22, v90, 0
    v_dot2_f32_bf16 v71, v22, v58, 0
    v_dot2_f32_bf16 v72, v23, v91, 0
    v_dot2_f32_bf16 v73, v23, v59, 0
    v_dot2_f32_bf16 v74, v24, v92, 0
    v_dot2_f32_bf16 v75, v24, v60, 0
    v_dot2_f32_bf16 v76, v25, v93, 0
    v_dot2_f32_bf16 v77, v25, v61, 0
    v_dot2_f32_bf16 v78, v26, v94, 0
    v_dot2_f32_bf16 v79, v26, v62, 0
    v_dot2_f32_bf16 v80, v27, v95, 0
    v_dot2_f32_bf16 v81, v27, v63, 0
    s_nop 0
    v_cvt_pk_bf16_f32 v70, v70, v71
    v_cvt_pk_bf16_f32 v72, v72, v73
    v_cvt_pk_bf16_f32 v74, v74, v75
    v_cvt_pk_bf16_f32 v76, v76, v77
    v_cvt_pk_bf16_f32 v78, v78, v79
    v_cvt_pk_bf16_f32 v80, v80, v81
    v_dot2_f32_bf16 v12, v70, v15, v12
    v_dot2_f32_bf16 v12, v72, v15, v12
    v_dot2_f32_bf16 v12, v74, v15, v12
    v_dot2_f32_bf16 v12, v76, v15, v12
    v_dot2_f32_bf16 v12, v78, v15, v12
    v_dot2_f32_bf16 v12, v80, v15, v12
    v_dot2_f32_bf16 v70, v28, v96, 0
    v_dot2_f32_bf16 v71, v28, v64, 0
    v_dot2_f32_bf16 v72, v29, v97, 0
    v_dot2_f32_bf16 v73, v29, v65, 0
    v_dot2_f32_bf16 v74, v30, v98, 0
    v_dot2_f32_bf16 v75, v30, v66, 0
    v_dot2_f32_bf16 v76, v31, v99, 0
    v_dot2_f32_bf16 v77, v31, v67, 0
    v_dot2_f32_bf16 v78, v32, v100, 0
    v_dot2_f32_bf16 v79, v32, v68, 0
    v_dot2_f32_bf16 v80, v33, v101, 0
    v_dot2_f32_bf16 v81, v33, v69, 0
    s_nop 0
    v_cvt_pk_bf16_f32 v70, v70, v71
    v_cvt_pk_bf16_f32 v72, v72, v73
    v_cvt_pk_bf16_f32 v74, v74, v75
    v_cvt_pk_bf16_f32 v76, v76, v77
    v_cvt_pk_bf16_f32 v78, v78, v79
    v_cvt_pk_bf16_f32 v80, v80, v81
    v_dot2_f32_bf16 v12, v70, v15, v12
    v_dot2_f32_bf16 v12, v72, v15, v12
    v_dot2_f32_bf16 v12, v74, v15, v12
    v_dot2_f32_bf16 v12, v76, v15, v12
    v_dot2_f32_bf16 v12, v78, v15, v12
    v_dot2_f32_bf16 v12, v80, v15, v12
    v_add_u32 v5, 16384, v5
    s_nop 1
    v_add_f32_dpp v12, v12, v12 row_ror:8 row_mask:0xf bank_mask:0xf
    s_nop 1
    v_add_f32_dpp v12, v12, v12 row_ror:4 row_mask:0xf bank_mask:0xf
    s_nop 1
    v_add_f32_dpp v12, v12, v12 row_ror:2 row_mask:0xf bank_mask:0xf
    s_nop 1
    v_add_f32_dpp v12, v12, v12 row_ror:1 row_mask:0xf bank_mask:0xf
    v_cvt_pk_bf16_f32 v12, v12, v12
    v_and_b32 v12, 0xffff0000, v12
    v_mul_f32 v9, 0xbfb8aa3b, v12
    v_exp_f32 v9, v9
    s_nop 0
    v_add_f32 v9, 1.0, v9
    v_rcp_f32 v9, v9
    s_nop 0
    v_cvt_pk_bf16_f32 v12, v9, v9
    v_or_b32 v12, 1, v12
    s_mov_b64 exec, s[10:11]
    ds_write_b32 v13, v12 offset:128
    s_mov_b64 exec, -1
    s_cmp_lg_u32 s7, 0
    s_cbranch_scc1 RT_PG_X
    s_mov_b32 s9, 0
RT_PG:
    ds_read_b32 v12, v14 offset:128
    s_add_u32 s9, s9, 1
    s_waitcnt lgkmcnt(0)
    v_cmp_eq_u32 vcc, 0, v12
    s_cmp_ge_u32 s9, 0x40000
    s_cbranch_scc1 RT_PG_S
    s_cbranch_vccnz RT_PG
RT_PG_S:
    v_bfi_b32 v12, s8, v11, v12
    s_mov_b64 exec, 0xffffff
    global_store_dword v5, v12, s[50:51] sc1
    s_mov_b64 exec, -1
RT_PG_X:
    s_barrier
RT_TAIL:
    s_cmp_ge_u32 s2, 72
    s_cbranch_scc1 W_END
    s_cmp_ge_u32 s3, 10
    s_cbranch_scc1 W_END
    s_cmp_eq_u32 s3, 9
    s_cbranch_scc1 RT_CTL
    s_mul_i32 s6, s4, 9
    s_add_u32 s6, s6, s5
    v_mov_b32 v14, v11
    v_lshrrev_b32 v17, 3, v2
    v_mul_u32_u24 v17, 9216, v17
    v_and_b32 v7, 7, v2
    v_lshl_add_u32 v17, v7, 4, v17
    s_mul_i32 s74, s6, 73728
    s_lshl_b32 s9, s3, 7
    s_add_u32 s74, s74, s9
    s_add_u32 s75, s74, 4608
    s_mov_b32 s60, s42
    s_mov_b32 s61, s43
    s_mov_b32 s62, 5308416
    s_mov_b32 s63, 0x20000
    v_mul_u32_u24 v11, 144, v7
    v_add_u32 v11, 162048, v11
    v_lshrrev_b32 v12, 3, v3
    v_lshl_add_u32 v13, v4, 1, v12
    v_lshl_add_u32 v13, v13, 4, v11
    v_and_b32 v15, 1, v4
    v_lshlrev_b32 v15, 2, v15
    v_add_u32 v15, v15, v12
    v_lshrrev_b32 v16, 1, v4
    v_lshl_add_u32 v15, v15, 1, v16
    v_mul_u32_u24 v15, 9216, v15
    v_lshl_add_u32 v15, v7, 4, v15
    s_mul_i32 s8, s3, 147456
    s_lshl_b32 s9, s6, 7
    s_add_u32 s8, s8, s9
    s_add_u32 s8, s8, 40960
    v_add_u32 v15, s8, v15
    v_add_u32 v16, 36864, v15
    s_setprio 1
    s_barrier
    buffer_load_dwordx4 v[96:99], v17, s[60:63], s74 offen offset:0
    buffer_load_dwordx4 v[100:103], v17, s[60:63], s74 offen offset:1152
    buffer_load_dwordx4 v[104:107], v17, s[60:63], s74 offen offset:2304
    buffer_load_dwordx4 v[108:111], v17, s[60:63], s74 offen offset:3456
    buffer_load_dwordx4 v[112:115], v17, s[60:63], s75 offen offset:0
    buffer_load_dwordx4 v[116:119], v17, s[60:63], s75 offen offset:1152
    buffer_load_dwordx4 v[120:123], v17, s[60:63], s75 offen offset:2304
    buffer_load_dwordx4 v[124:127], v17, s[60:63], s75 offen offset:3456
    s_barrier
    s_waitcnt vmcnt(0)
    s_mov_b32 s76, 0x05040100
    s_mov_b32 s77, 0x07060302
    v_perm_b32 v128, v100, v96, s76
    v_perm_b32 v129, v108, v104, s76
    v_perm_b32 v130, v116, v112, s76
    v_perm_b32 v131, v124, v120, s76
    v_perm_b32 v132, v100, v96, s77
    v_perm_b32 v133, v108, v104, s77
    v_perm_b32 v134, v116, v112, s77
    v_perm_b32 v135, v124, v120, s77
    v_perm_b32 v136, v101, v97, s76
    v_perm_b32 v137, v109, v105, s76
    v_perm_b32 v138, v117, v113, s76
    v_perm_b32 v139, v125, v121, s76
    v_perm_b32 v140, v101, v97, s77
    v_perm_b32 v141, v109, v105, s77
    v_perm_b32 v142, v117, v113, s77
    v_perm_b32 v143, v125, v121, s77
    v_perm_b32 v144, v102, v98, s76
    v_perm_b32 v145, v110, v106, s76
    v_perm_b32 v146, v118, v114, s76
    v_perm_b32 v147, v126, v122, s76
    v_perm_b32 v148, v102, v98, s77
    v_perm_b32 v149, v110, v106, s77
    v_perm_b32 v150, v118, v114, s77
    v_perm_b32 v151, v126, v122, s77
    v_perm_b32 v152, v103, v99, s76
    v_perm_b32 v153, v111, v107, s76
    v_perm_b32 v154, v119, v115, s76
    v_perm_b32 v155, v127, v123, s76
    v_perm_b32 v156, v103, v99, s77
    v_perm_b32 v157, v111, v107, s77
    v_perm_b32 v158, v119, v115, s77
    v_perm_b32 v159, v127, v123, s77
    s_branch F_H
RT_CTL:
    s_mov_b32 s64, s16
    s_mov_b32 s65, s17
    s_mov_b32 s66, 2359296
    s_mov_b32 s67, 0x20000
    v_lshlrev_b32 v19, 4, v2
    v_lshlrev_b32 v20, 2, v2
    v_and_b32 v6, 7, v2
    s_lshl_b32 s9, s4, 8
    v_lshl_add_u32 v6, v6, 3, s9
    s_mov_b32 s12, 0
SP_C:
    s_add_u32 s12, s12, 1
    s_and_b32 s9, s12, 7
    s_cselect_b32 s9, 0, 128
    v_add_u32 v10, s9, v6
    global_load_dwordx2 v[8:9], v10, s[50:51] offset:256 sc1
    s_waitcnt vmcnt(0)
SPC_C:
    v_cmp_ne_u32 vcc, v9, v11
    s_cmp_ge_u32 s12, 16384
    s_cbranch_scc1 SPX_C
    s_cbranch_vccz SPX_C
    s_mov_b64 exec, vcc
    s_sleep 2
    s_branch SP_C
SPX_C:
    s_mov_b64 exec, -1
    v_not_b32 v8, v8
    v_and_b32 v8, 0x7ff, v8
    v_mul_u32_u24 v8, 1152, v8
    s_mov_b32 m0, 147456
    v_readlane_b32 s76, v8, 0
    v_readlane_b32 s77, v8, 1
    v_readlane_b32 s78, v8, 2
    v_readlane_b32 s79, v8, 3
    v_readlane_b32 s80, v8, 4
    v_readlane_b32 s81, v8, 5
    v_readlane_b32 s82, v8, 6
    v_readlane_b32 s83, v8, 7
    buffer_load_dwordx4 v19, s[64:67], s76 offen lds
    buffer_load_dword v20, s[64:67], s76 offen offset:1024 lds
    s_add_u32 m0, m0, 1312
    s_nop 0
    buffer_load_dwordx4 v19, s[64:67], s77 offen lds
    buffer_load_dword v20, s[64:67], s77 offen offset:1024 lds
    s_add_u32 m0, m0, 1312
    s_nop 0
    buffer_load_dwordx4 v19, s[64:67], s78 offen lds
    buffer_load_dword v20, s[64:67], s78 offen offset:1024 lds
    s_add_u32 m0, m0, 1312
    s_nop 0
    buffer_load_dwordx4 v19, s[64:67], s79 offen lds
    buffer_load_dword v20, s[64:67], s79 offen offset:1024 lds
    s_add_u32 m0, m0, 1312
    s_nop 0
    buffer_load_dwordx4 v19, s[64:67], s80 offen lds
    buffer_load_dword v20, s[64:67], s80 offen offset:1024 lds
    s_add_u32 m0, m0, 1312
    s_nop 0
    buffer_load_dwordx4 v19, s[64:67], s81 offen lds
    buffer_load_dword v20, s[64:67], s81 offen offset:1024 lds
    s_add_u32 m0, m0, 1312
    s_nop 0
    buffer_load_dwordx4 v19, s[64:67], s82 offen lds
    buffer_load_dword v20, s[64:67], s82 offen offset:1024 lds
    s_add_u32 m0, m0, 1312
    s_nop 0
    buffer_load_dwordx4 v19, s[64:67], s83 offen lds
    buffer_load_dword v20, s[64:67], s83 offen offset:1024 lds
    s_add_u32 m0, m0, 1312
    s_nop 0
    s_waitcnt vmcnt(0)
    s_barrier
    s_endpgm
F_MAIN:
    v_lshrrev_b32 v17, 3, v2
    v_mul_u32_u24 v17, 9216, v17
    v_and_b32 v7, 7, v2
    v_lshl_add_u32 v17, v7, 4, v17
    s_mul_i32 s74, s6, 73728
    s_lshl_b32 s9, s3, 7
    s_add_u32 s74, s74, s9
    s_add_u32 s75, s74, 4608
    s_mov_b32 s60, s42
    s_mov_b32 s61, s43
    s_mov_b32 s62, 5308416
    s_mov_b32 s63, 0x20000
    s_add_u32 m0, s15, 0
    s_add_u32 s8, s14, 0
    buffer_load_dwordx4 v5, s[52:55], s8 offen lds
    s_add_u32 m0, s15, 73728
    s_add_u32 s8, s14, 0
    buffer_load_dwordx4 v5, s[56:59], s8 offen lds
    s_and_b32 s12, s3, 3
    s_lshr_b32 s13, s3, 2
    v_and_b32 v18, 1, v4
    v_bfe_u32 v6, v2, 2, 2
    v_lshl_add_u32 v18, v18, 2, v6
    v_lshrrev_b32 v6, 1, v18
    v_xor_b32 v6, s12, v6
    v_lshlrev_b32 v18, 7, v18
    v_lshl_add_u32 v18, v6, 5, v18
    v_and_b32 v6, 3, v2
    v_lshl_add_u32 v18, v6, 3, v18
    v_lshrrev_b32 v6, 1, v4
    v_lshl_add_u32 v18, v6, 11, v18
    s_lshl_b32 s8, s13, 12
    v_add_u32 v18, s8, v18
    v_add_u32 v6, 73728, v18
    v_add_u32 v0, 40960, v18
    v_add_u32 v1, 40960, v6
    v_mul_u32_u24 v8, 1312, v7
    v_lshl_add_u32 v8, v4, 4, v8
    s_lshl_b32 s8, s13, 6
    s_add_u32 s8, s8, 147456
    v_add_u32 v8, s8, v8
    s_lshl_b32 s8, s3, 9
    s_add_u32 s8, s8, 157952
    v_lshl_add_u32 v9, v2, 3, s8
    s_xor_b32 s8, s3, 4
    s_lshl_b32 s8, s8, 9
    s_add_u32 s8, s8, 157952
    v_lshl_add_u32 v10, v2, 3, s8
    v_mul_u32_u24 v11, 144, v7
    v_add_u32 v11, 162048, v11
    v_lshrrev_b32 v12, 3, v3
    v_lshl_add_u32 v13, v4, 1, v12
    v_lshl_add_u32 v13, v13, 4, v11
    v_and_b32 v15, 1, v4
    v_lshlrev_b32 v15, 2, v15
    v_add_u32 v15, v15, v12
    v_lshrrev_b32 v16, 1, v4
    v_lshl_add_u32 v15, v15, 1, v16
    v_mul_u32_u24 v15, 9216, v15
    v_lshl_add_u32 v15, v7, 4, v15
    s_mul_i32 s8, s3, 147456
    s_lshl_b32 s9, s6, 7
    s_add_u32 s8, s8, s9
    s_add_u32 s8, s8, 40960
    v_add_u32 v15, s8, v15
    v_add_u32 v16, 36864, v15
    v_lshl_add_u32 v12, v4, 2, v12
    s_lshl_b32 s8, s12, 4
    s_lshl_b32 s9, s13, 1
    s_add_u32 s8, s8, s9
    v_add_u32 v12, s8, v12
    v_lshl_add_u32 v11, v12, 1, v11
    v_mov_b32 v21, 163456
    v_mov_b32 v22, 1
    s_mov_b32 s10, 0xff00ff00
    s_mov_b32 s11, 0xff00ff00
    s_waitcnt vmcnt(0)
    s_add_u32 m0, s15, 8192
    s_add_u32 s8, s14, 589824
    buffer_load_dwordx4 v5, s[52:55], s8 offen lds
    s_add_u32 m0, s15, 81920
    s_add_u32 s8, s14, 589824
    buffer_load_dwordx4 v5, s[56:59], s8 offen lds
    s_add_u32 m0, s15, 16384
    s_add_u32 s8, s14, 1179648
    buffer_load_dwordx4 v5, s[52:55], s8 offen lds
    s_barrier
    ds_read_b32 v14, v21 offset:4
    s_add_u32 m0, s15, 90112
    s_add_u32 s8, s14, 1179648
    buffer_load_dwordx4 v5, s[56:59], s8 offen lds
    s_waitcnt vmcnt(3)
    s_add_u32 m0, s15, 24576
    s_add_u32 s8, s14, 1769472
    buffer_load_dwordx4 v5, s[52:55], s8 offen lds
    s_waitcnt vmcnt(3)
    s_add_u32 m0, s15, 98304
    s_add_u32 s8, s14, 1769472
    buffer_load_dwordx4 v5, s[56:59], s8 offen lds
    s_waitcnt vmcnt(3)
    s_add_u32 m0, s15, 32768
    s_add_u32 s8, s14, 2359296
    buffer_load_dwordx4 v5, s[52:55], s8 offen lds
    s_waitcnt vmcnt(3)
    s_add_u32 m0, s15, 106496
    s_add_u32 s8, s14, 2359296
    buffer_load_dwordx4 v5, s[56:59], s8 offen lds
    s_waitcnt vmcnt(3)
    s_add_u32 m0, s15, 40960
    s_add_u32 s8, s14, 2949120
    buffer_load_dwordx4 v5, s[52:55], s8 offen lds
    s_waitcnt vmcnt(3)
    s_add_u32 m0, s15, 114688
    s_add_u32 s8, s14, 2949120
    buffer_load_dwordx4 v5, s[56:59], s8 offen lds
    s_waitcnt vmcnt(3)
    s_add_u32 m0, s15, 49152
    s_add_u32 s8, s14, 3538944
    buffer_load_dwordx4 v5, s[52:55], s8 offen lds
    s_waitcnt vmcnt(3)
    s_add_u32 m0, s15, 122880
    s_add_u32 s8, s14, 3538944
    buffer_load_dwordx4 v5, s[56:59], s8 offen lds
    s_waitcnt vmcnt(3)
    s_add_u32 m0, s15, 57344
    s_add_u32 s8, s14, 4128768
    buffer_load_dwordx4 v5, s[52:55], s8 offen lds
    s_waitcnt vmcnt(3)
    s_add_u32 m0, s15, 131072
    s_add_u32 s8, s14, 4128768
    buffer_load_dwordx4 v5, s[56:59], s8 offen lds
    s_waitcnt vmcnt(3)
    s_add_u32 m0, s15, 65536
    s_add_u32 s8, s14, 4718592
    buffer_load_dwordx4 v5, s[52:55], s8 offen lds
    s_waitcnt vmcnt(3)
    s_add_u32 m0, s15, 139264
    s_add_u32 s8, s14, 4718592
    buffer_load_dwordx4 v5, s[56:59], s8 offen lds
    s_waitcnt vmcnt(4)
    s_mov_b64 exec, 1
    ds_add_u32 v21, v22 offset:160
    s_mov_b64 exec, -1
    s_mov_b32 s9, 0
F_LAND:
    ds_read_b32 v22, v21 offset:160
    s_add_u32 s9, s9, 1
    s_waitcnt lgkmcnt(0)
    v_cmp_ne_u32 vcc, 8, v22
    s_cmp_ge_u32 s9, 0x40000
    s_cbranch_scc1 F_LANDED
    s_cbranch_vccnz F_LAND
F_LANDED:
    ds_read_b64_tr_b16 v[24:25], v18 offset:0
    ds_read_b64_tr_b16 v[26:27], v18 offset:1024
    ds_read_b64_tr_b16 v[28:29], v6 offset:0
    ds_read_b64_tr_b16 v[30:31], v6 offset:1024
    ds_read_b64_tr_b16 v[32:33], v18 offset:8192
    ds_read_b64_tr_b16 v[34:35], v18 offset:9216
    ds_read_b64_tr_b16 v[36:37], v6 offset:8192
    ds_read_b64_tr_b16 v[38:39], v6 offset:9216
    ds_read_b64_tr_b16 v[40:41], v18 offset:16384
    ds_read_b64_tr_b16 v[42:43], v18 offset:17408
    ds_read_b64_tr_b16 v[44:45], v6 offset:16384
    ds_read_b64_tr_b16 v[46:47], v6 offset:17408
    ds_read_b64_tr_b16 v[48:49], v18 offset:24576
    ds_read_b64_tr_b16 v[50:51], v18 offset:25600
    ds_read_b64_tr_b16 v[52:53], v6 offset:24576
    ds_read_b64_tr_b16 v[54:55], v6 offset:25600
    ds_read_b64_tr_b16 v[56:57], v18 offset:32768
    ds_read_b64_tr_b16 v[58:59], v18 offset:33792
    ds_read_b64_tr_b16 v[60:61], v6 offset:32768
    ds_read_b64_tr_b16 v[62:63], v6 offset:33792
    ds_read_b64_tr_b16 v[64:65], v0 offset:0
    ds_read_b64_tr_b16 v[66:67], v0 offset:1024
    ds_read_b64_tr_b16 v[68:69], v1 offset:0
    ds_read_b64_tr_b16 v[70:71], v1 offset:1024
    ds_read_b64_tr_b16 v[72:73], v0 offset:8192
    ds_read_b64_tr_b16 v[74:75], v0 offset:9216
    ds_read_b64_tr_b16 v[76:77], v1 offset:8192
    ds_read_b64_tr_b16 v[78:79], v1 offset:9216
    s_waitcnt vmcnt(0)
    s_barrier
    ds_read_b128 v[128:131], v8 offset:0
    ds_read_b128 v[132:135], v8 offset:128
    ds_read_b128 v[136:139], v8 offset:256
    ds_read_b128 v[140:143], v8 offset:384
    ds_read_b128 v[144:147], v8 offset:512
    ds_read_b128 v[148:151], v8 offset:640
    ds_read_b128 v[152:155], v8 offset:768
    ds_read_b128 v[156:159], v8 offset:896
    s_waitcnt lgkmcnt(7)
    v_mfma_f32_16x16x32_bf16 v[160:163], v[24:27], v[128:131], 0
    v_mfma_f32_16x16x32_bf16 v[164:167], v[28:31], v[128:131], 0
    buffer_load_dwordx4 v[96:99], v17, s[60:63], s74 offen offset:0
    s_waitcnt lgkmcnt(6)
    v_mfma_f32_16x16x32_bf16 v[160:163], v[32:35], v[132:135], v[160:163]
    v_mfma_f32_16x16x32_bf16 v[164:167], v[36:39], v[132:135], v[164:167]
    buffer_load_dwordx4 v[100:103], v17, s[60:63], s74 offen offset:1152
    ds_read_b128 v[128:131], v8 offset:1024
    ds_read_b64_tr_b16 v[80:81], v0 offset:16384
    ds_read_b64_tr_b16 v[82:83], v0 offset:17408
    ds_read_b64_tr_b16 v[84:85], v1 offset:16384
    ds_read_b64_tr_b16 v[86:87], v1 offset:17408
    s_waitcnt lgkmcnt(10)
    v_mfma_f32_16x16x32_bf16 v[160:163], v[40:43], v[136:139], v[160:163]
    v_mfma_f32_16x16x32_bf16 v[164:167], v[44:47], v[136:139], v[164:167]
    buffer_load_dwordx4 v[104:107], v17, s[60:63], s74 offen offset:2304
    ds_read_b64_tr_b16 v[88:89], v0 offset:24576
    ds_read_b64_tr_b16 v[90:91], v0 offset:25600
    ds_read_b64_tr_b16 v[92:93], v1 offset:24576
    ds_read_b64_tr_b16 v[94:95], v1 offset:25600
    s_waitcnt lgkmcnt(13)
    v_mfma_f32_16x16x32_bf16 v[160:163], v[48:51], v[140:143], v[160:163]
    v_mfma_f32_16x16x32_bf16 v[164:167], v[52:55], v[140:143], v[164:167]
    buffer_load_dwordx4 v[108:111], v17, s[60:63], s74 offen offset:3456
    s_waitcnt lgkmcnt(12)
    v_mfma_f32_16x16x32_bf16 v[160:163], v[56:59], v[144:147], v[160:163]
    v_mfma_f32_16x16x32_bf16 v[164:167], v[60:63], v[144:147], v[164:167]
    buffer_load_dwordx4 v[112:115], v17, s[60:63], s75 offen offset:0
    s_waitcnt lgkmcnt(11)
    v_mfma_f32_16x16x32_bf16 v[160:163], v[64:67], v[148:151], v[160:163]
    v_mfma_f32_16x16x32_bf16 v[164:167], v[68:71], v[148:151], v[164:167]
    buffer_load_dwordx4 v[116:119], v17, s[60:63], s75 offen offset:1152
    s_waitcnt lgkmcnt(10)
    v_mfma_f32_16x16x32_bf16 v[160:163], v[72:75], v[152:155], v[160:163]
    v_mfma_f32_16x16x32_bf16 v[164:167], v[76:79], v[152:155], v[164:167]
    buffer_load_dwordx4 v[120:123], v17, s[60:63], s75 offen offset:2304
    s_waitcnt lgkmcnt(4)
    v_mfma_f32_16x16x32_bf16 v[160:163], v[80:83], v[156:159], v[160:163]
    v_mfma_f32_16x16x32_bf16 v[164:167], v[84:87], v[156:159], v[164:167]
    buffer_load_dwordx4 v[124:127], v17, s[60:63], s75 offen offset:3456
    s_waitcnt lgkmcnt(0)
    v_mfma_f32_16x16x32_bf16 v[160:163], v[88:91], v[128:131], v[160:163]
    v_mfma_f32_16x16x32_bf16 v[164:167], v[92:95], v[128:131], v[164:167]
    s_cmp_eq_u32 s13, 0
    s_cselect_b64 vcc, -1, 0
    s_nop 5
    v_cndmask_b32 v24, v160, v161, s[10:11]
    v_cndmask_b32 v25, v162, v163, s[10:11]
    v_cndmask_b32 v26, v164, v165, s[10:11]
    v_cndmask_b32 v27, v166, v167, s[10:11]
    v_cndmask_b32 v28, v24, v25, vcc
    v_cndmask_b32 v29, v26, v27, vcc
    ds_write_b64 v9, v[28:29]
    v_cndmask_b32 v24, v25, v24, vcc
    v_cndmask_b32 v25, v27, v26, vcc
    s_waitcnt lgkmcnt(0)
    s_barrier
    ds_read_b64 v[28:29], v10
    s_waitcnt lgkmcnt(0)
    v_add_f32 v24, v24, v28
    v_add_f32 v25, v25, v29
    v_cvt_pk_bf16_f32 v24, v24, v25
    v_lshlrev_b32 v25, 16, v24
    v_mul_f32 v26, 0xbfb8aa3b, v25
    v_exp_f32 v26, v26
    v_and_b32 v24, 0xffff0000, v24
    v_add_f32 v26, 1.0, v26
    v_rcp_f32 v26, v26
    s_nop 0
    v_mul_f32 v25, v25, v26
    v_cvt_pk_bf16_f32 v25, v25, v25
    v_and_b32 v25, 0xffff0000, v25
    v_mul_f32 v24, v24, v25
    v_cvt_pk_bf16_f32 v24, v24, v24
    ds_write_b16 v11, v24
    s_waitcnt vmcnt(0)
    s_mov_b32 s76, 0x05040100
    s_mov_b32 s77, 0x07060302
    v_perm_b32 v128, v100, v96, s76
    v_perm_b32 v129, v108, v104, s76
    v_perm_b32 v130, v116, v112, s76
    v_perm_b32 v131, v124, v120, s76
    v_perm_b32 v132, v100, v96, s77
    v_perm_b32 v133, v108, v104, s77
    v_perm_b32 v134, v116, v112, s77
    v_perm_b32 v135, v124, v120, s77
    v_perm_b32 v136, v101, v97, s76
    v_perm_b32 v137, v109, v105, s76
    v_perm_b32 v138, v117, v113, s76
    v_perm_b32 v139, v125, v121, s76
    v_perm_b32 v140, v101, v97, s77
    v_perm_b32 v141, v109, v105, s77
    v_perm_b32 v142, v117, v113, s77
    v_perm_b32 v143, v125, v121, s77
    v_perm_b32 v144, v102, v98, s76
    v_perm_b32 v145, v110, v106, s76
    v_perm_b32 v146, v118, v114, s76
    v_perm_b32 v147, v126, v122, s76
    v_perm_b32 v148, v102, v98, s77
    v_perm_b32 v149, v110, v106, s77
    v_perm_b32 v150, v118, v114, s77
    v_perm_b32 v151, v126, v122, s77
    v_perm_b32 v152, v103, v99, s76
    v_perm_b32 v153, v111, v107, s76
    v_perm_b32 v154, v119, v115, s76
    v_perm_b32 v155, v127, v123, s76
    v_perm_b32 v156, v103, v99, s77
    v_perm_b32 v157, v111, v107, s77
    v_perm_b32 v158, v119, v115, s77
    v_perm_b32 v159, v127, v123, s77
    s_waitcnt lgkmcnt(0)
F_H:
    s_movk_i32 s78, 0xff
    s_barrier
    ds_read_b128 v[24:27], v13
    s_waitcnt lgkmcnt(0)
    v_mfma_f32_16x16x32_bf16 v[32:35], v[128:131], v[24:27], 0
    v_mfma_f32_16x16x32_bf16 v[48:51], v[144:147], v[24:27], 0
    v_mfma_f32_16x16x32_bf16 v[36:39], v[132:135], v[24:27], 0
    v_mfma_f32_16x16x32_bf16 v[52:55], v[148:151], v[24:27], 0
    v_mfma_f32_16x16x32_bf16 v[40:43], v[136:139], v[24:27], 0
    v_mfma_f32_16x16x32_bf16 v[56:59], v[152:155], v[24:27], 0
    v_mfma_f32_16x16x32_bf16 v[44:47], v[140:143], v[24:27], 0
    v_mfma_f32_16x16x32_bf16 v[60:63], v[156:159], v[24:27], 0
    s_nop 1
    v_permlane32_swap_b32 v32, v48
    v_permlane32_swap_b32 v33, v49
    v_permlane32_swap_b32 v34, v50
    v_permlane32_swap_b32 v35, v51
    v_permlane32_swap_b32 v36, v52
    v_permlane32_swap_b32 v37, v53
    v_permlane32_swap_b32 v38, v54
    v_permlane32_swap_b32 v39, v55
    v_permlane32_swap_b32 v40, v56
    v_permlane32_swap_b32 v41, v57
    v_permlane32_swap_b32 v42, v58
    v_permlane32_swap_b32 v43, v59
    v_permlane32_swap_b32 v44, v60
    v_permlane32_swap_b32 v45, v61
    v_permlane32_swap_b32 v46, v62
    v_permlane32_swap_b32 v47, v63
    v_add_f32_dpp v64, v48, v32 row_ror:8 row_mask:0xf bank_mask:0x3
    v_add_f32_dpp v65, v52, v36 row_ror:8 row_mask:0xf bank_mask:0x3
    v_add_f32_dpp v66, v56, v40 row_ror:8 row_mask:0xf bank_mask:0x3
    v_add_f32_dpp v67, v60, v44 row_ror:8 row_mask:0xf bank_mask:0x3
    v_add_f32_dpp v64, v33, v49 row_ror:8 row_mask:0xf bank_mask:0xc
    v_add_f32_dpp v65, v37, v53 row_ror:8 row_mask:0xf bank_mask:0xc
    v_add_f32_dpp v66, v41, v57 row_ror:8 row_mask:0xf bank_mask:0xc
    v_add_f32_dpp v67, v45, v61 row_ror:8 row_mask:0xf bank_mask:0xc
    v_add_f32_dpp v68, v50, v34 row_ror:8 row_mask:0xf bank_mask:0x3
    v_add_f32_dpp v69, v54, v38 row_ror:8 row_mask:0xf bank_mask:0x3
    v_add_f32_dpp v70, v58, v42 row_ror:8 row_mask:0xf bank_mask:0x3
    v_add_f32_dpp v71, v62, v46 row_ror:8 row_mask:0xf bank_mask:0x3
    v_add_f32_dpp v68, v35, v51 row_ror:8 row_mask:0xf bank_mask:0xc
    v_add_f32_dpp v69, v39, v55 row_ror:8 row_mask:0xf bank_mask:0xc
    v_add_f32_dpp v70, v43, v59 row_ror:8 row_mask:0xf bank_mask:0xc
    v_add_f32_dpp v71, v47, v63 row_ror:8 row_mask:0xf bank_mask:0xc
    v_bfi_b32 v64, s78, v14, v64
    v_bfi_b32 v65, s78, v14, v65
    v_bfi_b32 v66, s78, v14, v66
    v_bfi_b32 v67, s78, v14, v67
    global_store_dwordx4 v15, v[64:67], s[50:51] sc1
    v_bfi_b32 v68, s78, v14, v68
    v_bfi_b32 v69, s78, v14, v69
    v_bfi_b32 v70, s78, v14, v70
    v_bfi_b32 v71, s78, v14, v71
    global_store_dwordx4 v16, v[68:71], s[50:51] sc1
    s_endpgm
SEL_MAIN:
    v_min_u32 v19, 8, v2
    v_lshlrev_b32 v19, 7, v19
    v_lshlrev_b32 v20, 2, v2
    v_lshlrev_b32 v37, 4, v2
    v_and_b32 v24, 0x3c0, v37
    v_add_u32 v24, v24, v37
    v_and_b32 v36, 0x3e0, v37
    v_mul_u32_u24 v36, 3, v36
    v_add_u32 v36, v36, v37
    v_add_u32 v36, 10304, v36
    s_lshl_b32 s8, s3, 11
    v_add_u32 v24, s8, v24
    s_cmp_eq_u32 s3, 7
    s_cselect_b64 vcc, -1, 0
    v_cndmask_b32 v24, v24, v36, vcc
    v_add_u32 v24, 4096, v24
    s_lshl_b32 s8, s3, 8
    s_sub_u32 s8, 0xfff, s8
    v_sub_u32 v32, s8, v20
    v_subrev_u32 v33, 1, v32
    v_subrev_u32 v34, 2, v32
    v_subrev_u32 v35, 3, v32
    v_mov_b32 v21, 163456
    s_lshl_b32 s8, s3, 5
    s_add_u32 s8, s8, 163200
    v_lshl_add_u32 v25, v4, 3, s8
    v_and_b32 v27, 28, v20
    v_add_u32 v27, s8, v27
    v_add_u32 v26, 163200, v20
    s_mov_b32 s76, 0xffff
    s_mov_b32 s10, 0x00010001
    s_mov_b32 s11, 0x00010001
    s_barrier
    ds_read_b32 v14, v21 offset:4
    s_mov_b32 s7, 0
    s_waitcnt lgkmcnt(0)
    s_waitcnt vmcnt(0)
F_POLL:
    global_load_dwordx4 v[28:31], v24, s[50:51] sc1
    s_add_u32 s7, s7, 1
    s_waitcnt vmcnt(0)
    v_xor_b32 v36, v28, v14
    v_bitop3_b32 v36, v36, v29, v14 bitop3:0xf6
    v_bitop3_b32 v36, v36, v30, v14 bitop3:0xf6
    v_bitop3_b32 v36, v36, v31, v14 bitop3:0xf6
    v_and_b32 v36, 0xffff, v36
    v_cmp_ne_u32 vcc, 0, v36
    s_cmp_ge_u32 s7, 16384
    s_cbranch_scc1 F_GOT
    s_cbranch_vccz F_GOT
    s_mov_b64 exec, vcc
    s_sleep 4
    s_branch F_POLL
F_GOT:
    s_mov_b64 exec, -1
    v_bfi_b32 v28, s76, v32, v28
    v_bfi_b32 v29, s76, v33, v29
    v_bfi_b32 v30, s76, v34, v30
    v_bfi_b32 v31, s76, v35, v31
    v_max_u32 v36, v28, v29
    v_min_u32 v37, v28, v29
    v_max3_u32 v40, v36, v30, v31
    v_med3_u32 v41, v36, v30, v31
    v_med3_u32 v42, v37, v30, v31
    v_max_u32 v41, v41, v37
    v_min_u32 v42, v42, v36
    v_max_u32_dpp v44, v40, v40 row_ror:8 row_mask:0xf bank_mask:0xf
    s_nop 1
    v_max_u32_dpp v44, v44, v44 row_ror:4 row_mask:0xf bank_mask:0xf
    s_nop 1
    v_max_u32_dpp v44, v44, v44 row_ror:2 row_mask:0xf bank_mask:0xf
    s_nop 1
    v_max_u32_dpp v44, v44, v44 row_ror:1 row_mask:0xf bank_mask:0xf
    v_cmp_eq_u32 vcc, v40, v44
    s_nop 1
    v_cndmask_b32 v40, v40, v41, vcc
    v_cndmask_b32 v41, v41, v42, vcc
    s_nop 0
    v_max_u32_dpp v45, v40, v40 row_ror:8 row_mask:0xf bank_mask:0xf
    s_nop 1
    v_max_u32_dpp v45, v45, v45 row_ror:4 row_mask:0xf bank_mask:0xf
    s_nop 1
    v_max_u32_dpp v45, v45, v45 row_ror:2 row_mask:0xf bank_mask:0xf
    s_nop 1
    v_max_u32_dpp v45, v45, v45 row_ror:1 row_mask:0xf bank_mask:0xf
    v_cmp_eq_u32 vcc, v40, v45
    s_nop 1
    v_cndmask_b32 v40, v40, v41, vcc
    s_nop 1
    v_max_u32_dpp v46, v40, v40 row_ror:8 row_mask:0xf bank_mask:0xf
    s_nop 1
    v_max_u32_dpp v46, v46, v46 row_ror:4 row_mask:0xf bank_mask:0xf
    s_nop 1
    v_max_u32_dpp v46, v46, v46 row_ror:2 row_mask:0xf bank_mask:0xf
    s_nop 1
    v_max_u32_dpp v46, v46, v46 row_ror:1 row_mask:0xf bank_mask:0xf
    s_mov_b64 exec, s[10:11]
    ds_write_b64 v25, v[44:45]
    ds_max_u32 v21, v46
    s_mov_b64 exec, -1
    v_readlane_b32 s77, v44, 0
    v_readlane_b32 s78, v45, 0
    v_readlane_b32 s79, v44, 16
    v_readlane_b32 s80, v45, 16
    v_readlane_b32 s81, v44, 32
    v_readlane_b32 s82, v45, 32
    v_readlane_b32 s83, v44, 48
    v_readlane_b32 s100, v45, 48
    ds_read_b32 v48, v27
    v_mov_b32 v49, v14
    s_lshl_b32 s72, s4, 8
    s_waitcnt lgkmcnt(0)
    s_barrier
    ds_read_b32 v36, v26
    ds_read_b32 v37, v21
    v_not_b32 v50, v48
    v_and_b32 v50, 0x7ff, v50
    v_mul_u32_u24 v50, 1152, v50
    s_waitcnt lgkmcnt(0)
    v_cmp_gt_u32 vcc, v36, v37
    v_cmp_lt_u32 s[18:19], s77, v36
    v_cmp_lt_u32 s[20:21], s78, v36
    v_cmp_lt_u32 s[22:23], s79, v36
    v_cmp_lt_u32 s[24:25], s80, v36
    v_cmp_lt_u32 s[26:27], s81, v36
    v_cmp_lt_u32 s[28:29], s82, v36
    v_cmp_lt_u32 s[30:31], s83, v36
    v_cmp_lt_u32 s[34:35], s100, v36
    s_bcnt1_i32_b64 s8, vcc
    s_cmp_lt_u32 s8, 8
    s_cbranch_scc1 F_SLOW
    s_bcnt1_i32_b64 s18, s[18:19]
    v_writelane_b32 v37, s18, 0
    s_bcnt1_i32_b64 s20, s[20:21]
    v_writelane_b32 v37, s20, 1
    s_bcnt1_i32_b64 s22, s[22:23]
    v_writelane_b32 v37, s22, 2
    s_bcnt1_i32_b64 s24, s[24:25]
    v_writelane_b32 v37, s24, 3
    s_bcnt1_i32_b64 s26, s[26:27]
    v_writelane_b32 v37, s26, 4
    s_bcnt1_i32_b64 s28, s[28:29]
    v_writelane_b32 v37, s28, 5
    s_bcnt1_i32_b64 s30, s[30:31]
    v_writelane_b32 v37, s30, 6
    s_bcnt1_i32_b64 s34, s[34:35]
    v_writelane_b32 v37, s34, 7
    v_cmp_gt_u32 vcc, 8, v37
    v_lshl_add_u32 v37, v37, 3, s72
    s_and_b64 exec, vcc, 0xff
    s_cbranch_execz F_REST
    global_store_dwordx2 v37, v[48:49], s[50:51] offset:256
    global_store_dwordx2 v37, v[48:49], s[50:51] offset:384 sc1
    global_load_dword v51, v50, s[16:17] offset:0
    global_load_dword v51, v50, s[16:17] offset:128
    global_load_dword v51, v50, s[16:17] offset:256
    global_load_dword v51, v50, s[16:17] offset:384
    global_load_dword v51, v50, s[16:17] offset:512
    global_load_dword v51, v50, s[16:17] offset:640
    global_load_dword v51, v50, s[16:17] offset:768
    global_load_dword v51, v50, s[16:17] offset:896
    global_load_dword v51, v50, s[16:17] offset:1024
F_REST:
    s_cmp_lg_u32 s2, 72
    s_cbranch_scc1 W_END
    s_cmp_lg_u32 s3, 0
    s_cbranch_scc1 W_END
    s_mov_b64 exec, 1
    v_mov_b32 v50, 0
    global_store_dword v50, v14, s[50:51] sc1
    s_endpgm
F_SLOW:
    v_lshlrev_b32 v27, 4, v2
    v_and_b32 v24, 0x3c0, v27
    v_add_u32 v24, v24, v27
    v_and_b32 v26, 0x3e0, v27
    v_mul_u32_u24 v26, 3, v26
    v_add_u32 v26, v26, v27
    v_add_u32 v26, 10304, v26
    v_add_u32 v24, 8192, v24
    v_add_u32 v25, 8192, v24
    v_add_u32 v26, 2048, v26
    global_load_dwordx4 v[28:31], v24, s[50:51] offset:-4096 sc1
    global_load_dwordx4 v[32:35], v24, s[50:51] offset:-2048 sc1
    global_load_dwordx4 v[36:39], v24, s[50:51] offset:0 sc1
    global_load_dwordx4 v[40:43], v24, s[50:51] offset:2048 sc1
    global_load_dwordx4 v[44:47], v25, s[50:51] offset:-4096 sc1
    global_load_dwordx4 v[48:51], v25, s[50:51] offset:-2048 sc1
    global_load_dwordx4 v[52:55], v25, s[50:51] offset:0 sc1
    global_load_dwordx4 v[56:59], v26, s[50:51] offset:2048 sc1
    v_sub_u32 v24, 0xfff, v20
    s_waitcnt vmcnt(0)
    v_subrev_u32 v25, 0, v24
    v_bfi_b32 v28, s76, v25, v28
    v_subrev_u32 v25, 1, v24
    v_bfi_b32 v29, s76, v25, v29
    v_subrev_u32 v25, 2, v24
    v_bfi_b32 v30, s76, v25, v30
    v_subrev_u32 v25, 3, v24
    v_bfi_b32 v31, s76, v25, v31
    v_subrev_u32 v25, 256, v24
    v_bfi_b32 v32, s76, v25, v32
    v_subrev_u32 v25, 257, v24
    v_bfi_b32 v33, s76, v25, v33
    v_subrev_u32 v25, 258, v24
    v_bfi_b32 v34, s76, v25, v34
    v_subrev_u32 v25, 259, v24
    v_bfi_b32 v35, s76, v25, v35
    v_subrev_u32 v25, 512, v24
    v_bfi_b32 v36, s76, v25, v36
    v_subrev_u32 v25, 513, v24
    v_bfi_b32 v37, s76, v25, v37
    v_subrev_u32 v25, 514, v24
    v_bfi_b32 v38, s76, v25, v38
    v_subrev_u32 v25, 515, v24
    v_bfi_b32 v39, s76, v25, v39
    v_subrev_u32 v25, 768, v24
    v_bfi_b32 v40, s76, v25, v40
    v_subrev_u32 v25, 769, v24
    v_bfi_b32 v41, s76, v25, v41
    v_subrev_u32 v25, 770, v24
    v_bfi_b32 v42, s76, v25, v42
    v_subrev_u32 v25, 771, v24
    v_bfi_b32 v43, s76, v25, v43
    v_subrev_u32 v25, 1024, v24
    v_bfi_b32 v44, s76, v25, v44
    v_subrev_u32 v25, 1025, v24
    v_bfi_b32 v45, s76, v25, v45
    v_subrev_u32 v25, 1026, v24
    v_bfi_b32 v46, s76, v25, v46
    v_subrev_u32 v25, 1027, v24
    v_bfi_b32 v47, s76, v25, v47
    v_subrev_u32 v25, 1280, v24
    v_bfi_b32 v48, s76, v25, v48
    v_subrev_u32 v25, 1281, v24
    v_bfi_b32 v49, s76, v25, v49
    v_subrev_u32 v25, 1282, v24
    v_bfi_b32 v50, s76, v25, v50
    v_subrev_u32 v25, 1283, v24
    v_bfi_b32 v51, s76, v25, v51
    v_subrev_u32 v25, 1536, v24
    v_bfi_b32 v52, s76, v25, v52
    v_subrev_u32 v25, 1537, v24
    v_bfi_b32 v53, s76, v25, v53
    v_subrev_u32 v25, 1538, v24
    v_bfi_b32 v54, s76, v25, v54
    v_subrev_u32 v25, 1539, v24
    v_bfi_b32 v55, s76, v25, v55
    v_subrev_u32 v25, 1792, v24
    v_bfi_b32 v56, s76, v25, v56
    v_subrev_u32 v25, 1793, v24
    v_bfi_b32 v57, s76, v25, v57
    v_subrev_u32 v25, 1794, v24
    v_bfi_b32 v58, s76, v25, v58
    v_subrev_u32 v25, 1795, v24
    v_bfi_b32 v59, s76, v25, v59
    s_mov_b32 s77, 0
    s_mov_b32 s7, 0
F_SLOOP:
    v_subrev_u32 v60, s77, v28
    v_subrev_u32 v61, s77, v29
    v_subrev_u32 v62, s77, v30
    v_subrev_u32 v63, s77, v31
    v_subrev_u32 v64, s77, v32
    v_subrev_u32 v65, s77, v33
    v_subrev_u32 v66, s77, v34
    v_subrev_u32 v67, s77, v35
    v_subrev_u32 v68, s77, v36
    v_subrev_u32 v69, s77, v37
    v_subrev_u32 v70, s77, v38
    v_subrev_u32 v71, s77, v39
    v_subrev_u32 v72, s77, v40
    v_subrev_u32 v73, s77, v41
    v_subrev_u32 v74, s77, v42
    v_subrev_u32 v75, s77, v43
    v_subrev_u32 v76, s77, v44
    v_subrev_u32 v77, s77, v45
    v_subrev_u32 v78, s77, v46
    v_subrev_u32 v79, s77, v47
    v_subrev_u32 v80, s77, v48
    v_subrev_u32 v81, s77, v49
    v_subrev_u32 v82, s77, v50
    v_subrev_u32 v83, s77, v51
    v_subrev_u32 v84, s77, v52
    v_subrev_u32 v85, s77, v53
    v_subrev_u32 v86, s77, v54
    v_subrev_u32 v87, s77, v55
    v_subrev_u32 v88, s77, v56
    v_subrev_u32 v89, s77, v57
    v_subrev_u32 v90, s77, v58
    v_subrev_u32 v91, s77, v59
    v_max_u32 v60, v60, v61
    v_max3_u32 v60, v60, v62, v63
    v_max3_u32 v60, v60, v64, v65
    v_max3_u32 v60, v60, v66, v67
    v_max3_u32 v60, v60, v68, v69
    v_max3_u32 v60, v60, v70, v71
    v_max3_u32 v60, v60, v72, v73
    v_max3_u32 v60, v60, v74, v75
    v_max3_u32 v60, v60, v76, v77
    v_max3_u32 v60, v60, v78, v79
    v_max3_u32 v60, v60, v80, v81
    v_max3_u32 v60, v60, v82, v83
    v_max3_u32 v60, v60, v84, v85
    v_max3_u32 v60, v60, v86, v87
    v_max3_u32 v60, v60, v88, v89
    v_max3_u32 v60, v60, v90, v91
    s_nop 1
    v_max_u32_dpp v60, v60, v60 row_shr:1 row_mask:0xf bank_mask:0xf
    s_nop 1
    v_max_u32_dpp v60, v60, v60 row_shr:2 row_mask:0xf bank_mask:0xf
    s_nop 1
    v_max_u32_dpp v60, v60, v60 row_shr:4 row_mask:0xf bank_mask:0xf
    s_nop 1
    v_max_u32_dpp v60, v60, v60 row_shr:8 row_mask:0xf bank_mask:0xf
    s_nop 1
    v_max_u32_dpp v60, v60, v60 row_bcast:15 row_mask:0xa bank_mask:0xf
    s_nop 1
    v_max_u32_dpp v60, v60, v60 row_bcast:31 row_mask:0xc bank_mask:0xf
    s_nop 0
    v_readlane_b32 s8, v60, 63
    s_add_u32 s77, s77, s8
    s_add_u32 s7, s7, 1
    s_cmp_le_u32 s7, s3
    s_cbranch_scc1 F_SLOOP
    s_mov_b64 exec, 1
    v_mov_b32 v48, s77
    v_mov_b32 v49, v14
    s_lshl_b32 s8, s3, 3
    s_add_u32 s8, s8, s72
    v_mov_b32 v50, s8
    global_store_dwordx2 v50, v[48:49], s[50:51] offset:256
    global_store_dwordx2 v50, v[48:49], s[50:51] offset:384 sc1
    s_branch F_REST
CK_MAIN:
    s_mul_i32 s13, s7, 8704
    s_add_u32 s13, s13, 120832
    s_lshr_b32 s14, s7, 1
    s_mul_i32 s14, s14, 60192
    s_and_b32 s8, s7, 1
    s_lshl_b32 s8, s8, 9
    s_add_u32 s14, s14, s8
    s_lshl_b32 s8, s12, 8
    s_add_u32 m0, s14, s8
    v_mov_b32 v124, 0
    v_mov_b32 v125, 0
    v_mov_b32 v126, 0
    v_mov_b32 v127, 0
    s_lshl_b32 s8, s12, 11
    s_add_u32 s8, s8, s13
    v_lshl_add_u32 v20, v2, 4, s8
    ds_write_b128 v20, v[124:127]
    ds_write_b128 v20, v[124:127] offset:1024
    v_mul_u32_u24 v128, 1056, v3
    v_lshl_add_u32 v128, v4, 4, v128
    v_add_u32 v128, s14, v128
    s_lshl_b32 s8, s3, 2
    s_add_u32 s9, s8, 155680
    v_mov_b32 v129, s9
    s_xor_b32 s8, s8, 16
    s_add_u32 s9, s8, 155680
    v_mov_b32 v130, s9
    v_mov_b32 v21, 0x3c00
    ds_write_addtid_b32 v21 offset:43296
    v_mov_b32 v22, 0x3fb8aa3b
    v_mov_b32 v23, 0x32a57060
    v_mov_b32 v24, 0x3fb8aa3b
    v_mov_b32 v25, 0x3e22f983
    s_mov_b32 s15, 0x7fff7fff
    s_cmp_eq_u32 s12, 0
    s_mov_b32 s73, 0x01000c0c
    s_cselect_b32 s73, s73, 0x03020c0c
    s_waitcnt vmcnt(6)
    v_mul_f32 v19, v18, v22
    v_fma_f32 v22, v18, v22, -v19
    v_exp_f32 v19, v19
    v_fma_f32 v22, v18, v23, v22
    v_mul_f32 v22, 0x3f317218, v22
    v_fma_f32 v19, v19, v22, v19
    v_cvt_pk_bf16_f32 v19, v19, v19
    v_and_b32 v18, 0xffff0000, v19
    v_pk_mul_f32 v[24:25], v[24:25], v[18:19] op_sel_hi:[1,0]
    s_waitcnt vmcnt(0)
    v_and_b32 v14, s15, v30
    v_and_b32 v15, s15, v31
    v_and_b32 v16, s15, v32
    v_and_b32 v17, s15, v33
    v_perm_b32 v8, v28, v28, s73
    v_perm_b32 v9, v29, v29, s73
    v_perm_b32 v10, v30, v30, s73
    v_perm_b32 v11, v31, v31, s73
    v_perm_b32 v12, v32, v32, s73
    v_perm_b32 v13, v33, v33, s73
    v_pk_max_u16 v14, v14, v15
    v_pk_max_u16 v16, v16, v17
    v_lshlrev_b32 v15, 16, v14
    v_lshlrev_b32 v17, 16, v16
    v_pk_mul_f32 v[14:15], v[14:15], v[16:17]
    v_pk_mul_f32 v[8:9], v[8:9], v[24:25]
    v_max_f32 v14, v14, v15
    v_pk_mul_f32 v[10:11], v[10:11], v[18:19] op_sel_hi:[1,0]
    v_mul_f32 v14, v14, v18
    v_pk_mul_f32 v[66:67], v[12:13], v[10:11] op_sel:[1,1] op_sel_hi:[1,0]
    v_pk_fma_f32 v[56:57], v[12:13], v[10:11], v[66:67] op_sel:[0,0,0] op_sel_hi:[0,1,1] neg_lo:[0,0,1]
    v_max_u32_dpp v14, v14, v14 row_shr:1 row_mask:0xf bank_mask:0xf
    v_mul_f32 v60, 0x41000000, v8
    v_mul_f32 v61, 0xc1000000, v9
    v_max_u32_dpp v14, v14, v14 row_shr:2 row_mask:0xf bank_mask:0xf
    v_mul_f32 v62, 0x43000000, v8
    v_mul_f32 v63, 0x43000000, v9
    v_max_u32_dpp v14, v14, v14 row_shr:4 row_mask:0xf bank_mask:0xf
    v_fract_f32 v59, v9
    v_fract_f32 v61, v61
    v_max_u32_dpp v14, v14, v14 row_shr:8 row_mask:0xf bank_mask:0xf
    v_fract_f32 v63, v63
    v_exp_f32 v20, v8
    v_max_u32_dpp v14, v14, v14 row_bcast:15 row_mask:0xa bank_mask:0xf
    v_exp_f32 v22, v60
    v_exp_f32 v26, v62
    v_max_u32_dpp v14, v14, v14 row_bcast:31 row_mask:0xc bank_mask:0xf
    v_cos_f32 v60, v61
    v_readlane_b32 s8, v14, 63
    v_sin_f32 v61, v61
    v_cos_f32 v58, v59
    v_sin_f32 v59, v59
    v_cos_f32 v62, v63
    v_sin_f32 v63, v63
    s_lshr_b32 s8, s8, 23
    s_sub_i32 s8, 258, s8
    s_max_i32 s8, s8, 1
    s_min_i32 s8, s8, 253
    s_lshl_b32 s10, s8, 23
    v_pk_mul_f32 v[60:61], v[60:61], v[22:23] op_sel_hi:[1,0]
    v_pk_mul_f32 v[58:59], v[58:59], v[20:21] op_sel_hi:[1,0]
    v_pk_mul_f32 v[62:63], v[62:63], v[26:27] op_sel_hi:[1,0]
    v_pk_mul_f32 v[56:57], v[56:57], s[10:11] op_sel_hi:[1,0]
    v_cvt_pk_f16_f32 v70, v60, v61
    ds_write_addtid_b32 v70 offset:44352
    v_cvt_pk_f16_f32 v71, v56, v57
    ds_write_addtid_b32 v71 offset:42240
    v_pk_mul_f32 v[66:67], v[56:57], v[58:59] op_sel:[1,1] op_sel_hi:[1,0]
    v_pk_fma_f32 v[40:41], v[56:57], v[58:59], v[66:67] op_sel:[0,0,0] op_sel_hi:[0,1,1] neg_lo:[0,0,1]
    v_cvt_pk_f16_f32 v72, v40, v41
    ds_write_addtid_b32 v72 offset:0
    v_pk_mul_f32 v[66:67], v[40:41], v[58:59] op_sel:[1,1] op_sel_hi:[1,0]
    v_pk_fma_f32 v[42:43], v[40:41], v[58:59], v[66:67] op_sel:[0,0,0] op_sel_hi:[0,1,1] neg_lo:[0,0,1]
    v_cvt_pk_f16_f32 v73, v42, v43
    ds_write_addtid_b32 v73 offset:1056
    v_pk_mul_f32 v[66:67], v[42:43], v[58:59] op_sel:[1,1] op_sel_hi:[1,0]
    v_pk_fma_f32 v[44:45], v[42:43], v[58:59], v[66:67] op_sel:[0,0,0] op_sel_hi:[0,1,1] neg_lo:[0,0,1]
    v_cvt_pk_f16_f32 v70, v44, v45
    ds_write_addtid_b32 v70 offset:2112
    v_pk_mul_f32 v[66:67], v[44:45], v[58:59] op_sel:[1,1] op_sel_hi:[1,0]
    v_pk_fma_f32 v[46:47], v[44:45], v[58:59], v[66:67] op_sel:[0,0,0] op_sel_hi:[0,1,1] neg_lo:[0,0,1]
    v_cvt_pk_f16_f32 v71, v46, v47
    ds_write_addtid_b32 v71 offset:3168
    v_pk_mul_f32 v[66:67], v[46:47], v[58:59] op_sel:[1,1] op_sel_hi:[1,0]
    v_pk_fma_f32 v[48:49], v[46:47], v[58:59], v[66:67] op_sel:[0,0,0] op_sel_hi:[0,1,1] neg_lo:[0,0,1]
    v_cvt_pk_f16_f32 v72, v48, v49
    ds_write_addtid_b32 v72 offset:4224
    v_pk_mul_f32 v[66:67], v[48:49], v[58:59] op_sel:[1,1] op_sel_hi:[1,0]
    v_pk_fma_f32 v[50:51], v[48:49], v[58:59], v[66:67] op_sel:[0,0,0] op_sel_hi:[0,1,1] neg_lo:[0,0,1]
    v_cvt_pk_f16_f32 v73, v50, v51
    ds_write_addtid_b32 v73 offset:5280
    v_pk_mul_f32 v[66:67], v[50:51], v[58:59] op_sel:[1,1] op_sel_hi:[1,0]
    v_pk_fma_f32 v[52:53], v[50:51], v[58:59], v[66:67] op_sel:[0,0,0] op_sel_hi:[0,1,1] neg_lo:[0,0,1]
    v_cvt_pk_f16_f32 v70, v52, v53
    ds_write_addtid_b32 v70 offset:6336
    v_pk_mul_f32 v[66:67], v[52:53], v[58:59] op_sel:[1,1] op_sel_hi:[1,0]
    v_pk_fma_f32 v[54:55], v[52:53], v[58:59], v[66:67] op_sel:[0,0,0] op_sel_hi:[0,1,1] neg_lo:[0,0,1]
    v_cvt_pk_f16_f32 v71, v54, v55
    ds_write_addtid_b32 v71 offset:7392
    v_pk_mul_f32 v[66:67], v[40:41], v[62:63] op_sel:[1,1] op_sel_hi:[1,0]
    v_pk_fma_f32 v[40:41], v[40:41], v[62:63], v[66:67] op_sel:[0,0,0] op_sel_hi:[0,1,1] neg_lo:[0,0,1]
    v_cvt_pk_f16_f32 v72, v40, v41
    ds_write_addtid_b32 v72 offset:8448
    v_pk_mul_f32 v[66:67], v[42:43], v[62:63] op_sel:[1,1] op_sel_hi:[1,0]
    v_pk_fma_f32 v[42:43], v[42:43], v[62:63], v[66:67] op_sel:[0,0,0] op_sel_hi:[0,1,1] neg_lo:[0,0,1]
    v_cvt_pk_f16_f32 v73, v42, v43
    ds_write_addtid_b32 v73 offset:9504
    v_pk_mul_f32 v[66:67], v[44:45], v[62:63] op_sel:[1,1] op_sel_hi:[1,0]
    v_pk_fma_f32 v[44:45], v[44:45], v[62:63], v[66:67] op_sel:[0,0,0] op_sel_hi:[0,1,1] neg_lo:[0,0,1]
    v_cvt_pk_f16_f32 v70, v44, v45
    ds_write_addtid_b32 v70 offset:10560
    v_pk_mul_f32 v[66:67], v[46:47], v[62:63] op_sel:[1,1] op_sel_hi:[1,0]
    v_pk_fma_f32 v[46:47], v[46:47], v[62:63], v[66:67] op_sel:[0,0,0] op_sel_hi:[0,1,1] neg_lo:[0,0,1]
    v_cvt_pk_f16_f32 v71, v46, v47
    ds_write_addtid_b32 v71 offset:11616
    v_pk_mul_f32 v[66:67], v[48:49], v[62:63] op_sel:[1,1] op_sel_hi:[1,0]
    v_pk_fma_f32 v[48:49], v[48:49], v[62:63], v[66:67] op_sel:[0,0,0] op_sel_hi:[0,1,1] neg_lo:[0,0,1]
    v_cvt_pk_f16_f32 v72, v48, v49
    ds_write_addtid_b32 v72 offset:12672
    v_pk_mul_f32 v[66:67], v[50:51], v[62:63] op_sel:[1,1] op_sel_hi:[1,0]
    v_pk_fma_f32 v[50:51], v[50:51], v[62:63], v[66:67] op_sel:[0,0,0] op_sel_hi:[0,1,1] neg_lo:[0,0,1]
    v_cvt_pk_f16_f32 v73, v50, v51
    ds_write_addtid_b32 v73 offset:13728
    v_pk_mul_f32 v[66:67], v[52:53], v[62:63] op_sel:[1,1] op_sel_hi:[1,0]
    v_pk_fma_f32 v[52:53], v[52:53], v[62:63], v[66:67] op_sel:[0,0,0] op_sel_hi:[0,1,1] neg_lo:[0,0,1]
    v_cvt_pk_f16_f32 v70, v52, v53
    ds_write_addtid_b32 v70 offset:14784
    v_pk_mul_f32 v[66:67], v[54:55], v[62:63] op_sel:[1,1] op_sel_hi:[1,0]
    v_pk_fma_f32 v[54:55], v[54:55], v[62:63], v[66:67] op_sel:[0,0,0] op_sel_hi:[0,1,1] neg_lo:[0,0,1]
    v_cvt_pk_f16_f32 v71, v54, v55
    ds_write_addtid_b32 v71 offset:15840
    v_pk_mul_f32 v[66:67], v[42:43], v[62:63] op_sel:[1,1] op_sel_hi:[1,0]
    v_pk_fma_f32 v[42:43], v[42:43], v[62:63], v[66:67] op_sel:[0,0,0] op_sel_hi:[0,1,1] neg_lo:[0,0,1]
    v_cvt_pk_f16_f32 v72, v42, v43
    ds_write_addtid_b32 v72 offset:16896
    v_pk_mul_f32 v[66:67], v[46:47], v[62:63] op_sel:[1,1] op_sel_hi:[1,0]
    v_pk_fma_f32 v[46:47], v[46:47], v[62:63], v[66:67] op_sel:[0,0,0] op_sel_hi:[0,1,1] neg_lo:[0,0,1]
    v_cvt_pk_f16_f32 v73, v46, v47
    ds_write_addtid_b32 v73 offset:17952
    v_pk_mul_f32 v[66:67], v[50:51], v[62:63] op_sel:[1,1] op_sel_hi:[1,0]
    v_pk_fma_f32 v[50:51], v[50:51], v[62:63], v[66:67] op_sel:[0,0,0] op_sel_hi:[0,1,1] neg_lo:[0,0,1]
    v_cvt_pk_f16_f32 v70, v50, v51
    ds_write_addtid_b32 v70 offset:19008
    v_pk_mul_f32 v[66:67], v[54:55], v[62:63] op_sel:[1,1] op_sel_hi:[1,0]
    v_pk_fma_f32 v[54:55], v[54:55], v[62:63], v[66:67] op_sel:[0,0,0] op_sel_hi:[0,1,1] neg_lo:[0,0,1]
    v_cvt_pk_f16_f32 v71, v54, v55
    ds_write_addtid_b32 v71 offset:20064
    v_pk_mul_f32 v[66:67], v[42:43], v[62:63] op_sel:[1,1] op_sel_hi:[1,0]
    v_pk_fma_f32 v[42:43], v[42:43], v[62:63], v[66:67] op_sel:[0,0,0] op_sel_hi:[0,1,1] neg_lo:[0,0,1]
    v_cvt_pk_f16_f32 v72, v42, v43
    ds_write_addtid_b32 v72 offset:21120
    v_pk_mul_f32 v[66:67], v[46:47], v[62:63] op_sel:[1,1] op_sel_hi:[1,0]
    v_pk_fma_f32 v[46:47], v[46:47], v[62:63], v[66:67] op_sel:[0,0,0] op_sel_hi:[0,1,1] neg_lo:[0,0,1]
    v_cvt_pk_f16_f32 v73, v46, v47
    ds_write_addtid_b32 v73 offset:22176
    v_pk_mul_f32 v[66:67], v[50:51], v[62:63] op_sel:[1,1] op_sel_hi:[1,0]
    v_pk_fma_f32 v[50:51], v[50:51], v[62:63], v[66:67] op_sel:[0,0,0] op_sel_hi:[0,1,1] neg_lo:[0,0,1]
    v_cvt_pk_f16_f32 v70, v50, v51
    ds_write_addtid_b32 v70 offset:23232
    v_pk_mul_f32 v[66:67], v[54:55], v[62:63] op_sel:[1,1] op_sel_hi:[1,0]
    v_pk_fma_f32 v[54:55], v[54:55], v[62:63], v[66:67] op_sel:[0,0,0] op_sel_hi:[0,1,1] neg_lo:[0,0,1]
    v_cvt_pk_f16_f32 v71, v54, v55
    ds_write_addtid_b32 v71 offset:24288
    v_pk_mul_f32 v[66:67], v[46:47], v[62:63] op_sel:[1,1] op_sel_hi:[1,0]
    v_pk_fma_f32 v[46:47], v[46:47], v[62:63], v[66:67] op_sel:[0,0,0] op_sel_hi:[0,1,1] neg_lo:[0,0,1]
    v_cvt_pk_f16_f32 v72, v46, v47
    ds_write_addtid_b32 v72 offset:25344
    v_pk_mul_f32 v[66:67], v[54:55], v[62:63] op_sel:[1,1] op_sel_hi:[1,0]
    v_pk_fma_f32 v[54:55], v[54:55], v[62:63], v[66:67] op_sel:[0,0,0] op_sel_hi:[0,1,1] neg_lo:[0,0,1]
    v_cvt_pk_f16_f32 v73, v54, v55
    ds_write_addtid_b32 v73 offset:26400
    v_pk_mul_f32 v[66:67], v[46:47], v[62:63] op_sel:[1,1] op_sel_hi:[1,0]
    v_pk_fma_f32 v[46:47], v[46:47], v[62:63], v[66:67] op_sel:[0,0,0] op_sel_hi:[0,1,1] neg_lo:[0,0,1]
    v_cvt_pk_f16_f32 v70, v46, v47
    ds_write_addtid_b32 v70 offset:27456
    v_pk_mul_f32 v[66:67], v[54:55], v[62:63] op_sel:[1,1] op_sel_hi:[1,0]
    v_pk_fma_f32 v[54:55], v[54:55], v[62:63], v[66:67] op_sel:[0,0,0] op_sel_hi:[0,1,1] neg_lo:[0,0,1]
    v_cvt_pk_f16_f32 v71, v54, v55
    ds_write_addtid_b32 v71 offset:28512
    v_pk_mul_f32 v[66:67], v[46:47], v[62:63] op_sel:[1,1] op_sel_hi:[1,0]
    v_pk_fma_f32 v[46:47], v[46:47], v[62:63], v[66:67] op_sel:[0,0,0] op_sel_hi:[0,1,1] neg_lo:[0,0,1]
    v_cvt_pk_f16_f32 v72, v46, v47
    ds_write_addtid_b32 v72 offset:29568
    v_pk_mul_f32 v[66:67], v[54:55], v[62:63] op_sel:[1,1] op_sel_hi:[1,0]
    v_pk_fma_f32 v[54:55], v[54:55], v[62:63], v[66:67] op_sel:[0,0,0] op_sel_hi:[0,1,1] neg_lo:[0,0,1]
    v_cvt_pk_f16_f32 v73, v54, v55
    ds_write_addtid_b32 v73 offset:30624
    v_pk_mul_f32 v[66:67], v[46:47], v[62:63] op_sel:[1,1] op_sel_hi:[1,0]
    v_pk_fma_f32 v[46:47], v[46:47], v[62:63], v[66:67] op_sel:[0,0,0] op_sel_hi:[0,1,1] neg_lo:[0,0,1]
    v_cvt_pk_f16_f32 v70, v46, v47
    ds_write_addtid_b32 v70 offset:31680
    v_pk_mul_f32 v[66:67], v[54:55], v[62:63] op_sel:[1,1] op_sel_hi:[1,0]
    v_pk_fma_f32 v[54:55], v[54:55], v[62:63], v[66:67] op_sel:[0,0,0] op_sel_hi:[0,1,1] neg_lo:[0,0,1]
    v_cvt_pk_f16_f32 v71, v54, v55
    ds_write_addtid_b32 v71 offset:32736
    v_pk_mul_f32 v[66:67], v[54:55], v[62:63] op_sel:[1,1] op_sel_hi:[1,0]
    v_pk_fma_f32 v[54:55], v[54:55], v[62:63], v[66:67] op_sel:[0,0,0] op_sel_hi:[0,1,1] neg_lo:[0,0,1]
    v_cvt_pk_f16_f32 v72, v54, v55
    ds_write_addtid_b32 v72 offset:33792
    v_pk_mul_f32 v[66:67], v[54:55], v[62:63] op_sel:[1,1] op_sel_hi:[1,0]
    v_pk_fma_f32 v[54:55], v[54:55], v[62:63], v[66:67] op_sel:[0,0,0] op_sel_hi:[0,1,1] neg_lo:[0,0,1]
    v_cvt_pk_f16_f32 v73, v54, v55
    ds_write_addtid_b32 v73 offset:34848
    v_pk_mul_f32 v[66:67], v[54:55], v[62:63] op_sel:[1,1] op_sel_hi:[1,0]
    v_pk_fma_f32 v[54:55], v[54:55], v[62:63], v[66:67] op_sel:[0,0,0] op_sel_hi:[0,1,1] neg_lo:[0,0,1]
    v_cvt_pk_f16_f32 v70, v54, v55
    ds_write_addtid_b32 v70 offset:35904
    v_pk_mul_f32 v[66:67], v[54:55], v[62:63] op_sel:[1,1] op_sel_hi:[1,0]
    v_pk_fma_f32 v[54:55], v[54:55], v[62:63], v[66:67] op_sel:[0,0,0] op_sel_hi:[0,1,1] neg_lo:[0,0,1]
    v_cvt_pk_f16_f32 v71, v54, v55
    ds_write_addtid_b32 v71 offset:36960
    v_pk_mul_f32 v[66:67], v[54:55], v[62:63] op_sel:[1,1] op_sel_hi:[1,0]
    v_pk_fma_f32 v[54:55], v[54:55], v[62:63], v[66:67] op_sel:[0,0,0] op_sel_hi:[0,1,1] neg_lo:[0,0,1]
    v_cvt_pk_f16_f32 v72, v54, v55
    ds_write_addtid_b32 v72 offset:38016
    v_pk_mul_f32 v[66:67], v[54:55], v[62:63] op_sel:[1,1] op_sel_hi:[1,0]
    v_pk_fma_f32 v[54:55], v[54:55], v[62:63], v[66:67] op_sel:[0,0,0] op_sel_hi:[0,1,1] neg_lo:[0,0,1]
    v_cvt_pk_f16_f32 v73, v54, v55
    ds_write_addtid_b32 v73 offset:39072
    v_pk_mul_f32 v[66:67], v[54:55], v[62:63] op_sel:[1,1] op_sel_hi:[1,0]
    v_pk_fma_f32 v[54:55], v[54:55], v[62:63], v[66:67] op_sel:[0,0,0] op_sel_hi:[0,1,1] neg_lo:[0,0,1]
    v_cvt_pk_f16_f32 v70, v54, v55
    ds_write_addtid_b32 v70 offset:40128
    v_pk_mul_f32 v[66:67], v[54:55], v[62:63] op_sel:[1,1] op_sel_hi:[1,0]
    v_pk_fma_f32 v[54:55], v[54:55], v[62:63], v[66:67] op_sel:[0,0,0] op_sel_hi:[0,1,1] neg_lo:[0,0,1]
    v_cvt_pk_f16_f32 v71, v54, v55
    ds_write_addtid_b32 v71 offset:41184
    v_pk_mul_f32 v[66:67], v[60:61], v[60:61] op_sel:[1,1] op_sel_hi:[1,0]
    v_pk_fma_f32 v[64:65], v[60:61], v[60:61], v[66:67] op_sel:[0,0,0] op_sel_hi:[0,1,1] neg_lo:[0,0,1]
    v_cvt_pk_f16_f32 v72, v64, v65
    ds_write_addtid_b32 v72 offset:45408
    v_pk_mul_f32 v[66:67], v[64:65], v[60:61] op_sel:[1,1] op_sel_hi:[1,0]
    v_pk_fma_f32 v[64:65], v[64:65], v[60:61], v[66:67] op_sel:[0,0,0] op_sel_hi:[0,1,1] neg_lo:[0,0,1]
    v_cvt_pk_f16_f32 v73, v64, v65
    ds_write_addtid_b32 v73 offset:46464
    v_pk_mul_f32 v[66:67], v[64:65], v[60:61] op_sel:[1,1] op_sel_hi:[1,0]
    v_pk_fma_f32 v[64:65], v[64:65], v[60:61], v[66:67] op_sel:[0,0,0] op_sel_hi:[0,1,1] neg_lo:[0,0,1]
    v_cvt_pk_f16_f32 v70, v64, v65
    ds_write_addtid_b32 v70 offset:47520
    v_pk_mul_f32 v[66:67], v[64:65], v[60:61] op_sel:[1,1] op_sel_hi:[1,0]
    v_pk_fma_f32 v[64:65], v[64:65], v[60:61], v[66:67] op_sel:[0,0,0] op_sel_hi:[0,1,1] neg_lo:[0,0,1]
    v_cvt_pk_f16_f32 v71, v64, v65
    ds_write_addtid_b32 v71 offset:48576
    v_pk_mul_f32 v[66:67], v[64:65], v[60:61] op_sel:[1,1] op_sel_hi:[1,0]
    v_pk_fma_f32 v[64:65], v[64:65], v[60:61], v[66:67] op_sel:[0,0,0] op_sel_hi:[0,1,1] neg_lo:[0,0,1]
    v_cvt_pk_f16_f32 v72, v64, v65
    ds_write_addtid_b32 v72 offset:49632
    v_pk_mul_f32 v[66:67], v[64:65], v[60:61] op_sel:[1,1] op_sel_hi:[1,0]
    v_pk_fma_f32 v[64:65], v[64:65], v[60:61], v[66:67] op_sel:[0,0,0] op_sel_hi:[0,1,1] neg_lo:[0,0,1]
    v_cvt_pk_f16_f32 v73, v64, v65
    ds_write_addtid_b32 v73 offset:50688
    v_pk_mul_f32 v[66:67], v[64:65], v[60:61] op_sel:[1,1] op_sel_hi:[1,0]
    v_pk_fma_f32 v[64:65], v[64:65], v[60:61], v[66:67] op_sel:[0,0,0] op_sel_hi:[0,1,1] neg_lo:[0,0,1]
    v_cvt_pk_f16_f32 v70, v64, v65
    ds_write_addtid_b32 v70 offset:51744
    v_pk_mul_f32 v[66:67], v[64:65], v[60:61] op_sel:[1,1] op_sel_hi:[1,0]
    v_pk_fma_f32 v[64:65], v[64:65], v[60:61], v[66:67] op_sel:[0,0,0] op_sel_hi:[0,1,1] neg_lo:[0,0,1]
    v_cvt_pk_f16_f32 v71, v64, v65
    ds_write_addtid_b32 v71 offset:52800
    v_pk_mul_f32 v[66:67], v[64:65], v[60:61] op_sel:[1,1] op_sel_hi:[1,0]
    v_pk_fma_f32 v[64:65], v[64:65], v[60:61], v[66:67] op_sel:[0,0,0] op_sel_hi:[0,1,1] neg_lo:[0,0,1]
    v_cvt_pk_f16_f32 v72, v64, v65
    ds_write_addtid_b32 v72 offset:53856
    v_pk_mul_f32 v[66:67], v[64:65], v[60:61] op_sel:[1,1] op_sel_hi:[1,0]
    v_pk_fma_f32 v[64:65], v[64:65], v[60:61], v[66:67] op_sel:[0,0,0] op_sel_hi:[0,1,1] neg_lo:[0,0,1]
    v_cvt_pk_f16_f32 v73, v64, v65
    ds_write_addtid_b32 v73 offset:54912
    v_pk_mul_f32 v[66:67], v[64:65], v[60:61] op_sel:[1,1] op_sel_hi:[1,0]
    v_pk_fma_f32 v[64:65], v[64:65], v[60:61], v[66:67] op_sel:[0,0,0] op_sel_hi:[0,1,1] neg_lo:[0,0,1]
    v_cvt_pk_f16_f32 v70, v64, v65
    ds_write_addtid_b32 v70 offset:55968
    v_pk_mul_f32 v[66:67], v[64:65], v[60:61] op_sel:[1,1] op_sel_hi:[1,0]
    v_pk_fma_f32 v[64:65], v[64:65], v[60:61], v[66:67] op_sel:[0,0,0] op_sel_hi:[0,1,1] neg_lo:[0,0,1]
    v_cvt_pk_f16_f32 v71, v64, v65
    ds_write_addtid_b32 v71 offset:57024
    v_pk_mul_f32 v[66:67], v[64:65], v[60:61] op_sel:[1,1] op_sel_hi:[1,0]
    v_pk_fma_f32 v[64:65], v[64:65], v[60:61], v[66:67] op_sel:[0,0,0] op_sel_hi:[0,1,1] neg_lo:[0,0,1]
    v_cvt_pk_f16_f32 v72, v64, v65
    ds_write_addtid_b32 v72 offset:58080
    v_pk_mul_f32 v[66:67], v[64:65], v[60:61] op_sel:[1,1] op_sel_hi:[1,0]
    v_pk_fma_f32 v[64:65], v[64:65], v[60:61], v[66:67] op_sel:[0,0,0] op_sel_hi:[0,1,1] neg_lo:[0,0,1]
    v_cvt_pk_f16_f32 v73, v64, v65
    ds_write_addtid_b32 v73 offset:59136
CK_SKIP:
    ds_write_b32 v129, v129
    s_mov_b32 s9, 0
CK_PAIR:
    ds_read_b32 v8, v130
    s_add_u32 s9, s9, 1
    s_waitcnt lgkmcnt(0)
    v_cmp_eq_u32 vcc, 0, v8
    s_cmp_ge_u32 s9, 0x40000
    s_cbranch_scc1 CK_PAIRED
    s_cbranch_vccnz CK_PAIR
CK_PAIRED:
    s_cmp_eq_u32 s12, 0
    s_cbranch_scc0 CK_T1
    ds_read_b128 v[8:11], v128 offset:43296
    ds_read_b128 v[40:43], v128 offset:0
    ds_read_b128 v[12:15], v128 offset:43360
    ds_read_b128 v[44:47], v128 offset:64
    ds_read_b128 v[16:19], v128 offset:43424
    ds_read_b128 v[48:51], v128 offset:128
    ds_read_b128 v[20:23], v128 offset:43488
    ds_read_b128 v[52:55], v128 offset:192
    s_lshl_b32 s9, s7, 2
    s_add_u32 s9, s9, 155664
    v_mov_b32 v112, s9
    v_mov_b32 v113, s8
    ds_read_b128 v[24:27], v128 offset:43552
    ds_read_b128 v[56:59], v128 offset:256
    ds_read_b128 v[28:31], v128 offset:43616
    ds_read_b128 v[60:63], v128 offset:320
    ds_read_b128 v[32:35], v128 offset:43680
    ds_read_b128 v[64:67], v128 offset:384
    ds_read_b128 v[36:39], v128 offset:43744
    ds_read_b128 v[68:71], v128 offset:448
    v_lshrrev_b32 v114, 1, v4
    v_lshlrev_b32 v114, 8, v114
    v_lshl_add_u32 v114, v3, 4, v114
    v_and_b32 v115, 1, v4
    v_lshl_add_u32 v114, v115, 3, v114
    v_add_u32 v114, s13, v114
    v_lshlrev_b32 v115, 5, v3
    v_lshl_add_u32 v115, v4, 3, v115
    v_add_u32 v115, s13, v115
    v_mov_b32 v116, s13
    s_waitcnt lgkmcnt(14)
    v_mfma_f32_16x16x32_f16 v[104:107], v[40:43], v[8:11], 0
    ds_read_b128 v[72:75], v128 offset:33792
    s_waitcnt lgkmcnt(13)
    v_mfma_f32_16x16x32_f16 v[104:107], v[44:47], v[12:15], v[104:107]
    ds_read_b128 v[76:79], v128 offset:33856
    s_waitcnt lgkmcnt(12)
    v_mfma_f32_16x16x32_f16 v[104:107], v[48:51], v[16:19], v[104:107]
    ds_read_b128 v[80:83], v128 offset:33920
    s_waitcnt lgkmcnt(11)
    v_mfma_f32_16x16x32_f16 v[104:107], v[52:55], v[20:23], v[104:107]
    ds_read_b128 v[84:87], v128 offset:33984
    s_waitcnt lgkmcnt(10)
    v_mfma_f32_16x16x32_f16 v[104:107], v[56:59], v[24:27], v[104:107]
    ds_read_b128 v[88:91], v128 offset:34048
    s_waitcnt lgkmcnt(9)
    v_mfma_f32_16x16x32_f16 v[104:107], v[60:63], v[28:31], v[104:107]
    ds_read_b128 v[92:95], v128 offset:34112
    s_waitcnt lgkmcnt(8)
    v_mfma_f32_16x16x32_f16 v[104:107], v[64:67], v[32:35], v[104:107]
    ds_read_b128 v[96:99], v128 offset:34176
    s_waitcnt lgkmcnt(7)
    v_mfma_f32_16x16x32_f16 v[104:107], v[68:71], v[36:39], v[104:107]
    ds_read_b128 v[100:103], v128 offset:34240
    s_waitcnt lgkmcnt(7)
    v_mfma_f32_16x16x32_f16 v[108:111], v[8:11], v[72:75], 0
    s_waitcnt lgkmcnt(6)
    v_mfma_f32_16x16x32_f16 v[108:111], v[12:15], v[76:79], v[108:111]
    s_waitcnt lgkmcnt(5)
    v_mfma_f32_16x16x32_f16 v[108:111], v[16:19], v[80:83], v[108:111]
    s_waitcnt lgkmcnt(4)
    v_mfma_f32_16x16x32_f16 v[108:111], v[20:23], v[84:87], v[108:111]
    s_waitcnt lgkmcnt(3)
    v_mfma_f32_16x16x32_f16 v[108:111], v[24:27], v[88:91], v[108:111]
    s_waitcnt lgkmcnt(2)
    v_mfma_f32_16x16x32_f16 v[108:111], v[28:31], v[92:95], v[108:111]
    s_waitcnt lgkmcnt(1)
    v_mfma_f32_16x16x32_f16 v[108:111], v[32:35], v[96:99], v[108:111]
    s_waitcnt lgkmcnt(0)
    v_mfma_f32_16x16x32_f16 v[108:111], v[36:39], v[100:103], v[108:111]
    ds_write_b32 v112, v113
    v_cvt_pk_f16_f32 v118, v104, v105
    v_cvt_pk_f16_f32 v119, v106, v107
    v_cvt_pk_f16_f32 v120, v105, v106
    v_cvt_pk_f16_f32 v121, v107, v107
    ds_write_b16 v114, v121 offset:1256
    ds_write_b64 v114, v[120:121] offset:32
    ds_write_b64 v114, v[118:119] offset:1248
    ds_write_b16 v114, v118 offset:30
    v_cvt_pk_f16_f32 v118, v108, v109
    v_cvt_pk_f16_f32 v119, v110, v111
    s_mov_b32 s10, 0x00ff00ff
    s_mov_b32 s11, 0x00ff00ff
    s_mov_b64 exec, s[10:11]
    ds_write_b64 v115, v[118:119] offset:2912
    s_mov_b64 exec, 0x100
    ds_write_b16 v116, v118 offset:28
    ds_write_b16 v116, v118 offset:1246
    s_mov_b64 exec, -1
    v_mov_b32 v127, 155648
    v_mov_b32 v126, 1
    s_mov_b64 exec, 1
    ds_add_u32 v127, v126 offset:76
    s_mov_b64 exec, -1
    v_mul_u32_u24 v124, 320, v4
    v_lshl_add_u32 v124, v3, 4, v124
    s_mul_i32 s8, s7, 20480
    v_add_u32 v124, s8, v124
    s_lshl_b32 s8, s3, 2
    s_add_u32 s8, s8, 155904
    v_mov_b32 v125, s8
    v_and_b32 v5, 1, v3
    v_mul_u32_u24 v5, 1216, v5
    v_sub_u32 v5, 1264, v5
    v_lshrrev_b32 v6, 1, v3
    v_lshl_add_u32 v5, v6, 2, v5
    v_lshlrev_b32 v6, 4, v4
    v_sub_u32 v5, v5, v6
    v_add_u32 v5, s13, v5
    v_add_u32 v7, 576, v5
    v_lshl_add_u32 v6, v3, 5, v6
    v_add_u32 v6, 3616, v6
    v_add_u32 v6, s13, v6
    s_mov_b32 s9, 0
SPN1:
    ds_read_b32 v128, v127 offset:76
    s_add_u32 s9, s9, 1
    s_waitcnt lgkmcnt(0)
    v_cmp_ne_u32 vcc, 8, v128
    s_cmp_ge_u32 s9, 0x40000
    s_cbranch_scc1 SPX1
    s_cbranch_vccz SPX1
    s_sleep 1
    s_branch SPN1
SPX1:
    ds_read2_b32 v[36:37], v5 offset0:115 offset1:114
    ds_read2_b32 v[38:39], v5 offset0:113 offset1:112
    ds_read2_b32 v[32:33], v5 offset0:99 offset1:98
    ds_read2_b32 v[34:35], v5 offset0:97 offset1:96
    ds_read2_b32 v[28:29], v5 offset0:83 offset1:82
    ds_read2_b32 v[30:31], v5 offset0:81 offset1:80
    ds_read2_b32 v[24:25], v5 offset0:67 offset1:66
    ds_read2_b32 v[26:27], v5 offset0:65 offset1:64
    ds_read2_b32 v[20:21], v5 offset0:51 offset1:50
    ds_read2_b32 v[22:23], v5 offset0:49 offset1:48
    ds_read2_b32 v[16:17], v5 offset0:35 offset1:34
    ds_read2_b32 v[18:19], v5 offset0:33 offset1:32
    ds_read2_b32 v[12:13], v5 offset0:19 offset1:18
    ds_read2_b32 v[14:15], v5 offset0:17 offset1:16
    ds_read2_b32 v[8:9], v5 offset0:3 offset1:2
    ds_read2_b32 v[10:11], v5 offset0:1 offset1:0
    ds_read2_b32 v[68:69], v7 offset0:99 offset1:98
    ds_read2_b32 v[70:71], v7 offset0:97 offset1:96
    ds_read2_b32 v[64:65], v7 offset0:83 offset1:82
    ds_read2_b32 v[66:67], v7 offset0:81 offset1:80
    ds_read2_b32 v[60:61], v7 offset0:67 offset1:66
    ds_read2_b32 v[62:63], v7 offset0:65 offset1:64
    ds_read2_b32 v[56:57], v7 offset0:51 offset1:50
    ds_read2_b32 v[58:59], v7 offset0:49 offset1:48
    ds_read2_b32 v[52:53], v7 offset0:35 offset1:34
    ds_read2_b32 v[54:55], v7 offset0:33 offset1:32
    ds_read2_b32 v[48:49], v7 offset0:19 offset1:18
    ds_read2_b32 v[50:51], v7 offset0:17 offset1:16
    ds_read2_b32 v[44:45], v7 offset0:3 offset1:2
    ds_read2_b32 v[46:47], v7 offset0:1 offset1:0
    ds_read2_b32 v[40:41], v5 offset0:131 offset1:130
    ds_read2_b32 v[42:43], v5 offset0:129 offset1:128
    ds_read2_b32 v[72:73], v7 offset0:115 offset1:114
    ds_read2_b32 v[74:75], v7 offset0:113 offset1:112
    s_mov_b32 s9, 0
SPN2:
    ds_read_b32 v128, v127 offset:72
    s_add_u32 s9, s9, 1
    s_waitcnt lgkmcnt(0)
    v_cmp_gt_u32 vcc, 2, v128
    s_cmp_ge_u32 s9, 0x40000
    s_cbranch_scc1 SPX2
    s_cbranch_vccz SPX2
    s_sleep 1
    s_branch SPN2
SPX2:
D_LOOP:
    ds_read_b128 v[80:83], v6 offset:0
    ds_read_b128 v[84:87], v6 offset:64
    ds_read_b128 v[88:91], v6 offset:128
    ds_read_b128 v[92:95], v6 offset:192
    ds_read_b128 v[96:99], v6 offset:256
    ds_read_b128 v[100:103], v6 offset:320
    ds_read_b128 v[104:107], v6 offset:384
    s_waitcnt lgkmcnt(6)
    v_mfma_f32_16x16x32_f16 v[108:111], v[36:39], v[80:83], 0
    v_mfma_f32_16x16x32_f16 v[112:115], v[68:71], v[80:83], 0
    ds_read_b128 v[76:79], v6 offset:448
    s_waitcnt lgkmcnt(6)
    v_mfma_f32_16x16x32_f16 v[108:111], v[32:35], v[84:87], v[108:111]
    v_mfma_f32_16x16x32_f16 v[112:115], v[64:67], v[84:87], v[112:115]
    ds_read_b128 v[80:83], v6 offset:512
    s_waitcnt lgkmcnt(6)
    v_mfma_f32_16x16x32_f16 v[108:111], v[28:31], v[88:91], v[108:111]
    v_mfma_f32_16x16x32_f16 v[112:115], v[60:63], v[88:91], v[112:115]
    ds_read_b128 v[84:87], v6 offset:576
    s_waitcnt lgkmcnt(6)
    v_mfma_f32_16x16x32_f16 v[108:111], v[24:27], v[92:95], v[108:111]
    v_mfma_f32_16x16x32_f16 v[112:115], v[56:59], v[92:95], v[112:115]
    ds_read_b128 v[88:91], v6 offset:640
    s_waitcnt lgkmcnt(6)
    v_mfma_f32_16x16x32_f16 v[108:111], v[20:23], v[96:99], v[108:111]
    v_mfma_f32_16x16x32_f16 v[112:115], v[52:55], v[96:99], v[112:115]
    ds_read_b128 v[92:95], v6 offset:704
    s_waitcnt lgkmcnt(6)
    v_mfma_f32_16x16x32_f16 v[108:111], v[16:19], v[100:103], v[108:111]
    v_mfma_f32_16x16x32_f16 v[112:115], v[48:51], v[100:103], v[112:115]
    ds_read_b128 v[96:99], v6 offset:768
    s_waitcnt lgkmcnt(6)
    v_mfma_f32_16x16x32_f16 v[108:111], v[12:15], v[104:107], v[108:111]
    v_mfma_f32_16x16x32_f16 v[112:115], v[44:47], v[104:107], v[112:115]
    ds_read_b128 v[100:103], v6 offset:832
    s_waitcnt lgkmcnt(6)
    v_mfma_f32_16x16x32_f16 v[108:111], v[8:11], v[76:79], v[108:111]
    v_mfma_f32_16x16x32_f16 v[112:115], v[40:43], v[76:79], v[112:115]
    v_mfma_f32_16x16x32_f16 v[116:119], v[72:75], v[76:79], 0
    ds_read_b128 v[104:107], v6 offset:896
    s_waitcnt lgkmcnt(6)
    v_mfma_f32_16x16x32_f16 v[112:115], v[36:39], v[80:83], v[112:115]
    v_mfma_f32_16x16x32_f16 v[116:119], v[68:71], v[80:83], v[116:119]
    ds_read_b128 v[76:79], v6 offset:960
    s_waitcnt lgkmcnt(6)
    v_mfma_f32_16x16x32_f16 v[112:115], v[32:35], v[84:87], v[112:115]
    v_mfma_f32_16x16x32_f16 v[116:119], v[64:67], v[84:87], v[116:119]
    ds_read_b128 v[80:83], v6 offset:1024
    s_waitcnt lgkmcnt(6)
    v_mfma_f32_16x16x32_f16 v[112:115], v[28:31], v[88:91], v[112:115]
    ds_write_b64 v124, v[108:109] offset:0
    v_mfma_f32_16x16x32_f16 v[116:119], v[60:63], v[88:91], v[116:119]
    ds_read_b128 v[84:87], v6 offset:1088
    s_waitcnt lgkmcnt(7)
    v_mfma_f32_16x16x32_f16 v[112:115], v[24:27], v[92:95], v[112:115]
    ds_write_b64 v124, v[110:111] offset:8
    v_mfma_f32_16x16x32_f16 v[116:119], v[56:59], v[92:95], v[116:119]
    ds_read_b128 v[88:91], v6 offset:1152
    s_waitcnt lgkmcnt(8)
    v_mfma_f32_16x16x32_f16 v[112:115], v[20:23], v[96:99], v[112:115]
    ds_write_b32 v125, v126 offset:0
    v_mfma_f32_16x16x32_f16 v[116:119], v[52:55], v[96:99], v[116:119]
    ds_read_b128 v[92:95], v6 offset:1216
    s_waitcnt lgkmcnt(9)
    v_mfma_f32_16x16x32_f16 v[112:115], v[16:19], v[100:103], v[112:115]
    v_mfma_f32_16x16x32_f16 v[116:119], v[48:51], v[100:103], v[116:119]
    ds_read_b128 v[96:99], v6 offset:1280
    s_waitcnt lgkmcnt(9)
    v_mfma_f32_16x16x32_f16 v[112:115], v[12:15], v[104:107], v[112:115]
    v_mfma_f32_16x16x32_f16 v[116:119], v[44:47], v[104:107], v[116:119]
    ds_read_b128 v[100:103], v6 offset:1344
    s_waitcnt lgkmcnt(9)
    v_mfma_f32_16x16x32_f16 v[112:115], v[8:11], v[76:79], v[112:115]
    v_mfma_f32_16x16x32_f16 v[116:119], v[40:43], v[76:79], v[116:119]
    v_mfma_f32_16x16x32_f16 v[120:123], v[72:75], v[76:79], 0
    ds_read_b128 v[104:107], v6 offset:1408
    s_waitcnt lgkmcnt(9)
    v_mfma_f32_16x16x32_f16 v[116:119], v[36:39], v[80:83], v[116:119]
    v_mfma_f32_16x16x32_f16 v[120:123], v[68:71], v[80:83], v[120:123]
    ds_read_b128 v[76:79], v6 offset:1472
    s_waitcnt lgkmcnt(8)
    v_mfma_f32_16x16x32_f16 v[116:119], v[32:35], v[84:87], v[116:119]
    v_mfma_f32_16x16x32_f16 v[120:123], v[64:67], v[84:87], v[120:123]
    ds_read_b128 v[80:83], v6 offset:1536
    s_waitcnt lgkmcnt(7)
    v_mfma_f32_16x16x32_f16 v[116:119], v[28:31], v[88:91], v[116:119]
    ds_write_b64 v124, v[112:113] offset:1280
    v_mfma_f32_16x16x32_f16 v[120:123], v[60:63], v[88:91], v[120:123]
    ds_read_b128 v[84:87], v6 offset:1600
    s_waitcnt lgkmcnt(7)
    v_mfma_f32_16x16x32_f16 v[116:119], v[24:27], v[92:95], v[116:119]
    ds_write_b64 v124, v[114:115] offset:1288
    v_mfma_f32_16x16x32_f16 v[120:123], v[56:59], v[92:95], v[120:123]
    ds_read_b128 v[88:91], v6 offset:1664
    s_waitcnt lgkmcnt(8)
    v_mfma_f32_16x16x32_f16 v[116:119], v[20:23], v[96:99], v[116:119]
    ds_write_b32 v125, v126 offset:32
    v_mfma_f32_16x16x32_f16 v[120:123], v[52:55], v[96:99], v[120:123]
    ds_read_b128 v[92:95], v6 offset:1728
    s_waitcnt lgkmcnt(9)
    v_mfma_f32_16x16x32_f16 v[116:119], v[16:19], v[100:103], v[116:119]
    v_mfma_f32_16x16x32_f16 v[120:123], v[48:51], v[100:103], v[120:123]
    ds_read_b128 v[96:99], v6 offset:1792
    s_waitcnt lgkmcnt(9)
    v_mfma_f32_16x16x32_f16 v[116:119], v[12:15], v[104:107], v[116:119]
    v_mfma_f32_16x16x32_f16 v[120:123], v[44:47], v[104:107], v[120:123]
    ds_read_b128 v[100:103], v6 offset:1856
    s_waitcnt lgkmcnt(9)
    v_mfma_f32_16x16x32_f16 v[116:119], v[8:11], v[76:79], v[116:119]
    v_mfma_f32_16x16x32_f16 v[120:123], v[40:43], v[76:79], v[120:123]
    v_mfma_f32_16x16x32_f16 v[108:111], v[72:75], v[76:79], 0
    ds_read_b128 v[104:107], v6 offset:1920
    s_waitcnt lgkmcnt(9)
    v_mfma_f32_16x16x32_f16 v[120:123], v[36:39], v[80:83], v[120:123]
    v_mfma_f32_16x16x32_f16 v[108:111], v[68:71], v[80:83], v[108:111]
    ds_read_b128 v[76:79], v6 offset:1984
    s_waitcnt lgkmcnt(8)
    v_mfma_f32_16x16x32_f16 v[120:123], v[32:35], v[84:87], v[120:123]
    v_mfma_f32_16x16x32_f16 v[108:111], v[64:67], v[84:87], v[108:111]
    s_waitcnt lgkmcnt(6)
    v_mfma_f32_16x16x32_f16 v[120:123], v[28:31], v[88:91], v[120:123]
    ds_write_b64 v124, v[116:117] offset:2560
    v_mfma_f32_16x16x32_f16 v[108:111], v[60:63], v[88:91], v[108:111]
    s_waitcnt lgkmcnt(5)
    v_mfma_f32_16x16x32_f16 v[120:123], v[24:27], v[92:95], v[120:123]
    ds_write_b64 v124, v[118:119] offset:2568
    v_mfma_f32_16x16x32_f16 v[108:111], v[56:59], v[92:95], v[108:111]
    s_waitcnt lgkmcnt(5)
    v_mfma_f32_16x16x32_f16 v[120:123], v[20:23], v[96:99], v[120:123]
    ds_write_b32 v125, v126 offset:64
    v_mfma_f32_16x16x32_f16 v[108:111], v[52:55], v[96:99], v[108:111]
    s_waitcnt lgkmcnt(5)
    v_mfma_f32_16x16x32_f16 v[120:123], v[16:19], v[100:103], v[120:123]
    v_mfma_f32_16x16x32_f16 v[108:111], v[48:51], v[100:103], v[108:111]
    s_waitcnt lgkmcnt(4)
    v_mfma_f32_16x16x32_f16 v[120:123], v[12:15], v[104:107], v[120:123]
    v_mfma_f32_16x16x32_f16 v[108:111], v[44:47], v[104:107], v[108:111]
    s_waitcnt lgkmcnt(3)
    v_mfma_f32_16x16x32_f16 v[120:123], v[8:11], v[76:79], v[120:123]
    v_mfma_f32_16x16x32_f16 v[108:111], v[40:43], v[76:79], v[108:111]
    v_mfma_f32_16x16x32_f16 v[112:115], v[72:75], v[76:79], 0
    s_nop 7
    ds_write_b64 v124, v[120:121] offset:3840
    ds_write_b64 v124, v[122:123] offset:3848
    ds_write_b32 v125, v126 offset:96
    s_mov_b32 s9, 0
SPN3:
    ds_read_b32 v128, v127 offset:72
    s_add_u32 s9, s9, 1
    s_waitcnt lgkmcnt(0)
    v_cmp_ne_u32 vcc, 4, v128
    s_cmp_ge_u32 s9, 0x40000
    s_cbranch_scc1 SPX3
    s_cbranch_vccz SPX3
    s_sleep 1
    s_branch SPN3
SPX3:
    s_lshl_b32 s8, s7, 2
    v_add_u32 v128, s8, v127
    ds_read_b32 v128, v128 offset:96
    ds_read_b128 v[80:83], v6 offset:2560
    ds_read_b128 v[84:87], v6 offset:2624
    ds_read_b128 v[88:91], v6 offset:2688
    ds_read_b128 v[92:95], v6 offset:2752
    ds_read_b128 v[96:99], v6 offset:2816
    ds_read_b128 v[100:103], v6 offset:2880
    ds_read_b128 v[104:107], v6 offset:2944
    s_waitcnt lgkmcnt(7)
    v_mul_f32 v108, v108, v128
    v_mul_f32 v109, v109, v128
    v_mul_f32 v110, v110, v128
    v_mul_f32 v111, v111, v128
    v_mul_f32 v112, v112, v128
    v_mul_f32 v113, v113, v128
    v_mul_f32 v114, v114, v128
    v_mul_f32 v115, v115, v128
    s_waitcnt lgkmcnt(6)
    v_mfma_f32_16x16x32_f16 v[108:111], v[36:39], v[80:83], v[108:111]
    v_mfma_f32_16x16x32_f16 v[112:115], v[68:71], v[80:83], v[112:115]
    ds_read_b128 v[76:79], v6 offset:3008
    s_waitcnt lgkmcnt(6)
    v_mfma_f32_16x16x32_f16 v[108:111], v[32:35], v[84:87], v[108:111]
    v_mfma_f32_16x16x32_f16 v[112:115], v[64:67], v[84:87], v[112:115]
    ds_read_b128 v[80:83], v6 offset:3072
    s_waitcnt lgkmcnt(6)
    v_mfma_f32_16x16x32_f16 v[108:111], v[28:31], v[88:91], v[108:111]
    v_mfma_f32_16x16x32_f16 v[112:115], v[60:63], v[88:91], v[112:115]
    ds_read_b128 v[84:87], v6 offset:3136
    s_waitcnt lgkmcnt(6)
    v_mfma_f32_16x16x32_f16 v[108:111], v[24:27], v[92:95], v[108:111]
    v_mfma_f32_16x16x32_f16 v[112:115], v[56:59], v[92:95], v[112:115]
    ds_read_b128 v[88:91], v6 offset:3200
    s_waitcnt lgkmcnt(6)
    v_mfma_f32_16x16x32_f16 v[108:111], v[20:23], v[96:99], v[108:111]
    v_mfma_f32_16x16x32_f16 v[112:115], v[52:55], v[96:99], v[112:115]
    ds_read_b128 v[92:95], v6 offset:3264
    s_waitcnt lgkmcnt(6)
    v_mfma_f32_16x16x32_f16 v[108:111], v[16:19], v[100:103], v[108:111]
    v_mfma_f32_16x16x32_f16 v[112:115], v[48:51], v[100:103], v[112:115]
    ds_read_b128 v[96:99], v6 offset:3328
    s_waitcnt lgkmcnt(6)
    v_mfma_f32_16x16x32_f16 v[108:111], v[12:15], v[104:107], v[108:111]
    v_mfma_f32_16x16x32_f16 v[112:115], v[44:47], v[104:107], v[112:115]
    ds_read_b128 v[100:103], v6 offset:3392
    s_waitcnt lgkmcnt(6)
    v_mfma_f32_16x16x32_f16 v[108:111], v[8:11], v[76:79], v[108:111]
    v_mfma_f32_16x16x32_f16 v[112:115], v[40:43], v[76:79], v[112:115]
    v_mfma_f32_16x16x32_f16 v[116:119], v[72:75], v[76:79], 0
    ds_read_b128 v[104:107], v6 offset:3456
    s_waitcnt lgkmcnt(6)
    v_mfma_f32_16x16x32_f16 v[112:115], v[36:39], v[80:83], v[112:115]
    v_mfma_f32_16x16x32_f16 v[116:119], v[68:71], v[80:83], v[116:119]
    ds_read_b128 v[76:79], v6 offset:3520
    s_waitcnt lgkmcnt(6)
    v_mfma_f32_16x16x32_f16 v[112:115], v[32:35], v[84:87], v[112:115]
    v_mfma_f32_16x16x32_f16 v[116:119], v[64:67], v[84:87], v[116:119]
    ds_read_b128 v[80:83], v6 offset:3584
    s_waitcnt lgkmcnt(6)
    v_mfma_f32_16x16x32_f16 v[112:115], v[28:31], v[88:91], v[112:115]
    ds_write_b64 v124, v[108:109] offset:5120
    v_mfma_f32_16x16x32_f16 v[116:119], v[60:63], v[88:91], v[116:119]
    ds_read_b128 v[84:87], v6 offset:3648
    s_waitcnt lgkmcnt(7)
    v_mfma_f32_16x16x32_f16 v[112:115], v[24:27], v[92:95], v[112:115]
    ds_write_b64 v124, v[110:111] offset:5128
    v_mfma_f32_16x16x32_f16 v[116:119], v[56:59], v[92:95], v[116:119]
    ds_read_b128 v[88:91], v6 offset:3712
    s_waitcnt lgkmcnt(8)
    v_mfma_f32_16x16x32_f16 v[112:115], v[20:23], v[96:99], v[112:115]
    ds_write_b32 v125, v126 offset:128
    v_mfma_f32_16x16x32_f16 v[116:119], v[52:55], v[96:99], v[116:119]
    ds_read_b128 v[92:95], v6 offset:3776
    s_waitcnt lgkmcnt(9)
    v_mfma_f32_16x16x32_f16 v[112:115], v[16:19], v[100:103], v[112:115]
    v_mfma_f32_16x16x32_f16 v[116:119], v[48:51], v[100:103], v[116:119]
    ds_read_b128 v[96:99], v6 offset:3840
    s_waitcnt lgkmcnt(9)
    v_mfma_f32_16x16x32_f16 v[112:115], v[12:15], v[104:107], v[112:115]
    v_mfma_f32_16x16x32_f16 v[116:119], v[44:47], v[104:107], v[116:119]
    ds_read_b128 v[100:103], v6 offset:3904
    s_waitcnt lgkmcnt(9)
    v_mfma_f32_16x16x32_f16 v[112:115], v[8:11], v[76:79], v[112:115]
    v_mfma_f32_16x16x32_f16 v[116:119], v[40:43], v[76:79], v[116:119]
    v_mfma_f32_16x16x32_f16 v[120:123], v[72:75], v[76:79], 0
    ds_read_b128 v[104:107], v6 offset:3968
    s_waitcnt lgkmcnt(9)
    v_mfma_f32_16x16x32_f16 v[116:119], v[36:39], v[80:83], v[116:119]
    v_mfma_f32_16x16x32_f16 v[120:123], v[68:71], v[80:83], v[120:123]
    ds_read_b128 v[76:79], v6 offset:4032
    s_waitcnt lgkmcnt(8)
    v_mfma_f32_16x16x32_f16 v[116:119], v[32:35], v[84:87], v[116:119]
    v_mfma_f32_16x16x32_f16 v[120:123], v[64:67], v[84:87], v[120:123]
    ds_read_b128 v[80:83], v6 offset:4096
    s_waitcnt lgkmcnt(7)
    v_mfma_f32_16x16x32_f16 v[116:119], v[28:31], v[88:91], v[116:119]
    ds_write_b64 v124, v[112:113] offset:6400
    v_mfma_f32_16x16x32_f16 v[120:123], v[60:63], v[88:91], v[120:123]
    ds_read_b128 v[84:87], v6 offset:4160
    s_waitcnt lgkmcnt(7)
    v_mfma_f32_16x16x32_f16 v[116:119], v[24:27], v[92:95], v[116:119]
    ds_write_b64 v124, v[114:115] offset:6408
    v_mfma_f32_16x16x32_f16 v[120:123], v[56:59], v[92:95], v[120:123]
    ds_read_b128 v[88:91], v6 offset:4224
    s_waitcnt lgkmcnt(8)
    v_mfma_f32_16x16x32_f16 v[116:119], v[20:23], v[96:99], v[116:119]
    ds_write_b32 v125, v126 offset:160
    v_mfma_f32_16x16x32_f16 v[120:123], v[52:55], v[96:99], v[120:123]
    ds_read_b128 v[92:95], v6 offset:4288
    s_waitcnt lgkmcnt(9)
    v_mfma_f32_16x16x32_f16 v[116:119], v[16:19], v[100:103], v[116:119]
    v_mfma_f32_16x16x32_f16 v[120:123], v[48:51], v[100:103], v[120:123]
    ds_read_b128 v[96:99], v6 offset:4352
    s_waitcnt lgkmcnt(9)
    v_mfma_f32_16x16x32_f16 v[116:119], v[12:15], v[104:107], v[116:119]
    v_mfma_f32_16x16x32_f16 v[120:123], v[44:47], v[104:107], v[120:123]
    ds_read_b128 v[100:103], v6 offset:4416
    s_waitcnt lgkmcnt(9)
    v_mfma_f32_16x16x32_f16 v[116:119], v[8:11], v[76:79], v[116:119]
    v_mfma_f32_16x16x32_f16 v[120:123], v[40:43], v[76:79], v[120:123]
    ds_read_b128 v[104:107], v6 offset:4480
    s_waitcnt lgkmcnt(9)
    v_mfma_f32_16x16x32_f16 v[120:123], v[36:39], v[80:83], v[120:123]
    ds_read_b128 v[76:79], v6 offset:4544
    s_waitcnt lgkmcnt(8)
    v_mfma_f32_16x16x32_f16 v[120:123], v[32:35], v[84:87], v[120:123]
    s_waitcnt lgkmcnt(6)
    v_mfma_f32_16x16x32_f16 v[120:123], v[28:31], v[88:91], v[120:123]
    s_waitcnt lgkmcnt(4)
    v_mfma_f32_16x16x32_f16 v[120:123], v[24:27], v[92:95], v[120:123]
    s_waitcnt lgkmcnt(3)
    v_mfma_f32_16x16x32_f16 v[120:123], v[20:23], v[96:99], v[120:123]
    ds_write_b64 v124, v[116:117] offset:7680
    s_waitcnt lgkmcnt(3)
    v_mfma_f32_16x16x32_f16 v[120:123], v[16:19], v[100:103], v[120:123]
    ds_write_b64 v124, v[118:119] offset:7688
    s_waitcnt lgkmcnt(3)
    v_mfma_f32_16x16x32_f16 v[120:123], v[12:15], v[104:107], v[120:123]
    ds_write_b32 v125, v126 offset:192
    s_waitcnt lgkmcnt(3)
    v_mfma_f32_16x16x32_f16 v[120:123], v[8:11], v[76:79], v[120:123]
    s_nop 7
    ds_write_b64 v124, v[120:121] offset:8960
    ds_write_b64 v124, v[122:123] offset:8968
    ds_write_b32 v125, v126 offset:224
    s_waitcnt lgkmcnt(0)
    s_endpgm
CK_T1:
    ds_read_b128 v[8:11], v128 offset:43296
    ds_read_b128 v[40:43], v128 offset:16896
    ds_read_b128 v[12:15], v128 offset:43360
    ds_read_b128 v[44:47], v128 offset:16960
    ds_read_b128 v[16:19], v128 offset:43424
    ds_read_b128 v[48:51], v128 offset:17024
    ds_read_b128 v[20:23], v128 offset:43488
    ds_read_b128 v[52:55], v128 offset:17088
    ds_read_b128 v[24:27], v128 offset:43552
    ds_read_b128 v[56:59], v128 offset:17152
    ds_read_b128 v[28:31], v128 offset:43616
    ds_read_b128 v[60:63], v128 offset:17216
    ds_read_b128 v[32:35], v128 offset:43680
    ds_read_b128 v[64:67], v128 offset:17280
    ds_read_b128 v[36:39], v128 offset:43744
    ds_read_b128 v[68:71], v128 offset:17344
    v_lshlrev_b32 v114, 8, v4
    v_lshl_add_u32 v114, v3, 4, v114
    v_add_u32 v114, s13, v114
    v_lshlrev_b32 v115, 7, v4
    v_lshl_add_u32 v115, v3, 2, v115
    v_add_u32 v115, s13, v115
    s_waitcnt lgkmcnt(14)
    v_mfma_f32_16x16x32_f16 v[104:107], v[40:43], v[8:11], 0
    s_waitcnt lgkmcnt(12)
    v_mfma_f32_16x16x32_f16 v[104:107], v[44:47], v[12:15], v[104:107]
    s_waitcnt lgkmcnt(10)
    v_mfma_f32_16x16x32_f16 v[104:107], v[48:51], v[16:19], v[104:107]
    s_waitcnt lgkmcnt(8)
    v_mfma_f32_16x16x32_f16 v[104:107], v[52:55], v[20:23], v[104:107]
    s_waitcnt lgkmcnt(6)
    v_mfma_f32_16x16x32_f16 v[104:107], v[56:59], v[24:27], v[104:107]
    s_waitcnt lgkmcnt(4)
    v_mfma_f32_16x16x32_f16 v[104:107], v[60:63], v[28:31], v[104:107]
    s_waitcnt lgkmcnt(2)
    v_mfma_f32_16x16x32_f16 v[104:107], v[64:67], v[32:35], v[104:107]
    s_waitcnt lgkmcnt(0)
    v_mfma_f32_16x16x32_f16 v[104:107], v[68:71], v[36:39], v[104:107]
    s_nop 7
    v_cvt_pk_f16_f32 v116, v104, v105
    v_cvt_pk_f16_f32 v117, v105, v105
    v_cvt_pk_f16_f32 v118, v106, v107
    v_cvt_pk_f16_f32 v119, v107, v107
    v_cvt_pk_f16_f32 v120, v105, v106
    s_mov_b32 exec_hi, 0
    ds_write_b16 v114, v119 offset:560
    v_add_u32 v121, 1728, v114
    ds_write_b128 v114, v[116:119] offset:544
    ds_write2_b32 v121, v119, v119 offset0:11 offset1:12
    ds_write2_b32 v121, v117, v120 offset0:9 offset1:10
    ds_write_b16 v121, v116 offset:34
    s_not_b64 exec, exec
    ds_write_b32 v115, v116 offset:2208
    ds_write_b32 v115, v118 offset:2272
    s_mov_b64 exec, -1
    v_mov_b32 v167, 155648
    v_mov_b32 v166, 1
    s_mov_b64 exec, 1
    ds_add_u32 v167, v166 offset:76
    s_mov_b64 exec, -1
    v_mul_u32_u24 v164, 320, v4
    v_lshl_add_u32 v164, v3, 4, v164
    s_mul_i32 s8, s7, 20480
    v_add_u32 v164, s8, v164
    s_lshl_b32 s8, s3, 2
    s_add_u32 s8, s8, 155904
    v_mov_b32 v165, s8
    v_lshlrev_b32 v74, 3, v4
    v_sub_u32 v74, v74, v3
    v_and_b32 v74, 0xffff, v74
    v_lshl_or_b32 v74, v74, 16, v74
    v_mov_b32 v75, 0x3c003c00
    s_mov_b32 s8, 0xfff0fff1
    v_pk_add_u16 v76, v74, s8
    s_mov_b32 s8, 0xfff2fff3
    v_pk_add_u16 v77, v74, s8
    s_mov_b32 s8, 0xfff4fff5
    v_pk_add_u16 v78, v74, s8
    s_mov_b32 s8, 0xfff6fff7
    v_pk_add_u16 v79, v74, s8
    v_pk_add_u16 v80, v76, 2 op_sel_hi:[1,0]
    v_pk_ashrrev_i16 v80, 15, v80 op_sel_hi:[0,1]
    v_pk_add_u16 v81, v77, 2 op_sel_hi:[1,0]
    v_pk_ashrrev_i16 v81, 15, v81 op_sel_hi:[0,1]
    v_pk_add_u16 v82, v78, 2 op_sel_hi:[1,0]
    v_pk_ashrrev_i16 v82, 15, v82 op_sel_hi:[0,1]
    v_pk_add_u16 v83, v79, 2 op_sel_hi:[1,0]
    v_pk_ashrrev_i16 v83, 15, v83 op_sel_hi:[0,1]
    v_pk_add_u16 v84, v76, 3 op_sel_hi:[1,0]
    v_pk_ashrrev_i16 v84, 15, v84 op_sel_hi:[0,1]
    v_pk_add_u16 v85, v77, 3 op_sel_hi:[1,0]
    v_pk_ashrrev_i16 v85, 15, v85 op_sel_hi:[0,1]
    v_pk_add_u16 v86, v78, 3 op_sel_hi:[1,0]
    v_pk_ashrrev_i16 v86, 15, v86 op_sel_hi:[0,1]
    v_pk_add_u16 v87, v79, 3 op_sel_hi:[1,0]
    v_pk_ashrrev_i16 v87, 15, v87 op_sel_hi:[0,1]
    v_pk_add_u16 v88, v76, 4 op_sel_hi:[1,0]
    v_pk_ashrrev_i16 v88, 15, v88 op_sel_hi:[0,1]
    v_pk_add_u16 v89, v77, 4 op_sel_hi:[1,0]
    v_pk_ashrrev_i16 v89, 15, v89 op_sel_hi:[0,1]
    v_pk_add_u16 v90, v78, 4 op_sel_hi:[1,0]
    v_pk_ashrrev_i16 v90, 15, v90 op_sel_hi:[0,1]
    v_pk_add_u16 v91, v79, 4 op_sel_hi:[1,0]
    v_pk_ashrrev_i16 v91, 15, v91 op_sel_hi:[0,1]
    v_pk_add_u16 v92, v76, 5 op_sel_hi:[1,0]
    v_pk_ashrrev_i16 v92, 15, v92 op_sel_hi:[0,1]
    v_pk_add_u16 v93, v77, 5 op_sel_hi:[1,0]
    v_pk_ashrrev_i16 v93, 15, v93 op_sel_hi:[0,1]
    v_pk_add_u16 v94, v78, 5 op_sel_hi:[1,0]
    v_pk_ashrrev_i16 v94, 15, v94 op_sel_hi:[0,1]
    v_pk_add_u16 v95, v79, 5 op_sel_hi:[1,0]
    v_pk_ashrrev_i16 v95, 15, v95 op_sel_hi:[0,1]
    v_pk_add_u16 v96, v76, 10 op_sel_hi:[1,0]
    v_pk_ashrrev_i16 v96, 15, v96 op_sel_hi:[0,1]
    v_pk_add_u16 v97, v77, 10 op_sel_hi:[1,0]
    v_pk_ashrrev_i16 v97, 15, v97 op_sel_hi:[0,1]
    v_pk_add_u16 v98, v78, 10 op_sel_hi:[1,0]
    v_pk_ashrrev_i16 v98, 15, v98 op_sel_hi:[0,1]
    v_pk_add_u16 v99, v79, 10 op_sel_hi:[1,0]
    v_pk_ashrrev_i16 v99, 15, v99 op_sel_hi:[0,1]
    v_pk_add_u16 v100, v76, 11 op_sel_hi:[1,0]
    v_pk_ashrrev_i16 v100, 15, v100 op_sel_hi:[0,1]
    v_pk_add_u16 v101, v77, 11 op_sel_hi:[1,0]
    v_pk_ashrrev_i16 v101, 15, v101 op_sel_hi:[0,1]
    v_pk_add_u16 v102, v78, 11 op_sel_hi:[1,0]
    v_pk_ashrrev_i16 v102, 15, v102 op_sel_hi:[0,1]
    v_pk_add_u16 v103, v79, 11 op_sel_hi:[1,0]
    v_pk_ashrrev_i16 v103, 15, v103 op_sel_hi:[0,1]
    v_pk_add_u16 v104, v76, 12 op_sel_hi:[1,0]
    v_pk_ashrrev_i16 v104, 15, v104 op_sel_hi:[0,1]
    v_pk_add_u16 v105, v77, 12 op_sel_hi:[1,0]
    v_pk_ashrrev_i16 v105, 15, v105 op_sel_hi:[0,1]
    v_pk_add_u16 v106, v78, 12 op_sel_hi:[1,0]
    v_pk_ashrrev_i16 v106, 15, v106 op_sel_hi:[0,1]
    v_pk_add_u16 v107, v79, 12 op_sel_hi:[1,0]
    v_pk_ashrrev_i16 v107, 15, v107 op_sel_hi:[0,1]
    v_bitop3_b32 v140, v80, v92, v75 bitop3:0x28
    v_bitop3_b32 v141, v81, v93, v75 bitop3:0x28
    v_bitop3_b32 v142, v82, v94, v75 bitop3:0x28
    v_bitop3_b32 v143, v83, v95, v75 bitop3:0x28
    v_bitop3_b32 v144, v92, v96, v75 bitop3:0x28
    v_bitop3_b32 v145, v93, v97, v75 bitop3:0x28
    v_bitop3_b32 v146, v94, v98, v75 bitop3:0x28
    v_bitop3_b32 v147, v95, v99, v75 bitop3:0x28
    v_bitop3_b32 v148, v88, v100, v75 bitop3:0x28
    v_bitop3_b32 v149, v89, v101, v75 bitop3:0x28
    v_bitop3_b32 v150, v90, v102, v75 bitop3:0x28
    v_bitop3_b32 v151, v91, v103, v75 bitop3:0x28
    v_bitop3_b32 v152, v84, v104, v75 bitop3:0x28
    v_bitop3_b32 v153, v85, v105, v75 bitop3:0x28
    v_bitop3_b32 v154, v86, v106, v75 bitop3:0x28
    v_bitop3_b32 v155, v87, v107, v75 bitop3:0x28
    v_xor_b32 v156, v80, v88
    v_xor_b32 v157, v81, v89
    v_xor_b32 v158, v82, v90
    v_xor_b32 v159, v83, v91
    v_lshlrev_b32 v5, 2, v4
    v_sub_u32 v5, v3, v5
    v_lshl_add_u32 v7, v5, 2, s13
    v_lshl_add_u32 v5, v5, 3, s13
    v_add_u32 v7, 2848, v7
    v_mov_b32 v6, s13
    s_mov_b32 s9, 0
SPN4:
    ds_read_b32 v128, v167 offset:76
    s_add_u32 s9, s9, 1
    s_waitcnt lgkmcnt(0)
    v_cmp_ne_u32 vcc, 8, v128
    s_cmp_ge_u32 s9, 0x40000
    s_cbranch_scc1 SPX4
    s_cbranch_vccz SPX4
    s_sleep 1
    s_branch SPN4
SPX4:
    ds_read_b32 v130, v6 offset:2716
    ds_read_b64 v[8:9], v5 offset:2464
    ds_read_b64 v[10:11], v5 offset:2456
    ds_read_b64 v[12:13], v5 offset:2448
    ds_read_b64 v[14:15], v5 offset:2440
    ds_read_b64 v[16:17], v5 offset:2592
    ds_read_b64 v[18:19], v5 offset:2584
    ds_read_b64 v[20:21], v5 offset:2576
    ds_read_b64 v[22:23], v5 offset:2568
    ds_read_b64 v[24:25], v5 offset:2720
    ds_read_b64 v[26:27], v5 offset:2712
    ds_read_b64 v[28:29], v5 offset:2704
    ds_read_b64 v[30:31], v5 offset:2696
    ds_read2_b32 v[32:33], v7 offset0:16 offset1:15
    ds_read2_b32 v[34:35], v7 offset0:14 offset1:13
    ds_read2_b32 v[36:37], v7 offset0:32 offset1:31
    ds_read2_b32 v[38:39], v7 offset0:30 offset1:29
    ds_read2_b32 v[40:41], v7 offset0:48 offset1:47
    ds_read2_b32 v[42:43], v7 offset0:46 offset1:45
    ds_read2_b32 v[44:45], v7 offset0:64 offset1:63
    ds_read2_b32 v[46:47], v7 offset0:62 offset1:61
    v_lshlrev_b32 v6, 4, v4
    v_lshl_add_u32 v6, v3, 5, v6
    v_add_u32 v6, 4048, v6
    v_add_u32 v6, s13, v6
    ds_write_b128 v164, v[124:127] offset:10240
    ds_write_b32 v165, v166 offset:0
    ds_write_b128 v164, v[124:127] offset:11520
    ds_write_b32 v165, v166 offset:32
    s_mov_b32 s8, 0x07060706
    s_mov_b32 s9, 0
SPN5:
    ds_read_b32 v128, v167 offset:72
    s_add_u32 s9, s9, 1
    s_waitcnt lgkmcnt(0)
    v_cmp_gt_u32 vcc, 2, v128
    s_cmp_ge_u32 s9, 0x40000
    s_cbranch_scc1 SPX5
    s_cbranch_vccz SPX5
    s_sleep 1
    s_branch SPN5
SPX5:
    v_perm_b32 v130, v130, v130, s8
Z_LOOP:
    ds_read_b128 v[48:51], v6 offset:16
    ds_read_b128 v[52:55], v6 offset:0
    ds_read_b128 v[56:59], v6 offset:528
    ds_read_b128 v[60:63], v6 offset:512
    v_and_b32 v156, v130, v156
    v_and_b32 v157, v130, v157
    v_and_b32 v158, v130, v158
    v_and_b32 v159, v130, v159
    s_waitcnt lgkmcnt(2)
    v_mfma_f32_16x16x32_f16 v[64:67], v[48:51], v[140:143], 0
    v_mfma_f32_16x16x32_f16 v[68:71], v[48:51], v[144:147], 0
    v_mfma_f32_16x16x32_f16 v[72:75], v[52:55], v[140:143], 0
    v_mfma_f32_16x16x32_f16 v[76:79], v[52:55], v[144:147], 0
    v_mfma_f32_16x16x32_f16 v[80:83], v[48:51], v[148:151], 0
    v_mfma_f32_16x16x32_f16 v[84:87], v[52:55], v[152:155], 0
    s_nop 3
    v_cvt_pk_f16_f32 v88, v64, v68
    v_cvt_pk_f16_f32 v90, v65, v69
    v_cvt_pk_f16_f32 v92, v66, v70
    v_cvt_pk_f16_f32 v94, v67, v71
    v_cvt_pk_f16_f32 v89, v72, v76
    v_cvt_pk_f16_f32 v91, v73, v77
    v_cvt_pk_f16_f32 v93, v74, v78
    v_cvt_pk_f16_f32 v95, v75, v79
    v_cvt_pk_f16_f32 v96, v80, v84
    v_cvt_pk_f16_f32 v97, v81, v85
    v_cvt_pk_f16_f32 v98, v82, v86
    v_cvt_pk_f16_f32 v99, v83, v87
    s_waitcnt lgkmcnt(0)
    v_mfma_f32_16x16x32_f16 v[64:67], v[56:59], v[140:143], 0
    v_mfma_f32_16x16x32_f16 v[68:71], v[56:59], v[144:147], 0
    v_mfma_f32_16x16x32_f16 v[72:75], v[60:63], v[140:143], 0
    v_mfma_f32_16x16x32_f16 v[76:79], v[60:63], v[144:147], 0
    v_mfma_f32_16x16x32_f16 v[80:83], v[56:59], v[148:151], 0
    v_mfma_f32_16x16x32_f16 v[84:87], v[60:63], v[152:155], 0
    v_mfma_f32_16x16x32_f16 v[108:111], v[156:159], v[48:51], 0
    ds_read_b128 v[48:51], v6 offset:1040
    ds_read_b128 v[52:55], v6 offset:1024
    v_mfma_f32_16x16x32_f16 v[100:103], v[88:91], v[8:11], 0
    v_mfma_f32_16x16x32_f16 v[100:103], v[92:95], v[12:15], v[100:103]
    v_cvt_pk_f16_f32 v132, v64, v68
    v_cvt_pk_f16_f32 v134, v65, v69
    v_mfma_f32_16x16x32_f16 v[104:107], v[88:91], v[16:19], 0
    v_cvt_pk_f16_f32 v136, v66, v70
    v_cvt_pk_f16_f32 v138, v67, v71
    v_mfma_f32_16x16x32_f16 v[104:107], v[92:95], v[20:23], v[104:107]
    v_cvt_pk_f16_f32 v133, v72, v76
    v_cvt_pk_f16_f32 v135, v73, v77
    v_mfma_f32_16x16x32_f16 v[108:111], v[88:91], v[24:27], v[108:111]
    v_cvt_pk_f16_f32 v137, v74, v78
    v_cvt_pk_f16_f32 v139, v75, v79
    v_mfma_f32_16x16x32_f16 v[108:111], v[92:95], v[28:31], v[108:111]
    v_cvt_pk_f16_f32 v160, v80, v84
    v_cvt_pk_f16_f32 v161, v81, v85
    v_mfma_f32_16x16x32_f16 v[108:111], v[96:99], v[32:35], v[108:111]
    v_cvt_pk_f16_f32 v162, v82, v86
    v_cvt_pk_f16_f32 v163, v83, v87
    v_mfma_f32_16x16x32_f16 v[112:115], v[96:99], v[36:39], 0
    v_mfma_f32_16x16x32_f16 v[116:119], v[96:99], v[40:43], 0
    v_mfma_f32_16x16x32_f16 v[120:123], v[96:99], v[44:47], 0
    s_waitcnt lgkmcnt(0)
    v_mfma_f32_16x16x32_f16 v[64:67], v[48:51], v[140:143], 0
    v_mfma_f32_16x16x32_f16 v[68:71], v[48:51], v[144:147], 0
    ds_write_b64 v164, v[100:101] offset:12800
    v_mfma_f32_16x16x32_f16 v[72:75], v[52:55], v[140:143], 0
    ds_write_b64 v164, v[102:103] offset:12808
    v_mfma_f32_16x16x32_f16 v[76:79], v[52:55], v[144:147], 0
    ds_write_b32 v165, v166 offset:64
    v_mfma_f32_16x16x32_f16 v[80:83], v[48:51], v[148:151], 0
    v_mfma_f32_16x16x32_f16 v[84:87], v[52:55], v[152:155], 0
    v_mfma_f32_16x16x32_f16 v[112:115], v[156:159], v[56:59], v[112:115]
    ds_read_b128 v[56:59], v6 offset:1552
    ds_read_b128 v[60:63], v6 offset:1536
    v_mfma_f32_16x16x32_f16 v[104:107], v[132:135], v[8:11], v[104:107]
    v_mfma_f32_16x16x32_f16 v[104:107], v[136:139], v[12:15], v[104:107]
    v_cvt_pk_f16_f32 v88, v64, v68
    v_cvt_pk_f16_f32 v90, v65, v69
    v_mfma_f32_16x16x32_f16 v[108:111], v[132:135], v[16:19], v[108:111]
    v_cvt_pk_f16_f32 v92, v66, v70
    v_cvt_pk_f16_f32 v94, v67, v71
    v_mfma_f32_16x16x32_f16 v[108:111], v[136:139], v[20:23], v[108:111]
    v_cvt_pk_f16_f32 v89, v72, v76
    v_cvt_pk_f16_f32 v91, v73, v77
    v_mfma_f32_16x16x32_f16 v[112:115], v[132:135], v[24:27], v[112:115]
    v_cvt_pk_f16_f32 v93, v74, v78
    v_cvt_pk_f16_f32 v95, v75, v79
    v_mfma_f32_16x16x32_f16 v[112:115], v[136:139], v[28:31], v[112:115]
    v_cvt_pk_f16_f32 v96, v80, v84
    v_cvt_pk_f16_f32 v97, v81, v85
    v_mfma_f32_16x16x32_f16 v[112:115], v[160:163], v[32:35], v[112:115]
    v_cvt_pk_f16_f32 v98, v82, v86
    v_cvt_pk_f16_f32 v99, v83, v87
    v_mfma_f32_16x16x32_f16 v[116:119], v[160:163], v[36:39], v[116:119]
    v_mfma_f32_16x16x32_f16 v[120:123], v[160:163], v[40:43], v[120:123]
    s_waitcnt lgkmcnt(0)
    v_mfma_f32_16x16x32_f16 v[64:67], v[56:59], v[140:143], 0
    v_mfma_f32_16x16x32_f16 v[68:71], v[56:59], v[144:147], 0
    ds_write_b64 v164, v[104:105] offset:14080
    v_mfma_f32_16x16x32_f16 v[72:75], v[60:63], v[140:143], 0
    ds_write_b64 v164, v[106:107] offset:14088
    v_mfma_f32_16x16x32_f16 v[76:79], v[60:63], v[144:147], 0
    ds_write_b32 v165, v166 offset:96
    v_mfma_f32_16x16x32_f16 v[80:83], v[56:59], v[148:151], 0
    v_mfma_f32_16x16x32_f16 v[84:87], v[60:63], v[152:155], 0
    v_mfma_f32_16x16x32_f16 v[116:119], v[156:159], v[48:51], v[116:119]
    v_mfma_f32_16x16x32_f16 v[108:111], v[88:91], v[8:11], v[108:111]
    v_mfma_f32_16x16x32_f16 v[108:111], v[92:95], v[12:15], v[108:111]
    v_mfma_f32_16x16x32_f16 v[112:115], v[88:91], v[16:19], v[112:115]
    v_cvt_pk_f16_f32 v132, v64, v68
    v_cvt_pk_f16_f32 v134, v65, v69
    v_mfma_f32_16x16x32_f16 v[112:115], v[92:95], v[20:23], v[112:115]
    v_cvt_pk_f16_f32 v136, v66, v70
    v_cvt_pk_f16_f32 v138, v67, v71
    v_mfma_f32_16x16x32_f16 v[116:119], v[88:91], v[24:27], v[116:119]
    v_cvt_pk_f16_f32 v133, v72, v76
    v_cvt_pk_f16_f32 v135, v73, v77
    v_mfma_f32_16x16x32_f16 v[116:119], v[92:95], v[28:31], v[116:119]
    v_cvt_pk_f16_f32 v137, v74, v78
    v_cvt_pk_f16_f32 v139, v75, v79
    v_mfma_f32_16x16x32_f16 v[116:119], v[96:99], v[32:35], v[116:119]
    v_cvt_pk_f16_f32 v160, v80, v84
    v_cvt_pk_f16_f32 v161, v81, v85
    v_mfma_f32_16x16x32_f16 v[120:123], v[96:99], v[36:39], v[120:123]
    v_cvt_pk_f16_f32 v162, v82, v86
    v_cvt_pk_f16_f32 v163, v83, v87
    s_nop 1
    v_mfma_f32_16x16x32_f16 v[120:123], v[156:159], v[56:59], v[120:123]
    v_mfma_f32_16x16x32_f16 v[112:115], v[132:135], v[8:11], v[112:115]
    v_mfma_f32_16x16x32_f16 v[112:115], v[136:139], v[12:15], v[112:115]
    v_mfma_f32_16x16x32_f16 v[116:119], v[132:135], v[16:19], v[116:119]
    v_mfma_f32_16x16x32_f16 v[116:119], v[136:139], v[20:23], v[116:119]
    v_mfma_f32_16x16x32_f16 v[120:123], v[132:135], v[24:27], v[120:123]
    v_mfma_f32_16x16x32_f16 v[120:123], v[136:139], v[28:31], v[120:123]
    v_mfma_f32_16x16x32_f16 v[120:123], v[160:163], v[32:35], v[120:123]
    s_mov_b32 s9, 0
SPN6:
    ds_read_b32 v128, v167 offset:72
    s_add_u32 s9, s9, 1
    s_waitcnt lgkmcnt(0)
    v_cmp_ne_u32 vcc, 4, v128
    s_cmp_ge_u32 s9, 0x40000
    s_cbranch_scc1 SPX6
    s_cbranch_vccz SPX6
    s_sleep 1
    s_branch SPN6
SPX6:
    s_lshl_b32 s8, s7, 2
    v_add_u32 v128, s8, v167
    ds_read_b32 v128, v128 offset:96
    s_cmp_lg_u32 s3, 4
    s_cbranch_scc1 Z_NOSEL
    v_and_b32 v126, 7, v2
    s_lshl_b32 s9, s4, 8
    v_lshl_add_u32 v126, v126, 3, s9
    global_load_dwordx2 v[124:125], v126, s[50:51] offset:256 sc1
Z_NOSEL:
    ds_read_b128 v[48:51], v6 offset:2576
    ds_read_b128 v[52:55], v6 offset:2560
    ds_read_b128 v[56:59], v6 offset:3088
    ds_read_b128 v[60:63], v6 offset:3072
    s_waitcnt lgkmcnt(4)
    v_mul_f32 v108, v108, v128
    v_mul_f32 v109, v109, v128
    v_mul_f32 v110, v110, v128
    v_mul_f32 v111, v111, v128
    v_mul_f32 v112, v112, v128
    v_mul_f32 v113, v113, v128
    v_mul_f32 v114, v114, v128
    v_mul_f32 v115, v115, v128
    v_mul_f32 v116, v116, v128
    v_mul_f32 v117, v117, v128
    v_mul_f32 v118, v118, v128
    v_mul_f32 v119, v119, v128
    v_mul_f32 v120, v120, v128
    v_mul_f32 v121, v121, v128
    v_mul_f32 v122, v122, v128
    v_mul_f32 v123, v123, v128
    s_waitcnt lgkmcnt(2)
    v_mfma_f32_16x16x32_f16 v[64:67], v[48:51], v[140:143], 0
    ds_write_b64 v164, v[108:109] offset:15360
    v_mfma_f32_16x16x32_f16 v[68:71], v[48:51], v[144:147], 0
    ds_write_b64 v164, v[110:111] offset:15368
    v_mfma_f32_16x16x32_f16 v[72:75], v[52:55], v[140:143], 0
    ds_write_b32 v165, v166 offset:128
    v_mfma_f32_16x16x32_f16 v[76:79], v[52:55], v[144:147], 0
    ds_write_b64 v164, v[112:113] offset:16640
    ds_write_b64 v164, v[114:115] offset:16648
    ds_write_b32 v165, v166 offset:160
    s_nop 1
    v_cvt_pk_f16_f32 v88, v64, v68
    v_cvt_pk_f16_f32 v90, v65, v69
    v_cvt_pk_f16_f32 v92, v66, v70
    v_cvt_pk_f16_f32 v94, v67, v71
    v_cvt_pk_f16_f32 v89, v72, v76
    v_cvt_pk_f16_f32 v91, v73, v77
    v_cvt_pk_f16_f32 v93, v74, v78
    v_cvt_pk_f16_f32 v95, v75, v79
    s_waitcnt lgkmcnt(6)
    v_mfma_f32_16x16x32_f16 v[64:67], v[56:59], v[140:143], 0
    v_mfma_f32_16x16x32_f16 v[68:71], v[56:59], v[144:147], 0
    v_mfma_f32_16x16x32_f16 v[72:75], v[60:63], v[140:143], 0
    v_mfma_f32_16x16x32_f16 v[76:79], v[60:63], v[144:147], 0
    v_mfma_f32_16x16x32_f16 v[116:119], v[88:91], v[8:11], v[116:119]
    v_mfma_f32_16x16x32_f16 v[116:119], v[92:95], v[12:15], v[116:119]
    v_mfma_f32_16x16x32_f16 v[120:123], v[88:91], v[16:19], v[120:123]
    v_mfma_f32_16x16x32_f16 v[120:123], v[92:95], v[20:23], v[120:123]
    s_nop 1
    v_cvt_pk_f16_f32 v132, v64, v68
    v_cvt_pk_f16_f32 v134, v65, v69
    v_cvt_pk_f16_f32 v136, v66, v70
    v_cvt_pk_f16_f32 v138, v67, v71
    v_cvt_pk_f16_f32 v133, v72, v76
    v_cvt_pk_f16_f32 v135, v73, v77
    v_cvt_pk_f16_f32 v137, v74, v78
    v_cvt_pk_f16_f32 v139, v75, v79
    ds_write_b64 v164, v[116:117] offset:17920
    ds_write_b64 v164, v[118:119] offset:17928
    v_mfma_f32_16x16x32_f16 v[120:123], v[132:135], v[8:11], v[120:123]
    v_mfma_f32_16x16x32_f16 v[120:123], v[136:139], v[12:15], v[120:123]
    ds_write_b32 v165, v166 offset:192
    s_nop 6
    ds_write_b64 v164, v[120:121] offset:19200
    ds_write_b64 v164, v[122:123] offset:19208
    ds_write_b32 v165, v166 offset:224
    s_setprio 0
    s_cmp_eq_u32 s3, 4
    s_cbranch_scc1 FINAL
    s_waitcnt lgkmcnt(0)
    s_endpgm
CU_C3A:
    s_cmp_ge_u32 s101, 4
    s_cbranch_scc1 CU_C3B
    s_sub_u32 s14, 3, s4
    s_and_b32 s14, s14, 7
    s_and_b32 s8, s101, 1
    s_lshl_b32 s8, s8, 3
    s_lshr_b32 s9, s101, 1
    s_cmp_eq_u32 s4, 3
    s_cselect_b32 s14, s8, s14
    s_cselect_b32 s9, s9, s101
    s_add_u32 s9, s9, 2
    s_min_u32 s9, s9, 17
    s_mul_i32 s9, s9, 9
    s_add_u32 s14, s14, s9
    v_mul_u32_u24 v140, 9216, v2
    s_mul_i32 s8, s4, 1152
    v_add_u32 v140, s8, v140
    s_mul_i32 s8, s14, 7282
    s_lshr_b32 s8, s8, 16
    s_mul_i32 s9, s8, 9
    s_sub_u32 s9, s14, s9
    s_lshl_b32 s9, s9, 7
    s_bitcmp1_b32 s8, 0
    s_cselect_b32 s12, s40, s38
    s_cselect_b32 s13, s41, s39
    s_lshr_b32 s8, s8, 1
    s_add_u32 s8, s8, 0
    s_mul_i32 s8, s8, 589824
    s_add_u32 s8, s8, s9
    v_add_u32 v148, s8, v140
    global_load_dword v149, v148, s[12:13]
    s_lshl_b32 s9, s6, 3
    s_branch CU_C3B
CU_C3:
    s_add_u32 s10, s10, 4
    s_sub_u32 s14, 3, s4
    s_and_b32 s14, s14, 7
    s_and_b32 s8, s10, 1
    s_lshl_b32 s8, s8, 3
    s_lshr_b32 s9, s10, 1
    s_cmp_eq_u32 s4, 3
    s_cselect_b32 s14, s8, s14
    s_cselect_b32 s9, s9, s10
    s_add_u32 s9, s9, 2
    s_min_u32 s9, s9, 17
    s_mul_i32 s9, s9, 9
    s_add_u32 s14, s14, s9
    v_mul_u32_u24 v140, 9216, v2
    s_mul_i32 s8, s4, 1152
    v_add_u32 v140, s8, v140
    s_mul_i32 s8, s14, 7282
    s_lshr_b32 s8, s8, 16
    s_mul_i32 s9, s8, 9
    s_sub_u32 s9, s14, s9
    s_lshl_b32 s9, s9, 7
    s_bitcmp1_b32 s8, 0
    s_cselect_b32 s12, s40, s38
    s_cselect_b32 s13, s41, s39
    s_lshr_b32 s8, s8, 1
    s_add_u32 s8, s8, 0
    s_mul_i32 s8, s8, 589824
    s_add_u32 s8, s8, s9
    v_add_u32 v148, s8, v140
    global_load_dword v149, v148, s[12:13]
    s_lshl_b32 s9, s6, 3
    s_branch CU_C3X
CU_MID:
    s_mov_b32 s12, 0
SPN7:
    ds_read_b32 v56, v57 offset:64
    s_add_u32 s12, s12, 1
    s_waitcnt lgkmcnt(0)
    v_cmp_gt_u32 vcc, 2, v56
    s_cmp_ge_u32 s12, 0x40000
    s_cbranch_scc1 SPX7
    s_cbranch_vccz SPX7
    s_sleep 2
    s_branch SPN7
SPX7:
    s_branch CU_LD
CU_MAIN:
    s_load_dwordx2 s[52:53], s[32:33], s9
    v_mov_b32 v139, 1
    v_lshlrev_b32 v137, 4, v2
    v_and_b32 v7, 0x3c0, v137
    v_add_u32 v7, v7, v137
    v_and_b32 v138, 0x3e0, v137
    v_mul_u32_u24 v138, 3, v138
    v_add_u32 v138, v138, v137
    v_add_u32 v138, 10304, v138
    s_lshl_b32 s8, s15, 11
    s_add_u32 s8, s8, 24576
    v_add_u32 v7, s8, v7
    v_add_u32 v137, 8192, v7
    v_add_u32 v138, 20480, v138
    s_cmp_eq_u32 s7, 1
    s_cselect_b64 vcc, -1, 0
    v_cndmask_b32 v138, v137, v138, vcc
    s_mov_b32 s72, s15
    s_cmp_ge_u32 s7, 2
    s_cbranch_scc1 CU_P2
    s_mov_b64 exec, 1
    ds_add_u32 v57, v139 offset:64
    s_mov_b64 exec, -1
    s_setprio 3
    v_and_b32 v56, 12, v3
    v_add_u32 v136, 155728, v56
    v_add_u32 v56, 155648, v56
    v_and_b32 v146, 3, v2
    v_lshl_add_u32 v146, v146, 2, v57
    v_add_u32 v147, 0, v146
    s_lshl_b32 s8, s72, 9
    s_add_u32 s8, s8, 124928
    v_lshl_add_u32 v58, v2, 3, s8
    v_mov_b32 v148, 1
    s_mov_b32 s73, 15
    s_mov_b32 s74, 2
    s_waitcnt vmcnt(7)
    v_lshlrev_b32 v24, 16, v8
    v_and_b32 v28, 0xffff0000, v8
    v_lshlrev_b32 v32, 16, v9
    v_and_b32 v36, 0xffff0000, v9
    s_waitcnt vmcnt(6)
    v_lshlrev_b32 v25, 16, v10
    v_and_b32 v29, 0xffff0000, v10
    v_lshlrev_b32 v33, 16, v11
    v_and_b32 v37, 0xffff0000, v11
    v_max3_f32 v62, |v24|, |v25|, 0
    v_max3_f32 v63, |v28|, |v29|, 0
    v_max3_f32 v64, |v32|, |v33|, 0
    v_max3_f32 v65, |v36|, |v37|, 0
    s_waitcnt vmcnt(5)
    v_lshlrev_b32 v26, 16, v12
    v_and_b32 v30, 0xffff0000, v12
    v_lshlrev_b32 v34, 16, v13
    v_and_b32 v38, 0xffff0000, v13
    s_waitcnt vmcnt(4)
    v_lshlrev_b32 v27, 16, v14
    v_and_b32 v31, 0xffff0000, v14
    v_lshlrev_b32 v35, 16, v15
    v_and_b32 v39, 0xffff0000, v15
    v_max3_f32 v62, |v26|, |v27|, v62
    v_max3_f32 v63, |v30|, |v31|, v63
    v_max3_f32 v64, |v34|, |v35|, v64
    v_max3_f32 v65, |v38|, |v39|, v65
    s_waitcnt vmcnt(3)
    v_lshlrev_b32 v40, 16, v16
    v_and_b32 v44, 0xffff0000, v16
    v_lshlrev_b32 v48, 16, v17
    v_and_b32 v52, 0xffff0000, v17
    s_waitcnt vmcnt(2)
    v_lshlrev_b32 v41, 16, v18
    v_and_b32 v45, 0xffff0000, v18
    v_lshlrev_b32 v49, 16, v19
    v_and_b32 v53, 0xffff0000, v19
    v_max3_f32 v62, |v40|, |v41|, v62
    v_max3_f32 v63, |v44|, |v45|, v63
    v_max3_f32 v64, |v48|, |v49|, v64
    v_max3_f32 v65, |v52|, |v53|, v65
    s_waitcnt vmcnt(1)
    v_lshlrev_b32 v42, 16, v20
    v_and_b32 v46, 0xffff0000, v20
    v_lshlrev_b32 v50, 16, v21
    v_and_b32 v54, 0xffff0000, v21
    s_waitcnt vmcnt(0)
    v_lshlrev_b32 v43, 16, v22
    v_and_b32 v47, 0xffff0000, v22
    v_lshlrev_b32 v51, 16, v23
    v_and_b32 v55, 0xffff0000, v23
    v_max3_f32 v62, |v42|, |v43|, v62
    v_max3_f32 v63, |v46|, |v47|, v63
    v_max3_f32 v64, |v50|, |v51|, v64
    v_max3_f32 v65, |v54|, |v55|, v65
    s_branch CU_MAX
CU_P2:
    s_mov_b64 exec, 1
    ds_add_u32 v57, v139 offset:64
    s_mov_b64 exec, -1
    v_and_b32 v56, 12, v3
    v_add_u32 v136, 155728, v56
    v_add_u32 v56, 155728, v56
    v_and_b32 v146, 3, v2
    v_lshl_add_u32 v146, v146, 2, v57
    v_add_u32 v147, 80, v146
    s_lshl_b32 s8, s72, 9
    s_add_u32 s8, s8, 125440
    v_lshl_add_u32 v58, v2, 3, s8
    v_mov_b32 v148, 16
    s_mov_b32 s73, 255
    s_mov_b32 s74, 34
    s_setprio 3
    s_waitcnt vmcnt(7)
    v_lshlrev_b32 v24, 16, v8
    v_and_b32 v28, 0xffff0000, v8
    v_lshlrev_b32 v32, 16, v9
    v_and_b32 v36, 0xffff0000, v9
    s_waitcnt vmcnt(6)
    v_lshlrev_b32 v25, 16, v10
    v_and_b32 v29, 0xffff0000, v10
    v_lshlrev_b32 v33, 16, v11
    v_and_b32 v37, 0xffff0000, v11
    v_max3_f32 v62, |v24|, |v25|, 0
    v_max3_f32 v63, |v28|, |v29|, 0
    v_max3_f32 v64, |v32|, |v33|, 0
    v_max3_f32 v65, |v36|, |v37|, 0
    s_waitcnt vmcnt(5)
    v_lshlrev_b32 v26, 16, v12
    v_and_b32 v30, 0xffff0000, v12
    v_lshlrev_b32 v34, 16, v13
    v_and_b32 v38, 0xffff0000, v13
    s_waitcnt vmcnt(4)
    v_lshlrev_b32 v27, 16, v14
    v_and_b32 v31, 0xffff0000, v14
    v_lshlrev_b32 v35, 16, v15
    v_and_b32 v39, 0xffff0000, v15
    v_max3_f32 v62, |v26|, |v27|, v62
    v_max3_f32 v63, |v30|, |v31|, v63
    v_max3_f32 v64, |v34|, |v35|, v64
    v_max3_f32 v65, |v38|, |v39|, v65
    s_waitcnt vmcnt(3)
    v_lshlrev_b32 v40, 16, v16
    v_and_b32 v44, 0xffff0000, v16
    v_lshlrev_b32 v48, 16, v17
    v_and_b32 v52, 0xffff0000, v17
    s_waitcnt vmcnt(2)
    v_lshlrev_b32 v41, 16, v18
    v_and_b32 v45, 0xffff0000, v18
    v_lshlrev_b32 v49, 16, v19
    v_and_b32 v53, 0xffff0000, v19
    v_max3_f32 v62, |v40|, |v41|, v62
    v_max3_f32 v63, |v44|, |v45|, v63
    v_max3_f32 v64, |v48|, |v49|, v64
    v_max3_f32 v65, |v52|, |v53|, v65
    s_waitcnt vmcnt(1)
    v_lshlrev_b32 v42, 16, v20
    v_and_b32 v46, 0xffff0000, v20
    v_lshlrev_b32 v50, 16, v21
    v_and_b32 v54, 0xffff0000, v21
    s_waitcnt vmcnt(0)
    v_lshlrev_b32 v43, 16, v22
    v_and_b32 v47, 0xffff0000, v22
    v_lshlrev_b32 v51, 16, v23
    v_and_b32 v55, 0xffff0000, v23
    v_max3_f32 v62, |v42|, |v43|, v62
    v_max3_f32 v63, |v46|, |v47|, v63
    v_max3_f32 v64, |v50|, |v51|, v64
    v_max3_f32 v65, |v54|, |v55|, v65
CU_MAX:
    s_mov_b32 s10, 0x11111111
    s_mov_b32 s11, 0x11111111
    v_max_u32_dpp v62, v62, v62 row_ror:4 row_mask:0xf bank_mask:0xf
    v_max_u32_dpp v63, v63, v63 row_ror:4 row_mask:0xf bank_mask:0xf
    v_max_u32_dpp v64, v64, v64 row_ror:4 row_mask:0xf bank_mask:0xf
    v_max_u32_dpp v65, v65, v65 row_ror:4 row_mask:0xf bank_mask:0xf
    v_max_u32_dpp v61, v62, v62 row_ror:8 row_mask:0xf bank_mask:0x1
    s_nop 1
    v_max_u32_dpp v61, v63, v63 row_ror:8 row_mask:0xf bank_mask:0x2
    s_nop 1
    v_max_u32_dpp v61, v64, v64 row_ror:8 row_mask:0xf bank_mask:0x4
    s_nop 1
    v_max_u32_dpp v61, v65, v65 row_ror:8 row_mask:0xf bank_mask:0x8
    s_nop 1
    v_max_u32_dpp v61, v61, v61 quad_perm:[1,0,3,2] row_mask:0xf bank_mask:0xf
    s_nop 1
    v_max_u32_dpp v61, v61, v61 quad_perm:[2,3,0,1] row_mask:0xf bank_mask:0xf
    s_mov_b64 exec, s[10:11]
    ds_max_u32 v56, v61
    ds_max_u32 v136, v61
    s_mov_b64 exec, 1
    ds_add_u32 v57, v148 offset:68
    s_mov_b64 exec, -1
    s_mov_b32 s12, 0
SPN8:
    ds_read_b32 v60, v57 offset:68
    s_add_u32 s12, s12, 1
    s_waitcnt lgkmcnt(0)
    v_and_b32 v60, s73, v60
    v_cmp_ne_u32 vcc, s74, v60
    s_cmp_ge_u32 s12, 0x40000
    s_cbranch_scc1 SPX8
    s_cbranch_vccz SPX8
    s_sleep 1
    s_branch SPN8
SPX8:
    ds_read_b32 v62, v147
    ds_read_b32 v63, v146
    s_waitcnt lgkmcnt(1)
    v_lshrrev_b32 v62, 23, v62
    v_sub_u32 v62, 265, v62
    v_min_i32 v62, 253, v62
    v_lshlrev_b32 v64, 23, v62
    s_nop 1
    v_mov_b32_dpp v150, v64 quad_perm:[0,0,0,0] row_mask:0xf bank_mask:0xf
    v_mov_b32_dpp v151, v64 quad_perm:[1,1,1,1] row_mask:0xf bank_mask:0xf
    v_mov_b32_dpp v152, v64 quad_perm:[2,2,2,2] row_mask:0xf bank_mask:0xf
    v_mov_b32_dpp v153, v64 quad_perm:[3,3,3,3] row_mask:0xf bank_mask:0xf
    v_mul_f32 v66, v24, v150
    v_mul_f32 v67, v25, v150
    v_mul_f32 v68, v26, v150
    v_mul_f32 v69, v27, v150
    v_cvt_pk_f16_f32 v70, v67, v66
    v_cvt_pk_f16_f32 v71, v69, v68
    ds_write_b64 v58, v[70:71] offset:0
    v_mul_f32 v72, v28, v151
    v_mul_f32 v73, v29, v151
    v_mul_f32 v74, v30, v151
    v_mul_f32 v75, v31, v151
    v_cvt_pk_f16_f32 v76, v73, v72
    v_cvt_pk_f16_f32 v77, v75, v74
    ds_write_b64 v58, v[76:77] offset:8704
    v_mul_f32 v66, v32, v152
    v_mul_f32 v67, v33, v152
    v_mul_f32 v68, v34, v152
    v_mul_f32 v69, v35, v152
    v_cvt_pk_f16_f32 v70, v67, v66
    v_cvt_pk_f16_f32 v71, v69, v68
    ds_write_b64 v58, v[70:71] offset:17408
    v_mul_f32 v72, v36, v153
    v_mul_f32 v73, v37, v153
    v_mul_f32 v74, v38, v153
    v_mul_f32 v75, v39, v153
    v_cvt_pk_f16_f32 v76, v73, v72
    v_cvt_pk_f16_f32 v77, v75, v74
    ds_write_b64 v58, v[76:77] offset:26112
    v_mul_f32 v66, v40, v150
    v_mul_f32 v67, v41, v150
    v_mul_f32 v68, v42, v150
    v_mul_f32 v69, v43, v150
    v_cvt_pk_f16_f32 v70, v67, v66
    v_cvt_pk_f16_f32 v71, v69, v68
    ds_write_b64 v58, v[70:71] offset:1024
    v_mul_f32 v72, v44, v151
    v_mul_f32 v73, v45, v151
    v_mul_f32 v74, v46, v151
    v_mul_f32 v75, v47, v151
    v_cvt_pk_f16_f32 v76, v73, v72
    v_cvt_pk_f16_f32 v77, v75, v74
    ds_write_b64 v58, v[76:77] offset:9728
    v_mul_f32 v66, v48, v152
    v_mul_f32 v67, v49, v152
    v_mul_f32 v68, v50, v152
    v_mul_f32 v69, v51, v152
    v_cvt_pk_f16_f32 v70, v67, v66
    v_cvt_pk_f16_f32 v71, v69, v68
    ds_write_b64 v58, v[70:71] offset:18432
    v_mul_f32 v72, v52, v153
    v_mul_f32 v73, v53, v153
    v_mul_f32 v74, v54, v153
    v_mul_f32 v75, v55, v153
    v_cvt_pk_f16_f32 v76, v73, v72
    v_cvt_pk_f16_f32 v77, v75, v74
    ds_write_b64 v58, v[76:77] offset:27136
    s_cmp_lt_u32 s7, 2
    s_cbranch_scc1 CU_CVD
    s_mov_b32 s12, 0
SPN9:
    ds_read_b32 v60, v57 offset:72
    s_add_u32 s12, s12, 1
    s_waitcnt lgkmcnt(0)
    v_cmp_gt_u32 vcc, 2, v60
    s_cmp_ge_u32 s12, 0x40000
    s_cbranch_scc1 SPX9
    s_cbranch_vccz SPX9
    s_sleep 1
    s_branch SPN9
SPX9:
    s_sub_u32 s8, s7, 2
    s_lshl_b32 s9, s8, 1
    s_mul_i32 s8, s8, 17408
    s_add_u32 s8, s8, 126464
    v_lshl_add_u32 v60, v2, 3, s8
    ds_read_b64 v[66:67], v60
    ds_read_b64 v[68:69], v60 offset:8704
    v_lshrrev_b32 v63, 23, v63
    v_sub_u32 v63, 265, v63
    v_min_i32 v63, 253, v63
    v_sub_u32 v63, v62, v63
    v_add_u32 v63, 127, v63
    v_max_i32 v63, 0, v63
    v_lshlrev_b32 v63, 23, v63
    ds_write_b32 v146, v63 offset:96
    v_cvt_pk_f16_f32 v63, v63, v63
    s_add_u32 s8, s9, 1
    v_readlane_b32 s10, v63, s9
    v_readlane_b32 s11, v63, s8
    s_waitcnt lgkmcnt(1)
    v_pk_mul_f16 v66, v66, s10
    v_pk_mul_f16 v67, v67, s10
    v_pk_mul_f16 v68, v68, s11
    v_pk_mul_f16 v69, v69, s11
    ds_write_b64 v60, v[66:67] offset:512
    ds_write_b64 v60, v[68:69] offset:9216
CU_CVD:
    s_mov_b64 exec, 1
    ds_add_u32 v57, v139 offset:72
    s_mov_b64 exec, -1
    s_setprio 3
    v_lshlrev_b32 v154, 16, s52
    v_mov_b32 v155, s52
    v_lshlrev_b32 v156, 16, s53
    v_mov_b32 v157, s53
    v_and_b32 v155, 0xffff0000, v155
    v_and_b32 v157, 0xffff0000, v157
    s_cmp_ge_u32 s7, 2
    s_cbranch_scc1 E_NOG
    s_mov_b32 s12, 0
SPN10:
    ds_read_b32 v60, v57 offset:64
    s_add_u32 s12, s12, 1
    s_waitcnt lgkmcnt(0)
    v_cmp_gt_u32 vcc, 4, v60
    s_cmp_ge_u32 s12, 0x40000
    s_cbranch_scc1 SPX10
    s_cbranch_vccz SPX10
    s_sleep 2
    s_branch SPN10
SPX10:
    global_load_dwordx2 v[144:145], v59, s[48:49] sc1
    global_load_dwordx4 v[128:131], v7, s[50:51] offset:-4096 sc1
    global_load_dwordx4 v[132:135], v7, s[50:51] sc1
    global_load_dwordx4 v[160:163], v137, s[50:51] offset:-4096 sc1
    global_load_dwordx4 v[164:167], v138, s[50:51] sc1
    s_add_u32 s15, s7, 0
    s_cmp_ge_u32 s15, 0
    s_cbranch_scc1 CPF_DE0
    s_mul_i32 s14, s15, 18
    s_add_u32 s14, s14, s101
    v_mul_u32_u24 v140, 9216, v2
    s_mul_i32 s8, s4, 1152
    v_add_u32 v140, s8, v140
    s_mul_i32 s8, s14, 7282
    s_lshr_b32 s8, s8, 16
    s_mul_i32 s9, s8, 9
    s_sub_u32 s9, s14, s9
    s_lshl_b32 s9, s9, 7
    s_bitcmp1_b32 s8, 0
    s_cselect_b32 s12, s40, s38
    s_cselect_b32 s13, s41, s39
    s_lshr_b32 s8, s8, 1
    s_add_u32 s8, s8, 9
    s_mul_i32 s8, s8, 589824
    s_add_u32 s8, s8, s9
    v_add_u32 v148, s8, v140
    global_load_dword v149, v148, s[12:13]
    s_branch CPF_XE0
CPF_DE0:
    s_sub_u32 s14, s15, 0
    s_mul_i32 s14, s14, 18
    s_add_u32 s14, s14, s101
    s_min_u32 s14, s14, 80
    s_mul_i32 s8, s4, 81
    s_add_u32 s8, s8, s14
    s_lshl_b32 s8, s8, 13
    v_lshl_add_u32 v148, v2, 7, s8
    global_load_dword v149, v148, s[42:43]
CPF_XE0:
    s_add_u32 s15, s7, 2
    s_cmp_ge_u32 s15, 0
    s_cbranch_scc1 CPF_DE1
    s_mul_i32 s14, s15, 18
    s_add_u32 s14, s14, s101
    v_mul_u32_u24 v140, 9216, v2
    s_mul_i32 s8, s4, 1152
    v_add_u32 v140, s8, v140
    s_mul_i32 s8, s14, 7282
    s_lshr_b32 s8, s8, 16
    s_mul_i32 s9, s8, 9
    s_sub_u32 s9, s14, s9
    s_lshl_b32 s9, s9, 7
    s_bitcmp1_b32 s8, 0
    s_cselect_b32 s12, s40, s38
    s_cselect_b32 s13, s41, s39
    s_lshr_b32 s8, s8, 1
    s_add_u32 s8, s8, 9
    s_mul_i32 s8, s8, 589824
    s_add_u32 s8, s8, s9
    v_add_u32 v148, s8, v140
    global_load_dword v149, v148, s[12:13]
    s_branch CPF_XE1
CPF_DE1:
    s_sub_u32 s14, s15, 0
    s_mul_i32 s14, s14, 18
    s_add_u32 s14, s14, s101
    s_min_u32 s14, s14, 80
    s_mul_i32 s8, s4, 81
    s_add_u32 s8, s8, s14
    s_lshl_b32 s8, s8, 13
    v_lshl_add_u32 v148, v2, 7, s8
    global_load_dword v149, v148, s[42:43]
CPF_XE1:
E_NOG:
    v_and_b32 v56, 3, v2
    v_mul_u32_u24 v56, 320, v56
    v_lshrrev_b32 v136, 2, v2
    v_lshl_add_u32 v56, v136, 4, v56
    s_mul_i32 s8, s72, 1280
    v_add_u32 v56, s8, v56
    v_add_u32 v136, 40960, v56
    v_and_b32 v58, 7, v2
    s_lshl_b32 s8, s72, 5
    s_add_u32 s8, s8, 155904
    v_lshl_add_u32 v58, v58, 2, s8
    s_lshl_b32 s8, s72, 10
    v_lshl_add_u32 v147, v2, 4, s8
    v_lshlrev_b32 v148, 1, v147
    v_add_u32 v147, 98304, v147
    v_add_u32 v148, 81920, v148
    v_mul_f32 v64, v24, v154
    v_cvt_pk_bf16_f32 v64, 0, v64
    v_mul_f32 v65, v25, v154
    v_cvt_pk_bf16_f32 v65, 0, v65
    v_mul_f32 v66, v26, v154
    v_cvt_pk_bf16_f32 v66, 0, v66
    v_mul_f32 v67, v27, v154
    v_cvt_pk_bf16_f32 v67, 0, v67
    v_mul_f32 v68, v28, v155
    v_cvt_pk_bf16_f32 v68, 0, v68
    v_mul_f32 v69, v29, v155
    v_cvt_pk_bf16_f32 v69, 0, v69
    v_mul_f32 v70, v30, v155
    v_cvt_pk_bf16_f32 v70, 0, v70
    v_mul_f32 v71, v31, v155
    v_cvt_pk_bf16_f32 v71, 0, v71
    v_mul_f32 v72, v32, v156
    v_cvt_pk_bf16_f32 v72, 0, v72
    v_mul_f32 v73, v33, v156
    v_cvt_pk_bf16_f32 v73, 0, v73
    v_mul_f32 v74, v34, v156
    v_cvt_pk_bf16_f32 v74, 0, v74
    v_mul_f32 v75, v35, v156
    v_cvt_pk_bf16_f32 v75, 0, v75
    v_mul_f32 v76, v36, v157
    v_cvt_pk_bf16_f32 v76, 0, v76
    v_mul_f32 v77, v37, v157
    v_cvt_pk_bf16_f32 v77, 0, v77
    v_mul_f32 v78, v38, v157
    v_cvt_pk_bf16_f32 v78, 0, v78
    v_mul_f32 v79, v39, v157
    v_cvt_pk_bf16_f32 v79, 0, v79
    v_mul_f32 v80, v40, v154
    v_cvt_pk_bf16_f32 v80, 0, v80
    v_mul_f32 v81, v41, v154
    v_cvt_pk_bf16_f32 v81, 0, v81
    v_mul_f32 v82, v42, v154
    v_cvt_pk_bf16_f32 v82, 0, v82
    v_mul_f32 v83, v43, v154
    v_cvt_pk_bf16_f32 v83, 0, v83
    v_mul_f32 v84, v44, v155
    v_cvt_pk_bf16_f32 v84, 0, v84
    v_mul_f32 v85, v45, v155
    v_cvt_pk_bf16_f32 v85, 0, v85
    v_mul_f32 v86, v46, v155
    v_cvt_pk_bf16_f32 v86, 0, v86
    v_mul_f32 v87, v47, v155
    v_cvt_pk_bf16_f32 v87, 0, v87
    v_mul_f32 v88, v48, v156
    v_cvt_pk_bf16_f32 v88, 0, v88
    v_mul_f32 v89, v49, v156
    v_cvt_pk_bf16_f32 v89, 0, v89
    v_mul_f32 v90, v50, v156
    v_cvt_pk_bf16_f32 v90, 0, v90
    v_mul_f32 v91, v51, v156
    v_cvt_pk_bf16_f32 v91, 0, v91
    v_mul_f32 v92, v52, v157
    v_cvt_pk_bf16_f32 v92, 0, v92
    v_mul_f32 v93, v53, v157
    v_cvt_pk_bf16_f32 v93, 0, v93
    v_mul_f32 v94, v54, v157
    v_cvt_pk_bf16_f32 v94, 0, v94
    v_mul_f32 v95, v55, v157
    v_cvt_pk_bf16_f32 v95, 0, v95
    s_cmp_ge_u32 s7, 2
    s_cbranch_scc1 E_GATES
E_T0:
    s_mov_b32 s12, 0
SPN11:
    ds_read_b32 v60, v58 offset:0
    s_add_u32 s12, s12, 1
    s_waitcnt lgkmcnt(0)
    v_cmp_eq_u32 vcc, 0, v60
    s_cmp_ge_u32 s12, 0x40000
    s_cbranch_scc1 SPX11
    s_cbranch_vccz SPX11
    s_sleep 1
    s_branch SPN11
SPX11:
    ds_read_b32 v63, v146 offset:16
    ds_read_b128 v[96:99], v56 offset:0
    ds_read_b128 v[112:115], v56 offset:10240
    ds_read_b128 v[100:103], v56 offset:20480
    ds_read_b128 v[116:119], v56 offset:30720
    ds_read_b128 v[104:107], v136 offset:0
    ds_read_b128 v[120:123], v136 offset:10240
    ds_read_b128 v[108:111], v136 offset:20480
    ds_read_b128 v[124:127], v136 offset:30720
    s_waitcnt lgkmcnt(8)
    v_add_u32 v62, v62, v63
    v_sub_u32 v62, 381, v62
    v_max_i32 v62, 0, v62
    v_min_i32 v62, 254, v62
    v_lshlrev_b32 v62, 23, v62
    s_nop 1
    v_mov_b32_dpp v150, v62 quad_perm:[0,0,0,0] row_mask:0xf bank_mask:0xf
    v_mov_b32_dpp v151, v62 quad_perm:[1,1,1,1] row_mask:0xf bank_mask:0xf
    v_mov_b32_dpp v152, v62 quad_perm:[2,2,2,2] row_mask:0xf bank_mask:0xf
    v_mov_b32_dpp v153, v62 quad_perm:[3,3,3,3] row_mask:0xf bank_mask:0xf
    s_waitcnt lgkmcnt(6)
    v_add_f32 v96, v96, v112
    v_cvt_pk_bf16_f32 v96, 0, v96
    v_fma_f32 v96, v96, v150, v64
    v_cvt_pk_bf16_f32 v96, 0, v96
    v_add_f32 v97, v97, v113
    v_cvt_pk_bf16_f32 v97, 0, v97
    v_fma_f32 v97, v97, v150, v65
    v_cvt_pk_bf16_f32 v97, 0, v97
    v_add_f32 v98, v98, v114
    v_cvt_pk_bf16_f32 v98, 0, v98
    v_fma_f32 v98, v98, v150, v66
    v_cvt_pk_bf16_f32 v98, 0, v98
    v_add_f32 v99, v99, v115
    v_cvt_pk_bf16_f32 v99, 0, v99
    v_fma_f32 v99, v99, v150, v67
    v_cvt_pk_bf16_f32 v99, 0, v99
    s_waitcnt lgkmcnt(4)
    v_add_f32 v100, v100, v116
    v_cvt_pk_bf16_f32 v100, 0, v100
    v_fma_f32 v100, v100, v151, v68
    v_cvt_pk_bf16_f32 v100, 0, v100
    v_add_f32 v101, v101, v117
    v_cvt_pk_bf16_f32 v101, 0, v101
    v_fma_f32 v101, v101, v151, v69
    v_cvt_pk_bf16_f32 v101, 0, v101
    v_add_f32 v102, v102, v118
    v_cvt_pk_bf16_f32 v102, 0, v102
    v_fma_f32 v102, v102, v151, v70
    v_cvt_pk_bf16_f32 v102, 0, v102
    v_add_f32 v103, v103, v119
    v_cvt_pk_bf16_f32 v103, 0, v103
    v_fma_f32 v103, v103, v151, v71
    v_cvt_pk_bf16_f32 v103, 0, v103
    s_waitcnt lgkmcnt(2)
    v_add_f32 v104, v104, v120
    v_cvt_pk_bf16_f32 v104, 0, v104
    v_fma_f32 v104, v104, v152, v72
    v_cvt_pk_bf16_f32 v104, 0, v104
    v_add_f32 v105, v105, v121
    v_cvt_pk_bf16_f32 v105, 0, v105
    v_fma_f32 v105, v105, v152, v73
    v_cvt_pk_bf16_f32 v105, 0, v105
    v_add_f32 v106, v106, v122
    v_cvt_pk_bf16_f32 v106, 0, v106
    v_fma_f32 v106, v106, v152, v74
    v_cvt_pk_bf16_f32 v106, 0, v106
    v_add_f32 v107, v107, v123
    v_cvt_pk_bf16_f32 v107, 0, v107
    v_fma_f32 v107, v107, v152, v75
    v_cvt_pk_bf16_f32 v107, 0, v107
    s_waitcnt lgkmcnt(0)
    v_add_f32 v108, v108, v124
    v_cvt_pk_bf16_f32 v108, 0, v108
    v_fma_f32 v108, v108, v153, v76
    v_cvt_pk_bf16_f32 v108, 0, v108
    v_add_f32 v109, v109, v125
    v_cvt_pk_bf16_f32 v109, 0, v109
    v_fma_f32 v109, v109, v153, v77
    v_cvt_pk_bf16_f32 v109, 0, v109
    v_add_f32 v110, v110, v126
    v_cvt_pk_bf16_f32 v110, 0, v110
    v_fma_f32 v110, v110, v153, v78
    v_cvt_pk_bf16_f32 v110, 0, v110
    v_add_f32 v111, v111, v127
    v_cvt_pk_bf16_f32 v111, 0, v111
    v_fma_f32 v111, v111, v153, v79
    v_cvt_pk_bf16_f32 v111, 0, v111
    s_cmp_ge_u32 s7, 2
    s_cbranch_scc1 E_OUT0
E_GATES:
    s_cmp_lt_u32 s7, 2
    s_cbranch_scc1 E_G1
    s_mov_b32 s12, 0
SPN12:
    ds_read_b32 v60, v57 offset:116
    s_add_u32 s12, s12, 1
    s_waitcnt lgkmcnt(0)
    v_cmp_ne_u32 vcc, 2, v60
    s_cmp_ge_u32 s12, 0x40000
    s_cbranch_scc1 SPX12
    s_cbranch_vccz SPX12
    s_sleep 1
    s_branch SPN12
SPX12:
    ds_read_b128 v[128:131], v147
    ds_read_b128 v[132:135], v147 offset:2048
    s_waitcnt lgkmcnt(0)
    s_branch E_GX
E_G1:
    s_mov_b32 s12, 0
    s_waitcnt vmcnt(2)
    s_branch E_GCHK
E_GPOLL:
    global_load_dwordx2 v[144:145], v59, s[48:49] sc1
    global_load_dwordx4 v[128:131], v7, s[50:51] offset:-4096 sc1
    global_load_dwordx4 v[132:135], v7, s[50:51] sc1
    global_load_dwordx4 v[160:163], v137, s[50:51] offset:-4096 sc1
    global_load_dwordx4 v[164:167], v138, s[50:51] sc1
    s_add_u32 s12, s12, 1
    s_waitcnt vmcnt(0)
E_GCHK:
    v_xor_b32 v61, 1, v145
    v_bitop3_b32 v61, v61, v128, v144 bitop3:0xf6
    v_bitop3_b32 v61, v61, v129, v144 bitop3:0xf6
    v_bitop3_b32 v61, v61, v130, v144 bitop3:0xf6
    v_bitop3_b32 v61, v61, v131, v144 bitop3:0xf6
    v_bitop3_b32 v61, v61, v132, v144 bitop3:0xf6
    v_bitop3_b32 v61, v61, v133, v144 bitop3:0xf6
    v_bitop3_b32 v61, v61, v134, v144 bitop3:0xf6
    v_bitop3_b32 v61, v61, v135, v144 bitop3:0xf6
    v_bitop3_b32 v61, v61, v160, v144 bitop3:0xf6
    v_bitop3_b32 v61, v61, v161, v144 bitop3:0xf6
    v_bitop3_b32 v61, v61, v162, v144 bitop3:0xf6
    v_bitop3_b32 v61, v61, v163, v144 bitop3:0xf6
    v_bitop3_b32 v61, v61, v164, v144 bitop3:0xf6
    v_bitop3_b32 v61, v61, v165, v144 bitop3:0xf6
    v_bitop3_b32 v61, v61, v166, v144 bitop3:0xf6
    v_bitop3_b32 v61, v61, v167, v144 bitop3:0xf6
    v_and_b32 v61, 0xffff, v61
    v_cmp_ne_u32 vcc, 0, v61
    s_cmp_ge_u32 s12, 16384
    s_cbranch_scc1 E_GOK
    s_cbranch_vccnz E_GPOLL
E_GOK:
    ds_write_b128 v147, v[160:163] offset:4096
    ds_write_b128 v147, v[164:167] offset:6144
    ds_write_b128 v147, v[128:131] offset:0
    ds_write_b128 v147, v[132:135] offset:2048
    ds_write_b32 v57, v144 offset:120
    s_mov_b64 exec, 1
    ds_add_u32 v57, v139 offset:116
    s_mov_b64 exec, -1
E_GX:
    ds_write_b128 v148, v[8:11] offset:0
    ds_write_b128 v148, v[12:15] offset:16
    ds_write_b128 v148, v[16:19] offset:4096
    ds_write_b128 v148, v[20:23] offset:4112
    s_mov_b64 exec, 1
    ds_add_u32 v57, v139 offset:112
    s_mov_b64 exec, -1
    v_and_b32 v128, 0xffff0000, v128
    v_sub_f32 v140, 1.0, v128
    v_cvt_pk_bf16_f32 v140, 0, v140
    v_and_b32 v129, 0xffff0000, v129
    v_sub_f32 v141, 1.0, v129
    v_cvt_pk_bf16_f32 v141, 0, v141
    v_and_b32 v130, 0xffff0000, v130
    v_sub_f32 v142, 1.0, v130
    v_cvt_pk_bf16_f32 v142, 0, v142
    v_and_b32 v131, 0xffff0000, v131
    v_sub_f32 v143, 1.0, v131
    v_cvt_pk_bf16_f32 v143, 0, v143
    v_mul_f32 v24, v24, v140
    v_cvt_pk_bf16_f32 v24, 0, v24
    v_mul_f32 v25, v25, v141
    v_cvt_pk_bf16_f32 v25, 0, v25
    v_mul_f32 v26, v26, v142
    v_cvt_pk_bf16_f32 v26, 0, v26
    v_mul_f32 v27, v27, v143
    v_cvt_pk_bf16_f32 v27, 0, v27
    v_mul_f32 v28, v28, v140
    v_cvt_pk_bf16_f32 v28, 0, v28
    v_mul_f32 v29, v29, v141
    v_cvt_pk_bf16_f32 v29, 0, v29
    v_mul_f32 v30, v30, v142
    v_cvt_pk_bf16_f32 v30, 0, v30
    v_mul_f32 v31, v31, v143
    v_cvt_pk_bf16_f32 v31, 0, v31
    v_mul_f32 v32, v32, v140
    v_cvt_pk_bf16_f32 v32, 0, v32
    v_mul_f32 v33, v33, v141
    v_cvt_pk_bf16_f32 v33, 0, v33
    v_mul_f32 v34, v34, v142
    v_cvt_pk_bf16_f32 v34, 0, v34
    v_mul_f32 v35, v35, v143
    v_cvt_pk_bf16_f32 v35, 0, v35
    v_mul_f32 v36, v36, v140
    v_cvt_pk_bf16_f32 v36, 0, v36
    v_mul_f32 v37, v37, v141
    v_cvt_pk_bf16_f32 v37, 0, v37
    v_mul_f32 v38, v38, v142
    v_cvt_pk_bf16_f32 v38, 0, v38
    v_mul_f32 v39, v39, v143
    v_cvt_pk_bf16_f32 v39, 0, v39
    s_cmp_ge_u32 s7, 2
    s_cbranch_scc1 E_T0
E_OUT0:
    v_mul_f32 v96, v96, v128
    v_cvt_pk_bf16_f32 v96, 0, v96
    v_add_f32 v96, v96, v24
    v_mul_f32 v100, v100, v128
    v_cvt_pk_bf16_f32 v100, 0, v100
    v_add_f32 v100, v100, v28
    v_mul_f32 v104, v104, v128
    v_cvt_pk_bf16_f32 v104, 0, v104
    v_add_f32 v104, v104, v32
    v_mul_f32 v108, v108, v128
    v_cvt_pk_bf16_f32 v108, 0, v108
    v_add_f32 v108, v108, v36
    v_cvt_pk_bf16_f32 v112, v96, v100
    v_cvt_pk_bf16_f32 v113, v104, v108
    global_store_dwordx2 v5, v[112:113], s[46:47] offset:0
    v_mul_f32 v97, v97, v129
    v_cvt_pk_bf16_f32 v97, 0, v97
    v_add_f32 v97, v97, v25
    v_mul_f32 v101, v101, v129
    v_cvt_pk_bf16_f32 v101, 0, v101
    v_add_f32 v101, v101, v29
    v_mul_f32 v105, v105, v129
    v_cvt_pk_bf16_f32 v105, 0, v105
    v_add_f32 v105, v105, v33
    v_mul_f32 v109, v109, v129
    v_cvt_pk_bf16_f32 v109, 0, v109
    v_add_f32 v109, v109, v37
    v_cvt_pk_bf16_f32 v114, v97, v101
    v_cvt_pk_bf16_f32 v115, v105, v109
    global_store_dwordx2 v5, v[114:115], s[46:47] offset:1152
    v_mul_f32 v98, v98, v130
    v_cvt_pk_bf16_f32 v98, 0, v98
    v_add_f32 v98, v98, v26
    v_mul_f32 v102, v102, v130
    v_cvt_pk_bf16_f32 v102, 0, v102
    v_add_f32 v102, v102, v30
    v_mul_f32 v106, v106, v130
    v_cvt_pk_bf16_f32 v106, 0, v106
    v_add_f32 v106, v106, v34
    v_mul_f32 v110, v110, v130
    v_cvt_pk_bf16_f32 v110, 0, v110
    v_add_f32 v110, v110, v38
    v_cvt_pk_bf16_f32 v116, v98, v102
    v_cvt_pk_bf16_f32 v117, v106, v110
    global_store_dwordx2 v5, v[116:117], s[46:47] offset:2304
    v_mul_f32 v99, v99, v131
    v_cvt_pk_bf16_f32 v99, 0, v99
    v_add_f32 v99, v99, v27
    v_mul_f32 v103, v103, v131
    v_cvt_pk_bf16_f32 v103, 0, v103
    v_add_f32 v103, v103, v31
    v_mul_f32 v107, v107, v131
    v_cvt_pk_bf16_f32 v107, 0, v107
    v_add_f32 v107, v107, v35
    v_mul_f32 v111, v111, v131
    v_cvt_pk_bf16_f32 v111, 0, v111
    v_add_f32 v111, v111, v39
    v_cvt_pk_bf16_f32 v118, v99, v103
    v_cvt_pk_bf16_f32 v119, v107, v111
    global_store_dwordx2 v5, v[118:119], s[46:47] offset:3456
    v_and_b32 v132, 0xffff0000, v132
    v_sub_f32 v140, 1.0, v132
    v_cvt_pk_bf16_f32 v140, 0, v140
    v_and_b32 v133, 0xffff0000, v133
    v_sub_f32 v141, 1.0, v133
    v_cvt_pk_bf16_f32 v141, 0, v141
    v_and_b32 v134, 0xffff0000, v134
    v_sub_f32 v142, 1.0, v134
    v_cvt_pk_bf16_f32 v142, 0, v142
    v_and_b32 v135, 0xffff0000, v135
    v_sub_f32 v143, 1.0, v135
    v_cvt_pk_bf16_f32 v143, 0, v143
    v_mul_f32 v40, v40, v140
    v_cvt_pk_bf16_f32 v40, 0, v40
    v_mul_f32 v41, v41, v141
    v_cvt_pk_bf16_f32 v41, 0, v41
    v_mul_f32 v42, v42, v142
    v_cvt_pk_bf16_f32 v42, 0, v42
    v_mul_f32 v43, v43, v143
    v_cvt_pk_bf16_f32 v43, 0, v43
    v_mul_f32 v44, v44, v140
    v_cvt_pk_bf16_f32 v44, 0, v44
    v_mul_f32 v45, v45, v141
    v_cvt_pk_bf16_f32 v45, 0, v45
    v_mul_f32 v46, v46, v142
    v_cvt_pk_bf16_f32 v46, 0, v46
    v_mul_f32 v47, v47, v143
    v_cvt_pk_bf16_f32 v47, 0, v47
    v_mul_f32 v48, v48, v140
    v_cvt_pk_bf16_f32 v48, 0, v48
    v_mul_f32 v49, v49, v141
    v_cvt_pk_bf16_f32 v49, 0, v49
    v_mul_f32 v50, v50, v142
    v_cvt_pk_bf16_f32 v50, 0, v50
    v_mul_f32 v51, v51, v143
    v_cvt_pk_bf16_f32 v51, 0, v51
    v_mul_f32 v52, v52, v140
    v_cvt_pk_bf16_f32 v52, 0, v52
    v_mul_f32 v53, v53, v141
    v_cvt_pk_bf16_f32 v53, 0, v53
    v_mul_f32 v54, v54, v142
    v_cvt_pk_bf16_f32 v54, 0, v54
    v_mul_f32 v55, v55, v143
    v_cvt_pk_bf16_f32 v55, 0, v55
    s_mov_b32 s12, 0
SPN13:
    ds_read_b32 v60, v58 offset:64
    s_add_u32 s12, s12, 1
    s_waitcnt lgkmcnt(0)
    v_cmp_eq_u32 vcc, 0, v60
    s_cmp_ge_u32 s12, 0x40000
    s_cbranch_scc1 SPX13
    s_cbranch_vccz SPX13
    s_sleep 1
    s_branch SPN13
SPX13:
    ds_read_b128 v[96:99], v56 offset:2560
    ds_read_b128 v[112:115], v56 offset:12800
    ds_read_b128 v[100:103], v56 offset:23040
    ds_read_b128 v[116:119], v56 offset:33280
    ds_read_b128 v[104:107], v136 offset:2560
    ds_read_b128 v[120:123], v136 offset:12800
    ds_read_b128 v[108:111], v136 offset:23040
    ds_read_b128 v[124:127], v136 offset:33280
    s_waitcnt lgkmcnt(6)
    v_add_f32 v96, v96, v112
    v_cvt_pk_bf16_f32 v96, 0, v96
    v_fma_f32 v96, v96, v150, v80
    v_cvt_pk_bf16_f32 v96, 0, v96
    v_add_f32 v97, v97, v113
    v_cvt_pk_bf16_f32 v97, 0, v97
    v_fma_f32 v97, v97, v150, v81
    v_cvt_pk_bf16_f32 v97, 0, v97
    v_add_f32 v98, v98, v114
    v_cvt_pk_bf16_f32 v98, 0, v98
    v_fma_f32 v98, v98, v150, v82
    v_cvt_pk_bf16_f32 v98, 0, v98
    v_add_f32 v99, v99, v115
    v_cvt_pk_bf16_f32 v99, 0, v99
    v_fma_f32 v99, v99, v150, v83
    v_cvt_pk_bf16_f32 v99, 0, v99
    s_waitcnt lgkmcnt(4)
    v_add_f32 v100, v100, v116
    v_cvt_pk_bf16_f32 v100, 0, v100
    v_fma_f32 v100, v100, v151, v84
    v_cvt_pk_bf16_f32 v100, 0, v100
    v_add_f32 v101, v101, v117
    v_cvt_pk_bf16_f32 v101, 0, v101
    v_fma_f32 v101, v101, v151, v85
    v_cvt_pk_bf16_f32 v101, 0, v101
    v_add_f32 v102, v102, v118
    v_cvt_pk_bf16_f32 v102, 0, v102
    v_fma_f32 v102, v102, v151, v86
    v_cvt_pk_bf16_f32 v102, 0, v102
    v_add_f32 v103, v103, v119
    v_cvt_pk_bf16_f32 v103, 0, v103
    v_fma_f32 v103, v103, v151, v87
    v_cvt_pk_bf16_f32 v103, 0, v103
    s_waitcnt lgkmcnt(2)
    v_add_f32 v104, v104, v120
    v_cvt_pk_bf16_f32 v104, 0, v104
    v_fma_f32 v104, v104, v152, v88
    v_cvt_pk_bf16_f32 v104, 0, v104
    v_add_f32 v105, v105, v121
    v_cvt_pk_bf16_f32 v105, 0, v105
    v_fma_f32 v105, v105, v152, v89
    v_cvt_pk_bf16_f32 v105, 0, v105
    v_add_f32 v106, v106, v122
    v_cvt_pk_bf16_f32 v106, 0, v106
    v_fma_f32 v106, v106, v152, v90
    v_cvt_pk_bf16_f32 v106, 0, v106
    v_add_f32 v107, v107, v123
    v_cvt_pk_bf16_f32 v107, 0, v107
    v_fma_f32 v107, v107, v152, v91
    v_cvt_pk_bf16_f32 v107, 0, v107
    s_waitcnt lgkmcnt(0)
    v_add_f32 v108, v108, v124
    v_cvt_pk_bf16_f32 v108, 0, v108
    v_fma_f32 v108, v108, v153, v92
    v_cvt_pk_bf16_f32 v108, 0, v108
    v_add_f32 v109, v109, v125
    v_cvt_pk_bf16_f32 v109, 0, v109
    v_fma_f32 v109, v109, v153, v93
    v_cvt_pk_bf16_f32 v109, 0, v109
    v_add_f32 v110, v110, v126
    v_cvt_pk_bf16_f32 v110, 0, v110
    v_fma_f32 v110, v110, v153, v94
    v_cvt_pk_bf16_f32 v110, 0, v110
    v_add_f32 v111, v111, v127
    v_cvt_pk_bf16_f32 v111, 0, v111
    v_fma_f32 v111, v111, v153, v95
    v_cvt_pk_bf16_f32 v111, 0, v111
    v_mul_f32 v96, v96, v132
    v_cvt_pk_bf16_f32 v96, 0, v96
    v_add_f32 v96, v96, v40
    v_mul_f32 v100, v100, v132
    v_cvt_pk_bf16_f32 v100, 0, v100
    v_add_f32 v100, v100, v44
    v_mul_f32 v104, v104, v132
    v_cvt_pk_bf16_f32 v104, 0, v104
    v_add_f32 v104, v104, v48
    v_mul_f32 v108, v108, v132
    v_cvt_pk_bf16_f32 v108, 0, v108
    v_add_f32 v108, v108, v52
    v_cvt_pk_bf16_f32 v112, v96, v100
    v_cvt_pk_bf16_f32 v113, v104, v108
    global_store_dwordx2 v6, v[112:113], s[46:47] offset:0
    v_mul_f32 v97, v97, v133
    v_cvt_pk_bf16_f32 v97, 0, v97
    v_add_f32 v97, v97, v41
    v_mul_f32 v101, v101, v133
    v_cvt_pk_bf16_f32 v101, 0, v101
    v_add_f32 v101, v101, v45
    v_mul_f32 v105, v105, v133
    v_cvt_pk_bf16_f32 v105, 0, v105
    v_add_f32 v105, v105, v49
    v_mul_f32 v109, v109, v133
    v_cvt_pk_bf16_f32 v109, 0, v109
    v_add_f32 v109, v109, v53
    v_cvt_pk_bf16_f32 v114, v97, v101
    v_cvt_pk_bf16_f32 v115, v105, v109
    global_store_dwordx2 v6, v[114:115], s[46:47] offset:1152
    v_mul_f32 v98, v98, v134
    v_cvt_pk_bf16_f32 v98, 0, v98
    v_add_f32 v98, v98, v42
    v_mul_f32 v102, v102, v134
    v_cvt_pk_bf16_f32 v102, 0, v102
    v_add_f32 v102, v102, v46
    v_mul_f32 v106, v106, v134
    v_cvt_pk_bf16_f32 v106, 0, v106
    v_add_f32 v106, v106, v50
    v_mul_f32 v110, v110, v134
    v_cvt_pk_bf16_f32 v110, 0, v110
    v_add_f32 v110, v110, v54
    v_cvt_pk_bf16_f32 v116, v98, v102
    v_cvt_pk_bf16_f32 v117, v106, v110
    global_store_dwordx2 v6, v[116:117], s[46:47] offset:2304
    v_mul_f32 v99, v99, v135
    v_cvt_pk_bf16_f32 v99, 0, v99
    v_add_f32 v99, v99, v43
    v_mul_f32 v103, v103, v135
    v_cvt_pk_bf16_f32 v103, 0, v103
    v_add_f32 v103, v103, v47
    v_mul_f32 v107, v107, v135
    v_cvt_pk_bf16_f32 v107, 0, v107
    v_add_f32 v107, v107, v51
    v_mul_f32 v111, v111, v135
    v_cvt_pk_bf16_f32 v111, 0, v111
    v_add_f32 v111, v111, v55
    v_cvt_pk_bf16_f32 v118, v99, v103
    v_cvt_pk_bf16_f32 v119, v107, v111
    global_store_dwordx2 v6, v[118:119], s[46:47] offset:3456
    s_waitcnt vmcnt(0)
    s_endpgm
FINAL:
    v_and_b32 v5, 7, v2
    v_lshlrev_b32 v5, 2, v5
    s_lshl_b32 s10, s6, 3
    s_load_dwordx2 s[52:53], s[32:33], s10
    s_mov_b32 s12, 0
SPN14:
    ds_read_b32 v42, v167 offset:112
    s_add_u32 s12, s12, 1
    s_waitcnt lgkmcnt(0)
    v_cmp_ne_u32 vcc, 4, v42
    s_cmp_ge_u32 s12, 0x40000
    s_cbranch_scc1 SPX14
    s_cbranch_vccz SPX14
    s_sleep 1
    s_branch SPN14
SPX14:
    ds_read_b32 v42, v167 offset:120
    s_waitcnt lgkmcnt(0)
    v_and_b32 v6, 7, v2
    s_lshl_b32 s9, s4, 8
    v_lshl_add_u32 v6, v6, 3, s9
    s_mov_b32 s12, 0
    s_waitcnt vmcnt(0)
    v_mov_b32 v8, v124
    v_mov_b32 v9, v125
    s_branch SPC_F
SP_F:
    s_add_u32 s12, s12, 1
    s_and_b32 s9, s12, 7
    s_cselect_b32 s9, 0, 128
    v_add_u32 v10, s9, v6
    global_load_dwordx2 v[8:9], v10, s[50:51] offset:256 sc1
    s_waitcnt vmcnt(0)
SPC_F:
    v_cmp_ne_u32 vcc, v9, v42
    s_cmp_ge_u32 s12, 16384
    s_cbranch_scc1 SPX_F
    s_cbranch_vccz SPX_F
    s_mov_b64 exec, vcc
    s_sleep 2
    s_branch SP_F
SPX_F:
    s_mov_b64 exec, -1
    v_mov_b32 v9, v42
    v_not_b32 v10, v8
    v_and_b32 v10, 0x7ff, v10
    v_mul_u32_u24 v11, 1152, v10
    v_add_u32 v11, s10, v11
    v_lshlrev_b32 v14, 3, v10
    v_add_u32 v14, 81920, v14
    ds_read_b64 v[12:13], v14
    v_lshlrev_b32 v14, 2, v10
    v_add_u32 v14, 98304, v14
    ds_read_b32 v15, v14
    v_lshrrev_b32 v16, 8, v10
    v_mul_u32_u24 v16, 1280, v16
    v_and_b32 v17, 0xf0, v10
    v_add_u32 v16, v16, v17
    v_bfe_u32 v17, v10, 2, 2
    v_mul_u32_u24 v17, 320, v17
    v_add_u32 v16, v16, v17
    v_and_b32 v17, 3, v10
    v_lshl_add_u32 v16, v17, 2, v16
    v_add_u32 v17, 40960, v16
    v_add_u32 v18, 156128, v5
    v_mov_b32 v19, 155648
    ds_read_b128 v[44:47], v19 offset:16
    v_lshrrev_b32 v36, 10, v10
    v_mul_u32_u24 v36, 80, v36
    v_add_u32 v19, v19, v36
    ds_read_b128 v[36:39], v19
    v_and_b32 v20, 0xffff0000, v8
    v_not_b32 v21, v20
    v_ashrrev_i32 v21, 31, v21
    v_and_b32 v21, 0x7fff0000, v21
    v_or_b32 v21, 0x80000000, v21
    v_xor_b32 v20, v20, v21
    v_mul_f32 v21, 0xbfb8aa3b, v20
    v_exp_f32 v21, v21
    s_nop 0
    v_add_f32 v21, 1.0, v21
    v_rcp_f32 v21, v21
    s_nop 0
    v_cvt_pk_bf16_f32 v20, v21, v21
    v_and_b32 v20, 0xffff0000, v20
    s_waitcnt lgkmcnt(0)
    v_and_b32 v15, 0xffff0000, v15
    v_sub_f32 v21, 1.0, v15
    v_cvt_pk_bf16_f32 v21, v21, v21
    v_and_b32 v21, 0xffff0000, v21
    v_lshlrev_b32 v24, 16, v12
    v_and_b32 v25, 0xffff0000, v12
    v_lshlrev_b32 v26, 16, v13
    v_and_b32 v27, 0xffff0000, v13
    s_waitcnt lgkmcnt(0)
    v_lshrrev_b32 v36, 23, v36
    v_sub_u32 v36, 265, v36
    v_min_i32 v36, 253, v36
    v_add_u32 v36, v36, v44
    v_sub_u32 v36, 381, v36
    v_max_i32 v36, 0, v36
    v_min_i32 v36, 254, v36
    v_lshlrev_b32 v36, 23, v36
    v_lshrrev_b32 v37, 23, v37
    v_sub_u32 v37, 265, v37
    v_min_i32 v37, 253, v37
    v_add_u32 v37, v37, v45
    v_sub_u32 v37, 381, v37
    v_max_i32 v37, 0, v37
    v_min_i32 v37, 254, v37
    v_lshlrev_b32 v37, 23, v37
    v_lshrrev_b32 v38, 23, v38
    v_sub_u32 v38, 265, v38
    v_min_i32 v38, 253, v38
    v_add_u32 v38, v38, v46
    v_sub_u32 v38, 381, v38
    v_max_i32 v38, 0, v38
    v_min_i32 v38, 254, v38
    v_lshlrev_b32 v38, 23, v38
    v_lshrrev_b32 v39, 23, v39
    v_sub_u32 v39, 265, v39
    v_min_i32 v39, 253, v39
    v_add_u32 v39, v39, v47
    v_sub_u32 v39, 381, v39
    v_max_i32 v39, 0, v39
    v_min_i32 v39, 254, v39
    v_lshlrev_b32 v39, 23, v39
    s_mov_b32 s12, 0
FN_WAIT:
    ds_read_b32 v22, v18
    s_add_u32 s12, s12, 1
    s_waitcnt lgkmcnt(0)
    v_cmp_eq_u32 vcc, 0, v22
    s_cmp_ge_u32 s12, 0x40000
    s_cbranch_scc1 FN_RDY
    s_cbranch_vccz FN_RDY
    s_sleep 1
    s_branch FN_WAIT
FN_RDY:
    ds_read_b32 v28, v16 offset:0
    ds_read_b32 v32, v16 offset:10240
    ds_read_b32 v29, v16 offset:20480
    ds_read_b32 v33, v16 offset:30720
    ds_read_b32 v30, v17 offset:0
    ds_read_b32 v34, v17 offset:10240
    ds_read_b32 v31, v17 offset:20480
    ds_read_b32 v35, v17 offset:30720
    s_lshl_b32 s60, s52, 16
    s_and_b32 s61, s52, 0xffff0000
    s_lshl_b32 s62, s53, 16
    s_and_b32 s63, s53, 0xffff0000
    s_mul_i32 s8, s6, 9216
    s_add_u32 s8, s8, 45056
    v_lshl_add_u32 v22, v2, 4, s8
    v_add_u32 v23, 4096, v22
    s_waitcnt lgkmcnt(0)
    v_add_f32 v28, v28, v32
    v_mul_f32 v28, v28, v36
    v_mul_f32 v32, s60, v24
    v_add_f32 v29, v29, v33
    v_mul_f32 v29, v29, v37
    v_mul_f32 v33, s61, v25
    v_add_f32 v30, v30, v34
    v_mul_f32 v30, v30, v38
    v_mul_f32 v34, s62, v26
    v_add_f32 v31, v31, v35
    v_mul_f32 v31, v31, v39
    v_mul_f32 v35, s63, v27
    v_cvt_pk_bf16_f32 v28, 0, v28
    v_cvt_pk_bf16_f32 v29, 0, v29
    v_cvt_pk_bf16_f32 v30, 0, v30
    v_cvt_pk_bf16_f32 v31, 0, v31
    v_cvt_pk_bf16_f32 v32, 0, v32
    v_cvt_pk_bf16_f32 v33, 0, v33
    v_cvt_pk_bf16_f32 v34, 0, v34
    v_cvt_pk_bf16_f32 v35, 0, v35
    v_add_f32 v28, v28, v32
    v_add_f32 v29, v29, v33
    v_add_f32 v30, v30, v34
    v_add_f32 v31, v31, v35
    v_cvt_pk_bf16_f32 v28, 0, v28
    v_cvt_pk_bf16_f32 v29, 0, v29
    v_cvt_pk_bf16_f32 v30, 0, v30
    v_cvt_pk_bf16_f32 v31, 0, v31
    v_mul_f32 v28, v28, v15
    v_mul_f32 v29, v29, v15
    v_mul_f32 v30, v30, v15
    v_mul_f32 v31, v31, v15
    v_cvt_pk_bf16_f32 v28, 0, v28
    v_cvt_pk_bf16_f32 v29, 0, v29
    v_cvt_pk_bf16_f32 v30, 0, v30
    v_cvt_pk_bf16_f32 v31, 0, v31
    v_and_b32 v33, 7, v2
    v_mul_u32_u24 v33, 1152, v33
    s_mul_i32 s11, s101, 29
    s_lshr_b32 s11, s11, 6
    s_lshl_b32 s11, s11, 7
    s_add_u32 s11, s11, s8
    v_add_u32 v33, s11, v33
    s_mov_b32 s12, 0
FN_R:
    global_load_dword v34, v33, s[50:51] offset:-4096 sc1
    s_add_u32 s12, s12, 1
    s_waitcnt vmcnt(0)
    v_xor_b32 v34, v34, v9
    v_and_b32 v34, 0xff, v34
    v_cmp_ne_u32 vcc, 0, v34
    s_cmp_ge_u32 s12, 16384
    s_cbranch_scc1 FN_RX
    s_cbranch_vccz FN_RX
    s_mov_b64 exec, vcc
    s_sleep 2
    s_branch FN_R
FN_RX:
    s_mov_b64 exec, -1
    s_mov_b32 s12, 0
FN_P:
    global_load_dwordx4 v[48:51], v22, s[50:51] offset:-4096 sc1
    global_load_dwordx4 v[52:55], v22, s[50:51] offset:-3072 sc1
    global_load_dwordx4 v[56:59], v22, s[50:51] offset:-2048 sc1
    global_load_dwordx4 v[60:63], v22, s[50:51] offset:-1024 sc1
    global_load_dwordx4 v[64:67], v22, s[50:51] offset:0 sc1
    global_load_dwordx4 v[68:71], v22, s[50:51] offset:1024 sc1
    global_load_dwordx4 v[72:75], v22, s[50:51] offset:2048 sc1
    global_load_dwordx4 v[76:79], v22, s[50:51] offset:3072 sc1
    global_load_dwordx4 v[80:83], v23, s[50:51] offset:0 sc1
    s_add_u32 s12, s12, 1
    s_waitcnt vmcnt(8)
    v_xor_b32 v32, v48, v9
    v_bitop3_b32 v32, v32, v49, v9 bitop3:0xf6
    v_bitop3_b32 v32, v32, v50, v9 bitop3:0xf6
    v_bitop3_b32 v32, v32, v51, v9 bitop3:0xf6
    s_waitcnt vmcnt(7)
    v_bitop3_b32 v32, v32, v52, v9 bitop3:0xf6
    v_bitop3_b32 v32, v32, v53, v9 bitop3:0xf6
    v_bitop3_b32 v32, v32, v54, v9 bitop3:0xf6
    v_bitop3_b32 v32, v32, v55, v9 bitop3:0xf6
    v_pk_add_f32 v[48:49], v[48:49], v[52:53]
    v_pk_add_f32 v[50:51], v[50:51], v[54:55]
    s_waitcnt vmcnt(6)
    v_bitop3_b32 v32, v32, v56, v9 bitop3:0xf6
    v_bitop3_b32 v32, v32, v57, v9 bitop3:0xf6
    v_bitop3_b32 v32, v32, v58, v9 bitop3:0xf6
    v_bitop3_b32 v32, v32, v59, v9 bitop3:0xf6
    v_pk_add_f32 v[48:49], v[48:49], v[56:57]
    v_pk_add_f32 v[50:51], v[50:51], v[58:59]
    s_waitcnt vmcnt(5)
    v_bitop3_b32 v32, v32, v60, v9 bitop3:0xf6
    v_bitop3_b32 v32, v32, v61, v9 bitop3:0xf6
    v_bitop3_b32 v32, v32, v62, v9 bitop3:0xf6
    v_bitop3_b32 v32, v32, v63, v9 bitop3:0xf6
    v_pk_add_f32 v[48:49], v[48:49], v[60:61]
    v_pk_add_f32 v[50:51], v[50:51], v[62:63]
    s_waitcnt vmcnt(4)
    v_bitop3_b32 v32, v32, v64, v9 bitop3:0xf6
    v_bitop3_b32 v32, v32, v65, v9 bitop3:0xf6
    v_bitop3_b32 v32, v32, v66, v9 bitop3:0xf6
    v_bitop3_b32 v32, v32, v67, v9 bitop3:0xf6
    v_pk_add_f32 v[48:49], v[48:49], v[64:65]
    v_pk_add_f32 v[50:51], v[50:51], v[66:67]
    s_waitcnt vmcnt(3)
    v_bitop3_b32 v32, v32, v68, v9 bitop3:0xf6
    v_bitop3_b32 v32, v32, v69, v9 bitop3:0xf6
    v_bitop3_b32 v32, v32, v70, v9 bitop3:0xf6
    v_bitop3_b32 v32, v32, v71, v9 bitop3:0xf6
    v_pk_add_f32 v[48:49], v[48:49], v[68:69]
    v_pk_add_f32 v[50:51], v[50:51], v[70:71]
    s_waitcnt vmcnt(2)
    v_bitop3_b32 v32, v32, v72, v9 bitop3:0xf6
    v_bitop3_b32 v32, v32, v73, v9 bitop3:0xf6
    v_bitop3_b32 v32, v32, v74, v9 bitop3:0xf6
    v_bitop3_b32 v32, v32, v75, v9 bitop3:0xf6
    v_pk_add_f32 v[48:49], v[48:49], v[72:73]
    v_pk_add_f32 v[50:51], v[50:51], v[74:75]
    s_waitcnt vmcnt(1)
    v_bitop3_b32 v32, v32, v76, v9 bitop3:0xf6
    v_bitop3_b32 v32, v32, v77, v9 bitop3:0xf6
    v_bitop3_b32 v32, v32, v78, v9 bitop3:0xf6
    v_bitop3_b32 v32, v32, v79, v9 bitop3:0xf6
    v_pk_add_f32 v[48:49], v[48:49], v[76:77]
    v_pk_add_f32 v[50:51], v[50:51], v[78:79]
    s_waitcnt vmcnt(0)
    v_bitop3_b32 v32, v32, v80, v9 bitop3:0xf6
    v_bitop3_b32 v32, v32, v81, v9 bitop3:0xf6
    v_bitop3_b32 v32, v32, v82, v9 bitop3:0xf6
    v_bitop3_b32 v32, v32, v83, v9 bitop3:0xf6
    v_pk_add_f32 v[48:49], v[48:49], v[80:81]
    v_pk_add_f32 v[50:51], v[50:51], v[82:83]
    v_and_b32 v32, 0xff, v32
    v_cmp_ne_u32 vcc, 0, v32
    s_cmp_ge_u32 s12, 16384
    s_cbranch_scc1 FN_POK
    s_cbranch_vccz FN_POK
    s_mov_b64 exec, vcc
    s_sleep 2
    s_branch FN_P
FN_POK:
    s_mov_b64 exec, -1
    v_add_f32_dpp v48, v48, v48 row_ror:8 row_mask:0xf bank_mask:0xf
    v_add_f32_dpp v49, v49, v49 row_ror:8 row_mask:0xf bank_mask:0xf
    v_add_f32_dpp v50, v50, v50 row_ror:8 row_mask:0xf bank_mask:0xf
    v_add_f32_dpp v51, v51, v51 row_ror:8 row_mask:0xf bank_mask:0xf
    v_mov_b32 v52, v48
    v_mov_b32 v53, v49
    v_mov_b32 v54, v50
    v_mov_b32 v55, v51
    v_permlane16_swap_b32 v48, v52
    v_permlane16_swap_b32 v49, v53
    v_permlane16_swap_b32 v50, v54
    v_permlane16_swap_b32 v51, v55
    v_add_f32 v48, v48, v52
    v_add_f32 v49, v49, v53
    v_add_f32 v50, v50, v54
    v_add_f32 v51, v51, v55
    v_mov_b32 v52, v48
    v_mov_b32 v53, v49
    v_mov_b32 v54, v50
    v_mov_b32 v55, v51
    v_permlane32_swap_b32 v48, v52
    v_permlane32_swap_b32 v49, v53
    v_permlane32_swap_b32 v50, v54
    v_permlane32_swap_b32 v51, v55
    v_add_f32 v48, v48, v52
    v_add_f32 v49, v49, v53
    v_add_f32 v50, v50, v54
    v_add_f32 v51, v51, v55
    v_cvt_pk_bf16_f32 v48, 0, v48
    v_cvt_pk_bf16_f32 v49, 0, v49
    v_cvt_pk_bf16_f32 v50, 0, v50
    v_cvt_pk_bf16_f32 v51, 0, v51
    v_mul_f32 v48, v48, v20
    v_mul_f32 v49, v49, v20
    v_mul_f32 v50, v50, v20
    v_mul_f32 v51, v51, v20
    v_cvt_pk_bf16_f32 v48, 0, v48
    v_cvt_pk_bf16_f32 v49, 0, v49
    v_cvt_pk_bf16_f32 v50, 0, v50
    v_cvt_pk_bf16_f32 v51, 0, v51
    v_add_f32 v48, v48, v24
    v_add_f32 v49, v49, v25
    v_add_f32 v50, v50, v26
    v_add_f32 v51, v51, v27
    v_cvt_pk_bf16_f32 v48, 0, v48
    v_cvt_pk_bf16_f32 v49, 0, v49
    v_cvt_pk_bf16_f32 v50, 0, v50
    v_cvt_pk_bf16_f32 v51, 0, v51
    v_mul_f32 v48, v48, v21
    v_mul_f32 v49, v49, v21
    v_mul_f32 v50, v50, v21
    v_mul_f32 v51, v51, v21
    v_cvt_pk_bf16_f32 v48, 0, v48
    v_cvt_pk_bf16_f32 v49, 0, v49
    v_cvt_pk_bf16_f32 v50, 0, v50
    v_cvt_pk_bf16_f32 v51, 0, v51
    v_add_f32 v48, v48, v28
    v_add_f32 v49, v49, v29
    v_add_f32 v50, v50, v30
    v_add_f32 v51, v51, v31
    v_cvt_pk_bf16_f32 v40, v48, v49
    v_cvt_pk_bf16_f32 v41, v50, v51
    s_barrier
    s_mov_b64 exec, 0xff
    global_store_dwordx2 v11, v[40:41], s[46:47]
    s_endpgm
W_END:
    s_endpgm
K_END:
    s_endpgm
CODE_END:
.section .rodata,"a"
.p2align 6
.amdhsa_kernel k1_kernel
  .amdhsa_next_free_vgpr 168
  .amdhsa_next_free_sgpr 102
  .amdhsa_accum_offset 168
  .amdhsa_group_segment_fixed_size 0
  .amdhsa_kernarg_size 144
  .amdhsa_user_sgpr_count 2
  .amdhsa_user_sgpr_kernarg_segment_ptr 1
  .amdhsa_system_sgpr_workgroup_id_x 1
.end_amdhsa_kernel
```

```asm
; @launch kernel=k1_kernel grid=(256,1,1) block=(768,1,1) lds=163840
.amdgcn_target "amdgcn-amd-amdhsa--gfx950"
.text
.p2align 8
.globl k1_kernel
.type k1_kernel,@function
k1_kernel:
    s_cmp_ge_u32 s2, 256
    s_cbranch_scc1 K_END
    s_load_dwordx16 s[16:31], s[0:1], 0
    s_load_dwordx16 s[32:47], s[0:1], 64
    s_load_dwordx4 s[48:51], s[0:1], 128
    v_lshrrev_b32 v1, 6, v0
    v_and_b32 v2, 63, v0
    v_readfirstlane_b32 s3, v1
    v_and_b32 v3, 15, v2
    v_lshrrev_b32 v4, 4, v2
    s_and_b32 s4, s2, 7
    s_lshr_b32 s5, s2, 3
    s_cmp_lg_u32 s3, 0
    s_cbranch_scc1 K_NOCPF
    s_getpc_b64 s[8:9]
    s_and_b32 s8, s8, 0xffffff00
    v_and_b32 v5, 7, v2
    v_lshl_add_u32 v5, s5, 3, v5
    v_lshlrev_b32 v5, 7, v5
    v_min_u32 v5, CODE_END-k1_kernel-4, v5
    global_load_dword v167, v5, s[8:9]
K_NOCPF:
    s_cmp_lt_u32 s2, 112
    s_cbranch_scc1 K_NC
    s_sub_u32 s101, s5, 14
    s_mul_i32 s6, s4, 18
    s_add_u32 s6, s6, s101
    s_cmp_lt_u32 s3, 8
    s_cbranch_scc1 CK_PRO
CU_PRO:
    s_sub_u32 s7, s3, 8
    s_lshl_b32 s8, s101, 2
    s_add_u32 s8, s8, s7
    s_mul_i32 s10, s8, 57
    s_lshr_b32 s10, s10, 9
    s_mul_i32 s11, s10, 9
    s_sub_u32 s11, s8, s11
    s_sub_u32 s8, s8, s10
    s_mul_i32 s8, s8, 36864
    s_lshl_b32 s9, s4, 7
    s_add_u32 s8, s8, s9
    v_lshrrev_b32 v5, 1, v2
    v_mul_u32_u24 v5, 1152, v5
    v_and_b32 v6, 1, v2
    v_lshl_add_u32 v5, v6, 7, v5
    v_add_u32 v7, s8, v5
    s_and_b32 s15, s7, 2
    s_add_u32 s15, s15, s7
    s_mul_i32 s8, s15, 294912
    s_lshl_b32 s9, s6, 3
    s_add_u32 s8, s8, s9
    v_mul_u32_u24 v5, 4608, v2
    v_add_u32 v5, s8, v5
    v_add_u32 v6, 589824, v5
    v_mov_b32 v58, 0
    v_mov_b32 v59, 0
    v_mov_b32 v57, 155648
    v_lshl_add_u32 v56, v2, 3, v57
    ds_write_b64 v56, v[58:59]
    s_waitcnt lgkmcnt(0)
    s_barrier
    s_cmp_eq_u32 s7, 3
    s_cbranch_scc1 CU_C3A
CU_C3B:
    global_load_dword v60, v59, s[30:31]
    s_waitcnt vmcnt(0)
    s_cmp_eq_u32 s11, 8
    s_cbranch_scc1 CU_C3
    global_load_dword v60, v7, s[16:17]
CU_C3X:
    s_cmp_ge_u32 s7, 2
    s_cbranch_scc1 CU_MID
CU_LD:
    global_load_dwordx2 v[8:9], v5, s[16:17] offset:0 sc1
    global_load_dwordx2 v[10:11], v5, s[16:17] offset:1152 sc1
    global_load_dwordx2 v[12:13], v5, s[16:17] offset:2304 sc1
    global_load_dwordx2 v[14:15], v5, s[16:17] offset:3456 sc1
    global_load_dwordx2 v[16:17], v6, s[16:17] offset:0 sc1
    global_load_dwordx2 v[18:19], v6, s[16:17] offset:1152 sc1
    global_load_dwordx2 v[20:21], v6, s[16:17] offset:2304 sc1
    global_load_dwordx2 v[22:23], v6, s[16:17] offset:3456 sc1
    s_branch CU_MAIN
CK_PRO:
    s_and_b32 s7, s3, 3
    s_lshr_b32 s12, s3, 2
    s_lshl_b32 s8, s6, 2
    s_add_u32 s8, s8, s7
    s_lshl_b32 s9, s8, 8
    v_lshl_add_u32 v6, v2, 2, s9
    s_lshl_b32 s8, s8, 1
    v_mov_b32 v7, s8
    v_mov_b32 v18, 0
    s_waitcnt lgkmcnt(0)
    global_load_short_d16_hi v18, v7, s[30:31]
    global_load_dword v28, v6, s[18:19]
    global_load_dword v29, v6, s[20:21]
    global_load_dword v30, v6, s[22:23]
    global_load_dword v31, v6, s[24:25]
    global_load_dword v32, v6, s[26:27]
    global_load_dword v33, v6, s[28:29]
    s_barrier
    s_branch CK_MAIN
K_NC:
    s_lshl_b32 s6, s2, 4
    s_lshl_b32 s7, s3, 2
    s_sub_u32 s7, s7, 32
    s_cmp_ge_u32 s3, 8
    s_cbranch_scc1 RT_PRO
    s_cmp_lt_u32 s2, 72
    s_cbranch_scc1 F_PRO
    s_cmp_lt_u32 s3, 6
    s_cbranch_scc1 HELPER
    s_cmp_lt_u32 s2, 80
    s_cbranch_scc1 HELPER
    s_add_u32 s7, s7, 24
    s_lshr_b32 s6, s6, 1
    s_add_u32 s6, s6, 1136
RT_PRO:
    s_add_u32 s6, s6, s7
    v_add_u32 v5, s6, v4
    v_lshlrev_b32 v6, 4, v3
    v_lshlrev_b32 v7, 3, v3
    v_mul_u32_u24 v9, 1152, v5
    v_add_u32 v8, v9, v6
    v_add_u32 v9, v9, v7
    v_mov_b32 v10, 0
    v_lshlrev_b32 v11, 2, v2
    v_add_u32 v12, 163520, v11
    ds_write_b32 v12, v10
    v_and_b32 v11, 0x7c, v11
    v_lshlrev_b32 v12, 4, v2
    s_mul_i32 s13, s7, 640
    s_add_u32 s13, s13, 147456
    s_mov_b32 m0, s13
    s_waitcnt lgkmcnt(0)
    s_load_dword s12, s[50:51], 0
    global_load_lds_dwordx4 v12, s[36:37]
    global_load_lds_dword v11, s[36:37] offset:1024
    s_add_u32 m0, s13, 1280
    v_add_u32 v6, s13, v6
    global_load_lds_dwordx4 v12, s[44:45]
    global_load_lds_dword v11, s[44:45] offset:1024
    global_load_dwordx4 v[16:19], v8, s[16:17] offset:0
    global_load_dwordx4 v[20:23], v8, s[16:17] offset:256
    global_load_dwordx4 v[24:27], v8, s[16:17] offset:512
    global_load_dwordx4 v[28:31], v8, s[16:17] offset:768
    global_load_dwordx2 v[32:33], v9, s[16:17] offset:1024
    s_barrier
    s_branch RT_MAIN
F_PRO:
    s_mul_i32 s6, s4, 9
    s_add_u32 s6, s6, s5
    v_lshrrev_b32 v6, 3, v2
    v_and_b32 v7, 4, v6
    v_add_u32 v7, v6, v7
    v_mul_u32_u24 v5, 9216, v7
    v_and_b32 v7, 6, v6
    v_xor_b32 v7, v7, v2
    v_and_b32 v7, 7, v7
    v_lshl_add_u32 v5, v7, 4, v5
    s_and_b32 s8, s3, 1
    s_lshr_b32 s9, s3, 1
    s_lshl_b32 s9, s9, 2
    s_add_u32 s8, s8, s9
    s_mul_i32 s14, s8, 36864
    s_lshl_b32 s8, s6, 7
    s_add_u32 s14, s14, s8
    s_lshl_b32 s15, s3, 10
    s_mov_b32 s54, 5308416
    s_mov_b32 s55, 0x20000
    s_mov_b32 s58, 5308416
    s_mov_b32 s59, 0x20000
    s_waitcnt lgkmcnt(0)
    s_mov_b64 s[52:53], s[38:39]
    s_mov_b64 s[56:57], s[40:41]
    s_barrier
    s_branch F_MAIN
HELPER:
    s_lshl_b32 s6, s3, 2
    s_add_u32 s6, s6, s5
    s_sub_u32 s6, s6, 10
    v_mul_u32_u24 v5, 9216, v2
    s_mul_i32 s7, s4, 1152
    v_add_u32 v5, s7, v5
    s_waitcnt lgkmcnt(0)
    s_barrier
    s_cmp_lt_u32 s2, 80
    s_cbranch_scc1 SEL_MAIN
    s_cmp_ge_u32 s3, 4
    s_cbranch_scc1 W_END
    s_cmp_ge_u32 s3, 3
    s_cbranch_scc1 HP_BAR
    v_mov_b32 v8, 0
    global_load_dword v9, v8, s[36:37]
    s_waitcnt vmcnt(0)
    s_mul_i32 s8, s6, 7282
    s_lshr_b32 s8, s8, 16
    s_mul_i32 s9, s8, 9
    s_sub_u32 s9, s6, s9
    s_lshl_b32 s9, s9, 7
    s_bitcmp1_b32 s8, 0
    s_cselect_b32 s12, s40, s38
    s_cselect_b32 s13, s41, s39
    s_lshr_b32 s8, s8, 1
    s_add_u32 s8, s8, 6
    s_mul_i32 s8, s8, 589824
    s_add_u32 s8, s8, s9
    v_add_u32 v6, s8, v5
    global_load_dword v7, v6, s[12:13]
    s_add_u32 s6, s6, 16
HP_BAR:
    s_barrier
HP_LOOP:
    s_waitcnt vmcnt(0)
    s_cmp_ge_u32 s6, 54
    s_cbranch_scc1 HP_DN
    s_mul_i32 s8, s6, 7282
    s_lshr_b32 s8, s8, 16
    s_mul_i32 s9, s8, 9
    s_sub_u32 s9, s6, s9
    s_lshl_b32 s9, s9, 7
    s_bitcmp1_b32 s8, 0
    s_cselect_b32 s12, s40, s38
    s_cselect_b32 s13, s41, s39
    s_lshr_b32 s8, s8, 1
    s_add_u32 s8, s8, 6
    s_mul_i32 s8, s8, 589824
    s_add_u32 s8, s8, s9
    v_add_u32 v6, s8, v5
    global_load_dword v7, v6, s[12:13]
    s_add_u32 s6, s6, 16
    s_branch HP_LOOP
HP_DN:
    s_cmp_ge_u32 s6, 63
    s_cbranch_scc1 W_END
    s_mul_i32 s8, s4, 81
    s_add_u32 s8, s8, s6
    s_add_u32 s8, s8, 18
    s_lshl_b32 s8, s8, 13
    v_lshl_add_u32 v6, v2, 7, s8
    global_load_dword v7, v6, s[42:43]
    s_add_u32 s6, s6, 16
    s_branch HP_LOOP
RT_MAIN:
    s_lshl_b32 s6, s2, 7
    s_add_u32 s6, s6, 4096
    s_cmp_lt_u32 s2, 80
    s_cselect_b32 s8, 15, 23
    v_min_u32 v14, s8, v2
    v_lshl_add_u32 v5, v14, 2, s6
    s_mov_b32 s8, 163520
    v_lshl_add_u32 v14, v14, 2, s8
    v_add_u32 v13, s7, v4
    v_lshl_add_u32 v13, v13, 2, s8
    s_mov_b32 s8, 0xffff
    s_mov_b32 s10, 0x00010001
    s_mov_b32 s11, 0x00010001
    v_mov_b32 v15, 0x3f803f80
    v_mov_b32 v12, 163456
    s_waitcnt lgkmcnt(0)
    s_add_u32 s12, s12, 1
    v_mov_b32 v11, s12
    ds_write_b64 v12, v[10:11]
    v_add_u32 v7, s13, v7
    s_waitcnt vmcnt(5)
    ds_read_b128 v[52:55], v6 offset:1280
    ds_read_b128 v[56:59], v6 offset:1536
    ds_read_b128 v[60:63], v6 offset:1792
    ds_read_b128 v[64:67], v6 offset:2048
    ds_read_b64 v[68:69], v7 offset:2304
    ds_read_b128 v[34:37], v6 offset:0
    ds_read_b128 v[38:41], v6 offset:256
    ds_read_b128 v[42:45], v6 offset:512
    ds_read_b128 v[46:49], v6 offset:768
    ds_read_b64 v[50:51], v7 offset:1024
    s_waitcnt lgkmcnt(5)
    v_and_b32 v84, 0xffff, v52
    v_and_b32 v52, 0xffff0000, v52
    v_and_b32 v85, 0xffff, v53
    v_and_b32 v53, 0xffff0000, v53
    v_and_b32 v86, 0xffff, v54
    v_and_b32 v54, 0xffff0000, v54
    v_and_b32 v87, 0xffff, v55
    v_and_b32 v55, 0xffff0000, v55
    v_and_b32 v88, 0xffff, v56
    v_and_b32 v56, 0xffff0000, v56
    v_and_b32 v89, 0xffff, v57
    v_and_b32 v57, 0xffff0000, v57
    v_and_b32 v90, 0xffff, v58
    v_and_b32 v58, 0xffff0000, v58
    v_and_b32 v91, 0xffff, v59
    v_and_b32 v59, 0xffff0000, v59
    v_and_b32 v92, 0xffff, v60
    v_and_b32 v60, 0xffff0000, v60
    v_and_b32 v93, 0xffff, v61
    v_and_b32 v61, 0xffff0000, v61
    v_and_b32 v94, 0xffff, v62
    v_and_b32 v62, 0xffff0000, v62
    v_and_b32 v95, 0xffff, v63
    v_and_b32 v63, 0xffff0000, v63
    v_and_b32 v96, 0xffff, v64
    v_and_b32 v64, 0xffff0000, v64
    v_and_b32 v97, 0xffff, v65
    v_and_b32 v65, 0xffff0000, v65
    v_and_b32 v98, 0xffff, v66
    v_and_b32 v66, 0xffff0000, v66
    v_and_b32 v99, 0xffff, v67
    v_and_b32 v67, 0xffff0000, v67
    v_and_b32 v100, 0xffff, v68
    v_and_b32 v68, 0xffff0000, v68
    v_and_b32 v101, 0xffff, v69
    v_and_b32 v69, 0xffff0000, v69
    s_waitcnt vmcnt(0) lgkmcnt(0)
    v_dot2_f32_bf16 v12, v16, v34, 0
    v_dot2_f32_bf16 v12, v17, v35, v12
    v_dot2_f32_bf16 v12, v18, v36, v12
    v_dot2_f32_bf16 v12, v19, v37, v12
    v_dot2_f32_bf16 v12, v20, v38, v12
    v_dot2_f32_bf16 v12, v21, v39, v12
    v_dot2_f32_bf16 v12, v22, v40, v12
    v_dot2_f32_bf16 v12, v23, v41, v12
    v_dot2_f32_bf16 v12, v24, v42, v12
    v_dot2_f32_bf16 v12, v25, v43, v12
    v_dot2_f32_bf16 v12, v26, v44, v12
    v_dot2_f32_bf16 v12, v27, v45, v12
    v_dot2_f32_bf16 v12, v28, v46, v12
    v_dot2_f32_bf16 v12, v29, v47, v12
    v_dot2_f32_bf16 v12, v30, v48, v12
    v_dot2_f32_bf16 v12, v31, v49, v12
    v_dot2_f32_bf16 v12, v32, v50, v12
    v_dot2_f32_bf16 v12, v33, v51, v12
    s_nop 0
    s_nop 1
    v_add_f32_dpp v12, v12, v12 row_ror:8 row_mask:0xf bank_mask:0xf
    s_nop 1
    v_add_f32_dpp v12, v12, v12 row_ror:4 row_mask:0xf bank_mask:0xf
    s_nop 1
    v_add_f32_dpp v12, v12, v12 row_ror:2 row_mask:0xf bank_mask:0xf
    s_nop 1
    v_add_f32_dpp v12, v12, v12 row_ror:1 row_mask:0xf bank_mask:0xf
    v_cvt_pk_bf16_f32 v12, v12, v12
    v_ashrrev_i32 v9, 31, v12
    v_or_b32 v9, 0x80000000, v9
    v_xor_b32 v12, v12, v9
    v_or_b32 v12, 1, v12
    s_mov_b64 exec, s[10:11]
    ds_write_b32 v13, v12 offset:0
    s_mov_b64 exec, -1
    s_cmp_lg_u32 s7, 0
    s_cbranch_scc1 RT_PK_X
    s_mov_b32 s9, 0
RT_PK:
    ds_read_b32 v12, v14 offset:0
    s_add_u32 s9, s9, 1
    s_waitcnt lgkmcnt(0)
    v_cmp_eq_u32 vcc, 0, v12
    s_cmp_ge_u32 s9, 0x40000
    s_cbranch_scc1 RT_PK_S
    s_cbranch_vccnz RT_PK
RT_PK_S:
    v_bfi_b32 v12, s8, v11, v12
    s_mov_b64 exec, 0xffffff
    global_store_dword v5, v12, s[50:51] sc1
    s_mov_b64 exec, -1
RT_PK_X:
    s_or_b32 s9, s2, s7
    s_cmp_lg_u32 s9, 0
    s_cbranch_scc1 RT_NOT
    v_mov_b32 v8, v11
    v_mov_b32 v9, 1
    global_store_dwordx2 v10, v[8:9], s[48:49] sc1
RT_NOT:
    v_dot2_f32_bf16 v70, v16, v84, 0
    v_dot2_f32_bf16 v71, v16, v52, 0
    v_dot2_f32_bf16 v72, v17, v85, 0
    v_dot2_f32_bf16 v73, v17, v53, 0
    v_dot2_f32_bf16 v74, v18, v86, 0
    v_dot2_f32_bf16 v75, v18, v54, 0
    v_dot2_f32_bf16 v76, v19, v87, 0
    v_dot2_f32_bf16 v77, v19, v55, 0
    v_dot2_f32_bf16 v78, v20, v88, 0
    v_dot2_f32_bf16 v79, v20, v56, 0
    v_dot2_f32_bf16 v80, v21, v89, 0
    v_dot2_f32_bf16 v81, v21, v57, 0
    s_nop 0
    v_cvt_pk_bf16_f32 v70, v70, v71
    v_cvt_pk_bf16_f32 v72, v72, v73
    v_cvt_pk_bf16_f32 v74, v74, v75
    v_cvt_pk_bf16_f32 v76, v76, v77
    v_cvt_pk_bf16_f32 v78, v78, v79
    v_cvt_pk_bf16_f32 v80, v80, v81
    v_dot2_f32_bf16 v12, v70, v15, 0
    v_dot2_f32_bf16 v12, v72, v15, v12
    v_dot2_f32_bf16 v12, v74, v15, v12
    v_dot2_f32_bf16 v12, v76, v15, v12
    v_dot2_f32_bf16 v12, v78, v15, v12
    v_dot2_f32_bf16 v12, v80, v15, v12
    v_dot2_f32_bf16 v70, v22, v90, 0
    v_dot2_f32_bf16 v71, v22, v58, 0
    v_dot2_f32_bf16 v72, v23, v91, 0
    v_dot2_f32_bf16 v73, v23, v59, 0
    v_dot2_f32_bf16 v74, v24, v92, 0
    v_dot2_f32_bf16 v75, v24, v60, 0
    v_dot2_f32_bf16 v76, v25, v93, 0
    v_dot2_f32_bf16 v77, v25, v61, 0
    v_dot2_f32_bf16 v78, v26, v94, 0
    v_dot2_f32_bf16 v79, v26, v62, 0
    v_dot2_f32_bf16 v80, v27, v95, 0
    v_dot2_f32_bf16 v81, v27, v63, 0
    s_nop 0
    v_cvt_pk_bf16_f32 v70, v70, v71
    v_cvt_pk_bf16_f32 v72, v72, v73
    v_cvt_pk_bf16_f32 v74, v74, v75
    v_cvt_pk_bf16_f32 v76, v76, v77
    v_cvt_pk_bf16_f32 v78, v78, v79
    v_cvt_pk_bf16_f32 v80, v80, v81
    v_dot2_f32_bf16 v12, v70, v15, v12
    v_dot2_f32_bf16 v12, v72, v15, v12
    v_dot2_f32_bf16 v12, v74, v15, v12
    v_dot2_f32_bf16 v12, v76, v15, v12
    v_dot2_f32_bf16 v12, v78, v15, v12
    v_dot2_f32_bf16 v12, v80, v15, v12
    v_dot2_f32_bf16 v70, v28, v96, 0
    v_dot2_f32_bf16 v71, v28, v64, 0
    v_dot2_f32_bf16 v72, v29, v97, 0
    v_dot2_f32_bf16 v73, v29, v65, 0
    v_dot2_f32_bf16 v74, v30, v98, 0
    v_dot2_f32_bf16 v75, v30, v66, 0
    v_dot2_f32_bf16 v76, v31, v99, 0
    v_dot2_f32_bf16 v77, v31, v67, 0
    v_dot2_f32_bf16 v78, v32, v100, 0
    v_dot2_f32_bf16 v79, v32, v68, 0
    v_dot2_f32_bf16 v80, v33, v101, 0
    v_dot2_f32_bf16 v81, v33, v69, 0
    s_nop 0
    v_cvt_pk_bf16_f32 v70, v70, v71
    v_cvt_pk_bf16_f32 v72, v72, v73
    v_cvt_pk_bf16_f32 v74, v74, v75
    v_cvt_pk_bf16_f32 v76, v76, v77
    v_cvt_pk_bf16_f32 v78, v78, v79
    v_cvt_pk_bf16_f32 v80, v80, v81
    v_dot2_f32_bf16 v12, v70, v15, v12
    v_dot2_f32_bf16 v12, v72, v15, v12
    v_dot2_f32_bf16 v12, v74, v15, v12
    v_dot2_f32_bf16 v12, v76, v15, v12
    v_dot2_f32_bf16 v12, v78, v15, v12
    v_dot2_f32_bf16 v12, v80, v15, v12
    v_add_u32 v5, 16384, v5
    s_nop 1
    v_add_f32_dpp v12, v12, v12 row_ror:8 row_mask:0xf bank_mask:0xf
    s_nop 1
    v_add_f32_dpp v12, v12, v12 row_ror:4 row_mask:0xf bank_mask:0xf
    s_nop 1
    v_add_f32_dpp v12, v12, v12 row_ror:2 row_mask:0xf bank_mask:0xf
    s_nop 1
    v_add_f32_dpp v12, v12, v12 row_ror:1 row_mask:0xf bank_mask:0xf
    v_cvt_pk_bf16_f32 v12, v12, v12
    v_and_b32 v12, 0xffff0000, v12
    v_mul_f32 v9, 0xbfb8aa3b, v12
    v_exp_f32 v9, v9
    s_nop 0
    v_add_f32 v9, 1.0, v9
    v_rcp_f32 v9, v9
    s_nop 0
    v_cvt_pk_bf16_f32 v12, v9, v9
    v_or_b32 v12, 1, v12
    s_mov_b64 exec, s[10:11]
    ds_write_b32 v13, v12 offset:128
    s_mov_b64 exec, -1
    s_cmp_lg_u32 s7, 0
    s_cbranch_scc1 RT_PG_X
    s_mov_b32 s9, 0
RT_PG:
    ds_read_b32 v12, v14 offset:128
    s_add_u32 s9, s9, 1
    s_waitcnt lgkmcnt(0)
    v_cmp_eq_u32 vcc, 0, v12
    s_cmp_ge_u32 s9, 0x40000
    s_cbranch_scc1 RT_PG_S
    s_cbranch_vccnz RT_PG
RT_PG_S:
    v_bfi_b32 v12, s8, v11, v12
    s_mov_b64 exec, 0xffffff
    global_store_dword v5, v12, s[50:51] sc1
    s_mov_b64 exec, -1
RT_PG_X:
    s_barrier
RT_TAIL:
    s_cmp_ge_u32 s2, 72
    s_cbranch_scc1 W_END
    s_cmp_ge_u32 s3, 10
    s_cbranch_scc1 W_END
    s_cmp_eq_u32 s3, 9
    s_cbranch_scc1 RT_CTL
    s_mul_i32 s6, s4, 9
    s_add_u32 s6, s6, s5
    v_mov_b32 v14, v11
    v_lshrrev_b32 v17, 3, v2
    v_mul_u32_u24 v17, 9216, v17
    v_and_b32 v7, 7, v2
    v_lshl_add_u32 v17, v7, 4, v17
    s_mul_i32 s74, s6, 73728
    s_lshl_b32 s9, s3, 7
    s_add_u32 s74, s74, s9
    s_add_u32 s75, s74, 4608
    s_mov_b32 s60, s42
    s_mov_b32 s61, s43
    s_mov_b32 s62, 5308416
    s_mov_b32 s63, 0x20000
    v_mul_u32_u24 v11, 144, v7
    v_add_u32 v11, 162048, v11
    v_lshrrev_b32 v12, 3, v3
    v_lshl_add_u32 v13, v4, 1, v12
    v_lshl_add_u32 v13, v13, 4, v11
    v_and_b32 v15, 1, v4
    v_lshlrev_b32 v15, 2, v15
    v_add_u32 v15, v15, v12
    v_lshrrev_b32 v16, 1, v4
    v_lshl_add_u32 v15, v15, 1, v16
    v_mul_u32_u24 v15, 9216, v15
    v_lshl_add_u32 v15, v7, 4, v15
    s_mul_i32 s8, s3, 147456
    s_lshl_b32 s9, s6, 7
    s_add_u32 s8, s8, s9
    s_add_u32 s8, s8, 40960
    v_add_u32 v15, s8, v15
    v_add_u32 v16, 36864, v15
    s_setprio 1
    s_barrier
    buffer_load_dwordx4 v[96:99], v17, s[60:63], s74 offen offset:0
    buffer_load_dwordx4 v[100:103], v17, s[60:63], s74 offen offset:1152
    buffer_load_dwordx4 v[104:107], v17, s[60:63], s74 offen offset:2304
    buffer_load_dwordx4 v[108:111], v17, s[60:63], s74 offen offset:3456
    buffer_load_dwordx4 v[112:115], v17, s[60:63], s75 offen offset:0
    buffer_load_dwordx4 v[116:119], v17, s[60:63], s75 offen offset:1152
    buffer_load_dwordx4 v[120:123], v17, s[60:63], s75 offen offset:2304
    buffer_load_dwordx4 v[124:127], v17, s[60:63], s75 offen offset:3456
    s_barrier
    s_waitcnt vmcnt(0)
    s_mov_b32 s76, 0x05040100
    s_mov_b32 s77, 0x07060302
    v_perm_b32 v128, v100, v96, s76
    v_perm_b32 v129, v108, v104, s76
    v_perm_b32 v130, v116, v112, s76
    v_perm_b32 v131, v124, v120, s76
    v_perm_b32 v132, v100, v96, s77
    v_perm_b32 v133, v108, v104, s77
    v_perm_b32 v134, v116, v112, s77
    v_perm_b32 v135, v124, v120, s77
    v_perm_b32 v136, v101, v97, s76
    v_perm_b32 v137, v109, v105, s76
    v_perm_b32 v138, v117, v113, s76
    v_perm_b32 v139, v125, v121, s76
    v_perm_b32 v140, v101, v97, s77
    v_perm_b32 v141, v109, v105, s77
    v_perm_b32 v142, v117, v113, s77
    v_perm_b32 v143, v125, v121, s77
    v_perm_b32 v144, v102, v98, s76
    v_perm_b32 v145, v110, v106, s76
    v_perm_b32 v146, v118, v114, s76
    v_perm_b32 v147, v126, v122, s76
    v_perm_b32 v148, v102, v98, s77
    v_perm_b32 v149, v110, v106, s77
    v_perm_b32 v150, v118, v114, s77
    v_perm_b32 v151, v126, v122, s77
    v_perm_b32 v152, v103, v99, s76
    v_perm_b32 v153, v111, v107, s76
    v_perm_b32 v154, v119, v115, s76
    v_perm_b32 v155, v127, v123, s76
    v_perm_b32 v156, v103, v99, s77
    v_perm_b32 v157, v111, v107, s77
    v_perm_b32 v158, v119, v115, s77
    v_perm_b32 v159, v127, v123, s77
    s_branch F_H
RT_CTL:
    s_mov_b32 s64, s16
    s_mov_b32 s65, s17
    s_mov_b32 s66, 2359296
    s_mov_b32 s67, 0x20000
    v_lshlrev_b32 v19, 4, v2
    v_lshlrev_b32 v20, 2, v2
    v_and_b32 v6, 7, v2
    s_lshl_b32 s9, s4, 8
    v_lshl_add_u32 v6, v6, 3, s9
    s_mov_b32 s12, 0
SP_C:
    s_add_u32 s12, s12, 1
    s_and_b32 s9, s12, 7
    s_cselect_b32 s9, 0, 128
    v_add_u32 v10, s9, v6
    global_load_dwordx2 v[8:9], v10, s[50:51] offset:256 sc1
    s_waitcnt vmcnt(0)
SPC_C:
    v_cmp_ne_u32 vcc, v9, v11
    s_cmp_ge_u32 s12, 16384
    s_cbranch_scc1 SPX_C
    s_cbranch_vccz SPX_C
    s_mov_b64 exec, vcc
    s_sleep 2
    s_branch SP_C
SPX_C:
    s_mov_b64 exec, -1
    v_not_b32 v8, v8
    v_and_b32 v8, 0x7ff, v8
    v_mul_u32_u24 v8, 1152, v8
    s_mov_b32 m0, 147456
    v_readlane_b32 s76, v8, 0
    v_readlane_b32 s77, v8, 1
    v_readlane_b32 s78, v8, 2
    v_readlane_b32 s79, v8, 3
    v_readlane_b32 s80, v8, 4
    v_readlane_b32 s81, v8, 5
    v_readlane_b32 s82, v8, 6
    v_readlane_b32 s83, v8, 7
    buffer_load_dwordx4 v19, s[64:67], s76 offen lds
    buffer_load_dword v20, s[64:67], s76 offen offset:1024 lds
    s_add_u32 m0, m0, 1312
    s_nop 0
    buffer_load_dwordx4 v19, s[64:67], s77 offen lds
    buffer_load_dword v20, s[64:67], s77 offen offset:1024 lds
    s_add_u32 m0, m0, 1312
    s_nop 0
    buffer_load_dwordx4 v19, s[64:67], s78 offen lds
    buffer_load_dword v20, s[64:67], s78 offen offset:1024 lds
    s_add_u32 m0, m0, 1312
    s_nop 0
    buffer_load_dwordx4 v19, s[64:67], s79 offen lds
    buffer_load_dword v20, s[64:67], s79 offen offset:1024 lds
    s_add_u32 m0, m0, 1312
    s_nop 0
    buffer_load_dwordx4 v19, s[64:67], s80 offen lds
    buffer_load_dword v20, s[64:67], s80 offen offset:1024 lds
    s_add_u32 m0, m0, 1312
    s_nop 0
    buffer_load_dwordx4 v19, s[64:67], s81 offen lds
    buffer_load_dword v20, s[64:67], s81 offen offset:1024 lds
    s_add_u32 m0, m0, 1312
    s_nop 0
    buffer_load_dwordx4 v19, s[64:67], s82 offen lds
    buffer_load_dword v20, s[64:67], s82 offen offset:1024 lds
    s_add_u32 m0, m0, 1312
    s_nop 0
    buffer_load_dwordx4 v19, s[64:67], s83 offen lds
    buffer_load_dword v20, s[64:67], s83 offen offset:1024 lds
    s_add_u32 m0, m0, 1312
    s_nop 0
    s_waitcnt vmcnt(0)
    s_barrier
    s_endpgm
F_MAIN:
    v_lshrrev_b32 v17, 3, v2
    v_mul_u32_u24 v17, 9216, v17
    v_and_b32 v7, 7, v2
    v_lshl_add_u32 v17, v7, 4, v17
    s_mul_i32 s74, s6, 73728
    s_lshl_b32 s9, s3, 7
    s_add_u32 s74, s74, s9
    s_add_u32 s75, s74, 4608
    s_mov_b32 s60, s42
    s_mov_b32 s61, s43
    s_mov_b32 s62, 5308416
    s_mov_b32 s63, 0x20000
    s_add_u32 m0, s15, 0
    s_add_u32 s8, s14, 0
    buffer_load_dwordx4 v5, s[52:55], s8 offen lds
    s_add_u32 m0, s15, 73728
    s_add_u32 s8, s14, 0
    buffer_load_dwordx4 v5, s[56:59], s8 offen lds
    s_and_b32 s12, s3, 3
    s_lshr_b32 s13, s3, 2
    v_and_b32 v18, 1, v4
    v_bfe_u32 v6, v2, 2, 2
    v_lshl_add_u32 v18, v18, 2, v6
    v_lshrrev_b32 v6, 1, v18
    v_xor_b32 v6, s12, v6
    v_lshlrev_b32 v18, 7, v18
    v_lshl_add_u32 v18, v6, 5, v18
    v_and_b32 v6, 3, v2
    v_lshl_add_u32 v18, v6, 3, v18
    v_lshrrev_b32 v6, 1, v4
    v_lshl_add_u32 v18, v6, 11, v18
    s_lshl_b32 s8, s13, 12
    v_add_u32 v18, s8, v18
    v_add_u32 v6, 73728, v18
    v_add_u32 v0, 40960, v18
    v_add_u32 v1, 40960, v6
    v_mul_u32_u24 v8, 1312, v7
    v_lshl_add_u32 v8, v4, 4, v8
    s_lshl_b32 s8, s13, 6
    s_add_u32 s8, s8, 147456
    v_add_u32 v8, s8, v8
    s_lshl_b32 s8, s3, 9
    s_add_u32 s8, s8, 157952
    v_lshl_add_u32 v9, v2, 3, s8
    s_xor_b32 s8, s3, 4
    s_lshl_b32 s8, s8, 9
    s_add_u32 s8, s8, 157952
    v_lshl_add_u32 v10, v2, 3, s8
    v_mul_u32_u24 v11, 144, v7
    v_add_u32 v11, 162048, v11
    v_lshrrev_b32 v12, 3, v3
    v_lshl_add_u32 v13, v4, 1, v12
    v_lshl_add_u32 v13, v13, 4, v11
    v_and_b32 v15, 1, v4
    v_lshlrev_b32 v15, 2, v15
    v_add_u32 v15, v15, v12
    v_lshrrev_b32 v16, 1, v4
    v_lshl_add_u32 v15, v15, 1, v16
    v_mul_u32_u24 v15, 9216, v15
    v_lshl_add_u32 v15, v7, 4, v15
    s_mul_i32 s8, s3, 147456
    s_lshl_b32 s9, s6, 7
    s_add_u32 s8, s8, s9
    s_add_u32 s8, s8, 40960
    v_add_u32 v15, s8, v15
    v_add_u32 v16, 36864, v15
    v_lshl_add_u32 v12, v4, 2, v12
    s_lshl_b32 s8, s12, 4
    s_lshl_b32 s9, s13, 1
    s_add_u32 s8, s8, s9
    v_add_u32 v12, s8, v12
    v_lshl_add_u32 v11, v12, 1, v11
    v_mov_b32 v21, 163456
    v_mov_b32 v22, 1
    s_mov_b32 s10, 0xff00ff00
    s_mov_b32 s11, 0xff00ff00
    s_waitcnt vmcnt(0)
    s_add_u32 m0, s15, 8192
    s_add_u32 s8, s14, 589824
    buffer_load_dwordx4 v5, s[52:55], s8 offen lds
    s_add_u32 m0, s15, 81920
    s_add_u32 s8, s14, 589824
    buffer_load_dwordx4 v5, s[56:59], s8 offen lds
    s_add_u32 m0, s15, 16384
    s_add_u32 s8, s14, 1179648
    buffer_load_dwordx4 v5, s[52:55], s8 offen lds
    s_barrier
    ds_read_b32 v14, v21 offset:4
    s_add_u32 m0, s15, 90112
    s_add_u32 s8, s14, 1179648
    buffer_load_dwordx4 v5, s[56:59], s8 offen lds
    s_waitcnt vmcnt(3)
    s_add_u32 m0, s15, 24576
    s_add_u32 s8, s14, 1769472
    buffer_load_dwordx4 v5, s[52:55], s8 offen lds
    s_waitcnt vmcnt(3)
    s_add_u32 m0, s15, 98304
    s_add_u32 s8, s14, 1769472
    buffer_load_dwordx4 v5, s[56:59], s8 offen lds
    s_waitcnt vmcnt(3)
    s_add_u32 m0, s15, 32768
    s_add_u32 s8, s14, 2359296
    buffer_load_dwordx4 v5, s[52:55], s8 offen lds
    s_waitcnt vmcnt(3)
    s_add_u32 m0, s15, 106496
    s_add_u32 s8, s14, 2359296
    buffer_load_dwordx4 v5, s[56:59], s8 offen lds
    s_waitcnt vmcnt(3)
    s_add_u32 m0, s15, 40960
    s_add_u32 s8, s14, 2949120
    buffer_load_dwordx4 v5, s[52:55], s8 offen lds
    s_waitcnt vmcnt(3)
    s_add_u32 m0, s15, 114688
    s_add_u32 s8, s14, 2949120
    buffer_load_dwordx4 v5, s[56:59], s8 offen lds
    s_waitcnt vmcnt(3)
    s_add_u32 m0, s15, 49152
    s_add_u32 s8, s14, 3538944
    buffer_load_dwordx4 v5, s[52:55], s8 offen lds
    s_waitcnt vmcnt(3)
    s_add_u32 m0, s15, 122880
    s_add_u32 s8, s14, 3538944
    buffer_load_dwordx4 v5, s[56:59], s8 offen lds
    s_waitcnt vmcnt(3)
    s_add_u32 m0, s15, 57344
    s_add_u32 s8, s14, 4128768
    buffer_load_dwordx4 v5, s[52:55], s8 offen lds
    s_waitcnt vmcnt(3)
    s_add_u32 m0, s15, 131072
    s_add_u32 s8, s14, 4128768
    buffer_load_dwordx4 v5, s[56:59], s8 offen lds
    s_waitcnt vmcnt(3)
    s_add_u32 m0, s15, 65536
    s_add_u32 s8, s14, 4718592
    buffer_load_dwordx4 v5, s[52:55], s8 offen lds
    s_waitcnt vmcnt(3)
    s_add_u32 m0, s15, 139264
    s_add_u32 s8, s14, 4718592
    buffer_load_dwordx4 v5, s[56:59], s8 offen lds
    s_waitcnt vmcnt(4)
    s_mov_b64 exec, 1
    ds_add_u32 v21, v22 offset:160
    s_mov_b64 exec, -1
    s_mov_b32 s9, 0
F_LAND:
    ds_read_b32 v22, v21 offset:160
    s_add_u32 s9, s9, 1
    s_waitcnt lgkmcnt(0)
    v_cmp_ne_u32 vcc, 8, v22
    s_cmp_ge_u32 s9, 0x40000
    s_cbranch_scc1 F_LANDED
    s_cbranch_vccnz F_LAND
F_LANDED:
    ds_read_b64_tr_b16 v[24:25], v18 offset:0
    ds_read_b64_tr_b16 v[26:27], v18 offset:1024
    ds_read_b64_tr_b16 v[28:29], v6 offset:0
    ds_read_b64_tr_b16 v[30:31], v6 offset:1024
    ds_read_b64_tr_b16 v[32:33], v18 offset:8192
    ds_read_b64_tr_b16 v[34:35], v18 offset:9216
    ds_read_b64_tr_b16 v[36:37], v6 offset:8192
    ds_read_b64_tr_b16 v[38:39], v6 offset:9216
    ds_read_b64_tr_b16 v[40:41], v18 offset:16384
    ds_read_b64_tr_b16 v[42:43], v18 offset:17408
    ds_read_b64_tr_b16 v[44:45], v6 offset:16384
    ds_read_b64_tr_b16 v[46:47], v6 offset:17408
    ds_read_b64_tr_b16 v[48:49], v18 offset:24576
    ds_read_b64_tr_b16 v[50:51], v18 offset:25600
    ds_read_b64_tr_b16 v[52:53], v6 offset:24576
    ds_read_b64_tr_b16 v[54:55], v6 offset:25600
    ds_read_b64_tr_b16 v[56:57], v18 offset:32768
    ds_read_b64_tr_b16 v[58:59], v18 offset:33792
    ds_read_b64_tr_b16 v[60:61], v6 offset:32768
    ds_read_b64_tr_b16 v[62:63], v6 offset:33792
    ds_read_b64_tr_b16 v[64:65], v0 offset:0
    ds_read_b64_tr_b16 v[66:67], v0 offset:1024
    ds_read_b64_tr_b16 v[68:69], v1 offset:0
    ds_read_b64_tr_b16 v[70:71], v1 offset:1024
    ds_read_b64_tr_b16 v[72:73], v0 offset:8192
    ds_read_b64_tr_b16 v[74:75], v0 offset:9216
    ds_read_b64_tr_b16 v[76:77], v1 offset:8192
    ds_read_b64_tr_b16 v[78:79], v1 offset:9216
    s_waitcnt vmcnt(0)
    s_barrier
    ds_read_b128 v[128:131], v8 offset:0
    ds_read_b128 v[132:135], v8 offset:128
    ds_read_b128 v[136:139], v8 offset:256
    ds_read_b128 v[140:143], v8 offset:384
    ds_read_b128 v[144:147], v8 offset:512
    ds_read_b128 v[148:151], v8 offset:640
    ds_read_b128 v[152:155], v8 offset:768
    ds_read_b128 v[156:159], v8 offset:896
    s_waitcnt lgkmcnt(7)
    v_mfma_f32_16x16x32_bf16 v[160:163], v[24:27], v[128:131], 0
    v_mfma_f32_16x16x32_bf16 v[164:167], v[28:31], v[128:131], 0
    buffer_load_dwordx4 v[96:99], v17, s[60:63], s74 offen offset:0
    s_waitcnt lgkmcnt(6)
    v_mfma_f32_16x16x32_bf16 v[160:163], v[32:35], v[132:135], v[160:163]
    v_mfma_f32_16x16x32_bf16 v[164:167], v[36:39], v[132:135], v[164:167]
    buffer_load_dwordx4 v[100:103], v17, s[60:63], s74 offen offset:1152
    ds_read_b128 v[128:131], v8 offset:1024
    ds_read_b64_tr_b16 v[80:81], v0 offset:16384
    ds_read_b64_tr_b16 v[82:83], v0 offset:17408
    ds_read_b64_tr_b16 v[84:85], v1 offset:16384
    ds_read_b64_tr_b16 v[86:87], v1 offset:17408
    s_waitcnt lgkmcnt(10)
    v_mfma_f32_16x16x32_bf16 v[160:163], v[40:43], v[136:139], v[160:163]
    v_mfma_f32_16x16x32_bf16 v[164:167], v[44:47], v[136:139], v[164:167]
    buffer_load_dwordx4 v[104:107], v17, s[60:63], s74 offen offset:2304
    ds_read_b64_tr_b16 v[88:89], v0 offset:24576
    ds_read_b64_tr_b16 v[90:91], v0 offset:25600
    ds_read_b64_tr_b16 v[92:93], v1 offset:24576
    ds_read_b64_tr_b16 v[94:95], v1 offset:25600
    s_waitcnt lgkmcnt(13)
    v_mfma_f32_16x16x32_bf16 v[160:163], v[48:51], v[140:143], v[160:163]
    v_mfma_f32_16x16x32_bf16 v[164:167], v[52:55], v[140:143], v[164:167]
    buffer_load_dwordx4 v[108:111], v17, s[60:63], s74 offen offset:3456
    s_waitcnt lgkmcnt(12)
    v_mfma_f32_16x16x32_bf16 v[160:163], v[56:59], v[144:147], v[160:163]
    v_mfma_f32_16x16x32_bf16 v[164:167], v[60:63], v[144:147], v[164:167]
    buffer_load_dwordx4 v[112:115], v17, s[60:63], s75 offen offset:0
    s_waitcnt lgkmcnt(11)
    v_mfma_f32_16x16x32_bf16 v[160:163], v[64:67], v[148:151], v[160:163]
    v_mfma_f32_16x16x32_bf16 v[164:167], v[68:71], v[148:151], v[164:167]
    buffer_load_dwordx4 v[116:119], v17, s[60:63], s75 offen offset:1152
    s_waitcnt lgkmcnt(10)
    v_mfma_f32_16x16x32_bf16 v[160:163], v[72:75], v[152:155], v[160:163]
    v_mfma_f32_16x16x32_bf16 v[164:167], v[76:79], v[152:155], v[164:167]
    buffer_load_dwordx4 v[120:123], v17, s[60:63], s75 offen offset:2304
    s_waitcnt lgkmcnt(4)
    v_mfma_f32_16x16x32_bf16 v[160:163], v[80:83], v[156:159], v[160:163]
    v_mfma_f32_16x16x32_bf16 v[164:167], v[84:87], v[156:159], v[164:167]
    buffer_load_dwordx4 v[124:127], v17, s[60:63], s75 offen offset:3456
    s_waitcnt lgkmcnt(0)
    v_mfma_f32_16x16x32_bf16 v[160:163], v[88:91], v[128:131], v[160:163]
    v_mfma_f32_16x16x32_bf16 v[164:167], v[92:95], v[128:131], v[164:167]
    s_cmp_eq_u32 s13, 0
    s_cselect_b64 vcc, -1, 0
    s_nop 5
    v_cndmask_b32 v24, v160, v161, s[10:11]
    v_cndmask_b32 v25, v162, v163, s[10:11]
    v_cndmask_b32 v26, v164, v165, s[10:11]
    v_cndmask_b32 v27, v166, v167, s[10:11]
    v_cndmask_b32 v28, v24, v25, vcc
    v_cndmask_b32 v29, v26, v27, vcc
    ds_write_b64 v9, v[28:29]
    v_cndmask_b32 v24, v25, v24, vcc
    v_cndmask_b32 v25, v27, v26, vcc
    s_waitcnt lgkmcnt(0)
    s_barrier
    ds_read_b64 v[28:29], v10
    s_waitcnt lgkmcnt(0)
    v_add_f32 v24, v24, v28
    v_add_f32 v25, v25, v29
    v_cvt_pk_bf16_f32 v24, v24, v25
    v_lshlrev_b32 v25, 16, v24
    v_mul_f32 v26, 0xbfb8aa3b, v25
    v_exp_f32 v26, v26
    v_and_b32 v24, 0xffff0000, v24
    v_add_f32 v26, 1.0, v26
    v_rcp_f32 v26, v26
    s_nop 0
    v_mul_f32 v25, v25, v26
    v_cvt_pk_bf16_f32 v25, v25, v25
    v_and_b32 v25, 0xffff0000, v25
    v_mul_f32 v24, v24, v25
    v_cvt_pk_bf16_f32 v24, v24, v24
    ds_write_b16 v11, v24
    s_waitcnt vmcnt(0)
    s_mov_b32 s76, 0x05040100
    s_mov_b32 s77, 0x07060302
    v_perm_b32 v128, v100, v96, s76
    v_perm_b32 v129, v108, v104, s76
    v_perm_b32 v130, v116, v112, s76
    v_perm_b32 v131, v124, v120, s76
    v_perm_b32 v132, v100, v96, s77
    v_perm_b32 v133, v108, v104, s77
    v_perm_b32 v134, v116, v112, s77
    v_perm_b32 v135, v124, v120, s77
    v_perm_b32 v136, v101, v97, s76
    v_perm_b32 v137, v109, v105, s76
    v_perm_b32 v138, v117, v113, s76
    v_perm_b32 v139, v125, v121, s76
    v_perm_b32 v140, v101, v97, s77
    v_perm_b32 v141, v109, v105, s77
    v_perm_b32 v142, v117, v113, s77
    v_perm_b32 v143, v125, v121, s77
    v_perm_b32 v144, v102, v98, s76
    v_perm_b32 v145, v110, v106, s76
    v_perm_b32 v146, v118, v114, s76
    v_perm_b32 v147, v126, v122, s76
    v_perm_b32 v148, v102, v98, s77
    v_perm_b32 v149, v110, v106, s77
    v_perm_b32 v150, v118, v114, s77
    v_perm_b32 v151, v126, v122, s77
    v_perm_b32 v152, v103, v99, s76
    v_perm_b32 v153, v111, v107, s76
    v_perm_b32 v154, v119, v115, s76
    v_perm_b32 v155, v127, v123, s76
    v_perm_b32 v156, v103, v99, s77
    v_perm_b32 v157, v111, v107, s77
    v_perm_b32 v158, v119, v115, s77
    v_perm_b32 v159, v127, v123, s77
    s_waitcnt lgkmcnt(0)
F_H:
    s_movk_i32 s78, 0xff
    s_barrier
    ds_read_b128 v[24:27], v13
    s_waitcnt lgkmcnt(0)
    v_mfma_f32_16x16x32_bf16 v[32:35], v[128:131], v[24:27], 0
    v_mfma_f32_16x16x32_bf16 v[48:51], v[144:147], v[24:27], 0
    v_mfma_f32_16x16x32_bf16 v[36:39], v[132:135], v[24:27], 0
    v_mfma_f32_16x16x32_bf16 v[52:55], v[148:151], v[24:27], 0
    v_mfma_f32_16x16x32_bf16 v[40:43], v[136:139], v[24:27], 0
    v_mfma_f32_16x16x32_bf16 v[56:59], v[152:155], v[24:27], 0
    v_mfma_f32_16x16x32_bf16 v[44:47], v[140:143], v[24:27], 0
    v_mfma_f32_16x16x32_bf16 v[60:63], v[156:159], v[24:27], 0
    s_nop 1
    v_permlane32_swap_b32 v32, v48
    v_permlane32_swap_b32 v33, v49
    v_permlane32_swap_b32 v34, v50
    v_permlane32_swap_b32 v35, v51
    v_permlane32_swap_b32 v36, v52
    v_permlane32_swap_b32 v37, v53
    v_permlane32_swap_b32 v38, v54
    v_permlane32_swap_b32 v39, v55
    v_permlane32_swap_b32 v40, v56
    v_permlane32_swap_b32 v41, v57
    v_permlane32_swap_b32 v42, v58
    v_permlane32_swap_b32 v43, v59
    v_permlane32_swap_b32 v44, v60
    v_permlane32_swap_b32 v45, v61
    v_permlane32_swap_b32 v46, v62
    v_permlane32_swap_b32 v47, v63
    v_add_f32_dpp v64, v48, v32 row_ror:8 row_mask:0xf bank_mask:0x3
    v_add_f32_dpp v65, v52, v36 row_ror:8 row_mask:0xf bank_mask:0x3
    v_add_f32_dpp v66, v56, v40 row_ror:8 row_mask:0xf bank_mask:0x3
    v_add_f32_dpp v67, v60, v44 row_ror:8 row_mask:0xf bank_mask:0x3
    v_add_f32_dpp v64, v33, v49 row_ror:8 row_mask:0xf bank_mask:0xc
    v_add_f32_dpp v65, v37, v53 row_ror:8 row_mask:0xf bank_mask:0xc
    v_add_f32_dpp v66, v41, v57 row_ror:8 row_mask:0xf bank_mask:0xc
    v_add_f32_dpp v67, v45, v61 row_ror:8 row_mask:0xf bank_mask:0xc
    v_add_f32_dpp v68, v50, v34 row_ror:8 row_mask:0xf bank_mask:0x3
    v_add_f32_dpp v69, v54, v38 row_ror:8 row_mask:0xf bank_mask:0x3
    v_add_f32_dpp v70, v58, v42 row_ror:8 row_mask:0xf bank_mask:0x3
    v_add_f32_dpp v71, v62, v46 row_ror:8 row_mask:0xf bank_mask:0x3
    v_add_f32_dpp v68, v35, v51 row_ror:8 row_mask:0xf bank_mask:0xc
    v_add_f32_dpp v69, v39, v55 row_ror:8 row_mask:0xf bank_mask:0xc
    v_add_f32_dpp v70, v43, v59 row_ror:8 row_mask:0xf bank_mask:0xc
    v_add_f32_dpp v71, v47, v63 row_ror:8 row_mask:0xf bank_mask:0xc
    v_bfi_b32 v64, s78, v14, v64
    v_bfi_b32 v65, s78, v14, v65
    v_bfi_b32 v66, s78, v14, v66
    v_bfi_b32 v67, s78, v14, v67
    global_store_dwordx4 v15, v[64:67], s[50:51] sc1
    v_bfi_b32 v68, s78, v14, v68
    v_bfi_b32 v69, s78, v14, v69
    v_bfi_b32 v70, s78, v14, v70
    v_bfi_b32 v71, s78, v14, v71
    global_store_dwordx4 v16, v[68:71], s[50:51] sc1
    s_endpgm
SEL_MAIN:
    v_min_u32 v19, 8, v2
    v_lshlrev_b32 v19, 7, v19
    v_lshlrev_b32 v20, 2, v2
    v_lshlrev_b32 v37, 4, v2
    v_and_b32 v24, 0x3c0, v37
    v_add_u32 v24, v24, v37
    v_and_b32 v36, 0x3e0, v37
    v_mul_u32_u24 v36, 3, v36
    v_add_u32 v36, v36, v37
    v_add_u32 v36, 10304, v36
    s_lshl_b32 s8, s3, 11
    v_add_u32 v24, s8, v24
    s_cmp_eq_u32 s3, 7
    s_cselect_b64 vcc, -1, 0
    v_cndmask_b32 v24, v24, v36, vcc
    v_add_u32 v24, 4096, v24
    s_lshl_b32 s8, s3, 8
    s_sub_u32 s8, 0xfff, s8
    v_sub_u32 v32, s8, v20
    v_subrev_u32 v33, 1, v32
    v_subrev_u32 v34, 2, v32
    v_subrev_u32 v35, 3, v32
    v_mov_b32 v21, 163456
    s_lshl_b32 s8, s3, 5
    s_add_u32 s8, s8, 163200
    v_lshl_add_u32 v25, v4, 3, s8
    v_and_b32 v27, 28, v20
    v_add_u32 v27, s8, v27
    v_add_u32 v26, 163200, v20
    s_mov_b32 s76, 0xffff
    s_mov_b32 s10, 0x00010001
    s_mov_b32 s11, 0x00010001
    s_barrier
    ds_read_b32 v14, v21 offset:4
    s_mov_b32 s7, 0
    s_waitcnt lgkmcnt(0)
    s_waitcnt vmcnt(0)
F_POLL:
    global_load_dwordx4 v[28:31], v24, s[50:51] sc1
    s_add_u32 s7, s7, 1
    s_waitcnt vmcnt(0)
    v_xor_b32 v36, v28, v14
    v_bitop3_b32 v36, v36, v29, v14 bitop3:0xf6
    v_bitop3_b32 v36, v36, v30, v14 bitop3:0xf6
    v_bitop3_b32 v36, v36, v31, v14 bitop3:0xf6
    v_and_b32 v36, 0xffff, v36
    v_cmp_ne_u32 vcc, 0, v36
    s_cmp_ge_u32 s7, 16384
    s_cbranch_scc1 F_GOT
    s_cbranch_vccz F_GOT
    s_mov_b64 exec, vcc
    s_sleep 4
    s_branch F_POLL
F_GOT:
    s_mov_b64 exec, -1
    v_bfi_b32 v28, s76, v32, v28
    v_bfi_b32 v29, s76, v33, v29
    v_bfi_b32 v30, s76, v34, v30
    v_bfi_b32 v31, s76, v35, v31
    v_max_u32 v36, v28, v29
    v_min_u32 v37, v28, v29
    v_max3_u32 v40, v36, v30, v31
    v_med3_u32 v41, v36, v30, v31
    v_med3_u32 v42, v37, v30, v31
    v_max_u32 v41, v41, v37
    v_min_u32 v42, v42, v36
    v_max_u32_dpp v44, v40, v40 row_ror:8 row_mask:0xf bank_mask:0xf
    s_nop 1
    v_max_u32_dpp v44, v44, v44 row_ror:4 row_mask:0xf bank_mask:0xf
    s_nop 1
    v_max_u32_dpp v44, v44, v44 row_ror:2 row_mask:0xf bank_mask:0xf
    s_nop 1
    v_max_u32_dpp v44, v44, v44 row_ror:1 row_mask:0xf bank_mask:0xf
    v_cmp_eq_u32 vcc, v40, v44
    s_nop 1
    v_cndmask_b32 v40, v40, v41, vcc
    v_cndmask_b32 v41, v41, v42, vcc
    s_nop 0
    v_max_u32_dpp v45, v40, v40 row_ror:8 row_mask:0xf bank_mask:0xf
    s_nop 1
    v_max_u32_dpp v45, v45, v45 row_ror:4 row_mask:0xf bank_mask:0xf
    s_nop 1
    v_max_u32_dpp v45, v45, v45 row_ror:2 row_mask:0xf bank_mask:0xf
    s_nop 1
    v_max_u32_dpp v45, v45, v45 row_ror:1 row_mask:0xf bank_mask:0xf
    v_cmp_eq_u32 vcc, v40, v45
    s_nop 1
    v_cndmask_b32 v40, v40, v41, vcc
    s_nop 1
    v_max_u32_dpp v46, v40, v40 row_ror:8 row_mask:0xf bank_mask:0xf
    s_nop 1
    v_max_u32_dpp v46, v46, v46 row_ror:4 row_mask:0xf bank_mask:0xf
    s_nop 1
    v_max_u32_dpp v46, v46, v46 row_ror:2 row_mask:0xf bank_mask:0xf
    s_nop 1
    v_max_u32_dpp v46, v46, v46 row_ror:1 row_mask:0xf bank_mask:0xf
    s_mov_b64 exec, s[10:11]
    ds_write_b64 v25, v[44:45]
    ds_max_u32 v21, v46
    s_mov_b64 exec, -1
    v_readlane_b32 s77, v44, 0
    v_readlane_b32 s78, v45, 0
    v_readlane_b32 s79, v44, 16
    v_readlane_b32 s80, v45, 16
    v_readlane_b32 s81, v44, 32
    v_readlane_b32 s82, v45, 32
    v_readlane_b32 s83, v44, 48
    v_readlane_b32 s100, v45, 48
    ds_read_b32 v48, v27
    v_mov_b32 v49, v14
    s_lshl_b32 s72, s4, 8
    s_waitcnt lgkmcnt(0)
    s_barrier
    ds_read_b32 v36, v26
    ds_read_b32 v37, v21
    v_not_b32 v50, v48
    v_and_b32 v50, 0x7ff, v50
    v_mul_u32_u24 v50, 1152, v50
    s_waitcnt lgkmcnt(0)
    v_cmp_gt_u32 vcc, v36, v37
    v_cmp_lt_u32 s[18:19], s77, v36
    v_cmp_lt_u32 s[20:21], s78, v36
    v_cmp_lt_u32 s[22:23], s79, v36
    v_cmp_lt_u32 s[24:25], s80, v36
    v_cmp_lt_u32 s[26:27], s81, v36
    v_cmp_lt_u32 s[28:29], s82, v36
    v_cmp_lt_u32 s[30:31], s83, v36
    v_cmp_lt_u32 s[34:35], s100, v36
    s_bcnt1_i32_b64 s8, vcc
    s_cmp_lt_u32 s8, 8
    s_cbranch_scc1 F_SLOW
    s_bcnt1_i32_b64 s18, s[18:19]
    v_writelane_b32 v37, s18, 0
    s_bcnt1_i32_b64 s20, s[20:21]
    v_writelane_b32 v37, s20, 1
    s_bcnt1_i32_b64 s22, s[22:23]
    v_writelane_b32 v37, s22, 2
    s_bcnt1_i32_b64 s24, s[24:25]
    v_writelane_b32 v37, s24, 3
    s_bcnt1_i32_b64 s26, s[26:27]
    v_writelane_b32 v37, s26, 4
    s_bcnt1_i32_b64 s28, s[28:29]
    v_writelane_b32 v37, s28, 5
    s_bcnt1_i32_b64 s30, s[30:31]
    v_writelane_b32 v37, s30, 6
    s_bcnt1_i32_b64 s34, s[34:35]
    v_writelane_b32 v37, s34, 7
    v_cmp_gt_u32 vcc, 8, v37
    v_lshl_add_u32 v37, v37, 3, s72
    s_and_b64 exec, vcc, 0xff
    s_cbranch_execz F_REST
    global_store_dwordx2 v37, v[48:49], s[50:51] offset:256
    global_store_dwordx2 v37, v[48:49], s[50:51] offset:384 sc1
    global_load_dword v51, v50, s[16:17] offset:0
    global_load_dword v51, v50, s[16:17] offset:128
    global_load_dword v51, v50, s[16:17] offset:256
    global_load_dword v51, v50, s[16:17] offset:384
    global_load_dword v51, v50, s[16:17] offset:512
    global_load_dword v51, v50, s[16:17] offset:640
    global_load_dword v51, v50, s[16:17] offset:768
    global_load_dword v51, v50, s[16:17] offset:896
    global_load_dword v51, v50, s[16:17] offset:1024
F_REST:
    s_cmp_lg_u32 s2, 72
    s_cbranch_scc1 W_END
    s_cmp_lg_u32 s3, 0
    s_cbranch_scc1 W_END
    s_mov_b64 exec, 1
    v_mov_b32 v50, 0
    global_store_dword v50, v14, s[50:51] sc1
    s_endpgm
F_SLOW:
    v_lshlrev_b32 v27, 4, v2
    v_and_b32 v24, 0x3c0, v27
    v_add_u32 v24, v24, v27
    v_and_b32 v26, 0x3e0, v27
    v_mul_u32_u24 v26, 3, v26
    v_add_u32 v26, v26, v27
    v_add_u32 v26, 10304, v26
    v_add_u32 v24, 8192, v24
    v_add_u32 v25, 8192, v24
    v_add_u32 v26, 2048, v26
    global_load_dwordx4 v[28:31], v24, s[50:51] offset:-4096 sc1
    global_load_dwordx4 v[32:35], v24, s[50:51] offset:-2048 sc1
    global_load_dwordx4 v[36:39], v24, s[50:51] offset:0 sc1
    global_load_dwordx4 v[40:43], v24, s[50:51] offset:2048 sc1
    global_load_dwordx4 v[44:47], v25, s[50:51] offset:-4096 sc1
    global_load_dwordx4 v[48:51], v25, s[50:51] offset:-2048 sc1
    global_load_dwordx4 v[52:55], v25, s[50:51] offset:0 sc1
    global_load_dwordx4 v[56:59], v26, s[50:51] offset:2048 sc1
    v_sub_u32 v24, 0xfff, v20
    s_waitcnt vmcnt(0)
    v_subrev_u32 v25, 0, v24
    v_bfi_b32 v28, s76, v25, v28
    v_subrev_u32 v25, 1, v24
    v_bfi_b32 v29, s76, v25, v29
    v_subrev_u32 v25, 2, v24
    v_bfi_b32 v30, s76, v25, v30
    v_subrev_u32 v25, 3, v24
    v_bfi_b32 v31, s76, v25, v31
    v_subrev_u32 v25, 256, v24
    v_bfi_b32 v32, s76, v25, v32
    v_subrev_u32 v25, 257, v24
    v_bfi_b32 v33, s76, v25, v33
    v_subrev_u32 v25, 258, v24
    v_bfi_b32 v34, s76, v25, v34
    v_subrev_u32 v25, 259, v24
    v_bfi_b32 v35, s76, v25, v35
    v_subrev_u32 v25, 512, v24
    v_bfi_b32 v36, s76, v25, v36
    v_subrev_u32 v25, 513, v24
    v_bfi_b32 v37, s76, v25, v37
    v_subrev_u32 v25, 514, v24
    v_bfi_b32 v38, s76, v25, v38
    v_subrev_u32 v25, 515, v24
    v_bfi_b32 v39, s76, v25, v39
    v_subrev_u32 v25, 768, v24
    v_bfi_b32 v40, s76, v25, v40
    v_subrev_u32 v25, 769, v24
    v_bfi_b32 v41, s76, v25, v41
    v_subrev_u32 v25, 770, v24
    v_bfi_b32 v42, s76, v25, v42
    v_subrev_u32 v25, 771, v24
    v_bfi_b32 v43, s76, v25, v43
    v_subrev_u32 v25, 1024, v24
    v_bfi_b32 v44, s76, v25, v44
    v_subrev_u32 v25, 1025, v24
    v_bfi_b32 v45, s76, v25, v45
    v_subrev_u32 v25, 1026, v24
    v_bfi_b32 v46, s76, v25, v46
    v_subrev_u32 v25, 1027, v24
    v_bfi_b32 v47, s76, v25, v47
    v_subrev_u32 v25, 1280, v24
    v_bfi_b32 v48, s76, v25, v48
    v_subrev_u32 v25, 1281, v24
    v_bfi_b32 v49, s76, v25, v49
    v_subrev_u32 v25, 1282, v24
    v_bfi_b32 v50, s76, v25, v50
    v_subrev_u32 v25, 1283, v24
    v_bfi_b32 v51, s76, v25, v51
    v_subrev_u32 v25, 1536, v24
    v_bfi_b32 v52, s76, v25, v52
    v_subrev_u32 v25, 1537, v24
    v_bfi_b32 v53, s76, v25, v53
    v_subrev_u32 v25, 1538, v24
    v_bfi_b32 v54, s76, v25, v54
    v_subrev_u32 v25, 1539, v24
    v_bfi_b32 v55, s76, v25, v55
    v_subrev_u32 v25, 1792, v24
    v_bfi_b32 v56, s76, v25, v56
    v_subrev_u32 v25, 1793, v24
    v_bfi_b32 v57, s76, v25, v57
    v_subrev_u32 v25, 1794, v24
    v_bfi_b32 v58, s76, v25, v58
    v_subrev_u32 v25, 1795, v24
    v_bfi_b32 v59, s76, v25, v59
    s_mov_b32 s77, 0
    s_mov_b32 s7, 0
F_SLOOP:
    v_subrev_u32 v60, s77, v28
    v_subrev_u32 v61, s77, v29
    v_subrev_u32 v62, s77, v30
    v_subrev_u32 v63, s77, v31
    v_subrev_u32 v64, s77, v32
    v_subrev_u32 v65, s77, v33
    v_subrev_u32 v66, s77, v34
    v_subrev_u32 v67, s77, v35
    v_subrev_u32 v68, s77, v36
    v_subrev_u32 v69, s77, v37
    v_subrev_u32 v70, s77, v38
    v_subrev_u32 v71, s77, v39
    v_subrev_u32 v72, s77, v40
    v_subrev_u32 v73, s77, v41
    v_subrev_u32 v74, s77, v42
    v_subrev_u32 v75, s77, v43
    v_subrev_u32 v76, s77, v44
    v_subrev_u32 v77, s77, v45
    v_subrev_u32 v78, s77, v46
    v_subrev_u32 v79, s77, v47
    v_subrev_u32 v80, s77, v48
    v_subrev_u32 v81, s77, v49
    v_subrev_u32 v82, s77, v50
    v_subrev_u32 v83, s77, v51
    v_subrev_u32 v84, s77, v52
    v_subrev_u32 v85, s77, v53
    v_subrev_u32 v86, s77, v54
    v_subrev_u32 v87, s77, v55
    v_subrev_u32 v88, s77, v56
    v_subrev_u32 v89, s77, v57
    v_subrev_u32 v90, s77, v58
    v_subrev_u32 v91, s77, v59
    v_max_u32 v60, v60, v61
    v_max3_u32 v60, v60, v62, v63
    v_max3_u32 v60, v60, v64, v65
    v_max3_u32 v60, v60, v66, v67
    v_max3_u32 v60, v60, v68, v69
    v_max3_u32 v60, v60, v70, v71
    v_max3_u32 v60, v60, v72, v73
    v_max3_u32 v60, v60, v74, v75
    v_max3_u32 v60, v60, v76, v77
    v_max3_u32 v60, v60, v78, v79
    v_max3_u32 v60, v60, v80, v81
    v_max3_u32 v60, v60, v82, v83
    v_max3_u32 v60, v60, v84, v85
    v_max3_u32 v60, v60, v86, v87
    v_max3_u32 v60, v60, v88, v89
    v_max3_u32 v60, v60, v90, v91
    s_nop 1
    v_max_u32_dpp v60, v60, v60 row_shr:1 row_mask:0xf bank_mask:0xf
    s_nop 1
    v_max_u32_dpp v60, v60, v60 row_shr:2 row_mask:0xf bank_mask:0xf
    s_nop 1
    v_max_u32_dpp v60, v60, v60 row_shr:4 row_mask:0xf bank_mask:0xf
    s_nop 1
    v_max_u32_dpp v60, v60, v60 row_shr:8 row_mask:0xf bank_mask:0xf
    s_nop 1
    v_max_u32_dpp v60, v60, v60 row_bcast:15 row_mask:0xa bank_mask:0xf
    s_nop 1
    v_max_u32_dpp v60, v60, v60 row_bcast:31 row_mask:0xc bank_mask:0xf
    s_nop 0
    v_readlane_b32 s8, v60, 63
    s_add_u32 s77, s77, s8
    s_add_u32 s7, s7, 1
    s_cmp_le_u32 s7, s3
    s_cbranch_scc1 F_SLOOP
    s_mov_b64 exec, 1
    v_mov_b32 v48, s77
    v_mov_b32 v49, v14
    s_lshl_b32 s8, s3, 3
    s_add_u32 s8, s8, s72
    v_mov_b32 v50, s8
    global_store_dwordx2 v50, v[48:49], s[50:51] offset:256
    global_store_dwordx2 v50, v[48:49], s[50:51] offset:384 sc1
    s_branch F_REST
CK_MAIN:
    s_mul_i32 s13, s7, 8704
    s_add_u32 s13, s13, 120832
    s_lshr_b32 s14, s7, 1
    s_mul_i32 s14, s14, 60192
    s_and_b32 s8, s7, 1
    s_lshl_b32 s8, s8, 9
    s_add_u32 s14, s14, s8
    s_lshl_b32 s8, s12, 8
    s_add_u32 m0, s14, s8
    v_mov_b32 v124, 0
    v_mov_b32 v125, 0
    v_mov_b32 v126, 0
    v_mov_b32 v127, 0
    s_lshl_b32 s8, s12, 11
    s_add_u32 s8, s8, s13
    v_lshl_add_u32 v20, v2, 4, s8
    ds_write_b128 v20, v[124:127]
    ds_write_b128 v20, v[124:127] offset:1024
    v_mul_u32_u24 v128, 1056, v3
    v_lshl_add_u32 v128, v4, 4, v128
    v_add_u32 v128, s14, v128
    s_lshl_b32 s8, s3, 2
    s_add_u32 s9, s8, 155680
    v_mov_b32 v129, s9
    s_xor_b32 s8, s8, 16
    s_add_u32 s9, s8, 155680
    v_mov_b32 v130, s9
    v_mov_b32 v21, 0x3c00
    ds_write_addtid_b32 v21 offset:43296
    v_mov_b32 v22, 0x3fb8aa3b
    v_mov_b32 v23, 0x32a57060
    v_mov_b32 v24, 0x3fb8aa3b
    v_mov_b32 v25, 0x3e22f983
    s_mov_b32 s15, 0x7fff7fff
    s_cmp_eq_u32 s12, 0
    s_mov_b32 s73, 0x01000c0c
    s_cselect_b32 s73, s73, 0x03020c0c
    s_waitcnt vmcnt(6)
    v_mul_f32 v19, v18, v22
    v_fma_f32 v22, v18, v22, -v19
    v_exp_f32 v19, v19
    v_fma_f32 v22, v18, v23, v22
    v_mul_f32 v22, 0x3f317218, v22
    v_fma_f32 v19, v19, v22, v19
    v_cvt_pk_bf16_f32 v19, v19, v19
    v_and_b32 v18, 0xffff0000, v19
    v_pk_mul_f32 v[24:25], v[24:25], v[18:19] op_sel_hi:[1,0]
    s_waitcnt vmcnt(0)
    v_and_b32 v14, s15, v30
    v_and_b32 v15, s15, v31
    v_and_b32 v16, s15, v32
    v_and_b32 v17, s15, v33
    v_perm_b32 v8, v28, v28, s73
    v_perm_b32 v9, v29, v29, s73
    v_perm_b32 v10, v30, v30, s73
    v_perm_b32 v11, v31, v31, s73
    v_perm_b32 v12, v32, v32, s73
    v_perm_b32 v13, v33, v33, s73
    v_pk_max_u16 v14, v14, v15
    v_pk_max_u16 v16, v16, v17
    v_lshlrev_b32 v15, 16, v14
    v_lshlrev_b32 v17, 16, v16
    v_pk_mul_f32 v[14:15], v[14:15], v[16:17]
    v_pk_mul_f32 v[8:9], v[8:9], v[24:25]
    v_max_f32 v14, v14, v15
    v_pk_mul_f32 v[10:11], v[10:11], v[18:19] op_sel_hi:[1,0]
    v_mul_f32 v14, v14, v18
    v_pk_mul_f32 v[66:67], v[12:13], v[10:11] op_sel:[1,1] op_sel_hi:[1,0]
    v_pk_fma_f32 v[56:57], v[12:13], v[10:11], v[66:67] op_sel:[0,0,0] op_sel_hi:[0,1,1] neg_lo:[0,0,1]
    v_max_u32_dpp v14, v14, v14 row_shr:1 row_mask:0xf bank_mask:0xf
    v_mul_f32 v60, 0x41000000, v8
    v_mul_f32 v61, 0xc1000000, v9
    v_max_u32_dpp v14, v14, v14 row_shr:2 row_mask:0xf bank_mask:0xf
    v_mul_f32 v62, 0x43000000, v8
    v_mul_f32 v63, 0x43000000, v9
    v_max_u32_dpp v14, v14, v14 row_shr:4 row_mask:0xf bank_mask:0xf
    v_fract_f32 v59, v9
    v_fract_f32 v61, v61
    v_max_u32_dpp v14, v14, v14 row_shr:8 row_mask:0xf bank_mask:0xf
    v_fract_f32 v63, v63
    v_exp_f32 v20, v8
    v_max_u32_dpp v14, v14, v14 row_bcast:15 row_mask:0xa bank_mask:0xf
    v_exp_f32 v22, v60
    v_exp_f32 v26, v62
    v_max_u32_dpp v14, v14, v14 row_bcast:31 row_mask:0xc bank_mask:0xf
    v_cos_f32 v60, v61
    v_readlane_b32 s8, v14, 63
    v_sin_f32 v61, v61
    v_cos_f32 v58, v59
    v_sin_f32 v59, v59
    v_cos_f32 v62, v63
    v_sin_f32 v63, v63
    s_lshr_b32 s8, s8, 23
    s_sub_i32 s8, 258, s8
    s_max_i32 s8, s8, 1
    s_min_i32 s8, s8, 253
    s_lshl_b32 s10, s8, 23
    v_pk_mul_f32 v[60:61], v[60:61], v[22:23] op_sel_hi:[1,0]
    v_pk_mul_f32 v[58:59], v[58:59], v[20:21] op_sel_hi:[1,0]
    v_pk_mul_f32 v[62:63], v[62:63], v[26:27] op_sel_hi:[1,0]
    v_pk_mul_f32 v[56:57], v[56:57], s[10:11] op_sel_hi:[1,0]
    v_cvt_pk_f16_f32 v70, v60, v61
    ds_write_addtid_b32 v70 offset:44352
    v_cvt_pk_f16_f32 v71, v56, v57
    ds_write_addtid_b32 v71 offset:42240
    v_pk_mul_f32 v[66:67], v[56:57], v[58:59] op_sel:[1,1] op_sel_hi:[1,0]
    v_pk_fma_f32 v[40:41], v[56:57], v[58:59], v[66:67] op_sel:[0,0,0] op_sel_hi:[0,1,1] neg_lo:[0,0,1]
    v_cvt_pk_f16_f32 v72, v40, v41
    ds_write_addtid_b32 v72 offset:0
    v_pk_mul_f32 v[66:67], v[40:41], v[58:59] op_sel:[1,1] op_sel_hi:[1,0]
    v_pk_fma_f32 v[42:43], v[40:41], v[58:59], v[66:67] op_sel:[0,0,0] op_sel_hi:[0,1,1] neg_lo:[0,0,1]
    v_cvt_pk_f16_f32 v73, v42, v43
    ds_write_addtid_b32 v73 offset:1056
    v_pk_mul_f32 v[66:67], v[42:43], v[58:59] op_sel:[1,1] op_sel_hi:[1,0]
    v_pk_fma_f32 v[44:45], v[42:43], v[58:59], v[66:67] op_sel:[0,0,0] op_sel_hi:[0,1,1] neg_lo:[0,0,1]
    v_cvt_pk_f16_f32 v70, v44, v45
    ds_write_addtid_b32 v70 offset:2112
    v_pk_mul_f32 v[66:67], v[44:45], v[58:59] op_sel:[1,1] op_sel_hi:[1,0]
    v_pk_fma_f32 v[46:47], v[44:45], v[58:59], v[66:67] op_sel:[0,0,0] op_sel_hi:[0,1,1] neg_lo:[0,0,1]
    v_cvt_pk_f16_f32 v71, v46, v47
    ds_write_addtid_b32 v71 offset:3168
    v_pk_mul_f32 v[66:67], v[46:47], v[58:59] op_sel:[1,1] op_sel_hi:[1,0]
    v_pk_fma_f32 v[48:49], v[46:47], v[58:59], v[66:67] op_sel:[0,0,0] op_sel_hi:[0,1,1] neg_lo:[0,0,1]
    v_cvt_pk_f16_f32 v72, v48, v49
    ds_write_addtid_b32 v72 offset:4224
    v_pk_mul_f32 v[66:67], v[48:49], v[58:59] op_sel:[1,1] op_sel_hi:[1,0]
    v_pk_fma_f32 v[50:51], v[48:49], v[58:59], v[66:67] op_sel:[0,0,0] op_sel_hi:[0,1,1] neg_lo:[0,0,1]
    v_cvt_pk_f16_f32 v73, v50, v51
    ds_write_addtid_b32 v73 offset:5280
    v_pk_mul_f32 v[66:67], v[50:51], v[58:59] op_sel:[1,1] op_sel_hi:[1,0]
    v_pk_fma_f32 v[52:53], v[50:51], v[58:59], v[66:67] op_sel:[0,0,0] op_sel_hi:[0,1,1] neg_lo:[0,0,1]
    v_cvt_pk_f16_f32 v70, v52, v53
    ds_write_addtid_b32 v70 offset:6336
    v_pk_mul_f32 v[66:67], v[52:53], v[58:59] op_sel:[1,1] op_sel_hi:[1,0]
    v_pk_fma_f32 v[54:55], v[52:53], v[58:59], v[66:67] op_sel:[0,0,0] op_sel_hi:[0,1,1] neg_lo:[0,0,1]
    v_cvt_pk_f16_f32 v71, v54, v55
    ds_write_addtid_b32 v71 offset:7392
    v_pk_mul_f32 v[66:67], v[40:41], v[62:63] op_sel:[1,1] op_sel_hi:[1,0]
    v_pk_fma_f32 v[40:41], v[40:41], v[62:63], v[66:67] op_sel:[0,0,0] op_sel_hi:[0,1,1] neg_lo:[0,0,1]
    v_cvt_pk_f16_f32 v72, v40, v41
    ds_write_addtid_b32 v72 offset:8448
    v_pk_mul_f32 v[66:67], v[42:43], v[62:63] op_sel:[1,1] op_sel_hi:[1,0]
    v_pk_fma_f32 v[42:43], v[42:43], v[62:63], v[66:67] op_sel:[0,0,0] op_sel_hi:[0,1,1] neg_lo:[0,0,1]
    v_cvt_pk_f16_f32 v73, v42, v43
    ds_write_addtid_b32 v73 offset:9504
    v_pk_mul_f32 v[66:67], v[44:45], v[62:63] op_sel:[1,1] op_sel_hi:[1,0]
    v_pk_fma_f32 v[44:45], v[44:45], v[62:63], v[66:67] op_sel:[0,0,0] op_sel_hi:[0,1,1] neg_lo:[0,0,1]
    v_cvt_pk_f16_f32 v70, v44, v45
    ds_write_addtid_b32 v70 offset:10560
    v_pk_mul_f32 v[66:67], v[46:47], v[62:63] op_sel:[1,1] op_sel_hi:[1,0]
    v_pk_fma_f32 v[46:47], v[46:47], v[62:63], v[66:67] op_sel:[0,0,0] op_sel_hi:[0,1,1] neg_lo:[0,0,1]
    v_cvt_pk_f16_f32 v71, v46, v47
    ds_write_addtid_b32 v71 offset:11616
    v_pk_mul_f32 v[66:67], v[48:49], v[62:63] op_sel:[1,1] op_sel_hi:[1,0]
    v_pk_fma_f32 v[48:49], v[48:49], v[62:63], v[66:67] op_sel:[0,0,0] op_sel_hi:[0,1,1] neg_lo:[0,0,1]
    v_cvt_pk_f16_f32 v72, v48, v49
    ds_write_addtid_b32 v72 offset:12672
    v_pk_mul_f32 v[66:67], v[50:51], v[62:63] op_sel:[1,1] op_sel_hi:[1,0]
    v_pk_fma_f32 v[50:51], v[50:51], v[62:63], v[66:67] op_sel:[0,0,0] op_sel_hi:[0,1,1] neg_lo:[0,0,1]
    v_cvt_pk_f16_f32 v73, v50, v51
    ds_write_addtid_b32 v73 offset:13728
    v_pk_mul_f32 v[66:67], v[52:53], v[62:63] op_sel:[1,1] op_sel_hi:[1,0]
    v_pk_fma_f32 v[52:53], v[52:53], v[62:63], v[66:67] op_sel:[0,0,0] op_sel_hi:[0,1,1] neg_lo:[0,0,1]
    v_cvt_pk_f16_f32 v70, v52, v53
    ds_write_addtid_b32 v70 offset:14784
    v_pk_mul_f32 v[66:67], v[54:55], v[62:63] op_sel:[1,1] op_sel_hi:[1,0]
    v_pk_fma_f32 v[54:55], v[54:55], v[62:63], v[66:67] op_sel:[0,0,0] op_sel_hi:[0,1,1] neg_lo:[0,0,1]
    v_cvt_pk_f16_f32 v71, v54, v55
    ds_write_addtid_b32 v71 offset:15840
    v_pk_mul_f32 v[66:67], v[42:43], v[62:63] op_sel:[1,1] op_sel_hi:[1,0]
    v_pk_fma_f32 v[42:43], v[42:43], v[62:63], v[66:67] op_sel:[0,0,0] op_sel_hi:[0,1,1] neg_lo:[0,0,1]
    v_cvt_pk_f16_f32 v72, v42, v43
    ds_write_addtid_b32 v72 offset:16896
    v_pk_mul_f32 v[66:67], v[46:47], v[62:63] op_sel:[1,1] op_sel_hi:[1,0]
    v_pk_fma_f32 v[46:47], v[46:47], v[62:63], v[66:67] op_sel:[0,0,0] op_sel_hi:[0,1,1] neg_lo:[0,0,1]
    v_cvt_pk_f16_f32 v73, v46, v47
    ds_write_addtid_b32 v73 offset:17952
    v_pk_mul_f32 v[66:67], v[50:51], v[62:63] op_sel:[1,1] op_sel_hi:[1,0]
    v_pk_fma_f32 v[50:51], v[50:51], v[62:63], v[66:67] op_sel:[0,0,0] op_sel_hi:[0,1,1] neg_lo:[0,0,1]
    v_cvt_pk_f16_f32 v70, v50, v51
    ds_write_addtid_b32 v70 offset:19008
    v_pk_mul_f32 v[66:67], v[54:55], v[62:63] op_sel:[1,1] op_sel_hi:[1,0]
    v_pk_fma_f32 v[54:55], v[54:55], v[62:63], v[66:67] op_sel:[0,0,0] op_sel_hi:[0,1,1] neg_lo:[0,0,1]
    v_cvt_pk_f16_f32 v71, v54, v55
    ds_write_addtid_b32 v71 offset:20064
    v_pk_mul_f32 v[66:67], v[42:43], v[62:63] op_sel:[1,1] op_sel_hi:[1,0]
    v_pk_fma_f32 v[42:43], v[42:43], v[62:63], v[66:67] op_sel:[0,0,0] op_sel_hi:[0,1,1] neg_lo:[0,0,1]
    v_cvt_pk_f16_f32 v72, v42, v43
    ds_write_addtid_b32 v72 offset:21120
    v_pk_mul_f32 v[66:67], v[46:47], v[62:63] op_sel:[1,1] op_sel_hi:[1,0]
    v_pk_fma_f32 v[46:47], v[46:47], v[62:63], v[66:67] op_sel:[0,0,0] op_sel_hi:[0,1,1] neg_lo:[0,0,1]
    v_cvt_pk_f16_f32 v73, v46, v47
    ds_write_addtid_b32 v73 offset:22176
    v_pk_mul_f32 v[66:67], v[50:51], v[62:63] op_sel:[1,1] op_sel_hi:[1,0]
    v_pk_fma_f32 v[50:51], v[50:51], v[62:63], v[66:67] op_sel:[0,0,0] op_sel_hi:[0,1,1] neg_lo:[0,0,1]
    v_cvt_pk_f16_f32 v70, v50, v51
    ds_write_addtid_b32 v70 offset:23232
    v_pk_mul_f32 v[66:67], v[54:55], v[62:63] op_sel:[1,1] op_sel_hi:[1,0]
    v_pk_fma_f32 v[54:55], v[54:55], v[62:63], v[66:67] op_sel:[0,0,0] op_sel_hi:[0,1,1] neg_lo:[0,0,1]
    v_cvt_pk_f16_f32 v71, v54, v55
    ds_write_addtid_b32 v71 offset:24288
    v_pk_mul_f32 v[66:67], v[46:47], v[62:63] op_sel:[1,1] op_sel_hi:[1,0]
    v_pk_fma_f32 v[46:47], v[46:47], v[62:63], v[66:67] op_sel:[0,0,0] op_sel_hi:[0,1,1] neg_lo:[0,0,1]
    v_cvt_pk_f16_f32 v72, v46, v47
    ds_write_addtid_b32 v72 offset:25344
    v_pk_mul_f32 v[66:67], v[54:55], v[62:63] op_sel:[1,1] op_sel_hi:[1,0]
    v_pk_fma_f32 v[54:55], v[54:55], v[62:63], v[66:67] op_sel:[0,0,0] op_sel_hi:[0,1,1] neg_lo:[0,0,1]
    v_cvt_pk_f16_f32 v73, v54, v55
    ds_write_addtid_b32 v73 offset:26400
    v_pk_mul_f32 v[66:67], v[46:47], v[62:63] op_sel:[1,1] op_sel_hi:[1,0]
    v_pk_fma_f32 v[46:47], v[46:47], v[62:63], v[66:67] op_sel:[0,0,0] op_sel_hi:[0,1,1] neg_lo:[0,0,1]
    v_cvt_pk_f16_f32 v70, v46, v47
    ds_write_addtid_b32 v70 offset:27456
    v_pk_mul_f32 v[66:67], v[54:55], v[62:63] op_sel:[1,1] op_sel_hi:[1,0]
    v_pk_fma_f32 v[54:55], v[54:55], v[62:63], v[66:67] op_sel:[0,0,0] op_sel_hi:[0,1,1] neg_lo:[0,0,1]
    v_cvt_pk_f16_f32 v71, v54, v55
    ds_write_addtid_b32 v71 offset:28512
    v_pk_mul_f32 v[66:67], v[46:47], v[62:63] op_sel:[1,1] op_sel_hi:[1,0]
    v_pk_fma_f32 v[46:47], v[46:47], v[62:63], v[66:67] op_sel:[0,0,0] op_sel_hi:[0,1,1] neg_lo:[0,0,1]
    v_cvt_pk_f16_f32 v72, v46, v47
    ds_write_addtid_b32 v72 offset:29568
    v_pk_mul_f32 v[66:67], v[54:55], v[62:63] op_sel:[1,1] op_sel_hi:[1,0]
    v_pk_fma_f32 v[54:55], v[54:55], v[62:63], v[66:67] op_sel:[0,0,0] op_sel_hi:[0,1,1] neg_lo:[0,0,1]
    v_cvt_pk_f16_f32 v73, v54, v55
    ds_write_addtid_b32 v73 offset:30624
    v_pk_mul_f32 v[66:67], v[46:47], v[62:63] op_sel:[1,1] op_sel_hi:[1,0]
    v_pk_fma_f32 v[46:47], v[46:47], v[62:63], v[66:67] op_sel:[0,0,0] op_sel_hi:[0,1,1] neg_lo:[0,0,1]
    v_cvt_pk_f16_f32 v70, v46, v47
    ds_write_addtid_b32 v70 offset:31680
    v_pk_mul_f32 v[66:67], v[54:55], v[62:63] op_sel:[1,1] op_sel_hi:[1,0]
    v_pk_fma_f32 v[54:55], v[54:55], v[62:63], v[66:67] op_sel:[0,0,0] op_sel_hi:[0,1,1] neg_lo:[0,0,1]
    v_cvt_pk_f16_f32 v71, v54, v55
    ds_write_addtid_b32 v71 offset:32736
    v_pk_mul_f32 v[66:67], v[54:55], v[62:63] op_sel:[1,1] op_sel_hi:[1,0]
    v_pk_fma_f32 v[54:55], v[54:55], v[62:63], v[66:67] op_sel:[0,0,0] op_sel_hi:[0,1,1] neg_lo:[0,0,1]
    v_cvt_pk_f16_f32 v72, v54, v55
    ds_write_addtid_b32 v72 offset:33792
    v_pk_mul_f32 v[66:67], v[54:55], v[62:63] op_sel:[1,1] op_sel_hi:[1,0]
    v_pk_fma_f32 v[54:55], v[54:55], v[62:63], v[66:67] op_sel:[0,0,0] op_sel_hi:[0,1,1] neg_lo:[0,0,1]
    v_cvt_pk_f16_f32 v73, v54, v55
    ds_write_addtid_b32 v73 offset:34848
    v_pk_mul_f32 v[66:67], v[54:55], v[62:63] op_sel:[1,1] op_sel_hi:[1,0]
    v_pk_fma_f32 v[54:55], v[54:55], v[62:63], v[66:67] op_sel:[0,0,0] op_sel_hi:[0,1,1] neg_lo:[0,0,1]
    v_cvt_pk_f16_f32 v70, v54, v55
    ds_write_addtid_b32 v70 offset:35904
    v_pk_mul_f32 v[66:67], v[54:55], v[62:63] op_sel:[1,1] op_sel_hi:[1,0]
    v_pk_fma_f32 v[54:55], v[54:55], v[62:63], v[66:67] op_sel:[0,0,0] op_sel_hi:[0,1,1] neg_lo:[0,0,1]
    v_cvt_pk_f16_f32 v71, v54, v55
    ds_write_addtid_b32 v71 offset:36960
    v_pk_mul_f32 v[66:67], v[54:55], v[62:63] op_sel:[1,1] op_sel_hi:[1,0]
    v_pk_fma_f32 v[54:55], v[54:55], v[62:63], v[66:67] op_sel:[0,0,0] op_sel_hi:[0,1,1] neg_lo:[0,0,1]
    v_cvt_pk_f16_f32 v72, v54, v55
    ds_write_addtid_b32 v72 offset:38016
    v_pk_mul_f32 v[66:67], v[54:55], v[62:63] op_sel:[1,1] op_sel_hi:[1,0]
    v_pk_fma_f32 v[54:55], v[54:55], v[62:63], v[66:67] op_sel:[0,0,0] op_sel_hi:[0,1,1] neg_lo:[0,0,1]
    v_cvt_pk_f16_f32 v73, v54, v55
    ds_write_addtid_b32 v73 offset:39072
    v_pk_mul_f32 v[66:67], v[54:55], v[62:63] op_sel:[1,1] op_sel_hi:[1,0]
    v_pk_fma_f32 v[54:55], v[54:55], v[62:63], v[66:67] op_sel:[0,0,0] op_sel_hi:[0,1,1] neg_lo:[0,0,1]
    v_cvt_pk_f16_f32 v70, v54, v55
    ds_write_addtid_b32 v70 offset:40128
    v_pk_mul_f32 v[66:67], v[54:55], v[62:63] op_sel:[1,1] op_sel_hi:[1,0]
    v_pk_fma_f32 v[54:55], v[54:55], v[62:63], v[66:67] op_sel:[0,0,0] op_sel_hi:[0,1,1] neg_lo:[0,0,1]
    v_cvt_pk_f16_f32 v71, v54, v55
    ds_write_addtid_b32 v71 offset:41184
    v_pk_mul_f32 v[66:67], v[60:61], v[60:61] op_sel:[1,1] op_sel_hi:[1,0]
    v_pk_fma_f32 v[64:65], v[60:61], v[60:61], v[66:67] op_sel:[0,0,0] op_sel_hi:[0,1,1] neg_lo:[0,0,1]
    v_cvt_pk_f16_f32 v72, v64, v65
    ds_write_addtid_b32 v72 offset:45408
    v_pk_mul_f32 v[66:67], v[64:65], v[60:61] op_sel:[1,1] op_sel_hi:[1,0]
    v_pk_fma_f32 v[64:65], v[64:65], v[60:61], v[66:67] op_sel:[0,0,0] op_sel_hi:[0,1,1] neg_lo:[0,0,1]
    v_cvt_pk_f16_f32 v73, v64, v65
    ds_write_addtid_b32 v73 offset:46464
    v_pk_mul_f32 v[66:67], v[64:65], v[60:61] op_sel:[1,1] op_sel_hi:[1,0]
    v_pk_fma_f32 v[64:65], v[64:65], v[60:61], v[66:67] op_sel:[0,0,0] op_sel_hi:[0,1,1] neg_lo:[0,0,1]
    v_cvt_pk_f16_f32 v70, v64, v65
    ds_write_addtid_b32 v70 offset:47520
    v_pk_mul_f32 v[66:67], v[64:65], v[60:61] op_sel:[1,1] op_sel_hi:[1,0]
    v_pk_fma_f32 v[64:65], v[64:65], v[60:61], v[66:67] op_sel:[0,0,0] op_sel_hi:[0,1,1] neg_lo:[0,0,1]
    v_cvt_pk_f16_f32 v71, v64, v65
    ds_write_addtid_b32 v71 offset:48576
    v_pk_mul_f32 v[66:67], v[64:65], v[60:61] op_sel:[1,1] op_sel_hi:[1,0]
    v_pk_fma_f32 v[64:65], v[64:65], v[60:61], v[66:67] op_sel:[0,0,0] op_sel_hi:[0,1,1] neg_lo:[0,0,1]
    v_cvt_pk_f16_f32 v72, v64, v65
    ds_write_addtid_b32 v72 offset:49632
    v_pk_mul_f32 v[66:67], v[64:65], v[60:61] op_sel:[1,1] op_sel_hi:[1,0]
    v_pk_fma_f32 v[64:65], v[64:65], v[60:61], v[66:67] op_sel:[0,0,0] op_sel_hi:[0,1,1] neg_lo:[0,0,1]
    v_cvt_pk_f16_f32 v73, v64, v65
    ds_write_addtid_b32 v73 offset:50688
    v_pk_mul_f32 v[66:67], v[64:65], v[60:61] op_sel:[1,1] op_sel_hi:[1,0]
    v_pk_fma_f32 v[64:65], v[64:65], v[60:61], v[66:67] op_sel:[0,0,0] op_sel_hi:[0,1,1] neg_lo:[0,0,1]
    v_cvt_pk_f16_f32 v70, v64, v65
    ds_write_addtid_b32 v70 offset:51744
    v_pk_mul_f32 v[66:67], v[64:65], v[60:61] op_sel:[1,1] op_sel_hi:[1,0]
    v_pk_fma_f32 v[64:65], v[64:65], v[60:61], v[66:67] op_sel:[0,0,0] op_sel_hi:[0,1,1] neg_lo:[0,0,1]
    v_cvt_pk_f16_f32 v71, v64, v65
    ds_write_addtid_b32 v71 offset:52800
    v_pk_mul_f32 v[66:67], v[64:65], v[60:61] op_sel:[1,1] op_sel_hi:[1,0]
    v_pk_fma_f32 v[64:65], v[64:65], v[60:61], v[66:67] op_sel:[0,0,0] op_sel_hi:[0,1,1] neg_lo:[0,0,1]
    v_cvt_pk_f16_f32 v72, v64, v65
    ds_write_addtid_b32 v72 offset:53856
    v_pk_mul_f32 v[66:67], v[64:65], v[60:61] op_sel:[1,1] op_sel_hi:[1,0]
    v_pk_fma_f32 v[64:65], v[64:65], v[60:61], v[66:67] op_sel:[0,0,0] op_sel_hi:[0,1,1] neg_lo:[0,0,1]
    v_cvt_pk_f16_f32 v73, v64, v65
    ds_write_addtid_b32 v73 offset:54912
    v_pk_mul_f32 v[66:67], v[64:65], v[60:61] op_sel:[1,1] op_sel_hi:[1,0]
    v_pk_fma_f32 v[64:65], v[64:65], v[60:61], v[66:67] op_sel:[0,0,0] op_sel_hi:[0,1,1] neg_lo:[0,0,1]
    v_cvt_pk_f16_f32 v70, v64, v65
    ds_write_addtid_b32 v70 offset:55968
    v_pk_mul_f32 v[66:67], v[64:65], v[60:61] op_sel:[1,1] op_sel_hi:[1,0]
    v_pk_fma_f32 v[64:65], v[64:65], v[60:61], v[66:67] op_sel:[0,0,0] op_sel_hi:[0,1,1] neg_lo:[0,0,1]
    v_cvt_pk_f16_f32 v71, v64, v65
    ds_write_addtid_b32 v71 offset:57024
    v_pk_mul_f32 v[66:67], v[64:65], v[60:61] op_sel:[1,1] op_sel_hi:[1,0]
    v_pk_fma_f32 v[64:65], v[64:65], v[60:61], v[66:67] op_sel:[0,0,0] op_sel_hi:[0,1,1] neg_lo:[0,0,1]
    v_cvt_pk_f16_f32 v72, v64, v65
    ds_write_addtid_b32 v72 offset:58080
    v_pk_mul_f32 v[66:67], v[64:65], v[60:61] op_sel:[1,1] op_sel_hi:[1,0]
    v_pk_fma_f32 v[64:65], v[64:65], v[60:61], v[66:67] op_sel:[0,0,0] op_sel_hi:[0,1,1] neg_lo:[0,0,1]
    v_cvt_pk_f16_f32 v73, v64, v65
    ds_write_addtid_b32 v73 offset:59136
CK_SKIP:
    ds_write_b32 v129, v129
    s_mov_b32 s9, 0
CK_PAIR:
    ds_read_b32 v8, v130
    s_add_u32 s9, s9, 1
    s_waitcnt lgkmcnt(0)
    v_cmp_eq_u32 vcc, 0, v8
    s_cmp_ge_u32 s9, 0x40000
    s_cbranch_scc1 CK_PAIRED
    s_cbranch_vccnz CK_PAIR
CK_PAIRED:
    s_cmp_eq_u32 s12, 0
    s_cbranch_scc0 CK_T1
    ds_read_b128 v[8:11], v128 offset:43296
    ds_read_b128 v[40:43], v128 offset:0
    ds_read_b128 v[12:15], v128 offset:43360
    ds_read_b128 v[44:47], v128 offset:64
    ds_read_b128 v[16:19], v128 offset:43424
    ds_read_b128 v[48:51], v128 offset:128
    ds_read_b128 v[20:23], v128 offset:43488
    ds_read_b128 v[52:55], v128 offset:192
    s_lshl_b32 s9, s7, 2
    s_add_u32 s9, s9, 155664
    v_mov_b32 v112, s9
    v_mov_b32 v113, s8
    ds_read_b128 v[24:27], v128 offset:43552
    ds_read_b128 v[56:59], v128 offset:256
    ds_read_b128 v[28:31], v128 offset:43616
    ds_read_b128 v[60:63], v128 offset:320
    ds_read_b128 v[32:35], v128 offset:43680
    ds_read_b128 v[64:67], v128 offset:384
    ds_read_b128 v[36:39], v128 offset:43744
    ds_read_b128 v[68:71], v128 offset:448
    v_lshrrev_b32 v114, 1, v4
    v_lshlrev_b32 v114, 8, v114
    v_lshl_add_u32 v114, v3, 4, v114
    v_and_b32 v115, 1, v4
    v_lshl_add_u32 v114, v115, 3, v114
    v_add_u32 v114, s13, v114
    v_lshlrev_b32 v115, 5, v3
    v_lshl_add_u32 v115, v4, 3, v115
    v_add_u32 v115, s13, v115
    v_mov_b32 v116, s13
    s_waitcnt lgkmcnt(14)
    v_mfma_f32_16x16x32_f16 v[104:107], v[40:43], v[8:11], 0
    ds_read_b128 v[72:75], v128 offset:33792
    s_waitcnt lgkmcnt(13)
    v_mfma_f32_16x16x32_f16 v[104:107], v[44:47], v[12:15], v[104:107]
    ds_read_b128 v[76:79], v128 offset:33856
    s_waitcnt lgkmcnt(12)
    v_mfma_f32_16x16x32_f16 v[104:107], v[48:51], v[16:19], v[104:107]
    ds_read_b128 v[80:83], v128 offset:33920
    s_waitcnt lgkmcnt(11)
    v_mfma_f32_16x16x32_f16 v[104:107], v[52:55], v[20:23], v[104:107]
    ds_read_b128 v[84:87], v128 offset:33984
    s_waitcnt lgkmcnt(10)
    v_mfma_f32_16x16x32_f16 v[104:107], v[56:59], v[24:27], v[104:107]
    ds_read_b128 v[88:91], v128 offset:34048
    s_waitcnt lgkmcnt(9)
    v_mfma_f32_16x16x32_f16 v[104:107], v[60:63], v[28:31], v[104:107]
    ds_read_b128 v[92:95], v128 offset:34112
    s_waitcnt lgkmcnt(8)
    v_mfma_f32_16x16x32_f16 v[104:107], v[64:67], v[32:35], v[104:107]
    ds_read_b128 v[96:99], v128 offset:34176
    s_waitcnt lgkmcnt(7)
    v_mfma_f32_16x16x32_f16 v[104:107], v[68:71], v[36:39], v[104:107]
    ds_read_b128 v[100:103], v128 offset:34240
    s_waitcnt lgkmcnt(7)
    v_mfma_f32_16x16x32_f16 v[108:111], v[8:11], v[72:75], 0
    s_waitcnt lgkmcnt(6)
    v_mfma_f32_16x16x32_f16 v[108:111], v[12:15], v[76:79], v[108:111]
    s_waitcnt lgkmcnt(5)
    v_mfma_f32_16x16x32_f16 v[108:111], v[16:19], v[80:83], v[108:111]
    s_waitcnt lgkmcnt(4)
    v_mfma_f32_16x16x32_f16 v[108:111], v[20:23], v[84:87], v[108:111]
    s_waitcnt lgkmcnt(3)
    v_mfma_f32_16x16x32_f16 v[108:111], v[24:27], v[88:91], v[108:111]
    s_waitcnt lgkmcnt(2)
    v_mfma_f32_16x16x32_f16 v[108:111], v[28:31], v[92:95], v[108:111]
    s_waitcnt lgkmcnt(1)
    v_mfma_f32_16x16x32_f16 v[108:111], v[32:35], v[96:99], v[108:111]
    s_waitcnt lgkmcnt(0)
    v_mfma_f32_16x16x32_f16 v[108:111], v[36:39], v[100:103], v[108:111]
    ds_write_b32 v112, v113
    v_cvt_pk_f16_f32 v118, v104, v105
    v_cvt_pk_f16_f32 v119, v106, v107
    v_cvt_pk_f16_f32 v120, v105, v106
    v_cvt_pk_f16_f32 v121, v107, v107
    ds_write_b16 v114, v121 offset:1256
    ds_write_b64 v114, v[120:121] offset:32
    ds_write_b64 v114, v[118:119] offset:1248
    ds_write_b16 v114, v118 offset:30
    v_cvt_pk_f16_f32 v118, v108, v109
    v_cvt_pk_f16_f32 v119, v110, v111
    s_mov_b32 s10, 0x00ff00ff
    s_mov_b32 s11, 0x00ff00ff
    s_mov_b64 exec, s[10:11]
    ds_write_b64 v115, v[118:119] offset:2912
    s_mov_b64 exec, 0x100
    ds_write_b16 v116, v118 offset:28
    ds_write_b16 v116, v118 offset:1246
    s_mov_b64 exec, -1
    v_mov_b32 v127, 155648
    v_mov_b32 v126, 1
    s_mov_b64 exec, 1
    ds_add_u32 v127, v126 offset:76
    s_mov_b64 exec, -1
    v_mul_u32_u24 v124, 320, v4
    v_lshl_add_u32 v124, v3, 4, v124
    s_mul_i32 s8, s7, 20480
    v_add_u32 v124, s8, v124
    s_lshl_b32 s8, s3, 2
    s_add_u32 s8, s8, 155904
    v_mov_b32 v125, s8
    v_and_b32 v5, 1, v3
    v_mul_u32_u24 v5, 1216, v5
    v_sub_u32 v5, 1264, v5
    v_lshrrev_b32 v6, 1, v3
    v_lshl_add_u32 v5, v6, 2, v5
    v_lshlrev_b32 v6, 4, v4
    v_sub_u32 v5, v5, v6
    v_add_u32 v5, s13, v5
    v_add_u32 v7, 576, v5
    v_lshl_add_u32 v6, v3, 5, v6
    v_add_u32 v6, 3616, v6
    v_add_u32 v6, s13, v6
    s_mov_b32 s9, 0
SPN1:
    ds_read_b32 v128, v127 offset:76
    s_add_u32 s9, s9, 1
    s_waitcnt lgkmcnt(0)
    v_cmp_ne_u32 vcc, 8, v128
    s_cmp_ge_u32 s9, 0x40000
    s_cbranch_scc1 SPX1
    s_cbranch_vccz SPX1
    s_sleep 1
    s_branch SPN1
SPX1:
    ds_read2_b32 v[36:37], v5 offset0:115 offset1:114
    ds_read2_b32 v[38:39], v5 offset0:113 offset1:112
    ds_read2_b32 v[32:33], v5 offset0:99 offset1:98
    ds_read2_b32 v[34:35], v5 offset0:97 offset1:96
    ds_read2_b32 v[28:29], v5 offset0:83 offset1:82
    ds_read2_b32 v[30:31], v5 offset0:81 offset1:80
    ds_read2_b32 v[24:25], v5 offset0:67 offset1:66
    ds_read2_b32 v[26:27], v5 offset0:65 offset1:64
    ds_read2_b32 v[20:21], v5 offset0:51 offset1:50
    ds_read2_b32 v[22:23], v5 offset0:49 offset1:48
    ds_read2_b32 v[16:17], v5 offset0:35 offset1:34
    ds_read2_b32 v[18:19], v5 offset0:33 offset1:32
    ds_read2_b32 v[12:13], v5 offset0:19 offset1:18
    ds_read2_b32 v[14:15], v5 offset0:17 offset1:16
    ds_read2_b32 v[8:9], v5 offset0:3 offset1:2
    ds_read2_b32 v[10:11], v5 offset0:1 offset1:0
    ds_read2_b32 v[68:69], v7 offset0:99 offset1:98
    ds_read2_b32 v[70:71], v7 offset0:97 offset1:96
    ds_read2_b32 v[64:65], v7 offset0:83 offset1:82
    ds_read2_b32 v[66:67], v7 offset0:81 offset1:80
    ds_read2_b32 v[60:61], v7 offset0:67 offset1:66
    ds_read2_b32 v[62:63], v7 offset0:65 offset1:64
    ds_read2_b32 v[56:57], v7 offset0:51 offset1:50
    ds_read2_b32 v[58:59], v7 offset0:49 offset1:48
    ds_read2_b32 v[52:53], v7 offset0:35 offset1:34
    ds_read2_b32 v[54:55], v7 offset0:33 offset1:32
    ds_read2_b32 v[48:49], v7 offset0:19 offset1:18
    ds_read2_b32 v[50:51], v7 offset0:17 offset1:16
    ds_read2_b32 v[44:45], v7 offset0:3 offset1:2
    ds_read2_b32 v[46:47], v7 offset0:1 offset1:0
    ds_read2_b32 v[40:41], v5 offset0:131 offset1:130
    ds_read2_b32 v[42:43], v5 offset0:129 offset1:128
    ds_read2_b32 v[72:73], v7 offset0:115 offset1:114
    ds_read2_b32 v[74:75], v7 offset0:113 offset1:112
    s_mov_b32 s9, 0
SPN2:
    ds_read_b32 v128, v127 offset:72
    s_add_u32 s9, s9, 1
    s_waitcnt lgkmcnt(0)
    v_cmp_gt_u32 vcc, 2, v128
    s_cmp_ge_u32 s9, 0x40000
    s_cbranch_scc1 SPX2
    s_cbranch_vccz SPX2
    s_sleep 1
    s_branch SPN2
SPX2:
D_LOOP:
    ds_read_b128 v[80:83], v6 offset:0
    ds_read_b128 v[84:87], v6 offset:64
    ds_read_b128 v[88:91], v6 offset:128
    ds_read_b128 v[92:95], v6 offset:192
    ds_read_b128 v[96:99], v6 offset:256
    ds_read_b128 v[100:103], v6 offset:320
    ds_read_b128 v[104:107], v6 offset:384
    s_waitcnt lgkmcnt(6)
    v_mfma_f32_16x16x32_f16 v[108:111], v[36:39], v[80:83], 0
    v_mfma_f32_16x16x32_f16 v[112:115], v[68:71], v[80:83], 0
    ds_read_b128 v[76:79], v6 offset:448
    s_waitcnt lgkmcnt(6)
    v_mfma_f32_16x16x32_f16 v[108:111], v[32:35], v[84:87], v[108:111]
    v_mfma_f32_16x16x32_f16 v[112:115], v[64:67], v[84:87], v[112:115]
    ds_read_b128 v[80:83], v6 offset:512
    s_waitcnt lgkmcnt(6)
    v_mfma_f32_16x16x32_f16 v[108:111], v[28:31], v[88:91], v[108:111]
    v_mfma_f32_16x16x32_f16 v[112:115], v[60:63], v[88:91], v[112:115]
    ds_read_b128 v[84:87], v6 offset:576
    s_waitcnt lgkmcnt(6)
    v_mfma_f32_16x16x32_f16 v[108:111], v[24:27], v[92:95], v[108:111]
    v_mfma_f32_16x16x32_f16 v[112:115], v[56:59], v[92:95], v[112:115]
    ds_read_b128 v[88:91], v6 offset:640
    s_waitcnt lgkmcnt(6)
    v_mfma_f32_16x16x32_f16 v[108:111], v[20:23], v[96:99], v[108:111]
    v_mfma_f32_16x16x32_f16 v[112:115], v[52:55], v[96:99], v[112:115]
    ds_read_b128 v[92:95], v6 offset:704
    s_waitcnt lgkmcnt(6)
    v_mfma_f32_16x16x32_f16 v[108:111], v[16:19], v[100:103], v[108:111]
    v_mfma_f32_16x16x32_f16 v[112:115], v[48:51], v[100:103], v[112:115]
    ds_read_b128 v[96:99], v6 offset:768
    s_waitcnt lgkmcnt(6)
    v_mfma_f32_16x16x32_f16 v[108:111], v[12:15], v[104:107], v[108:111]
    v_mfma_f32_16x16x32_f16 v[112:115], v[44:47], v[104:107], v[112:115]
    ds_read_b128 v[100:103], v6 offset:832
    s_waitcnt lgkmcnt(6)
    v_mfma_f32_16x16x32_f16 v[108:111], v[8:11], v[76:79], v[108:111]
    v_mfma_f32_16x16x32_f16 v[112:115], v[40:43], v[76:79], v[112:115]
    v_mfma_f32_16x16x32_f16 v[116:119], v[72:75], v[76:79], 0
    ds_read_b128 v[104:107], v6 offset:896
    s_waitcnt lgkmcnt(6)
    v_mfma_f32_16x16x32_f16 v[112:115], v[36:39], v[80:83], v[112:115]
    v_mfma_f32_16x16x32_f16 v[116:119], v[68:71], v[80:83], v[116:119]
    ds_read_b128 v[76:79], v6 offset:960
    s_waitcnt lgkmcnt(6)
    v_mfma_f32_16x16x32_f16 v[112:115], v[32:35], v[84:87], v[112:115]
    v_mfma_f32_16x16x32_f16 v[116:119], v[64:67], v[84:87], v[116:119]
    ds_read_b128 v[80:83], v6 offset:1024
    s_waitcnt lgkmcnt(6)
    v_mfma_f32_16x16x32_f16 v[112:115], v[28:31], v[88:91], v[112:115]
    ds_write_b64 v124, v[108:109] offset:0
    v_mfma_f32_16x16x32_f16 v[116:119], v[60:63], v[88:91], v[116:119]
    ds_read_b128 v[84:87], v6 offset:1088
    s_waitcnt lgkmcnt(7)
    v_mfma_f32_16x16x32_f16 v[112:115], v[24:27], v[92:95], v[112:115]
    ds_write_b64 v124, v[110:111] offset:8
    v_mfma_f32_16x16x32_f16 v[116:119], v[56:59], v[92:95], v[116:119]
    ds_read_b128 v[88:91], v6 offset:1152
    s_waitcnt lgkmcnt(8)
    v_mfma_f32_16x16x32_f16 v[112:115], v[20:23], v[96:99], v[112:115]
    ds_write_b32 v125, v126 offset:0
    v_mfma_f32_16x16x32_f16 v[116:119], v[52:55], v[96:99], v[116:119]
    ds_read_b128 v[92:95], v6 offset:1216
    s_waitcnt lgkmcnt(9)
    v_mfma_f32_16x16x32_f16 v[112:115], v[16:19], v[100:103], v[112:115]
    v_mfma_f32_16x16x32_f16 v[116:119], v[48:51], v[100:103], v[116:119]
    ds_read_b128 v[96:99], v6 offset:1280
    s_waitcnt lgkmcnt(9)
    v_mfma_f32_16x16x32_f16 v[112:115], v[12:15], v[104:107], v[112:115]
    v_mfma_f32_16x16x32_f16 v[116:119], v[44:47], v[104:107], v[116:119]
    ds_read_b128 v[100:103], v6 offset:1344
    s_waitcnt lgkmcnt(9)
    v_mfma_f32_16x16x32_f16 v[112:115], v[8:11], v[76:79], v[112:115]
    v_mfma_f32_16x16x32_f16 v[116:119], v[40:43], v[76:79], v[116:119]
    v_mfma_f32_16x16x32_f16 v[120:123], v[72:75], v[76:79], 0
    ds_read_b128 v[104:107], v6 offset:1408
    s_waitcnt lgkmcnt(9)
    v_mfma_f32_16x16x32_f16 v[116:119], v[36:39], v[80:83], v[116:119]
    v_mfma_f32_16x16x32_f16 v[120:123], v[68:71], v[80:83], v[120:123]
    ds_read_b128 v[76:79], v6 offset:1472
    s_waitcnt lgkmcnt(8)
    v_mfma_f32_16x16x32_f16 v[116:119], v[32:35], v[84:87], v[116:119]
    v_mfma_f32_16x16x32_f16 v[120:123], v[64:67], v[84:87], v[120:123]
    ds_read_b128 v[80:83], v6 offset:1536
    s_waitcnt lgkmcnt(7)
    v_mfma_f32_16x16x32_f16 v[116:119], v[28:31], v[88:91], v[116:119]
    ds_write_b64 v124, v[112:113] offset:1280
    v_mfma_f32_16x16x32_f16 v[120:123], v[60:63], v[88:91], v[120:123]
    ds_read_b128 v[84:87], v6 offset:1600
    s_waitcnt lgkmcnt(7)
    v_mfma_f32_16x16x32_f16 v[116:119], v[24:27], v[92:95], v[116:119]
    ds_write_b64 v124, v[114:115] offset:1288
    v_mfma_f32_16x16x32_f16 v[120:123], v[56:59], v[92:95], v[120:123]
    ds_read_b128 v[88:91], v6 offset:1664
    s_waitcnt lgkmcnt(8)
    v_mfma_f32_16x16x32_f16 v[116:119], v[20:23], v[96:99], v[116:119]
    ds_write_b32 v125, v126 offset:32
    v_mfma_f32_16x16x32_f16 v[120:123], v[52:55], v[96:99], v[120:123]
    ds_read_b128 v[92:95], v6 offset:1728
    s_waitcnt lgkmcnt(9)
    v_mfma_f32_16x16x32_f16 v[116:119], v[16:19], v[100:103], v[116:119]
    v_mfma_f32_16x16x32_f16 v[120:123], v[48:51], v[100:103], v[120:123]
    ds_read_b128 v[96:99], v6 offset:1792
    s_waitcnt lgkmcnt(9)
    v_mfma_f32_16x16x32_f16 v[116:119], v[12:15], v[104:107], v[116:119]
    v_mfma_f32_16x16x32_f16 v[120:123], v[44:47], v[104:107], v[120:123]
    ds_read_b128 v[100:103], v6 offset:1856
    s_waitcnt lgkmcnt(9)
    v_mfma_f32_16x16x32_f16 v[116:119], v[8:11], v[76:79], v[116:119]
    v_mfma_f32_16x16x32_f16 v[120:123], v[40:43], v[76:79], v[120:123]
    v_mfma_f32_16x16x32_f16 v[108:111], v[72:75], v[76:79], 0
    ds_read_b128 v[104:107], v6 offset:1920
    s_waitcnt lgkmcnt(9)
    v_mfma_f32_16x16x32_f16 v[120:123], v[36:39], v[80:83], v[120:123]
    v_mfma_f32_16x16x32_f16 v[108:111], v[68:71], v[80:83], v[108:111]
    ds_read_b128 v[76:79], v6 offset:1984
    s_waitcnt lgkmcnt(8)
    v_mfma_f32_16x16x32_f16 v[120:123], v[32:35], v[84:87], v[120:123]
    v_mfma_f32_16x16x32_f16 v[108:111], v[64:67], v[84:87], v[108:111]
    s_waitcnt lgkmcnt(6)
    v_mfma_f32_16x16x32_f16 v[120:123], v[28:31], v[88:91], v[120:123]
    ds_write_b64 v124, v[116:117] offset:2560
    v_mfma_f32_16x16x32_f16 v[108:111], v[60:63], v[88:91], v[108:111]
    s_waitcnt lgkmcnt(5)
    v_mfma_f32_16x16x32_f16 v[120:123], v[24:27], v[92:95], v[120:123]
    ds_write_b64 v124, v[118:119] offset:2568
    v_mfma_f32_16x16x32_f16 v[108:111], v[56:59], v[92:95], v[108:111]
    s_waitcnt lgkmcnt(5)
    v_mfma_f32_16x16x32_f16 v[120:123], v[20:23], v[96:99], v[120:123]
    ds_write_b32 v125, v126 offset:64
    v_mfma_f32_16x16x32_f16 v[108:111], v[52:55], v[96:99], v[108:111]
    s_waitcnt lgkmcnt(5)
    v_mfma_f32_16x16x32_f16 v[120:123], v[16:19], v[100:103], v[120:123]
    v_mfma_f32_16x16x32_f16 v[108:111], v[48:51], v[100:103], v[108:111]
    s_waitcnt lgkmcnt(4)
    v_mfma_f32_16x16x32_f16 v[120:123], v[12:15], v[104:107], v[120:123]
    v_mfma_f32_16x16x32_f16 v[108:111], v[44:47], v[104:107], v[108:111]
    s_waitcnt lgkmcnt(3)
    v_mfma_f32_16x16x32_f16 v[120:123], v[8:11], v[76:79], v[120:123]
    v_mfma_f32_16x16x32_f16 v[108:111], v[40:43], v[76:79], v[108:111]
    v_mfma_f32_16x16x32_f16 v[112:115], v[72:75], v[76:79], 0
    s_nop 7
    ds_write_b64 v124, v[120:121] offset:3840
    ds_write_b64 v124, v[122:123] offset:3848
    ds_write_b32 v125, v126 offset:96
    s_mov_b32 s9, 0
SPN3:
    ds_read_b32 v128, v127 offset:72
    s_add_u32 s9, s9, 1
    s_waitcnt lgkmcnt(0)
    v_cmp_ne_u32 vcc, 4, v128
    s_cmp_ge_u32 s9, 0x40000
    s_cbranch_scc1 SPX3
    s_cbranch_vccz SPX3
    s_sleep 1
    s_branch SPN3
SPX3:
    s_lshl_b32 s8, s7, 2
    v_add_u32 v128, s8, v127
    ds_read_b32 v128, v128 offset:96
    ds_read_b128 v[80:83], v6 offset:2560
    ds_read_b128 v[84:87], v6 offset:2624
    ds_read_b128 v[88:91], v6 offset:2688
    ds_read_b128 v[92:95], v6 offset:2752
    ds_read_b128 v[96:99], v6 offset:2816
    ds_read_b128 v[100:103], v6 offset:2880
    ds_read_b128 v[104:107], v6 offset:2944
    s_waitcnt lgkmcnt(7)
    v_mul_f32 v108, v108, v128
    v_mul_f32 v109, v109, v128
    v_mul_f32 v110, v110, v128
    v_mul_f32 v111, v111, v128
    v_mul_f32 v112, v112, v128
    v_mul_f32 v113, v113, v128
    v_mul_f32 v114, v114, v128
    v_mul_f32 v115, v115, v128
    s_waitcnt lgkmcnt(6)
    v_mfma_f32_16x16x32_f16 v[108:111], v[36:39], v[80:83], v[108:111]
    v_mfma_f32_16x16x32_f16 v[112:115], v[68:71], v[80:83], v[112:115]
    ds_read_b128 v[76:79], v6 offset:3008
    s_waitcnt lgkmcnt(6)
    v_mfma_f32_16x16x32_f16 v[108:111], v[32:35], v[84:87], v[108:111]
    v_mfma_f32_16x16x32_f16 v[112:115], v[64:67], v[84:87], v[112:115]
    ds_read_b128 v[80:83], v6 offset:3072
    s_waitcnt lgkmcnt(6)
    v_mfma_f32_16x16x32_f16 v[108:111], v[28:31], v[88:91], v[108:111]
    v_mfma_f32_16x16x32_f16 v[112:115], v[60:63], v[88:91], v[112:115]
    ds_read_b128 v[84:87], v6 offset:3136
    s_waitcnt lgkmcnt(6)
    v_mfma_f32_16x16x32_f16 v[108:111], v[24:27], v[92:95], v[108:111]
    v_mfma_f32_16x16x32_f16 v[112:115], v[56:59], v[92:95], v[112:115]
    ds_read_b128 v[88:91], v6 offset:3200
    s_waitcnt lgkmcnt(6)
    v_mfma_f32_16x16x32_f16 v[108:111], v[20:23], v[96:99], v[108:111]
    v_mfma_f32_16x16x32_f16 v[112:115], v[52:55], v[96:99], v[112:115]
    ds_read_b128 v[92:95], v6 offset:3264
    s_waitcnt lgkmcnt(6)
    v_mfma_f32_16x16x32_f16 v[108:111], v[16:19], v[100:103], v[108:111]
    v_mfma_f32_16x16x32_f16 v[112:115], v[48:51], v[100:103], v[112:115]
    ds_read_b128 v[96:99], v6 offset:3328
    s_waitcnt lgkmcnt(6)
    v_mfma_f32_16x16x32_f16 v[108:111], v[12:15], v[104:107], v[108:111]
    v_mfma_f32_16x16x32_f16 v[112:115], v[44:47], v[104:107], v[112:115]
    ds_read_b128 v[100:103], v6 offset:3392
    s_waitcnt lgkmcnt(6)
    v_mfma_f32_16x16x32_f16 v[108:111], v[8:11], v[76:79], v[108:111]
    v_mfma_f32_16x16x32_f16 v[112:115], v[40:43], v[76:79], v[112:115]
    v_mfma_f32_16x16x32_f16 v[116:119], v[72:75], v[76:79], 0
    ds_read_b128 v[104:107], v6 offset:3456
    s_waitcnt lgkmcnt(6)
    v_mfma_f32_16x16x32_f16 v[112:115], v[36:39], v[80:83], v[112:115]
    v_mfma_f32_16x16x32_f16 v[116:119], v[68:71], v[80:83], v[116:119]
    ds_read_b128 v[76:79], v6 offset:3520
    s_waitcnt lgkmcnt(6)
    v_mfma_f32_16x16x32_f16 v[112:115], v[32:35], v[84:87], v[112:115]
    v_mfma_f32_16x16x32_f16 v[116:119], v[64:67], v[84:87], v[116:119]
    ds_read_b128 v[80:83], v6 offset:3584
    s_waitcnt lgkmcnt(6)
    v_mfma_f32_16x16x32_f16 v[112:115], v[28:31], v[88:91], v[112:115]
    ds_write_b64 v124, v[108:109] offset:5120
    v_mfma_f32_16x16x32_f16 v[116:119], v[60:63], v[88:91], v[116:119]
    ds_read_b128 v[84:87], v6 offset:3648
    s_waitcnt lgkmcnt(7)
    v_mfma_f32_16x16x32_f16 v[112:115], v[24:27], v[92:95], v[112:115]
    ds_write_b64 v124, v[110:111] offset:5128
    v_mfma_f32_16x16x32_f16 v[116:119], v[56:59], v[92:95], v[116:119]
    ds_read_b128 v[88:91], v6 offset:3712
    s_waitcnt lgkmcnt(8)
    v_mfma_f32_16x16x32_f16 v[112:115], v[20:23], v[96:99], v[112:115]
    ds_write_b32 v125, v126 offset:128
    v_mfma_f32_16x16x32_f16 v[116:119], v[52:55], v[96:99], v[116:119]
    ds_read_b128 v[92:95], v6 offset:3776
    s_waitcnt lgkmcnt(9)
    v_mfma_f32_16x16x32_f16 v[112:115], v[16:19], v[100:103], v[112:115]
    v_mfma_f32_16x16x32_f16 v[116:119], v[48:51], v[100:103], v[116:119]
    ds_read_b128 v[96:99], v6 offset:3840
    s_waitcnt lgkmcnt(9)
    v_mfma_f32_16x16x32_f16 v[112:115], v[12:15], v[104:107], v[112:115]
    v_mfma_f32_16x16x32_f16 v[116:119], v[44:47], v[104:107], v[116:119]
    ds_read_b128 v[100:103], v6 offset:3904
    s_waitcnt lgkmcnt(9)
    v_mfma_f32_16x16x32_f16 v[112:115], v[8:11], v[76:79], v[112:115]
    v_mfma_f32_16x16x32_f16 v[116:119], v[40:43], v[76:79], v[116:119]
    v_mfma_f32_16x16x32_f16 v[120:123], v[72:75], v[76:79], 0
    ds_read_b128 v[104:107], v6 offset:3968
    s_waitcnt lgkmcnt(9)
    v_mfma_f32_16x16x32_f16 v[116:119], v[36:39], v[80:83], v[116:119]
    v_mfma_f32_16x16x32_f16 v[120:123], v[68:71], v[80:83], v[120:123]
    ds_read_b128 v[76:79], v6 offset:4032
    s_waitcnt lgkmcnt(8)
    v_mfma_f32_16x16x32_f16 v[116:119], v[32:35], v[84:87], v[116:119]
    v_mfma_f32_16x16x32_f16 v[120:123], v[64:67], v[84:87], v[120:123]
    ds_read_b128 v[80:83], v6 offset:4096
    s_waitcnt lgkmcnt(7)
    v_mfma_f32_16x16x32_f16 v[116:119], v[28:31], v[88:91], v[116:119]
    ds_write_b64 v124, v[112:113] offset:6400
    v_mfma_f32_16x16x32_f16 v[120:123], v[60:63], v[88:91], v[120:123]
    ds_read_b128 v[84:87], v6 offset:4160
    s_waitcnt lgkmcnt(7)
    v_mfma_f32_16x16x32_f16 v[116:119], v[24:27], v[92:95], v[116:119]
    ds_write_b64 v124, v[114:115] offset:6408
    v_mfma_f32_16x16x32_f16 v[120:123], v[56:59], v[92:95], v[120:123]
    ds_read_b128 v[88:91], v6 offset:4224
    s_waitcnt lgkmcnt(8)
    v_mfma_f32_16x16x32_f16 v[116:119], v[20:23], v[96:99], v[116:119]
    ds_write_b32 v125, v126 offset:160
    v_mfma_f32_16x16x32_f16 v[120:123], v[52:55], v[96:99], v[120:123]
    ds_read_b128 v[92:95], v6 offset:4288
    s_waitcnt lgkmcnt(9)
    v_mfma_f32_16x16x32_f16 v[116:119], v[16:19], v[100:103], v[116:119]
    v_mfma_f32_16x16x32_f16 v[120:123], v[48:51], v[100:103], v[120:123]
    ds_read_b128 v[96:99], v6 offset:4352
    s_waitcnt lgkmcnt(9)
    v_mfma_f32_16x16x32_f16 v[116:119], v[12:15], v[104:107], v[116:119]
    v_mfma_f32_16x16x32_f16 v[120:123], v[44:47], v[104:107], v[120:123]
    ds_read_b128 v[100:103], v6 offset:4416
    s_waitcnt lgkmcnt(9)
    v_mfma_f32_16x16x32_f16 v[116:119], v[8:11], v[76:79], v[116:119]
    v_mfma_f32_16x16x32_f16 v[120:123], v[40:43], v[76:79], v[120:123]
    ds_read_b128 v[104:107], v6 offset:4480
    s_waitcnt lgkmcnt(9)
    v_mfma_f32_16x16x32_f16 v[120:123], v[36:39], v[80:83], v[120:123]
    ds_read_b128 v[76:79], v6 offset:4544
    s_waitcnt lgkmcnt(8)
    v_mfma_f32_16x16x32_f16 v[120:123], v[32:35], v[84:87], v[120:123]
    s_waitcnt lgkmcnt(6)
    v_mfma_f32_16x16x32_f16 v[120:123], v[28:31], v[88:91], v[120:123]
    s_waitcnt lgkmcnt(4)
    v_mfma_f32_16x16x32_f16 v[120:123], v[24:27], v[92:95], v[120:123]
    s_waitcnt lgkmcnt(3)
    v_mfma_f32_16x16x32_f16 v[120:123], v[20:23], v[96:99], v[120:123]
    ds_write_b64 v124, v[116:117] offset:7680
    s_waitcnt lgkmcnt(3)
    v_mfma_f32_16x16x32_f16 v[120:123], v[16:19], v[100:103], v[120:123]
    ds_write_b64 v124, v[118:119] offset:7688
    s_waitcnt lgkmcnt(3)
    v_mfma_f32_16x16x32_f16 v[120:123], v[12:15], v[104:107], v[120:123]
    ds_write_b32 v125, v126 offset:192
    s_waitcnt lgkmcnt(3)
    v_mfma_f32_16x16x32_f16 v[120:123], v[8:11], v[76:79], v[120:123]
    s_nop 7
    ds_write_b64 v124, v[120:121] offset:8960
    ds_write_b64 v124, v[122:123] offset:8968
    ds_write_b32 v125, v126 offset:224
    s_waitcnt lgkmcnt(0)
    s_endpgm
CK_T1:
    ds_read_b128 v[8:11], v128 offset:43296
    ds_read_b128 v[40:43], v128 offset:16896
    ds_read_b128 v[12:15], v128 offset:43360
    ds_read_b128 v[44:47], v128 offset:16960
    ds_read_b128 v[16:19], v128 offset:43424
    ds_read_b128 v[48:51], v128 offset:17024
    ds_read_b128 v[20:23], v128 offset:43488
    ds_read_b128 v[52:55], v128 offset:17088
    ds_read_b128 v[24:27], v128 offset:43552
    ds_read_b128 v[56:59], v128 offset:17152
    ds_read_b128 v[28:31], v128 offset:43616
    ds_read_b128 v[60:63], v128 offset:17216
    ds_read_b128 v[32:35], v128 offset:43680
    ds_read_b128 v[64:67], v128 offset:17280
    ds_read_b128 v[36:39], v128 offset:43744
    ds_read_b128 v[68:71], v128 offset:17344
    v_lshlrev_b32 v114, 8, v4
    v_lshl_add_u32 v114, v3, 4, v114
    v_add_u32 v114, s13, v114
    v_lshlrev_b32 v115, 7, v4
    v_lshl_add_u32 v115, v3, 2, v115
    v_add_u32 v115, s13, v115
    s_waitcnt lgkmcnt(14)
    v_mfma_f32_16x16x32_f16 v[104:107], v[40:43], v[8:11], 0
    s_waitcnt lgkmcnt(12)
    v_mfma_f32_16x16x32_f16 v[104:107], v[44:47], v[12:15], v[104:107]
    s_waitcnt lgkmcnt(10)
    v_mfma_f32_16x16x32_f16 v[104:107], v[48:51], v[16:19], v[104:107]
    s_waitcnt lgkmcnt(8)
    v_mfma_f32_16x16x32_f16 v[104:107], v[52:55], v[20:23], v[104:107]
    s_waitcnt lgkmcnt(6)
    v_mfma_f32_16x16x32_f16 v[104:107], v[56:59], v[24:27], v[104:107]
    s_waitcnt lgkmcnt(4)
    v_mfma_f32_16x16x32_f16 v[104:107], v[60:63], v[28:31], v[104:107]
    s_waitcnt lgkmcnt(2)
    v_mfma_f32_16x16x32_f16 v[104:107], v[64:67], v[32:35], v[104:107]
    s_waitcnt lgkmcnt(0)
    v_mfma_f32_16x16x32_f16 v[104:107], v[68:71], v[36:39], v[104:107]
    s_nop 7
    v_cvt_pk_f16_f32 v116, v104, v105
    v_cvt_pk_f16_f32 v117, v105, v105
    v_cvt_pk_f16_f32 v118, v106, v107
    v_cvt_pk_f16_f32 v119, v107, v107
    v_cvt_pk_f16_f32 v120, v105, v106
    s_mov_b32 exec_hi, 0
    ds_write_b16 v114, v119 offset:560
    v_add_u32 v121, 1728, v114
    ds_write_b128 v114, v[116:119] offset:544
    ds_write2_b32 v121, v119, v119 offset0:11 offset1:12
    ds_write2_b32 v121, v117, v120 offset0:9 offset1:10
    ds_write_b16 v121, v116 offset:34
    s_not_b64 exec, exec
    ds_write_b32 v115, v116 offset:2208
    ds_write_b32 v115, v118 offset:2272
    s_mov_b64 exec, -1
    v_mov_b32 v167, 155648
    v_mov_b32 v166, 1
    s_mov_b64 exec, 1
    ds_add_u32 v167, v166 offset:76
    s_mov_b64 exec, -1
    v_mul_u32_u24 v164, 320, v4
    v_lshl_add_u32 v164, v3, 4, v164
    s_mul_i32 s8, s7, 20480
    v_add_u32 v164, s8, v164
    s_lshl_b32 s8, s3, 2
    s_add_u32 s8, s8, 155904
    v_mov_b32 v165, s8
    v_lshlrev_b32 v74, 3, v4
    v_sub_u32 v74, v74, v3
    v_and_b32 v74, 0xffff, v74
    v_lshl_or_b32 v74, v74, 16, v74
    v_mov_b32 v75, 0x3c003c00
    s_mov_b32 s8, 0xfff0fff1
    v_pk_add_u16 v76, v74, s8
    s_mov_b32 s8, 0xfff2fff3
    v_pk_add_u16 v77, v74, s8
    s_mov_b32 s8, 0xfff4fff5
    v_pk_add_u16 v78, v74, s8
    s_mov_b32 s8, 0xfff6fff7
    v_pk_add_u16 v79, v74, s8
    v_pk_add_u16 v80, v76, 2 op_sel_hi:[1,0]
    v_pk_ashrrev_i16 v80, 15, v80 op_sel_hi:[0,1]
    v_pk_add_u16 v81, v77, 2 op_sel_hi:[1,0]
    v_pk_ashrrev_i16 v81, 15, v81 op_sel_hi:[0,1]
    v_pk_add_u16 v82, v78, 2 op_sel_hi:[1,0]
    v_pk_ashrrev_i16 v82, 15, v82 op_sel_hi:[0,1]
    v_pk_add_u16 v83, v79, 2 op_sel_hi:[1,0]
    v_pk_ashrrev_i16 v83, 15, v83 op_sel_hi:[0,1]
    v_pk_add_u16 v84, v76, 3 op_sel_hi:[1,0]
    v_pk_ashrrev_i16 v84, 15, v84 op_sel_hi:[0,1]
    v_pk_add_u16 v85, v77, 3 op_sel_hi:[1,0]
    v_pk_ashrrev_i16 v85, 15, v85 op_sel_hi:[0,1]
    v_pk_add_u16 v86, v78, 3 op_sel_hi:[1,0]
    v_pk_ashrrev_i16 v86, 15, v86 op_sel_hi:[0,1]
    v_pk_add_u16 v87, v79, 3 op_sel_hi:[1,0]
    v_pk_ashrrev_i16 v87, 15, v87 op_sel_hi:[0,1]
    v_pk_add_u16 v88, v76, 4 op_sel_hi:[1,0]
    v_pk_ashrrev_i16 v88, 15, v88 op_sel_hi:[0,1]
    v_pk_add_u16 v89, v77, 4 op_sel_hi:[1,0]
    v_pk_ashrrev_i16 v89, 15, v89 op_sel_hi:[0,1]
    v_pk_add_u16 v90, v78, 4 op_sel_hi:[1,0]
    v_pk_ashrrev_i16 v90, 15, v90 op_sel_hi:[0,1]
    v_pk_add_u16 v91, v79, 4 op_sel_hi:[1,0]
    v_pk_ashrrev_i16 v91, 15, v91 op_sel_hi:[0,1]
    v_pk_add_u16 v92, v76, 5 op_sel_hi:[1,0]
    v_pk_ashrrev_i16 v92, 15, v92 op_sel_hi:[0,1]
    v_pk_add_u16 v93, v77, 5 op_sel_hi:[1,0]
    v_pk_ashrrev_i16 v93, 15, v93 op_sel_hi:[0,1]
    v_pk_add_u16 v94, v78, 5 op_sel_hi:[1,0]
    v_pk_ashrrev_i16 v94, 15, v94 op_sel_hi:[0,1]
    v_pk_add_u16 v95, v79, 5 op_sel_hi:[1,0]
    v_pk_ashrrev_i16 v95, 15, v95 op_sel_hi:[0,1]
    v_pk_add_u16 v96, v76, 10 op_sel_hi:[1,0]
    v_pk_ashrrev_i16 v96, 15, v96 op_sel_hi:[0,1]
    v_pk_add_u16 v97, v77, 10 op_sel_hi:[1,0]
    v_pk_ashrrev_i16 v97, 15, v97 op_sel_hi:[0,1]
    v_pk_add_u16 v98, v78, 10 op_sel_hi:[1,0]
    v_pk_ashrrev_i16 v98, 15, v98 op_sel_hi:[0,1]
    v_pk_add_u16 v99, v79, 10 op_sel_hi:[1,0]
    v_pk_ashrrev_i16 v99, 15, v99 op_sel_hi:[0,1]
    v_pk_add_u16 v100, v76, 11 op_sel_hi:[1,0]
    v_pk_ashrrev_i16 v100, 15, v100 op_sel_hi:[0,1]
    v_pk_add_u16 v101, v77, 11 op_sel_hi:[1,0]
    v_pk_ashrrev_i16 v101, 15, v101 op_sel_hi:[0,1]
    v_pk_add_u16 v102, v78, 11 op_sel_hi:[1,0]
    v_pk_ashrrev_i16 v102, 15, v102 op_sel_hi:[0,1]
    v_pk_add_u16 v103, v79, 11 op_sel_hi:[1,0]
    v_pk_ashrrev_i16 v103, 15, v103 op_sel_hi:[0,1]
    v_pk_add_u16 v104, v76, 12 op_sel_hi:[1,0]
    v_pk_ashrrev_i16 v104, 15, v104 op_sel_hi:[0,1]
    v_pk_add_u16 v105, v77, 12 op_sel_hi:[1,0]
    v_pk_ashrrev_i16 v105, 15, v105 op_sel_hi:[0,1]
    v_pk_add_u16 v106, v78, 12 op_sel_hi:[1,0]
    v_pk_ashrrev_i16 v106, 15, v106 op_sel_hi:[0,1]
    v_pk_add_u16 v107, v79, 12 op_sel_hi:[1,0]
    v_pk_ashrrev_i16 v107, 15, v107 op_sel_hi:[0,1]
    v_bitop3_b32 v140, v80, v92, v75 bitop3:0x28
    v_bitop3_b32 v141, v81, v93, v75 bitop3:0x28
    v_bitop3_b32 v142, v82, v94, v75 bitop3:0x28
    v_bitop3_b32 v143, v83, v95, v75 bitop3:0x28
    v_bitop3_b32 v144, v92, v96, v75 bitop3:0x28
    v_bitop3_b32 v145, v93, v97, v75 bitop3:0x28
    v_bitop3_b32 v146, v94, v98, v75 bitop3:0x28
    v_bitop3_b32 v147, v95, v99, v75 bitop3:0x28
    v_bitop3_b32 v148, v88, v100, v75 bitop3:0x28
    v_bitop3_b32 v149, v89, v101, v75 bitop3:0x28
    v_bitop3_b32 v150, v90, v102, v75 bitop3:0x28
    v_bitop3_b32 v151, v91, v103, v75 bitop3:0x28
    v_bitop3_b32 v152, v84, v104, v75 bitop3:0x28
    v_bitop3_b32 v153, v85, v105, v75 bitop3:0x28
    v_bitop3_b32 v154, v86, v106, v75 bitop3:0x28
    v_bitop3_b32 v155, v87, v107, v75 bitop3:0x28
    v_xor_b32 v156, v80, v88
    v_xor_b32 v157, v81, v89
    v_xor_b32 v158, v82, v90
    v_xor_b32 v159, v83, v91
    v_lshlrev_b32 v5, 2, v4
    v_sub_u32 v5, v3, v5
    v_lshl_add_u32 v7, v5, 2, s13
    v_lshl_add_u32 v5, v5, 3, s13
    v_add_u32 v7, 2848, v7
    v_mov_b32 v6, s13
    s_mov_b32 s9, 0
SPN4:
    ds_read_b32 v128, v167 offset:76
    s_add_u32 s9, s9, 1
    s_waitcnt lgkmcnt(0)
    v_cmp_ne_u32 vcc, 8, v128
    s_cmp_ge_u32 s9, 0x40000
    s_cbranch_scc1 SPX4
    s_cbranch_vccz SPX4
    s_sleep 1
    s_branch SPN4
SPX4:
    ds_read_b32 v130, v6 offset:2716
    ds_read_b64 v[8:9], v5 offset:2464
    ds_read_b64 v[10:11], v5 offset:2456
    ds_read_b64 v[12:13], v5 offset:2448
    ds_read_b64 v[14:15], v5 offset:2440
    ds_read_b64 v[16:17], v5 offset:2592
    ds_read_b64 v[18:19], v5 offset:2584
    ds_read_b64 v[20:21], v5 offset:2576
    ds_read_b64 v[22:23], v5 offset:2568
    ds_read_b64 v[24:25], v5 offset:2720
    ds_read_b64 v[26:27], v5 offset:2712
    ds_read_b64 v[28:29], v5 offset:2704
    ds_read_b64 v[30:31], v5 offset:2696
    ds_read2_b32 v[32:33], v7 offset0:16 offset1:15
    ds_read2_b32 v[34:35], v7 offset0:14 offset1:13
    ds_read2_b32 v[36:37], v7 offset0:32 offset1:31
    ds_read2_b32 v[38:39], v7 offset0:30 offset1:29
    ds_read2_b32 v[40:41], v7 offset0:48 offset1:47
    ds_read2_b32 v[42:43], v7 offset0:46 offset1:45
    ds_read2_b32 v[44:45], v7 offset0:64 offset1:63
    ds_read2_b32 v[46:47], v7 offset0:62 offset1:61
    v_lshlrev_b32 v6, 4, v4
    v_lshl_add_u32 v6, v3, 5, v6
    v_add_u32 v6, 4048, v6
    v_add_u32 v6, s13, v6
    ds_write_b128 v164, v[124:127] offset:10240
    ds_write_b32 v165, v166 offset:0
    ds_write_b128 v164, v[124:127] offset:11520
    ds_write_b32 v165, v166 offset:32
    s_mov_b32 s8, 0x07060706
    s_mov_b32 s9, 0
SPN5:
    ds_read_b32 v128, v167 offset:72
    s_add_u32 s9, s9, 1
    s_waitcnt lgkmcnt(0)
    v_cmp_gt_u32 vcc, 2, v128
    s_cmp_ge_u32 s9, 0x40000
    s_cbranch_scc1 SPX5
    s_cbranch_vccz SPX5
    s_sleep 1
    s_branch SPN5
SPX5:
    v_perm_b32 v130, v130, v130, s8
Z_LOOP:
    ds_read_b128 v[48:51], v6 offset:16
    ds_read_b128 v[52:55], v6 offset:0
    ds_read_b128 v[56:59], v6 offset:528
    ds_read_b128 v[60:63], v6 offset:512
    v_and_b32 v156, v130, v156
    v_and_b32 v157, v130, v157
    v_and_b32 v158, v130, v158
    v_and_b32 v159, v130, v159
    s_waitcnt lgkmcnt(2)
    v_mfma_f32_16x16x32_f16 v[64:67], v[48:51], v[140:143], 0
    v_mfma_f32_16x16x32_f16 v[68:71], v[48:51], v[144:147], 0
    v_mfma_f32_16x16x32_f16 v[72:75], v[52:55], v[140:143], 0
    v_mfma_f32_16x16x32_f16 v[76:79], v[52:55], v[144:147], 0
    v_mfma_f32_16x16x32_f16 v[80:83], v[48:51], v[148:151], 0
    v_mfma_f32_16x16x32_f16 v[84:87], v[52:55], v[152:155], 0
    s_nop 3
    v_cvt_pk_f16_f32 v88, v64, v68
    v_cvt_pk_f16_f32 v90, v65, v69
    v_cvt_pk_f16_f32 v92, v66, v70
    v_cvt_pk_f16_f32 v94, v67, v71
    v_cvt_pk_f16_f32 v89, v72, v76
    v_cvt_pk_f16_f32 v91, v73, v77
    v_cvt_pk_f16_f32 v93, v74, v78
    v_cvt_pk_f16_f32 v95, v75, v79
    v_cvt_pk_f16_f32 v96, v80, v84
    v_cvt_pk_f16_f32 v97, v81, v85
    v_cvt_pk_f16_f32 v98, v82, v86
    v_cvt_pk_f16_f32 v99, v83, v87
    s_waitcnt lgkmcnt(0)
    v_mfma_f32_16x16x32_f16 v[64:67], v[56:59], v[140:143], 0
    v_mfma_f32_16x16x32_f16 v[68:71], v[56:59], v[144:147], 0
    v_mfma_f32_16x16x32_f16 v[72:75], v[60:63], v[140:143], 0
    v_mfma_f32_16x16x32_f16 v[76:79], v[60:63], v[144:147], 0
    v_mfma_f32_16x16x32_f16 v[80:83], v[56:59], v[148:151], 0
    v_mfma_f32_16x16x32_f16 v[84:87], v[60:63], v[152:155], 0
    v_mfma_f32_16x16x32_f16 v[108:111], v[156:159], v[48:51], 0
    ds_read_b128 v[48:51], v6 offset:1040
    ds_read_b128 v[52:55], v6 offset:1024
    v_mfma_f32_16x16x32_f16 v[100:103], v[88:91], v[8:11], 0
    v_mfma_f32_16x16x32_f16 v[100:103], v[92:95], v[12:15], v[100:103]
    v_cvt_pk_f16_f32 v132, v64, v68
    v_cvt_pk_f16_f32 v134, v65, v69
    v_mfma_f32_16x16x32_f16 v[104:107], v[88:91], v[16:19], 0
    v_cvt_pk_f16_f32 v136, v66, v70
    v_cvt_pk_f16_f32 v138, v67, v71
    v_mfma_f32_16x16x32_f16 v[104:107], v[92:95], v[20:23], v[104:107]
    v_cvt_pk_f16_f32 v133, v72, v76
    v_cvt_pk_f16_f32 v135, v73, v77
    v_mfma_f32_16x16x32_f16 v[108:111], v[88:91], v[24:27], v[108:111]
    v_cvt_pk_f16_f32 v137, v74, v78
    v_cvt_pk_f16_f32 v139, v75, v79
    v_mfma_f32_16x16x32_f16 v[108:111], v[92:95], v[28:31], v[108:111]
    v_cvt_pk_f16_f32 v160, v80, v84
    v_cvt_pk_f16_f32 v161, v81, v85
    v_mfma_f32_16x16x32_f16 v[108:111], v[96:99], v[32:35], v[108:111]
    v_cvt_pk_f16_f32 v162, v82, v86
    v_cvt_pk_f16_f32 v163, v83, v87
    v_mfma_f32_16x16x32_f16 v[112:115], v[96:99], v[36:39], 0
    v_mfma_f32_16x16x32_f16 v[116:119], v[96:99], v[40:43], 0
    v_mfma_f32_16x16x32_f16 v[120:123], v[96:99], v[44:47], 0
    s_waitcnt lgkmcnt(0)
    v_mfma_f32_16x16x32_f16 v[64:67], v[48:51], v[140:143], 0
    v_mfma_f32_16x16x32_f16 v[68:71], v[48:51], v[144:147], 0
    ds_write_b64 v164, v[100:101] offset:12800
    v_mfma_f32_16x16x32_f16 v[72:75], v[52:55], v[140:143], 0
    ds_write_b64 v164, v[102:103] offset:12808
    v_mfma_f32_16x16x32_f16 v[76:79], v[52:55], v[144:147], 0
    ds_write_b32 v165, v166 offset:64
    v_mfma_f32_16x16x32_f16 v[80:83], v[48:51], v[148:151], 0
    v_mfma_f32_16x16x32_f16 v[84:87], v[52:55], v[152:155], 0
    v_mfma_f32_16x16x32_f16 v[112:115], v[156:159], v[56:59], v[112:115]
    ds_read_b128 v[56:59], v6 offset:1552
    ds_read_b128 v[60:63], v6 offset:1536
    v_mfma_f32_16x16x32_f16 v[104:107], v[132:135], v[8:11], v[104:107]
    v_mfma_f32_16x16x32_f16 v[104:107], v[136:139], v[12:15], v[104:107]
    v_cvt_pk_f16_f32 v88, v64, v68
    v_cvt_pk_f16_f32 v90, v65, v69
    v_mfma_f32_16x16x32_f16 v[108:111], v[132:135], v[16:19], v[108:111]
    v_cvt_pk_f16_f32 v92, v66, v70
    v_cvt_pk_f16_f32 v94, v67, v71
    v_mfma_f32_16x16x32_f16 v[108:111], v[136:139], v[20:23], v[108:111]
    v_cvt_pk_f16_f32 v89, v72, v76
    v_cvt_pk_f16_f32 v91, v73, v77
    v_mfma_f32_16x16x32_f16 v[112:115], v[132:135], v[24:27], v[112:115]
    v_cvt_pk_f16_f32 v93, v74, v78
    v_cvt_pk_f16_f32 v95, v75, v79
    v_mfma_f32_16x16x32_f16 v[112:115], v[136:139], v[28:31], v[112:115]
    v_cvt_pk_f16_f32 v96, v80, v84
    v_cvt_pk_f16_f32 v97, v81, v85
    v_mfma_f32_16x16x32_f16 v[112:115], v[160:163], v[32:35], v[112:115]
    v_cvt_pk_f16_f32 v98, v82, v86
    v_cvt_pk_f16_f32 v99, v83, v87
    v_mfma_f32_16x16x32_f16 v[116:119], v[160:163], v[36:39], v[116:119]
    v_mfma_f32_16x16x32_f16 v[120:123], v[160:163], v[40:43], v[120:123]
    s_waitcnt lgkmcnt(0)
    v_mfma_f32_16x16x32_f16 v[64:67], v[56:59], v[140:143], 0
    v_mfma_f32_16x16x32_f16 v[68:71], v[56:59], v[144:147], 0
    ds_write_b64 v164, v[104:105] offset:14080
    v_mfma_f32_16x16x32_f16 v[72:75], v[60:63], v[140:143], 0
    ds_write_b64 v164, v[106:107] offset:14088
    v_mfma_f32_16x16x32_f16 v[76:79], v[60:63], v[144:147], 0
    ds_write_b32 v165, v166 offset:96
    v_mfma_f32_16x16x32_f16 v[80:83], v[56:59], v[148:151], 0
    v_mfma_f32_16x16x32_f16 v[84:87], v[60:63], v[152:155], 0
    v_mfma_f32_16x16x32_f16 v[116:119], v[156:159], v[48:51], v[116:119]
    v_mfma_f32_16x16x32_f16 v[108:111], v[88:91], v[8:11], v[108:111]
    v_mfma_f32_16x16x32_f16 v[108:111], v[92:95], v[12:15], v[108:111]
    v_mfma_f32_16x16x32_f16 v[112:115], v[88:91], v[16:19], v[112:115]
    v_cvt_pk_f16_f32 v132, v64, v68
    v_cvt_pk_f16_f32 v134, v65, v69
    v_mfma_f32_16x16x32_f16 v[112:115], v[92:95], v[20:23], v[112:115]
    v_cvt_pk_f16_f32 v136, v66, v70
    v_cvt_pk_f16_f32 v138, v67, v71
    v_mfma_f32_16x16x32_f16 v[116:119], v[88:91], v[24:27], v[116:119]
    v_cvt_pk_f16_f32 v133, v72, v76
    v_cvt_pk_f16_f32 v135, v73, v77
    v_mfma_f32_16x16x32_f16 v[116:119], v[92:95], v[28:31], v[116:119]
    v_cvt_pk_f16_f32 v137, v74, v78
    v_cvt_pk_f16_f32 v139, v75, v79
    v_mfma_f32_16x16x32_f16 v[116:119], v[96:99], v[32:35], v[116:119]
    v_cvt_pk_f16_f32 v160, v80, v84
    v_cvt_pk_f16_f32 v161, v81, v85
    v_mfma_f32_16x16x32_f16 v[120:123], v[96:99], v[36:39], v[120:123]
    v_cvt_pk_f16_f32 v162, v82, v86
    v_cvt_pk_f16_f32 v163, v83, v87
    s_nop 1
    v_mfma_f32_16x16x32_f16 v[120:123], v[156:159], v[56:59], v[120:123]
    v_mfma_f32_16x16x32_f16 v[112:115], v[132:135], v[8:11], v[112:115]
    v_mfma_f32_16x16x32_f16 v[112:115], v[136:139], v[12:15], v[112:115]
    v_mfma_f32_16x16x32_f16 v[116:119], v[132:135], v[16:19], v[116:119]
    v_mfma_f32_16x16x32_f16 v[116:119], v[136:139], v[20:23], v[116:119]
    v_mfma_f32_16x16x32_f16 v[120:123], v[132:135], v[24:27], v[120:123]
    v_mfma_f32_16x16x32_f16 v[120:123], v[136:139], v[28:31], v[120:123]
    v_mfma_f32_16x16x32_f16 v[120:123], v[160:163], v[32:35], v[120:123]
    s_mov_b32 s9, 0
SPN6:
    ds_read_b32 v128, v167 offset:72
    s_add_u32 s9, s9, 1
    s_waitcnt lgkmcnt(0)
    v_cmp_ne_u32 vcc, 4, v128
    s_cmp_ge_u32 s9, 0x40000
    s_cbranch_scc1 SPX6
    s_cbranch_vccz SPX6
    s_sleep 1
    s_branch SPN6
SPX6:
    s_lshl_b32 s8, s7, 2
    v_add_u32 v128, s8, v167
    ds_read_b32 v128, v128 offset:96
    s_cmp_lg_u32 s3, 4
    s_cbranch_scc1 Z_NOSEL
    v_and_b32 v126, 7, v2
    s_lshl_b32 s9, s4, 8
    v_lshl_add_u32 v126, v126, 3, s9
    global_load_dwordx2 v[124:125], v126, s[50:51] offset:256 sc1
Z_NOSEL:
    ds_read_b128 v[48:51], v6 offset:2576
    ds_read_b128 v[52:55], v6 offset:2560
    ds_read_b128 v[56:59], v6 offset:3088
    ds_read_b128 v[60:63], v6 offset:3072
    s_waitcnt lgkmcnt(4)
    v_mul_f32 v108, v108, v128
    v_mul_f32 v109, v109, v128
    v_mul_f32 v110, v110, v128
    v_mul_f32 v111, v111, v128
    v_mul_f32 v112, v112, v128
    v_mul_f32 v113, v113, v128
    v_mul_f32 v114, v114, v128
    v_mul_f32 v115, v115, v128
    v_mul_f32 v116, v116, v128
    v_mul_f32 v117, v117, v128
    v_mul_f32 v118, v118, v128
    v_mul_f32 v119, v119, v128
    v_mul_f32 v120, v120, v128
    v_mul_f32 v121, v121, v128
    v_mul_f32 v122, v122, v128
    v_mul_f32 v123, v123, v128
    s_waitcnt lgkmcnt(2)
    v_mfma_f32_16x16x32_f16 v[64:67], v[48:51], v[140:143], 0
    ds_write_b64 v164, v[108:109] offset:15360
    v_mfma_f32_16x16x32_f16 v[68:71], v[48:51], v[144:147], 0
    ds_write_b64 v164, v[110:111] offset:15368
    v_mfma_f32_16x16x32_f16 v[72:75], v[52:55], v[140:143], 0
    ds_write_b32 v165, v166 offset:128
    v_mfma_f32_16x16x32_f16 v[76:79], v[52:55], v[144:147], 0
    ds_write_b64 v164, v[112:113] offset:16640
    ds_write_b64 v164, v[114:115] offset:16648
    ds_write_b32 v165, v166 offset:160
    s_nop 1
    v_cvt_pk_f16_f32 v88, v64, v68
    v_cvt_pk_f16_f32 v90, v65, v69
    v_cvt_pk_f16_f32 v92, v66, v70
    v_cvt_pk_f16_f32 v94, v67, v71
    v_cvt_pk_f16_f32 v89, v72, v76
    v_cvt_pk_f16_f32 v91, v73, v77
    v_cvt_pk_f16_f32 v93, v74, v78
    v_cvt_pk_f16_f32 v95, v75, v79
    s_waitcnt lgkmcnt(6)
    v_mfma_f32_16x16x32_f16 v[64:67], v[56:59], v[140:143], 0
    v_mfma_f32_16x16x32_f16 v[68:71], v[56:59], v[144:147], 0
    v_mfma_f32_16x16x32_f16 v[72:75], v[60:63], v[140:143], 0
    v_mfma_f32_16x16x32_f16 v[76:79], v[60:63], v[144:147], 0
    v_mfma_f32_16x16x32_f16 v[116:119], v[88:91], v[8:11], v[116:119]
    v_mfma_f32_16x16x32_f16 v[116:119], v[92:95], v[12:15], v[116:119]
    v_mfma_f32_16x16x32_f16 v[120:123], v[88:91], v[16:19], v[120:123]
    v_mfma_f32_16x16x32_f16 v[120:123], v[92:95], v[20:23], v[120:123]
    s_nop 1
    v_cvt_pk_f16_f32 v132, v64, v68
    v_cvt_pk_f16_f32 v134, v65, v69
    v_cvt_pk_f16_f32 v136, v66, v70
    v_cvt_pk_f16_f32 v138, v67, v71
    v_cvt_pk_f16_f32 v133, v72, v76
    v_cvt_pk_f16_f32 v135, v73, v77
    v_cvt_pk_f16_f32 v137, v74, v78
    v_cvt_pk_f16_f32 v139, v75, v79
    ds_write_b64 v164, v[116:117] offset:17920
    ds_write_b64 v164, v[118:119] offset:17928
    v_mfma_f32_16x16x32_f16 v[120:123], v[132:135], v[8:11], v[120:123]
    v_mfma_f32_16x16x32_f16 v[120:123], v[136:139], v[12:15], v[120:123]
    ds_write_b32 v165, v166 offset:192
    s_nop 6
    ds_write_b64 v164, v[120:121] offset:19200
    ds_write_b64 v164, v[122:123] offset:19208
    ds_write_b32 v165, v166 offset:224
    s_setprio 0
    s_cmp_eq_u32 s3, 4
    s_cbranch_scc1 FINAL
    s_waitcnt lgkmcnt(0)
    s_endpgm
CU_C3A:
    s_cmp_ge_u32 s101, 4
    s_cbranch_scc1 CU_C3B
    s_sub_u32 s14, 3, s4
    s_and_b32 s14, s14, 7
    s_and_b32 s8, s101, 1
    s_lshl_b32 s8, s8, 3
    s_lshr_b32 s9, s101, 1
    s_cmp_eq_u32 s4, 3
    s_cselect_b32 s14, s8, s14
    s_cselect_b32 s9, s9, s101
    s_add_u32 s9, s9, 2
    s_min_u32 s9, s9, 17
    s_mul_i32 s9, s9, 9
    s_add_u32 s14, s14, s9
    v_mul_u32_u24 v140, 9216, v2
    s_mul_i32 s8, s4, 1152
    v_add_u32 v140, s8, v140
    s_mul_i32 s8, s14, 7282
    s_lshr_b32 s8, s8, 16
    s_mul_i32 s9, s8, 9
    s_sub_u32 s9, s14, s9
    s_lshl_b32 s9, s9, 7
    s_bitcmp1_b32 s8, 0
    s_cselect_b32 s12, s40, s38
    s_cselect_b32 s13, s41, s39
    s_lshr_b32 s8, s8, 1
    s_add_u32 s8, s8, 0
    s_mul_i32 s8, s8, 589824
    s_add_u32 s8, s8, s9
    v_add_u32 v148, s8, v140
    global_load_dword v149, v148, s[12:13]
    s_lshl_b32 s9, s6, 3
    s_branch CU_C3B
CU_C3:
    s_add_u32 s10, s10, 4
    s_sub_u32 s14, 3, s4
    s_and_b32 s14, s14, 7
    s_and_b32 s8, s10, 1
    s_lshl_b32 s8, s8, 3
    s_lshr_b32 s9, s10, 1
    s_cmp_eq_u32 s4, 3
    s_cselect_b32 s14, s8, s14
    s_cselect_b32 s9, s9, s10
    s_add_u32 s9, s9, 2
    s_min_u32 s9, s9, 17
    s_mul_i32 s9, s9, 9
    s_add_u32 s14, s14, s9
    v_mul_u32_u24 v140, 9216, v2
    s_mul_i32 s8, s4, 1152
    v_add_u32 v140, s8, v140
    s_mul_i32 s8, s14, 7282
    s_lshr_b32 s8, s8, 16
    s_mul_i32 s9, s8, 9
    s_sub_u32 s9, s14, s9
    s_lshl_b32 s9, s9, 7
    s_bitcmp1_b32 s8, 0
    s_cselect_b32 s12, s40, s38
    s_cselect_b32 s13, s41, s39
    s_lshr_b32 s8, s8, 1
    s_add_u32 s8, s8, 0
    s_mul_i32 s8, s8, 589824
    s_add_u32 s8, s8, s9
    v_add_u32 v148, s8, v140
    global_load_dword v149, v148, s[12:13]
    s_lshl_b32 s9, s6, 3
    s_branch CU_C3X
CU_MID:
    s_mov_b32 s12, 0
SPN7:
    ds_read_b32 v56, v57 offset:64
    s_add_u32 s12, s12, 1
    s_waitcnt lgkmcnt(0)
    v_cmp_gt_u32 vcc, 2, v56
    s_cmp_ge_u32 s12, 0x40000
    s_cbranch_scc1 SPX7
    s_cbranch_vccz SPX7
    s_sleep 2
    s_branch SPN7
SPX7:
    s_branch CU_LD
CU_MAIN:
    s_load_dwordx2 s[52:53], s[32:33], s9
    v_mov_b32 v139, 1
    v_lshlrev_b32 v137, 4, v2
    v_and_b32 v7, 0x3c0, v137
    v_add_u32 v7, v7, v137
    v_and_b32 v138, 0x3e0, v137
    v_mul_u32_u24 v138, 3, v138
    v_add_u32 v138, v138, v137
    v_add_u32 v138, 10304, v138
    s_lshl_b32 s8, s15, 11
    s_add_u32 s8, s8, 24576
    v_add_u32 v7, s8, v7
    v_add_u32 v137, 8192, v7
    v_add_u32 v138, 20480, v138
    s_cmp_eq_u32 s7, 1
    s_cselect_b64 vcc, -1, 0
    v_cndmask_b32 v138, v137, v138, vcc
    s_mov_b32 s72, s15
    s_cmp_ge_u32 s7, 2
    s_cbranch_scc1 CU_P2
    s_mov_b64 exec, 1
    ds_add_u32 v57, v139 offset:64
    s_mov_b64 exec, -1
    s_setprio 3
    v_and_b32 v56, 12, v3
    v_add_u32 v136, 155728, v56
    v_add_u32 v56, 155648, v56
    v_and_b32 v146, 3, v2
    v_lshl_add_u32 v146, v146, 2, v57
    v_add_u32 v147, 0, v146
    s_lshl_b32 s8, s72, 9
    s_add_u32 s8, s8, 124928
    v_lshl_add_u32 v58, v2, 3, s8
    v_mov_b32 v148, 1
    s_mov_b32 s73, 15
    s_mov_b32 s74, 2
    s_waitcnt vmcnt(7)
    v_lshlrev_b32 v24, 16, v8
    v_and_b32 v28, 0xffff0000, v8
    v_lshlrev_b32 v32, 16, v9
    v_and_b32 v36, 0xffff0000, v9
    s_waitcnt vmcnt(6)
    v_lshlrev_b32 v25, 16, v10
    v_and_b32 v29, 0xffff0000, v10
    v_lshlrev_b32 v33, 16, v11
    v_and_b32 v37, 0xffff0000, v11
    v_max3_f32 v62, |v24|, |v25|, 0
    v_max3_f32 v63, |v28|, |v29|, 0
    v_max3_f32 v64, |v32|, |v33|, 0
    v_max3_f32 v65, |v36|, |v37|, 0
    s_waitcnt vmcnt(5)
    v_lshlrev_b32 v26, 16, v12
    v_and_b32 v30, 0xffff0000, v12
    v_lshlrev_b32 v34, 16, v13
    v_and_b32 v38, 0xffff0000, v13
    s_waitcnt vmcnt(4)
    v_lshlrev_b32 v27, 16, v14
    v_and_b32 v31, 0xffff0000, v14
    v_lshlrev_b32 v35, 16, v15
    v_and_b32 v39, 0xffff0000, v15
    v_max3_f32 v62, |v26|, |v27|, v62
    v_max3_f32 v63, |v30|, |v31|, v63
    v_max3_f32 v64, |v34|, |v35|, v64
    v_max3_f32 v65, |v38|, |v39|, v65
    s_waitcnt vmcnt(3)
    v_lshlrev_b32 v40, 16, v16
    v_and_b32 v44, 0xffff0000, v16
    v_lshlrev_b32 v48, 16, v17
    v_and_b32 v52, 0xffff0000, v17
    s_waitcnt vmcnt(2)
    v_lshlrev_b32 v41, 16, v18
    v_and_b32 v45, 0xffff0000, v18
    v_lshlrev_b32 v49, 16, v19
    v_and_b32 v53, 0xffff0000, v19
    v_max3_f32 v62, |v40|, |v41|, v62
    v_max3_f32 v63, |v44|, |v45|, v63
    v_max3_f32 v64, |v48|, |v49|, v64
    v_max3_f32 v65, |v52|, |v53|, v65
    s_waitcnt vmcnt(1)
    v_lshlrev_b32 v42, 16, v20
    v_and_b32 v46, 0xffff0000, v20
    v_lshlrev_b32 v50, 16, v21
    v_and_b32 v54, 0xffff0000, v21
    s_waitcnt vmcnt(0)
    v_lshlrev_b32 v43, 16, v22
    v_and_b32 v47, 0xffff0000, v22
    v_lshlrev_b32 v51, 16, v23
    v_and_b32 v55, 0xffff0000, v23
    v_max3_f32 v62, |v42|, |v43|, v62
    v_max3_f32 v63, |v46|, |v47|, v63
    v_max3_f32 v64, |v50|, |v51|, v64
    v_max3_f32 v65, |v54|, |v55|, v65
    s_branch CU_MAX
CU_P2:
    s_mov_b64 exec, 1
    ds_add_u32 v57, v139 offset:64
    s_mov_b64 exec, -1
    v_and_b32 v56, 12, v3
    v_add_u32 v136, 155728, v56
    v_add_u32 v56, 155728, v56
    v_and_b32 v146, 3, v2
    v_lshl_add_u32 v146, v146, 2, v57
    v_add_u32 v147, 80, v146
    s_lshl_b32 s8, s72, 9
    s_add_u32 s8, s8, 125440
    v_lshl_add_u32 v58, v2, 3, s8
    v_mov_b32 v148, 16
    s_mov_b32 s73, 255
    s_mov_b32 s74, 34
    s_setprio 3
    s_waitcnt vmcnt(7)
    v_lshlrev_b32 v24, 16, v8
    v_and_b32 v28, 0xffff0000, v8
    v_lshlrev_b32 v32, 16, v9
    v_and_b32 v36, 0xffff0000, v9
    s_waitcnt vmcnt(6)
    v_lshlrev_b32 v25, 16, v10
    v_and_b32 v29, 0xffff0000, v10
    v_lshlrev_b32 v33, 16, v11
    v_and_b32 v37, 0xffff0000, v11
    v_max3_f32 v62, |v24|, |v25|, 0
    v_max3_f32 v63, |v28|, |v29|, 0
    v_max3_f32 v64, |v32|, |v33|, 0
    v_max3_f32 v65, |v36|, |v37|, 0
    s_waitcnt vmcnt(5)
    v_lshlrev_b32 v26, 16, v12
    v_and_b32 v30, 0xffff0000, v12
    v_lshlrev_b32 v34, 16, v13
    v_and_b32 v38, 0xffff0000, v13
    s_waitcnt vmcnt(4)
    v_lshlrev_b32 v27, 16, v14
    v_and_b32 v31, 0xffff0000, v14
    v_lshlrev_b32 v35, 16, v15
    v_and_b32 v39, 0xffff0000, v15
    v_max3_f32 v62, |v26|, |v27|, v62
    v_max3_f32 v63, |v30|, |v31|, v63
    v_max3_f32 v64, |v34|, |v35|, v64
    v_max3_f32 v65, |v38|, |v39|, v65
    s_waitcnt vmcnt(3)
    v_lshlrev_b32 v40, 16, v16
    v_and_b32 v44, 0xffff0000, v16
    v_lshlrev_b32 v48, 16, v17
    v_and_b32 v52, 0xffff0000, v17
    s_waitcnt vmcnt(2)
    v_lshlrev_b32 v41, 16, v18
    v_and_b32 v45, 0xffff0000, v18
    v_lshlrev_b32 v49, 16, v19
    v_and_b32 v53, 0xffff0000, v19
    v_max3_f32 v62, |v40|, |v41|, v62
    v_max3_f32 v63, |v44|, |v45|, v63
    v_max3_f32 v64, |v48|, |v49|, v64
    v_max3_f32 v65, |v52|, |v53|, v65
    s_waitcnt vmcnt(1)
    v_lshlrev_b32 v42, 16, v20
    v_and_b32 v46, 0xffff0000, v20
    v_lshlrev_b32 v50, 16, v21
    v_and_b32 v54, 0xffff0000, v21
    s_waitcnt vmcnt(0)
    v_lshlrev_b32 v43, 16, v22
    v_and_b32 v47, 0xffff0000, v22
    v_lshlrev_b32 v51, 16, v23
    v_and_b32 v55, 0xffff0000, v23
    v_max3_f32 v62, |v42|, |v43|, v62
    v_max3_f32 v63, |v46|, |v47|, v63
    v_max3_f32 v64, |v50|, |v51|, v64
    v_max3_f32 v65, |v54|, |v55|, v65
CU_MAX:
    s_mov_b32 s10, 0x11111111
    s_mov_b32 s11, 0x11111111
    v_max_u32_dpp v62, v62, v62 row_ror:4 row_mask:0xf bank_mask:0xf
    v_max_u32_dpp v63, v63, v63 row_ror:4 row_mask:0xf bank_mask:0xf
    v_max_u32_dpp v64, v64, v64 row_ror:4 row_mask:0xf bank_mask:0xf
    v_max_u32_dpp v65, v65, v65 row_ror:4 row_mask:0xf bank_mask:0xf
    v_max_u32_dpp v61, v62, v62 row_ror:8 row_mask:0xf bank_mask:0x1
    s_nop 1
    v_max_u32_dpp v61, v63, v63 row_ror:8 row_mask:0xf bank_mask:0x2
    s_nop 1
    v_max_u32_dpp v61, v64, v64 row_ror:8 row_mask:0xf bank_mask:0x4
    s_nop 1
    v_max_u32_dpp v61, v65, v65 row_ror:8 row_mask:0xf bank_mask:0x8
    s_nop 1
    v_max_u32_dpp v61, v61, v61 quad_perm:[1,0,3,2] row_mask:0xf bank_mask:0xf
    s_nop 1
    v_max_u32_dpp v61, v61, v61 quad_perm:[2,3,0,1] row_mask:0xf bank_mask:0xf
    s_mov_b64 exec, s[10:11]
    ds_max_u32 v56, v61
    ds_max_u32 v136, v61
    s_mov_b64 exec, 1
    ds_add_u32 v57, v148 offset:68
    s_mov_b64 exec, -1
    s_mov_b32 s12, 0
SPN8:
    ds_read_b32 v60, v57 offset:68
    s_add_u32 s12, s12, 1
    s_waitcnt lgkmcnt(0)
    v_and_b32 v60, s73, v60
    v_cmp_ne_u32 vcc, s74, v60
    s_cmp_ge_u32 s12, 0x40000
    s_cbranch_scc1 SPX8
    s_cbranch_vccz SPX8
    s_sleep 1
    s_branch SPN8
SPX8:
    ds_read_b32 v62, v147
    ds_read_b32 v63, v146
    s_waitcnt lgkmcnt(1)
    v_lshrrev_b32 v62, 23, v62
    v_sub_u32 v62, 265, v62
    v_min_i32 v62, 253, v62
    v_lshlrev_b32 v64, 23, v62
    s_nop 1
    v_mov_b32_dpp v150, v64 quad_perm:[0,0,0,0] row_mask:0xf bank_mask:0xf
    v_mov_b32_dpp v151, v64 quad_perm:[1,1,1,1] row_mask:0xf bank_mask:0xf
    v_mov_b32_dpp v152, v64 quad_perm:[2,2,2,2] row_mask:0xf bank_mask:0xf
    v_mov_b32_dpp v153, v64 quad_perm:[3,3,3,3] row_mask:0xf bank_mask:0xf
    v_mul_f32 v66, v24, v150
    v_mul_f32 v67, v25, v150
    v_mul_f32 v68, v26, v150
    v_mul_f32 v69, v27, v150
    v_cvt_pk_f16_f32 v70, v67, v66
    v_cvt_pk_f16_f32 v71, v69, v68
    ds_write_b64 v58, v[70:71] offset:0
    v_mul_f32 v72, v28, v151
    v_mul_f32 v73, v29, v151
    v_mul_f32 v74, v30, v151
    v_mul_f32 v75, v31, v151
    v_cvt_pk_f16_f32 v76, v73, v72
    v_cvt_pk_f16_f32 v77, v75, v74
    ds_write_b64 v58, v[76:77] offset:8704
    v_mul_f32 v66, v32, v152
    v_mul_f32 v67, v33, v152
    v_mul_f32 v68, v34, v152
    v_mul_f32 v69, v35, v152
    v_cvt_pk_f16_f32 v70, v67, v66
    v_cvt_pk_f16_f32 v71, v69, v68
    ds_write_b64 v58, v[70:71] offset:17408
    v_mul_f32 v72, v36, v153
    v_mul_f32 v73, v37, v153
    v_mul_f32 v74, v38, v153
    v_mul_f32 v75, v39, v153
    v_cvt_pk_f16_f32 v76, v73, v72
    v_cvt_pk_f16_f32 v77, v75, v74
    ds_write_b64 v58, v[76:77] offset:26112
    v_mul_f32 v66, v40, v150
    v_mul_f32 v67, v41, v150
    v_mul_f32 v68, v42, v150
    v_mul_f32 v69, v43, v150
    v_cvt_pk_f16_f32 v70, v67, v66
    v_cvt_pk_f16_f32 v71, v69, v68
    ds_write_b64 v58, v[70:71] offset:1024
    v_mul_f32 v72, v44, v151
    v_mul_f32 v73, v45, v151
    v_mul_f32 v74, v46, v151
    v_mul_f32 v75, v47, v151
    v_cvt_pk_f16_f32 v76, v73, v72
    v_cvt_pk_f16_f32 v77, v75, v74
    ds_write_b64 v58, v[76:77] offset:9728
    v_mul_f32 v66, v48, v152
    v_mul_f32 v67, v49, v152
    v_mul_f32 v68, v50, v152
    v_mul_f32 v69, v51, v152
    v_cvt_pk_f16_f32 v70, v67, v66
    v_cvt_pk_f16_f32 v71, v69, v68
    ds_write_b64 v58, v[70:71] offset:18432
    v_mul_f32 v72, v52, v153
    v_mul_f32 v73, v53, v153
    v_mul_f32 v74, v54, v153
    v_mul_f32 v75, v55, v153
    v_cvt_pk_f16_f32 v76, v73, v72
    v_cvt_pk_f16_f32 v77, v75, v74
    ds_write_b64 v58, v[76:77] offset:27136
    s_cmp_lt_u32 s7, 2
    s_cbranch_scc1 CU_CVD
    s_mov_b32 s12, 0
SPN9:
    ds_read_b32 v60, v57 offset:72
    s_add_u32 s12, s12, 1
    s_waitcnt lgkmcnt(0)
    v_cmp_gt_u32 vcc, 2, v60
    s_cmp_ge_u32 s12, 0x40000
    s_cbranch_scc1 SPX9
    s_cbranch_vccz SPX9
    s_sleep 1
    s_branch SPN9
SPX9:
    s_sub_u32 s8, s7, 2
    s_lshl_b32 s9, s8, 1
    s_mul_i32 s8, s8, 17408
    s_add_u32 s8, s8, 126464
    v_lshl_add_u32 v60, v2, 3, s8
    ds_read_b64 v[66:67], v60
    ds_read_b64 v[68:69], v60 offset:8704
    v_lshrrev_b32 v63, 23, v63
    v_sub_u32 v63, 265, v63
    v_min_i32 v63, 253, v63
    v_sub_u32 v63, v62, v63
    v_add_u32 v63, 127, v63
    v_max_i32 v63, 0, v63
    v_lshlrev_b32 v63, 23, v63
    ds_write_b32 v146, v63 offset:96
    v_cvt_pk_f16_f32 v63, v63, v63
    s_add_u32 s8, s9, 1
    v_readlane_b32 s10, v63, s9
    v_readlane_b32 s11, v63, s8
    s_waitcnt lgkmcnt(1)
    v_pk_mul_f16 v66, v66, s10
    v_pk_mul_f16 v67, v67, s10
    v_pk_mul_f16 v68, v68, s11
    v_pk_mul_f16 v69, v69, s11
    ds_write_b64 v60, v[66:67] offset:512
    ds_write_b64 v60, v[68:69] offset:9216
CU_CVD:
    s_mov_b64 exec, 1
    ds_add_u32 v57, v139 offset:72
    s_mov_b64 exec, -1
    s_setprio 3
    v_lshlrev_b32 v154, 16, s52
    v_mov_b32 v155, s52
    v_lshlrev_b32 v156, 16, s53
    v_mov_b32 v157, s53
    v_and_b32 v155, 0xffff0000, v155
    v_and_b32 v157, 0xffff0000, v157
    s_cmp_ge_u32 s7, 2
    s_cbranch_scc1 E_NOG
    s_mov_b32 s12, 0
SPN10:
    ds_read_b32 v60, v57 offset:64
    s_add_u32 s12, s12, 1
    s_waitcnt lgkmcnt(0)
    v_cmp_gt_u32 vcc, 4, v60
    s_cmp_ge_u32 s12, 0x40000
    s_cbranch_scc1 SPX10
    s_cbranch_vccz SPX10
    s_sleep 2
    s_branch SPN10
SPX10:
    global_load_dwordx2 v[144:145], v59, s[48:49] sc1
    global_load_dwordx4 v[128:131], v7, s[50:51] offset:-4096 sc1
    global_load_dwordx4 v[132:135], v7, s[50:51] sc1
    global_load_dwordx4 v[160:163], v137, s[50:51] offset:-4096 sc1
    global_load_dwordx4 v[164:167], v138, s[50:51] sc1
    s_add_u32 s15, s7, 0
    s_cmp_ge_u32 s15, 0
    s_cbranch_scc1 CPF_DE0
    s_mul_i32 s14, s15, 18
    s_add_u32 s14, s14, s101
    v_mul_u32_u24 v140, 9216, v2
    s_mul_i32 s8, s4, 1152
    v_add_u32 v140, s8, v140
    s_mul_i32 s8, s14, 7282
    s_lshr_b32 s8, s8, 16
    s_mul_i32 s9, s8, 9
    s_sub_u32 s9, s14, s9
    s_lshl_b32 s9, s9, 7
    s_bitcmp1_b32 s8, 0
    s_cselect_b32 s12, s40, s38
    s_cselect_b32 s13, s41, s39
    s_lshr_b32 s8, s8, 1
    s_add_u32 s8, s8, 9
    s_mul_i32 s8, s8, 589824
    s_add_u32 s8, s8, s9
    v_add_u32 v148, s8, v140
    global_load_dword v149, v148, s[12:13]
    s_branch CPF_XE0
CPF_DE0:
    s_sub_u32 s14, s15, 0
    s_mul_i32 s14, s14, 18
    s_add_u32 s14, s14, s101
    s_min_u32 s14, s14, 80
    s_mul_i32 s8, s4, 81
    s_add_u32 s8, s8, s14
    s_lshl_b32 s8, s8, 13
    v_lshl_add_u32 v148, v2, 7, s8
    global_load_dword v149, v148, s[42:43]
CPF_XE0:
    s_add_u32 s15, s7, 2
    s_cmp_ge_u32 s15, 0
    s_cbranch_scc1 CPF_DE1
    s_mul_i32 s14, s15, 18
    s_add_u32 s14, s14, s101
    v_mul_u32_u24 v140, 9216, v2
    s_mul_i32 s8, s4, 1152
    v_add_u32 v140, s8, v140
    s_mul_i32 s8, s14, 7282
    s_lshr_b32 s8, s8, 16
    s_mul_i32 s9, s8, 9
    s_sub_u32 s9, s14, s9
    s_lshl_b32 s9, s9, 7
    s_bitcmp1_b32 s8, 0
    s_cselect_b32 s12, s40, s38
    s_cselect_b32 s13, s41, s39
    s_lshr_b32 s8, s8, 1
    s_add_u32 s8, s8, 9
    s_mul_i32 s8, s8, 589824
    s_add_u32 s8, s8, s9
    v_add_u32 v148, s8, v140
    global_load_dword v149, v148, s[12:13]
    s_branch CPF_XE1
CPF_DE1:
    s_sub_u32 s14, s15, 0
    s_mul_i32 s14, s14, 18
    s_add_u32 s14, s14, s101
    s_min_u32 s14, s14, 80
    s_mul_i32 s8, s4, 81
    s_add_u32 s8, s8, s14
    s_lshl_b32 s8, s8, 13
    v_lshl_add_u32 v148, v2, 7, s8
    global_load_dword v149, v148, s[42:43]
CPF_XE1:
E_NOG:
    v_and_b32 v56, 3, v2
    v_mul_u32_u24 v56, 320, v56
    v_lshrrev_b32 v136, 2, v2
    v_lshl_add_u32 v56, v136, 4, v56
    s_mul_i32 s8, s72, 1280
    v_add_u32 v56, s8, v56
    v_add_u32 v136, 40960, v56
    v_and_b32 v58, 7, v2
    s_lshl_b32 s8, s72, 5
    s_add_u32 s8, s8, 155904
    v_lshl_add_u32 v58, v58, 2, s8
    s_lshl_b32 s8, s72, 10
    v_lshl_add_u32 v147, v2, 4, s8
    v_lshlrev_b32 v148, 1, v147
    v_add_u32 v147, 98304, v147
    v_add_u32 v148, 81920, v148
    v_mul_f32 v64, v24, v154
    v_cvt_pk_bf16_f32 v64, 0, v64
    v_mul_f32 v65, v25, v154
    v_cvt_pk_bf16_f32 v65, 0, v65
    v_mul_f32 v66, v26, v154
    v_cvt_pk_bf16_f32 v66, 0, v66
    v_mul_f32 v67, v27, v154
    v_cvt_pk_bf16_f32 v67, 0, v67
    v_mul_f32 v68, v28, v155
    v_cvt_pk_bf16_f32 v68, 0, v68
    v_mul_f32 v69, v29, v155
    v_cvt_pk_bf16_f32 v69, 0, v69
    v_mul_f32 v70, v30, v155
    v_cvt_pk_bf16_f32 v70, 0, v70
    v_mul_f32 v71, v31, v155
    v_cvt_pk_bf16_f32 v71, 0, v71
    v_mul_f32 v72, v32, v156
    v_cvt_pk_bf16_f32 v72, 0, v72
    v_mul_f32 v73, v33, v156
    v_cvt_pk_bf16_f32 v73, 0, v73
    v_mul_f32 v74, v34, v156
    v_cvt_pk_bf16_f32 v74, 0, v74
    v_mul_f32 v75, v35, v156
    v_cvt_pk_bf16_f32 v75, 0, v75
    v_mul_f32 v76, v36, v157
    v_cvt_pk_bf16_f32 v76, 0, v76
    v_mul_f32 v77, v37, v157
    v_cvt_pk_bf16_f32 v77, 0, v77
    v_mul_f32 v78, v38, v157
    v_cvt_pk_bf16_f32 v78, 0, v78
    v_mul_f32 v79, v39, v157
    v_cvt_pk_bf16_f32 v79, 0, v79
    v_mul_f32 v80, v40, v154
    v_cvt_pk_bf16_f32 v80, 0, v80
    v_mul_f32 v81, v41, v154
    v_cvt_pk_bf16_f32 v81, 0, v81
    v_mul_f32 v82, v42, v154
    v_cvt_pk_bf16_f32 v82, 0, v82
    v_mul_f32 v83, v43, v154
    v_cvt_pk_bf16_f32 v83, 0, v83
    v_mul_f32 v84, v44, v155
    v_cvt_pk_bf16_f32 v84, 0, v84
    v_mul_f32 v85, v45, v155
    v_cvt_pk_bf16_f32 v85, 0, v85
    v_mul_f32 v86, v46, v155
    v_cvt_pk_bf16_f32 v86, 0, v86
    v_mul_f32 v87, v47, v155
    v_cvt_pk_bf16_f32 v87, 0, v87
    v_mul_f32 v88, v48, v156
    v_cvt_pk_bf16_f32 v88, 0, v88
    v_mul_f32 v89, v49, v156
    v_cvt_pk_bf16_f32 v89, 0, v89
    v_mul_f32 v90, v50, v156
    v_cvt_pk_bf16_f32 v90, 0, v90
    v_mul_f32 v91, v51, v156
    v_cvt_pk_bf16_f32 v91, 0, v91
    v_mul_f32 v92, v52, v157
    v_cvt_pk_bf16_f32 v92, 0, v92
    v_mul_f32 v93, v53, v157
    v_cvt_pk_bf16_f32 v93, 0, v93
    v_mul_f32 v94, v54, v157
    v_cvt_pk_bf16_f32 v94, 0, v94
    v_mul_f32 v95, v55, v157
    v_cvt_pk_bf16_f32 v95, 0, v95
    s_cmp_ge_u32 s7, 2
    s_cbranch_scc1 E_GATES
E_T0:
    s_mov_b32 s12, 0
SPN11:
    ds_read_b32 v60, v58 offset:0
    s_add_u32 s12, s12, 1
    s_waitcnt lgkmcnt(0)
    v_cmp_eq_u32 vcc, 0, v60
    s_cmp_ge_u32 s12, 0x40000
    s_cbranch_scc1 SPX11
    s_cbranch_vccz SPX11
    s_sleep 1
    s_branch SPN11
SPX11:
    ds_read_b32 v63, v146 offset:16
    ds_read_b128 v[96:99], v56 offset:0
    ds_read_b128 v[112:115], v56 offset:10240
    ds_read_b128 v[100:103], v56 offset:20480
    ds_read_b128 v[116:119], v56 offset:30720
    ds_read_b128 v[104:107], v136 offset:0
    ds_read_b128 v[120:123], v136 offset:10240
    ds_read_b128 v[108:111], v136 offset:20480
    ds_read_b128 v[124:127], v136 offset:30720
    s_waitcnt lgkmcnt(8)
    v_add_u32 v62, v62, v63
    v_sub_u32 v62, 381, v62
    v_max_i32 v62, 0, v62
    v_min_i32 v62, 254, v62
    v_lshlrev_b32 v62, 23, v62
    s_nop 1
    v_mov_b32_dpp v150, v62 quad_perm:[0,0,0,0] row_mask:0xf bank_mask:0xf
    v_mov_b32_dpp v151, v62 quad_perm:[1,1,1,1] row_mask:0xf bank_mask:0xf
    v_mov_b32_dpp v152, v62 quad_perm:[2,2,2,2] row_mask:0xf bank_mask:0xf
    v_mov_b32_dpp v153, v62 quad_perm:[3,3,3,3] row_mask:0xf bank_mask:0xf
    s_waitcnt lgkmcnt(6)
    v_add_f32 v96, v96, v112
    v_cvt_pk_bf16_f32 v96, 0, v96
    v_fma_f32 v96, v96, v150, v64
    v_cvt_pk_bf16_f32 v96, 0, v96
    v_add_f32 v97, v97, v113
    v_cvt_pk_bf16_f32 v97, 0, v97
    v_fma_f32 v97, v97, v150, v65
    v_cvt_pk_bf16_f32 v97, 0, v97
    v_add_f32 v98, v98, v114
    v_cvt_pk_bf16_f32 v98, 0, v98
    v_fma_f32 v98, v98, v150, v66
    v_cvt_pk_bf16_f32 v98, 0, v98
    v_add_f32 v99, v99, v115
    v_cvt_pk_bf16_f32 v99, 0, v99
    v_fma_f32 v99, v99, v150, v67
    v_cvt_pk_bf16_f32 v99, 0, v99
    s_waitcnt lgkmcnt(4)
    v_add_f32 v100, v100, v116
    v_cvt_pk_bf16_f32 v100, 0, v100
    v_fma_f32 v100, v100, v151, v68
    v_cvt_pk_bf16_f32 v100, 0, v100
    v_add_f32 v101, v101, v117
    v_cvt_pk_bf16_f32 v101, 0, v101
    v_fma_f32 v101, v101, v151, v69
    v_cvt_pk_bf16_f32 v101, 0, v101
    v_add_f32 v102, v102, v118
    v_cvt_pk_bf16_f32 v102, 0, v102
    v_fma_f32 v102, v102, v151, v70
    v_cvt_pk_bf16_f32 v102, 0, v102
    v_add_f32 v103, v103, v119
    v_cvt_pk_bf16_f32 v103, 0, v103
    v_fma_f32 v103, v103, v151, v71
    v_cvt_pk_bf16_f32 v103, 0, v103
    s_waitcnt lgkmcnt(2)
    v_add_f32 v104, v104, v120
    v_cvt_pk_bf16_f32 v104, 0, v104
    v_fma_f32 v104, v104, v152, v72
    v_cvt_pk_bf16_f32 v104, 0, v104
    v_add_f32 v105, v105, v121
    v_cvt_pk_bf16_f32 v105, 0, v105
    v_fma_f32 v105, v105, v152, v73
    v_cvt_pk_bf16_f32 v105, 0, v105
    v_add_f32 v106, v106, v122
    v_cvt_pk_bf16_f32 v106, 0, v106
    v_fma_f32 v106, v106, v152, v74
    v_cvt_pk_bf16_f32 v106, 0, v106
    v_add_f32 v107, v107, v123
    v_cvt_pk_bf16_f32 v107, 0, v107
    v_fma_f32 v107, v107, v152, v75
    v_cvt_pk_bf16_f32 v107, 0, v107
    s_waitcnt lgkmcnt(0)
    v_add_f32 v108, v108, v124
    v_cvt_pk_bf16_f32 v108, 0, v108
    v_fma_f32 v108, v108, v153, v76
    v_cvt_pk_bf16_f32 v108, 0, v108
    v_add_f32 v109, v109, v125
    v_cvt_pk_bf16_f32 v109, 0, v109
    v_fma_f32 v109, v109, v153, v77
    v_cvt_pk_bf16_f32 v109, 0, v109
    v_add_f32 v110, v110, v126
    v_cvt_pk_bf16_f32 v110, 0, v110
    v_fma_f32 v110, v110, v153, v78
    v_cvt_pk_bf16_f32 v110, 0, v110
    v_add_f32 v111, v111, v127
    v_cvt_pk_bf16_f32 v111, 0, v111
    v_fma_f32 v111, v111, v153, v79
    v_cvt_pk_bf16_f32 v111, 0, v111
    s_cmp_ge_u32 s7, 2
    s_cbranch_scc1 E_OUT0
E_GATES:
    s_cmp_lt_u32 s7, 2
    s_cbranch_scc1 E_G1
    s_mov_b32 s12, 0
SPN12:
    ds_read_b32 v60, v57 offset:116
    s_add_u32 s12, s12, 1
    s_waitcnt lgkmcnt(0)
    v_cmp_ne_u32 vcc, 2, v60
    s_cmp_ge_u32 s12, 0x40000
    s_cbranch_scc1 SPX12
    s_cbranch_vccz SPX12
    s_sleep 1
    s_branch SPN12
SPX12:
    ds_read_b128 v[128:131], v147
    ds_read_b128 v[132:135], v147 offset:2048
    s_waitcnt lgkmcnt(0)
    s_branch E_GX
E_G1:
    s_mov_b32 s12, 0
    s_waitcnt vmcnt(2)
    s_branch E_GCHK
E_GPOLL:
    global_load_dwordx2 v[144:145], v59, s[48:49] sc1
    global_load_dwordx4 v[128:131], v7, s[50:51] offset:-4096 sc1
    global_load_dwordx4 v[132:135], v7, s[50:51] sc1
    global_load_dwordx4 v[160:163], v137, s[50:51] offset:-4096 sc1
    global_load_dwordx4 v[164:167], v138, s[50:51] sc1
    s_add_u32 s12, s12, 1
    s_waitcnt vmcnt(0)
E_GCHK:
    v_xor_b32 v61, 1, v145
    v_bitop3_b32 v61, v61, v128, v144 bitop3:0xf6
    v_bitop3_b32 v61, v61, v129, v144 bitop3:0xf6
    v_bitop3_b32 v61, v61, v130, v144 bitop3:0xf6
    v_bitop3_b32 v61, v61, v131, v144 bitop3:0xf6
    v_bitop3_b32 v61, v61, v132, v144 bitop3:0xf6
    v_bitop3_b32 v61, v61, v133, v144 bitop3:0xf6
    v_bitop3_b32 v61, v61, v134, v144 bitop3:0xf6
    v_bitop3_b32 v61, v61, v135, v144 bitop3:0xf6
    v_bitop3_b32 v61, v61, v160, v144 bitop3:0xf6
    v_bitop3_b32 v61, v61, v161, v144 bitop3:0xf6
    v_bitop3_b32 v61, v61, v162, v144 bitop3:0xf6
    v_bitop3_b32 v61, v61, v163, v144 bitop3:0xf6
    v_bitop3_b32 v61, v61, v164, v144 bitop3:0xf6
    v_bitop3_b32 v61, v61, v165, v144 bitop3:0xf6
    v_bitop3_b32 v61, v61, v166, v144 bitop3:0xf6
    v_bitop3_b32 v61, v61, v167, v144 bitop3:0xf6
    v_and_b32 v61, 0xffff, v61
    v_cmp_ne_u32 vcc, 0, v61
    s_cmp_ge_u32 s12, 16384
    s_cbranch_scc1 E_GOK
    s_cbranch_vccnz E_GPOLL
E_GOK:
    ds_write_b128 v147, v[160:163] offset:4096
    ds_write_b128 v147, v[164:167] offset:6144
    ds_write_b128 v147, v[128:131] offset:0
    ds_write_b128 v147, v[132:135] offset:2048
    ds_write_b32 v57, v144 offset:120
    s_mov_b64 exec, 1
    ds_add_u32 v57, v139 offset:116
    s_mov_b64 exec, -1
E_GX:
    ds_write_b128 v148, v[8:11] offset:0
    ds_write_b128 v148, v[12:15] offset:16
    ds_write_b128 v148, v[16:19] offset:4096
    ds_write_b128 v148, v[20:23] offset:4112
    s_mov_b64 exec, 1
    ds_add_u32 v57, v139 offset:112
    s_mov_b64 exec, -1
    v_and_b32 v128, 0xffff0000, v128
    v_sub_f32 v140, 1.0, v128
    v_cvt_pk_bf16_f32 v140, 0, v140
    v_and_b32 v129, 0xffff0000, v129
    v_sub_f32 v141, 1.0, v129
    v_cvt_pk_bf16_f32 v141, 0, v141
    v_and_b32 v130, 0xffff0000, v130
    v_sub_f32 v142, 1.0, v130
    v_cvt_pk_bf16_f32 v142, 0, v142
    v_and_b32 v131, 0xffff0000, v131
    v_sub_f32 v143, 1.0, v131
    v_cvt_pk_bf16_f32 v143, 0, v143
    v_mul_f32 v24, v24, v140
    v_cvt_pk_bf16_f32 v24, 0, v24
    v_mul_f32 v25, v25, v141
    v_cvt_pk_bf16_f32 v25, 0, v25
    v_mul_f32 v26, v26, v142
    v_cvt_pk_bf16_f32 v26, 0, v26
    v_mul_f32 v27, v27, v143
    v_cvt_pk_bf16_f32 v27, 0, v27
    v_mul_f32 v28, v28, v140
    v_cvt_pk_bf16_f32 v28, 0, v28
    v_mul_f32 v29, v29, v141
    v_cvt_pk_bf16_f32 v29, 0, v29
    v_mul_f32 v30, v30, v142
    v_cvt_pk_bf16_f32 v30, 0, v30
    v_mul_f32 v31, v31, v143
    v_cvt_pk_bf16_f32 v31, 0, v31
    v_mul_f32 v32, v32, v140
    v_cvt_pk_bf16_f32 v32, 0, v32
    v_mul_f32 v33, v33, v141
    v_cvt_pk_bf16_f32 v33, 0, v33
    v_mul_f32 v34, v34, v142
    v_cvt_pk_bf16_f32 v34, 0, v34
    v_mul_f32 v35, v35, v143
    v_cvt_pk_bf16_f32 v35, 0, v35
    v_mul_f32 v36, v36, v140
    v_cvt_pk_bf16_f32 v36, 0, v36
    v_mul_f32 v37, v37, v141
    v_cvt_pk_bf16_f32 v37, 0, v37
    v_mul_f32 v38, v38, v142
    v_cvt_pk_bf16_f32 v38, 0, v38
    v_mul_f32 v39, v39, v143
    v_cvt_pk_bf16_f32 v39, 0, v39
    s_cmp_ge_u32 s7, 2
    s_cbranch_scc1 E_T0
E_OUT0:
    v_mul_f32 v96, v96, v128
    v_cvt_pk_bf16_f32 v96, 0, v96
    v_add_f32 v96, v96, v24
    v_mul_f32 v100, v100, v128
    v_cvt_pk_bf16_f32 v100, 0, v100
    v_add_f32 v100, v100, v28
    v_mul_f32 v104, v104, v128
    v_cvt_pk_bf16_f32 v104, 0, v104
    v_add_f32 v104, v104, v32
    v_mul_f32 v108, v108, v128
    v_cvt_pk_bf16_f32 v108, 0, v108
    v_add_f32 v108, v108, v36
    v_cvt_pk_bf16_f32 v112, v96, v100
    v_cvt_pk_bf16_f32 v113, v104, v108
    global_store_dwordx2 v5, v[112:113], s[46:47] offset:0
    v_mul_f32 v97, v97, v129
    v_cvt_pk_bf16_f32 v97, 0, v97
    v_add_f32 v97, v97, v25
    v_mul_f32 v101, v101, v129
    v_cvt_pk_bf16_f32 v101, 0, v101
    v_add_f32 v101, v101, v29
    v_mul_f32 v105, v105, v129
    v_cvt_pk_bf16_f32 v105, 0, v105
    v_add_f32 v105, v105, v33
    v_mul_f32 v109, v109, v129
    v_cvt_pk_bf16_f32 v109, 0, v109
    v_add_f32 v109, v109, v37
    v_cvt_pk_bf16_f32 v114, v97, v101
    v_cvt_pk_bf16_f32 v115, v105, v109
    global_store_dwordx2 v5, v[114:115], s[46:47] offset:1152
    v_mul_f32 v98, v98, v130
    v_cvt_pk_bf16_f32 v98, 0, v98
    v_add_f32 v98, v98, v26
    v_mul_f32 v102, v102, v130
    v_cvt_pk_bf16_f32 v102, 0, v102
    v_add_f32 v102, v102, v30
    v_mul_f32 v106, v106, v130
    v_cvt_pk_bf16_f32 v106, 0, v106
    v_add_f32 v106, v106, v34
    v_mul_f32 v110, v110, v130
    v_cvt_pk_bf16_f32 v110, 0, v110
    v_add_f32 v110, v110, v38
    v_cvt_pk_bf16_f32 v116, v98, v102
    v_cvt_pk_bf16_f32 v117, v106, v110
    global_store_dwordx2 v5, v[116:117], s[46:47] offset:2304
    v_mul_f32 v99, v99, v131
    v_cvt_pk_bf16_f32 v99, 0, v99
    v_add_f32 v99, v99, v27
    v_mul_f32 v103, v103, v131
    v_cvt_pk_bf16_f32 v103, 0, v103
    v_add_f32 v103, v103, v31
    v_mul_f32 v107, v107, v131
    v_cvt_pk_bf16_f32 v107, 0, v107
    v_add_f32 v107, v107, v35
    v_mul_f32 v111, v111, v131
    v_cvt_pk_bf16_f32 v111, 0, v111
    v_add_f32 v111, v111, v39
    v_cvt_pk_bf16_f32 v118, v99, v103
    v_cvt_pk_bf16_f32 v119, v107, v111
    global_store_dwordx2 v5, v[118:119], s[46:47] offset:3456
    v_and_b32 v132, 0xffff0000, v132
    v_sub_f32 v140, 1.0, v132
    v_cvt_pk_bf16_f32 v140, 0, v140
    v_and_b32 v133, 0xffff0000, v133
    v_sub_f32 v141, 1.0, v133
    v_cvt_pk_bf16_f32 v141, 0, v141
    v_and_b32 v134, 0xffff0000, v134
    v_sub_f32 v142, 1.0, v134
    v_cvt_pk_bf16_f32 v142, 0, v142
    v_and_b32 v135, 0xffff0000, v135
    v_sub_f32 v143, 1.0, v135
    v_cvt_pk_bf16_f32 v143, 0, v143
    v_mul_f32 v40, v40, v140
    v_cvt_pk_bf16_f32 v40, 0, v40
    v_mul_f32 v41, v41, v141
    v_cvt_pk_bf16_f32 v41, 0, v41
    v_mul_f32 v42, v42, v142
    v_cvt_pk_bf16_f32 v42, 0, v42
    v_mul_f32 v43, v43, v143
    v_cvt_pk_bf16_f32 v43, 0, v43
    v_mul_f32 v44, v44, v140
    v_cvt_pk_bf16_f32 v44, 0, v44
    v_mul_f32 v45, v45, v141
    v_cvt_pk_bf16_f32 v45, 0, v45
    v_mul_f32 v46, v46, v142
    v_cvt_pk_bf16_f32 v46, 0, v46
    v_mul_f32 v47, v47, v143
    v_cvt_pk_bf16_f32 v47, 0, v47
    v_mul_f32 v48, v48, v140
    v_cvt_pk_bf16_f32 v48, 0, v48
    v_mul_f32 v49, v49, v141
    v_cvt_pk_bf16_f32 v49, 0, v49
    v_mul_f32 v50, v50, v142
    v_cvt_pk_bf16_f32 v50, 0, v50
    v_mul_f32 v51, v51, v143
    v_cvt_pk_bf16_f32 v51, 0, v51
    v_mul_f32 v52, v52, v140
    v_cvt_pk_bf16_f32 v52, 0, v52
    v_mul_f32 v53, v53, v141
    v_cvt_pk_bf16_f32 v53, 0, v53
    v_mul_f32 v54, v54, v142
    v_cvt_pk_bf16_f32 v54, 0, v54
    v_mul_f32 v55, v55, v143
    v_cvt_pk_bf16_f32 v55, 0, v55
    s_mov_b32 s12, 0
SPN13:
    ds_read_b32 v60, v58 offset:64
    s_add_u32 s12, s12, 1
    s_waitcnt lgkmcnt(0)
    v_cmp_eq_u32 vcc, 0, v60
    s_cmp_ge_u32 s12, 0x40000
    s_cbranch_scc1 SPX13
    s_cbranch_vccz SPX13
    s_sleep 1
    s_branch SPN13
SPX13:
    ds_read_b128 v[96:99], v56 offset:2560
    ds_read_b128 v[112:115], v56 offset:12800
    ds_read_b128 v[100:103], v56 offset:23040
    ds_read_b128 v[116:119], v56 offset:33280
    ds_read_b128 v[104:107], v136 offset:2560
    ds_read_b128 v[120:123], v136 offset:12800
    ds_read_b128 v[108:111], v136 offset:23040
    ds_read_b128 v[124:127], v136 offset:33280
    s_waitcnt lgkmcnt(6)
    v_add_f32 v96, v96, v112
    v_cvt_pk_bf16_f32 v96, 0, v96
    v_fma_f32 v96, v96, v150, v80
    v_cvt_pk_bf16_f32 v96, 0, v96
    v_add_f32 v97, v97, v113
    v_cvt_pk_bf16_f32 v97, 0, v97
    v_fma_f32 v97, v97, v150, v81
    v_cvt_pk_bf16_f32 v97, 0, v97
    v_add_f32 v98, v98, v114
    v_cvt_pk_bf16_f32 v98, 0, v98
    v_fma_f32 v98, v98, v150, v82
    v_cvt_pk_bf16_f32 v98, 0, v98
    v_add_f32 v99, v99, v115
    v_cvt_pk_bf16_f32 v99, 0, v99
    v_fma_f32 v99, v99, v150, v83
    v_cvt_pk_bf16_f32 v99, 0, v99
    s_waitcnt lgkmcnt(4)
    v_add_f32 v100, v100, v116
    v_cvt_pk_bf16_f32 v100, 0, v100
    v_fma_f32 v100, v100, v151, v84
    v_cvt_pk_bf16_f32 v100, 0, v100
    v_add_f32 v101, v101, v117
    v_cvt_pk_bf16_f32 v101, 0, v101
    v_fma_f32 v101, v101, v151, v85
    v_cvt_pk_bf16_f32 v101, 0, v101
    v_add_f32 v102, v102, v118
    v_cvt_pk_bf16_f32 v102, 0, v102
    v_fma_f32 v102, v102, v151, v86
    v_cvt_pk_bf16_f32 v102, 0, v102
    v_add_f32 v103, v103, v119
    v_cvt_pk_bf16_f32 v103, 0, v103
    v_fma_f32 v103, v103, v151, v87
    v_cvt_pk_bf16_f32 v103, 0, v103
    s_waitcnt lgkmcnt(2)
    v_add_f32 v104, v104, v120
    v_cvt_pk_bf16_f32 v104, 0, v104
    v_fma_f32 v104, v104, v152, v88
    v_cvt_pk_bf16_f32 v104, 0, v104
    v_add_f32 v105, v105, v121
    v_cvt_pk_bf16_f32 v105, 0, v105
    v_fma_f32 v105, v105, v152, v89
    v_cvt_pk_bf16_f32 v105, 0, v105
    v_add_f32 v106, v106, v122
    v_cvt_pk_bf16_f32 v106, 0, v106
    v_fma_f32 v106, v106, v152, v90
    v_cvt_pk_bf16_f32 v106, 0, v106
    v_add_f32 v107, v107, v123
    v_cvt_pk_bf16_f32 v107, 0, v107
    v_fma_f32 v107, v107, v152, v91
    v_cvt_pk_bf16_f32 v107, 0, v107
    s_waitcnt lgkmcnt(0)
    v_add_f32 v108, v108, v124
    v_cvt_pk_bf16_f32 v108, 0, v108
    v_fma_f32 v108, v108, v153, v92
    v_cvt_pk_bf16_f32 v108, 0, v108
    v_add_f32 v109, v109, v125
    v_cvt_pk_bf16_f32 v109, 0, v109
    v_fma_f32 v109, v109, v153, v93
    v_cvt_pk_bf16_f32 v109, 0, v109
    v_add_f32 v110, v110, v126
    v_cvt_pk_bf16_f32 v110, 0, v110
    v_fma_f32 v110, v110, v153, v94
    v_cvt_pk_bf16_f32 v110, 0, v110
    v_add_f32 v111, v111, v127
    v_cvt_pk_bf16_f32 v111, 0, v111
    v_fma_f32 v111, v111, v153, v95
    v_cvt_pk_bf16_f32 v111, 0, v111
    v_mul_f32 v96, v96, v132
    v_cvt_pk_bf16_f32 v96, 0, v96
    v_add_f32 v96, v96, v40
    v_mul_f32 v100, v100, v132
    v_cvt_pk_bf16_f32 v100, 0, v100
    v_add_f32 v100, v100, v44
    v_mul_f32 v104, v104, v132
    v_cvt_pk_bf16_f32 v104, 0, v104
    v_add_f32 v104, v104, v48
    v_mul_f32 v108, v108, v132
    v_cvt_pk_bf16_f32 v108, 0, v108
    v_add_f32 v108, v108, v52
    v_cvt_pk_bf16_f32 v112, v96, v100
    v_cvt_pk_bf16_f32 v113, v104, v108
    global_store_dwordx2 v6, v[112:113], s[46:47] offset:0
    v_mul_f32 v97, v97, v133
    v_cvt_pk_bf16_f32 v97, 0, v97
    v_add_f32 v97, v97, v41
    v_mul_f32 v101, v101, v133
    v_cvt_pk_bf16_f32 v101, 0, v101
    v_add_f32 v101, v101, v45
    v_mul_f32 v105, v105, v133
    v_cvt_pk_bf16_f32 v105, 0, v105
    v_add_f32 v105, v105, v49
    v_mul_f32 v109, v109, v133
    v_cvt_pk_bf16_f32 v109, 0, v109
    v_add_f32 v109, v109, v53
    v_cvt_pk_bf16_f32 v114, v97, v101
    v_cvt_pk_bf16_f32 v115, v105, v109
    global_store_dwordx2 v6, v[114:115], s[46:47] offset:1152
    v_mul_f32 v98, v98, v134
    v_cvt_pk_bf16_f32 v98, 0, v98
    v_add_f32 v98, v98, v42
    v_mul_f32 v102, v102, v134
    v_cvt_pk_bf16_f32 v102, 0, v102
    v_add_f32 v102, v102, v46
    v_mul_f32 v106, v106, v134
    v_cvt_pk_bf16_f32 v106, 0, v106
    v_add_f32 v106, v106, v50
    v_mul_f32 v110, v110, v134
    v_cvt_pk_bf16_f32 v110, 0, v110
    v_add_f32 v110, v110, v54
    v_cvt_pk_bf16_f32 v116, v98, v102
    v_cvt_pk_bf16_f32 v117, v106, v110
    global_store_dwordx2 v6, v[116:117], s[46:47] offset:2304
    v_mul_f32 v99, v99, v135
    v_cvt_pk_bf16_f32 v99, 0, v99
    v_add_f32 v99, v99, v43
    v_mul_f32 v103, v103, v135
    v_cvt_pk_bf16_f32 v103, 0, v103
    v_add_f32 v103, v103, v47
    v_mul_f32 v107, v107, v135
    v_cvt_pk_bf16_f32 v107, 0, v107
    v_add_f32 v107, v107, v51
    v_mul_f32 v111, v111, v135
    v_cvt_pk_bf16_f32 v111, 0, v111
    v_add_f32 v111, v111, v55
    v_cvt_pk_bf16_f32 v118, v99, v103
    v_cvt_pk_bf16_f32 v119, v107, v111
    global_store_dwordx2 v6, v[118:119], s[46:47] offset:3456
    s_waitcnt vmcnt(0)
    s_endpgm
FINAL:
    v_and_b32 v5, 7, v2
    v_lshlrev_b32 v5, 2, v5
    s_lshl_b32 s10, s6, 3
    s_load_dwordx2 s[52:53], s[32:33], s10
    s_mov_b32 s12, 0
SPN14:
    ds_read_b32 v42, v167 offset:112
    s_add_u32 s12, s12, 1
    s_waitcnt lgkmcnt(0)
    v_cmp_ne_u32 vcc, 4, v42
    s_cmp_ge_u32 s12, 0x40000
    s_cbranch_scc1 SPX14
    s_cbranch_vccz SPX14
    s_sleep 1
    s_branch SPN14
SPX14:
    ds_read_b32 v42, v167 offset:120
    s_waitcnt lgkmcnt(0)
    v_and_b32 v6, 7, v2
    s_lshl_b32 s9, s4, 8
    v_lshl_add_u32 v6, v6, 3, s9
    s_mov_b32 s12, 0
    s_waitcnt vmcnt(0)
    v_mov_b32 v8, v124
    v_mov_b32 v9, v125
    s_branch SPC_F
SP_F:
    s_add_u32 s12, s12, 1
    s_and_b32 s9, s12, 7
    s_cselect_b32 s9, 0, 128
    v_add_u32 v10, s9, v6
    global_load_dwordx2 v[8:9], v10, s[50:51] offset:256 sc1
    s_waitcnt vmcnt(0)
SPC_F:
    v_cmp_ne_u32 vcc, v9, v42
    s_cmp_ge_u32 s12, 16384
    s_cbranch_scc1 SPX_F
    s_cbranch_vccz SPX_F
    s_mov_b64 exec, vcc
    s_sleep 2
    s_branch SP_F
SPX_F:
    s_mov_b64 exec, -1
    v_and_b32 v9, 0xff, v42
    v_not_b32 v10, v8
    v_and_b32 v10, 0x7ff, v10
    v_mul_u32_u24 v11, 1152, v10
    v_add_u32 v11, s10, v11
    v_lshlrev_b32 v14, 3, v10
    v_add_u32 v14, 81920, v14
    ds_read_b64 v[12:13], v14
    v_lshlrev_b32 v14, 2, v10
    v_add_u32 v14, 98304, v14
    ds_read_b32 v15, v14
    v_lshrrev_b32 v16, 8, v10
    v_mul_u32_u24 v16, 1280, v16
    v_and_b32 v17, 0xf0, v10
    v_add_u32 v16, v16, v17
    v_bfe_u32 v17, v10, 2, 2
    v_mul_u32_u24 v17, 320, v17
    v_add_u32 v16, v16, v17
    v_and_b32 v17, 3, v10
    v_lshl_add_u32 v16, v17, 2, v16
    v_add_u32 v17, 40960, v16
    v_add_u32 v18, 156128, v5
    v_mov_b32 v19, 155648
    ds_read_b128 v[44:47], v19 offset:16
    v_lshrrev_b32 v36, 10, v10
    v_mul_u32_u24 v36, 80, v36
    v_add_u32 v19, v19, v36
    ds_read_b128 v[36:39], v19
    v_and_b32 v20, 0xffff0000, v8
    v_not_b32 v21, v20
    v_ashrrev_i32 v21, 31, v21
    v_and_b32 v21, 0x7fff0000, v21
    v_or_b32 v21, 0x80000000, v21
    v_xor_b32 v20, v20, v21
    v_mul_f32 v21, 0xbfb8aa3b, v20
    v_exp_f32 v21, v21
    s_nop 0
    v_add_f32 v21, 1.0, v21
    v_rcp_f32 v21, v21
    s_nop 0
    v_cvt_pk_bf16_f32 v20, v21, v21
    v_and_b32 v20, 0xffff0000, v20
    s_waitcnt lgkmcnt(0)
    v_and_b32 v15, 0xffff0000, v15
    v_sub_f32 v21, 1.0, v15
    v_cvt_pk_bf16_f32 v21, v21, v21
    v_and_b32 v21, 0xffff0000, v21
    v_lshlrev_b32 v24, 16, v12
    v_and_b32 v25, 0xffff0000, v12
    v_lshlrev_b32 v26, 16, v13
    v_and_b32 v27, 0xffff0000, v13
    s_waitcnt lgkmcnt(0)
    v_lshrrev_b32 v36, 23, v36
    v_sub_u32 v36, 265, v36
    v_min_i32 v36, 253, v36
    v_add_u32 v36, v36, v44
    v_sub_u32 v36, 381, v36
    v_max_i32 v36, 0, v36
    v_min_i32 v36, 254, v36
    v_lshlrev_b32 v36, 23, v36
    v_lshrrev_b32 v37, 23, v37
    v_sub_u32 v37, 265, v37
    v_min_i32 v37, 253, v37
    v_add_u32 v37, v37, v45
    v_sub_u32 v37, 381, v37
    v_max_i32 v37, 0, v37
    v_min_i32 v37, 254, v37
    v_lshlrev_b32 v37, 23, v37
    v_lshrrev_b32 v38, 23, v38
    v_sub_u32 v38, 265, v38
    v_min_i32 v38, 253, v38
    v_add_u32 v38, v38, v46
    v_sub_u32 v38, 381, v38
    v_max_i32 v38, 0, v38
    v_min_i32 v38, 254, v38
    v_lshlrev_b32 v38, 23, v38
    v_lshrrev_b32 v39, 23, v39
    v_sub_u32 v39, 265, v39
    v_min_i32 v39, 253, v39
    v_add_u32 v39, v39, v47
    v_sub_u32 v39, 381, v39
    v_max_i32 v39, 0, v39
    v_min_i32 v39, 254, v39
    v_lshlrev_b32 v39, 23, v39
    s_mov_b32 s12, 0
FN_WAIT:
    ds_read_b32 v22, v18
    s_add_u32 s12, s12, 1
    s_waitcnt lgkmcnt(0)
    v_cmp_eq_u32 vcc, 0, v22
    s_cmp_ge_u32 s12, 0x40000
    s_cbranch_scc1 FN_RDY
    s_cbranch_vccz FN_RDY
    s_sleep 1
    s_branch FN_WAIT
FN_RDY:
    ds_read_b32 v28, v16 offset:0
    ds_read_b32 v32, v16 offset:10240
    ds_read_b32 v29, v16 offset:20480
    ds_read_b32 v33, v16 offset:30720
    ds_read_b32 v30, v17 offset:0
    ds_read_b32 v34, v17 offset:10240
    ds_read_b32 v31, v17 offset:20480
    ds_read_b32 v35, v17 offset:30720
    s_lshl_b32 s60, s52, 16
    s_and_b32 s61, s52, 0xffff0000
    s_lshl_b32 s62, s53, 16
    s_and_b32 s63, s53, 0xffff0000
    s_mul_i32 s8, s6, 9216
    s_add_u32 s8, s8, 45056
    v_lshl_add_u32 v22, v2, 4, s8
    v_add_u32 v23, 4096, v22
    s_waitcnt lgkmcnt(0)
    v_add_f32 v28, v28, v32
    v_mul_f32 v28, v28, v36
    v_mul_f32 v32, s60, v24
    v_add_f32 v29, v29, v33
    v_mul_f32 v29, v29, v37
    v_mul_f32 v33, s61, v25
    v_add_f32 v30, v30, v34
    v_mul_f32 v30, v30, v38
    v_mul_f32 v34, s62, v26
    v_add_f32 v31, v31, v35
    v_mul_f32 v31, v31, v39
    v_mul_f32 v35, s63, v27
    v_cvt_pk_bf16_f32 v28, 0, v28
    v_cvt_pk_bf16_f32 v29, 0, v29
    v_cvt_pk_bf16_f32 v30, 0, v30
    v_cvt_pk_bf16_f32 v31, 0, v31
    v_cvt_pk_bf16_f32 v32, 0, v32
    v_cvt_pk_bf16_f32 v33, 0, v33
    v_cvt_pk_bf16_f32 v34, 0, v34
    v_cvt_pk_bf16_f32 v35, 0, v35
    v_add_f32 v28, v28, v32
    v_add_f32 v29, v29, v33
    v_add_f32 v30, v30, v34
    v_add_f32 v31, v31, v35
    v_cvt_pk_bf16_f32 v28, 0, v28
    v_cvt_pk_bf16_f32 v29, 0, v29
    v_cvt_pk_bf16_f32 v30, 0, v30
    v_cvt_pk_bf16_f32 v31, 0, v31
    v_mul_f32 v28, v28, v15
    v_mul_f32 v29, v29, v15
    v_mul_f32 v30, v30, v15
    v_mul_f32 v31, v31, v15
    v_cvt_pk_bf16_f32 v28, 0, v28
    v_cvt_pk_bf16_f32 v29, 0, v29
    v_cvt_pk_bf16_f32 v30, 0, v30
    v_cvt_pk_bf16_f32 v31, 0, v31
    v_and_b32 v33, 7, v2
    v_mul_u32_u24 v33, 1152, v33
    s_mul_i32 s11, s101, 29
    s_lshr_b32 s11, s11, 6
    s_lshl_b32 s11, s11, 7
    s_add_u32 s11, s11, s8
    v_add_u32 v33, s11, v33
    s_mov_b32 s12, 0
FN_R:
    global_load_dword v34, v33, s[50:51] offset:-4096 sc1
    s_add_u32 s12, s12, 1
    s_waitcnt vmcnt(0)
    v_xor_b32 v34, v34, v9
    v_and_b32 v34, 0xff, v34
    v_cmp_ne_u32 vcc, 0, v34
    s_cmp_ge_u32 s12, 16384
    s_cbranch_scc1 FN_RX
    s_cbranch_vccz FN_RX
    s_mov_b64 exec, vcc
    s_sleep 2
    s_branch FN_R
FN_RX:
    s_mov_b64 exec, -1
    s_mov_b32 s12, 0
FN_P:
    global_load_dwordx4 v[48:51], v22, s[50:51] offset:-4096 sc1
    global_load_dwordx4 v[52:55], v22, s[50:51] offset:-3072 sc1
    global_load_dwordx4 v[56:59], v22, s[50:51] offset:-2048 sc1
    global_load_dwordx4 v[60:63], v22, s[50:51] offset:-1024 sc1
    global_load_dwordx4 v[64:67], v22, s[50:51] offset:0 sc1
    global_load_dwordx4 v[68:71], v22, s[50:51] offset:1024 sc1
    global_load_dwordx4 v[72:75], v22, s[50:51] offset:2048 sc1
    global_load_dwordx4 v[76:79], v22, s[50:51] offset:3072 sc1
    global_load_dwordx4 v[80:83], v23, s[50:51] offset:0 sc1
    s_add_u32 s12, s12, 1
    s_waitcnt vmcnt(8)
    v_xor_b32 v48, v48, v9
    v_xor_b32 v49, v49, v9
    v_xor_b32 v50, v50, v9
    v_xor_b32 v51, v51, v9
    v_or3_b32 v32, 0, v48, v49
    v_or3_b32 v32, v32, v50, v51
    s_waitcnt vmcnt(7)
    v_xor_b32 v52, v52, v9
    v_xor_b32 v53, v53, v9
    v_xor_b32 v54, v54, v9
    v_xor_b32 v55, v55, v9
    v_or3_b32 v32, v32, v52, v53
    v_or3_b32 v32, v32, v54, v55
    v_pk_add_f32 v[48:49], v[48:49], v[52:53]
    v_pk_add_f32 v[50:51], v[50:51], v[54:55]
    s_waitcnt vmcnt(6)
    v_xor_b32 v56, v56, v9
    v_xor_b32 v57, v57, v9
    v_xor_b32 v58, v58, v9
    v_xor_b32 v59, v59, v9
    v_or3_b32 v32, v32, v56, v57
    v_or3_b32 v32, v32, v58, v59
    v_pk_add_f32 v[48:49], v[48:49], v[56:57]
    v_pk_add_f32 v[50:51], v[50:51], v[58:59]
    s_waitcnt vmcnt(5)
    v_xor_b32 v60, v60, v9
    v_xor_b32 v61, v61, v9
    v_xor_b32 v62, v62, v9
    v_xor_b32 v63, v63, v9
    v_or3_b32 v32, v32, v60, v61
    v_or3_b32 v32, v32, v62, v63
    v_pk_add_f32 v[48:49], v[48:49], v[60:61]
    v_pk_add_f32 v[50:51], v[50:51], v[62:63]
    s_waitcnt vmcnt(4)
    v_xor_b32 v64, v64, v9
    v_xor_b32 v65, v65, v9
    v_xor_b32 v66, v66, v9
    v_xor_b32 v67, v67, v9
    v_or3_b32 v32, v32, v64, v65
    v_or3_b32 v32, v32, v66, v67
    v_pk_add_f32 v[48:49], v[48:49], v[64:65]
    v_pk_add_f32 v[50:51], v[50:51], v[66:67]
    s_waitcnt vmcnt(3)
    v_xor_b32 v68, v68, v9
    v_xor_b32 v69, v69, v9
    v_xor_b32 v70, v70, v9
    v_xor_b32 v71, v71, v9
    v_or3_b32 v32, v32, v68, v69
    v_or3_b32 v32, v32, v70, v71
    v_pk_add_f32 v[48:49], v[48:49], v[68:69]
    v_pk_add_f32 v[50:51], v[50:51], v[70:71]
    s_waitcnt vmcnt(2)
    v_xor_b32 v72, v72, v9
    v_xor_b32 v73, v73, v9
    v_xor_b32 v74, v74, v9
    v_xor_b32 v75, v75, v9
    v_or3_b32 v32, v32, v72, v73
    v_or3_b32 v32, v32, v74, v75
    v_pk_add_f32 v[48:49], v[48:49], v[72:73]
    v_pk_add_f32 v[50:51], v[50:51], v[74:75]
    s_waitcnt vmcnt(1)
    v_xor_b32 v76, v76, v9
    v_xor_b32 v77, v77, v9
    v_xor_b32 v78, v78, v9
    v_xor_b32 v79, v79, v9
    v_or3_b32 v32, v32, v76, v77
    v_or3_b32 v32, v32, v78, v79
    v_pk_add_f32 v[48:49], v[48:49], v[76:77]
    v_pk_add_f32 v[50:51], v[50:51], v[78:79]
    s_waitcnt vmcnt(0)
    v_xor_b32 v80, v80, v9
    v_xor_b32 v81, v81, v9
    v_xor_b32 v82, v82, v9
    v_xor_b32 v83, v83, v9
    v_or3_b32 v32, v32, v80, v81
    v_or3_b32 v32, v32, v82, v83
    v_pk_add_f32 v[48:49], v[48:49], v[80:81]
    v_pk_add_f32 v[50:51], v[50:51], v[82:83]
    v_and_b32 v32, 0xff, v32
    v_cmp_ne_u32 vcc, 0, v32
    s_cmp_ge_u32 s12, 16384
    s_cbranch_scc1 FN_POK
    s_cbranch_vccz FN_POK
    s_mov_b64 exec, vcc
    s_sleep 2
    s_branch FN_P
FN_POK:
    s_mov_b64 exec, -1
    v_add_f32_dpp v48, v48, v48 row_ror:8 row_mask:0xf bank_mask:0xf
    v_add_f32_dpp v49, v49, v49 row_ror:8 row_mask:0xf bank_mask:0xf
    v_add_f32_dpp v50, v50, v50 row_ror:8 row_mask:0xf bank_mask:0xf
    v_add_f32_dpp v51, v51, v51 row_ror:8 row_mask:0xf bank_mask:0xf
    v_mov_b32 v52, v48
    v_mov_b32 v53, v49
    v_mov_b32 v54, v50
    v_mov_b32 v55, v51
    v_permlane16_swap_b32 v48, v52
    v_permlane16_swap_b32 v49, v53
    v_permlane16_swap_b32 v50, v54
    v_permlane16_swap_b32 v51, v55
    v_add_f32 v48, v48, v52
    v_add_f32 v49, v49, v53
    v_add_f32 v50, v50, v54
    v_add_f32 v51, v51, v55
    v_mov_b32 v52, v48
    v_mov_b32 v53, v49
    v_mov_b32 v54, v50
    v_mov_b32 v55, v51
    v_permlane32_swap_b32 v48, v52
    v_permlane32_swap_b32 v49, v53
    v_permlane32_swap_b32 v50, v54
    v_permlane32_swap_b32 v51, v55
    v_add_f32 v48, v48, v52
    v_add_f32 v49, v49, v53
    v_add_f32 v50, v50, v54
    v_add_f32 v51, v51, v55
    v_cvt_pk_bf16_f32 v48, 0, v48
    v_cvt_pk_bf16_f32 v49, 0, v49
    v_cvt_pk_bf16_f32 v50, 0, v50
    v_cvt_pk_bf16_f32 v51, 0, v51
    v_mul_f32 v48, v48, v20
    v_mul_f32 v49, v49, v20
    v_mul_f32 v50, v50, v20
    v_mul_f32 v51, v51, v20
    v_cvt_pk_bf16_f32 v48, 0, v48
    v_cvt_pk_bf16_f32 v49, 0, v49
    v_cvt_pk_bf16_f32 v50, 0, v50
    v_cvt_pk_bf16_f32 v51, 0, v51
    v_add_f32 v48, v48, v24
    v_add_f32 v49, v49, v25
    v_add_f32 v50, v50, v26
    v_add_f32 v51, v51, v27
    v_cvt_pk_bf16_f32 v48, 0, v48
    v_cvt_pk_bf16_f32 v49, 0, v49
    v_cvt_pk_bf16_f32 v50, 0, v50
    v_cvt_pk_bf16_f32 v51, 0, v51
    v_mul_f32 v48, v48, v21
    v_mul_f32 v49, v49, v21
    v_mul_f32 v50, v50, v21
    v_mul_f32 v51, v51, v21
    v_cvt_pk_bf16_f32 v48, 0, v48
    v_cvt_pk_bf16_f32 v49, 0, v49
    v_cvt_pk_bf16_f32 v50, 0, v50
    v_cvt_pk_bf16_f32 v51, 0, v51
    v_add_f32 v48, v48, v28
    v_add_f32 v49, v49, v29
    v_add_f32 v50, v50, v30
    v_add_f32 v51, v51, v31
    v_cvt_pk_bf16_f32 v40, v48, v49
    v_cvt_pk_bf16_f32 v41, v50, v51
    s_barrier
    s_mov_b64 exec, 0xff
    global_store_dwordx2 v11, v[40:41], s[46:47]
    s_endpgm
W_END:
    s_endpgm
K_END:
    s_endpgm
CODE_END:
.section .rodata,"a"
.p2align 6
.amdhsa_kernel k1_kernel
  .amdhsa_next_free_vgpr 168
  .amdhsa_next_free_sgpr 102
  .amdhsa_accum_offset 168
  .amdhsa_group_segment_fixed_size 0
  .amdhsa_kernarg_size 144
  .amdhsa_user_sgpr_count 2
  .amdhsa_user_sgpr_kernarg_segment_ptr 1
  .amdhsa_system_sgpr_workgroup_id_x 1
.end_amdhsa_kernel
```

```asm
; @launch kernel=k1_kernel grid=(256,1,1) block=(768,1,1) lds=163840
.amdgcn_target "amdgcn-amd-amdhsa--gfx950"
.text
.p2align 8
.globl k1_kernel
.type k1_kernel,@function
k1_kernel:
    s_cmp_ge_u32 s2, 256
    s_cbranch_scc1 K_END
    s_load_dwordx16 s[16:31], s[0:1], 0
    s_load_dwordx16 s[32:47], s[0:1], 64
    s_load_dwordx4 s[48:51], s[0:1], 128
    v_lshrrev_b32 v1, 6, v0
    v_and_b32 v2, 63, v0
    v_readfirstlane_b32 s3, v1
    v_and_b32 v3, 15, v2
    v_lshrrev_b32 v4, 4, v2
    s_and_b32 s4, s2, 7
    s_lshr_b32 s5, s2, 3
    s_cmp_lg_u32 s3, 0
    s_cbranch_scc1 K_NOCPF
    s_getpc_b64 s[8:9]
    s_and_b32 s8, s8, 0xffffff00
    v_and_b32 v5, 7, v2
    v_lshl_add_u32 v5, s5, 3, v5
    v_lshlrev_b32 v5, 7, v5
    v_min_u32 v5, CODE_END-k1_kernel-4, v5
    global_load_dword v167, v5, s[8:9]
K_NOCPF:
    s_cmp_lt_u32 s2, 112
    s_cbranch_scc1 K_NC
    s_sub_u32 s101, s5, 14
    s_mul_i32 s6, s4, 18
    s_add_u32 s6, s6, s101
    s_cmp_lt_u32 s3, 8
    s_cbranch_scc1 CK_PRO
CU_PRO:
    s_sub_u32 s7, s3, 8
    s_lshl_b32 s8, s101, 2
    s_add_u32 s8, s8, s7
    s_mul_i32 s10, s8, 57
    s_lshr_b32 s10, s10, 9
    s_mul_i32 s11, s10, 9
    s_sub_u32 s11, s8, s11
    s_sub_u32 s8, s8, s10
    s_mul_i32 s8, s8, 36864
    s_lshl_b32 s9, s4, 7
    s_add_u32 s8, s8, s9
    v_lshrrev_b32 v5, 1, v2
    v_mul_u32_u24 v5, 1152, v5
    v_and_b32 v6, 1, v2
    v_lshl_add_u32 v5, v6, 7, v5
    v_add_u32 v7, s8, v5
    s_and_b32 s15, s7, 2
    s_add_u32 s15, s15, s7
    s_mul_i32 s8, s15, 294912
    s_lshl_b32 s9, s6, 3
    s_add_u32 s8, s8, s9
    v_mul_u32_u24 v5, 4608, v2
    v_add_u32 v5, s8, v5
    v_add_u32 v6, 589824, v5
    v_mov_b32 v58, 0
    v_mov_b32 v59, 0
    v_mov_b32 v57, 153600
    v_lshl_add_u32 v56, v2, 3, v57
    ds_write_b64 v56, v[58:59]
    s_waitcnt lgkmcnt(0)
    s_barrier
    s_cmp_eq_u32 s7, 3
    s_cbranch_scc1 CU_C3A
CU_C3B:
    global_load_dword v60, v59, s[30:31]
    s_waitcnt vmcnt(0)
    s_cmp_eq_u32 s11, 8
    s_cbranch_scc1 CU_C3
    global_load_dword v60, v7, s[16:17]
CU_C3X:
    s_cmp_ge_u32 s7, 1
    s_cbranch_scc1 CU_MID
CU_LD:
    global_load_dwordx2 v[8:9], v5, s[16:17] offset:0 sc1
    global_load_dwordx2 v[10:11], v5, s[16:17] offset:1152 sc1
    global_load_dwordx2 v[12:13], v5, s[16:17] offset:2304 sc1
    global_load_dwordx2 v[14:15], v5, s[16:17] offset:3456 sc1
    global_load_dwordx2 v[16:17], v6, s[16:17] offset:0 sc1
    global_load_dwordx2 v[18:19], v6, s[16:17] offset:1152 sc1
    global_load_dwordx2 v[20:21], v6, s[16:17] offset:2304 sc1
    global_load_dwordx2 v[22:23], v6, s[16:17] offset:3456 sc1
    s_branch CU_MAIN
CK_PRO:
    s_and_b32 s7, s3, 3
    s_lshr_b32 s12, s3, 2
    s_lshl_b32 s8, s6, 2
    s_add_u32 s8, s8, s7
    s_lshl_b32 s9, s8, 8
    v_lshl_add_u32 v6, v2, 2, s9
    s_lshl_b32 s8, s8, 1
    v_mov_b32 v7, s8
    v_mov_b32 v18, 0
    s_waitcnt lgkmcnt(0)
    global_load_short_d16_hi v18, v7, s[30:31]
    global_load_dword v28, v6, s[18:19]
    global_load_dword v29, v6, s[20:21]
    global_load_dword v30, v6, s[22:23]
    global_load_dword v31, v6, s[24:25]
    global_load_dword v32, v6, s[26:27]
    global_load_dword v33, v6, s[28:29]
    s_barrier
    s_branch CK_MAIN
K_NC:
    s_lshl_b32 s6, s2, 4
    s_lshl_b32 s7, s3, 2
    s_sub_u32 s7, s7, 32
    s_cmp_ge_u32 s3, 8
    s_cbranch_scc1 RT_PRO
    s_cmp_lt_u32 s2, 72
    s_cbranch_scc1 F_PRO
    s_cmp_lt_u32 s3, 6
    s_cbranch_scc1 HELPER
    s_cmp_lt_u32 s2, 80
    s_cbranch_scc1 HELPER
    s_add_u32 s7, s7, 24
    s_lshr_b32 s6, s6, 1
    s_add_u32 s6, s6, 1136
RT_PRO:
    s_add_u32 s6, s6, s7
    v_add_u32 v5, s6, v4
    v_lshlrev_b32 v6, 4, v3
    v_lshlrev_b32 v7, 3, v3
    v_mul_u32_u24 v9, 1152, v5
    v_add_u32 v8, v9, v6
    v_add_u32 v9, v9, v7
    v_mov_b32 v10, 0
    v_lshlrev_b32 v11, 2, v2
    v_add_u32 v12, 163520, v11
    ds_write_b32 v12, v10
    v_and_b32 v11, 0x7c, v11
    v_lshlrev_b32 v12, 4, v2
    s_mul_i32 s13, s7, 640
    s_add_u32 s13, s13, 147456
    s_mov_b32 m0, s13
    s_waitcnt lgkmcnt(0)
    s_load_dword s12, s[50:51], 0
    global_load_lds_dwordx4 v12, s[36:37]
    global_load_lds_dword v11, s[36:37] offset:1024
    s_add_u32 m0, s13, 1280
    v_add_u32 v6, s13, v6
    global_load_lds_dwordx4 v12, s[44:45]
    global_load_lds_dword v11, s[44:45] offset:1024
    global_load_dwordx4 v[16:19], v8, s[16:17] offset:0
    global_load_dwordx4 v[20:23], v8, s[16:17] offset:256
    global_load_dwordx4 v[24:27], v8, s[16:17] offset:512
    global_load_dwordx4 v[28:31], v8, s[16:17] offset:768
    global_load_dwordx2 v[32:33], v9, s[16:17] offset:1024
    s_barrier
    s_branch RT_MAIN
F_PRO:
    s_mul_i32 s6, s4, 9
    s_add_u32 s6, s6, s5
    v_lshrrev_b32 v6, 3, v2
    v_and_b32 v7, 4, v6
    v_add_u32 v7, v6, v7
    v_mul_u32_u24 v5, 9216, v7
    v_and_b32 v7, 6, v6
    v_xor_b32 v7, v7, v2
    v_and_b32 v7, 7, v7
    v_lshl_add_u32 v5, v7, 4, v5
    s_and_b32 s8, s3, 1
    s_lshr_b32 s9, s3, 1
    s_lshl_b32 s9, s9, 2
    s_add_u32 s8, s8, s9
    s_mul_i32 s14, s8, 36864
    s_lshl_b32 s8, s6, 7
    s_add_u32 s14, s14, s8
    s_lshl_b32 s15, s3, 10
    s_mov_b32 s54, 5308416
    s_mov_b32 s55, 0x20000
    s_mov_b32 s58, 5308416
    s_mov_b32 s59, 0x20000
    s_waitcnt lgkmcnt(0)
    s_mov_b64 s[52:53], s[38:39]
    s_mov_b64 s[56:57], s[40:41]
    s_barrier
    s_branch F_MAIN
HELPER:
    v_lshrrev_b32 v6, 3, v2
    v_and_b32 v7, 4, v6
    v_add_u32 v7, v6, v7
    v_mul_u32_u24 v5, 1152, v7
    v_and_b32 v7, 6, v6
    v_xor_b32 v7, v7, v2
    v_and_b32 v7, 7, v7
    v_lshl_add_u32 v5, v7, 4, v5
    s_lshl_b32 s8, s5, 1
    s_sub_u32 s8, s8, 20
    s_cmp_lt_u32 s2, 80
    s_cselect_b32 s8, 8, s8
    s_cselect_b32 s70, 8, 6
    s_cselect_b32 s69, 2, 4
    s_cselect_b32 s71, 1, 2
    s_mul_i32 s71, s71, 72
    s_mul_i32 s9, s4, 9
    s_add_u32 s8, s8, s9
    s_mul_i32 s14, s8, 73728
    s_mov_b32 s6, s3
    s_waitcnt lgkmcnt(0)
    s_mov_b32 s60, s42
    s_mov_b32 s61, s43
    s_mov_b32 s62, 5308416
    s_mov_b32 s63, 0x20000
    s_barrier
    s_branch DN_LOAD
RT_MAIN:
    s_mul_i32 s6, s2, 128
    s_add_u32 s6, s6, 4096
    s_cmp_lt_u32 s2, 80
    s_cselect_b32 s8, 15, 23
    v_min_u32 v14, s8, v2
    v_lshl_add_u32 v5, v2, 2, s6
    s_mov_b32 s8, 163520
    v_lshl_add_u32 v14, v14, 2, s8
    v_add_u32 v13, s7, v4
    v_lshl_add_u32 v13, v13, 2, s8
    s_mov_b32 s8, 0xffff
    s_mov_b32 s10, 0x00010001
    s_mov_b32 s11, 0x00010001
    v_mov_b32 v15, 0x3f803f80
    v_mov_b32 v12, 163456
    s_waitcnt lgkmcnt(0)
    s_add_u32 s12, s12, 1
    v_mov_b32 v11, s12
    ds_write_b64 v12, v[10:11]
    v_add_u32 v7, s13, v7
    s_waitcnt vmcnt(5)
    ds_read_b128 v[52:55], v6 offset:1280
    ds_read_b128 v[56:59], v6 offset:1536
    ds_read_b128 v[60:63], v6 offset:1792
    ds_read_b128 v[64:67], v6 offset:2048
    ds_read_b64 v[68:69], v7 offset:2304
    ds_read_b128 v[34:37], v6 offset:0
    ds_read_b128 v[38:41], v6 offset:256
    ds_read_b128 v[42:45], v6 offset:512
    ds_read_b128 v[46:49], v6 offset:768
    ds_read_b64 v[50:51], v7 offset:1024
    s_waitcnt lgkmcnt(5)
    v_and_b32 v84, 0xffff, v52
    v_and_b32 v52, 0xffff0000, v52
    v_and_b32 v85, 0xffff, v53
    v_and_b32 v53, 0xffff0000, v53
    v_and_b32 v86, 0xffff, v54
    v_and_b32 v54, 0xffff0000, v54
    v_and_b32 v87, 0xffff, v55
    v_and_b32 v55, 0xffff0000, v55
    v_and_b32 v88, 0xffff, v56
    v_and_b32 v56, 0xffff0000, v56
    v_and_b32 v89, 0xffff, v57
    v_and_b32 v57, 0xffff0000, v57
    v_and_b32 v90, 0xffff, v58
    v_and_b32 v58, 0xffff0000, v58
    v_and_b32 v91, 0xffff, v59
    v_and_b32 v59, 0xffff0000, v59
    v_and_b32 v92, 0xffff, v60
    v_and_b32 v60, 0xffff0000, v60
    v_and_b32 v93, 0xffff, v61
    v_and_b32 v61, 0xffff0000, v61
    v_and_b32 v94, 0xffff, v62
    v_and_b32 v62, 0xffff0000, v62
    v_and_b32 v95, 0xffff, v63
    v_and_b32 v63, 0xffff0000, v63
    v_and_b32 v96, 0xffff, v64
    v_and_b32 v64, 0xffff0000, v64
    v_and_b32 v97, 0xffff, v65
    v_and_b32 v65, 0xffff0000, v65
    v_and_b32 v98, 0xffff, v66
    v_and_b32 v66, 0xffff0000, v66
    v_and_b32 v99, 0xffff, v67
    v_and_b32 v67, 0xffff0000, v67
    v_and_b32 v100, 0xffff, v68
    v_and_b32 v68, 0xffff0000, v68
    v_and_b32 v101, 0xffff, v69
    v_and_b32 v69, 0xffff0000, v69
    s_waitcnt vmcnt(0) lgkmcnt(0)
    v_dot2_f32_bf16 v12, v16, v34, 0
    v_dot2_f32_bf16 v12, v17, v35, v12
    v_dot2_f32_bf16 v12, v18, v36, v12
    v_dot2_f32_bf16 v12, v19, v37, v12
    v_dot2_f32_bf16 v12, v20, v38, v12
    v_dot2_f32_bf16 v12, v21, v39, v12
    v_dot2_f32_bf16 v12, v22, v40, v12
    v_dot2_f32_bf16 v12, v23, v41, v12
    v_dot2_f32_bf16 v12, v24, v42, v12
    v_dot2_f32_bf16 v12, v25, v43, v12
    v_dot2_f32_bf16 v12, v26, v44, v12
    v_dot2_f32_bf16 v12, v27, v45, v12
    v_dot2_f32_bf16 v12, v28, v46, v12
    v_dot2_f32_bf16 v12, v29, v47, v12
    v_dot2_f32_bf16 v12, v30, v48, v12
    v_dot2_f32_bf16 v12, v31, v49, v12
    v_dot2_f32_bf16 v12, v32, v50, v12
    v_dot2_f32_bf16 v12, v33, v51, v12
    s_nop 0
    s_nop 1
    v_add_f32_dpp v12, v12, v12 row_ror:8 row_mask:0xf bank_mask:0xf
    s_nop 1
    v_add_f32_dpp v12, v12, v12 row_ror:4 row_mask:0xf bank_mask:0xf
    s_nop 1
    v_add_f32_dpp v12, v12, v12 row_ror:2 row_mask:0xf bank_mask:0xf
    s_nop 1
    v_add_f32_dpp v12, v12, v12 row_ror:1 row_mask:0xf bank_mask:0xf
    v_cvt_pk_bf16_f32 v12, v12, v12
    v_ashrrev_i32 v9, 31, v12
    v_or_b32 v9, 0x80000000, v9
    v_xor_b32 v12, v12, v9
    v_or_b32 v12, 1, v12
    s_mov_b64 exec, s[10:11]
    ds_write_b32 v13, v12 offset:0
    s_mov_b64 exec, -1
    s_cmp_lg_u32 s7, 0
    s_cbranch_scc1 RT_PK_X
    s_mov_b32 s9, 0
RT_PK:
    ds_read_b32 v12, v14 offset:0
    s_add_u32 s9, s9, 1
    s_waitcnt lgkmcnt(0)
    v_cmp_eq_u32 vcc, 0, v12
    s_cmp_ge_u32 s9, 0x40000
    s_cbranch_scc1 RT_PK_S
    s_cbranch_vccnz RT_PK
RT_PK_S:
    v_bfi_b32 v12, s8, v11, v12
    s_mov_b32 exec_hi, 0
    global_store_dword v5, v12, s[50:51] sc1
    s_mov_b64 exec, -1
RT_PK_X:
    s_or_b32 s9, s2, s7
    s_cmp_lg_u32 s9, 0
    s_cbranch_scc1 RT_NOT
    v_mov_b32 v8, v11
    v_mov_b32 v9, 1
    global_store_dwordx2 v10, v[8:9], s[48:49] sc1
RT_NOT:
    v_dot2_f32_bf16 v70, v16, v84, 0
    v_dot2_f32_bf16 v71, v16, v52, 0
    v_dot2_f32_bf16 v72, v17, v85, 0
    v_dot2_f32_bf16 v73, v17, v53, 0
    v_dot2_f32_bf16 v74, v18, v86, 0
    v_dot2_f32_bf16 v75, v18, v54, 0
    v_dot2_f32_bf16 v76, v19, v87, 0
    v_dot2_f32_bf16 v77, v19, v55, 0
    v_dot2_f32_bf16 v78, v20, v88, 0
    v_dot2_f32_bf16 v79, v20, v56, 0
    v_dot2_f32_bf16 v80, v21, v89, 0
    v_dot2_f32_bf16 v81, v21, v57, 0
    s_nop 0
    v_cvt_pk_bf16_f32 v70, v70, v71
    v_cvt_pk_bf16_f32 v72, v72, v73
    v_cvt_pk_bf16_f32 v74, v74, v75
    v_cvt_pk_bf16_f32 v76, v76, v77
    v_cvt_pk_bf16_f32 v78, v78, v79
    v_cvt_pk_bf16_f32 v80, v80, v81
    v_dot2_f32_bf16 v12, v70, v15, 0
    v_dot2_f32_bf16 v12, v72, v15, v12
    v_dot2_f32_bf16 v12, v74, v15, v12
    v_dot2_f32_bf16 v12, v76, v15, v12
    v_dot2_f32_bf16 v12, v78, v15, v12
    v_dot2_f32_bf16 v12, v80, v15, v12
    v_dot2_f32_bf16 v70, v22, v90, 0
    v_dot2_f32_bf16 v71, v22, v58, 0
    v_dot2_f32_bf16 v72, v23, v91, 0
    v_dot2_f32_bf16 v73, v23, v59, 0
    v_dot2_f32_bf16 v74, v24, v92, 0
    v_dot2_f32_bf16 v75, v24, v60, 0
    v_dot2_f32_bf16 v76, v25, v93, 0
    v_dot2_f32_bf16 v77, v25, v61, 0
    v_dot2_f32_bf16 v78, v26, v94, 0
    v_dot2_f32_bf16 v79, v26, v62, 0
    v_dot2_f32_bf16 v80, v27, v95, 0
    v_dot2_f32_bf16 v81, v27, v63, 0
    s_nop 0
    v_cvt_pk_bf16_f32 v70, v70, v71
    v_cvt_pk_bf16_f32 v72, v72, v73
    v_cvt_pk_bf16_f32 v74, v74, v75
    v_cvt_pk_bf16_f32 v76, v76, v77
    v_cvt_pk_bf16_f32 v78, v78, v79
    v_cvt_pk_bf16_f32 v80, v80, v81
    v_dot2_f32_bf16 v12, v70, v15, v12
    v_dot2_f32_bf16 v12, v72, v15, v12
    v_dot2_f32_bf16 v12, v74, v15, v12
    v_dot2_f32_bf16 v12, v76, v15, v12
    v_dot2_f32_bf16 v12, v78, v15, v12
    v_dot2_f32_bf16 v12, v80, v15, v12
    v_dot2_f32_bf16 v70, v28, v96, 0
    v_dot2_f32_bf16 v71, v28, v64, 0
    v_dot2_f32_bf16 v72, v29, v97, 0
    v_dot2_f32_bf16 v73, v29, v65, 0
    v_dot2_f32_bf16 v74, v30, v98, 0
    v_dot2_f32_bf16 v75, v30, v66, 0
    v_dot2_f32_bf16 v76, v31, v99, 0
    v_dot2_f32_bf16 v77, v31, v67, 0
    v_dot2_f32_bf16 v78, v32, v100, 0
    v_dot2_f32_bf16 v79, v32, v68, 0
    v_dot2_f32_bf16 v80, v33, v101, 0
    v_dot2_f32_bf16 v81, v33, v69, 0
    s_nop 0
    v_cvt_pk_bf16_f32 v70, v70, v71
    v_cvt_pk_bf16_f32 v72, v72, v73
    v_cvt_pk_bf16_f32 v74, v74, v75
    v_cvt_pk_bf16_f32 v76, v76, v77
    v_cvt_pk_bf16_f32 v78, v78, v79
    v_cvt_pk_bf16_f32 v80, v80, v81
    v_dot2_f32_bf16 v12, v70, v15, v12
    v_dot2_f32_bf16 v12, v72, v15, v12
    v_dot2_f32_bf16 v12, v74, v15, v12
    v_dot2_f32_bf16 v12, v76, v15, v12
    v_dot2_f32_bf16 v12, v78, v15, v12
    v_dot2_f32_bf16 v12, v80, v15, v12
    v_add_u32 v5, 16384, v5
    s_nop 1
    v_add_f32_dpp v12, v12, v12 row_ror:8 row_mask:0xf bank_mask:0xf
    s_nop 1
    v_add_f32_dpp v12, v12, v12 row_ror:4 row_mask:0xf bank_mask:0xf
    s_nop 1
    v_add_f32_dpp v12, v12, v12 row_ror:2 row_mask:0xf bank_mask:0xf
    s_nop 1
    v_add_f32_dpp v12, v12, v12 row_ror:1 row_mask:0xf bank_mask:0xf
    v_cvt_pk_bf16_f32 v12, v12, v12
    v_and_b32 v12, 0xffff0000, v12
    v_mul_f32 v9, 0xbfb8aa3b, v12
    v_exp_f32 v9, v9
    s_nop 0
    v_add_f32 v9, 1.0, v9
    v_rcp_f32 v9, v9
    s_nop 0
    v_cvt_pk_bf16_f32 v12, v9, v9
    v_or_b32 v12, 1, v12
    s_mov_b64 exec, s[10:11]
    ds_write_b32 v13, v12 offset:128
    s_mov_b64 exec, -1
    s_cmp_lg_u32 s7, 0
    s_cbranch_scc1 RT_PG_X
    s_mov_b32 s9, 0
RT_PG:
    ds_read_b32 v12, v14 offset:128
    s_add_u32 s9, s9, 1
    s_waitcnt lgkmcnt(0)
    v_cmp_eq_u32 vcc, 0, v12
    s_cmp_ge_u32 s9, 0x40000
    s_cbranch_scc1 RT_PG_S
    s_cbranch_vccnz RT_PG
RT_PG_S:
    v_bfi_b32 v12, s8, v11, v12
    s_mov_b32 exec_hi, 0
    global_store_dword v5, v12, s[50:51] sc1
    s_mov_b64 exec, -1
RT_PG_X:
    s_barrier
RT_TAIL:
    s_cmp_ge_u32 s2, 80
    s_cbranch_scc1 DN_JOIN
    s_cmp_lt_u32 s2, 72
    s_cbranch_scc1 RT_CTL
    s_barrier
    s_branch DN_JOIN
RT_CTL:
    s_cmp_lg_u32 s3, 8
    s_cbranch_scc1 W_END
    v_mov_b32 v14, v11
    v_mov_b32 v21, 163456
    v_mov_b32 v22, 16
    s_mov_b32 s64, s16
    s_mov_b32 s65, s17
    s_mov_b32 s66, 2359296
    s_mov_b32 s67, 0x20000
    v_lshlrev_b32 v19, 4, v2
    v_lshlrev_b32 v20, 2, v2
    s_lshl_b32 s13, s4, 10
    s_add_u32 s13, s13, 40960
    s_add_u32 s7, s13, 1024
    s_sleep 16
RT_SC:
    s_load_dwordx16 s[16:31], s[50:51], s13
    s_add_u32 s13, s13, 64
    s_waitcnt lgkmcnt(0)
    s_xor_b32 s8, s17, s12
    s_xor_b32 s9, s19, s12
    s_or_b32 s8, s8, s9
    s_xor_b32 s9, s21, s12
    s_or_b32 s8, s8, s9
    s_xor_b32 s9, s23, s12
    s_or_b32 s8, s8, s9
    s_xor_b32 s9, s25, s12
    s_or_b32 s8, s8, s9
    s_xor_b32 s9, s27, s12
    s_or_b32 s8, s8, s9
    s_xor_b32 s9, s29, s12
    s_or_b32 s8, s8, s9
    s_xor_b32 s9, s31, s12
    s_or_b32 s8, s8, s9
    s_cbranch_scc0 RT_SCOK
    s_sleep 2
    s_cmp_lt_u32 s13, s7
    s_cbranch_scc1 RT_SC
    v_and_b32 v6, 7, v2
    s_lshl_b32 s9, s4, 8
    v_lshl_add_u32 v6, v6, 3, s9
    v_and_b32 v7, 7, v2
    s_lshl_b32 s9, s4, 10
    s_add_u32 s9, s9, 48896
    v_lshl_add_u32 v7, v7, 7, s9
    s_mov_b32 s12, 0
SP_C:
    s_add_u32 s12, s12, 1
    s_and_b32 s9, s12, 7
    s_cselect_b64 s[14:15], 0, -1
    v_cndmask_b32 v10, v6, v7, s[14:15]
    global_load_dwordx2 v[8:9], v10, s[50:51] offset:256 sc1
    s_waitcnt vmcnt(0)
SPC_C:
    v_cmp_ne_u32 vcc, v9, v14
    s_cmp_ge_u32 s12, 16384
    s_cbranch_scc1 SPX_C
    s_cbranch_vccz SPX_C
    s_mov_b64 exec, vcc
    s_sleep 2
    s_branch SP_C
SPX_C:
    s_mov_b64 exec, -1
    v_readlane_b32 s16, v8, 0
    v_readlane_b32 s18, v8, 1
    v_readlane_b32 s20, v8, 2
    v_readlane_b32 s22, v8, 3
    v_readlane_b32 s24, v8, 4
    v_readlane_b32 s26, v8, 5
    v_readlane_b32 s28, v8, 6
    v_readlane_b32 s30, v8, 7
RT_SCOK:
    s_mov_b32 m0, 147456
    s_andn2_b32 s76, 0x7ff, s16
    s_mul_i32 s76, s76, 1152
    s_andn2_b32 s77, 0x7ff, s18
    s_mul_i32 s77, s77, 1152
    s_andn2_b32 s78, 0x7ff, s20
    s_mul_i32 s78, s78, 1152
    s_andn2_b32 s79, 0x7ff, s22
    s_mul_i32 s79, s79, 1152
    s_andn2_b32 s80, 0x7ff, s24
    s_mul_i32 s80, s80, 1152
    s_andn2_b32 s81, 0x7ff, s26
    s_mul_i32 s81, s81, 1152
    s_andn2_b32 s82, 0x7ff, s28
    s_mul_i32 s82, s82, 1152
    s_andn2_b32 s83, 0x7ff, s30
    s_mul_i32 s83, s83, 1152
    buffer_load_dwordx4 v19, s[64:67], s76 offen lds
    buffer_load_dword v20, s[64:67], s76 offen offset:1024 lds
    s_add_u32 m0, m0, 1312
    s_nop 0
    buffer_load_dwordx4 v19, s[64:67], s77 offen lds
    buffer_load_dword v20, s[64:67], s77 offen offset:1024 lds
    s_add_u32 m0, m0, 1312
    s_nop 0
    buffer_load_dwordx4 v19, s[64:67], s78 offen lds
    buffer_load_dword v20, s[64:67], s78 offen offset:1024 lds
    s_add_u32 m0, m0, 1312
    s_nop 0
    buffer_load_dwordx4 v19, s[64:67], s79 offen lds
    buffer_load_dword v20, s[64:67], s79 offen offset:1024 lds
    s_add_u32 m0, m0, 1312
    s_nop 0
    buffer_load_dwordx4 v19, s[64:67], s80 offen lds
    buffer_load_dword v20, s[64:67], s80 offen offset:1024 lds
    s_add_u32 m0, m0, 1312
    s_nop 0
    buffer_load_dwordx4 v19, s[64:67], s81 offen lds
    buffer_load_dword v20, s[64:67], s81 offen offset:1024 lds
    s_add_u32 m0, m0, 1312
    s_nop 0
    buffer_load_dwordx4 v19, s[64:67], s82 offen lds
    buffer_load_dword v20, s[64:67], s82 offen offset:1024 lds
    s_add_u32 m0, m0, 1312
    s_nop 0
    buffer_load_dwordx4 v19, s[64:67], s83 offen lds
    buffer_load_dword v20, s[64:67], s83 offen offset:1024 lds
    s_add_u32 m0, m0, 1312
    s_nop 0
    s_waitcnt vmcnt(0)
    s_barrier
    s_endpgm
DN_LOAD:
    s_mul_i32 s8, s6, 7282
    s_lshr_b32 s8, s8, 16
    s_mul_i32 s9, s8, 9
    s_sub_u32 s9, s6, s9
    s_lshl_b32 s12, s9, 4
    s_add_u32 s12, s12, s8
    s_lshl_b32 m0, s12, 10
    s_and_b32 s12, s8, 1
    s_lshl_b32 s8, s8, 1
    s_sub_u32 s8, s8, s12
    s_mul_i32 s8, s8, 4608
    s_lshl_b32 s9, s9, 7
    s_add_u32 s8, s8, s9
    s_add_u32 s8, s8, s14
    buffer_load_dwordx4 v5, s[60:63], s8 offen  lds
    s_add_u32 s6, s6, s70
    s_waitcnt vmcnt(0)
    s_mov_b32 s13, 0
DN_L1:
    s_mul_i32 s8, s6, 7282
    s_lshr_b32 s8, s8, 16
    s_mul_i32 s9, s8, 9
    s_sub_u32 s9, s6, s9
    s_lshl_b32 s12, s9, 4
    s_add_u32 s12, s12, s8
    s_lshl_b32 m0, s12, 10
    s_and_b32 s12, s8, 1
    s_lshl_b32 s8, s8, 1
    s_sub_u32 s8, s8, s12
    s_mul_i32 s8, s8, 4608
    s_lshl_b32 s9, s9, 7
    s_add_u32 s8, s8, s9
    s_add_u32 s8, s8, s14
    buffer_load_dwordx4 v5, s[60:63], s8 offen  lds
    s_add_u32 s6, s6, s70
    s_add_u32 s13, s13, 1
    s_cmp_lt_u32 s13, s69
    s_cbranch_scc1 DN_L1
    s_cmp_lt_u32 s2, 80
    s_cbranch_scc1 SEL_MAIN
    s_barrier
DN_L2:
    s_cmp_ge_u32 s6, s71
    s_cbranch_scc1 DN_LX
    s_waitcnt vmcnt(5)
    s_mul_i32 s8, s6, 7282
    s_lshr_b32 s8, s8, 16
    s_mul_i32 s9, s8, 9
    s_sub_u32 s9, s6, s9
    s_lshl_b32 s12, s9, 4
    s_add_u32 s12, s12, s8
    s_lshl_b32 m0, s12, 10
    s_and_b32 s12, s8, 1
    s_lshl_b32 s8, s8, 1
    s_sub_u32 s8, s8, s12
    s_mul_i32 s8, s8, 4608
    s_lshl_b32 s9, s9, 7
    s_add_u32 s8, s8, s9
    s_add_u32 s8, s8, s14
    buffer_load_dwordx4 v5, s[60:63], s8 offen  lds
    s_add_u32 s6, s6, s70
    s_branch DN_L2
DN_LX:
DN_JOIN:
    v_mov_b32 v21, 163460
    ds_read_b32 v14, v21
    v_and_b32 v18, 1, v4
    v_bfe_u32 v6, v2, 2, 2
    v_lshl_add_u32 v18, v18, 2, v6
    v_lshrrev_b32 v19, 1, v18
    v_lshlrev_b32 v18, 7, v18
    v_and_b32 v6, 3, v2
    v_lshl_add_u32 v18, v6, 3, v18
    v_lshrrev_b32 v6, 1, v4
    v_lshl_add_u32 v18, v6, 11, v18
    s_mul_i32 s12, s3, 3
    s_add_u32 s8, s12, 0
    s_and_b32 s9, s8, 3
    s_lshr_b32 s8, s8, 2
    s_lshl_b32 s8, s8, 14
    v_xor_b32 v6, s9, v19
    v_lshl_add_u32 v6, v6, 5, v18
    v_add_u32 v8, s8, v6
    s_add_u32 s8, s12, 1
    s_and_b32 s9, s8, 3
    s_lshr_b32 s8, s8, 2
    s_lshl_b32 s8, s8, 14
    v_xor_b32 v6, s9, v19
    v_lshl_add_u32 v6, v6, 5, v18
    v_add_u32 v9, s8, v6
    s_add_u32 s8, s12, 2
    s_and_b32 s9, s8, 3
    s_lshr_b32 s8, s8, 2
    s_lshl_b32 s8, s8, 14
    v_xor_b32 v6, s9, v19
    v_lshl_add_u32 v6, v6, 5, v18
    v_add_u32 v10, s8, v6
    v_and_b32 v7, 7, v2
    v_mul_u32_u24 v11, 272, v7
    v_lshl_add_u32 v11, v4, 4, v11
    v_add_u32 v11, 157952, v11
    v_mul_u32_u24 v12, 5248, v4
    v_lshl_add_u32 v12, v7, 4, v12
    s_mul_i32 s8, s3, 62976
    s_lshl_b32 s9, s2, 7
    s_add_u32 s8, s8, s9
    s_add_u32 s8, s8, 343040
    v_add_u32 v12, s8, v12
    v_add_u32 v15, 41984, v12
    v_lshrrev_b32 v13, 3, v3
    v_mul_u32_u24 v13, 20992, v13
    v_add_u32 v12, v12, v13
    s_lshl_b32 s8, s5, 1
    s_sub_u32 s8, s8, 20
    s_cmp_lt_u32 s2, 80
    s_cselect_b32 s8, 8, s8
    s_cselect_b32 s13, 11, 12
    s_mul_i32 s9, s4, 9
    s_add_u32 s8, s8, s9
    s_sub_u32 s9, s3, 10
    s_add_u32 s8, s8, s9
    s_lshl_b32 s8, s8, 12
    s_add_u32 s8, s8, 57344
    v_lshl_add_u32 v16, v2, 5, s8
    v_and_b32 v17, 30, v2
    v_lshlrev_b32 v17, 1, v17
    v_and_b32 v20, 1, v2
    v_add_u32 v17, v17, v20
    v_lshrrev_b32 v20, 5, v2
    v_lshl_add_u32 v17, v20, 1, v17
    v_lshlrev_b32 v17, 1, v17
    s_lshl_b32 s9, s9, 7
    s_add_u32 s9, s9, 157952
    v_add_u32 v17, s9, v17
    s_cmp_lt_u32 s3, 10
    s_cbranch_scc1 DN_NOWARM
    global_load_dword v20, v16, s[50:51] sc1
DN_NOWARM:
    s_mov_b32 s10, 0x00ff00ff
    s_mov_b32 s11, 0x00ff00ff
    s_movk_i32 s78, 0xff
    s_waitcnt vmcnt(0) lgkmcnt(0)
    s_barrier
    ds_read_b64_tr_b16 v[24:25], v8 offset:0
    ds_read_b64_tr_b16 v[26:27], v8 offset:1024
    ds_read_b64_tr_b16 v[40:41], v9 offset:0
    ds_read_b64_tr_b16 v[42:43], v9 offset:1024
    ds_read_b64_tr_b16 v[56:57], v10 offset:0
    ds_read_b64_tr_b16 v[58:59], v10 offset:1024
    ds_read_b64_tr_b16 v[28:29], v8 offset:4096
    ds_read_b64_tr_b16 v[30:31], v8 offset:5120
    ds_read_b64_tr_b16 v[44:45], v9 offset:4096
    ds_read_b64_tr_b16 v[46:47], v9 offset:5120
    ds_read_b64_tr_b16 v[60:61], v10 offset:4096
    ds_read_b64_tr_b16 v[62:63], v10 offset:5120
    ds_read_b64_tr_b16 v[32:33], v8 offset:8192
    ds_read_b64_tr_b16 v[34:35], v8 offset:9216
    ds_read_b64_tr_b16 v[48:49], v9 offset:8192
    ds_read_b64_tr_b16 v[50:51], v9 offset:9216
    ds_read_b64_tr_b16 v[64:65], v10 offset:8192
    ds_read_b64_tr_b16 v[66:67], v10 offset:9216
    ds_read_b64_tr_b16 v[36:37], v8 offset:12288
    ds_read_b64_tr_b16 v[38:39], v8 offset:13312
    ds_read_b64_tr_b16 v[52:53], v9 offset:12288
    ds_read_b64_tr_b16 v[54:55], v9 offset:13312
    ds_read_b64_tr_b16 v[68:69], v10 offset:12288
    ds_read_b64_tr_b16 v[70:71], v10 offset:13312
    s_cmp_lt_u32 s3, 10
    s_cbranch_scc1 DN_W
    s_cmp_ge_u32 s3, s13
    s_cbranch_scc1 DN_W
    s_mov_b32 s12, 0
    s_mov_b32 s76, 0x07060302
DN_POLL:
    s_add_u32 s12, s12, 1
    s_and_b32 s8, s12, 15
    s_cselect_b32 s8, 0, 2048
    v_add_u32 v20, s8, v16
    global_load_dwordx4 v[72:75], v20, s[50:51] sc1
    global_load_dwordx4 v[76:79], v20, s[50:51] offset:16 sc1
    s_waitcnt vmcnt(0)
    v_xor_b32 v20, v72, v14
    v_bitop3_b32 v20, v20, v73, v14 bitop3:0xf6
    v_bitop3_b32 v20, v20, v74, v14 bitop3:0xf6
    v_bitop3_b32 v20, v20, v75, v14 bitop3:0xf6
    v_bitop3_b32 v20, v20, v76, v14 bitop3:0xf6
    v_bitop3_b32 v20, v20, v77, v14 bitop3:0xf6
    v_bitop3_b32 v20, v20, v78, v14 bitop3:0xf6
    v_bitop3_b32 v20, v20, v79, v14 bitop3:0xf6
    v_and_b32 v20, 0xffff, v20
    v_cmp_ne_u32 vcc, 0, v20
    s_cmp_ge_u32 s12, 65536
    s_cbranch_scc1 DN_GOT
    s_cbranch_vccnz DN_POLL
DN_GOT:
    ds_write_b16_d16_hi v17, v72 offset:0
    ds_write_b16_d16_hi v17, v73 offset:272
    ds_write_b16_d16_hi v17, v74 offset:544
    ds_write_b16_d16_hi v17, v75 offset:816
    ds_write_b16_d16_hi v17, v76 offset:1088
    ds_write_b16_d16_hi v17, v77 offset:1360
    ds_write_b16_d16_hi v17, v78 offset:1632
    ds_write_b16_d16_hi v17, v79 offset:1904
DN_W:
    s_waitcnt lgkmcnt(0)
    s_barrier
    ds_read_b128 v[72:75], v11 offset:0
    ds_read_b128 v[76:79], v11 offset:64
    ds_read_b128 v[80:83], v11 offset:128
    ds_read_b128 v[84:87], v11 offset:192
    s_waitcnt lgkmcnt(3)
    v_mfma_f32_16x16x32_bf16 v[88:91], v[24:27], v[72:75], 0
    v_mfma_f32_16x16x32_bf16 v[92:95], v[40:43], v[72:75], 0
    v_mfma_f32_16x16x32_bf16 v[96:99], v[56:59], v[72:75], 0
    s_waitcnt lgkmcnt(2)
    v_mfma_f32_16x16x32_bf16 v[88:91], v[28:31], v[76:79], v[88:91]
    v_mfma_f32_16x16x32_bf16 v[92:95], v[44:47], v[76:79], v[92:95]
    v_mfma_f32_16x16x32_bf16 v[96:99], v[60:63], v[76:79], v[96:99]
    s_cmp_lt_u32 s2, 80
    s_cbranch_scc1 DN_ONE
    s_waitcnt lgkmcnt(1)
    v_mfma_f32_16x16x32_bf16 v[88:91], v[32:35], v[80:83], v[88:91]
    v_mfma_f32_16x16x32_bf16 v[92:95], v[48:51], v[80:83], v[92:95]
    v_mfma_f32_16x16x32_bf16 v[96:99], v[64:67], v[80:83], v[96:99]
    s_waitcnt lgkmcnt(0)
    v_mfma_f32_16x16x32_bf16 v[88:91], v[36:39], v[84:87], v[88:91]
    v_mfma_f32_16x16x32_bf16 v[92:95], v[52:55], v[84:87], v[92:95]
    v_mfma_f32_16x16x32_bf16 v[96:99], v[68:71], v[84:87], v[96:99]
DN_ONE:
    s_nop 6
    v_cndmask_b32 v88, v92, v88, s[10:11]
    v_cndmask_b32 v89, v93, v89, s[10:11]
    v_cndmask_b32 v90, v94, v90, s[10:11]
    v_cndmask_b32 v91, v95, v91, s[10:11]
    v_bfi_b32 v88, s78, v14, v88
    v_bfi_b32 v89, s78, v14, v89
    v_bfi_b32 v90, s78, v14, v90
    v_bfi_b32 v91, s78, v14, v91
    global_store_dwordx4 v12, v[88:91], s[50:51] sc1
    s_mov_b64 exec, s[10:11]
    v_bfi_b32 v96, s78, v14, v96
    v_bfi_b32 v97, s78, v14, v97
    v_bfi_b32 v98, s78, v14, v98
    v_bfi_b32 v99, s78, v14, v99
    global_store_dwordx4 v15, v[96:99], s[50:51] sc1
    s_cmp_lg_u32 s3, 11
    s_cbranch_scc1 DN_NOH
    s_lshl_b32 s8, s4, 7
    s_lshl_b32 s9, s5, 2
    s_add_u32 s8, s8, s9
    v_mov_b32 v20, s8
    global_store_dword v20, v14, s[50:51] offset:2268
DN_NOH:
    s_cmp_lg_u32 s3, 11
    s_cbranch_scc1 DN_NOHINT
    s_cmp_lg_u32 s2, 72
    s_cbranch_scc1 DN_NOHINT
    v_mov_b32 v20, 0
    global_store_dword v20, v14, s[50:51] sc1
DN_NOHINT:
    s_endpgm
F_MAIN:
    v_and_b32 v7, 7, v2
    s_add_u32 m0, s15, 0
    s_add_u32 s8, s14, 0
    buffer_load_dwordx4 v5, s[52:55], s8 offen  lds
    s_add_u32 m0, s15, 73728
    s_add_u32 s8, s14, 0
    buffer_load_dwordx4 v5, s[56:59], s8 offen  lds
    s_and_b32 s12, s3, 3
    s_lshr_b32 s13, s3, 2
    v_and_b32 v18, 1, v4
    v_bfe_u32 v6, v2, 2, 2
    v_lshl_add_u32 v18, v18, 2, v6
    v_lshrrev_b32 v6, 1, v18
    v_xor_b32 v6, s12, v6
    v_lshlrev_b32 v18, 7, v18
    v_lshl_add_u32 v18, v6, 5, v18
    v_and_b32 v6, 3, v2
    v_lshl_add_u32 v18, v6, 3, v18
    v_lshrrev_b32 v6, 1, v4
    v_lshl_add_u32 v18, v6, 11, v18
    s_lshl_b32 s8, s13, 12
    v_add_u32 v18, s8, v18
    v_add_u32 v6, 73728, v18
    v_add_u32 v0, 40960, v18
    v_add_u32 v1, 40960, v6
    v_mul_u32_u24 v8, 1312, v7
    v_lshl_add_u32 v8, v4, 4, v8
    s_lshl_b32 s8, s13, 6
    s_add_u32 s8, s8, 147456
    v_add_u32 v8, s8, v8
    s_lshl_b32 s8, s3, 9
    s_add_u32 s8, s8, 157952
    v_lshl_add_u32 v9, v2, 3, s8
    s_xor_b32 s8, s3, 4
    s_lshl_b32 s8, s8, 9
    s_add_u32 s8, s8, 157952
    v_lshl_add_u32 v10, v2, 3, s8
    s_lshl_b32 s8, s6, 12
    s_lshl_b32 s9, s3, 8
    s_add_u32 s8, s8, s9
    s_add_u32 s8, s8, 57344
    v_lshl_add_u32 v11, v2, 2, s8
    s_mov_b32 s76, 0xffff
    v_mov_b32 v21, 163456
    v_mov_b32 v22, 1
    s_mov_b32 s10, 0xff00ff00
    s_mov_b32 s11, 0xff00ff00
    s_waitcnt vmcnt(0)
    s_add_u32 m0, s15, 8192
    s_add_u32 s8, s14, 589824
    buffer_load_dwordx4 v5, s[52:55], s8 offen  lds
    s_add_u32 m0, s15, 81920
    s_add_u32 s8, s14, 589824
    buffer_load_dwordx4 v5, s[56:59], s8 offen  lds
    s_add_u32 m0, s15, 16384
    s_add_u32 s8, s14, 1179648
    buffer_load_dwordx4 v5, s[52:55], s8 offen  lds
    s_barrier
    ds_read_b32 v14, v21 offset:4
    s_add_u32 m0, s15, 90112
    s_add_u32 s8, s14, 1179648
    buffer_load_dwordx4 v5, s[56:59], s8 offen  lds
    s_waitcnt vmcnt(3)
    s_add_u32 m0, s15, 24576
    s_add_u32 s8, s14, 1769472
    buffer_load_dwordx4 v5, s[52:55], s8 offen  lds
    s_waitcnt vmcnt(3)
    s_add_u32 m0, s15, 98304
    s_add_u32 s8, s14, 1769472
    buffer_load_dwordx4 v5, s[56:59], s8 offen  lds
    s_waitcnt vmcnt(3)
    s_add_u32 m0, s15, 32768
    s_add_u32 s8, s14, 2359296
    buffer_load_dwordx4 v5, s[52:55], s8 offen  lds
    s_waitcnt vmcnt(3)
    s_add_u32 m0, s15, 106496
    s_add_u32 s8, s14, 2359296
    buffer_load_dwordx4 v5, s[56:59], s8 offen  lds
    s_waitcnt vmcnt(3)
    s_add_u32 m0, s15, 40960
    s_add_u32 s8, s14, 2949120
    buffer_load_dwordx4 v5, s[52:55], s8 offen  lds
    s_waitcnt vmcnt(3)
    s_add_u32 m0, s15, 114688
    s_add_u32 s8, s14, 2949120
    buffer_load_dwordx4 v5, s[56:59], s8 offen  lds
    s_waitcnt vmcnt(3)
    s_add_u32 m0, s15, 49152
    s_add_u32 s8, s14, 3538944
    buffer_load_dwordx4 v5, s[52:55], s8 offen  lds
    s_waitcnt vmcnt(3)
    s_add_u32 m0, s15, 122880
    s_add_u32 s8, s14, 3538944
    buffer_load_dwordx4 v5, s[56:59], s8 offen  lds
    s_waitcnt vmcnt(3)
    s_add_u32 m0, s15, 57344
    s_add_u32 s8, s14, 4128768
    buffer_load_dwordx4 v5, s[52:55], s8 offen  lds
    s_waitcnt vmcnt(3)
    s_add_u32 m0, s15, 131072
    s_add_u32 s8, s14, 4128768
    buffer_load_dwordx4 v5, s[56:59], s8 offen  lds
    s_waitcnt vmcnt(3)
    s_add_u32 m0, s15, 65536
    s_add_u32 s8, s14, 4718592
    buffer_load_dwordx4 v5, s[52:55], s8 offen  lds
    s_waitcnt vmcnt(3)
    s_add_u32 m0, s15, 139264
    s_add_u32 s8, s14, 4718592
    buffer_load_dwordx4 v5, s[56:59], s8 offen  lds
    s_waitcnt vmcnt(4)
    s_mov_b64 exec, 1
    ds_add_u32 v21, v22 offset:160
    s_mov_b64 exec, -1
    s_mov_b32 s9, 0
SPN1:
    ds_read_b32 v23, v21 offset:160
    s_add_u32 s9, s9, 1
    s_waitcnt lgkmcnt(0)
    v_cmp_ne_u32 vcc, 8, v23
    s_cmp_ge_u32 s9, 0x40000
    s_cbranch_scc1 SPX1
    s_cbranch_vccnz SPN1
SPX1:
    ds_read_b64_tr_b16 v[24:25], v18 offset:0
    ds_read_b64_tr_b16 v[26:27], v18 offset:1024
    ds_read_b64_tr_b16 v[28:29], v6 offset:0
    ds_read_b64_tr_b16 v[30:31], v6 offset:1024
    ds_read_b64_tr_b16 v[32:33], v18 offset:8192
    ds_read_b64_tr_b16 v[34:35], v18 offset:9216
    ds_read_b64_tr_b16 v[36:37], v6 offset:8192
    ds_read_b64_tr_b16 v[38:39], v6 offset:9216
    ds_read_b64_tr_b16 v[40:41], v18 offset:16384
    ds_read_b64_tr_b16 v[42:43], v18 offset:17408
    ds_read_b64_tr_b16 v[44:45], v6 offset:16384
    ds_read_b64_tr_b16 v[46:47], v6 offset:17408
    ds_read_b64_tr_b16 v[48:49], v18 offset:24576
    ds_read_b64_tr_b16 v[50:51], v18 offset:25600
    ds_read_b64_tr_b16 v[52:53], v6 offset:24576
    ds_read_b64_tr_b16 v[54:55], v6 offset:25600
    ds_read_b64_tr_b16 v[56:57], v18 offset:32768
    ds_read_b64_tr_b16 v[58:59], v18 offset:33792
    ds_read_b64_tr_b16 v[60:61], v6 offset:32768
    ds_read_b64_tr_b16 v[62:63], v6 offset:33792
    ds_read_b64_tr_b16 v[64:65], v0 offset:0
    ds_read_b64_tr_b16 v[66:67], v0 offset:1024
    ds_read_b64_tr_b16 v[68:69], v1 offset:0
    ds_read_b64_tr_b16 v[70:71], v1 offset:1024
    ds_read_b64_tr_b16 v[72:73], v0 offset:8192
    ds_read_b64_tr_b16 v[74:75], v0 offset:9216
    ds_read_b64_tr_b16 v[76:77], v1 offset:8192
    ds_read_b64_tr_b16 v[78:79], v1 offset:9216
    s_waitcnt vmcnt(0)
    s_barrier
    ds_read_b128 v[96:99], v8 offset:0
    ds_read_b128 v[100:103], v8 offset:128
    ds_read_b128 v[104:107], v8 offset:256
    ds_read_b128 v[108:111], v8 offset:384
    ds_read_b128 v[112:115], v8 offset:512
    ds_read_b128 v[116:119], v8 offset:640
    ds_read_b64_tr_b16 v[80:81], v0 offset:16384
    ds_read_b64_tr_b16 v[82:83], v0 offset:17408
    ds_read_b64_tr_b16 v[84:85], v1 offset:16384
    ds_read_b64_tr_b16 v[86:87], v1 offset:17408
    ds_read_b128 v[120:123], v8 offset:768
    ds_read_b64_tr_b16 v[88:89], v0 offset:24576
    ds_read_b64_tr_b16 v[90:91], v0 offset:25600
    ds_read_b64_tr_b16 v[92:93], v1 offset:24576
    ds_read_b64_tr_b16 v[94:95], v1 offset:25600
    ds_read_b128 v[124:127], v8 offset:896
    ds_read_b128 v[128:131], v8 offset:1024
    s_waitcnt lgkmcnt(15)
    v_mfma_f32_16x16x32_bf16 v[160:163], v[24:27], v[96:99], 0
    v_mfma_f32_16x16x32_bf16 v[164:167], v[28:31], v[96:99], 0
    s_waitcnt lgkmcnt(15)
    v_mfma_f32_16x16x32_bf16 v[160:163], v[32:35], v[100:103], v[160:163]
    v_mfma_f32_16x16x32_bf16 v[164:167], v[36:39], v[100:103], v[164:167]
    s_waitcnt lgkmcnt(14)
    v_mfma_f32_16x16x32_bf16 v[160:163], v[40:43], v[104:107], v[160:163]
    v_mfma_f32_16x16x32_bf16 v[164:167], v[44:47], v[104:107], v[164:167]
    s_waitcnt lgkmcnt(13)
    v_mfma_f32_16x16x32_bf16 v[160:163], v[48:51], v[108:111], v[160:163]
    v_mfma_f32_16x16x32_bf16 v[164:167], v[52:55], v[108:111], v[164:167]
    s_waitcnt lgkmcnt(12)
    v_mfma_f32_16x16x32_bf16 v[160:163], v[56:59], v[112:115], v[160:163]
    v_mfma_f32_16x16x32_bf16 v[164:167], v[60:63], v[112:115], v[164:167]
    s_waitcnt lgkmcnt(11)
    v_mfma_f32_16x16x32_bf16 v[160:163], v[64:67], v[116:119], v[160:163]
    v_mfma_f32_16x16x32_bf16 v[164:167], v[68:71], v[116:119], v[164:167]
    s_waitcnt lgkmcnt(6)
    v_mfma_f32_16x16x32_bf16 v[160:163], v[72:75], v[120:123], v[160:163]
    v_mfma_f32_16x16x32_bf16 v[164:167], v[76:79], v[120:123], v[164:167]
    s_waitcnt lgkmcnt(1)
    v_mfma_f32_16x16x32_bf16 v[160:163], v[80:83], v[124:127], v[160:163]
    v_mfma_f32_16x16x32_bf16 v[164:167], v[84:87], v[124:127], v[164:167]
    s_waitcnt lgkmcnt(0)
    v_mfma_f32_16x16x32_bf16 v[160:163], v[88:91], v[128:131], v[160:163]
    v_mfma_f32_16x16x32_bf16 v[164:167], v[92:95], v[128:131], v[164:167]
    s_cmp_eq_u32 s13, 0
    s_cselect_b64 vcc, -1, 0
    s_nop 5
    v_cndmask_b32 v24, v160, v161, s[10:11]
    v_cndmask_b32 v25, v162, v163, s[10:11]
    v_cndmask_b32 v26, v164, v165, s[10:11]
    v_cndmask_b32 v27, v166, v167, s[10:11]
    v_cndmask_b32 v28, v24, v25, vcc
    v_cndmask_b32 v29, v26, v27, vcc
    ds_write_b64 v9, v[28:29]
    v_cndmask_b32 v24, v25, v24, vcc
    v_cndmask_b32 v25, v27, v26, vcc
    s_waitcnt lgkmcnt(0)
    s_barrier
    ds_read_b64 v[28:29], v10
    s_waitcnt lgkmcnt(0)
    v_add_f32 v24, v24, v28
    v_add_f32 v25, v25, v29
    v_cvt_pk_bf16_f32 v24, v24, v25
    v_lshlrev_b32 v25, 16, v24
    v_mul_f32 v26, 0xbfb8aa3b, v25
    v_exp_f32 v26, v26
    v_and_b32 v24, 0xffff0000, v24
    v_add_f32 v26, 1.0, v26
    v_rcp_f32 v26, v26
    s_nop 0
    v_mul_f32 v25, v25, v26
    v_cvt_pk_bf16_f32 v25, v25, v25
    v_and_b32 v25, 0xffff0000, v25
    v_mul_f32 v24, v24, v25
    v_cvt_pk_bf16_f32 v24, v24, v24
    v_bfi_b32 v24, s76, v14, v24
    global_store_dword v11, v24, s[50:51]
    global_store_dword v11, v24, s[50:51] offset:2048 sc1
    s_endpgm
SEL_MAIN:
    v_min_u32 v19, 8, v2
    v_lshlrev_b32 v19, 7, v19
    v_lshlrev_b32 v20, 2, v2
    v_lshrrev_b32 v24, 2, v2
    v_mul_u32_u24 v24, 128, v24
    v_and_b32 v37, 3, v2
    v_lshl_add_u32 v24, v37, 4, v24
    v_lshrrev_b32 v36, 1, v2
    v_mul_u32_u24 v36, 128, v36
    v_and_b32 v37, 1, v2
    v_lshl_add_u32 v36, v37, 4, v36
    v_add_u32 v36, 10304, v36
    s_mul_i32 s8, s3, 2048
    v_add_u32 v24, s8, v24
    s_cmp_eq_u32 s3, 7
    s_cselect_b64 vcc, -1, 0
    v_cndmask_b32 v24, v24, v36, vcc
    v_add_u32 v24, 4096, v24
    s_lshl_b32 s8, s3, 8
    s_sub_u32 s8, 0xfff, s8
    v_sub_u32 v32, s8, v20
    v_subrev_u32 v33, 1, v32
    v_subrev_u32 v34, 2, v32
    v_subrev_u32 v35, 3, v32
    v_mov_b32 v21, 163456
    s_lshl_b32 s8, s3, 5
    s_add_u32 s8, s8, 163200
    v_lshl_add_u32 v25, v4, 3, s8
    s_mov_b32 s74, 0x01010101
    s_mov_b32 s75, 0x01010101
    s_lshl_b32 s9, s4, 10
    s_add_u32 s9, s9, 40960
    v_lshl_add_u32 v53, v2, 4, s9
    global_load_dword v54, v53, s[50:51] sc1
    v_lshrrev_b32 v52, 3, v2
    v_lshl_add_u32 v52, v52, 6, s9
    v_and_b32 v27, 28, v20
    v_add_u32 v27, s8, v27
    v_add_u32 v26, 163200, v20
    s_mov_b32 s76, 0xffff
    s_mov_b32 s10, 0x00010001
    s_mov_b32 s11, 0x00010001
    s_barrier
    ds_read_b32 v14, v21 offset:4
    s_mov_b32 s7, 0
    s_waitcnt lgkmcnt(0)
    s_waitcnt vmcnt(0)
F_POLL:
    global_load_dwordx4 v[28:31], v24, s[50:51] sc1
    s_add_u32 s7, s7, 1
    s_waitcnt vmcnt(0)
    v_xor_b32 v36, v28, v14
    v_bitop3_b32 v36, v36, v29, v14 bitop3:0xf6
    v_bitop3_b32 v36, v36, v30, v14 bitop3:0xf6
    v_bitop3_b32 v36, v36, v31, v14 bitop3:0xf6
    v_and_b32 v36, 0xffff, v36
    v_cmp_ne_u32 vcc, 0, v36
    s_cmp_ge_u32 s7, 16384
    s_cbranch_scc1 F_GOT
    s_cbranch_vccz F_GOT
    s_mov_b64 exec, vcc
    s_sleep 4
    s_branch F_POLL
F_GOT:
    s_mov_b64 exec, -1
    v_bfi_b32 v28, s76, v32, v28
    v_bfi_b32 v29, s76, v33, v29
    v_bfi_b32 v30, s76, v34, v30
    v_bfi_b32 v31, s76, v35, v31
    v_max_u32 v36, v28, v29
    v_min_u32 v37, v28, v29
    v_max3_u32 v40, v36, v30, v31
    v_med3_u32 v41, v36, v30, v31
    v_med3_u32 v42, v37, v30, v31
    v_max_u32 v41, v41, v37
    v_min_u32 v42, v42, v36
    v_max_u32_dpp v44, v40, v40 row_ror:8 row_mask:0xf bank_mask:0xf
    s_nop 1
    v_max_u32_dpp v44, v44, v44 row_ror:4 row_mask:0xf bank_mask:0xf
    s_nop 1
    v_max_u32_dpp v44, v44, v44 row_ror:2 row_mask:0xf bank_mask:0xf
    s_nop 1
    v_max_u32_dpp v44, v44, v44 row_ror:1 row_mask:0xf bank_mask:0xf
    v_cmp_eq_u32 vcc, v40, v44
    s_nop 1
    v_cndmask_b32 v40, v40, v41, vcc
    v_cndmask_b32 v41, v41, v42, vcc
    s_nop 0
    v_max_u32_dpp v45, v40, v40 row_ror:8 row_mask:0xf bank_mask:0xf
    s_nop 1
    v_max_u32_dpp v45, v45, v45 row_ror:4 row_mask:0xf bank_mask:0xf
    s_nop 1
    v_max_u32_dpp v45, v45, v45 row_ror:2 row_mask:0xf bank_mask:0xf
    s_nop 1
    v_max_u32_dpp v45, v45, v45 row_ror:1 row_mask:0xf bank_mask:0xf
    v_cmp_eq_u32 vcc, v40, v45
    s_nop 1
    v_cndmask_b32 v40, v40, v41, vcc
    s_nop 1
    v_max_u32_dpp v46, v40, v40 row_ror:8 row_mask:0xf bank_mask:0xf
    s_nop 1
    v_max_u32_dpp v46, v46, v46 row_ror:4 row_mask:0xf bank_mask:0xf
    s_nop 1
    v_max_u32_dpp v46, v46, v46 row_ror:2 row_mask:0xf bank_mask:0xf
    s_nop 1
    v_max_u32_dpp v46, v46, v46 row_ror:1 row_mask:0xf bank_mask:0xf
    s_mov_b64 exec, s[10:11]
    ds_write_b64 v25, v[44:45]
    ds_max_u32 v21, v46
    s_mov_b64 exec, -1
    v_readlane_b32 s77, v44, 0
    v_readlane_b32 s78, v45, 0
    v_readlane_b32 s79, v44, 16
    v_readlane_b32 s80, v45, 16
    v_readlane_b32 s81, v44, 32
    v_readlane_b32 s82, v45, 32
    v_readlane_b32 s83, v44, 48
    v_readlane_b32 s100, v45, 48
    ds_read_b32 v48, v27
    v_mov_b32 v49, v14
    s_lshl_b32 s72, s4, 8
    s_lshl_b32 s73, s4, 10
    s_add_u32 s73, s73, 49152
    s_waitcnt lgkmcnt(0)
    s_barrier
    ds_read_b32 v36, v26
    ds_read_b32 v37, v21
    v_not_b32 v50, v48
    v_and_b32 v50, 0x7ff, v50
    v_mul_u32_u24 v50, 1152, v50
    s_waitcnt lgkmcnt(0)
    v_cmp_gt_u32 vcc, v36, v37
    v_cmp_lt_u32 s[18:19], s77, v36
    v_cmp_lt_u32 s[20:21], s78, v36
    v_cmp_lt_u32 s[22:23], s79, v36
    v_cmp_lt_u32 s[24:25], s80, v36
    v_cmp_lt_u32 s[26:27], s81, v36
    v_cmp_lt_u32 s[28:29], s82, v36
    v_cmp_lt_u32 s[30:31], s83, v36
    v_cmp_lt_u32 s[34:35], s100, v36
    s_bcnt1_i32_b64 s8, vcc
    s_cmp_lt_u32 s8, 8
    s_cbranch_scc1 F_SLOW
    s_bcnt1_i32_b64 s18, s[18:19]
    s_lshl_b64 exec, s[74:75], 0
    v_mov_b32 v37, s18
    s_bcnt1_i32_b64 s20, s[20:21]
    s_lshl_b64 exec, s[74:75], 1
    v_mov_b32 v37, s20
    s_bcnt1_i32_b64 s22, s[22:23]
    s_lshl_b64 exec, s[74:75], 2
    v_mov_b32 v37, s22
    s_bcnt1_i32_b64 s24, s[24:25]
    s_lshl_b64 exec, s[74:75], 3
    v_mov_b32 v37, s24
    s_bcnt1_i32_b64 s26, s[26:27]
    s_lshl_b64 exec, s[74:75], 4
    v_mov_b32 v37, s26
    s_bcnt1_i32_b64 s28, s[28:29]
    s_lshl_b64 exec, s[74:75], 5
    v_mov_b32 v37, s28
    s_bcnt1_i32_b64 s30, s[30:31]
    s_lshl_b64 exec, s[74:75], 6
    v_mov_b32 v37, s30
    s_bcnt1_i32_b64 s34, s[34:35]
    s_lshl_b64 exec, s[74:75], 7
    v_mov_b32 v37, s34
    s_mov_b64 exec, -1
    v_cmp_gt_u32 vcc, 8, v37
    v_lshl_add_u32 v52, v37, 3, v52
    v_lshl_add_u32 v55, v37, 7, s73
    v_lshl_add_u32 v37, v37, 3, s72
    s_and_b64 exec, vcc, exec
    s_cbranch_execz F_REST
    global_store_dwordx2 v52, v[48:49], s[50:51]
    global_store_dwordx2 v52, v[48:49], s[50:51] offset:512
    s_and_b64 exec, vcc, 0xff
    global_store_dwordx2 v37, v[48:49], s[50:51] offset:256
    global_load_dword v51, v50, s[16:17] offset:0
    global_load_dword v51, v50, s[16:17] offset:128
    global_load_dword v51, v50, s[16:17] offset:256
    global_load_dword v51, v50, s[16:17] offset:384
    global_load_dword v51, v50, s[16:17] offset:512
    global_load_dword v51, v50, s[16:17] offset:640
    global_load_dword v51, v50, s[16:17] offset:768
    global_load_dword v51, v50, s[16:17] offset:896
    global_load_dword v51, v50, s[16:17] offset:1024
    global_store_dwordx2 v55, v[48:49], s[50:51] sc1
F_REST:
    s_mov_b64 exec, -1
    s_branch DN_L2
F_SLOW:
    v_lshrrev_b32 v24, 2, v2
    v_mul_u32_u24 v24, 128, v24
    v_and_b32 v27, 3, v2
    v_lshl_add_u32 v24, v27, 4, v24
    v_lshrrev_b32 v26, 1, v2
    v_mul_u32_u24 v26, 128, v26
    v_and_b32 v27, 1, v2
    v_lshl_add_u32 v26, v27, 4, v26
    v_add_u32 v26, 10304, v26
    v_add_u32 v24, 4096, v24
    v_add_u32 v26, 4096, v26
    global_load_dwordx4 v[28:31], v24, s[50:51] sc1
    v_add_u32 v24, 2048, v24
    global_load_dwordx4 v[32:35], v24, s[50:51] sc1
    v_add_u32 v24, 2048, v24
    global_load_dwordx4 v[36:39], v24, s[50:51] sc1
    v_add_u32 v24, 2048, v24
    global_load_dwordx4 v[40:43], v24, s[50:51] sc1
    v_add_u32 v24, 2048, v24
    global_load_dwordx4 v[44:47], v24, s[50:51] sc1
    v_add_u32 v24, 2048, v24
    global_load_dwordx4 v[48:51], v24, s[50:51] sc1
    v_add_u32 v24, 2048, v24
    global_load_dwordx4 v[52:55], v24, s[50:51] sc1
    v_add_u32 v24, 2048, v24
    global_load_dwordx4 v[56:59], v26, s[50:51] sc1
    v_add_u32 v24, 2048, v24
    v_sub_u32 v24, 0xfff, v20
    s_waitcnt vmcnt(0)
    v_subrev_u32 v25, 0, v24
    v_bfi_b32 v28, s76, v25, v28
    v_subrev_u32 v25, 1, v24
    v_bfi_b32 v29, s76, v25, v29
    v_subrev_u32 v25, 2, v24
    v_bfi_b32 v30, s76, v25, v30
    v_subrev_u32 v25, 3, v24
    v_bfi_b32 v31, s76, v25, v31
    v_subrev_u32 v25, 256, v24
    v_bfi_b32 v32, s76, v25, v32
    v_subrev_u32 v25, 257, v24
    v_bfi_b32 v33, s76, v25, v33
    v_subrev_u32 v25, 258, v24
    v_bfi_b32 v34, s76, v25, v34
    v_subrev_u32 v25, 259, v24
    v_bfi_b32 v35, s76, v25, v35
    v_subrev_u32 v25, 512, v24
    v_bfi_b32 v36, s76, v25, v36
    v_subrev_u32 v25, 513, v24
    v_bfi_b32 v37, s76, v25, v37
    v_subrev_u32 v25, 514, v24
    v_bfi_b32 v38, s76, v25, v38
    v_subrev_u32 v25, 515, v24
    v_bfi_b32 v39, s76, v25, v39
    v_subrev_u32 v25, 768, v24
    v_bfi_b32 v40, s76, v25, v40
    v_subrev_u32 v25, 769, v24
    v_bfi_b32 v41, s76, v25, v41
    v_subrev_u32 v25, 770, v24
    v_bfi_b32 v42, s76, v25, v42
    v_subrev_u32 v25, 771, v24
    v_bfi_b32 v43, s76, v25, v43
    v_subrev_u32 v25, 1024, v24
    v_bfi_b32 v44, s76, v25, v44
    v_subrev_u32 v25, 1025, v24
    v_bfi_b32 v45, s76, v25, v45
    v_subrev_u32 v25, 1026, v24
    v_bfi_b32 v46, s76, v25, v46
    v_subrev_u32 v25, 1027, v24
    v_bfi_b32 v47, s76, v25, v47
    v_subrev_u32 v25, 1280, v24
    v_bfi_b32 v48, s76, v25, v48
    v_subrev_u32 v25, 1281, v24
    v_bfi_b32 v49, s76, v25, v49
    v_subrev_u32 v25, 1282, v24
    v_bfi_b32 v50, s76, v25, v50
    v_subrev_u32 v25, 1283, v24
    v_bfi_b32 v51, s76, v25, v51
    v_subrev_u32 v25, 1536, v24
    v_bfi_b32 v52, s76, v25, v52
    v_subrev_u32 v25, 1537, v24
    v_bfi_b32 v53, s76, v25, v53
    v_subrev_u32 v25, 1538, v24
    v_bfi_b32 v54, s76, v25, v54
    v_subrev_u32 v25, 1539, v24
    v_bfi_b32 v55, s76, v25, v55
    v_subrev_u32 v25, 1792, v24
    v_bfi_b32 v56, s76, v25, v56
    v_subrev_u32 v25, 1793, v24
    v_bfi_b32 v57, s76, v25, v57
    v_subrev_u32 v25, 1794, v24
    v_bfi_b32 v58, s76, v25, v58
    v_subrev_u32 v25, 1795, v24
    v_bfi_b32 v59, s76, v25, v59
    s_mov_b32 s77, 0
    s_mov_b32 s7, 0
F_SLOOP:
    v_subrev_u32 v60, s77, v28
    v_subrev_u32 v61, s77, v29
    v_subrev_u32 v62, s77, v30
    v_subrev_u32 v63, s77, v31
    v_subrev_u32 v64, s77, v32
    v_subrev_u32 v65, s77, v33
    v_subrev_u32 v66, s77, v34
    v_subrev_u32 v67, s77, v35
    v_subrev_u32 v68, s77, v36
    v_subrev_u32 v69, s77, v37
    v_subrev_u32 v70, s77, v38
    v_subrev_u32 v71, s77, v39
    v_subrev_u32 v72, s77, v40
    v_subrev_u32 v73, s77, v41
    v_subrev_u32 v74, s77, v42
    v_subrev_u32 v75, s77, v43
    v_subrev_u32 v76, s77, v44
    v_subrev_u32 v77, s77, v45
    v_subrev_u32 v78, s77, v46
    v_subrev_u32 v79, s77, v47
    v_subrev_u32 v80, s77, v48
    v_subrev_u32 v81, s77, v49
    v_subrev_u32 v82, s77, v50
    v_subrev_u32 v83, s77, v51
    v_subrev_u32 v84, s77, v52
    v_subrev_u32 v85, s77, v53
    v_subrev_u32 v86, s77, v54
    v_subrev_u32 v87, s77, v55
    v_subrev_u32 v88, s77, v56
    v_subrev_u32 v89, s77, v57
    v_subrev_u32 v90, s77, v58
    v_subrev_u32 v91, s77, v59
    v_max_u32 v60, v60, v61
    v_max3_u32 v60, v60, v62, v63
    v_max3_u32 v60, v60, v64, v65
    v_max3_u32 v60, v60, v66, v67
    v_max3_u32 v60, v60, v68, v69
    v_max3_u32 v60, v60, v70, v71
    v_max3_u32 v60, v60, v72, v73
    v_max3_u32 v60, v60, v74, v75
    v_max3_u32 v60, v60, v76, v77
    v_max3_u32 v60, v60, v78, v79
    v_max3_u32 v60, v60, v80, v81
    v_max3_u32 v60, v60, v82, v83
    v_max3_u32 v60, v60, v84, v85
    v_max3_u32 v60, v60, v86, v87
    v_max3_u32 v60, v60, v88, v89
    v_max3_u32 v60, v60, v90, v91
    s_nop 1
    v_max_u32_dpp v60, v60, v60 row_shr:1 row_mask:0xf bank_mask:0xf
    s_nop 1
    v_max_u32_dpp v60, v60, v60 row_shr:2 row_mask:0xf bank_mask:0xf
    s_nop 1
    v_max_u32_dpp v60, v60, v60 row_shr:4 row_mask:0xf bank_mask:0xf
    s_nop 1
    v_max_u32_dpp v60, v60, v60 row_shr:8 row_mask:0xf bank_mask:0xf
    s_nop 1
    v_max_u32_dpp v60, v60, v60 row_bcast:15 row_mask:0xa bank_mask:0xf
    s_nop 1
    v_max_u32_dpp v60, v60, v60 row_bcast:31 row_mask:0xc bank_mask:0xf
    s_nop 0
    v_readlane_b32 s8, v60, 63
    s_add_u32 s77, s77, s8
    s_add_u32 s7, s7, 1
    s_cmp_le_u32 s7, s3
    s_cbranch_scc1 F_SLOOP
    s_mov_b64 exec, 1
    v_mov_b32 v48, s77
    v_mov_b32 v49, v14
    s_lshl_b32 s8, s3, 3
    s_add_u32 s8, s8, s72
    v_mov_b32 v50, s8
    global_store_dwordx2 v50, v[48:49], s[50:51] offset:256
    s_lshl_b32 s8, s3, 7
    s_add_u32 s8, s8, s73
    v_mov_b32 v50, s8
    global_store_dwordx2 v50, v[48:49], s[50:51] sc1
    s_branch F_REST
CK_MAIN:
    s_mul_i32 s13, s7, 8192
    s_add_u32 s13, s13, 120832
    s_lshr_b32 s14, s7, 1
    s_mul_i32 s14, s14, 60192
    s_and_b32 s8, s7, 1
    s_lshl_b32 s8, s8, 9
    s_add_u32 s14, s14, s8
    s_lshl_b32 s8, s12, 8
    s_add_u32 m0, s14, s8
    v_mov_b32 v124, 0
    v_mov_b32 v125, 0
    v_mov_b32 v126, 0
    v_mov_b32 v127, 0
    s_lshl_b32 s8, s12, 11
    s_add_u32 s8, s8, s13
    v_lshl_add_u32 v20, v2, 4, s8
    ds_write_b128 v20, v[124:127]
    ds_write_b128 v20, v[124:127] offset:1024
    v_mul_u32_u24 v128, 1056, v3
    v_lshl_add_u32 v128, v4, 4, v128
    v_add_u32 v128, s14, v128
    s_lshl_b32 s8, s3, 2
    s_add_u32 s9, s8, 153632
    v_mov_b32 v129, s9
    s_xor_b32 s8, s8, 16
    s_add_u32 s9, s8, 153632
    v_mov_b32 v130, s9
    v_mov_b32 v21, 0x3c00
    ds_write_addtid_b32 v21 offset:43296
    v_mov_b32 v22, 0x3fb8aa3b
    v_mov_b32 v23, 0x32a57060
    v_mov_b32 v24, 0x3fb8aa3b
    v_mov_b32 v25, 0x3e22f983
    s_mov_b32 s15, 0x7fff7fff
    s_cmp_eq_u32 s12, 0
    s_mov_b32 s73, 0x01000c0c
    s_cselect_b32 s73, s73, 0x03020c0c
    s_waitcnt vmcnt(6)
    v_mul_f32 v19, v18, v22
    v_fma_f32 v22, v18, v22, -v19
    v_exp_f32 v19, v19
    v_fma_f32 v22, v18, v23, v22
    v_mul_f32 v22, 0x3f317218, v22
    v_fma_f32 v19, v19, v22, v19
    v_cvt_pk_bf16_f32 v19, v19, v19
    v_and_b32 v18, 0xffff0000, v19
    v_pk_mul_f32 v[24:25], v[24:25], v[18:19] op_sel_hi:[1,0]
    s_waitcnt vmcnt(0)
    v_and_b32 v14, s15, v30
    v_and_b32 v15, s15, v31
    v_and_b32 v16, s15, v32
    v_and_b32 v17, s15, v33
    v_perm_b32 v8, v28, v28, s73
    v_perm_b32 v9, v29, v29, s73
    v_perm_b32 v10, v30, v30, s73
    v_perm_b32 v11, v31, v31, s73
    v_perm_b32 v12, v32, v32, s73
    v_perm_b32 v13, v33, v33, s73
    v_pk_max_u16 v14, v14, v15
    v_pk_max_u16 v16, v16, v17
    v_lshlrev_b32 v15, 16, v14
    v_lshlrev_b32 v17, 16, v16
    v_pk_mul_f32 v[14:15], v[14:15], v[16:17]
    v_pk_mul_f32 v[8:9], v[8:9], v[24:25]
    v_max_f32 v14, v14, v15
    v_pk_mul_f32 v[10:11], v[10:11], v[18:19] op_sel_hi:[1,0]
    v_mul_f32 v14, v14, v18
    v_pk_mul_f32 v[66:67], v[12:13], v[10:11] op_sel:[1,1] op_sel_hi:[1,0]
    v_pk_fma_f32 v[56:57], v[12:13], v[10:11], v[66:67] op_sel:[0,0,0] op_sel_hi:[0,1,1] neg_lo:[0,0,1]
    v_max_u32_dpp v14, v14, v14 row_shr:1 row_mask:0xf bank_mask:0xf
    v_mul_f32 v60, 0x41000000, v8
    v_mul_f32 v61, 0xc1000000, v9
    v_max_u32_dpp v14, v14, v14 row_shr:2 row_mask:0xf bank_mask:0xf
    v_mul_f32 v62, 0x43000000, v8
    v_mul_f32 v63, 0x43000000, v9
    v_max_u32_dpp v14, v14, v14 row_shr:4 row_mask:0xf bank_mask:0xf
    v_fract_f32 v59, v9
    v_fract_f32 v61, v61
    v_max_u32_dpp v14, v14, v14 row_shr:8 row_mask:0xf bank_mask:0xf
    v_fract_f32 v63, v63
    v_exp_f32 v20, v8
    v_max_u32_dpp v14, v14, v14 row_bcast:15 row_mask:0xa bank_mask:0xf
    v_exp_f32 v22, v60
    v_exp_f32 v26, v62
    v_max_u32_dpp v14, v14, v14 row_bcast:31 row_mask:0xc bank_mask:0xf
    v_cos_f32 v60, v61
    v_readlane_b32 s8, v14, 63
    v_sin_f32 v61, v61
    v_cos_f32 v58, v59
    v_sin_f32 v59, v59
    v_cos_f32 v62, v63
    v_sin_f32 v63, v63
    s_lshr_b32 s8, s8, 23
    s_sub_i32 s8, 258, s8
    s_max_i32 s8, s8, 1
    s_min_i32 s8, s8, 253
    s_lshl_b32 s10, s8, 23
    v_pk_mul_f32 v[60:61], v[60:61], v[22:23] op_sel_hi:[1,0]
    v_pk_mul_f32 v[58:59], v[58:59], v[20:21] op_sel_hi:[1,0]
    v_pk_mul_f32 v[62:63], v[62:63], v[26:27] op_sel_hi:[1,0]
    v_pk_mul_f32 v[56:57], v[56:57], s[10:11] op_sel_hi:[1,0]
    v_cvt_pk_f16_f32 v70, v60, v61
    ds_write_addtid_b32 v70 offset:44352
    v_cvt_pk_f16_f32 v71, v56, v57
    ds_write_addtid_b32 v71 offset:42240
    v_pk_mul_f32 v[66:67], v[56:57], v[58:59] op_sel:[1,1] op_sel_hi:[1,0]
    v_pk_fma_f32 v[40:41], v[56:57], v[58:59], v[66:67] op_sel:[0,0,0] op_sel_hi:[0,1,1] neg_lo:[0,0,1]
    v_cvt_pk_f16_f32 v72, v40, v41
    ds_write_addtid_b32 v72 offset:0
    v_pk_mul_f32 v[66:67], v[40:41], v[58:59] op_sel:[1,1] op_sel_hi:[1,0]
    v_pk_fma_f32 v[42:43], v[40:41], v[58:59], v[66:67] op_sel:[0,0,0] op_sel_hi:[0,1,1] neg_lo:[0,0,1]
    v_cvt_pk_f16_f32 v73, v42, v43
    ds_write_addtid_b32 v73 offset:1056
    v_pk_mul_f32 v[66:67], v[42:43], v[58:59] op_sel:[1,1] op_sel_hi:[1,0]
    v_pk_fma_f32 v[44:45], v[42:43], v[58:59], v[66:67] op_sel:[0,0,0] op_sel_hi:[0,1,1] neg_lo:[0,0,1]
    v_cvt_pk_f16_f32 v70, v44, v45
    ds_write_addtid_b32 v70 offset:2112
    v_pk_mul_f32 v[66:67], v[44:45], v[58:59] op_sel:[1,1] op_sel_hi:[1,0]
    v_pk_fma_f32 v[46:47], v[44:45], v[58:59], v[66:67] op_sel:[0,0,0] op_sel_hi:[0,1,1] neg_lo:[0,0,1]
    v_cvt_pk_f16_f32 v71, v46, v47
    ds_write_addtid_b32 v71 offset:3168
    v_pk_mul_f32 v[66:67], v[46:47], v[58:59] op_sel:[1,1] op_sel_hi:[1,0]
    v_pk_fma_f32 v[48:49], v[46:47], v[58:59], v[66:67] op_sel:[0,0,0] op_sel_hi:[0,1,1] neg_lo:[0,0,1]
    v_cvt_pk_f16_f32 v72, v48, v49
    ds_write_addtid_b32 v72 offset:4224
    v_pk_mul_f32 v[66:67], v[48:49], v[58:59] op_sel:[1,1] op_sel_hi:[1,0]
    v_pk_fma_f32 v[50:51], v[48:49], v[58:59], v[66:67] op_sel:[0,0,0] op_sel_hi:[0,1,1] neg_lo:[0,0,1]
    v_cvt_pk_f16_f32 v73, v50, v51
    ds_write_addtid_b32 v73 offset:5280
    v_pk_mul_f32 v[66:67], v[50:51], v[58:59] op_sel:[1,1] op_sel_hi:[1,0]
    v_pk_fma_f32 v[52:53], v[50:51], v[58:59], v[66:67] op_sel:[0,0,0] op_sel_hi:[0,1,1] neg_lo:[0,0,1]
    v_cvt_pk_f16_f32 v70, v52, v53
    ds_write_addtid_b32 v70 offset:6336
    v_pk_mul_f32 v[66:67], v[52:53], v[58:59] op_sel:[1,1] op_sel_hi:[1,0]
    v_pk_fma_f32 v[54:55], v[52:53], v[58:59], v[66:67] op_sel:[0,0,0] op_sel_hi:[0,1,1] neg_lo:[0,0,1]
    v_cvt_pk_f16_f32 v71, v54, v55
    ds_write_addtid_b32 v71 offset:7392
    v_pk_mul_f32 v[66:67], v[40:41], v[62:63] op_sel:[1,1] op_sel_hi:[1,0]
    v_pk_fma_f32 v[40:41], v[40:41], v[62:63], v[66:67] op_sel:[0,0,0] op_sel_hi:[0,1,1] neg_lo:[0,0,1]
    v_cvt_pk_f16_f32 v72, v40, v41
    ds_write_addtid_b32 v72 offset:8448
    v_pk_mul_f32 v[66:67], v[42:43], v[62:63] op_sel:[1,1] op_sel_hi:[1,0]
    v_pk_fma_f32 v[42:43], v[42:43], v[62:63], v[66:67] op_sel:[0,0,0] op_sel_hi:[0,1,1] neg_lo:[0,0,1]
    v_cvt_pk_f16_f32 v73, v42, v43
    ds_write_addtid_b32 v73 offset:9504
    v_pk_mul_f32 v[66:67], v[44:45], v[62:63] op_sel:[1,1] op_sel_hi:[1,0]
    v_pk_fma_f32 v[44:45], v[44:45], v[62:63], v[66:67] op_sel:[0,0,0] op_sel_hi:[0,1,1] neg_lo:[0,0,1]
    v_cvt_pk_f16_f32 v70, v44, v45
    ds_write_addtid_b32 v70 offset:10560
    v_pk_mul_f32 v[66:67], v[46:47], v[62:63] op_sel:[1,1] op_sel_hi:[1,0]
    v_pk_fma_f32 v[46:47], v[46:47], v[62:63], v[66:67] op_sel:[0,0,0] op_sel_hi:[0,1,1] neg_lo:[0,0,1]
    v_cvt_pk_f16_f32 v71, v46, v47
    ds_write_addtid_b32 v71 offset:11616
    v_pk_mul_f32 v[66:67], v[48:49], v[62:63] op_sel:[1,1] op_sel_hi:[1,0]
    v_pk_fma_f32 v[48:49], v[48:49], v[62:63], v[66:67] op_sel:[0,0,0] op_sel_hi:[0,1,1] neg_lo:[0,0,1]
    v_cvt_pk_f16_f32 v72, v48, v49
    ds_write_addtid_b32 v72 offset:12672
    v_pk_mul_f32 v[66:67], v[50:51], v[62:63] op_sel:[1,1] op_sel_hi:[1,0]
    v_pk_fma_f32 v[50:51], v[50:51], v[62:63], v[66:67] op_sel:[0,0,0] op_sel_hi:[0,1,1] neg_lo:[0,0,1]
    v_cvt_pk_f16_f32 v73, v50, v51
    ds_write_addtid_b32 v73 offset:13728
    v_pk_mul_f32 v[66:67], v[52:53], v[62:63] op_sel:[1,1] op_sel_hi:[1,0]
    v_pk_fma_f32 v[52:53], v[52:53], v[62:63], v[66:67] op_sel:[0,0,0] op_sel_hi:[0,1,1] neg_lo:[0,0,1]
    v_cvt_pk_f16_f32 v70, v52, v53
    ds_write_addtid_b32 v70 offset:14784
    v_pk_mul_f32 v[66:67], v[54:55], v[62:63] op_sel:[1,1] op_sel_hi:[1,0]
    v_pk_fma_f32 v[54:55], v[54:55], v[62:63], v[66:67] op_sel:[0,0,0] op_sel_hi:[0,1,1] neg_lo:[0,0,1]
    v_cvt_pk_f16_f32 v71, v54, v55
    ds_write_addtid_b32 v71 offset:15840
    v_pk_mul_f32 v[66:67], v[42:43], v[62:63] op_sel:[1,1] op_sel_hi:[1,0]
    v_pk_fma_f32 v[42:43], v[42:43], v[62:63], v[66:67] op_sel:[0,0,0] op_sel_hi:[0,1,1] neg_lo:[0,0,1]
    v_cvt_pk_f16_f32 v72, v42, v43
    ds_write_addtid_b32 v72 offset:16896
    v_pk_mul_f32 v[66:67], v[46:47], v[62:63] op_sel:[1,1] op_sel_hi:[1,0]
    v_pk_fma_f32 v[46:47], v[46:47], v[62:63], v[66:67] op_sel:[0,0,0] op_sel_hi:[0,1,1] neg_lo:[0,0,1]
    v_cvt_pk_f16_f32 v73, v46, v47
    ds_write_addtid_b32 v73 offset:17952
    v_pk_mul_f32 v[66:67], v[50:51], v[62:63] op_sel:[1,1] op_sel_hi:[1,0]
    v_pk_fma_f32 v[50:51], v[50:51], v[62:63], v[66:67] op_sel:[0,0,0] op_sel_hi:[0,1,1] neg_lo:[0,0,1]
    v_cvt_pk_f16_f32 v70, v50, v51
    ds_write_addtid_b32 v70 offset:19008
    v_pk_mul_f32 v[66:67], v[54:55], v[62:63] op_sel:[1,1] op_sel_hi:[1,0]
    v_pk_fma_f32 v[54:55], v[54:55], v[62:63], v[66:67] op_sel:[0,0,0] op_sel_hi:[0,1,1] neg_lo:[0,0,1]
    v_cvt_pk_f16_f32 v71, v54, v55
    ds_write_addtid_b32 v71 offset:20064
    v_pk_mul_f32 v[66:67], v[42:43], v[62:63] op_sel:[1,1] op_sel_hi:[1,0]
    v_pk_fma_f32 v[42:43], v[42:43], v[62:63], v[66:67] op_sel:[0,0,0] op_sel_hi:[0,1,1] neg_lo:[0,0,1]
    v_cvt_pk_f16_f32 v72, v42, v43
    ds_write_addtid_b32 v72 offset:21120
    v_pk_mul_f32 v[66:67], v[46:47], v[62:63] op_sel:[1,1] op_sel_hi:[1,0]
    v_pk_fma_f32 v[46:47], v[46:47], v[62:63], v[66:67] op_sel:[0,0,0] op_sel_hi:[0,1,1] neg_lo:[0,0,1]
    v_cvt_pk_f16_f32 v73, v46, v47
    ds_write_addtid_b32 v73 offset:22176
    v_pk_mul_f32 v[66:67], v[50:51], v[62:63] op_sel:[1,1] op_sel_hi:[1,0]
    v_pk_fma_f32 v[50:51], v[50:51], v[62:63], v[66:67] op_sel:[0,0,0] op_sel_hi:[0,1,1] neg_lo:[0,0,1]
    v_cvt_pk_f16_f32 v70, v50, v51
    ds_write_addtid_b32 v70 offset:23232
    v_pk_mul_f32 v[66:67], v[54:55], v[62:63] op_sel:[1,1] op_sel_hi:[1,0]
    v_pk_fma_f32 v[54:55], v[54:55], v[62:63], v[66:67] op_sel:[0,0,0] op_sel_hi:[0,1,1] neg_lo:[0,0,1]
    v_cvt_pk_f16_f32 v71, v54, v55
    ds_write_addtid_b32 v71 offset:24288
    v_pk_mul_f32 v[66:67], v[46:47], v[62:63] op_sel:[1,1] op_sel_hi:[1,0]
    v_pk_fma_f32 v[46:47], v[46:47], v[62:63], v[66:67] op_sel:[0,0,0] op_sel_hi:[0,1,1] neg_lo:[0,0,1]
    v_cvt_pk_f16_f32 v72, v46, v47
    ds_write_addtid_b32 v72 offset:25344
    v_pk_mul_f32 v[66:67], v[54:55], v[62:63] op_sel:[1,1] op_sel_hi:[1,0]
    v_pk_fma_f32 v[54:55], v[54:55], v[62:63], v[66:67] op_sel:[0,0,0] op_sel_hi:[0,1,1] neg_lo:[0,0,1]
    v_cvt_pk_f16_f32 v73, v54, v55
    ds_write_addtid_b32 v73 offset:26400
    v_pk_mul_f32 v[66:67], v[46:47], v[62:63] op_sel:[1,1] op_sel_hi:[1,0]
    v_pk_fma_f32 v[46:47], v[46:47], v[62:63], v[66:67] op_sel:[0,0,0] op_sel_hi:[0,1,1] neg_lo:[0,0,1]
    v_cvt_pk_f16_f32 v70, v46, v47
    ds_write_addtid_b32 v70 offset:27456
    v_pk_mul_f32 v[66:67], v[54:55], v[62:63] op_sel:[1,1] op_sel_hi:[1,0]
    v_pk_fma_f32 v[54:55], v[54:55], v[62:63], v[66:67] op_sel:[0,0,0] op_sel_hi:[0,1,1] neg_lo:[0,0,1]
    v_cvt_pk_f16_f32 v71, v54, v55
    ds_write_addtid_b32 v71 offset:28512
    v_pk_mul_f32 v[66:67], v[46:47], v[62:63] op_sel:[1,1] op_sel_hi:[1,0]
    v_pk_fma_f32 v[46:47], v[46:47], v[62:63], v[66:67] op_sel:[0,0,0] op_sel_hi:[0,1,1] neg_lo:[0,0,1]
    v_cvt_pk_f16_f32 v72, v46, v47
    ds_write_addtid_b32 v72 offset:29568
    v_pk_mul_f32 v[66:67], v[54:55], v[62:63] op_sel:[1,1] op_sel_hi:[1,0]
    v_pk_fma_f32 v[54:55], v[54:55], v[62:63], v[66:67] op_sel:[0,0,0] op_sel_hi:[0,1,1] neg_lo:[0,0,1]
    v_cvt_pk_f16_f32 v73, v54, v55
    ds_write_addtid_b32 v73 offset:30624
    v_pk_mul_f32 v[66:67], v[46:47], v[62:63] op_sel:[1,1] op_sel_hi:[1,0]
    v_pk_fma_f32 v[46:47], v[46:47], v[62:63], v[66:67] op_sel:[0,0,0] op_sel_hi:[0,1,1] neg_lo:[0,0,1]
    v_cvt_pk_f16_f32 v70, v46, v47
    ds_write_addtid_b32 v70 offset:31680
    v_pk_mul_f32 v[66:67], v[54:55], v[62:63] op_sel:[1,1] op_sel_hi:[1,0]
    v_pk_fma_f32 v[54:55], v[54:55], v[62:63], v[66:67] op_sel:[0,0,0] op_sel_hi:[0,1,1] neg_lo:[0,0,1]
    v_cvt_pk_f16_f32 v71, v54, v55
    ds_write_addtid_b32 v71 offset:32736
    v_pk_mul_f32 v[66:67], v[54:55], v[62:63] op_sel:[1,1] op_sel_hi:[1,0]
    v_pk_fma_f32 v[54:55], v[54:55], v[62:63], v[66:67] op_sel:[0,0,0] op_sel_hi:[0,1,1] neg_lo:[0,0,1]
    v_cvt_pk_f16_f32 v72, v54, v55
    ds_write_addtid_b32 v72 offset:33792
    v_pk_mul_f32 v[66:67], v[54:55], v[62:63] op_sel:[1,1] op_sel_hi:[1,0]
    v_pk_fma_f32 v[54:55], v[54:55], v[62:63], v[66:67] op_sel:[0,0,0] op_sel_hi:[0,1,1] neg_lo:[0,0,1]
    v_cvt_pk_f16_f32 v73, v54, v55
    ds_write_addtid_b32 v73 offset:34848
    v_pk_mul_f32 v[66:67], v[54:55], v[62:63] op_sel:[1,1] op_sel_hi:[1,0]
    v_pk_fma_f32 v[54:55], v[54:55], v[62:63], v[66:67] op_sel:[0,0,0] op_sel_hi:[0,1,1] neg_lo:[0,0,1]
    v_cvt_pk_f16_f32 v70, v54, v55
    ds_write_addtid_b32 v70 offset:35904
    v_pk_mul_f32 v[66:67], v[54:55], v[62:63] op_sel:[1,1] op_sel_hi:[1,0]
    v_pk_fma_f32 v[54:55], v[54:55], v[62:63], v[66:67] op_sel:[0,0,0] op_sel_hi:[0,1,1] neg_lo:[0,0,1]
    v_cvt_pk_f16_f32 v71, v54, v55
    ds_write_addtid_b32 v71 offset:36960
    v_pk_mul_f32 v[66:67], v[54:55], v[62:63] op_sel:[1,1] op_sel_hi:[1,0]
    v_pk_fma_f32 v[54:55], v[54:55], v[62:63], v[66:67] op_sel:[0,0,0] op_sel_hi:[0,1,1] neg_lo:[0,0,1]
    v_cvt_pk_f16_f32 v72, v54, v55
    ds_write_addtid_b32 v72 offset:38016
    v_pk_mul_f32 v[66:67], v[54:55], v[62:63] op_sel:[1,1] op_sel_hi:[1,0]
    v_pk_fma_f32 v[54:55], v[54:55], v[62:63], v[66:67] op_sel:[0,0,0] op_sel_hi:[0,1,1] neg_lo:[0,0,1]
    v_cvt_pk_f16_f32 v73, v54, v55
    ds_write_addtid_b32 v73 offset:39072
    v_pk_mul_f32 v[66:67], v[54:55], v[62:63] op_sel:[1,1] op_sel_hi:[1,0]
    v_pk_fma_f32 v[54:55], v[54:55], v[62:63], v[66:67] op_sel:[0,0,0] op_sel_hi:[0,1,1] neg_lo:[0,0,1]
    v_cvt_pk_f16_f32 v70, v54, v55
    ds_write_addtid_b32 v70 offset:40128
    v_pk_mul_f32 v[66:67], v[54:55], v[62:63] op_sel:[1,1] op_sel_hi:[1,0]
    v_pk_fma_f32 v[54:55], v[54:55], v[62:63], v[66:67] op_sel:[0,0,0] op_sel_hi:[0,1,1] neg_lo:[0,0,1]
    v_cvt_pk_f16_f32 v71, v54, v55
    ds_write_addtid_b32 v71 offset:41184
    v_pk_mul_f32 v[66:67], v[60:61], v[60:61] op_sel:[1,1] op_sel_hi:[1,0]
    v_pk_fma_f32 v[64:65], v[60:61], v[60:61], v[66:67] op_sel:[0,0,0] op_sel_hi:[0,1,1] neg_lo:[0,0,1]
    v_cvt_pk_f16_f32 v72, v64, v65
    ds_write_addtid_b32 v72 offset:45408
    v_pk_mul_f32 v[66:67], v[64:65], v[60:61] op_sel:[1,1] op_sel_hi:[1,0]
    v_pk_fma_f32 v[64:65], v[64:65], v[60:61], v[66:67] op_sel:[0,0,0] op_sel_hi:[0,1,1] neg_lo:[0,0,1]
    v_cvt_pk_f16_f32 v73, v64, v65
    ds_write_addtid_b32 v73 offset:46464
    v_pk_mul_f32 v[66:67], v[64:65], v[60:61] op_sel:[1,1] op_sel_hi:[1,0]
    v_pk_fma_f32 v[64:65], v[64:65], v[60:61], v[66:67] op_sel:[0,0,0] op_sel_hi:[0,1,1] neg_lo:[0,0,1]
    v_cvt_pk_f16_f32 v70, v64, v65
    ds_write_addtid_b32 v70 offset:47520
    v_pk_mul_f32 v[66:67], v[64:65], v[60:61] op_sel:[1,1] op_sel_hi:[1,0]
    v_pk_fma_f32 v[64:65], v[64:65], v[60:61], v[66:67] op_sel:[0,0,0] op_sel_hi:[0,1,1] neg_lo:[0,0,1]
    v_cvt_pk_f16_f32 v71, v64, v65
    ds_write_addtid_b32 v71 offset:48576
    v_pk_mul_f32 v[66:67], v[64:65], v[60:61] op_sel:[1,1] op_sel_hi:[1,0]
    v_pk_fma_f32 v[64:65], v[64:65], v[60:61], v[66:67] op_sel:[0,0,0] op_sel_hi:[0,1,1] neg_lo:[0,0,1]
    v_cvt_pk_f16_f32 v72, v64, v65
    ds_write_addtid_b32 v72 offset:49632
    v_pk_mul_f32 v[66:67], v[64:65], v[60:61] op_sel:[1,1] op_sel_hi:[1,0]
    v_pk_fma_f32 v[64:65], v[64:65], v[60:61], v[66:67] op_sel:[0,0,0] op_sel_hi:[0,1,1] neg_lo:[0,0,1]
    v_cvt_pk_f16_f32 v73, v64, v65
    ds_write_addtid_b32 v73 offset:50688
    v_pk_mul_f32 v[66:67], v[64:65], v[60:61] op_sel:[1,1] op_sel_hi:[1,0]
    v_pk_fma_f32 v[64:65], v[64:65], v[60:61], v[66:67] op_sel:[0,0,0] op_sel_hi:[0,1,1] neg_lo:[0,0,1]
    v_cvt_pk_f16_f32 v70, v64, v65
    ds_write_addtid_b32 v70 offset:51744
    v_pk_mul_f32 v[66:67], v[64:65], v[60:61] op_sel:[1,1] op_sel_hi:[1,0]
    v_pk_fma_f32 v[64:65], v[64:65], v[60:61], v[66:67] op_sel:[0,0,0] op_sel_hi:[0,1,1] neg_lo:[0,0,1]
    v_cvt_pk_f16_f32 v71, v64, v65
    ds_write_addtid_b32 v71 offset:52800
    v_pk_mul_f32 v[66:67], v[64:65], v[60:61] op_sel:[1,1] op_sel_hi:[1,0]
    v_pk_fma_f32 v[64:65], v[64:65], v[60:61], v[66:67] op_sel:[0,0,0] op_sel_hi:[0,1,1] neg_lo:[0,0,1]
    v_cvt_pk_f16_f32 v72, v64, v65
    ds_write_addtid_b32 v72 offset:53856
    v_pk_mul_f32 v[66:67], v[64:65], v[60:61] op_sel:[1,1] op_sel_hi:[1,0]
    v_pk_fma_f32 v[64:65], v[64:65], v[60:61], v[66:67] op_sel:[0,0,0] op_sel_hi:[0,1,1] neg_lo:[0,0,1]
    v_cvt_pk_f16_f32 v73, v64, v65
    ds_write_addtid_b32 v73 offset:54912
    v_pk_mul_f32 v[66:67], v[64:65], v[60:61] op_sel:[1,1] op_sel_hi:[1,0]
    v_pk_fma_f32 v[64:65], v[64:65], v[60:61], v[66:67] op_sel:[0,0,0] op_sel_hi:[0,1,1] neg_lo:[0,0,1]
    v_cvt_pk_f16_f32 v70, v64, v65
    ds_write_addtid_b32 v70 offset:55968
    v_pk_mul_f32 v[66:67], v[64:65], v[60:61] op_sel:[1,1] op_sel_hi:[1,0]
    v_pk_fma_f32 v[64:65], v[64:65], v[60:61], v[66:67] op_sel:[0,0,0] op_sel_hi:[0,1,1] neg_lo:[0,0,1]
    v_cvt_pk_f16_f32 v71, v64, v65
    ds_write_addtid_b32 v71 offset:57024
    v_pk_mul_f32 v[66:67], v[64:65], v[60:61] op_sel:[1,1] op_sel_hi:[1,0]
    v_pk_fma_f32 v[64:65], v[64:65], v[60:61], v[66:67] op_sel:[0,0,0] op_sel_hi:[0,1,1] neg_lo:[0,0,1]
    v_cvt_pk_f16_f32 v72, v64, v65
    ds_write_addtid_b32 v72 offset:58080
    v_pk_mul_f32 v[66:67], v[64:65], v[60:61] op_sel:[1,1] op_sel_hi:[1,0]
    v_pk_fma_f32 v[64:65], v[64:65], v[60:61], v[66:67] op_sel:[0,0,0] op_sel_hi:[0,1,1] neg_lo:[0,0,1]
    v_cvt_pk_f16_f32 v73, v64, v65
    ds_write_addtid_b32 v73 offset:59136
CK_SKIP:
    ds_write_b32 v129, v129
    s_mov_b32 s9, 0
CK_PAIR:
    ds_read_b32 v8, v130
    s_add_u32 s9, s9, 1
    s_waitcnt lgkmcnt(0)
    v_cmp_eq_u32 vcc, 0, v8
    s_cmp_ge_u32 s9, 0x40000
    s_cbranch_scc1 CK_PAIRED
    s_cbranch_vccnz CK_PAIR
CK_PAIRED:
    s_cmp_eq_u32 s12, 0
    s_cbranch_scc0 CK_T1
    ds_read_b128 v[8:11], v128 offset:43296
    ds_read_b128 v[40:43], v128 offset:0
    ds_read_b128 v[12:15], v128 offset:43360
    ds_read_b128 v[44:47], v128 offset:64
    ds_read_b128 v[16:19], v128 offset:43424
    ds_read_b128 v[48:51], v128 offset:128
    ds_read_b128 v[20:23], v128 offset:43488
    ds_read_b128 v[52:55], v128 offset:192
    s_lshl_b32 s9, s7, 2
    s_add_u32 s9, s9, 153616
    v_mov_b32 v112, s9
    v_mov_b32 v113, s8
    ds_read_b128 v[24:27], v128 offset:43552
    ds_read_b128 v[56:59], v128 offset:256
    ds_read_b128 v[28:31], v128 offset:43616
    ds_read_b128 v[60:63], v128 offset:320
    ds_read_b128 v[32:35], v128 offset:43680
    ds_read_b128 v[64:67], v128 offset:384
    ds_read_b128 v[36:39], v128 offset:43744
    ds_read_b128 v[68:71], v128 offset:448
    v_lshrrev_b32 v114, 1, v4
    v_lshlrev_b32 v114, 8, v114
    v_lshl_add_u32 v114, v3, 4, v114
    v_and_b32 v115, 1, v4
    v_lshl_add_u32 v114, v115, 3, v114
    v_add_u32 v114, s13, v114
    v_lshlrev_b32 v115, 5, v3
    v_lshl_add_u32 v115, v4, 3, v115
    v_add_u32 v115, s13, v115
    v_mov_b32 v116, s13
    s_waitcnt lgkmcnt(14)
    v_mfma_f32_16x16x32_f16 v[104:107], v[40:43], v[8:11], 0
    ds_read_b128 v[72:75], v128 offset:33792
    s_waitcnt lgkmcnt(13)
    v_mfma_f32_16x16x32_f16 v[104:107], v[44:47], v[12:15], v[104:107]
    ds_read_b128 v[76:79], v128 offset:33856
    s_waitcnt lgkmcnt(12)
    v_mfma_f32_16x16x32_f16 v[104:107], v[48:51], v[16:19], v[104:107]
    ds_read_b128 v[80:83], v128 offset:33920
    s_waitcnt lgkmcnt(11)
    v_mfma_f32_16x16x32_f16 v[104:107], v[52:55], v[20:23], v[104:107]
    ds_read_b128 v[84:87], v128 offset:33984
    s_waitcnt lgkmcnt(10)
    v_mfma_f32_16x16x32_f16 v[104:107], v[56:59], v[24:27], v[104:107]
    ds_read_b128 v[88:91], v128 offset:34048
    s_waitcnt lgkmcnt(9)
    v_mfma_f32_16x16x32_f16 v[104:107], v[60:63], v[28:31], v[104:107]
    ds_read_b128 v[92:95], v128 offset:34112
    s_waitcnt lgkmcnt(8)
    v_mfma_f32_16x16x32_f16 v[104:107], v[64:67], v[32:35], v[104:107]
    ds_read_b128 v[96:99], v128 offset:34176
    s_waitcnt lgkmcnt(7)
    v_mfma_f32_16x16x32_f16 v[104:107], v[68:71], v[36:39], v[104:107]
    ds_read_b128 v[100:103], v128 offset:34240
    s_waitcnt lgkmcnt(7)
    v_mfma_f32_16x16x32_f16 v[108:111], v[8:11], v[72:75], 0
    s_waitcnt lgkmcnt(6)
    v_mfma_f32_16x16x32_f16 v[108:111], v[12:15], v[76:79], v[108:111]
    s_waitcnt lgkmcnt(5)
    v_mfma_f32_16x16x32_f16 v[108:111], v[16:19], v[80:83], v[108:111]
    s_waitcnt lgkmcnt(4)
    v_mfma_f32_16x16x32_f16 v[108:111], v[20:23], v[84:87], v[108:111]
    s_waitcnt lgkmcnt(3)
    v_mfma_f32_16x16x32_f16 v[108:111], v[24:27], v[88:91], v[108:111]
    s_waitcnt lgkmcnt(2)
    v_mfma_f32_16x16x32_f16 v[108:111], v[28:31], v[92:95], v[108:111]
    s_waitcnt lgkmcnt(1)
    v_mfma_f32_16x16x32_f16 v[108:111], v[32:35], v[96:99], v[108:111]
    s_waitcnt lgkmcnt(0)
    v_mfma_f32_16x16x32_f16 v[108:111], v[36:39], v[100:103], v[108:111]
    ds_write_b32 v112, v113
    v_cvt_pk_f16_f32 v118, v104, v105
    v_cvt_pk_f16_f32 v119, v106, v107
    v_cvt_pk_f16_f32 v120, v105, v106
    v_cvt_pk_f16_f32 v121, v107, v107
    ds_write_b16 v114, v121 offset:1256
    ds_write_b64 v114, v[120:121] offset:32
    ds_write_b64 v114, v[118:119] offset:1248
    ds_write_b16 v114, v118 offset:30
    v_cvt_pk_f16_f32 v118, v108, v109
    v_cvt_pk_f16_f32 v119, v110, v111
    s_mov_b32 s10, 0x00ff00ff
    s_mov_b32 s11, 0x00ff00ff
    s_mov_b64 exec, s[10:11]
    ds_write_b64 v115, v[118:119] offset:2912
    s_mov_b64 exec, 0x100
    ds_write_b16 v116, v118 offset:28
    ds_write_b16 v116, v118 offset:1246
    s_mov_b64 exec, -1
    v_mov_b32 v127, 153600
    v_mov_b32 v126, 1
    s_mov_b64 exec, 1
    ds_add_u32 v127, v126 offset:76
    s_mov_b64 exec, -1
    v_mul_u32_u24 v124, 320, v4
    v_lshl_add_u32 v124, v3, 4, v124
    s_mul_i32 s8, s7, 20480
    v_add_u32 v124, s8, v124
    s_lshl_b32 s8, s3, 2
    s_add_u32 s8, s8, 153856
    v_mov_b32 v125, s8
    v_and_b32 v5, 1, v3
    v_mul_u32_u24 v5, 1216, v5
    v_sub_u32 v5, 1264, v5
    v_lshrrev_b32 v6, 1, v3
    v_lshl_add_u32 v5, v6, 2, v5
    v_lshlrev_b32 v6, 4, v4
    v_sub_u32 v5, v5, v6
    v_add_u32 v5, s13, v5
    v_add_u32 v7, 576, v5
    v_lshl_add_u32 v6, v3, 5, v6
    v_add_u32 v6, 3616, v6
    v_add_u32 v6, s13, v6
    s_mov_b32 s9, 0
SPN2:
    ds_read_b32 v128, v127 offset:76
    s_add_u32 s9, s9, 1
    s_waitcnt lgkmcnt(0)
    v_cmp_ne_u32 vcc, 8, v128
    s_cmp_ge_u32 s9, 0x40000
    s_cbranch_scc1 SPX2
    s_cbranch_vccz SPX2
    s_sleep 1
    s_branch SPN2
SPX2:
    ds_read2_b32 v[36:37], v5 offset0:115 offset1:114
    ds_read2_b32 v[38:39], v5 offset0:113 offset1:112
    ds_read2_b32 v[32:33], v5 offset0:99 offset1:98
    ds_read2_b32 v[34:35], v5 offset0:97 offset1:96
    ds_read2_b32 v[28:29], v5 offset0:83 offset1:82
    ds_read2_b32 v[30:31], v5 offset0:81 offset1:80
    ds_read2_b32 v[24:25], v5 offset0:67 offset1:66
    ds_read2_b32 v[26:27], v5 offset0:65 offset1:64
    ds_read2_b32 v[20:21], v5 offset0:51 offset1:50
    ds_read2_b32 v[22:23], v5 offset0:49 offset1:48
    ds_read2_b32 v[16:17], v5 offset0:35 offset1:34
    ds_read2_b32 v[18:19], v5 offset0:33 offset1:32
    ds_read2_b32 v[12:13], v5 offset0:19 offset1:18
    ds_read2_b32 v[14:15], v5 offset0:17 offset1:16
    ds_read2_b32 v[8:9], v5 offset0:3 offset1:2
    ds_read2_b32 v[10:11], v5 offset0:1 offset1:0
    ds_read2_b32 v[68:69], v7 offset0:99 offset1:98
    ds_read2_b32 v[70:71], v7 offset0:97 offset1:96
    ds_read2_b32 v[64:65], v7 offset0:83 offset1:82
    ds_read2_b32 v[66:67], v7 offset0:81 offset1:80
    ds_read2_b32 v[60:61], v7 offset0:67 offset1:66
    ds_read2_b32 v[62:63], v7 offset0:65 offset1:64
    ds_read2_b32 v[56:57], v7 offset0:51 offset1:50
    ds_read2_b32 v[58:59], v7 offset0:49 offset1:48
    ds_read2_b32 v[52:53], v7 offset0:35 offset1:34
    ds_read2_b32 v[54:55], v7 offset0:33 offset1:32
    ds_read2_b32 v[48:49], v7 offset0:19 offset1:18
    ds_read2_b32 v[50:51], v7 offset0:17 offset1:16
    ds_read2_b32 v[44:45], v7 offset0:3 offset1:2
    ds_read2_b32 v[46:47], v7 offset0:1 offset1:0
    ds_read2_b32 v[40:41], v5 offset0:131 offset1:130
    ds_read2_b32 v[42:43], v5 offset0:129 offset1:128
    ds_read2_b32 v[72:73], v7 offset0:115 offset1:114
    ds_read2_b32 v[74:75], v7 offset0:113 offset1:112
D_PASS:
    s_mov_b32 s9, 0
SPN3:
    ds_read_b32 v128, v127 offset:240
    s_add_u32 s9, s9, 1
    s_waitcnt lgkmcnt(0)
    v_and_b32 v128, 15, v128
    v_cmp_ne_u32 vcc, 2, v128
    s_cmp_ge_u32 s9, 0x40000
    s_cbranch_scc1 SPX3
    s_cbranch_vccz SPX3
    s_sleep 1
    s_branch SPN3
SPX3:
D_LOOP:
    ds_read_b128 v[80:83], v6 offset:0
    ds_read_b128 v[84:87], v6 offset:64
    ds_read_b128 v[88:91], v6 offset:128
    ds_read_b128 v[92:95], v6 offset:192
    ds_read_b128 v[96:99], v6 offset:256
    ds_read_b128 v[100:103], v6 offset:320
    ds_read_b128 v[104:107], v6 offset:384
    s_waitcnt lgkmcnt(6)
    v_mfma_f32_16x16x32_f16 v[108:111], v[36:39], v[80:83], 0
    v_mfma_f32_16x16x32_f16 v[112:115], v[68:71], v[80:83], 0
    ds_read_b128 v[76:79], v6 offset:448
    s_waitcnt lgkmcnt(6)
    v_mfma_f32_16x16x32_f16 v[108:111], v[32:35], v[84:87], v[108:111]
    v_mfma_f32_16x16x32_f16 v[112:115], v[64:67], v[84:87], v[112:115]
    ds_read_b128 v[80:83], v6 offset:512
    s_waitcnt lgkmcnt(6)
    v_mfma_f32_16x16x32_f16 v[108:111], v[28:31], v[88:91], v[108:111]
    v_mfma_f32_16x16x32_f16 v[112:115], v[60:63], v[88:91], v[112:115]
    ds_read_b128 v[84:87], v6 offset:576
    s_waitcnt lgkmcnt(6)
    v_mfma_f32_16x16x32_f16 v[108:111], v[24:27], v[92:95], v[108:111]
    v_mfma_f32_16x16x32_f16 v[112:115], v[56:59], v[92:95], v[112:115]
    ds_read_b128 v[88:91], v6 offset:640
    s_waitcnt lgkmcnt(6)
    v_mfma_f32_16x16x32_f16 v[108:111], v[20:23], v[96:99], v[108:111]
    v_mfma_f32_16x16x32_f16 v[112:115], v[52:55], v[96:99], v[112:115]
    ds_read_b128 v[92:95], v6 offset:704
    s_waitcnt lgkmcnt(6)
    v_mfma_f32_16x16x32_f16 v[108:111], v[16:19], v[100:103], v[108:111]
    v_mfma_f32_16x16x32_f16 v[112:115], v[48:51], v[100:103], v[112:115]
    ds_read_b128 v[96:99], v6 offset:768
    s_waitcnt lgkmcnt(6)
    v_mfma_f32_16x16x32_f16 v[108:111], v[12:15], v[104:107], v[108:111]
    v_mfma_f32_16x16x32_f16 v[112:115], v[44:47], v[104:107], v[112:115]
    ds_read_b128 v[100:103], v6 offset:832
    s_waitcnt lgkmcnt(6)
    v_mfma_f32_16x16x32_f16 v[108:111], v[8:11], v[76:79], v[108:111]
    v_mfma_f32_16x16x32_f16 v[112:115], v[40:43], v[76:79], v[112:115]
    v_mfma_f32_16x16x32_f16 v[116:119], v[72:75], v[76:79], 0
    ds_read_b128 v[104:107], v6 offset:896
    s_waitcnt lgkmcnt(6)
    v_mfma_f32_16x16x32_f16 v[112:115], v[36:39], v[80:83], v[112:115]
    v_mfma_f32_16x16x32_f16 v[116:119], v[68:71], v[80:83], v[116:119]
    ds_read_b128 v[76:79], v6 offset:960
    s_waitcnt lgkmcnt(6)
    v_mfma_f32_16x16x32_f16 v[112:115], v[32:35], v[84:87], v[112:115]
    v_mfma_f32_16x16x32_f16 v[116:119], v[64:67], v[84:87], v[116:119]
    ds_read_b128 v[80:83], v6 offset:1024
    s_waitcnt lgkmcnt(6)
    v_mfma_f32_16x16x32_f16 v[112:115], v[28:31], v[88:91], v[112:115]
    ds_write_b64 v124, v[108:109] offset:0
    v_mfma_f32_16x16x32_f16 v[116:119], v[60:63], v[88:91], v[116:119]
    ds_read_b128 v[84:87], v6 offset:1088
    s_waitcnt lgkmcnt(7)
    v_mfma_f32_16x16x32_f16 v[112:115], v[24:27], v[92:95], v[112:115]
    ds_write_b64 v124, v[110:111] offset:8
    v_mfma_f32_16x16x32_f16 v[116:119], v[56:59], v[92:95], v[116:119]
    ds_read_b128 v[88:91], v6 offset:1152
    s_waitcnt lgkmcnt(8)
    v_mfma_f32_16x16x32_f16 v[112:115], v[20:23], v[96:99], v[112:115]
    ds_write_b32 v125, v126 offset:0
    v_mfma_f32_16x16x32_f16 v[116:119], v[52:55], v[96:99], v[116:119]
    ds_read_b128 v[92:95], v6 offset:1216
    s_waitcnt lgkmcnt(9)
    v_mfma_f32_16x16x32_f16 v[112:115], v[16:19], v[100:103], v[112:115]
    v_mfma_f32_16x16x32_f16 v[116:119], v[48:51], v[100:103], v[116:119]
    ds_read_b128 v[96:99], v6 offset:1280
    s_waitcnt lgkmcnt(9)
    v_mfma_f32_16x16x32_f16 v[112:115], v[12:15], v[104:107], v[112:115]
    v_mfma_f32_16x16x32_f16 v[116:119], v[44:47], v[104:107], v[116:119]
    ds_read_b128 v[100:103], v6 offset:1344
    s_waitcnt lgkmcnt(9)
    v_mfma_f32_16x16x32_f16 v[112:115], v[8:11], v[76:79], v[112:115]
    v_mfma_f32_16x16x32_f16 v[116:119], v[40:43], v[76:79], v[116:119]
    v_mfma_f32_16x16x32_f16 v[120:123], v[72:75], v[76:79], 0
    ds_read_b128 v[104:107], v6 offset:1408
    s_waitcnt lgkmcnt(9)
    v_mfma_f32_16x16x32_f16 v[116:119], v[36:39], v[80:83], v[116:119]
    v_mfma_f32_16x16x32_f16 v[120:123], v[68:71], v[80:83], v[120:123]
    ds_read_b128 v[76:79], v6 offset:1472
    s_waitcnt lgkmcnt(8)
    v_mfma_f32_16x16x32_f16 v[116:119], v[32:35], v[84:87], v[116:119]
    v_mfma_f32_16x16x32_f16 v[120:123], v[64:67], v[84:87], v[120:123]
    ds_read_b128 v[80:83], v6 offset:1536
    s_waitcnt lgkmcnt(7)
    v_mfma_f32_16x16x32_f16 v[116:119], v[28:31], v[88:91], v[116:119]
    ds_write_b64 v124, v[112:113] offset:1280
    v_mfma_f32_16x16x32_f16 v[120:123], v[60:63], v[88:91], v[120:123]
    ds_read_b128 v[84:87], v6 offset:1600
    s_waitcnt lgkmcnt(7)
    v_mfma_f32_16x16x32_f16 v[116:119], v[24:27], v[92:95], v[116:119]
    ds_write_b64 v124, v[114:115] offset:1288
    v_mfma_f32_16x16x32_f16 v[120:123], v[56:59], v[92:95], v[120:123]
    ds_read_b128 v[88:91], v6 offset:1664
    s_waitcnt lgkmcnt(8)
    v_mfma_f32_16x16x32_f16 v[116:119], v[20:23], v[96:99], v[116:119]
    ds_write_b32 v125, v126 offset:32
    v_mfma_f32_16x16x32_f16 v[120:123], v[52:55], v[96:99], v[120:123]
    ds_read_b128 v[92:95], v6 offset:1728
    s_waitcnt lgkmcnt(9)
    v_mfma_f32_16x16x32_f16 v[116:119], v[16:19], v[100:103], v[116:119]
    v_mfma_f32_16x16x32_f16 v[120:123], v[48:51], v[100:103], v[120:123]
    ds_read_b128 v[96:99], v6 offset:1792
    s_waitcnt lgkmcnt(9)
    v_mfma_f32_16x16x32_f16 v[116:119], v[12:15], v[104:107], v[116:119]
    v_mfma_f32_16x16x32_f16 v[120:123], v[44:47], v[104:107], v[120:123]
    ds_read_b128 v[100:103], v6 offset:1856
    s_waitcnt lgkmcnt(9)
    v_mfma_f32_16x16x32_f16 v[116:119], v[8:11], v[76:79], v[116:119]
    v_mfma_f32_16x16x32_f16 v[120:123], v[40:43], v[76:79], v[120:123]
    v_mfma_f32_16x16x32_f16 v[108:111], v[72:75], v[76:79], 0
    ds_read_b128 v[104:107], v6 offset:1920
    s_waitcnt lgkmcnt(9)
    v_mfma_f32_16x16x32_f16 v[120:123], v[36:39], v[80:83], v[120:123]
    v_mfma_f32_16x16x32_f16 v[108:111], v[68:71], v[80:83], v[108:111]
    ds_read_b128 v[76:79], v6 offset:1984
    s_waitcnt lgkmcnt(8)
    v_mfma_f32_16x16x32_f16 v[120:123], v[32:35], v[84:87], v[120:123]
    v_mfma_f32_16x16x32_f16 v[108:111], v[64:67], v[84:87], v[108:111]
    s_waitcnt lgkmcnt(6)
    v_mfma_f32_16x16x32_f16 v[120:123], v[28:31], v[88:91], v[120:123]
    ds_write_b64 v124, v[116:117] offset:2560
    v_mfma_f32_16x16x32_f16 v[108:111], v[60:63], v[88:91], v[108:111]
    s_waitcnt lgkmcnt(5)
    v_mfma_f32_16x16x32_f16 v[120:123], v[24:27], v[92:95], v[120:123]
    ds_write_b64 v124, v[118:119] offset:2568
    v_mfma_f32_16x16x32_f16 v[108:111], v[56:59], v[92:95], v[108:111]
    s_waitcnt lgkmcnt(5)
    v_mfma_f32_16x16x32_f16 v[120:123], v[20:23], v[96:99], v[120:123]
    ds_write_b32 v125, v126 offset:64
    v_mfma_f32_16x16x32_f16 v[108:111], v[52:55], v[96:99], v[108:111]
    s_waitcnt lgkmcnt(5)
    v_mfma_f32_16x16x32_f16 v[120:123], v[16:19], v[100:103], v[120:123]
    v_mfma_f32_16x16x32_f16 v[108:111], v[48:51], v[100:103], v[108:111]
    s_waitcnt lgkmcnt(4)
    v_mfma_f32_16x16x32_f16 v[120:123], v[12:15], v[104:107], v[120:123]
    v_mfma_f32_16x16x32_f16 v[108:111], v[44:47], v[104:107], v[108:111]
    s_waitcnt lgkmcnt(3)
    v_mfma_f32_16x16x32_f16 v[120:123], v[8:11], v[76:79], v[120:123]
    v_mfma_f32_16x16x32_f16 v[108:111], v[40:43], v[76:79], v[108:111]
    v_mfma_f32_16x16x32_f16 v[112:115], v[72:75], v[76:79], 0
    s_nop 7
    ds_write_b64 v124, v[120:121] offset:3840
    ds_write_b64 v124, v[122:123] offset:3848
    ds_write_b32 v125, v126 offset:96
    s_mov_b32 s9, 0
SPN4:
    ds_read_b32 v128, v127 offset:240
    s_add_u32 s9, s9, 1
    s_waitcnt lgkmcnt(0)
    v_and_b32 v128, 0xffff, v128
    v_cmp_ne_u32 vcc, 34, v128
    s_cmp_ge_u32 s9, 0x40000
    s_cbranch_scc1 SPX4
    s_cbranch_vccz SPX4
    s_sleep 1
    s_branch SPN4
SPX4:
    ds_read_b32 v128, v127 offset:240
    s_waitcnt lgkmcnt(0)
    v_cmp_ne_u32 vcc, 34, v128
    s_nop 0
    s_cbranch_vccnz D_REDO
    ds_read_b128 v[80:83], v6 offset:2048
    ds_read_b128 v[84:87], v6 offset:2112
    ds_read_b128 v[88:91], v6 offset:2176
    ds_read_b128 v[92:95], v6 offset:2240
    ds_read_b128 v[96:99], v6 offset:2304
    ds_read_b128 v[100:103], v6 offset:2368
    ds_read_b128 v[104:107], v6 offset:2432
    s_waitcnt lgkmcnt(6)
    v_mfma_f32_16x16x32_f16 v[108:111], v[36:39], v[80:83], v[108:111]
    v_mfma_f32_16x16x32_f16 v[112:115], v[68:71], v[80:83], v[112:115]
    ds_read_b128 v[76:79], v6 offset:2496
    s_waitcnt lgkmcnt(6)
    v_mfma_f32_16x16x32_f16 v[108:111], v[32:35], v[84:87], v[108:111]
    v_mfma_f32_16x16x32_f16 v[112:115], v[64:67], v[84:87], v[112:115]
    ds_read_b128 v[80:83], v6 offset:2560
    s_waitcnt lgkmcnt(6)
    v_mfma_f32_16x16x32_f16 v[108:111], v[28:31], v[88:91], v[108:111]
    v_mfma_f32_16x16x32_f16 v[112:115], v[60:63], v[88:91], v[112:115]
    ds_read_b128 v[84:87], v6 offset:2624
    s_waitcnt lgkmcnt(6)
    v_mfma_f32_16x16x32_f16 v[108:111], v[24:27], v[92:95], v[108:111]
    v_mfma_f32_16x16x32_f16 v[112:115], v[56:59], v[92:95], v[112:115]
    ds_read_b128 v[88:91], v6 offset:2688
    s_waitcnt lgkmcnt(6)
    v_mfma_f32_16x16x32_f16 v[108:111], v[20:23], v[96:99], v[108:111]
    v_mfma_f32_16x16x32_f16 v[112:115], v[52:55], v[96:99], v[112:115]
    ds_read_b128 v[92:95], v6 offset:2752
    s_waitcnt lgkmcnt(6)
    v_mfma_f32_16x16x32_f16 v[108:111], v[16:19], v[100:103], v[108:111]
    v_mfma_f32_16x16x32_f16 v[112:115], v[48:51], v[100:103], v[112:115]
    ds_read_b128 v[96:99], v6 offset:2816
    s_waitcnt lgkmcnt(6)
    v_mfma_f32_16x16x32_f16 v[108:111], v[12:15], v[104:107], v[108:111]
    v_mfma_f32_16x16x32_f16 v[112:115], v[44:47], v[104:107], v[112:115]
    ds_read_b128 v[100:103], v6 offset:2880
    s_waitcnt lgkmcnt(6)
    v_mfma_f32_16x16x32_f16 v[108:111], v[8:11], v[76:79], v[108:111]
    v_mfma_f32_16x16x32_f16 v[112:115], v[40:43], v[76:79], v[112:115]
    v_mfma_f32_16x16x32_f16 v[116:119], v[72:75], v[76:79], 0
    ds_read_b128 v[104:107], v6 offset:2944
    s_waitcnt lgkmcnt(6)
    v_mfma_f32_16x16x32_f16 v[112:115], v[36:39], v[80:83], v[112:115]
    v_mfma_f32_16x16x32_f16 v[116:119], v[68:71], v[80:83], v[116:119]
    ds_read_b128 v[76:79], v6 offset:3008
    s_waitcnt lgkmcnt(6)
    v_mfma_f32_16x16x32_f16 v[112:115], v[32:35], v[84:87], v[112:115]
    v_mfma_f32_16x16x32_f16 v[116:119], v[64:67], v[84:87], v[116:119]
    ds_read_b128 v[80:83], v6 offset:3072
    s_waitcnt lgkmcnt(6)
    v_mfma_f32_16x16x32_f16 v[112:115], v[28:31], v[88:91], v[112:115]
    ds_write_b64 v124, v[108:109] offset:5120
    v_mfma_f32_16x16x32_f16 v[116:119], v[60:63], v[88:91], v[116:119]
    ds_read_b128 v[84:87], v6 offset:3136
    s_waitcnt lgkmcnt(7)
    v_mfma_f32_16x16x32_f16 v[112:115], v[24:27], v[92:95], v[112:115]
    ds_write_b64 v124, v[110:111] offset:5128
    v_mfma_f32_16x16x32_f16 v[116:119], v[56:59], v[92:95], v[116:119]
    ds_read_b128 v[88:91], v6 offset:3200
    s_waitcnt lgkmcnt(8)
    v_mfma_f32_16x16x32_f16 v[112:115], v[20:23], v[96:99], v[112:115]
    ds_write_b32 v125, v126 offset:128
    v_mfma_f32_16x16x32_f16 v[116:119], v[52:55], v[96:99], v[116:119]
    ds_read_b128 v[92:95], v6 offset:3264
    s_waitcnt lgkmcnt(9)
    v_mfma_f32_16x16x32_f16 v[112:115], v[16:19], v[100:103], v[112:115]
    v_mfma_f32_16x16x32_f16 v[116:119], v[48:51], v[100:103], v[116:119]
    ds_read_b128 v[96:99], v6 offset:3328
    s_waitcnt lgkmcnt(9)
    v_mfma_f32_16x16x32_f16 v[112:115], v[12:15], v[104:107], v[112:115]
    v_mfma_f32_16x16x32_f16 v[116:119], v[44:47], v[104:107], v[116:119]
    ds_read_b128 v[100:103], v6 offset:3392
    s_waitcnt lgkmcnt(9)
    v_mfma_f32_16x16x32_f16 v[112:115], v[8:11], v[76:79], v[112:115]
    v_mfma_f32_16x16x32_f16 v[116:119], v[40:43], v[76:79], v[116:119]
    v_mfma_f32_16x16x32_f16 v[120:123], v[72:75], v[76:79], 0
    ds_read_b128 v[104:107], v6 offset:3456
    s_waitcnt lgkmcnt(9)
    v_mfma_f32_16x16x32_f16 v[116:119], v[36:39], v[80:83], v[116:119]
    v_mfma_f32_16x16x32_f16 v[120:123], v[68:71], v[80:83], v[120:123]
    ds_read_b128 v[76:79], v6 offset:3520
    s_waitcnt lgkmcnt(8)
    v_mfma_f32_16x16x32_f16 v[116:119], v[32:35], v[84:87], v[116:119]
    v_mfma_f32_16x16x32_f16 v[120:123], v[64:67], v[84:87], v[120:123]
    ds_read_b128 v[80:83], v6 offset:3584
    s_waitcnt lgkmcnt(7)
    v_mfma_f32_16x16x32_f16 v[116:119], v[28:31], v[88:91], v[116:119]
    ds_write_b64 v124, v[112:113] offset:6400
    v_mfma_f32_16x16x32_f16 v[120:123], v[60:63], v[88:91], v[120:123]
    ds_read_b128 v[84:87], v6 offset:3648
    s_waitcnt lgkmcnt(7)
    v_mfma_f32_16x16x32_f16 v[116:119], v[24:27], v[92:95], v[116:119]
    ds_write_b64 v124, v[114:115] offset:6408
    v_mfma_f32_16x16x32_f16 v[120:123], v[56:59], v[92:95], v[120:123]
    ds_read_b128 v[88:91], v6 offset:3712
    s_waitcnt lgkmcnt(8)
    v_mfma_f32_16x16x32_f16 v[116:119], v[20:23], v[96:99], v[116:119]
    ds_write_b32 v125, v126 offset:160
    v_mfma_f32_16x16x32_f16 v[120:123], v[52:55], v[96:99], v[120:123]
    ds_read_b128 v[92:95], v6 offset:3776
    s_waitcnt lgkmcnt(9)
    v_mfma_f32_16x16x32_f16 v[116:119], v[16:19], v[100:103], v[116:119]
    v_mfma_f32_16x16x32_f16 v[120:123], v[48:51], v[100:103], v[120:123]
    ds_read_b128 v[96:99], v6 offset:3840
    s_waitcnt lgkmcnt(9)
    v_mfma_f32_16x16x32_f16 v[116:119], v[12:15], v[104:107], v[116:119]
    v_mfma_f32_16x16x32_f16 v[120:123], v[44:47], v[104:107], v[120:123]
    ds_read_b128 v[100:103], v6 offset:3904
    s_waitcnt lgkmcnt(9)
    v_mfma_f32_16x16x32_f16 v[116:119], v[8:11], v[76:79], v[116:119]
    v_mfma_f32_16x16x32_f16 v[120:123], v[40:43], v[76:79], v[120:123]
    ds_read_b128 v[104:107], v6 offset:3968
    s_waitcnt lgkmcnt(9)
    v_mfma_f32_16x16x32_f16 v[120:123], v[36:39], v[80:83], v[120:123]
    ds_read_b128 v[76:79], v6 offset:4032
    s_waitcnt lgkmcnt(8)
    v_mfma_f32_16x16x32_f16 v[120:123], v[32:35], v[84:87], v[120:123]
    s_waitcnt lgkmcnt(6)
    v_mfma_f32_16x16x32_f16 v[120:123], v[28:31], v[88:91], v[120:123]
    s_waitcnt lgkmcnt(4)
    v_mfma_f32_16x16x32_f16 v[120:123], v[24:27], v[92:95], v[120:123]
    s_waitcnt lgkmcnt(3)
    v_mfma_f32_16x16x32_f16 v[120:123], v[20:23], v[96:99], v[120:123]
    ds_write_b64 v124, v[116:117] offset:7680
    s_waitcnt lgkmcnt(3)
    v_mfma_f32_16x16x32_f16 v[120:123], v[16:19], v[100:103], v[120:123]
    ds_write_b64 v124, v[118:119] offset:7688
    s_waitcnt lgkmcnt(3)
    v_mfma_f32_16x16x32_f16 v[120:123], v[12:15], v[104:107], v[120:123]
    ds_write_b32 v125, v126 offset:192
    s_waitcnt lgkmcnt(3)
    v_mfma_f32_16x16x32_f16 v[120:123], v[8:11], v[76:79], v[120:123]
    s_nop 7
    ds_write_b64 v124, v[120:121] offset:8960
    ds_write_b64 v124, v[122:123] offset:8968
    ds_write_b32 v125, v126 offset:224
    s_waitcnt lgkmcnt(0)
    s_endpgm
D_REDO:
    s_barrier
    s_barrier
    s_branch D_PASS
CK_T1:
    ds_read_b128 v[8:11], v128 offset:43296
    ds_read_b128 v[40:43], v128 offset:16896
    ds_read_b128 v[12:15], v128 offset:43360
    ds_read_b128 v[44:47], v128 offset:16960
    ds_read_b128 v[16:19], v128 offset:43424
    ds_read_b128 v[48:51], v128 offset:17024
    ds_read_b128 v[20:23], v128 offset:43488
    ds_read_b128 v[52:55], v128 offset:17088
    ds_read_b128 v[24:27], v128 offset:43552
    ds_read_b128 v[56:59], v128 offset:17152
    ds_read_b128 v[28:31], v128 offset:43616
    ds_read_b128 v[60:63], v128 offset:17216
    ds_read_b128 v[32:35], v128 offset:43680
    ds_read_b128 v[64:67], v128 offset:17280
    ds_read_b128 v[36:39], v128 offset:43744
    ds_read_b128 v[68:71], v128 offset:17344
    v_lshlrev_b32 v114, 8, v4
    v_lshl_add_u32 v114, v3, 4, v114
    v_add_u32 v114, s13, v114
    v_lshlrev_b32 v115, 7, v4
    v_lshl_add_u32 v115, v3, 2, v115
    v_add_u32 v115, s13, v115
    s_waitcnt lgkmcnt(14)
    v_mfma_f32_16x16x32_f16 v[104:107], v[40:43], v[8:11], 0
    s_waitcnt lgkmcnt(12)
    v_mfma_f32_16x16x32_f16 v[104:107], v[44:47], v[12:15], v[104:107]
    s_waitcnt lgkmcnt(10)
    v_mfma_f32_16x16x32_f16 v[104:107], v[48:51], v[16:19], v[104:107]
    s_waitcnt lgkmcnt(8)
    v_mfma_f32_16x16x32_f16 v[104:107], v[52:55], v[20:23], v[104:107]
    s_waitcnt lgkmcnt(6)
    v_mfma_f32_16x16x32_f16 v[104:107], v[56:59], v[24:27], v[104:107]
    s_waitcnt lgkmcnt(4)
    v_mfma_f32_16x16x32_f16 v[104:107], v[60:63], v[28:31], v[104:107]
    s_waitcnt lgkmcnt(2)
    v_mfma_f32_16x16x32_f16 v[104:107], v[64:67], v[32:35], v[104:107]
    s_waitcnt lgkmcnt(0)
    v_mfma_f32_16x16x32_f16 v[104:107], v[68:71], v[36:39], v[104:107]
    s_nop 7
    v_cvt_pk_f16_f32 v116, v104, v105
    v_cvt_pk_f16_f32 v117, v105, v105
    v_cvt_pk_f16_f32 v118, v106, v107
    v_cvt_pk_f16_f32 v119, v107, v107
    v_cvt_pk_f16_f32 v120, v105, v106
    s_mov_b32 exec_hi, 0
    ds_write_b16 v114, v119 offset:560
    v_add_u32 v121, 1728, v114
    ds_write_b128 v114, v[116:119] offset:544
    ds_write2_b32 v121, v119, v119 offset0:11 offset1:12
    ds_write2_b32 v121, v117, v120 offset0:9 offset1:10
    ds_write_b16 v121, v116 offset:34
    s_not_b64 exec, exec
    ds_write_b32 v115, v116 offset:2208
    ds_write_b32 v115, v118 offset:2272
    s_mov_b64 exec, -1
    v_mov_b32 v167, 153600
    v_mov_b32 v166, 1
    s_mov_b64 exec, 1
    ds_add_u32 v167, v166 offset:76
    s_mov_b64 exec, -1
    v_mul_u32_u24 v164, 320, v4
    v_lshl_add_u32 v164, v3, 4, v164
    s_mul_i32 s8, s7, 20480
    v_add_u32 v164, s8, v164
    s_lshl_b32 s8, s3, 2
    s_add_u32 s8, s8, 153856
    v_mov_b32 v165, s8
    v_lshlrev_b32 v74, 3, v4
    v_sub_u32 v74, v74, v3
    v_and_b32 v74, 0xffff, v74
    v_lshl_or_b32 v74, v74, 16, v74
    v_mov_b32 v75, 0x3c003c00
    s_mov_b32 s8, 0xfff0fff1
    v_pk_add_u16 v76, v74, s8
    s_mov_b32 s8, 0xfff2fff3
    v_pk_add_u16 v77, v74, s8
    s_mov_b32 s8, 0xfff4fff5
    v_pk_add_u16 v78, v74, s8
    s_mov_b32 s8, 0xfff6fff7
    v_pk_add_u16 v79, v74, s8
    v_pk_add_u16 v80, v76, 2 op_sel_hi:[1,0]
    v_pk_ashrrev_i16 v80, 15, v80 op_sel_hi:[0,1]
    v_pk_add_u16 v81, v77, 2 op_sel_hi:[1,0]
    v_pk_ashrrev_i16 v81, 15, v81 op_sel_hi:[0,1]
    v_pk_add_u16 v82, v78, 2 op_sel_hi:[1,0]
    v_pk_ashrrev_i16 v82, 15, v82 op_sel_hi:[0,1]
    v_pk_add_u16 v83, v79, 2 op_sel_hi:[1,0]
    v_pk_ashrrev_i16 v83, 15, v83 op_sel_hi:[0,1]
    v_pk_add_u16 v84, v76, 3 op_sel_hi:[1,0]
    v_pk_ashrrev_i16 v84, 15, v84 op_sel_hi:[0,1]
    v_pk_add_u16 v85, v77, 3 op_sel_hi:[1,0]
    v_pk_ashrrev_i16 v85, 15, v85 op_sel_hi:[0,1]
    v_pk_add_u16 v86, v78, 3 op_sel_hi:[1,0]
    v_pk_ashrrev_i16 v86, 15, v86 op_sel_hi:[0,1]
    v_pk_add_u16 v87, v79, 3 op_sel_hi:[1,0]
    v_pk_ashrrev_i16 v87, 15, v87 op_sel_hi:[0,1]
    v_pk_add_u16 v88, v76, 4 op_sel_hi:[1,0]
    v_pk_ashrrev_i16 v88, 15, v88 op_sel_hi:[0,1]
    v_pk_add_u16 v89, v77, 4 op_sel_hi:[1,0]
    v_pk_ashrrev_i16 v89, 15, v89 op_sel_hi:[0,1]
    v_pk_add_u16 v90, v78, 4 op_sel_hi:[1,0]
    v_pk_ashrrev_i16 v90, 15, v90 op_sel_hi:[0,1]
    v_pk_add_u16 v91, v79, 4 op_sel_hi:[1,0]
    v_pk_ashrrev_i16 v91, 15, v91 op_sel_hi:[0,1]
    v_pk_add_u16 v92, v76, 5 op_sel_hi:[1,0]
    v_pk_ashrrev_i16 v92, 15, v92 op_sel_hi:[0,1]
    v_pk_add_u16 v93, v77, 5 op_sel_hi:[1,0]
    v_pk_ashrrev_i16 v93, 15, v93 op_sel_hi:[0,1]
    v_pk_add_u16 v94, v78, 5 op_sel_hi:[1,0]
    v_pk_ashrrev_i16 v94, 15, v94 op_sel_hi:[0,1]
    v_pk_add_u16 v95, v79, 5 op_sel_hi:[1,0]
    v_pk_ashrrev_i16 v95, 15, v95 op_sel_hi:[0,1]
    v_pk_add_u16 v96, v76, 10 op_sel_hi:[1,0]
    v_pk_ashrrev_i16 v96, 15, v96 op_sel_hi:[0,1]
    v_pk_add_u16 v97, v77, 10 op_sel_hi:[1,0]
    v_pk_ashrrev_i16 v97, 15, v97 op_sel_hi:[0,1]
    v_pk_add_u16 v98, v78, 10 op_sel_hi:[1,0]
    v_pk_ashrrev_i16 v98, 15, v98 op_sel_hi:[0,1]
    v_pk_add_u16 v99, v79, 10 op_sel_hi:[1,0]
    v_pk_ashrrev_i16 v99, 15, v99 op_sel_hi:[0,1]
    v_pk_add_u16 v100, v76, 11 op_sel_hi:[1,0]
    v_pk_ashrrev_i16 v100, 15, v100 op_sel_hi:[0,1]
    v_pk_add_u16 v101, v77, 11 op_sel_hi:[1,0]
    v_pk_ashrrev_i16 v101, 15, v101 op_sel_hi:[0,1]
    v_pk_add_u16 v102, v78, 11 op_sel_hi:[1,0]
    v_pk_ashrrev_i16 v102, 15, v102 op_sel_hi:[0,1]
    v_pk_add_u16 v103, v79, 11 op_sel_hi:[1,0]
    v_pk_ashrrev_i16 v103, 15, v103 op_sel_hi:[0,1]
    v_pk_add_u16 v104, v76, 12 op_sel_hi:[1,0]
    v_pk_ashrrev_i16 v104, 15, v104 op_sel_hi:[0,1]
    v_pk_add_u16 v105, v77, 12 op_sel_hi:[1,0]
    v_pk_ashrrev_i16 v105, 15, v105 op_sel_hi:[0,1]
    v_pk_add_u16 v106, v78, 12 op_sel_hi:[1,0]
    v_pk_ashrrev_i16 v106, 15, v106 op_sel_hi:[0,1]
    v_pk_add_u16 v107, v79, 12 op_sel_hi:[1,0]
    v_pk_ashrrev_i16 v107, 15, v107 op_sel_hi:[0,1]
    v_bitop3_b32 v140, v80, v92, v75 bitop3:0x28
    v_bitop3_b32 v141, v81, v93, v75 bitop3:0x28
    v_bitop3_b32 v142, v82, v94, v75 bitop3:0x28
    v_bitop3_b32 v143, v83, v95, v75 bitop3:0x28
    v_bitop3_b32 v144, v92, v96, v75 bitop3:0x28
    v_bitop3_b32 v145, v93, v97, v75 bitop3:0x28
    v_bitop3_b32 v146, v94, v98, v75 bitop3:0x28
    v_bitop3_b32 v147, v95, v99, v75 bitop3:0x28
    v_bitop3_b32 v148, v88, v100, v75 bitop3:0x28
    v_bitop3_b32 v149, v89, v101, v75 bitop3:0x28
    v_bitop3_b32 v150, v90, v102, v75 bitop3:0x28
    v_bitop3_b32 v151, v91, v103, v75 bitop3:0x28
    v_bitop3_b32 v152, v84, v104, v75 bitop3:0x28
    v_bitop3_b32 v153, v85, v105, v75 bitop3:0x28
    v_bitop3_b32 v154, v86, v106, v75 bitop3:0x28
    v_bitop3_b32 v155, v87, v107, v75 bitop3:0x28
    v_xor_b32 v156, v80, v88
    v_xor_b32 v157, v81, v89
    v_xor_b32 v158, v82, v90
    v_xor_b32 v159, v83, v91
    v_lshlrev_b32 v5, 2, v4
    v_sub_u32 v5, v3, v5
    v_lshl_add_u32 v7, v5, 2, s13
    v_lshl_add_u32 v5, v5, 3, s13
    v_add_u32 v7, 2848, v7
    v_mov_b32 v6, s13
    s_mov_b32 s9, 0
SPN5:
    ds_read_b32 v128, v167 offset:76
    s_add_u32 s9, s9, 1
    s_waitcnt lgkmcnt(0)
    v_cmp_ne_u32 vcc, 8, v128
    s_cmp_ge_u32 s9, 0x40000
    s_cbranch_scc1 SPX5
    s_cbranch_vccz SPX5
    s_sleep 1
    s_branch SPN5
SPX5:
    ds_read_b32 v130, v6 offset:2716
    ds_read_b64 v[8:9], v5 offset:2464
    ds_read_b64 v[10:11], v5 offset:2456
    ds_read_b64 v[12:13], v5 offset:2448
    ds_read_b64 v[14:15], v5 offset:2440
    ds_read_b64 v[16:17], v5 offset:2592
    ds_read_b64 v[18:19], v5 offset:2584
    ds_read_b64 v[20:21], v5 offset:2576
    ds_read_b64 v[22:23], v5 offset:2568
    ds_read_b64 v[24:25], v5 offset:2720
    ds_read_b64 v[26:27], v5 offset:2712
    ds_read_b64 v[28:29], v5 offset:2704
    ds_read_b64 v[30:31], v5 offset:2696
    ds_read2_b32 v[32:33], v7 offset0:16 offset1:15
    ds_read2_b32 v[34:35], v7 offset0:14 offset1:13
    ds_read2_b32 v[36:37], v7 offset0:32 offset1:31
    ds_read2_b32 v[38:39], v7 offset0:30 offset1:29
    ds_read2_b32 v[40:41], v7 offset0:48 offset1:47
    ds_read2_b32 v[42:43], v7 offset0:46 offset1:45
    ds_read2_b32 v[44:45], v7 offset0:64 offset1:63
    ds_read2_b32 v[46:47], v7 offset0:62 offset1:61
    v_lshlrev_b32 v6, 4, v4
    v_lshl_add_u32 v6, v3, 5, v6
    v_add_u32 v6, 4048, v6
    v_add_u32 v6, s13, v6
Z_PASS:
    ds_write_b128 v164, v[124:127] offset:10240
    ds_write_b32 v165, v166 offset:0
    ds_write_b128 v164, v[124:127] offset:11520
    ds_write_b32 v165, v166 offset:32
    s_mov_b32 s8, 0x07060706
    s_mov_b32 s9, 0
SPN6:
    ds_read_b32 v128, v167 offset:240
    s_add_u32 s9, s9, 1
    s_waitcnt lgkmcnt(0)
    v_and_b32 v128, 15, v128
    v_cmp_ne_u32 vcc, 2, v128
    s_cmp_ge_u32 s9, 0x40000
    s_cbranch_scc1 SPX6
    s_cbranch_vccz SPX6
    s_sleep 1
    s_branch SPN6
SPX6:
    v_perm_b32 v130, v130, v130, s8
Z_LOOP:
    ds_read_b128 v[48:51], v6 offset:16
    ds_read_b128 v[52:55], v6 offset:0
    ds_read_b128 v[56:59], v6 offset:528
    ds_read_b128 v[60:63], v6 offset:512
    v_and_b32 v156, v130, v156
    v_and_b32 v157, v130, v157
    v_and_b32 v158, v130, v158
    v_and_b32 v159, v130, v159
    s_waitcnt lgkmcnt(2)
    v_mfma_f32_16x16x32_f16 v[64:67], v[48:51], v[140:143], 0
    v_mfma_f32_16x16x32_f16 v[68:71], v[48:51], v[144:147], 0
    v_mfma_f32_16x16x32_f16 v[72:75], v[52:55], v[140:143], 0
    v_mfma_f32_16x16x32_f16 v[76:79], v[52:55], v[144:147], 0
    v_mfma_f32_16x16x32_f16 v[80:83], v[48:51], v[148:151], 0
    v_mfma_f32_16x16x32_f16 v[84:87], v[52:55], v[152:155], 0
    s_nop 3
    v_cvt_pk_f16_f32 v88, v64, v68
    v_cvt_pk_f16_f32 v90, v65, v69
    v_cvt_pk_f16_f32 v92, v66, v70
    v_cvt_pk_f16_f32 v94, v67, v71
    v_cvt_pk_f16_f32 v89, v72, v76
    v_cvt_pk_f16_f32 v91, v73, v77
    v_cvt_pk_f16_f32 v93, v74, v78
    v_cvt_pk_f16_f32 v95, v75, v79
    v_cvt_pk_f16_f32 v96, v80, v84
    v_cvt_pk_f16_f32 v97, v81, v85
    v_cvt_pk_f16_f32 v98, v82, v86
    v_cvt_pk_f16_f32 v99, v83, v87
    s_waitcnt lgkmcnt(0)
    v_mfma_f32_16x16x32_f16 v[64:67], v[56:59], v[140:143], 0
    v_mfma_f32_16x16x32_f16 v[68:71], v[56:59], v[144:147], 0
    v_mfma_f32_16x16x32_f16 v[72:75], v[60:63], v[140:143], 0
    v_mfma_f32_16x16x32_f16 v[76:79], v[60:63], v[144:147], 0
    v_mfma_f32_16x16x32_f16 v[80:83], v[56:59], v[148:151], 0
    v_mfma_f32_16x16x32_f16 v[84:87], v[60:63], v[152:155], 0
    v_mfma_f32_16x16x32_f16 v[108:111], v[156:159], v[48:51], 0
    ds_read_b128 v[48:51], v6 offset:1040
    ds_read_b128 v[52:55], v6 offset:1024
    v_mfma_f32_16x16x32_f16 v[100:103], v[88:91], v[8:11], 0
    v_mfma_f32_16x16x32_f16 v[100:103], v[92:95], v[12:15], v[100:103]
    v_cvt_pk_f16_f32 v132, v64, v68
    v_cvt_pk_f16_f32 v134, v65, v69
    v_mfma_f32_16x16x32_f16 v[104:107], v[88:91], v[16:19], 0
    v_cvt_pk_f16_f32 v136, v66, v70
    v_cvt_pk_f16_f32 v138, v67, v71
    v_mfma_f32_16x16x32_f16 v[104:107], v[92:95], v[20:23], v[104:107]
    v_cvt_pk_f16_f32 v133, v72, v76
    v_cvt_pk_f16_f32 v135, v73, v77
    v_mfma_f32_16x16x32_f16 v[108:111], v[88:91], v[24:27], v[108:111]
    v_cvt_pk_f16_f32 v137, v74, v78
    v_cvt_pk_f16_f32 v139, v75, v79
    v_mfma_f32_16x16x32_f16 v[108:111], v[92:95], v[28:31], v[108:111]
    v_cvt_pk_f16_f32 v160, v80, v84
    v_cvt_pk_f16_f32 v161, v81, v85
    v_mfma_f32_16x16x32_f16 v[108:111], v[96:99], v[32:35], v[108:111]
    v_cvt_pk_f16_f32 v162, v82, v86
    v_cvt_pk_f16_f32 v163, v83, v87
    v_mfma_f32_16x16x32_f16 v[112:115], v[96:99], v[36:39], 0
    v_mfma_f32_16x16x32_f16 v[116:119], v[96:99], v[40:43], 0
    v_mfma_f32_16x16x32_f16 v[120:123], v[96:99], v[44:47], 0
    s_waitcnt lgkmcnt(0)
    v_mfma_f32_16x16x32_f16 v[64:67], v[48:51], v[140:143], 0
    v_mfma_f32_16x16x32_f16 v[68:71], v[48:51], v[144:147], 0
    ds_write_b64 v164, v[100:101] offset:12800
    v_mfma_f32_16x16x32_f16 v[72:75], v[52:55], v[140:143], 0
    ds_write_b64 v164, v[102:103] offset:12808
    v_mfma_f32_16x16x32_f16 v[76:79], v[52:55], v[144:147], 0
    ds_write_b32 v165, v166 offset:64
    v_mfma_f32_16x16x32_f16 v[80:83], v[48:51], v[148:151], 0
    v_mfma_f32_16x16x32_f16 v[84:87], v[52:55], v[152:155], 0
    v_mfma_f32_16x16x32_f16 v[112:115], v[156:159], v[56:59], v[112:115]
    ds_read_b128 v[56:59], v6 offset:1552
    ds_read_b128 v[60:63], v6 offset:1536
    v_mfma_f32_16x16x32_f16 v[104:107], v[132:135], v[8:11], v[104:107]
    v_mfma_f32_16x16x32_f16 v[104:107], v[136:139], v[12:15], v[104:107]
    v_cvt_pk_f16_f32 v88, v64, v68
    v_cvt_pk_f16_f32 v90, v65, v69
    v_mfma_f32_16x16x32_f16 v[108:111], v[132:135], v[16:19], v[108:111]
    v_cvt_pk_f16_f32 v92, v66, v70
    v_cvt_pk_f16_f32 v94, v67, v71
    v_mfma_f32_16x16x32_f16 v[108:111], v[136:139], v[20:23], v[108:111]
    v_cvt_pk_f16_f32 v89, v72, v76
    v_cvt_pk_f16_f32 v91, v73, v77
    v_mfma_f32_16x16x32_f16 v[112:115], v[132:135], v[24:27], v[112:115]
    v_cvt_pk_f16_f32 v93, v74, v78
    v_cvt_pk_f16_f32 v95, v75, v79
    v_mfma_f32_16x16x32_f16 v[112:115], v[136:139], v[28:31], v[112:115]
    v_cvt_pk_f16_f32 v96, v80, v84
    v_cvt_pk_f16_f32 v97, v81, v85
    v_mfma_f32_16x16x32_f16 v[112:115], v[160:163], v[32:35], v[112:115]
    v_cvt_pk_f16_f32 v98, v82, v86
    v_cvt_pk_f16_f32 v99, v83, v87
    v_mfma_f32_16x16x32_f16 v[116:119], v[160:163], v[36:39], v[116:119]
    v_mfma_f32_16x16x32_f16 v[120:123], v[160:163], v[40:43], v[120:123]
    s_waitcnt lgkmcnt(0)
    v_mfma_f32_16x16x32_f16 v[64:67], v[56:59], v[140:143], 0
    v_mfma_f32_16x16x32_f16 v[68:71], v[56:59], v[144:147], 0
    ds_write_b64 v164, v[104:105] offset:14080
    v_mfma_f32_16x16x32_f16 v[72:75], v[60:63], v[140:143], 0
    ds_write_b64 v164, v[106:107] offset:14088
    v_mfma_f32_16x16x32_f16 v[76:79], v[60:63], v[144:147], 0
    ds_write_b32 v165, v166 offset:96
    v_mfma_f32_16x16x32_f16 v[80:83], v[56:59], v[148:151], 0
    v_mfma_f32_16x16x32_f16 v[84:87], v[60:63], v[152:155], 0
    v_mfma_f32_16x16x32_f16 v[116:119], v[156:159], v[48:51], v[116:119]
    v_mfma_f32_16x16x32_f16 v[108:111], v[88:91], v[8:11], v[108:111]
    v_mfma_f32_16x16x32_f16 v[108:111], v[92:95], v[12:15], v[108:111]
    v_mfma_f32_16x16x32_f16 v[112:115], v[88:91], v[16:19], v[112:115]
    v_cvt_pk_f16_f32 v132, v64, v68
    v_cvt_pk_f16_f32 v134, v65, v69
    v_mfma_f32_16x16x32_f16 v[112:115], v[92:95], v[20:23], v[112:115]
    v_cvt_pk_f16_f32 v136, v66, v70
    v_cvt_pk_f16_f32 v138, v67, v71
    v_mfma_f32_16x16x32_f16 v[116:119], v[88:91], v[24:27], v[116:119]
    v_cvt_pk_f16_f32 v133, v72, v76
    v_cvt_pk_f16_f32 v135, v73, v77
    v_mfma_f32_16x16x32_f16 v[116:119], v[92:95], v[28:31], v[116:119]
    v_cvt_pk_f16_f32 v137, v74, v78
    v_cvt_pk_f16_f32 v139, v75, v79
    v_mfma_f32_16x16x32_f16 v[116:119], v[96:99], v[32:35], v[116:119]
    v_cvt_pk_f16_f32 v160, v80, v84
    v_cvt_pk_f16_f32 v161, v81, v85
    v_mfma_f32_16x16x32_f16 v[120:123], v[96:99], v[36:39], v[120:123]
    v_cvt_pk_f16_f32 v162, v82, v86
    v_cvt_pk_f16_f32 v163, v83, v87
    s_nop 1
    v_mfma_f32_16x16x32_f16 v[120:123], v[156:159], v[56:59], v[120:123]
    ds_write_b64 v164, v[108:109] offset:15360
    v_mfma_f32_16x16x32_f16 v[112:115], v[132:135], v[8:11], v[112:115]
    ds_write_b64 v164, v[110:111] offset:15368
    v_mfma_f32_16x16x32_f16 v[112:115], v[136:139], v[12:15], v[112:115]
    ds_write_b32 v165, v166 offset:128
    v_mfma_f32_16x16x32_f16 v[116:119], v[132:135], v[16:19], v[116:119]
    v_mfma_f32_16x16x32_f16 v[116:119], v[136:139], v[20:23], v[116:119]
    v_mfma_f32_16x16x32_f16 v[120:123], v[132:135], v[24:27], v[120:123]
    v_mfma_f32_16x16x32_f16 v[120:123], v[136:139], v[28:31], v[120:123]
    v_mfma_f32_16x16x32_f16 v[120:123], v[160:163], v[32:35], v[120:123]
    s_mov_b32 s9, 0
SPN7:
    ds_read_b32 v128, v167 offset:240
    s_add_u32 s9, s9, 1
    s_waitcnt lgkmcnt(0)
    v_and_b32 v128, 0xffff, v128
    v_cmp_ne_u32 vcc, 34, v128
    s_cmp_ge_u32 s9, 0x40000
    s_cbranch_scc1 SPX7
    s_cbranch_vccz SPX7
    s_sleep 1
    s_branch SPN7
SPX7:
    ds_read_b32 v128, v167 offset:240
    s_waitcnt lgkmcnt(0)
    v_cmp_ne_u32 vcc, 34, v128
    s_nop 0
    s_cbranch_vccnz Z_REDO
    s_cmp_lg_u32 s3, 4
    s_cbranch_scc1 Z_NOSEL
    v_and_b32 v126, 7, v2
    s_lshl_b32 s9, s4, 8
    v_lshl_add_u32 v126, v126, 3, s9
    global_load_dwordx2 v[124:125], v126, s[50:51] offset:256 sc1
    s_lshl_b32 s9, s4, 7
    v_mov_b32 v126, s9
    global_load_dword v127, v126, s[50:51] offset:2304 sc1
Z_NOSEL:
    ds_read_b128 v[48:51], v6 offset:2064
    ds_read_b128 v[52:55], v6 offset:2048
    ds_read_b128 v[56:59], v6 offset:2576
    ds_read_b128 v[60:63], v6 offset:2560
    ds_write_b64 v164, v[112:113] offset:16640
    ds_write_b64 v164, v[114:115] offset:16648
    ds_write_b32 v165, v166 offset:160
    s_waitcnt lgkmcnt(5)
    v_mfma_f32_16x16x32_f16 v[64:67], v[48:51], v[140:143], 0
    v_mfma_f32_16x16x32_f16 v[68:71], v[48:51], v[144:147], 0
    v_mfma_f32_16x16x32_f16 v[72:75], v[52:55], v[140:143], 0
    v_mfma_f32_16x16x32_f16 v[76:79], v[52:55], v[144:147], 0
    s_nop 5
    v_cvt_pk_f16_f32 v88, v64, v68
    v_cvt_pk_f16_f32 v90, v65, v69
    v_cvt_pk_f16_f32 v92, v66, v70
    v_cvt_pk_f16_f32 v94, v67, v71
    v_cvt_pk_f16_f32 v89, v72, v76
    v_cvt_pk_f16_f32 v91, v73, v77
    v_cvt_pk_f16_f32 v93, v74, v78
    v_cvt_pk_f16_f32 v95, v75, v79
    s_waitcnt lgkmcnt(3)
    v_mfma_f32_16x16x32_f16 v[64:67], v[56:59], v[140:143], 0
    v_mfma_f32_16x16x32_f16 v[68:71], v[56:59], v[144:147], 0
    v_mfma_f32_16x16x32_f16 v[72:75], v[60:63], v[140:143], 0
    v_mfma_f32_16x16x32_f16 v[76:79], v[60:63], v[144:147], 0
    v_mfma_f32_16x16x32_f16 v[116:119], v[88:91], v[8:11], v[116:119]
    v_mfma_f32_16x16x32_f16 v[116:119], v[92:95], v[12:15], v[116:119]
    v_mfma_f32_16x16x32_f16 v[120:123], v[88:91], v[16:19], v[120:123]
    v_mfma_f32_16x16x32_f16 v[120:123], v[92:95], v[20:23], v[120:123]
    s_nop 1
    v_cvt_pk_f16_f32 v132, v64, v68
    v_cvt_pk_f16_f32 v134, v65, v69
    v_cvt_pk_f16_f32 v136, v66, v70
    v_cvt_pk_f16_f32 v138, v67, v71
    v_cvt_pk_f16_f32 v133, v72, v76
    v_cvt_pk_f16_f32 v135, v73, v77
    v_cvt_pk_f16_f32 v137, v74, v78
    v_cvt_pk_f16_f32 v139, v75, v79
    ds_write_b64 v164, v[116:117] offset:17920
    ds_write_b64 v164, v[118:119] offset:17928
    v_mfma_f32_16x16x32_f16 v[120:123], v[132:135], v[8:11], v[120:123]
    v_mfma_f32_16x16x32_f16 v[120:123], v[136:139], v[12:15], v[120:123]
    ds_write_b32 v165, v166 offset:192
    s_nop 6
    ds_write_b64 v164, v[120:121] offset:19200
    ds_write_b64 v164, v[122:123] offset:19208
    ds_write_b32 v165, v166 offset:224
    s_setprio 0
    s_cmp_eq_u32 s3, 4
    s_cbranch_scc1 FINAL
    s_waitcnt lgkmcnt(0)
    s_endpgm
Z_REDO:
    s_barrier
    s_barrier
    s_branch Z_PASS
CU_C3A:
    s_cmp_eq_u32 s4, 3
    s_cselect_b32 s8, 18, 3
    s_cmp_ge_u32 s101, s8
    s_cbranch_scc1 CU_C3B
    s_sub_u32 s14, 3, s4
    s_and_b32 s14, s14, 7
    s_and_b32 s8, s101, 1
    s_lshl_b32 s8, s8, 3
    s_lshr_b32 s9, s101, 1
    s_cmp_eq_u32 s4, 3
    s_cselect_b32 s14, s8, s14
    s_cselect_b32 s9, s9, s101
    s_add_u32 s9, s9, 2
    s_min_u32 s9, s9, 17
    s_mul_i32 s9, s9, 9
    s_add_u32 s14, s14, s9
    v_mul_u32_u24 v140, 9216, v2
    s_mul_i32 s8, s4, 1152
    v_add_u32 v140, s8, v140
    s_mul_i32 s8, s14, 7282
    s_lshr_b32 s8, s8, 16
    s_mul_i32 s9, s8, 9
    s_sub_u32 s9, s14, s9
    s_lshl_b32 s9, s9, 7
    s_bitcmp1_b32 s8, 0
    s_cselect_b32 s12, s40, s38
    s_cselect_b32 s13, s41, s39
    s_lshr_b32 s8, s8, 1
    s_add_u32 s8, s8, 0
    s_mul_i32 s8, s8, 589824
    s_add_u32 s8, s8, s9
    v_add_u32 v148, s8, v140
    global_load_dword v149, v148, s[12:13]
    s_lshl_b32 s9, s6, 3
    s_branch CU_C3B
CU_C3:
    s_cmp_eq_u32 s4, 3
    s_cselect_b32 s8, 18, 3
    s_add_u32 s10, s10, s8
    s_sub_u32 s14, 3, s4
    s_and_b32 s14, s14, 7
    s_and_b32 s8, s10, 1
    s_lshl_b32 s8, s8, 3
    s_lshr_b32 s9, s10, 1
    s_cmp_eq_u32 s4, 3
    s_cselect_b32 s14, s8, s14
    s_cselect_b32 s9, s9, s10
    s_add_u32 s9, s9, 2
    s_min_u32 s9, s9, 17
    s_mul_i32 s9, s9, 9
    s_add_u32 s14, s14, s9
    v_mul_u32_u24 v140, 9216, v2
    s_mul_i32 s8, s4, 1152
    v_add_u32 v140, s8, v140
    s_mul_i32 s8, s14, 7282
    s_lshr_b32 s8, s8, 16
    s_mul_i32 s9, s8, 9
    s_sub_u32 s9, s14, s9
    s_lshl_b32 s9, s9, 7
    s_bitcmp1_b32 s8, 0
    s_cselect_b32 s12, s40, s38
    s_cselect_b32 s13, s41, s39
    s_lshr_b32 s8, s8, 1
    s_add_u32 s8, s8, 0
    s_mul_i32 s8, s8, 589824
    s_add_u32 s8, s8, s9
    v_add_u32 v148, s8, v140
    global_load_dword v149, v148, s[12:13]
    s_lshl_b32 s9, s6, 3
    s_branch CU_C3X
CU_MID:
    s_min_u32 s13, s7, 2
    s_mov_b32 s12, 0
SPN8:
    ds_read_b32 v56, v57 offset:64
    s_add_u32 s12, s12, 1
    s_waitcnt lgkmcnt(0)
    v_cmp_gt_u32 vcc, s13, v56
    s_cmp_ge_u32 s12, 0x40000
    s_cbranch_scc1 SPX8
    s_cbranch_vccz SPX8
    s_sleep 2
    s_branch SPN8
SPX8:
    s_branch CU_LD
CU_MAIN:
    s_load_dwordx2 s[52:53], s[32:33], s9
    v_mov_b32 v139, 1
    v_lshrrev_b32 v7, 2, v2
    v_mul_u32_u24 v7, 128, v7
    v_and_b32 v137, 3, v2
    v_lshl_add_u32 v7, v137, 4, v7
    v_lshrrev_b32 v138, 1, v2
    v_mul_u32_u24 v138, 128, v138
    v_and_b32 v137, 1, v2
    v_lshl_add_u32 v138, v137, 4, v138
    v_add_u32 v138, 10304, v138
    s_mul_i32 s8, s15, 2048
    s_add_u32 s8, s8, 20480
    v_add_u32 v7, s8, v7
    v_add_u32 v137, 12288, v7
    v_add_u32 v138, 20480, v138
    s_cmp_eq_u32 s7, 1
    s_cselect_b64 vcc, -1, 0
    v_cndmask_b32 v138, v137, v138, vcc
    s_mov_b32 s72, s15
    s_mov_b64 exec, 1
    ds_add_u32 v57, v139 offset:64
    s_mov_b64 exec, -1
    v_and_b32 v146, 3, v2
    v_lshl_add_u32 v146, v146, 2, v57
    s_mov_b32 s73, 0x45800000
    s_mov_b32 s74, 2
    s_setprio 3
    s_cmp_lg_u32 s7, 0
    s_cbranch_scc1 CU_PASS
    s_waitcnt vmcnt(7)
    v_lshlrev_b32 v24, 16, v8
    v_and_b32 v28, 0xffff0000, v8
    v_lshlrev_b32 v32, 16, v9
    v_and_b32 v36, 0xffff0000, v9
    s_waitcnt vmcnt(6)
    v_lshlrev_b32 v25, 16, v10
    v_and_b32 v29, 0xffff0000, v10
    v_lshlrev_b32 v33, 16, v11
    v_and_b32 v37, 0xffff0000, v11
    s_waitcnt vmcnt(5)
    v_lshlrev_b32 v26, 16, v12
    v_and_b32 v30, 0xffff0000, v12
    v_lshlrev_b32 v34, 16, v13
    v_and_b32 v38, 0xffff0000, v13
    s_waitcnt vmcnt(4)
    v_lshlrev_b32 v27, 16, v14
    v_and_b32 v31, 0xffff0000, v14
    v_lshlrev_b32 v35, 16, v15
    v_and_b32 v39, 0xffff0000, v15
    v_max3_f32 v78, |v24|, |v25|, 0
    v_max3_f32 v79, |v28|, |v29|, 0
    v_max3_f32 v80, |v32|, |v33|, 0
    v_max3_f32 v81, |v36|, |v37|, 0
    v_max3_f32 v78, |v26|, |v27|, v78
    v_max3_f32 v79, |v30|, |v31|, v79
    v_max3_f32 v80, |v34|, |v35|, v80
    v_max3_f32 v81, |v38|, |v39|, v81
    v_max_u32_dpp v78, v78, v78 row_ror:4 row_mask:0xf bank_mask:0xf
    v_max_u32_dpp v79, v79, v79 row_ror:4 row_mask:0xf bank_mask:0xf
    v_max_u32_dpp v80, v80, v80 row_ror:4 row_mask:0xf bank_mask:0xf
    v_max_u32_dpp v81, v81, v81 row_ror:4 row_mask:0xf bank_mask:0xf
    v_max_u32_dpp v61, v78, v78 row_ror:8 row_mask:0xf bank_mask:0x1
    s_nop 1
    v_max_u32_dpp v61, v79, v79 row_ror:8 row_mask:0xf bank_mask:0x2
    s_nop 1
    v_max_u32_dpp v61, v80, v80 row_ror:8 row_mask:0xf bank_mask:0x4
    s_nop 1
    v_max_u32_dpp v61, v81, v81 row_ror:8 row_mask:0xf bank_mask:0x8
    s_nop 1
    v_max_u32_dpp v61, v61, v61 quad_perm:[1,0,3,2] row_mask:0xf bank_mask:0xf
    s_nop 1
    v_max_u32_dpp v61, v61, v61 quad_perm:[2,3,0,1] row_mask:0xf bank_mask:0xf
    v_and_b32 v60, 12, v3
    v_add_u32 v60, v60, v57
    s_mov_b32 exec_lo, 0x11111111
    s_mov_b32 exec_hi, 0x11111111
    ds_max_u32 v60, v61 offset:0
    s_mov_b64 exec, -1
    s_mov_b64 exec, 1
    ds_add_u32 v57, v139 offset:68
    s_mov_b64 exec, -1
CU_PASS:
    s_lshl_b32 s8, s72, 9
    s_add_u32 s8, s8, 124928
    v_lshl_add_u32 v58, v2, 3, s8
    s_mov_b32 s12, 0
SPN9:
    ds_read_b32 v60, v57 offset:68
    s_add_u32 s12, s12, 1
    s_waitcnt lgkmcnt(0)
    v_cmp_eq_u32 vcc, 0, v60
    s_cmp_ge_u32 s12, 0x40000
    s_cbranch_scc1 SPX9
    s_cbranch_vccz SPX9
    s_sleep 2
    s_branch SPN9
SPX9:
    ds_read_b32 v62, v146 offset:0
    s_waitcnt lgkmcnt(0)
    v_lshrrev_b32 v62, 23, v62
    v_sub_u32 v62, 260, v62
    v_min_i32 v62, 253, v62
    v_lshlrev_b32 v64, 23, v62
    s_nop 1
    v_mov_b32_dpp v150, v64 quad_perm:[0,0,0,0] row_mask:0xf bank_mask:0xf
    v_mov_b32_dpp v151, v64 quad_perm:[1,1,1,1] row_mask:0xf bank_mask:0xf
    v_mov_b32_dpp v152, v64 quad_perm:[2,2,2,2] row_mask:0xf bank_mask:0xf
    v_mov_b32_dpp v153, v64 quad_perm:[3,3,3,3] row_mask:0xf bank_mask:0xf
    s_waitcnt vmcnt(7)
    v_lshlrev_b32 v24, 16, v8
    v_and_b32 v28, 0xffff0000, v8
    v_lshlrev_b32 v32, 16, v9
    v_and_b32 v36, 0xffff0000, v9
    s_waitcnt vmcnt(6)
    v_lshlrev_b32 v25, 16, v10
    v_and_b32 v29, 0xffff0000, v10
    v_lshlrev_b32 v33, 16, v11
    v_and_b32 v37, 0xffff0000, v11
    s_waitcnt vmcnt(5)
    v_lshlrev_b32 v26, 16, v12
    v_and_b32 v30, 0xffff0000, v12
    v_lshlrev_b32 v34, 16, v13
    v_and_b32 v38, 0xffff0000, v13
    s_waitcnt vmcnt(4)
    v_lshlrev_b32 v27, 16, v14
    v_and_b32 v31, 0xffff0000, v14
    v_lshlrev_b32 v35, 16, v15
    v_and_b32 v39, 0xffff0000, v15
    v_mul_f32 v66, v24, v150
    v_mul_f32 v67, v25, v150
    v_mul_f32 v68, v26, v150
    v_mul_f32 v69, v27, v150
    v_max3_f32 v65, |v66|, |v67|, 0
    v_cvt_pk_f16_f32 v70, v67, v66
    v_max3_f32 v65, |v68|, |v69|, v65
    v_cvt_pk_f16_f32 v71, v69, v68
    ds_write_b64 v58, v[70:71] offset:0
    v_mul_f32 v72, v28, v151
    v_mul_f32 v73, v29, v151
    v_mul_f32 v74, v30, v151
    v_mul_f32 v75, v31, v151
    v_max3_f32 v65, |v72|, |v73|, v65
    v_cvt_pk_f16_f32 v76, v73, v72
    v_max3_f32 v65, |v74|, |v75|, v65
    v_cvt_pk_f16_f32 v77, v75, v74
    ds_write_b64 v58, v[76:77] offset:8192
    v_mul_f32 v66, v32, v152
    v_mul_f32 v67, v33, v152
    v_mul_f32 v68, v34, v152
    v_mul_f32 v69, v35, v152
    v_max3_f32 v65, |v66|, |v67|, v65
    v_cvt_pk_f16_f32 v70, v67, v66
    v_max3_f32 v65, |v68|, |v69|, v65
    v_cvt_pk_f16_f32 v71, v69, v68
    ds_write_b64 v58, v[70:71] offset:16384
    v_mul_f32 v72, v36, v153
    v_mul_f32 v73, v37, v153
    v_mul_f32 v74, v38, v153
    v_mul_f32 v75, v39, v153
    v_max3_f32 v65, |v72|, |v73|, v65
    v_cvt_pk_f16_f32 v76, v73, v72
    v_max3_f32 v65, |v74|, |v75|, v65
    v_cvt_pk_f16_f32 v77, v75, v74
    ds_write_b64 v58, v[76:77] offset:24576
    s_waitcnt vmcnt(3)
    v_lshlrev_b32 v40, 16, v16
    v_and_b32 v44, 0xffff0000, v16
    v_lshlrev_b32 v48, 16, v17
    v_and_b32 v52, 0xffff0000, v17
    s_waitcnt vmcnt(2)
    v_lshlrev_b32 v41, 16, v18
    v_and_b32 v45, 0xffff0000, v18
    v_lshlrev_b32 v49, 16, v19
    v_and_b32 v53, 0xffff0000, v19
    s_waitcnt vmcnt(1)
    v_lshlrev_b32 v42, 16, v20
    v_and_b32 v46, 0xffff0000, v20
    v_lshlrev_b32 v50, 16, v21
    v_and_b32 v54, 0xffff0000, v21
    s_waitcnt vmcnt(0)
    v_lshlrev_b32 v43, 16, v22
    v_and_b32 v47, 0xffff0000, v22
    v_lshlrev_b32 v51, 16, v23
    v_and_b32 v55, 0xffff0000, v23
    v_mul_f32 v66, v40, v150
    v_mul_f32 v67, v41, v150
    v_mul_f32 v68, v42, v150
    v_mul_f32 v69, v43, v150
    v_max3_f32 v65, |v66|, |v67|, v65
    v_cvt_pk_f16_f32 v70, v67, v66
    v_max3_f32 v65, |v68|, |v69|, v65
    v_cvt_pk_f16_f32 v71, v69, v68
    ds_write_b64 v58, v[70:71] offset:1024
    v_mul_f32 v72, v44, v151
    v_mul_f32 v73, v45, v151
    v_mul_f32 v74, v46, v151
    v_mul_f32 v75, v47, v151
    v_max3_f32 v65, |v72|, |v73|, v65
    v_cvt_pk_f16_f32 v76, v73, v72
    v_max3_f32 v65, |v74|, |v75|, v65
    v_cvt_pk_f16_f32 v77, v75, v74
    ds_write_b64 v58, v[76:77] offset:9216
    v_mul_f32 v66, v48, v152
    v_mul_f32 v67, v49, v152
    v_mul_f32 v68, v50, v152
    v_mul_f32 v69, v51, v152
    v_max3_f32 v65, |v66|, |v67|, v65
    v_cvt_pk_f16_f32 v70, v67, v66
    v_max3_f32 v65, |v68|, |v69|, v65
    v_cvt_pk_f16_f32 v71, v69, v68
    ds_write_b64 v58, v[70:71] offset:17408
    v_mul_f32 v72, v52, v153
    v_mul_f32 v73, v53, v153
    v_mul_f32 v74, v54, v153
    v_mul_f32 v75, v55, v153
    v_max3_f32 v65, |v72|, |v73|, v65
    v_cvt_pk_f16_f32 v76, v73, v72
    v_max3_f32 v65, |v74|, |v75|, v65
    v_cvt_pk_f16_f32 v77, v75, v74
    ds_write_b64 v58, v[76:77] offset:25600
    v_cmp_lt_f32 vcc, s73, v65
    s_cmp_eq_u64 vcc, 0
    s_cselect_b32 s8, 0, 0x10000
    s_cmp_lt_u32 s7, 2
    s_cselect_b32 s9, 1, 16
    s_or_b32 s8, s8, s9
    v_mov_b32 v148, s8
    s_mov_b64 exec, 1
    ds_add_u32 v57, v148 offset:240
    s_mov_b64 exec, -1
    s_setprio 3
    v_lshlrev_b32 v154, 16, s52
    v_mov_b32 v155, s52
    v_lshlrev_b32 v156, 16, s53
    v_mov_b32 v157, s53
    v_and_b32 v155, 0xffff0000, v155
    v_and_b32 v157, 0xffff0000, v157
    v_add_f32 v154, -1.0, v154
    v_add_f32 v155, -1.0, v155
    v_add_f32 v156, -1.0, v156
    v_add_f32 v157, -1.0, v157
    s_cmp_ge_u32 s7, s74
    s_cbranch_scc1 E_NOG
    s_mov_b32 s12, 0
SPN10:
    ds_read_b32 v60, v57 offset:64
    s_add_u32 s12, s12, 1
    s_waitcnt lgkmcnt(0)
    v_cmp_gt_u32 vcc, 4, v60
    s_cmp_ge_u32 s12, 0x40000
    s_cbranch_scc1 SPX10
    s_cbranch_vccz SPX10
    s_sleep 1
    s_branch SPN10
SPX10:
    global_load_dwordx2 v[144:145], v59, s[48:49] sc1
    global_load_dwordx4 v[128:131], v7, s[50:51] sc1
    v_add_u32 v137, 4096, v7
    global_load_dwordx4 v[132:135], v137, s[50:51] sc1
    v_add_u32 v137, 8192, v7
    global_load_dwordx4 v[160:163], v137, s[50:51] sc1
    global_load_dwordx4 v[164:167], v138, s[50:51] sc1
    s_add_u32 s15, s7, 0
    s_cmp_ge_u32 s15, 6
    s_cbranch_scc1 CPF_DE0
    s_mul_i32 s14, s15, 18
    s_add_u32 s14, s14, s101
    v_mul_u32_u24 v140, 9216, v2
    s_mul_i32 s8, s4, 1152
    v_add_u32 v140, s8, v140
    s_mul_i32 s8, s14, 7282
    s_lshr_b32 s8, s8, 16
    s_mul_i32 s9, s8, 9
    s_sub_u32 s9, s14, s9
    s_lshl_b32 s9, s9, 7
    s_bitcmp1_b32 s8, 0
    s_cselect_b32 s12, s40, s38
    s_cselect_b32 s13, s41, s39
    s_lshr_b32 s8, s8, 1
    s_add_u32 s8, s8, 3
    s_mul_i32 s8, s8, 589824
    s_add_u32 s8, s8, s9
    v_add_u32 v148, s8, v140
    global_load_dword v149, v148, s[12:13]
    s_branch CPF_XE0
CPF_DE0:
    s_sub_u32 s14, s15, 6
    s_mul_i32 s14, s14, 18
    s_add_u32 s14, s14, s101
    s_and_b32 s8, s14, 3
    s_mul_i32 s8, s8, 18
    s_lshr_b32 s14, s14, 2
    s_min_u32 s14, s14, 17
    s_sub_u32 s8, s8, s14
    s_mul_i32 s14, s4, 81
    s_add_u32 s8, s8, s14
    s_add_u32 s8, s8, 17
    s_lshl_b32 s8, s8, 13
    v_lshl_add_u32 v148, v2, 7, s8
    global_load_dword v149, v148, s[42:43]
CPF_XE0:
    s_add_u32 s15, s7, 2
    s_cmp_ge_u32 s15, 6
    s_cbranch_scc1 CPF_DE1
    s_mul_i32 s14, s15, 18
    s_add_u32 s14, s14, s101
    v_mul_u32_u24 v140, 9216, v2
    s_mul_i32 s8, s4, 1152
    v_add_u32 v140, s8, v140
    s_mul_i32 s8, s14, 7282
    s_lshr_b32 s8, s8, 16
    s_mul_i32 s9, s8, 9
    s_sub_u32 s9, s14, s9
    s_lshl_b32 s9, s9, 7
    s_bitcmp1_b32 s8, 0
    s_cselect_b32 s12, s40, s38
    s_cselect_b32 s13, s41, s39
    s_lshr_b32 s8, s8, 1
    s_add_u32 s8, s8, 3
    s_mul_i32 s8, s8, 589824
    s_add_u32 s8, s8, s9
    v_add_u32 v148, s8, v140
    global_load_dword v149, v148, s[12:13]
    s_branch CPF_XE1
CPF_DE1:
    s_sub_u32 s14, s15, 6
    s_mul_i32 s14, s14, 18
    s_add_u32 s14, s14, s101
    s_and_b32 s8, s14, 3
    s_mul_i32 s8, s8, 18
    s_lshr_b32 s14, s14, 2
    s_min_u32 s14, s14, 17
    s_sub_u32 s8, s8, s14
    s_mul_i32 s14, s4, 81
    s_add_u32 s8, s8, s14
    s_add_u32 s8, s8, 17
    s_lshl_b32 s8, s8, 13
    v_lshl_add_u32 v148, v2, 7, s8
    global_load_dword v149, v148, s[42:43]
CPF_XE1:
    s_add_u32 s15, s7, 4
    s_cmp_ge_u32 s15, 6
    s_cbranch_scc1 CPF_DE2
    s_mul_i32 s14, s15, 18
    s_add_u32 s14, s14, s101
    v_mul_u32_u24 v140, 9216, v2
    s_mul_i32 s8, s4, 1152
    v_add_u32 v140, s8, v140
    s_mul_i32 s8, s14, 7282
    s_lshr_b32 s8, s8, 16
    s_mul_i32 s9, s8, 9
    s_sub_u32 s9, s14, s9
    s_lshl_b32 s9, s9, 7
    s_bitcmp1_b32 s8, 0
    s_cselect_b32 s12, s40, s38
    s_cselect_b32 s13, s41, s39
    s_lshr_b32 s8, s8, 1
    s_add_u32 s8, s8, 3
    s_mul_i32 s8, s8, 589824
    s_add_u32 s8, s8, s9
    v_add_u32 v148, s8, v140
    global_load_dword v149, v148, s[12:13]
    s_branch CPF_XE2
CPF_DE2:
    s_sub_u32 s14, s15, 6
    s_mul_i32 s14, s14, 18
    s_add_u32 s14, s14, s101
    s_and_b32 s8, s14, 3
    s_mul_i32 s8, s8, 18
    s_lshr_b32 s14, s14, 2
    s_min_u32 s14, s14, 17
    s_sub_u32 s8, s8, s14
    s_mul_i32 s14, s4, 81
    s_add_u32 s8, s8, s14
    s_add_u32 s8, s8, 17
    s_lshl_b32 s8, s8, 13
    v_lshl_add_u32 v148, v2, 7, s8
    global_load_dword v149, v148, s[42:43]
CPF_XE2:
    s_add_u32 s15, s7, 6
    s_cmp_ge_u32 s15, 6
    s_cbranch_scc1 CPF_DE3
    s_mul_i32 s14, s15, 18
    s_add_u32 s14, s14, s101
    v_mul_u32_u24 v140, 9216, v2
    s_mul_i32 s8, s4, 1152
    v_add_u32 v140, s8, v140
    s_mul_i32 s8, s14, 7282
    s_lshr_b32 s8, s8, 16
    s_mul_i32 s9, s8, 9
    s_sub_u32 s9, s14, s9
    s_lshl_b32 s9, s9, 7
    s_bitcmp1_b32 s8, 0
    s_cselect_b32 s12, s40, s38
    s_cselect_b32 s13, s41, s39
    s_lshr_b32 s8, s8, 1
    s_add_u32 s8, s8, 3
    s_mul_i32 s8, s8, 589824
    s_add_u32 s8, s8, s9
    v_add_u32 v148, s8, v140
    global_load_dword v149, v148, s[12:13]
    s_branch CPF_XE3
CPF_DE3:
    s_sub_u32 s14, s15, 6
    s_mul_i32 s14, s14, 18
    s_add_u32 s14, s14, s101
    s_and_b32 s8, s14, 3
    s_mul_i32 s8, s8, 18
    s_lshr_b32 s14, s14, 2
    s_min_u32 s14, s14, 17
    s_sub_u32 s8, s8, s14
    s_mul_i32 s14, s4, 81
    s_add_u32 s8, s8, s14
    s_add_u32 s8, s8, 17
    s_lshl_b32 s8, s8, 13
    v_lshl_add_u32 v148, v2, 7, s8
    global_load_dword v149, v148, s[42:43]
CPF_XE3:
E_NOG:
    v_and_b32 v56, 3, v2
    v_mul_u32_u24 v56, 320, v56
    v_lshrrev_b32 v136, 2, v2
    v_lshl_add_u32 v56, v136, 4, v56
    s_mul_i32 s8, s72, 1280
    v_add_u32 v56, s8, v56
    v_add_u32 v136, 40960, v56
    v_and_b32 v58, 7, v2
    s_lshl_b32 s8, s72, 5
    s_add_u32 s8, s8, 153856
    v_lshl_add_u32 v58, v58, 2, s8
    s_lshl_b32 s8, s72, 10
    v_lshl_add_u32 v147, v2, 4, s8
    v_lshlrev_b32 v148, 1, v147
    v_add_u32 v147, 98304, v147
    v_add_u32 v148, 81920, v148
    v_mul_f32 v64, v24, v154
    v_mul_f32 v65, v25, v154
    v_mul_f32 v66, v26, v154
    v_mul_f32 v67, v27, v154
    v_mul_f32 v68, v28, v155
    v_mul_f32 v69, v29, v155
    v_mul_f32 v70, v30, v155
    v_mul_f32 v71, v31, v155
    v_mul_f32 v72, v32, v156
    v_mul_f32 v73, v33, v156
    v_mul_f32 v74, v34, v156
    v_mul_f32 v75, v35, v156
    v_mul_f32 v76, v36, v157
    v_mul_f32 v77, v37, v157
    v_mul_f32 v78, v38, v157
    v_mul_f32 v79, v39, v157
    v_mul_f32 v80, v40, v154
    v_mul_f32 v81, v41, v154
    v_mul_f32 v82, v42, v154
    v_mul_f32 v83, v43, v154
    v_mul_f32 v84, v44, v155
    v_mul_f32 v85, v45, v155
    v_mul_f32 v86, v46, v155
    v_mul_f32 v87, v47, v155
    v_mul_f32 v88, v48, v156
    v_mul_f32 v89, v49, v156
    v_mul_f32 v90, v50, v156
    v_mul_f32 v91, v51, v156
    v_mul_f32 v92, v52, v157
    v_mul_f32 v93, v53, v157
    v_mul_f32 v94, v54, v157
    v_mul_f32 v95, v55, v157
    s_cmp_lt_u32 s7, 2
    s_cbranch_scc1 E_T0
    s_mov_b32 s12, 0
SPN11:
    ds_read_b32 v60, v57 offset:240
    s_add_u32 s12, s12, 1
    s_waitcnt lgkmcnt(0)
    v_and_b32 v60, 0xffff, v60
    v_cmp_ne_u32 vcc, 34, v60
    s_cmp_ge_u32 s12, 0x40000
    s_cbranch_scc1 SPX11
    s_cbranch_vccz SPX11
    s_sleep 1
    s_branch SPN11
SPX11:
    ds_read_b32 v60, v57 offset:240
    s_waitcnt lgkmcnt(0)
    v_cmp_ne_u32 vcc, 34, v60
    s_nop 0
    s_cbranch_vccnz CU_REDO
    s_branch E_GATES
E_T0:
    s_mov_b32 s12, 0
SPN12:
    ds_read_b32 v60, v58 offset:0
    s_add_u32 s12, s12, 1
    s_waitcnt lgkmcnt(0)
    v_cmp_eq_u32 vcc, 0, v60
    s_cmp_ge_u32 s12, 0x40000
    s_cbranch_scc1 SPX12
    s_cbranch_vccz SPX12
    s_sleep 1
    s_branch SPN12
SPX12:
    ds_read_b32 v63, v146 offset:16
    ds_read_b128 v[96:99], v56 offset:0
    ds_read_b128 v[112:115], v56 offset:10240
    ds_read_b128 v[100:103], v56 offset:20480
    ds_read_b128 v[116:119], v56 offset:30720
    ds_read_b128 v[104:107], v136 offset:0
    ds_read_b128 v[120:123], v136 offset:10240
    ds_read_b128 v[108:111], v136 offset:20480
    ds_read_b128 v[124:127], v136 offset:30720
    s_waitcnt lgkmcnt(8)
    v_add_u32 v62, v62, v63
    v_sub_u32 v62, 381, v62
    v_max_i32 v62, 0, v62
    v_min_i32 v62, 254, v62
    v_lshlrev_b32 v62, 23, v62
    s_nop 1
    v_mov_b32_dpp v150, v62 quad_perm:[0,0,0,0] row_mask:0xf bank_mask:0xf
    v_mov_b32_dpp v151, v62 quad_perm:[1,1,1,1] row_mask:0xf bank_mask:0xf
    v_mov_b32_dpp v152, v62 quad_perm:[2,2,2,2] row_mask:0xf bank_mask:0xf
    v_mov_b32_dpp v153, v62 quad_perm:[3,3,3,3] row_mask:0xf bank_mask:0xf
    s_waitcnt lgkmcnt(6)
    v_add_f32 v96, v96, v112
    v_fma_f32 v96, v96, v150, v64
    v_add_f32 v97, v97, v113
    v_fma_f32 v97, v97, v150, v65
    v_add_f32 v98, v98, v114
    v_fma_f32 v98, v98, v150, v66
    v_add_f32 v99, v99, v115
    v_fma_f32 v99, v99, v150, v67
    s_waitcnt lgkmcnt(4)
    v_add_f32 v100, v100, v116
    v_fma_f32 v100, v100, v151, v68
    v_add_f32 v101, v101, v117
    v_fma_f32 v101, v101, v151, v69
    v_add_f32 v102, v102, v118
    v_fma_f32 v102, v102, v151, v70
    v_add_f32 v103, v103, v119
    v_fma_f32 v103, v103, v151, v71
    s_waitcnt lgkmcnt(2)
    v_add_f32 v104, v104, v120
    v_fma_f32 v104, v104, v152, v72
    v_add_f32 v105, v105, v121
    v_fma_f32 v105, v105, v152, v73
    v_add_f32 v106, v106, v122
    v_fma_f32 v106, v106, v152, v74
    v_add_f32 v107, v107, v123
    v_fma_f32 v107, v107, v152, v75
    s_waitcnt lgkmcnt(0)
    v_add_f32 v108, v108, v124
    v_fma_f32 v108, v108, v153, v76
    v_add_f32 v109, v109, v125
    v_fma_f32 v109, v109, v153, v77
    v_add_f32 v110, v110, v126
    v_fma_f32 v110, v110, v153, v78
    v_add_f32 v111, v111, v127
    v_fma_f32 v111, v111, v153, v79
    s_cmp_ge_u32 s7, 2
    s_cbranch_scc1 E_OUT0
E_GATES:
    s_cmp_lt_u32 s7, s74
    s_cbranch_scc1 E_G1
    s_mov_b32 s12, 0
SPN13:
    ds_read_b32 v60, v57 offset:116
    s_add_u32 s12, s12, 1
    s_waitcnt lgkmcnt(0)
    v_cmp_ne_u32 vcc, 2, v60
    s_cmp_ge_u32 s12, 0x40000
    s_cbranch_scc1 SPX13
    s_cbranch_vccz SPX13
    s_sleep 1
    s_branch SPN13
SPX13:
    ds_read_b128 v[128:131], v147
    ds_read_b128 v[132:135], v147 offset:2048
    s_waitcnt lgkmcnt(0)
    s_branch E_GX
E_G1:
    s_mov_b32 s12, 0
    s_waitcnt vmcnt(4)
    s_branch E_GCHK
E_GPOLL:
    global_load_dwordx2 v[144:145], v59, s[48:49] sc1
    global_load_dwordx4 v[128:131], v7, s[50:51] sc1
    v_add_u32 v137, 4096, v7
    global_load_dwordx4 v[132:135], v137, s[50:51] sc1
    v_add_u32 v137, 8192, v7
    global_load_dwordx4 v[160:163], v137, s[50:51] sc1
    global_load_dwordx4 v[164:167], v138, s[50:51] sc1
    s_add_u32 s12, s12, 1
    s_waitcnt vmcnt(0)
E_GCHK:
    v_xor_b32 v61, 1, v145
    v_bitop3_b32 v61, v61, v128, v144 bitop3:0xf6
    v_bitop3_b32 v61, v61, v129, v144 bitop3:0xf6
    v_bitop3_b32 v61, v61, v130, v144 bitop3:0xf6
    v_bitop3_b32 v61, v61, v131, v144 bitop3:0xf6
    v_bitop3_b32 v61, v61, v132, v144 bitop3:0xf6
    v_bitop3_b32 v61, v61, v133, v144 bitop3:0xf6
    v_bitop3_b32 v61, v61, v134, v144 bitop3:0xf6
    v_bitop3_b32 v61, v61, v135, v144 bitop3:0xf6
    v_bitop3_b32 v61, v61, v160, v144 bitop3:0xf6
    v_bitop3_b32 v61, v61, v161, v144 bitop3:0xf6
    v_bitop3_b32 v61, v61, v162, v144 bitop3:0xf6
    v_bitop3_b32 v61, v61, v163, v144 bitop3:0xf6
    v_bitop3_b32 v61, v61, v164, v144 bitop3:0xf6
    v_bitop3_b32 v61, v61, v165, v144 bitop3:0xf6
    v_bitop3_b32 v61, v61, v166, v144 bitop3:0xf6
    v_bitop3_b32 v61, v61, v167, v144 bitop3:0xf6
    v_and_b32 v61, 0xffff, v61
    v_cmp_ne_u32 vcc, 0, v61
    s_cmp_ge_u32 s12, 16384
    s_cbranch_scc1 E_GOK
    s_cbranch_vccnz E_GPOLL
E_GOK:
    ds_write_b128 v147, v[160:163] offset:4096
    ds_write_b128 v147, v[164:167] offset:6144
    ds_write_b128 v147, v[128:131] offset:0
    ds_write_b128 v147, v[132:135] offset:2048
    ds_write_b32 v57, v144 offset:120
    s_mov_b64 exec, 1
    ds_add_u32 v57, v139 offset:116
    s_mov_b64 exec, -1
E_GX:
    ds_write_b128 v148, v[8:11] offset:0
    ds_write_b128 v148, v[12:15] offset:16
    ds_write_b128 v148, v[16:19] offset:4096
    ds_write_b128 v148, v[20:23] offset:4112
    s_mov_b64 exec, 1
    ds_add_u32 v57, v139 offset:244
    s_mov_b64 exec, -1
    v_and_b32 v128, 0xffff0000, v128
    v_and_b32 v129, 0xffff0000, v129
    v_and_b32 v130, 0xffff0000, v130
    v_and_b32 v131, 0xffff0000, v131
    s_cmp_ge_u32 s7, 2
    s_cbranch_scc1 E_T0
E_OUT0:
    v_fma_f32 v96, v96, v128, v24
    v_fma_f32 v100, v100, v128, v28
    v_fma_f32 v104, v104, v128, v32
    v_fma_f32 v108, v108, v128, v36
    v_cvt_pk_bf16_f32 v112, v96, v100
    v_cvt_pk_bf16_f32 v113, v104, v108
    global_store_dwordx2 v5, v[112:113], s[46:47] offset:0
    v_fma_f32 v97, v97, v129, v25
    v_fma_f32 v101, v101, v129, v29
    v_fma_f32 v105, v105, v129, v33
    v_fma_f32 v109, v109, v129, v37
    v_cvt_pk_bf16_f32 v114, v97, v101
    v_cvt_pk_bf16_f32 v115, v105, v109
    global_store_dwordx2 v5, v[114:115], s[46:47] offset:1152
    v_fma_f32 v98, v98, v130, v26
    v_fma_f32 v102, v102, v130, v30
    v_fma_f32 v106, v106, v130, v34
    v_fma_f32 v110, v110, v130, v38
    v_cvt_pk_bf16_f32 v116, v98, v102
    v_cvt_pk_bf16_f32 v117, v106, v110
    global_store_dwordx2 v5, v[116:117], s[46:47] offset:2304
    v_fma_f32 v99, v99, v131, v27
    v_fma_f32 v103, v103, v131, v31
    v_fma_f32 v107, v107, v131, v35
    v_fma_f32 v111, v111, v131, v39
    v_cvt_pk_bf16_f32 v118, v99, v103
    v_cvt_pk_bf16_f32 v119, v107, v111
    global_store_dwordx2 v5, v[118:119], s[46:47] offset:3456
    v_and_b32 v132, 0xffff0000, v132
    v_and_b32 v133, 0xffff0000, v133
    v_and_b32 v134, 0xffff0000, v134
    v_and_b32 v135, 0xffff0000, v135
    s_mov_b32 s12, 0
SPN14:
    ds_read_b32 v60, v58 offset:64
    s_add_u32 s12, s12, 1
    s_waitcnt lgkmcnt(0)
    v_cmp_eq_u32 vcc, 0, v60
    s_cmp_ge_u32 s12, 0x40000
    s_cbranch_scc1 SPX14
    s_cbranch_vccz SPX14
    s_sleep 1
    s_branch SPN14
SPX14:
    ds_read_b128 v[96:99], v56 offset:2560
    ds_read_b128 v[112:115], v56 offset:12800
    ds_read_b128 v[100:103], v56 offset:23040
    ds_read_b128 v[116:119], v56 offset:33280
    ds_read_b128 v[104:107], v136 offset:2560
    ds_read_b128 v[120:123], v136 offset:12800
    ds_read_b128 v[108:111], v136 offset:23040
    ds_read_b128 v[124:127], v136 offset:33280
    s_waitcnt lgkmcnt(6)
    v_add_f32 v96, v96, v112
    v_fma_f32 v96, v96, v150, v80
    v_add_f32 v97, v97, v113
    v_fma_f32 v97, v97, v150, v81
    v_add_f32 v98, v98, v114
    v_fma_f32 v98, v98, v150, v82
    v_add_f32 v99, v99, v115
    v_fma_f32 v99, v99, v150, v83
    s_waitcnt lgkmcnt(4)
    v_add_f32 v100, v100, v116
    v_fma_f32 v100, v100, v151, v84
    v_add_f32 v101, v101, v117
    v_fma_f32 v101, v101, v151, v85
    v_add_f32 v102, v102, v118
    v_fma_f32 v102, v102, v151, v86
    v_add_f32 v103, v103, v119
    v_fma_f32 v103, v103, v151, v87
    s_waitcnt lgkmcnt(2)
    v_add_f32 v104, v104, v120
    v_fma_f32 v104, v104, v152, v88
    v_add_f32 v105, v105, v121
    v_fma_f32 v105, v105, v152, v89
    v_add_f32 v106, v106, v122
    v_fma_f32 v106, v106, v152, v90
    v_add_f32 v107, v107, v123
    v_fma_f32 v107, v107, v152, v91
    s_waitcnt lgkmcnt(0)
    v_add_f32 v108, v108, v124
    v_fma_f32 v108, v108, v153, v92
    v_add_f32 v109, v109, v125
    v_fma_f32 v109, v109, v153, v93
    v_add_f32 v110, v110, v126
    v_fma_f32 v110, v110, v153, v94
    v_add_f32 v111, v111, v127
    v_fma_f32 v111, v111, v153, v95
    v_fma_f32 v96, v96, v132, v40
    v_fma_f32 v100, v100, v132, v44
    v_fma_f32 v104, v104, v132, v48
    v_fma_f32 v108, v108, v132, v52
    v_cvt_pk_bf16_f32 v112, v96, v100
    v_cvt_pk_bf16_f32 v113, v104, v108
    global_store_dwordx2 v6, v[112:113], s[46:47] offset:0
    v_fma_f32 v97, v97, v133, v41
    v_fma_f32 v101, v101, v133, v45
    v_fma_f32 v105, v105, v133, v49
    v_fma_f32 v109, v109, v133, v53
    v_cvt_pk_bf16_f32 v114, v97, v101
    v_cvt_pk_bf16_f32 v115, v105, v109
    global_store_dwordx2 v6, v[114:115], s[46:47] offset:1152
    v_fma_f32 v98, v98, v134, v42
    v_fma_f32 v102, v102, v134, v46
    v_fma_f32 v106, v106, v134, v50
    v_fma_f32 v110, v110, v134, v54
    v_cvt_pk_bf16_f32 v116, v98, v102
    v_cvt_pk_bf16_f32 v117, v106, v110
    global_store_dwordx2 v6, v[116:117], s[46:47] offset:2304
    v_fma_f32 v99, v99, v135, v43
    v_fma_f32 v103, v103, v135, v47
    v_fma_f32 v107, v107, v135, v51
    v_fma_f32 v111, v111, v135, v55
    v_cvt_pk_bf16_f32 v118, v99, v103
    v_cvt_pk_bf16_f32 v119, v107, v111
    global_store_dwordx2 v6, v[118:119], s[46:47] offset:3456
    s_mov_b32 s12, 0
SPN15:
    ds_read_b32 v60, v57 offset:240
    s_add_u32 s12, s12, 1
    s_waitcnt lgkmcnt(0)
    v_and_b32 v60, 0xffff, v60
    v_cmp_ne_u32 vcc, 34, v60
    s_cmp_ge_u32 s12, 0x40000
    s_cbranch_scc1 SPX15
    s_cbranch_vccz SPX15
    s_sleep 1
    s_branch SPN15
SPX15:
    ds_read_b32 v60, v57 offset:240
    s_waitcnt lgkmcnt(0)
    v_cmp_ne_u32 vcc, 34, v60
    s_nop 0
    s_cbranch_vccnz CU_REDO
    s_waitcnt vmcnt(0)
    s_endpgm
CU_REDO:
    s_waitcnt vmcnt(0)
    s_barrier
    v_lshlrev_b32 v24, 16, v8
    v_and_b32 v28, 0xffff0000, v8
    v_lshlrev_b32 v32, 16, v9
    v_and_b32 v36, 0xffff0000, v9
    v_lshlrev_b32 v25, 16, v10
    v_and_b32 v29, 0xffff0000, v10
    v_lshlrev_b32 v33, 16, v11
    v_and_b32 v37, 0xffff0000, v11
    v_lshlrev_b32 v26, 16, v12
    v_and_b32 v30, 0xffff0000, v12
    v_lshlrev_b32 v34, 16, v13
    v_and_b32 v38, 0xffff0000, v13
    v_lshlrev_b32 v27, 16, v14
    v_and_b32 v31, 0xffff0000, v14
    v_lshlrev_b32 v35, 16, v15
    v_and_b32 v39, 0xffff0000, v15
    v_max3_f32 v78, |v24|, |v25|, 0
    v_max3_f32 v79, |v28|, |v29|, 0
    v_max3_f32 v80, |v32|, |v33|, 0
    v_max3_f32 v81, |v36|, |v37|, 0
    v_max3_f32 v78, |v26|, |v27|, v78
    v_max3_f32 v79, |v30|, |v31|, v79
    v_max3_f32 v80, |v34|, |v35|, v80
    v_max3_f32 v81, |v38|, |v39|, v81
    v_lshlrev_b32 v40, 16, v16
    v_and_b32 v44, 0xffff0000, v16
    v_lshlrev_b32 v48, 16, v17
    v_and_b32 v52, 0xffff0000, v17
    v_lshlrev_b32 v41, 16, v18
    v_and_b32 v45, 0xffff0000, v18
    v_lshlrev_b32 v49, 16, v19
    v_and_b32 v53, 0xffff0000, v19
    v_lshlrev_b32 v42, 16, v20
    v_and_b32 v46, 0xffff0000, v20
    v_lshlrev_b32 v50, 16, v21
    v_and_b32 v54, 0xffff0000, v21
    v_lshlrev_b32 v43, 16, v22
    v_and_b32 v47, 0xffff0000, v22
    v_lshlrev_b32 v51, 16, v23
    v_and_b32 v55, 0xffff0000, v23
    v_max3_f32 v78, |v40|, |v41|, v78
    v_max3_f32 v79, |v44|, |v45|, v79
    v_max3_f32 v80, |v48|, |v49|, v80
    v_max3_f32 v81, |v52|, |v53|, v81
    v_max3_f32 v78, |v42|, |v43|, v78
    v_max3_f32 v79, |v46|, |v47|, v79
    v_max3_f32 v80, |v50|, |v51|, v80
    v_max3_f32 v81, |v54|, |v55|, v81
    v_max_u32_dpp v78, v78, v78 row_ror:4 row_mask:0xf bank_mask:0xf
    v_max_u32_dpp v79, v79, v79 row_ror:4 row_mask:0xf bank_mask:0xf
    v_max_u32_dpp v80, v80, v80 row_ror:4 row_mask:0xf bank_mask:0xf
    v_max_u32_dpp v81, v81, v81 row_ror:4 row_mask:0xf bank_mask:0xf
    v_max_u32_dpp v61, v78, v78 row_ror:8 row_mask:0xf bank_mask:0x1
    s_nop 1
    v_max_u32_dpp v61, v79, v79 row_ror:8 row_mask:0xf bank_mask:0x2
    s_nop 1
    v_max_u32_dpp v61, v80, v80 row_ror:8 row_mask:0xf bank_mask:0x4
    s_nop 1
    v_max_u32_dpp v61, v81, v81 row_ror:8 row_mask:0xf bank_mask:0x8
    s_nop 1
    v_max_u32_dpp v61, v61, v61 quad_perm:[1,0,3,2] row_mask:0xf bank_mask:0xf
    s_nop 1
    v_max_u32_dpp v61, v61, v61 quad_perm:[2,3,0,1] row_mask:0xf bank_mask:0xf
    v_and_b32 v60, 12, v3
    v_add_u32 v60, v60, v57
    s_mov_b32 exec_lo, 0x11111111
    s_mov_b32 exec_hi, 0x11111111
    ds_max_u32 v60, v61 offset:0
    s_mov_b64 exec, -1
    v_lshl_add_u32 v60, v2, 2, v57
    v_mov_b32 v61, 0
    ds_write_b32 v60, v61 offset:256
    ds_write_b32 v57, v61 offset:240
    ds_write_b32 v57, v61 offset:244
    s_mov_b32 s73, 0x7f800000
    s_mov_b32 s74, 0
    s_waitcnt lgkmcnt(0)
    s_barrier
    s_branch CU_PASS
FINAL:
    v_and_b32 v5, 7, v2
    v_lshlrev_b32 v5, 2, v5
    s_lshl_b32 s10, s6, 3
    s_load_dwordx2 s[52:53], s[32:33], s10
    s_mov_b32 s12, 0
SPN16:
    ds_read_b32 v42, v167 offset:244
    s_add_u32 s12, s12, 1
    s_waitcnt lgkmcnt(0)
    v_cmp_ne_u32 vcc, 4, v42
    s_cmp_ge_u32 s12, 0x40000
    s_cbranch_scc1 SPX16
    s_cbranch_vccz SPX16
    s_sleep 1
    s_branch SPN16
SPX16:
    ds_read_b32 v42, v167 offset:120
    s_waitcnt lgkmcnt(0)
    v_and_b32 v6, 7, v2
    s_lshl_b32 s9, s4, 8
    v_lshl_add_u32 v6, v6, 3, s9
    v_and_b32 v7, 7, v2
    s_lshl_b32 s9, s4, 10
    s_add_u32 s9, s9, 48896
    v_lshl_add_u32 v7, v7, 7, s9
    s_mov_b32 s12, 0
    s_waitcnt vmcnt(0)
    v_mov_b32 v8, v124
    v_mov_b32 v9, v125
    s_branch SPC_F
SP_F:
    s_add_u32 s12, s12, 1
    s_and_b32 s9, s12, 7
    s_cselect_b64 s[14:15], 0, -1
    v_cndmask_b32 v10, v6, v7, s[14:15]
    global_load_dwordx2 v[8:9], v10, s[50:51] offset:256 sc1
    s_waitcnt vmcnt(0)
SPC_F:
    v_cmp_ne_u32 vcc, v9, v42
    s_cmp_ge_u32 s12, 16384
    s_cbranch_scc1 SPX_F
    s_cbranch_vccz SPX_F
    s_mov_b64 exec, vcc
    s_sleep 2
    s_branch SP_F
SPX_F:
    s_mov_b64 exec, -1
    v_and_b32 v9, 0xff, v42
    v_not_b32 v10, v8
    v_and_b32 v10, 0x7ff, v10
    v_mul_u32_u24 v11, 1152, v10
    v_add_u32 v11, s10, v11
    v_lshlrev_b32 v14, 3, v10
    v_add_u32 v14, 81920, v14
    ds_read_b64 v[12:13], v14
    v_lshlrev_b32 v14, 2, v10
    v_add_u32 v14, 98304, v14
    ds_read_b32 v15, v14
    v_lshrrev_b32 v16, 8, v10
    v_mul_u32_u24 v16, 1280, v16
    v_and_b32 v17, 0xf0, v10
    v_add_u32 v16, v16, v17
    v_bfe_u32 v17, v10, 2, 2
    v_mul_u32_u24 v17, 320, v17
    v_add_u32 v16, v16, v17
    v_and_b32 v17, 3, v10
    v_lshl_add_u32 v16, v17, 2, v16
    v_add_u32 v17, 40960, v16
    v_add_u32 v18, 154080, v5
    v_mov_b32 v19, 153600
    ds_read_b128 v[44:47], v19 offset:16
    ds_read_b128 v[36:39], v19
    v_and_b32 v20, 0xffff0000, v8
    v_not_b32 v21, v20
    v_ashrrev_i32 v21, 31, v21
    v_and_b32 v21, 0x7fff0000, v21
    v_or_b32 v21, 0x80000000, v21
    v_xor_b32 v20, v20, v21
    v_mul_f32 v21, 0xbfb8aa3b, v20
    v_exp_f32 v21, v21
    s_nop 0
    v_add_f32 v21, 1.0, v21
    v_rcp_f32 v21, v21
    s_nop 0
    v_cvt_pk_bf16_f32 v20, v21, v21
    v_and_b32 v20, 0xffff0000, v20
    s_waitcnt lgkmcnt(0)
    v_and_b32 v15, 0xffff0000, v15
    v_sub_f32 v21, 1.0, v15
    v_cvt_pk_bf16_f32 v21, v21, v21
    v_and_b32 v21, 0xffff0000, v21
    v_lshlrev_b32 v24, 16, v12
    v_and_b32 v25, 0xffff0000, v12
    v_lshlrev_b32 v26, 16, v13
    v_and_b32 v27, 0xffff0000, v13
    s_waitcnt lgkmcnt(0)
    v_lshrrev_b32 v36, 23, v36
    v_sub_u32 v36, 260, v36
    v_min_i32 v36, 253, v36
    v_add_u32 v36, v36, v44
    v_sub_u32 v36, 381, v36
    v_max_i32 v36, 0, v36
    v_min_i32 v36, 254, v36
    v_lshlrev_b32 v36, 23, v36
    v_lshrrev_b32 v37, 23, v37
    v_sub_u32 v37, 260, v37
    v_min_i32 v37, 253, v37
    v_add_u32 v37, v37, v45
    v_sub_u32 v37, 381, v37
    v_max_i32 v37, 0, v37
    v_min_i32 v37, 254, v37
    v_lshlrev_b32 v37, 23, v37
    v_lshrrev_b32 v38, 23, v38
    v_sub_u32 v38, 260, v38
    v_min_i32 v38, 253, v38
    v_add_u32 v38, v38, v46
    v_sub_u32 v38, 381, v38
    v_max_i32 v38, 0, v38
    v_min_i32 v38, 254, v38
    v_lshlrev_b32 v38, 23, v38
    v_lshrrev_b32 v39, 23, v39
    v_sub_u32 v39, 260, v39
    v_min_i32 v39, 253, v39
    v_add_u32 v39, v39, v47
    v_sub_u32 v39, 381, v39
    v_max_i32 v39, 0, v39
    v_min_i32 v39, 254, v39
    v_lshlrev_b32 v39, 23, v39
    s_mov_b32 s12, 0
FN_WAIT:
    ds_read_b32 v22, v18
    s_add_u32 s12, s12, 1
    s_waitcnt lgkmcnt(0)
    v_cmp_eq_u32 vcc, 0, v22
    s_cmp_ge_u32 s12, 0x40000
    s_cbranch_scc1 FN_RDY
    s_cbranch_vccz FN_RDY
    s_sleep 1
    s_branch FN_WAIT
FN_RDY:
    ds_read_b32 v28, v16 offset:0
    ds_read_b32 v32, v16 offset:10240
    ds_read_b32 v29, v16 offset:20480
    ds_read_b32 v33, v16 offset:30720
    ds_read_b32 v30, v17 offset:0
    ds_read_b32 v34, v17 offset:10240
    ds_read_b32 v31, v17 offset:20480
    ds_read_b32 v35, v17 offset:30720
    s_lshl_b32 s60, s52, 16
    s_and_b32 s61, s52, 0xffff0000
    s_lshl_b32 s62, s53, 16
    s_and_b32 s63, s53, 0xffff0000
    s_mul_i32 s8, s6, 5248
    s_add_u32 s8, s8, 356352
    v_lshl_add_u32 v22, v2, 4, s8
    s_waitcnt lgkmcnt(0)
    v_add_f32 v28, v28, v32
    v_mul_f32 v28, v28, v36
    v_mul_f32 v32, s60, v24
    v_add_f32 v29, v29, v33
    v_mul_f32 v29, v29, v37
    v_mul_f32 v33, s61, v25
    v_add_f32 v30, v30, v34
    v_mul_f32 v30, v30, v38
    v_mul_f32 v34, s62, v26
    v_add_f32 v31, v31, v35
    v_mul_f32 v31, v31, v39
    v_mul_f32 v35, s63, v27
    v_cvt_pk_bf16_f32 v28, 0, v28
    v_cvt_pk_bf16_f32 v29, 0, v29
    v_cvt_pk_bf16_f32 v30, 0, v30
    v_cvt_pk_bf16_f32 v31, 0, v31
    v_cvt_pk_bf16_f32 v32, 0, v32
    v_cvt_pk_bf16_f32 v33, 0, v33
    v_cvt_pk_bf16_f32 v34, 0, v34
    v_cvt_pk_bf16_f32 v35, 0, v35
    v_add_f32 v28, v28, v32
    v_add_f32 v29, v29, v33
    v_add_f32 v30, v30, v34
    v_add_f32 v31, v31, v35
    v_cvt_pk_bf16_f32 v28, 0, v28
    v_cvt_pk_bf16_f32 v29, 0, v29
    v_cvt_pk_bf16_f32 v30, 0, v30
    v_cvt_pk_bf16_f32 v31, 0, v31
    v_mul_f32 v28, v28, v15
    v_mul_f32 v29, v29, v15
    v_mul_f32 v30, v30, v15
    v_mul_f32 v31, v31, v15
    v_cvt_pk_bf16_f32 v28, 0, v28
    v_cvt_pk_bf16_f32 v29, 0, v29
    v_cvt_pk_bf16_f32 v30, 0, v30
    v_cvt_pk_bf16_f32 v31, 0, v31
    v_min_u32 v33, 4, v2
    s_lshl_b32 s11, s4, 7
    v_lshl_add_u32 v33, v33, 2, s11
    s_mov_b32 s12, 0
FN_R:
    global_load_dword v34, v33, s[50:51] offset:2304 sc1
    s_add_u32 s12, s12, 1
    s_waitcnt vmcnt(0)
    v_cmp_ne_u32 vcc, v34, v42
    s_cmp_ge_u32 s12, 64
    s_cbranch_scc1 FN_RX
    s_cbranch_vccz FN_RX
    s_sleep 2
    s_branch FN_R
FN_RX:
    s_mov_b32 s12, 0
    s_mov_b64 s[52:53], -1
    s_mov_b64 s[54:55], -1
    s_mov_b64 s[56:57], -1
    s_mov_b64 s[58:59], -1
    s_mov_b64 s[60:61], -1
FN_P:
    s_mov_b64 exec, s[52:53]
    s_cbranch_execz FN_L0
    global_load_dwordx4 v[48:51], v22, s[50:51] offset:-4096 sc1
FN_L0:
    s_mov_b64 exec, s[54:55]
    s_cbranch_execz FN_L1
    global_load_dwordx4 v[52:55], v22, s[50:51] offset:-3072 sc1
FN_L1:
    s_mov_b64 exec, s[56:57]
    s_cbranch_execz FN_L2
    global_load_dwordx4 v[56:59], v22, s[50:51] offset:-2048 sc1
FN_L2:
    s_mov_b64 exec, s[58:59]
    s_cbranch_execz FN_L3
    global_load_dwordx4 v[60:63], v22, s[50:51] offset:-1024 sc1
FN_L3:
    s_mov_b64 exec, s[60:61]
    s_cbranch_execz FN_L4
    global_load_dwordx4 v[64:67], v22, s[50:51] offset:0 sc1
FN_L4:
    s_mov_b64 exec, -1
    s_add_u32 s12, s12, 1
    s_waitcnt vmcnt(0)
    v_xor_b32 v32, v48, v9
    v_bitop3_b32 v32, v32, v49, v9 bitop3:0xf6
    v_bitop3_b32 v32, v32, v50, v9 bitop3:0xf6
    v_bitop3_b32 v32, v32, v51, v9 bitop3:0xf6
    v_and_b32 v32, 0xff, v32
    v_cmp_ne_u32 s[52:53], 0, v32
    v_xor_b32 v32, v52, v9
    v_bitop3_b32 v32, v32, v53, v9 bitop3:0xf6
    v_bitop3_b32 v32, v32, v54, v9 bitop3:0xf6
    v_bitop3_b32 v32, v32, v55, v9 bitop3:0xf6
    v_and_b32 v32, 0xff, v32
    v_cmp_ne_u32 s[54:55], 0, v32
    v_xor_b32 v32, v56, v9
    v_bitop3_b32 v32, v32, v57, v9 bitop3:0xf6
    v_bitop3_b32 v32, v32, v58, v9 bitop3:0xf6
    v_bitop3_b32 v32, v32, v59, v9 bitop3:0xf6
    v_and_b32 v32, 0xff, v32
    v_cmp_ne_u32 s[56:57], 0, v32
    v_xor_b32 v32, v60, v9
    v_bitop3_b32 v32, v32, v61, v9 bitop3:0xf6
    v_bitop3_b32 v32, v32, v62, v9 bitop3:0xf6
    v_bitop3_b32 v32, v32, v63, v9 bitop3:0xf6
    v_and_b32 v32, 0xff, v32
    v_cmp_ne_u32 s[58:59], 0, v32
    v_xor_b32 v32, v64, v9
    v_bitop3_b32 v32, v32, v65, v9 bitop3:0xf6
    v_bitop3_b32 v32, v32, v66, v9 bitop3:0xf6
    v_bitop3_b32 v32, v32, v67, v9 bitop3:0xf6
    v_and_b32 v32, 0xff, v32
    v_cmp_ne_u32 s[60:61], 0, v32
    s_or_b64 vcc, s[52:53], s[54:55]
    s_or_b64 s[62:63], s[56:57], s[58:59]
    s_or_b64 vcc, vcc, s[60:61]
    s_or_b64 vcc, vcc, s[62:63]
    s_cbranch_scc0 FN_POK
    s_cmp_lt_u32 s12, 16384
    s_cbranch_scc1 FN_P
FN_POK:
    s_mov_b64 exec, -1
    v_and_b32 v48, 0xffffff00, v48
    v_and_b32 v49, 0xffffff00, v49
    v_and_b32 v50, 0xffffff00, v50
    v_and_b32 v51, 0xffffff00, v51
    v_and_b32 v52, 0xffffff00, v52
    v_and_b32 v53, 0xffffff00, v53
    v_and_b32 v54, 0xffffff00, v54
    v_and_b32 v55, 0xffffff00, v55
    v_and_b32 v56, 0xffffff00, v56
    v_and_b32 v57, 0xffffff00, v57
    v_and_b32 v58, 0xffffff00, v58
    v_and_b32 v59, 0xffffff00, v59
    v_and_b32 v60, 0xffffff00, v60
    v_and_b32 v61, 0xffffff00, v61
    v_and_b32 v62, 0xffffff00, v62
    v_and_b32 v63, 0xffffff00, v63
    v_and_b32 v64, 0xffffff00, v64
    v_and_b32 v65, 0xffffff00, v65
    v_and_b32 v66, 0xffffff00, v66
    v_and_b32 v67, 0xffffff00, v67
    v_pk_add_f32 v[48:49], v[48:49], v[52:53]
    v_pk_add_f32 v[50:51], v[50:51], v[54:55]
    v_pk_add_f32 v[48:49], v[48:49], v[56:57]
    v_pk_add_f32 v[50:51], v[50:51], v[58:59]
    v_pk_add_f32 v[48:49], v[48:49], v[60:61]
    v_pk_add_f32 v[50:51], v[50:51], v[62:63]
    v_pk_add_f32 v[48:49], v[48:49], v[64:65]
    v_pk_add_f32 v[50:51], v[50:51], v[66:67]
    s_nop 0
    v_add_f32_dpp v48, v48, v48 row_ror:8 row_mask:0xf bank_mask:0xf
    v_add_f32_dpp v49, v49, v49 row_ror:8 row_mask:0xf bank_mask:0xf
    v_add_f32_dpp v50, v50, v50 row_ror:8 row_mask:0xf bank_mask:0xf
    v_add_f32_dpp v51, v51, v51 row_ror:8 row_mask:0xf bank_mask:0xf
    v_mov_b32 v52, v48
    v_mov_b32 v53, v49
    v_mov_b32 v54, v50
    v_mov_b32 v55, v51
    v_permlane16_swap_b32 v48, v52
    v_permlane16_swap_b32 v49, v53
    v_permlane16_swap_b32 v50, v54
    v_permlane16_swap_b32 v51, v55
    v_add_f32 v48, v48, v52
    v_add_f32 v49, v49, v53
    v_add_f32 v50, v50, v54
    v_add_f32 v51, v51, v55
    v_mov_b32 v52, v48
    v_mov_b32 v53, v49
    v_mov_b32 v54, v50
    v_mov_b32 v55, v51
    v_permlane32_swap_b32 v48, v52
    v_permlane32_swap_b32 v49, v53
    v_permlane32_swap_b32 v50, v54
    v_permlane32_swap_b32 v51, v55
    v_add_f32 v48, v48, v52
    v_add_f32 v49, v49, v53
    v_add_f32 v50, v50, v54
    v_add_f32 v51, v51, v55
    v_cvt_pk_bf16_f32 v48, 0, v48
    v_cvt_pk_bf16_f32 v49, 0, v49
    v_cvt_pk_bf16_f32 v50, 0, v50
    v_cvt_pk_bf16_f32 v51, 0, v51
    v_mul_f32 v48, v48, v20
    v_mul_f32 v49, v49, v20
    v_mul_f32 v50, v50, v20
    v_mul_f32 v51, v51, v20
    v_cvt_pk_bf16_f32 v48, 0, v48
    v_cvt_pk_bf16_f32 v49, 0, v49
    v_cvt_pk_bf16_f32 v50, 0, v50
    v_cvt_pk_bf16_f32 v51, 0, v51
    v_add_f32 v48, v48, v24
    v_add_f32 v49, v49, v25
    v_add_f32 v50, v50, v26
    v_add_f32 v51, v51, v27
    v_cvt_pk_bf16_f32 v48, 0, v48
    v_cvt_pk_bf16_f32 v49, 0, v49
    v_cvt_pk_bf16_f32 v50, 0, v50
    v_cvt_pk_bf16_f32 v51, 0, v51
    v_mul_f32 v48, v48, v21
    v_mul_f32 v49, v49, v21
    v_mul_f32 v50, v50, v21
    v_mul_f32 v51, v51, v21
    v_cvt_pk_bf16_f32 v48, 0, v48
    v_cvt_pk_bf16_f32 v49, 0, v49
    v_cvt_pk_bf16_f32 v50, 0, v50
    v_cvt_pk_bf16_f32 v51, 0, v51
    v_add_f32 v48, v48, v28
    v_add_f32 v49, v49, v29
    v_add_f32 v50, v50, v30
    v_add_f32 v51, v51, v31
    v_cvt_pk_bf16_f32 v40, v48, v49
    v_cvt_pk_bf16_f32 v41, v50, v51
    s_barrier
    s_mov_b64 exec, 0xff
    global_store_dwordx2 v11, v[40:41], s[46:47]
    s_endpgm
W_END:
    s_endpgm
K_END:
    s_endpgm
CODE_END:
.section .rodata,"a"
.p2align 6
.amdhsa_kernel k1_kernel
  .amdhsa_next_free_vgpr 168
  .amdhsa_next_free_sgpr 102
  .amdhsa_accum_offset 168
  .amdhsa_group_segment_fixed_size 0
  .amdhsa_kernarg_size 144
  .amdhsa_user_sgpr_count 2
  .amdhsa_user_sgpr_kernarg_segment_ptr 1
  .amdhsa_system_sgpr_workgroup_id_x 1
.end_amdhsa_kernel
```

```asm
; @launch kernel=k1_kernel grid=(256,1,1) block=(768,1,1) lds=163840
.amdgcn_target "amdgcn-amd-amdhsa--gfx950"
.text
.p2align 8
.globl k1_kernel
.type k1_kernel,@function
k1_kernel:
    s_cmp_ge_u32 s2, 256
    s_cbranch_scc1 K_END
    s_load_dwordx16 s[16:31], s[0:1], 0
    s_load_dwordx16 s[32:47], s[0:1], 64
    s_load_dwordx4 s[48:51], s[0:1], 128
    v_lshrrev_b32 v1, 6, v0
    v_and_b32 v2, 63, v0
    v_readfirstlane_b32 s3, v1
    v_and_b32 v3, 15, v2
    v_lshrrev_b32 v4, 4, v2
    s_and_b32 s4, s2, 7
    s_lshr_b32 s5, s2, 3
    s_cmp_lg_u32 s3, 0
    s_cbranch_scc1 K_NOCPF
    s_getpc_b64 s[8:9]
    s_and_b32 s8, s8, 0xffffff00
    v_and_b32 v5, 7, v2
    v_lshl_add_u32 v5, s5, 3, v5
    v_lshlrev_b32 v5, 7, v5
    v_min_u32 v5, CODE_END-k1_kernel-4, v5
    global_load_dword v167, v5, s[8:9]
K_NOCPF:
    s_cmp_lt_u32 s2, 112
    s_cbranch_scc1 K_NC
    s_sub_u32 s101, s5, 14
    s_mul_i32 s6, s4, 18
    s_add_u32 s6, s6, s101
    s_cmp_lt_u32 s3, 8
    s_cbranch_scc1 CK_PRO
CU_PRO:
    s_sub_u32 s7, s3, 8
    s_lshl_b32 s8, s101, 2
    s_add_u32 s8, s8, s7
    s_mul_i32 s10, s8, 57
    s_lshr_b32 s10, s10, 9
    s_mul_i32 s11, s10, 9
    s_sub_u32 s11, s8, s11
    s_sub_u32 s8, s8, s10
    s_mul_i32 s8, s8, 36864
    s_lshl_b32 s9, s4, 7
    s_add_u32 s8, s8, s9
    v_lshrrev_b32 v5, 1, v2
    v_mul_u32_u24 v5, 1152, v5
    v_and_b32 v6, 1, v2
    v_lshl_add_u32 v5, v6, 7, v5
    v_add_u32 v7, s8, v5
    s_and_b32 s15, s7, 2
    s_add_u32 s15, s15, s7
    s_mul_i32 s8, s15, 294912
    s_lshl_b32 s9, s6, 3
    s_add_u32 s8, s8, s9
    v_mul_u32_u24 v5, 4608, v2
    v_add_u32 v5, s8, v5
    v_add_u32 v6, 589824, v5
    v_mov_b32 v58, 0
    v_mov_b32 v59, 0
    v_mov_b32 v57, 153600
    v_lshl_add_u32 v56, v2, 3, v57
    ds_write_b64 v56, v[58:59]
    s_waitcnt lgkmcnt(0)
    s_barrier
    s_cmp_eq_u32 s7, 3
    s_cbranch_scc1 CU_C3A
CU_C3B:
    global_load_dword v60, v59, s[30:31]
    s_load_dwordx2 s[52:53], s[32:33], s9
    s_branch CU_PRE
CU_PREX:
    s_cmp_eq_u32 s11, 8
    s_cbranch_scc1 CU_C3
    global_load_dword v60, v7, s[16:17]
CU_C3X:
    s_cmp_ge_u32 s7, 1
    s_cbranch_scc1 CU_MID
CU_LD:
    global_load_dwordx2 v[8:9], v5, s[16:17] offset:0 sc1
    global_load_dwordx2 v[10:11], v5, s[16:17] offset:1152 sc1
    global_load_dwordx2 v[12:13], v5, s[16:17] offset:2304 sc1
    global_load_dwordx2 v[14:15], v5, s[16:17] offset:3456 sc1
    global_load_dwordx2 v[16:17], v6, s[16:17] offset:0 sc1
    global_load_dwordx2 v[18:19], v6, s[16:17] offset:1152 sc1
    global_load_dwordx2 v[20:21], v6, s[16:17] offset:2304 sc1
    global_load_dwordx2 v[22:23], v6, s[16:17] offset:3456 sc1
    s_branch CU_MAIN
CK_PRO:
    s_and_b32 s7, s3, 3
    s_lshr_b32 s12, s3, 2
    s_lshl_b32 s8, s6, 2
    s_add_u32 s8, s8, s7
    s_lshl_b32 s9, s8, 8
    v_lshl_add_u32 v6, v2, 2, s9
    s_lshl_b32 s8, s8, 1
    v_mov_b32 v7, s8
    v_mov_b32 v18, 0
    s_waitcnt lgkmcnt(0)
    global_load_short_d16_hi v18, v7, s[30:31]
    global_load_dword v28, v6, s[18:19]
    global_load_dword v29, v6, s[20:21]
    global_load_dword v30, v6, s[22:23]
    global_load_dword v31, v6, s[24:25]
    global_load_dword v32, v6, s[26:27]
    global_load_dword v33, v6, s[28:29]
    s_barrier
    s_branch CK_MAIN
K_NC:
    s_lshl_b32 s6, s2, 4
    s_lshl_b32 s7, s3, 2
    s_sub_u32 s7, s7, 32
    s_cmp_ge_u32 s3, 8
    s_cbranch_scc1 RT_PRO
    s_cmp_lt_u32 s2, 72
    s_cbranch_scc1 F_PRO
    s_cmp_lt_u32 s3, 6
    s_cbranch_scc1 HELPER
    s_cmp_lt_u32 s2, 80
    s_cbranch_scc1 HELPER
    s_add_u32 s7, s7, 24
    s_lshr_b32 s6, s6, 1
    s_add_u32 s6, s6, 1136
RT_PRO:
    s_add_u32 s6, s6, s7
    v_add_u32 v5, s6, v4
    v_lshlrev_b32 v6, 4, v3
    v_lshlrev_b32 v7, 3, v3
    v_mul_u32_u24 v9, 1152, v5
    v_add_u32 v8, v9, v6
    v_add_u32 v9, v9, v7
    v_mov_b32 v10, 0
    v_lshlrev_b32 v11, 2, v2
    v_add_u32 v12, 163520, v11
    ds_write_b32 v12, v10
    v_and_b32 v11, 0x7c, v11
    v_lshlrev_b32 v12, 4, v2
    s_mul_i32 s13, s7, 640
    s_add_u32 s13, s13, 147456
    s_mov_b32 m0, s13
    s_waitcnt lgkmcnt(0)
    s_load_dword s12, s[50:51], 0
    global_load_lds_dwordx4 v12, s[36:37]
    global_load_lds_dword v11, s[36:37] offset:1024
    s_add_u32 m0, s13, 1280
    v_add_u32 v6, s13, v6
    global_load_lds_dwordx4 v12, s[44:45]
    global_load_lds_dword v11, s[44:45] offset:1024
    global_load_dwordx4 v[16:19], v8, s[16:17] offset:0
    global_load_dwordx4 v[20:23], v8, s[16:17] offset:256
    global_load_dwordx4 v[24:27], v8, s[16:17] offset:512
    global_load_dwordx4 v[28:31], v8, s[16:17] offset:768
    global_load_dwordx2 v[32:33], v9, s[16:17] offset:1024
    s_barrier
    s_branch RT_MAIN
F_PRO:
    s_mul_i32 s6, s4, 9
    s_add_u32 s6, s6, s5
    v_lshrrev_b32 v6, 3, v2
    v_and_b32 v7, 2, v6
    v_mad_u32_u24 v7, v7, 3, v6
    v_mul_u32_u24 v5, 9216, v7
    v_and_b32 v7, 6, v6
    v_xor_b32 v7, v7, v2
    v_and_b32 v7, 7, v7
    v_lshl_add_u32 v5, v7, 4, v5
    s_and_b32 s8, s3, 1
    s_lshr_b32 s9, s3, 1
    s_lshl_b32 s9, s9, 3
    s_add_u32 s8, s8, s9
    s_mul_i32 s14, s8, 18432
    s_lshl_b32 s8, s6, 7
    s_add_u32 s14, s14, s8
    s_lshl_b32 s15, s3, 10
    s_mov_b32 s54, 5308416
    s_mov_b32 s55, 0x20000
    s_mov_b32 s58, 5308416
    s_mov_b32 s59, 0x20000
    s_waitcnt lgkmcnt(0)
    s_mov_b64 s[52:53], s[38:39]
    s_mov_b64 s[56:57], s[40:41]
    s_barrier
    s_branch F_MAIN
HELPER:
    v_lshrrev_b32 v6, 3, v2
    v_and_b32 v7, 2, v6
    v_mad_u32_u24 v7, v7, 3, v6
    v_mul_u32_u24 v5, 1152, v7
    v_and_b32 v7, 6, v6
    v_xor_b32 v7, v7, v2
    v_and_b32 v7, 7, v7
    v_lshl_add_u32 v5, v7, 4, v5
    s_lshl_b32 s8, s5, 1
    s_sub_u32 s8, s8, 20
    s_cmp_lt_u32 s2, 80
    s_cselect_b32 s8, 8, s8
    s_cselect_b32 s70, 8, 6
    s_cselect_b32 s69, 2, 4
    s_cselect_b32 s67, 1, 0
    s_cselect_b32 s71, 1, 2
    s_mul_i32 s71, s71, 72
    s_lshl_b32 s8, s8, 7
    s_mul_i32 s14, s4, 663552
    s_add_u32 s14, s14, s8
    s_mov_b32 s6, s3
    s_waitcnt lgkmcnt(0)
    s_mov_b32 s60, s42
    s_mov_b32 s61, s43
    s_mov_b32 s62, 5308416
    s_mov_b32 s63, 0x20000
    s_barrier
    s_branch DN_LOAD
RT_MAIN:
    s_mul_i32 s6, s2, 128
    s_add_u32 s6, s6, 4096
    s_cmp_lt_u32 s2, 80
    s_cselect_b32 s8, 15, 23
    v_min_u32 v14, s8, v2
    v_lshl_add_u32 v5, v2, 2, s6
    s_mov_b32 s8, 163520
    v_lshl_add_u32 v14, v14, 2, s8
    v_add_u32 v13, s7, v4
    v_lshl_add_u32 v13, v13, 2, s8
    s_mov_b32 s8, 0xffff
    s_mov_b32 s10, 0x00010001
    s_mov_b32 s11, 0x00010001
    v_mov_b32 v15, 0x3f803f80
    v_mov_b32 v12, 163456
    s_waitcnt lgkmcnt(0)
    s_add_u32 s12, s12, 1
    v_mov_b32 v11, s12
    ds_write_b64 v12, v[10:11]
    v_add_u32 v7, s13, v7
    s_waitcnt vmcnt(5)
    ds_read_b128 v[52:55], v6 offset:1280
    ds_read_b128 v[56:59], v6 offset:1536
    ds_read_b128 v[60:63], v6 offset:1792
    ds_read_b128 v[64:67], v6 offset:2048
    ds_read_b64 v[68:69], v7 offset:2304
    ds_read_b128 v[34:37], v6 offset:0
    ds_read_b128 v[38:41], v6 offset:256
    ds_read_b128 v[42:45], v6 offset:512
    ds_read_b128 v[46:49], v6 offset:768
    ds_read_b64 v[50:51], v7 offset:1024
    s_waitcnt lgkmcnt(5)
    v_and_b32 v84, 0xffff, v52
    v_and_b32 v52, 0xffff0000, v52
    v_and_b32 v85, 0xffff, v53
    v_and_b32 v53, 0xffff0000, v53
    v_and_b32 v86, 0xffff, v54
    v_and_b32 v54, 0xffff0000, v54
    v_and_b32 v87, 0xffff, v55
    v_and_b32 v55, 0xffff0000, v55
    v_and_b32 v88, 0xffff, v56
    v_and_b32 v56, 0xffff0000, v56
    v_and_b32 v89, 0xffff, v57
    v_and_b32 v57, 0xffff0000, v57
    v_and_b32 v90, 0xffff, v58
    v_and_b32 v58, 0xffff0000, v58
    v_and_b32 v91, 0xffff, v59
    v_and_b32 v59, 0xffff0000, v59
    v_and_b32 v92, 0xffff, v60
    v_and_b32 v60, 0xffff0000, v60
    v_and_b32 v93, 0xffff, v61
    v_and_b32 v61, 0xffff0000, v61
    v_and_b32 v94, 0xffff, v62
    v_and_b32 v62, 0xffff0000, v62
    v_and_b32 v95, 0xffff, v63
    v_and_b32 v63, 0xffff0000, v63
    v_and_b32 v96, 0xffff, v64
    v_and_b32 v64, 0xffff0000, v64
    v_and_b32 v97, 0xffff, v65
    v_and_b32 v65, 0xffff0000, v65
    v_and_b32 v98, 0xffff, v66
    v_and_b32 v66, 0xffff0000, v66
    v_and_b32 v99, 0xffff, v67
    v_and_b32 v67, 0xffff0000, v67
    v_and_b32 v100, 0xffff, v68
    v_and_b32 v68, 0xffff0000, v68
    v_and_b32 v101, 0xffff, v69
    v_and_b32 v69, 0xffff0000, v69
    s_waitcnt vmcnt(0) lgkmcnt(0)
    v_dot2_f32_bf16 v12, v16, v34, 0
    v_dot2_f32_bf16 v12, v17, v35, v12
    v_dot2_f32_bf16 v12, v18, v36, v12
    v_dot2_f32_bf16 v12, v19, v37, v12
    v_dot2_f32_bf16 v12, v20, v38, v12
    v_dot2_f32_bf16 v12, v21, v39, v12
    v_dot2_f32_bf16 v12, v22, v40, v12
    v_dot2_f32_bf16 v12, v23, v41, v12
    v_dot2_f32_bf16 v12, v24, v42, v12
    v_dot2_f32_bf16 v12, v25, v43, v12
    v_dot2_f32_bf16 v12, v26, v44, v12
    v_dot2_f32_bf16 v12, v27, v45, v12
    v_dot2_f32_bf16 v12, v28, v46, v12
    v_dot2_f32_bf16 v12, v29, v47, v12
    v_dot2_f32_bf16 v12, v30, v48, v12
    v_dot2_f32_bf16 v12, v31, v49, v12
    v_dot2_f32_bf16 v12, v32, v50, v12
    v_dot2_f32_bf16 v12, v33, v51, v12
    s_nop 0
    s_nop 1
    v_add_f32_dpp v12, v12, v12 row_ror:8 row_mask:0xf bank_mask:0xf
    s_nop 1
    v_add_f32_dpp v12, v12, v12 row_ror:4 row_mask:0xf bank_mask:0xf
    s_nop 1
    v_add_f32_dpp v12, v12, v12 row_ror:2 row_mask:0xf bank_mask:0xf
    s_nop 1
    v_add_f32_dpp v12, v12, v12 row_ror:1 row_mask:0xf bank_mask:0xf
    v_cvt_pk_bf16_f32 v12, v12, v12
    v_ashrrev_i32 v9, 31, v12
    v_or_b32 v9, 0x80000000, v9
    v_xor_b32 v12, v12, v9
    v_or_b32 v12, 1, v12
    s_mov_b64 exec, s[10:11]
    ds_write_b32 v13, v12 offset:0
    s_mov_b64 exec, -1
    s_cmp_lg_u32 s7, 0
    s_cbranch_scc1 RT_PK_X
    s_mov_b32 s9, 0
RT_PK:
    ds_read_b32 v12, v14 offset:0
    s_add_u32 s9, s9, 1
    s_waitcnt lgkmcnt(0)
    v_cmp_eq_u32 vcc, 0, v12
    s_cmp_ge_u32 s9, 0x40000
    s_cbranch_scc1 RT_PK_S
    s_cbranch_vccnz RT_PK
RT_PK_S:
    v_bfi_b32 v12, s8, v11, v12
    s_mov_b32 exec_hi, 0
    global_store_dword v5, v12, s[50:51] sc1
    s_mov_b64 exec, -1
RT_PK_X:
    s_or_b32 s9, s2, s7
    s_cmp_lg_u32 s9, 0
    s_cbranch_scc1 RT_NOT
    v_mov_b32 v8, v11
    v_mov_b32 v9, 1
    global_store_dwordx2 v10, v[8:9], s[48:49] sc1
RT_NOT:
    v_dot2_f32_bf16 v70, v16, v84, 0
    v_dot2_f32_bf16 v71, v16, v52, 0
    v_dot2_f32_bf16 v72, v17, v85, 0
    v_dot2_f32_bf16 v73, v17, v53, 0
    v_dot2_f32_bf16 v74, v18, v86, 0
    v_dot2_f32_bf16 v75, v18, v54, 0
    v_dot2_f32_bf16 v76, v19, v87, 0
    v_dot2_f32_bf16 v77, v19, v55, 0
    v_dot2_f32_bf16 v78, v20, v88, 0
    v_dot2_f32_bf16 v79, v20, v56, 0
    v_dot2_f32_bf16 v80, v21, v89, 0
    v_dot2_f32_bf16 v81, v21, v57, 0
    s_nop 0
    v_cvt_pk_bf16_f32 v70, v70, v71
    v_cvt_pk_bf16_f32 v72, v72, v73
    v_cvt_pk_bf16_f32 v74, v74, v75
    v_cvt_pk_bf16_f32 v76, v76, v77
    v_cvt_pk_bf16_f32 v78, v78, v79
    v_cvt_pk_bf16_f32 v80, v80, v81
    v_dot2_f32_bf16 v12, v70, v15, 0
    v_dot2_f32_bf16 v12, v72, v15, v12
    v_dot2_f32_bf16 v12, v74, v15, v12
    v_dot2_f32_bf16 v12, v76, v15, v12
    v_dot2_f32_bf16 v12, v78, v15, v12
    v_dot2_f32_bf16 v12, v80, v15, v12
    v_dot2_f32_bf16 v70, v22, v90, 0
    v_dot2_f32_bf16 v71, v22, v58, 0
    v_dot2_f32_bf16 v72, v23, v91, 0
    v_dot2_f32_bf16 v73, v23, v59, 0
    v_dot2_f32_bf16 v74, v24, v92, 0
    v_dot2_f32_bf16 v75, v24, v60, 0
    v_dot2_f32_bf16 v76, v25, v93, 0
    v_dot2_f32_bf16 v77, v25, v61, 0
    v_dot2_f32_bf16 v78, v26, v94, 0
    v_dot2_f32_bf16 v79, v26, v62, 0
    v_dot2_f32_bf16 v80, v27, v95, 0
    v_dot2_f32_bf16 v81, v27, v63, 0
    s_nop 0
    v_cvt_pk_bf16_f32 v70, v70, v71
    v_cvt_pk_bf16_f32 v72, v72, v73
    v_cvt_pk_bf16_f32 v74, v74, v75
    v_cvt_pk_bf16_f32 v76, v76, v77
    v_cvt_pk_bf16_f32 v78, v78, v79
    v_cvt_pk_bf16_f32 v80, v80, v81
    v_dot2_f32_bf16 v12, v70, v15, v12
    v_dot2_f32_bf16 v12, v72, v15, v12
    v_dot2_f32_bf16 v12, v74, v15, v12
    v_dot2_f32_bf16 v12, v76, v15, v12
    v_dot2_f32_bf16 v12, v78, v15, v12
    v_dot2_f32_bf16 v12, v80, v15, v12
    v_dot2_f32_bf16 v70, v28, v96, 0
    v_dot2_f32_bf16 v71, v28, v64, 0
    v_dot2_f32_bf16 v72, v29, v97, 0
    v_dot2_f32_bf16 v73, v29, v65, 0
    v_dot2_f32_bf16 v74, v30, v98, 0
    v_dot2_f32_bf16 v75, v30, v66, 0
    v_dot2_f32_bf16 v76, v31, v99, 0
    v_dot2_f32_bf16 v77, v31, v67, 0
    v_dot2_f32_bf16 v78, v32, v100, 0
    v_dot2_f32_bf16 v79, v32, v68, 0
    v_dot2_f32_bf16 v80, v33, v101, 0
    v_dot2_f32_bf16 v81, v33, v69, 0
    s_nop 0
    v_cvt_pk_bf16_f32 v70, v70, v71
    v_cvt_pk_bf16_f32 v72, v72, v73
    v_cvt_pk_bf16_f32 v74, v74, v75
    v_cvt_pk_bf16_f32 v76, v76, v77
    v_cvt_pk_bf16_f32 v78, v78, v79
    v_cvt_pk_bf16_f32 v80, v80, v81
    v_dot2_f32_bf16 v12, v70, v15, v12
    v_dot2_f32_bf16 v12, v72, v15, v12
    v_dot2_f32_bf16 v12, v74, v15, v12
    v_dot2_f32_bf16 v12, v76, v15, v12
    v_dot2_f32_bf16 v12, v78, v15, v12
    v_dot2_f32_bf16 v12, v80, v15, v12
    v_add_u32 v5, 16384, v5
    s_nop 1
    v_add_f32_dpp v12, v12, v12 row_ror:8 row_mask:0xf bank_mask:0xf
    s_nop 1
    v_add_f32_dpp v12, v12, v12 row_ror:4 row_mask:0xf bank_mask:0xf
    s_nop 1
    v_add_f32_dpp v12, v12, v12 row_ror:2 row_mask:0xf bank_mask:0xf
    s_nop 1
    v_add_f32_dpp v12, v12, v12 row_ror:1 row_mask:0xf bank_mask:0xf
    v_cvt_pk_bf16_f32 v12, v12, v12
    v_and_b32 v12, 0xffff0000, v12
    v_mul_f32 v9, 0xbfb8aa3b, v12
    v_exp_f32 v9, v9
    s_nop 0
    v_add_f32 v9, 1.0, v9
    v_rcp_f32 v9, v9
    s_nop 0
    v_cvt_pk_bf16_f32 v12, v9, v9
    v_or_b32 v12, 1, v12
    s_mov_b64 exec, s[10:11]
    ds_write_b32 v13, v12 offset:128
    s_mov_b64 exec, -1
    s_cmp_lg_u32 s7, 0
    s_cbranch_scc1 RT_PG_X
    s_mov_b32 s9, 0
RT_PG:
    ds_read_b32 v12, v14 offset:128
    s_add_u32 s9, s9, 1
    s_waitcnt lgkmcnt(0)
    v_cmp_eq_u32 vcc, 0, v12
    s_cmp_ge_u32 s9, 0x40000
    s_cbranch_scc1 RT_PG_S
    s_cbranch_vccnz RT_PG
RT_PG_S:
    v_bfi_b32 v12, s8, v11, v12
    s_mov_b32 exec_hi, 0
    global_store_dword v5, v12, s[50:51] sc1
    s_mov_b64 exec, -1
RT_PG_X:
    s_barrier
RT_TAIL:
    s_cmp_ge_u32 s2, 80
    s_cbranch_scc1 DN_JOIN
    s_cmp_lt_u32 s2, 72
    s_cbranch_scc1 RT_CTL
    s_barrier
    s_branch DN_JOIN
RT_CTL:
    s_cmp_lg_u32 s3, 8
    s_cbranch_scc1 W_END
    v_mov_b32 v14, v11
    s_mul_i32 s8, s4, 9
    s_add_u32 s8, s8, s5
    s_lshl_b32 s8, s8, 12
    s_add_u32 s8, s8, 57344
    v_lshl_add_u32 v23, v3, 7, s8
    global_load_dword v24, v23, s[50:51] sc1
    v_mov_b32 v21, 163456
    v_mov_b32 v22, 16
    s_mov_b32 s64, s16
    s_mov_b32 s65, s17
    s_mov_b32 s66, 2359296
    s_mov_b32 s67, 0x20000
    v_lshlrev_b32 v19, 4, v2
    v_lshlrev_b32 v20, 2, v2
    s_lshl_b32 s13, s4, 10
    s_add_u32 s13, s13, 40960
    s_add_u32 s7, s13, 1024
    s_sleep 16
RT_SC:
    s_load_dwordx16 s[16:31], s[50:51], s13
    s_add_u32 s13, s13, 64
    s_waitcnt lgkmcnt(0)
    s_xor_b32 s8, s17, s12
    s_xor_b32 s9, s19, s12
    s_or_b32 s8, s8, s9
    s_xor_b32 s9, s21, s12
    s_or_b32 s8, s8, s9
    s_xor_b32 s9, s23, s12
    s_or_b32 s8, s8, s9
    s_xor_b32 s9, s25, s12
    s_or_b32 s8, s8, s9
    s_xor_b32 s9, s27, s12
    s_or_b32 s8, s8, s9
    s_xor_b32 s9, s29, s12
    s_or_b32 s8, s8, s9
    s_xor_b32 s9, s31, s12
    s_or_b32 s8, s8, s9
    s_cbranch_scc0 RT_SCOK
    s_sleep 2
    s_cmp_lt_u32 s13, s7
    s_cbranch_scc1 RT_SC
    v_and_b32 v6, 7, v2
    s_lshl_b32 s9, s4, 8
    v_lshl_add_u32 v6, v6, 3, s9
    v_and_b32 v7, 7, v2
    s_lshl_b32 s9, s4, 10
    s_add_u32 s9, s9, 48896
    v_lshl_add_u32 v7, v7, 7, s9
    s_mov_b32 s12, 0
SP_C:
    s_add_u32 s12, s12, 1
    s_and_b32 s9, s12, 7
    s_cselect_b64 s[14:15], 0, -1
    v_cndmask_b32 v10, v6, v7, s[14:15]
    global_load_dwordx2 v[8:9], v10, s[50:51] offset:256 sc1
    s_waitcnt vmcnt(0)
SPC_C:
    v_cmp_ne_u32 vcc, v9, v14
    s_cmp_ge_u32 s12, 16384
    s_cbranch_scc1 SPX_C
    s_cbranch_vccz SPX_C
    s_mov_b64 exec, vcc
    s_sleep 2
    s_branch SP_C
SPX_C:
    s_mov_b64 exec, -1
    v_readlane_b32 s16, v8, 0
    v_readlane_b32 s18, v8, 1
    v_readlane_b32 s20, v8, 2
    v_readlane_b32 s22, v8, 3
    v_readlane_b32 s24, v8, 4
    v_readlane_b32 s26, v8, 5
    v_readlane_b32 s28, v8, 6
    v_readlane_b32 s30, v8, 7
RT_SCOK:
    s_mov_b32 m0, 147456
    s_andn2_b32 s76, 0x7ff, s16
    s_mul_i32 s76, s76, 1152
    s_andn2_b32 s77, 0x7ff, s18
    s_mul_i32 s77, s77, 1152
    s_andn2_b32 s78, 0x7ff, s20
    s_mul_i32 s78, s78, 1152
    s_andn2_b32 s79, 0x7ff, s22
    s_mul_i32 s79, s79, 1152
    s_andn2_b32 s80, 0x7ff, s24
    s_mul_i32 s80, s80, 1152
    s_andn2_b32 s81, 0x7ff, s26
    s_mul_i32 s81, s81, 1152
    s_andn2_b32 s82, 0x7ff, s28
    s_mul_i32 s82, s82, 1152
    s_andn2_b32 s83, 0x7ff, s30
    s_mul_i32 s83, s83, 1152
    buffer_load_dwordx4 v19, s[64:67], s76 offen lds
    buffer_load_dword v20, s[64:67], s76 offen offset:1024 lds
    s_add_u32 m0, m0, 1344
    s_nop 0
    buffer_load_dwordx4 v19, s[64:67], s77 offen lds
    buffer_load_dword v20, s[64:67], s77 offen offset:1024 lds
    s_add_u32 m0, m0, 1344
    s_nop 0
    buffer_load_dwordx4 v19, s[64:67], s78 offen lds
    buffer_load_dword v20, s[64:67], s78 offen offset:1024 lds
    s_add_u32 m0, m0, 1344
    s_nop 0
    buffer_load_dwordx4 v19, s[64:67], s79 offen lds
    buffer_load_dword v20, s[64:67], s79 offen offset:1024 lds
    s_add_u32 m0, m0, 1344
    s_nop 0
    buffer_load_dwordx4 v19, s[64:67], s80 offen lds
    buffer_load_dword v20, s[64:67], s80 offen offset:1024 lds
    s_add_u32 m0, m0, 1344
    s_nop 0
    buffer_load_dwordx4 v19, s[64:67], s81 offen lds
    buffer_load_dword v20, s[64:67], s81 offen offset:1024 lds
    s_add_u32 m0, m0, 1344
    s_nop 0
    buffer_load_dwordx4 v19, s[64:67], s82 offen lds
    buffer_load_dword v20, s[64:67], s82 offen offset:1024 lds
    s_add_u32 m0, m0, 1344
    s_nop 0
    buffer_load_dwordx4 v19, s[64:67], s83 offen lds
    buffer_load_dword v20, s[64:67], s83 offen offset:1024 lds
    s_add_u32 m0, m0, 1344
    s_nop 0
    s_waitcnt vmcnt(0)
    s_barrier
    s_endpgm
DN_LOAD:
    s_lshr_b32 s8, s6, 3
    s_lshl_b32 s8, s8, s67
    s_and_b32 s9, s6, 7
    s_lshl_b32 s12, s8, 3
    s_add_u32 s12, s12, s9
    s_lshl_b32 m0, s12, 10
    s_mul_i32 s9, s9, 9216
    s_bitcmp1_b32 s6, 0
    s_cselect_b32 s12, 6912, 0
    s_sub_u32 s9, s9, s12
    s_bitcmp1_b32 s8, 0
    s_cselect_b32 s12, 36736, 0
    s_mul_i32 s8, s8, 36864
    s_sub_u32 s8, s8, s12
    s_add_u32 s8, s8, s9
    s_add_u32 s8, s8, s14
    buffer_load_dwordx4 v5, s[60:63], s8 offen  lds
    s_add_u32 s6, s6, s70
    s_waitcnt vmcnt(0)
    s_mov_b32 s13, 0
DN_L1:
    s_lshr_b32 s8, s6, 3
    s_lshl_b32 s8, s8, s67
    s_and_b32 s9, s6, 7
    s_lshl_b32 s12, s8, 3
    s_add_u32 s12, s12, s9
    s_lshl_b32 m0, s12, 10
    s_mul_i32 s9, s9, 9216
    s_bitcmp1_b32 s6, 0
    s_cselect_b32 s12, 6912, 0
    s_sub_u32 s9, s9, s12
    s_bitcmp1_b32 s8, 0
    s_cselect_b32 s12, 36736, 0
    s_mul_i32 s8, s8, 36864
    s_sub_u32 s8, s8, s12
    s_add_u32 s8, s8, s9
    s_add_u32 s8, s8, s14
    buffer_load_dwordx4 v5, s[60:63], s8 offen  lds
    s_add_u32 s6, s6, s70
    s_add_u32 s13, s13, 1
    s_cmp_lt_u32 s13, s69
    s_cbranch_scc1 DN_L1
    s_cmp_lt_u32 s2, 80
    s_cbranch_scc1 SEL_MAIN
    s_barrier
DN_L2:
    s_cmp_ge_u32 s6, s71
    s_cbranch_scc1 DN_LX
    s_waitcnt vmcnt(5)
    s_lshr_b32 s8, s6, 3
    s_lshl_b32 s8, s8, s67
    s_and_b32 s9, s6, 7
    s_lshl_b32 s12, s8, 3
    s_add_u32 s12, s12, s9
    s_lshl_b32 m0, s12, 10
    s_mul_i32 s9, s9, 9216
    s_bitcmp1_b32 s6, 0
    s_cselect_b32 s12, 6912, 0
    s_sub_u32 s9, s9, s12
    s_bitcmp1_b32 s8, 0
    s_cselect_b32 s12, 36736, 0
    s_mul_i32 s8, s8, 36864
    s_sub_u32 s8, s8, s12
    s_add_u32 s8, s8, s9
    s_add_u32 s8, s8, s14
    buffer_load_dwordx4 v5, s[60:63], s8 offen  lds
    s_add_u32 s6, s6, s70
    s_branch DN_L2
DN_LX:
    v_mov_b32 v21, 163456
    v_mov_b32 v22, 1
    s_cmp_lt_u32 s2, 80
    s_cbranch_scc1 DN_LS
    s_waitcnt vmcnt(5)
    s_branch DN_LP
DN_LS:
    s_waitcnt vmcnt(2)
DN_LP:
    s_mov_b64 exec, 1
    ds_add_u32 v21, v22 offset:160
    s_mov_b64 exec, -1
DN_JOIN:
    v_mov_b32 v21, 163456
    ds_read_b32 v14, v21 offset:4
    v_and_b32 v18, 1, v4
    v_bfe_u32 v6, v2, 2, 2
    v_lshl_add_u32 v18, v18, 2, v6
    v_lshrrev_b32 v19, 1, v18
    v_lshlrev_b32 v18, 7, v18
    v_and_b32 v7, 3, v2
    v_lshl_add_u32 v18, v7, 3, v18
    v_lshrrev_b32 v6, 1, v4
    v_lshl_add_u32 v18, v6, 11, v18
    s_and_b32 s9, s3, 3
    v_xor_b32 v19, s9, v19
    v_lshl_add_u32 v18, v19, 5, v18
    s_lshr_b32 s8, s3, 2
    s_lshl_b32 s8, s8, 13
    v_add_u32 v8, s8, v18
    v_add_u32 v9, 49152, v8
    v_add_u32 v10, 98304, v8
    v_lshrrev_b32 v11, 1, v3
    v_mul_u32_u24 v11, 1344, v11
    v_lshl_add_u32 v11, v4, 5, v11
    v_and_b32 v22, 1, v2
    v_lshl_add_u32 v11, v22, 4, v11
    v_add_u32 v11, 147456, v11
    v_mul_u32_u24 v22, 0xaaaa, v22
    v_add_u32 v22, 0x4444, v22
    v_mov_b32 v132, 0
    v_mov_b32 v133, 0
    v_mov_b32 v134, 0
    v_mov_b32 v135, 0
    v_lshrrev_b32 v12, 2, v3
    v_mul_u32_u24 v17, 2688, v12
    v_mul_u32_u24 v12, 1152, v12
    v_lshl_add_u32 v12, v7, 4, v12
    v_lshl_add_u32 v12, v6, 6, v12
    s_lshl_b32 s8, s5, 3
    s_sub_u32 s8, s8, 80
    s_cmp_lt_u32 s2, 80
    s_cselect_b32 s8, 32, s8
    s_cselect_b32 s13, 4, 8
    s_cselect_b32 s15, 8, 6
    s_add_u32 s8, s8, s3
    s_mul_i32 s8, s8, 4608
    s_lshl_b32 s9, s4, 7
    s_add_u32 s8, s8, s9
    s_add_u32 s8, s8, 352256
    v_add_u32 v12, s8, v12
    s_sub_u32 s9, s3, 3
    s_mul_i32 s8, s4, 9
    s_add_u32 s8, s8, s9
    s_lshl_b32 s8, s8, 12
    s_add_u32 s8, s8, 57344
    v_lshl_add_u32 v16, v2, 5, s8
    v_lshl_add_u32 v17, v4, 5, v17
    v_lshl_add_u32 v17, v7, 3, v17
    s_lshl_b32 s9, s9, 7
    s_add_u32 s9, s9, 147456
    v_add_u32 v17, s9, v17
    s_mov_b32 s10, 0xffff
    s_mov_b32 s11, 0xffff
    s_movk_i32 s78, 0xff
    s_mov_b32 s76, 0x07060302
    s_cmp_ge_u32 s3, s13
    s_cbranch_scc1 DN_NOF
    s_mov_b32 s9, 0
SPN1:
    ds_read_b32 v23, v21 offset:160
    s_add_u32 s9, s9, 1
    s_waitcnt lgkmcnt(0)
    v_cmp_ne_u32 vcc, s15, v23
    s_cmp_ge_u32 s9, 0x40000
    s_cbranch_scc1 SPX1
    s_cbranch_vccz SPX1
    s_sleep 2
    s_branch SPN1
SPX1:
    ds_read_b64_tr_b16 v[24:25], v8 offset:0
    ds_read_b64_tr_b16 v[26:27], v8 offset:1024
    ds_read_b64_tr_b16 v[28:29], v8 offset:4096
    ds_read_b64_tr_b16 v[30:31], v8 offset:5120
    ds_read_b64_tr_b16 v[32:33], v8 offset:16384
    ds_read_b64_tr_b16 v[34:35], v8 offset:17408
    ds_read_b64_tr_b16 v[36:37], v8 offset:20480
    ds_read_b64_tr_b16 v[38:39], v8 offset:21504
    ds_read_b64_tr_b16 v[40:41], v8 offset:32768
    ds_read_b64_tr_b16 v[42:43], v8 offset:33792
    ds_read_b64_tr_b16 v[44:45], v8 offset:36864
    ds_read_b64_tr_b16 v[46:47], v8 offset:37888
    ds_read_b64_tr_b16 v[48:49], v9 offset:0
    ds_read_b64_tr_b16 v[50:51], v9 offset:1024
    ds_read_b64_tr_b16 v[52:53], v9 offset:4096
    ds_read_b64_tr_b16 v[54:55], v9 offset:5120
    ds_read_b64_tr_b16 v[56:57], v9 offset:16384
    ds_read_b64_tr_b16 v[58:59], v9 offset:17408
    ds_read_b64_tr_b16 v[60:61], v9 offset:20480
    ds_read_b64_tr_b16 v[62:63], v9 offset:21504
    ds_read_b64_tr_b16 v[64:65], v9 offset:32768
    ds_read_b64_tr_b16 v[66:67], v9 offset:33792
    ds_read_b64_tr_b16 v[68:69], v9 offset:36864
    ds_read_b64_tr_b16 v[70:71], v9 offset:37888
    ds_read_b64_tr_b16 v[72:73], v10 offset:0
    ds_read_b64_tr_b16 v[74:75], v10 offset:1024
    ds_read_b64_tr_b16 v[76:77], v10 offset:4096
    ds_read_b64_tr_b16 v[78:79], v10 offset:5120
DN_NOF:
    s_waitcnt vmcnt(0) lgkmcnt(0)
    s_barrier
    s_cmp_ge_u32 s3, s13
    s_cbranch_scc1 DN_NOF2
    ds_read_b64_tr_b16 v[80:81], v10 offset:16384
    ds_read_b64_tr_b16 v[82:83], v10 offset:17408
    ds_read_b64_tr_b16 v[84:85], v10 offset:20480
    ds_read_b64_tr_b16 v[86:87], v10 offset:21504
    ds_read_b64_tr_b16 v[88:89], v10 offset:32768
    ds_read_b64_tr_b16 v[90:91], v10 offset:33792
    ds_read_b64_tr_b16 v[92:93], v10 offset:36864
    ds_read_b64_tr_b16 v[94:95], v10 offset:37888
DN_NOF2:
    s_cmp_lt_u32 s3, 3
    s_cbranch_scc1 DN_W
    s_mov_b32 s12, 0
DN_POLL:
    s_add_u32 s12, s12, 1
    s_and_b32 s8, s12, 15
    s_cselect_b32 s8, 0, 2048
    v_add_u32 v20, s8, v16
    global_load_dwordx4 v[96:99], v20, s[50:51] sc1
    global_load_dwordx4 v[100:103], v20, s[50:51] offset:16 sc1
    s_waitcnt vmcnt(0)
    v_xor_b32 v20, v96, v14
    v_bitop3_b32 v20, v20, v97, v14 bitop3:0xf6
    v_bitop3_b32 v20, v20, v98, v14 bitop3:0xf6
    v_bitop3_b32 v20, v20, v99, v14 bitop3:0xf6
    v_bitop3_b32 v20, v20, v100, v14 bitop3:0xf6
    v_bitop3_b32 v20, v20, v101, v14 bitop3:0xf6
    v_bitop3_b32 v20, v20, v102, v14 bitop3:0xf6
    v_bitop3_b32 v20, v20, v103, v14 bitop3:0xf6
    v_and_b32 v20, 0xffff, v20
    v_cmp_ne_u32 vcc, 0, v20
    s_cmp_ge_u32 s12, 65536
    s_cbranch_scc1 DN_GOT
    s_cbranch_vccnz DN_POLL
DN_GOT:
    v_perm_b32 v104, v98, v96, s76
    v_perm_b32 v105, v102, v100, s76
    v_perm_b32 v106, v99, v97, s76
    v_perm_b32 v107, v103, v101, s76
    ds_write_b64 v17, v[104:105]
    ds_write_b64 v17, v[106:107] offset:1344
DN_W:
    s_waitcnt lgkmcnt(0)
    s_barrier
    s_cmp_ge_u32 s3, s13
    s_cbranch_scc1 W_END
    ds_read_b128 v[96:99], v11 offset:0
    ds_read_b128 v[100:103], v11 offset:128
    ds_read_b128 v[104:107], v11 offset:256
    ds_read_b128 v[108:111], v11 offset:384
    ds_read_b128 v[112:115], v11 offset:512
    ds_read_b128 v[116:119], v11 offset:640
    ds_read_b128 v[120:123], v11 offset:768
    ds_read_b128 v[124:127], v11 offset:896
    ds_read_b128 v[128:131], v11 offset:1024
    s_waitcnt lgkmcnt(8)
    v_smfmac_f32_16x16x64_bf16 v[132:135], v[96:99], v[24:31], v22
    s_waitcnt lgkmcnt(7)
    v_smfmac_f32_16x16x64_bf16 v[132:135], v[100:103], v[32:39], v22
    s_waitcnt lgkmcnt(6)
    v_smfmac_f32_16x16x64_bf16 v[132:135], v[104:107], v[40:47], v22
    s_waitcnt lgkmcnt(5)
    v_smfmac_f32_16x16x64_bf16 v[132:135], v[108:111], v[48:55], v22
    s_waitcnt lgkmcnt(4)
    v_smfmac_f32_16x16x64_bf16 v[132:135], v[112:115], v[56:63], v22
    s_waitcnt lgkmcnt(3)
    v_smfmac_f32_16x16x64_bf16 v[132:135], v[116:119], v[64:71], v22
    s_waitcnt lgkmcnt(2)
    v_smfmac_f32_16x16x64_bf16 v[132:135], v[120:123], v[72:79], v22
    s_waitcnt lgkmcnt(1)
    v_smfmac_f32_16x16x64_bf16 v[132:135], v[124:127], v[80:87], v22
    s_waitcnt lgkmcnt(0)
    v_smfmac_f32_16x16x64_bf16 v[132:135], v[128:131], v[88:95], v22
    s_nop 7
    v_add_f32 v136, v132, v133
    v_add_f32 v137, v134, v135
    v_bfi_b32 v138, s78, v14, v136
    v_bfi_b32 v139, s78, v14, v137
    v_bfi_b32 v136, s78, v14, v136
    v_bfi_b32 v137, s78, v14, v137
    s_nop 0
    v_permlane16_swap_b32 v136, v138
    v_permlane16_swap_b32 v137, v139
    s_mov_b64 exec, s[10:11]
    global_store_dwordx4 v12, v[136:139], s[50:51] sc1
    s_cmp_lg_u32 s3, 3
    s_cbranch_scc1 DN_NOHINT
    s_lshl_b32 s8, s4, 7
    s_lshl_b32 s9, s5, 2
    s_add_u32 s8, s8, s9
    v_mov_b32 v20, s8
    global_store_dword v20, v14, s[50:51] offset:2268
    s_cmp_lg_u32 s2, 72
    s_cbranch_scc1 DN_NOHINT
    v_mov_b32 v20, 0
    global_store_dword v20, v14, s[50:51] sc1
DN_NOHINT:
    s_endpgm
F_MAIN:
    v_and_b32 v7, 7, v2
    s_add_u32 m0, s15, 0
    s_add_u32 s8, s14, 0
    buffer_load_dwordx4 v5, s[52:55], s8 offen  lds
    s_add_u32 m0, s15, 73728
    s_add_u32 s8, s14, 0
    buffer_load_dwordx4 v5, s[56:59], s8 offen  lds
    s_and_b32 s12, s3, 3
    v_and_b32 v18, 1, v4
    v_bfe_u32 v6, v2, 2, 2
    v_lshl_add_u32 v18, v18, 2, v6
    v_lshrrev_b32 v6, 1, v18
    v_xor_b32 v6, s12, v6
    v_lshlrev_b32 v18, 7, v18
    v_lshl_add_u32 v18, v6, 5, v18
    v_and_b32 v6, 3, v2
    v_lshl_add_u32 v18, v6, 3, v18
    v_lshrrev_b32 v6, 1, v4
    v_lshl_add_u32 v18, v6, 11, v18
    v_add_u32 v6, 73728, v18
    v_add_u32 v0, 40960, v18
    v_add_u32 v1, 40960, v6
    v_lshrrev_b32 v8, 1, v3
    v_mul_u32_u24 v8, 1344, v8
    v_lshl_add_u32 v8, v4, 5, v8
    v_and_b32 v9, 1, v2
    v_lshl_add_u32 v8, v9, 4, v8
    v_add_u32 v8, 147456, v8
    v_mul_u32_u24 v9, 0xaaaa, v9
    v_add_u32 v9, 0x4444, v9
    s_lshl_b32 s8, s6, 12
    s_lshl_b32 s9, s3, 9
    s_add_u32 s8, s8, s9
    s_add_u32 s8, s8, 57344
    v_lshl_add_u32 v11, v2, 3, s8
    s_mov_b32 s76, 0xffff
    v_mov_b32 v21, 163456
    v_mov_b32 v22, 1
    s_mov_b32 s10, 0xff00ff00
    s_mov_b32 s11, 0xff00ff00
    s_waitcnt vmcnt(0)
    s_add_u32 m0, s15, 8192
    s_add_u32 s8, s14, 589824
    buffer_load_dwordx4 v5, s[52:55], s8 offen  lds
    s_add_u32 m0, s15, 81920
    s_add_u32 s8, s14, 589824
    buffer_load_dwordx4 v5, s[56:59], s8 offen  lds
    s_add_u32 m0, s15, 16384
    s_add_u32 s8, s14, 1179648
    buffer_load_dwordx4 v5, s[52:55], s8 offen  lds
    v_mov_b32 v160, 0
    v_mov_b32 v161, 0
    v_mov_b32 v162, 0
    v_mov_b32 v163, 0
    v_mov_b32 v164, 0
    v_mov_b32 v165, 0
    v_mov_b32 v166, 0
    v_mov_b32 v167, 0
    s_barrier
    ds_read_b32 v14, v21 offset:4
    s_add_u32 m0, s15, 90112
    s_add_u32 s8, s14, 1179648
    buffer_load_dwordx4 v5, s[56:59], s8 offen  lds
    s_waitcnt vmcnt(3)
    s_add_u32 m0, s15, 24576
    s_add_u32 s8, s14, 1769472
    buffer_load_dwordx4 v5, s[52:55], s8 offen  lds
    s_waitcnt vmcnt(3)
    s_add_u32 m0, s15, 98304
    s_add_u32 s8, s14, 1769472
    buffer_load_dwordx4 v5, s[56:59], s8 offen  lds
    s_waitcnt vmcnt(3)
    s_add_u32 m0, s15, 32768
    s_add_u32 s8, s14, 2359296
    buffer_load_dwordx4 v5, s[52:55], s8 offen  lds
    s_waitcnt vmcnt(3)
    s_add_u32 m0, s15, 106496
    s_add_u32 s8, s14, 2359296
    buffer_load_dwordx4 v5, s[56:59], s8 offen  lds
    s_waitcnt vmcnt(3)
    s_add_u32 m0, s15, 40960
    s_add_u32 s8, s14, 2949120
    buffer_load_dwordx4 v5, s[52:55], s8 offen  lds
    s_waitcnt vmcnt(3)
    s_add_u32 m0, s15, 114688
    s_add_u32 s8, s14, 2949120
    buffer_load_dwordx4 v5, s[56:59], s8 offen  lds
    s_waitcnt vmcnt(3)
    s_add_u32 m0, s15, 49152
    s_add_u32 s8, s14, 3538944
    buffer_load_dwordx4 v5, s[52:55], s8 offen  lds
    s_waitcnt vmcnt(3)
    s_add_u32 m0, s15, 122880
    s_add_u32 s8, s14, 3538944
    buffer_load_dwordx4 v5, s[56:59], s8 offen  lds
    s_waitcnt vmcnt(3)
    s_add_u32 m0, s15, 57344
    s_add_u32 s8, s14, 4128768
    buffer_load_dwordx4 v5, s[52:55], s8 offen  lds
    s_waitcnt vmcnt(3)
    s_add_u32 m0, s15, 131072
    s_add_u32 s8, s14, 4128768
    buffer_load_dwordx4 v5, s[56:59], s8 offen  lds
    s_waitcnt vmcnt(3)
    s_add_u32 m0, s15, 65536
    s_add_u32 s8, s14, 4718592
    buffer_load_dwordx4 v5, s[52:55], s8 offen  lds
    s_waitcnt vmcnt(3)
    s_add_u32 m0, s15, 139264
    s_add_u32 s8, s14, 4718592
    buffer_load_dwordx4 v5, s[56:59], s8 offen  lds
    s_waitcnt vmcnt(4)
    s_mov_b64 exec, 1
    ds_add_u32 v21, v22 offset:160
    s_mov_b64 exec, -1
    s_cmp_ge_u32 s3, 4
    s_cbranch_scc1 F_LD
    s_mov_b32 s9, 0
SPN2:
    ds_read_b32 v23, v21 offset:160
    s_add_u32 s9, s9, 1
    s_waitcnt lgkmcnt(0)
    v_cmp_ne_u32 vcc, 8, v23
    s_cmp_ge_u32 s9, 0x40000
    s_cbranch_scc1 SPX2
    s_cbranch_vccnz SPN2
SPX2:
    ds_read_b64_tr_b16 v[24:25], v18 offset:0
    ds_read_b64_tr_b16 v[26:27], v18 offset:1024
    ds_read_b64_tr_b16 v[28:29], v18 offset:4096
    ds_read_b64_tr_b16 v[30:31], v18 offset:5120
    ds_read_b64_tr_b16 v[32:33], v6 offset:0
    ds_read_b64_tr_b16 v[34:35], v6 offset:1024
    ds_read_b64_tr_b16 v[36:37], v6 offset:4096
    ds_read_b64_tr_b16 v[38:39], v6 offset:5120
    ds_read_b64_tr_b16 v[40:41], v18 offset:8192
    ds_read_b64_tr_b16 v[42:43], v18 offset:9216
    ds_read_b64_tr_b16 v[44:45], v18 offset:12288
    ds_read_b64_tr_b16 v[46:47], v18 offset:13312
    ds_read_b64_tr_b16 v[48:49], v6 offset:8192
    ds_read_b64_tr_b16 v[50:51], v6 offset:9216
    ds_read_b64_tr_b16 v[52:53], v6 offset:12288
    ds_read_b64_tr_b16 v[54:55], v6 offset:13312
    ds_read_b64_tr_b16 v[56:57], v18 offset:16384
    ds_read_b64_tr_b16 v[58:59], v18 offset:17408
    ds_read_b64_tr_b16 v[60:61], v18 offset:20480
    ds_read_b64_tr_b16 v[62:63], v18 offset:21504
    ds_read_b64_tr_b16 v[64:65], v6 offset:16384
    ds_read_b64_tr_b16 v[66:67], v6 offset:17408
    ds_read_b64_tr_b16 v[68:69], v6 offset:20480
    ds_read_b64_tr_b16 v[70:71], v6 offset:21504
    ds_read_b64_tr_b16 v[72:73], v18 offset:24576
    ds_read_b64_tr_b16 v[74:75], v18 offset:25600
    ds_read_b64_tr_b16 v[76:77], v18 offset:28672
    ds_read_b64_tr_b16 v[78:79], v18 offset:29696
    ds_read_b64_tr_b16 v[80:81], v6 offset:24576
    ds_read_b64_tr_b16 v[82:83], v6 offset:25600
    ds_read_b64_tr_b16 v[84:85], v6 offset:28672
    ds_read_b64_tr_b16 v[86:87], v6 offset:29696
    ds_read_b64_tr_b16 v[88:89], v18 offset:32768
    ds_read_b64_tr_b16 v[90:91], v18 offset:33792
    ds_read_b64_tr_b16 v[92:93], v18 offset:36864
    ds_read_b64_tr_b16 v[94:95], v18 offset:37888
    ds_read_b64_tr_b16 v[96:97], v6 offset:32768
    ds_read_b64_tr_b16 v[98:99], v6 offset:33792
    ds_read_b64_tr_b16 v[100:101], v6 offset:36864
    ds_read_b64_tr_b16 v[102:103], v6 offset:37888
    ds_read_b64_tr_b16 v[104:105], v0 offset:0
    ds_read_b64_tr_b16 v[106:107], v0 offset:1024
    ds_read_b64_tr_b16 v[108:109], v0 offset:4096
    ds_read_b64_tr_b16 v[110:111], v0 offset:5120
    ds_read_b64_tr_b16 v[112:113], v1 offset:0
    ds_read_b64_tr_b16 v[114:115], v1 offset:1024
    ds_read_b64_tr_b16 v[116:117], v1 offset:4096
    ds_read_b64_tr_b16 v[118:119], v1 offset:5120
    ds_read_b64_tr_b16 v[120:121], v0 offset:8192
    ds_read_b64_tr_b16 v[122:123], v0 offset:9216
    ds_read_b64_tr_b16 v[124:125], v0 offset:12288
    ds_read_b64_tr_b16 v[126:127], v0 offset:13312
    ds_read_b64_tr_b16 v[128:129], v1 offset:8192
    ds_read_b64_tr_b16 v[130:131], v1 offset:9216
    ds_read_b64_tr_b16 v[132:133], v1 offset:12288
    ds_read_b64_tr_b16 v[134:135], v1 offset:13312
F_LD:
    s_waitcnt vmcnt(0)
    s_barrier
    s_cmp_ge_u32 s3, 4
    s_cbranch_scc1 W_END
    ds_read_b128 v[136:139], v8 offset:0
    ds_read_b128 v[140:143], v8 offset:128
    ds_read_b128 v[144:147], v8 offset:256
    ds_read_b128 v[148:151], v8 offset:384
    ds_read_b128 v[152:155], v8 offset:512
    ds_read_b128 v[156:159], v8 offset:640
    s_waitcnt lgkmcnt(5)
    v_smfmac_f32_16x16x64_bf16 v[160:163], v[136:139], v[24:31], v9
    v_smfmac_f32_16x16x64_bf16 v[164:167], v[136:139], v[32:39], v9
    s_waitcnt lgkmcnt(4)
    v_smfmac_f32_16x16x64_bf16 v[160:163], v[140:143], v[40:47], v9
    v_smfmac_f32_16x16x64_bf16 v[164:167], v[140:143], v[48:55], v9
    ds_read_b128 v[136:139], v8 offset:768
    ds_read_b64_tr_b16 v[24:25], v0 offset:16384
    ds_read_b64_tr_b16 v[26:27], v0 offset:17408
    ds_read_b64_tr_b16 v[28:29], v0 offset:20480
    ds_read_b64_tr_b16 v[30:31], v0 offset:21504
    ds_read_b64_tr_b16 v[32:33], v1 offset:16384
    ds_read_b64_tr_b16 v[34:35], v1 offset:17408
    ds_read_b64_tr_b16 v[36:37], v1 offset:20480
    ds_read_b64_tr_b16 v[38:39], v1 offset:21504
    s_waitcnt lgkmcnt(12)
    v_smfmac_f32_16x16x64_bf16 v[160:163], v[144:147], v[56:63], v9
    v_smfmac_f32_16x16x64_bf16 v[164:167], v[144:147], v[64:71], v9
    ds_read_b128 v[140:143], v8 offset:896
    ds_read_b64_tr_b16 v[40:41], v0 offset:24576
    ds_read_b64_tr_b16 v[42:43], v0 offset:25600
    ds_read_b64_tr_b16 v[44:45], v0 offset:28672
    ds_read_b64_tr_b16 v[46:47], v0 offset:29696
    ds_read_b64_tr_b16 v[48:49], v1 offset:24576
    ds_read_b64_tr_b16 v[50:51], v1 offset:25600
    ds_read_b64_tr_b16 v[52:53], v1 offset:28672
    ds_read_b64_tr_b16 v[54:55], v1 offset:29696
    s_waitcnt lgkmcnt(15)
    v_smfmac_f32_16x16x64_bf16 v[160:163], v[148:151], v[72:79], v9
    v_smfmac_f32_16x16x64_bf16 v[164:167], v[148:151], v[80:87], v9
    ds_read_b128 v[144:147], v8 offset:1024
    s_waitcnt lgkmcnt(15)
    v_smfmac_f32_16x16x64_bf16 v[160:163], v[152:155], v[88:95], v9
    v_smfmac_f32_16x16x64_bf16 v[164:167], v[152:155], v[96:103], v9
    s_waitcnt lgkmcnt(15)
    v_smfmac_f32_16x16x64_bf16 v[160:163], v[156:159], v[104:111], v9
    v_smfmac_f32_16x16x64_bf16 v[164:167], v[156:159], v[112:119], v9
    s_waitcnt lgkmcnt(15)
    v_smfmac_f32_16x16x64_bf16 v[160:163], v[136:139], v[120:127], v9
    v_smfmac_f32_16x16x64_bf16 v[164:167], v[136:139], v[128:135], v9
    s_waitcnt lgkmcnt(9)
    v_smfmac_f32_16x16x64_bf16 v[160:163], v[140:143], v[24:31], v9
    v_smfmac_f32_16x16x64_bf16 v[164:167], v[140:143], v[32:39], v9
    s_waitcnt lgkmcnt(0)
    v_smfmac_f32_16x16x64_bf16 v[160:163], v[144:147], v[40:47], v9
    v_smfmac_f32_16x16x64_bf16 v[164:167], v[144:147], v[48:55], v9
    s_nop 6
    v_add_f32 v24, v160, v161
    v_add_f32 v25, v162, v163
    v_add_f32 v26, v164, v165
    v_add_f32 v27, v166, v167
    v_cvt_pk_bf16_f32 v24, 0, v24
    v_cvt_pk_bf16_f32 v25, 0, v25
    v_cvt_pk_bf16_f32 v26, 0, v26
    v_cvt_pk_bf16_f32 v27, 0, v27
    v_mul_f32 v28, 0xbfb8aa3b, v24
    v_mul_f32 v29, 0xbfb8aa3b, v25
    v_exp_f32 v28, v28
    v_exp_f32 v29, v29
    v_add_f32 v28, 1.0, v28
    v_add_f32 v29, 1.0, v29
    v_rcp_f32 v28, v28
    v_rcp_f32 v29, v29
    v_mul_f32 v24, v24, v28
    v_mul_f32 v25, v25, v29
    v_cvt_pk_bf16_f32 v24, 0, v24
    v_cvt_pk_bf16_f32 v25, 0, v25
    v_mul_f32 v24, v24, v26
    v_mul_f32 v25, v25, v27
    v_cvt_pk_bf16_f32 v24, 0, v24
    v_cvt_pk_bf16_f32 v25, 0, v25
    v_bfi_b32 v24, s76, v14, v24
    v_bfi_b32 v25, s76, v14, v25
    global_store_dwordx2 v11, v[24:25], s[50:51]
    global_store_dwordx2 v11, v[24:25], s[50:51] offset:2048 sc1
    s_endpgm
SEL_MAIN:
    v_min_u32 v19, 8, v2
    v_lshlrev_b32 v19, 7, v19
    v_lshlrev_b32 v20, 2, v2
    v_lshrrev_b32 v24, 2, v2
    v_mul_u32_u24 v24, 128, v24
    v_and_b32 v37, 3, v2
    v_lshl_add_u32 v24, v37, 4, v24
    v_lshrrev_b32 v36, 1, v2
    v_mul_u32_u24 v36, 128, v36
    v_and_b32 v37, 1, v2
    v_lshl_add_u32 v36, v37, 4, v36
    v_add_u32 v36, 10304, v36
    s_mul_i32 s8, s3, 2048
    v_add_u32 v24, s8, v24
    s_cmp_eq_u32 s3, 7
    s_cselect_b64 vcc, -1, 0
    v_cndmask_b32 v24, v24, v36, vcc
    v_add_u32 v24, 4096, v24
    s_lshl_b32 s8, s3, 8
    s_sub_u32 s8, 0xfff, s8
    v_sub_u32 v32, s8, v20
    v_subrev_u32 v33, 1, v32
    v_subrev_u32 v34, 2, v32
    v_subrev_u32 v35, 3, v32
    v_mov_b32 v21, 163456
    s_lshl_b32 s8, s3, 5
    s_add_u32 s8, s8, 163200
    v_lshl_add_u32 v25, v4, 3, s8
    s_mov_b32 s74, 0x01010101
    s_mov_b32 s75, 0x01010101
    s_lshl_b32 s9, s4, 10
    s_add_u32 s9, s9, 40960
    v_lshl_add_u32 v53, v2, 4, s9
    global_load_dword v54, v53, s[50:51] sc1
    v_lshrrev_b32 v52, 3, v2
    v_lshl_add_u32 v52, v52, 6, s9
    v_and_b32 v27, 28, v20
    v_add_u32 v27, s8, v27
    v_add_u32 v26, 163200, v20
    s_mov_b32 s76, 0xffff
    s_mov_b32 s10, 0x00010001
    s_mov_b32 s11, 0x00010001
    s_barrier
    ds_read_b32 v14, v21 offset:4
    s_mov_b32 s7, 0
    s_waitcnt lgkmcnt(0)
    s_waitcnt vmcnt(0)
F_POLL:
    global_load_dwordx4 v[28:31], v24, s[50:51] sc1
    s_add_u32 s7, s7, 1
    s_waitcnt vmcnt(0)
    v_xor_b32 v36, v28, v14
    v_bitop3_b32 v36, v36, v29, v14 bitop3:0xf6
    v_bitop3_b32 v36, v36, v30, v14 bitop3:0xf6
    v_bitop3_b32 v36, v36, v31, v14 bitop3:0xf6
    v_and_b32 v36, 0xffff, v36
    v_cmp_ne_u32 vcc, 0, v36
    s_cmp_ge_u32 s7, 16384
    s_cbranch_scc1 F_GOT
    s_cbranch_vccz F_GOT
    s_mov_b64 exec, vcc
    s_sleep 4
    s_branch F_POLL
F_GOT:
    s_mov_b64 exec, -1
    v_bfi_b32 v28, s76, v32, v28
    v_bfi_b32 v29, s76, v33, v29
    v_bfi_b32 v30, s76, v34, v30
    v_bfi_b32 v31, s76, v35, v31
    v_max_u32 v36, v28, v29
    v_min_u32 v37, v28, v29
    v_max3_u32 v40, v36, v30, v31
    v_med3_u32 v41, v36, v30, v31
    v_med3_u32 v42, v37, v30, v31
    v_max_u32 v41, v41, v37
    v_min_u32 v42, v42, v36
    v_max_u32_dpp v44, v40, v40 row_ror:8 row_mask:0xf bank_mask:0xf
    s_nop 1
    v_max_u32_dpp v44, v44, v44 row_ror:4 row_mask:0xf bank_mask:0xf
    s_nop 1
    v_max_u32_dpp v44, v44, v44 row_ror:2 row_mask:0xf bank_mask:0xf
    s_nop 1
    v_max_u32_dpp v44, v44, v44 row_ror:1 row_mask:0xf bank_mask:0xf
    v_cmp_eq_u32 vcc, v40, v44
    s_nop 1
    v_cndmask_b32 v40, v40, v41, vcc
    v_cndmask_b32 v41, v41, v42, vcc
    s_nop 0
    v_max_u32_dpp v45, v40, v40 row_ror:8 row_mask:0xf bank_mask:0xf
    s_nop 1
    v_max_u32_dpp v45, v45, v45 row_ror:4 row_mask:0xf bank_mask:0xf
    s_nop 1
    v_max_u32_dpp v45, v45, v45 row_ror:2 row_mask:0xf bank_mask:0xf
    s_nop 1
    v_max_u32_dpp v45, v45, v45 row_ror:1 row_mask:0xf bank_mask:0xf
    v_cmp_eq_u32 vcc, v40, v45
    s_nop 1
    v_cndmask_b32 v40, v40, v41, vcc
    s_nop 1
    v_max_u32_dpp v46, v40, v40 row_ror:8 row_mask:0xf bank_mask:0xf
    s_nop 1
    v_max_u32_dpp v46, v46, v46 row_ror:4 row_mask:0xf bank_mask:0xf
    s_nop 1
    v_max_u32_dpp v46, v46, v46 row_ror:2 row_mask:0xf bank_mask:0xf
    s_nop 1
    v_max_u32_dpp v46, v46, v46 row_ror:1 row_mask:0xf bank_mask:0xf
    s_mov_b64 exec, s[10:11]
    ds_write_b64 v25, v[44:45]
    ds_max_u32 v21, v46
    s_mov_b64 exec, -1
    v_readlane_b32 s77, v44, 0
    v_readlane_b32 s78, v45, 0
    v_readlane_b32 s79, v44, 16
    v_readlane_b32 s80, v45, 16
    v_readlane_b32 s81, v44, 32
    v_readlane_b32 s82, v45, 32
    v_readlane_b32 s83, v44, 48
    v_readlane_b32 s100, v45, 48
    ds_read_b32 v48, v27
    v_mov_b32 v49, v14
    s_lshl_b32 s72, s4, 8
    s_lshl_b32 s73, s4, 10
    s_add_u32 s73, s73, 49152
    s_waitcnt lgkmcnt(0)
    s_barrier
    ds_read_b32 v36, v26
    ds_read_b32 v37, v21
    v_not_b32 v50, v48
    v_and_b32 v50, 0x7ff, v50
    v_mul_u32_u24 v50, 1152, v50
    s_waitcnt lgkmcnt(0)
    v_cmp_gt_u32 vcc, v36, v37
    v_cmp_lt_u32 s[18:19], s77, v36
    v_cmp_lt_u32 s[20:21], s78, v36
    v_cmp_lt_u32 s[22:23], s79, v36
    v_cmp_lt_u32 s[24:25], s80, v36
    v_cmp_lt_u32 s[26:27], s81, v36
    v_cmp_lt_u32 s[28:29], s82, v36
    v_cmp_lt_u32 s[30:31], s83, v36
    v_cmp_lt_u32 s[34:35], s100, v36
    s_bcnt1_i32_b64 s8, vcc
    s_cmp_lt_u32 s8, 8
    s_cbranch_scc1 F_SLOW
    s_bcnt1_i32_b64 s18, s[18:19]
    s_lshl_b64 exec, s[74:75], 0
    v_mov_b32 v37, s18
    s_bcnt1_i32_b64 s20, s[20:21]
    s_lshl_b64 exec, s[74:75], 1
    v_mov_b32 v37, s20
    s_bcnt1_i32_b64 s22, s[22:23]
    s_lshl_b64 exec, s[74:75], 2
    v_mov_b32 v37, s22
    s_bcnt1_i32_b64 s24, s[24:25]
    s_lshl_b64 exec, s[74:75], 3
    v_mov_b32 v37, s24
    s_bcnt1_i32_b64 s26, s[26:27]
    s_lshl_b64 exec, s[74:75], 4
    v_mov_b32 v37, s26
    s_bcnt1_i32_b64 s28, s[28:29]
    s_lshl_b64 exec, s[74:75], 5
    v_mov_b32 v37, s28
    s_bcnt1_i32_b64 s30, s[30:31]
    s_lshl_b64 exec, s[74:75], 6
    v_mov_b32 v37, s30
    s_bcnt1_i32_b64 s34, s[34:35]
    s_lshl_b64 exec, s[74:75], 7
    v_mov_b32 v37, s34
    s_mov_b64 exec, -1
    v_cmp_gt_u32 vcc, 8, v37
    v_lshl_add_u32 v52, v37, 3, v52
    v_lshl_add_u32 v55, v37, 7, s73
    v_lshl_add_u32 v37, v37, 3, s72
    s_and_b64 exec, vcc, exec
    s_cbranch_execz F_REST
    global_store_dwordx2 v52, v[48:49], s[50:51]
    global_store_dwordx2 v52, v[48:49], s[50:51] offset:512
    s_and_b64 exec, vcc, 0xff
    global_store_dwordx2 v37, v[48:49], s[50:51] offset:256
    global_load_dword v51, v50, s[16:17] offset:0
    global_load_dword v51, v50, s[16:17] offset:128
    global_load_dword v51, v50, s[16:17] offset:256
    global_load_dword v51, v50, s[16:17] offset:384
    global_load_dword v51, v50, s[16:17] offset:512
    global_load_dword v51, v50, s[16:17] offset:640
    global_load_dword v51, v50, s[16:17] offset:768
    global_load_dword v51, v50, s[16:17] offset:896
    global_load_dword v51, v50, s[16:17] offset:1024
    global_store_dwordx2 v55, v[48:49], s[50:51] sc1
F_REST:
    s_mov_b64 exec, -1
    s_branch DN_L2
F_SLOW:
    v_lshrrev_b32 v24, 2, v2
    v_mul_u32_u24 v24, 128, v24
    v_and_b32 v27, 3, v2
    v_lshl_add_u32 v24, v27, 4, v24
    v_lshrrev_b32 v26, 1, v2
    v_mul_u32_u24 v26, 128, v26
    v_and_b32 v27, 1, v2
    v_lshl_add_u32 v26, v27, 4, v26
    v_add_u32 v26, 10304, v26
    v_add_u32 v24, 4096, v24
    v_add_u32 v26, 4096, v26
    global_load_dwordx4 v[28:31], v24, s[50:51] sc1
    v_add_u32 v24, 2048, v24
    global_load_dwordx4 v[32:35], v24, s[50:51] sc1
    v_add_u32 v24, 2048, v24
    global_load_dwordx4 v[36:39], v24, s[50:51] sc1
    v_add_u32 v24, 2048, v24
    global_load_dwordx4 v[40:43], v24, s[50:51] sc1
    v_add_u32 v24, 2048, v24
    global_load_dwordx4 v[44:47], v24, s[50:51] sc1
    v_add_u32 v24, 2048, v24
    global_load_dwordx4 v[48:51], v24, s[50:51] sc1
    v_add_u32 v24, 2048, v24
    global_load_dwordx4 v[52:55], v24, s[50:51] sc1
    v_add_u32 v24, 2048, v24
    global_load_dwordx4 v[56:59], v26, s[50:51] sc1
    v_add_u32 v24, 2048, v24
    v_sub_u32 v24, 0xfff, v20
    s_waitcnt vmcnt(0)
    v_subrev_u32 v25, 0, v24
    v_bfi_b32 v28, s76, v25, v28
    v_subrev_u32 v25, 1, v24
    v_bfi_b32 v29, s76, v25, v29
    v_subrev_u32 v25, 2, v24
    v_bfi_b32 v30, s76, v25, v30
    v_subrev_u32 v25, 3, v24
    v_bfi_b32 v31, s76, v25, v31
    v_subrev_u32 v25, 256, v24
    v_bfi_b32 v32, s76, v25, v32
    v_subrev_u32 v25, 257, v24
    v_bfi_b32 v33, s76, v25, v33
    v_subrev_u32 v25, 258, v24
    v_bfi_b32 v34, s76, v25, v34
    v_subrev_u32 v25, 259, v24
    v_bfi_b32 v35, s76, v25, v35
    v_subrev_u32 v25, 512, v24
    v_bfi_b32 v36, s76, v25, v36
    v_subrev_u32 v25, 513, v24
    v_bfi_b32 v37, s76, v25, v37
    v_subrev_u32 v25, 514, v24
    v_bfi_b32 v38, s76, v25, v38
    v_subrev_u32 v25, 515, v24
    v_bfi_b32 v39, s76, v25, v39
    v_subrev_u32 v25, 768, v24
    v_bfi_b32 v40, s76, v25, v40
    v_subrev_u32 v25, 769, v24
    v_bfi_b32 v41, s76, v25, v41
    v_subrev_u32 v25, 770, v24
    v_bfi_b32 v42, s76, v25, v42
    v_subrev_u32 v25, 771, v24
    v_bfi_b32 v43, s76, v25, v43
    v_subrev_u32 v25, 1024, v24
    v_bfi_b32 v44, s76, v25, v44
    v_subrev_u32 v25, 1025, v24
    v_bfi_b32 v45, s76, v25, v45
    v_subrev_u32 v25, 1026, v24
    v_bfi_b32 v46, s76, v25, v46
    v_subrev_u32 v25, 1027, v24
    v_bfi_b32 v47, s76, v25, v47
    v_subrev_u32 v25, 1280, v24
    v_bfi_b32 v48, s76, v25, v48
    v_subrev_u32 v25, 1281, v24
    v_bfi_b32 v49, s76, v25, v49
    v_subrev_u32 v25, 1282, v24
    v_bfi_b32 v50, s76, v25, v50
    v_subrev_u32 v25, 1283, v24
    v_bfi_b32 v51, s76, v25, v51
    v_subrev_u32 v25, 1536, v24
    v_bfi_b32 v52, s76, v25, v52
    v_subrev_u32 v25, 1537, v24
    v_bfi_b32 v53, s76, v25, v53
    v_subrev_u32 v25, 1538, v24
    v_bfi_b32 v54, s76, v25, v54
    v_subrev_u32 v25, 1539, v24
    v_bfi_b32 v55, s76, v25, v55
    v_subrev_u32 v25, 1792, v24
    v_bfi_b32 v56, s76, v25, v56
    v_subrev_u32 v25, 1793, v24
    v_bfi_b32 v57, s76, v25, v57
    v_subrev_u32 v25, 1794, v24
    v_bfi_b32 v58, s76, v25, v58
    v_subrev_u32 v25, 1795, v24
    v_bfi_b32 v59, s76, v25, v59
    s_mov_b32 s77, 0
    s_mov_b32 s7, 0
F_SLOOP:
    v_subrev_u32 v60, s77, v28
    v_subrev_u32 v61, s77, v29
    v_subrev_u32 v62, s77, v30
    v_subrev_u32 v63, s77, v31
    v_subrev_u32 v64, s77, v32
    v_subrev_u32 v65, s77, v33
    v_subrev_u32 v66, s77, v34
    v_subrev_u32 v67, s77, v35
    v_subrev_u32 v68, s77, v36
    v_subrev_u32 v69, s77, v37
    v_subrev_u32 v70, s77, v38
    v_subrev_u32 v71, s77, v39
    v_subrev_u32 v72, s77, v40
    v_subrev_u32 v73, s77, v41
    v_subrev_u32 v74, s77, v42
    v_subrev_u32 v75, s77, v43
    v_subrev_u32 v76, s77, v44
    v_subrev_u32 v77, s77, v45
    v_subrev_u32 v78, s77, v46
    v_subrev_u32 v79, s77, v47
    v_subrev_u32 v80, s77, v48
    v_subrev_u32 v81, s77, v49
    v_subrev_u32 v82, s77, v50
    v_subrev_u32 v83, s77, v51
    v_subrev_u32 v84, s77, v52
    v_subrev_u32 v85, s77, v53
    v_subrev_u32 v86, s77, v54
    v_subrev_u32 v87, s77, v55
    v_subrev_u32 v88, s77, v56
    v_subrev_u32 v89, s77, v57
    v_subrev_u32 v90, s77, v58
    v_subrev_u32 v91, s77, v59
    v_max_u32 v60, v60, v61
    v_max3_u32 v60, v60, v62, v63
    v_max3_u32 v60, v60, v64, v65
    v_max3_u32 v60, v60, v66, v67
    v_max3_u32 v60, v60, v68, v69
    v_max3_u32 v60, v60, v70, v71
    v_max3_u32 v60, v60, v72, v73
    v_max3_u32 v60, v60, v74, v75
    v_max3_u32 v60, v60, v76, v77
    v_max3_u32 v60, v60, v78, v79
    v_max3_u32 v60, v60, v80, v81
    v_max3_u32 v60, v60, v82, v83
    v_max3_u32 v60, v60, v84, v85
    v_max3_u32 v60, v60, v86, v87
    v_max3_u32 v60, v60, v88, v89
    v_max3_u32 v60, v60, v90, v91
    s_nop 1
    v_max_u32_dpp v60, v60, v60 row_shr:1 row_mask:0xf bank_mask:0xf
    s_nop 1
    v_max_u32_dpp v60, v60, v60 row_shr:2 row_mask:0xf bank_mask:0xf
    s_nop 1
    v_max_u32_dpp v60, v60, v60 row_shr:4 row_mask:0xf bank_mask:0xf
    s_nop 1
    v_max_u32_dpp v60, v60, v60 row_shr:8 row_mask:0xf bank_mask:0xf
    s_nop 1
    v_max_u32_dpp v60, v60, v60 row_bcast:15 row_mask:0xa bank_mask:0xf
    s_nop 1
    v_max_u32_dpp v60, v60, v60 row_bcast:31 row_mask:0xc bank_mask:0xf
    s_nop 0
    v_readlane_b32 s8, v60, 63
    s_add_u32 s77, s77, s8
    s_add_u32 s7, s7, 1
    s_cmp_le_u32 s7, s3
    s_cbranch_scc1 F_SLOOP
    s_mov_b64 exec, 1
    v_mov_b32 v48, s77
    v_mov_b32 v49, v14
    s_lshl_b32 s8, s3, 3
    s_add_u32 s8, s8, s72
    v_mov_b32 v50, s8
    global_store_dwordx2 v50, v[48:49], s[50:51] offset:256
    s_lshl_b32 s8, s3, 7
    s_add_u32 s8, s8, s73
    v_mov_b32 v50, s8
    global_store_dwordx2 v50, v[48:49], s[50:51] sc1
    s_branch F_REST
CK_MAIN:
    s_mul_i32 s13, s7, 8192
    s_add_u32 s13, s13, 120832
    s_lshr_b32 s14, s7, 1
    s_mul_i32 s14, s14, 60192
    s_and_b32 s8, s7, 1
    s_lshl_b32 s8, s8, 9
    s_add_u32 s14, s14, s8
    s_lshl_b32 s8, s12, 8
    s_add_u32 m0, s14, s8
    v_mov_b32 v124, 0
    v_mov_b32 v125, 0
    v_mov_b32 v126, 0
    v_mov_b32 v127, 0
    s_lshl_b32 s8, s12, 11
    s_add_u32 s8, s8, s13
    v_lshl_add_u32 v20, v2, 4, s8
    ds_write_b128 v20, v[124:127]
    ds_write_b128 v20, v[124:127] offset:1024
    v_mul_u32_u24 v128, 1056, v3
    v_lshl_add_u32 v128, v4, 4, v128
    v_add_u32 v128, s14, v128
    s_lshl_b32 s8, s3, 2
    s_add_u32 s9, s8, 153632
    v_mov_b32 v129, s9
    s_xor_b32 s8, s8, 16
    s_add_u32 s9, s8, 153632
    v_mov_b32 v130, s9
    v_mov_b32 v21, 0x3c00
    ds_write_addtid_b32 v21 offset:43296
    v_mov_b32 v22, 0x3fb8aa3b
    v_mov_b32 v23, 0x32a57060
    v_mov_b32 v24, 0x3fb8aa3b
    v_mov_b32 v25, 0x3e22f983
    s_mov_b32 s15, 0x7fff7fff
    s_cmp_eq_u32 s12, 0
    s_mov_b32 s73, 0x01000c0c
    s_cselect_b32 s73, s73, 0x03020c0c
    s_waitcnt vmcnt(6)
    v_mul_f32 v19, v18, v22
    v_fma_f32 v22, v18, v22, -v19
    v_exp_f32 v19, v19
    v_fma_f32 v22, v18, v23, v22
    v_mul_f32 v22, 0x3f317218, v22
    v_fma_f32 v19, v19, v22, v19
    v_cvt_pk_bf16_f32 v19, v19, v19
    v_and_b32 v18, 0xffff0000, v19
    v_pk_mul_f32 v[24:25], v[24:25], v[18:19] op_sel_hi:[1,0]
    s_waitcnt vmcnt(0)
    v_and_b32 v14, s15, v30
    v_and_b32 v15, s15, v31
    v_and_b32 v16, s15, v32
    v_and_b32 v17, s15, v33
    v_perm_b32 v8, v28, v28, s73
    v_perm_b32 v9, v29, v29, s73
    v_perm_b32 v10, v30, v30, s73
    v_perm_b32 v11, v31, v31, s73
    v_perm_b32 v12, v32, v32, s73
    v_perm_b32 v13, v33, v33, s73
    v_pk_max_u16 v14, v14, v15
    v_pk_max_u16 v16, v16, v17
    v_lshlrev_b32 v15, 16, v14
    v_lshlrev_b32 v17, 16, v16
    v_pk_mul_f32 v[14:15], v[14:15], v[16:17]
    v_pk_mul_f32 v[8:9], v[8:9], v[24:25]
    v_max_f32 v14, v14, v15
    v_pk_mul_f32 v[10:11], v[10:11], v[18:19] op_sel_hi:[1,0]
    v_mul_f32 v14, v14, v18
    v_pk_mul_f32 v[66:67], v[12:13], v[10:11] op_sel:[1,1] op_sel_hi:[1,0]
    v_pk_fma_f32 v[56:57], v[12:13], v[10:11], v[66:67] op_sel:[0,0,0] op_sel_hi:[0,1,1] neg_lo:[0,0,1]
    v_max_u32_dpp v14, v14, v14 row_shr:1 row_mask:0xf bank_mask:0xf
    v_mul_f32 v60, 0x41000000, v8
    v_mul_f32 v61, 0xc1000000, v9
    v_max_u32_dpp v14, v14, v14 row_shr:2 row_mask:0xf bank_mask:0xf
    v_mul_f32 v62, 0x43000000, v8
    v_mul_f32 v63, 0x43000000, v9
    v_max_u32_dpp v14, v14, v14 row_shr:4 row_mask:0xf bank_mask:0xf
    v_fract_f32 v59, v9
    v_fract_f32 v61, v61
    v_max_u32_dpp v14, v14, v14 row_shr:8 row_mask:0xf bank_mask:0xf
    v_fract_f32 v63, v63
    v_exp_f32 v20, v8
    v_max_u32_dpp v14, v14, v14 row_bcast:15 row_mask:0xa bank_mask:0xf
    v_exp_f32 v22, v60
    v_exp_f32 v26, v62
    v_max_u32_dpp v14, v14, v14 row_bcast:31 row_mask:0xc bank_mask:0xf
    v_cos_f32 v60, v61
    v_readlane_b32 s8, v14, 63
    v_sin_f32 v61, v61
    v_cos_f32 v58, v59
    v_sin_f32 v59, v59
    v_cos_f32 v62, v63
    v_sin_f32 v63, v63
    s_lshr_b32 s8, s8, 23
    s_sub_i32 s8, 258, s8
    s_max_i32 s8, s8, 1
    s_min_i32 s8, s8, 253
    s_lshl_b32 s10, s8, 23
    v_pk_mul_f32 v[60:61], v[60:61], v[22:23] op_sel_hi:[1,0]
    v_pk_mul_f32 v[58:59], v[58:59], v[20:21] op_sel_hi:[1,0]
    v_pk_mul_f32 v[62:63], v[62:63], v[26:27] op_sel_hi:[1,0]
    v_pk_mul_f32 v[56:57], v[56:57], s[10:11] op_sel_hi:[1,0]
    v_cvt_pk_f16_f32 v70, v60, v61
    ds_write_addtid_b32 v70 offset:44352
    v_cvt_pk_f16_f32 v71, v56, v57
    ds_write_addtid_b32 v71 offset:42240
    v_pk_mul_f32 v[66:67], v[56:57], v[58:59] op_sel:[1,1] op_sel_hi:[1,0]
    v_pk_fma_f32 v[40:41], v[56:57], v[58:59], v[66:67] op_sel:[0,0,0] op_sel_hi:[0,1,1] neg_lo:[0,0,1]
    v_cvt_pk_f16_f32 v72, v40, v41
    ds_write_addtid_b32 v72 offset:0
    v_pk_mul_f32 v[66:67], v[40:41], v[58:59] op_sel:[1,1] op_sel_hi:[1,0]
    v_pk_fma_f32 v[42:43], v[40:41], v[58:59], v[66:67] op_sel:[0,0,0] op_sel_hi:[0,1,1] neg_lo:[0,0,1]
    v_cvt_pk_f16_f32 v73, v42, v43
    ds_write_addtid_b32 v73 offset:1056
    v_pk_mul_f32 v[66:67], v[42:43], v[58:59] op_sel:[1,1] op_sel_hi:[1,0]
    v_pk_fma_f32 v[44:45], v[42:43], v[58:59], v[66:67] op_sel:[0,0,0] op_sel_hi:[0,1,1] neg_lo:[0,0,1]
    v_cvt_pk_f16_f32 v70, v44, v45
    ds_write_addtid_b32 v70 offset:2112
    v_pk_mul_f32 v[66:67], v[44:45], v[58:59] op_sel:[1,1] op_sel_hi:[1,0]
    v_pk_fma_f32 v[46:47], v[44:45], v[58:59], v[66:67] op_sel:[0,0,0] op_sel_hi:[0,1,1] neg_lo:[0,0,1]
    v_cvt_pk_f16_f32 v71, v46, v47
    ds_write_addtid_b32 v71 offset:3168
    v_pk_mul_f32 v[66:67], v[46:47], v[58:59] op_sel:[1,1] op_sel_hi:[1,0]
    v_pk_fma_f32 v[48:49], v[46:47], v[58:59], v[66:67] op_sel:[0,0,0] op_sel_hi:[0,1,1] neg_lo:[0,0,1]
    v_cvt_pk_f16_f32 v72, v48, v49
    ds_write_addtid_b32 v72 offset:4224
    v_pk_mul_f32 v[66:67], v[48:49], v[58:59] op_sel:[1,1] op_sel_hi:[1,0]
    v_pk_fma_f32 v[50:51], v[48:49], v[58:59], v[66:67] op_sel:[0,0,0] op_sel_hi:[0,1,1] neg_lo:[0,0,1]
    v_cvt_pk_f16_f32 v73, v50, v51
    ds_write_addtid_b32 v73 offset:5280
    v_pk_mul_f32 v[66:67], v[50:51], v[58:59] op_sel:[1,1] op_sel_hi:[1,0]
    v_pk_fma_f32 v[52:53], v[50:51], v[58:59], v[66:67] op_sel:[0,0,0] op_sel_hi:[0,1,1] neg_lo:[0,0,1]
    v_cvt_pk_f16_f32 v70, v52, v53
    ds_write_addtid_b32 v70 offset:6336
    v_pk_mul_f32 v[66:67], v[52:53], v[58:59] op_sel:[1,1] op_sel_hi:[1,0]
    v_pk_fma_f32 v[54:55], v[52:53], v[58:59], v[66:67] op_sel:[0,0,0] op_sel_hi:[0,1,1] neg_lo:[0,0,1]
    v_cvt_pk_f16_f32 v71, v54, v55
    ds_write_addtid_b32 v71 offset:7392
    v_pk_mul_f32 v[66:67], v[40:41], v[62:63] op_sel:[1,1] op_sel_hi:[1,0]
    v_pk_fma_f32 v[40:41], v[40:41], v[62:63], v[66:67] op_sel:[0,0,0] op_sel_hi:[0,1,1] neg_lo:[0,0,1]
    v_cvt_pk_f16_f32 v72, v40, v41
    ds_write_addtid_b32 v72 offset:8448
    v_pk_mul_f32 v[66:67], v[42:43], v[62:63] op_sel:[1,1] op_sel_hi:[1,0]
    v_pk_fma_f32 v[42:43], v[42:43], v[62:63], v[66:67] op_sel:[0,0,0] op_sel_hi:[0,1,1] neg_lo:[0,0,1]
    v_cvt_pk_f16_f32 v73, v42, v43
    ds_write_addtid_b32 v73 offset:9504
    v_pk_mul_f32 v[66:67], v[44:45], v[62:63] op_sel:[1,1] op_sel_hi:[1,0]
    v_pk_fma_f32 v[44:45], v[44:45], v[62:63], v[66:67] op_sel:[0,0,0] op_sel_hi:[0,1,1] neg_lo:[0,0,1]
    v_cvt_pk_f16_f32 v70, v44, v45
    ds_write_addtid_b32 v70 offset:10560
    v_pk_mul_f32 v[66:67], v[46:47], v[62:63] op_sel:[1,1] op_sel_hi:[1,0]
    v_pk_fma_f32 v[46:47], v[46:47], v[62:63], v[66:67] op_sel:[0,0,0] op_sel_hi:[0,1,1] neg_lo:[0,0,1]
    v_cvt_pk_f16_f32 v71, v46, v47
    ds_write_addtid_b32 v71 offset:11616
    v_pk_mul_f32 v[66:67], v[48:49], v[62:63] op_sel:[1,1] op_sel_hi:[1,0]
    v_pk_fma_f32 v[48:49], v[48:49], v[62:63], v[66:67] op_sel:[0,0,0] op_sel_hi:[0,1,1] neg_lo:[0,0,1]
    v_cvt_pk_f16_f32 v72, v48, v49
    ds_write_addtid_b32 v72 offset:12672
    v_pk_mul_f32 v[66:67], v[50:51], v[62:63] op_sel:[1,1] op_sel_hi:[1,0]
    v_pk_fma_f32 v[50:51], v[50:51], v[62:63], v[66:67] op_sel:[0,0,0] op_sel_hi:[0,1,1] neg_lo:[0,0,1]
    v_cvt_pk_f16_f32 v73, v50, v51
    ds_write_addtid_b32 v73 offset:13728
    v_pk_mul_f32 v[66:67], v[52:53], v[62:63] op_sel:[1,1] op_sel_hi:[1,0]
    v_pk_fma_f32 v[52:53], v[52:53], v[62:63], v[66:67] op_sel:[0,0,0] op_sel_hi:[0,1,1] neg_lo:[0,0,1]
    v_cvt_pk_f16_f32 v70, v52, v53
    ds_write_addtid_b32 v70 offset:14784
    v_pk_mul_f32 v[66:67], v[54:55], v[62:63] op_sel:[1,1] op_sel_hi:[1,0]
    v_pk_fma_f32 v[54:55], v[54:55], v[62:63], v[66:67] op_sel:[0,0,0] op_sel_hi:[0,1,1] neg_lo:[0,0,1]
    v_cvt_pk_f16_f32 v71, v54, v55
    ds_write_addtid_b32 v71 offset:15840
    v_pk_mul_f32 v[66:67], v[42:43], v[62:63] op_sel:[1,1] op_sel_hi:[1,0]
    v_pk_fma_f32 v[42:43], v[42:43], v[62:63], v[66:67] op_sel:[0,0,0] op_sel_hi:[0,1,1] neg_lo:[0,0,1]
    v_cvt_pk_f16_f32 v72, v42, v43
    ds_write_addtid_b32 v72 offset:16896
    v_pk_mul_f32 v[66:67], v[46:47], v[62:63] op_sel:[1,1] op_sel_hi:[1,0]
    v_pk_fma_f32 v[46:47], v[46:47], v[62:63], v[66:67] op_sel:[0,0,0] op_sel_hi:[0,1,1] neg_lo:[0,0,1]
    v_cvt_pk_f16_f32 v73, v46, v47
    ds_write_addtid_b32 v73 offset:17952
    v_pk_mul_f32 v[66:67], v[50:51], v[62:63] op_sel:[1,1] op_sel_hi:[1,0]
    v_pk_fma_f32 v[50:51], v[50:51], v[62:63], v[66:67] op_sel:[0,0,0] op_sel_hi:[0,1,1] neg_lo:[0,0,1]
    v_cvt_pk_f16_f32 v70, v50, v51
    ds_write_addtid_b32 v70 offset:19008
    v_pk_mul_f32 v[66:67], v[54:55], v[62:63] op_sel:[1,1] op_sel_hi:[1,0]
    v_pk_fma_f32 v[54:55], v[54:55], v[62:63], v[66:67] op_sel:[0,0,0] op_sel_hi:[0,1,1] neg_lo:[0,0,1]
    v_cvt_pk_f16_f32 v71, v54, v55
    ds_write_addtid_b32 v71 offset:20064
    v_pk_mul_f32 v[66:67], v[42:43], v[62:63] op_sel:[1,1] op_sel_hi:[1,0]
    v_pk_fma_f32 v[42:43], v[42:43], v[62:63], v[66:67] op_sel:[0,0,0] op_sel_hi:[0,1,1] neg_lo:[0,0,1]
    v_cvt_pk_f16_f32 v72, v42, v43
    ds_write_addtid_b32 v72 offset:21120
    v_pk_mul_f32 v[66:67], v[46:47], v[62:63] op_sel:[1,1] op_sel_hi:[1,0]
    v_pk_fma_f32 v[46:47], v[46:47], v[62:63], v[66:67] op_sel:[0,0,0] op_sel_hi:[0,1,1] neg_lo:[0,0,1]
    v_cvt_pk_f16_f32 v73, v46, v47
    ds_write_addtid_b32 v73 offset:22176
    v_pk_mul_f32 v[66:67], v[50:51], v[62:63] op_sel:[1,1] op_sel_hi:[1,0]
    v_pk_fma_f32 v[50:51], v[50:51], v[62:63], v[66:67] op_sel:[0,0,0] op_sel_hi:[0,1,1] neg_lo:[0,0,1]
    v_cvt_pk_f16_f32 v70, v50, v51
    ds_write_addtid_b32 v70 offset:23232
    v_pk_mul_f32 v[66:67], v[54:55], v[62:63] op_sel:[1,1] op_sel_hi:[1,0]
    v_pk_fma_f32 v[54:55], v[54:55], v[62:63], v[66:67] op_sel:[0,0,0] op_sel_hi:[0,1,1] neg_lo:[0,0,1]
    v_cvt_pk_f16_f32 v71, v54, v55
    ds_write_addtid_b32 v71 offset:24288
    v_pk_mul_f32 v[66:67], v[46:47], v[62:63] op_sel:[1,1] op_sel_hi:[1,0]
    v_pk_fma_f32 v[46:47], v[46:47], v[62:63], v[66:67] op_sel:[0,0,0] op_sel_hi:[0,1,1] neg_lo:[0,0,1]
    v_cvt_pk_f16_f32 v72, v46, v47
    ds_write_addtid_b32 v72 offset:25344
    v_pk_mul_f32 v[66:67], v[54:55], v[62:63] op_sel:[1,1] op_sel_hi:[1,0]
    v_pk_fma_f32 v[54:55], v[54:55], v[62:63], v[66:67] op_sel:[0,0,0] op_sel_hi:[0,1,1] neg_lo:[0,0,1]
    v_cvt_pk_f16_f32 v73, v54, v55
    ds_write_addtid_b32 v73 offset:26400
    v_pk_mul_f32 v[66:67], v[46:47], v[62:63] op_sel:[1,1] op_sel_hi:[1,0]
    v_pk_fma_f32 v[46:47], v[46:47], v[62:63], v[66:67] op_sel:[0,0,0] op_sel_hi:[0,1,1] neg_lo:[0,0,1]
    v_cvt_pk_f16_f32 v70, v46, v47
    ds_write_addtid_b32 v70 offset:27456
    v_pk_mul_f32 v[66:67], v[54:55], v[62:63] op_sel:[1,1] op_sel_hi:[1,0]
    v_pk_fma_f32 v[54:55], v[54:55], v[62:63], v[66:67] op_sel:[0,0,0] op_sel_hi:[0,1,1] neg_lo:[0,0,1]
    v_cvt_pk_f16_f32 v71, v54, v55
    ds_write_addtid_b32 v71 offset:28512
    v_pk_mul_f32 v[66:67], v[46:47], v[62:63] op_sel:[1,1] op_sel_hi:[1,0]
    v_pk_fma_f32 v[46:47], v[46:47], v[62:63], v[66:67] op_sel:[0,0,0] op_sel_hi:[0,1,1] neg_lo:[0,0,1]
    v_cvt_pk_f16_f32 v72, v46, v47
    ds_write_addtid_b32 v72 offset:29568
    v_pk_mul_f32 v[66:67], v[54:55], v[62:63] op_sel:[1,1] op_sel_hi:[1,0]
    v_pk_fma_f32 v[54:55], v[54:55], v[62:63], v[66:67] op_sel:[0,0,0] op_sel_hi:[0,1,1] neg_lo:[0,0,1]
    v_cvt_pk_f16_f32 v73, v54, v55
    ds_write_addtid_b32 v73 offset:30624
    v_pk_mul_f32 v[66:67], v[46:47], v[62:63] op_sel:[1,1] op_sel_hi:[1,0]
    v_pk_fma_f32 v[46:47], v[46:47], v[62:63], v[66:67] op_sel:[0,0,0] op_sel_hi:[0,1,1] neg_lo:[0,0,1]
    v_cvt_pk_f16_f32 v70, v46, v47
    ds_write_addtid_b32 v70 offset:31680
    v_pk_mul_f32 v[66:67], v[54:55], v[62:63] op_sel:[1,1] op_sel_hi:[1,0]
    v_pk_fma_f32 v[54:55], v[54:55], v[62:63], v[66:67] op_sel:[0,0,0] op_sel_hi:[0,1,1] neg_lo:[0,0,1]
    v_cvt_pk_f16_f32 v71, v54, v55
    ds_write_addtid_b32 v71 offset:32736
    v_pk_mul_f32 v[66:67], v[54:55], v[62:63] op_sel:[1,1] op_sel_hi:[1,0]
    v_pk_fma_f32 v[54:55], v[54:55], v[62:63], v[66:67] op_sel:[0,0,0] op_sel_hi:[0,1,1] neg_lo:[0,0,1]
    v_cvt_pk_f16_f32 v72, v54, v55
    ds_write_addtid_b32 v72 offset:33792
    v_pk_mul_f32 v[66:67], v[54:55], v[62:63] op_sel:[1,1] op_sel_hi:[1,0]
    v_pk_fma_f32 v[54:55], v[54:55], v[62:63], v[66:67] op_sel:[0,0,0] op_sel_hi:[0,1,1] neg_lo:[0,0,1]
    v_cvt_pk_f16_f32 v73, v54, v55
    ds_write_addtid_b32 v73 offset:34848
    v_pk_mul_f32 v[66:67], v[54:55], v[62:63] op_sel:[1,1] op_sel_hi:[1,0]
    v_pk_fma_f32 v[54:55], v[54:55], v[62:63], v[66:67] op_sel:[0,0,0] op_sel_hi:[0,1,1] neg_lo:[0,0,1]
    v_cvt_pk_f16_f32 v70, v54, v55
    ds_write_addtid_b32 v70 offset:35904
    v_pk_mul_f32 v[66:67], v[54:55], v[62:63] op_sel:[1,1] op_sel_hi:[1,0]
    v_pk_fma_f32 v[54:55], v[54:55], v[62:63], v[66:67] op_sel:[0,0,0] op_sel_hi:[0,1,1] neg_lo:[0,0,1]
    v_cvt_pk_f16_f32 v71, v54, v55
    ds_write_addtid_b32 v71 offset:36960
    v_pk_mul_f32 v[66:67], v[54:55], v[62:63] op_sel:[1,1] op_sel_hi:[1,0]
    v_pk_fma_f32 v[54:55], v[54:55], v[62:63], v[66:67] op_sel:[0,0,0] op_sel_hi:[0,1,1] neg_lo:[0,0,1]
    v_cvt_pk_f16_f32 v72, v54, v55
    ds_write_addtid_b32 v72 offset:38016
    v_pk_mul_f32 v[66:67], v[54:55], v[62:63] op_sel:[1,1] op_sel_hi:[1,0]
    v_pk_fma_f32 v[54:55], v[54:55], v[62:63], v[66:67] op_sel:[0,0,0] op_sel_hi:[0,1,1] neg_lo:[0,0,1]
    v_cvt_pk_f16_f32 v73, v54, v55
    ds_write_addtid_b32 v73 offset:39072
    v_pk_mul_f32 v[66:67], v[54:55], v[62:63] op_sel:[1,1] op_sel_hi:[1,0]
    v_pk_fma_f32 v[54:55], v[54:55], v[62:63], v[66:67] op_sel:[0,0,0] op_sel_hi:[0,1,1] neg_lo:[0,0,1]
    v_cvt_pk_f16_f32 v70, v54, v55
    ds_write_addtid_b32 v70 offset:40128
    v_pk_mul_f32 v[66:67], v[54:55], v[62:63] op_sel:[1,1] op_sel_hi:[1,0]
    v_pk_fma_f32 v[54:55], v[54:55], v[62:63], v[66:67] op_sel:[0,0,0] op_sel_hi:[0,1,1] neg_lo:[0,0,1]
    v_cvt_pk_f16_f32 v71, v54, v55
    ds_write_addtid_b32 v71 offset:41184
    v_pk_mul_f32 v[66:67], v[60:61], v[60:61] op_sel:[1,1] op_sel_hi:[1,0]
    v_pk_fma_f32 v[64:65], v[60:61], v[60:61], v[66:67] op_sel:[0,0,0] op_sel_hi:[0,1,1] neg_lo:[0,0,1]
    v_cvt_pk_f16_f32 v72, v64, v65
    ds_write_addtid_b32 v72 offset:45408
    v_pk_mul_f32 v[66:67], v[64:65], v[60:61] op_sel:[1,1] op_sel_hi:[1,0]
    v_pk_fma_f32 v[64:65], v[64:65], v[60:61], v[66:67] op_sel:[0,0,0] op_sel_hi:[0,1,1] neg_lo:[0,0,1]
    v_cvt_pk_f16_f32 v73, v64, v65
    ds_write_addtid_b32 v73 offset:46464
    v_pk_mul_f32 v[66:67], v[64:65], v[60:61] op_sel:[1,1] op_sel_hi:[1,0]
    v_pk_fma_f32 v[64:65], v[64:65], v[60:61], v[66:67] op_sel:[0,0,0] op_sel_hi:[0,1,1] neg_lo:[0,0,1]
    v_cvt_pk_f16_f32 v70, v64, v65
    ds_write_addtid_b32 v70 offset:47520
    v_pk_mul_f32 v[66:67], v[64:65], v[60:61] op_sel:[1,1] op_sel_hi:[1,0]
    v_pk_fma_f32 v[64:65], v[64:65], v[60:61], v[66:67] op_sel:[0,0,0] op_sel_hi:[0,1,1] neg_lo:[0,0,1]
    v_cvt_pk_f16_f32 v71, v64, v65
    ds_write_addtid_b32 v71 offset:48576
    v_pk_mul_f32 v[66:67], v[64:65], v[60:61] op_sel:[1,1] op_sel_hi:[1,0]
    v_pk_fma_f32 v[64:65], v[64:65], v[60:61], v[66:67] op_sel:[0,0,0] op_sel_hi:[0,1,1] neg_lo:[0,0,1]
    v_cvt_pk_f16_f32 v72, v64, v65
    ds_write_addtid_b32 v72 offset:49632
    v_pk_mul_f32 v[66:67], v[64:65], v[60:61] op_sel:[1,1] op_sel_hi:[1,0]
    v_pk_fma_f32 v[64:65], v[64:65], v[60:61], v[66:67] op_sel:[0,0,0] op_sel_hi:[0,1,1] neg_lo:[0,0,1]
    v_cvt_pk_f16_f32 v73, v64, v65
    ds_write_addtid_b32 v73 offset:50688
    v_pk_mul_f32 v[66:67], v[64:65], v[60:61] op_sel:[1,1] op_sel_hi:[1,0]
    v_pk_fma_f32 v[64:65], v[64:65], v[60:61], v[66:67] op_sel:[0,0,0] op_sel_hi:[0,1,1] neg_lo:[0,0,1]
    v_cvt_pk_f16_f32 v70, v64, v65
    ds_write_addtid_b32 v70 offset:51744
    v_pk_mul_f32 v[66:67], v[64:65], v[60:61] op_sel:[1,1] op_sel_hi:[1,0]
    v_pk_fma_f32 v[64:65], v[64:65], v[60:61], v[66:67] op_sel:[0,0,0] op_sel_hi:[0,1,1] neg_lo:[0,0,1]
    v_cvt_pk_f16_f32 v71, v64, v65
    ds_write_addtid_b32 v71 offset:52800
    v_pk_mul_f32 v[66:67], v[64:65], v[60:61] op_sel:[1,1] op_sel_hi:[1,0]
    v_pk_fma_f32 v[64:65], v[64:65], v[60:61], v[66:67] op_sel:[0,0,0] op_sel_hi:[0,1,1] neg_lo:[0,0,1]
    v_cvt_pk_f16_f32 v72, v64, v65
    ds_write_addtid_b32 v72 offset:53856
    v_pk_mul_f32 v[66:67], v[64:65], v[60:61] op_sel:[1,1] op_sel_hi:[1,0]
    v_pk_fma_f32 v[64:65], v[64:65], v[60:61], v[66:67] op_sel:[0,0,0] op_sel_hi:[0,1,1] neg_lo:[0,0,1]
    v_cvt_pk_f16_f32 v73, v64, v65
    ds_write_addtid_b32 v73 offset:54912
    v_pk_mul_f32 v[66:67], v[64:65], v[60:61] op_sel:[1,1] op_sel_hi:[1,0]
    v_pk_fma_f32 v[64:65], v[64:65], v[60:61], v[66:67] op_sel:[0,0,0] op_sel_hi:[0,1,1] neg_lo:[0,0,1]
    v_cvt_pk_f16_f32 v70, v64, v65
    ds_write_addtid_b32 v70 offset:55968
    v_pk_mul_f32 v[66:67], v[64:65], v[60:61] op_sel:[1,1] op_sel_hi:[1,0]
    v_pk_fma_f32 v[64:65], v[64:65], v[60:61], v[66:67] op_sel:[0,0,0] op_sel_hi:[0,1,1] neg_lo:[0,0,1]
    v_cvt_pk_f16_f32 v71, v64, v65
    ds_write_addtid_b32 v71 offset:57024
    v_pk_mul_f32 v[66:67], v[64:65], v[60:61] op_sel:[1,1] op_sel_hi:[1,0]
    v_pk_fma_f32 v[64:65], v[64:65], v[60:61], v[66:67] op_sel:[0,0,0] op_sel_hi:[0,1,1] neg_lo:[0,0,1]
    v_cvt_pk_f16_f32 v72, v64, v65
    ds_write_addtid_b32 v72 offset:58080
    v_pk_mul_f32 v[66:67], v[64:65], v[60:61] op_sel:[1,1] op_sel_hi:[1,0]
    v_pk_fma_f32 v[64:65], v[64:65], v[60:61], v[66:67] op_sel:[0,0,0] op_sel_hi:[0,1,1] neg_lo:[0,0,1]
    v_cvt_pk_f16_f32 v73, v64, v65
    ds_write_addtid_b32 v73 offset:59136
CK_SKIP:
    ds_write_b32 v129, v129
    s_mov_b32 s9, 0
CK_PAIR:
    ds_read_b32 v8, v130
    s_add_u32 s9, s9, 1
    s_waitcnt lgkmcnt(0)
    v_cmp_eq_u32 vcc, 0, v8
    s_cmp_ge_u32 s9, 0x40000
    s_cbranch_scc1 CK_PAIRED
    s_cbranch_vccnz CK_PAIR
CK_PAIRED:
    s_cmp_eq_u32 s12, 0
    s_cbranch_scc0 CK_T1
    ds_read_b128 v[8:11], v128 offset:43296
    ds_read_b128 v[40:43], v128 offset:0
    ds_read_b128 v[12:15], v128 offset:43360
    ds_read_b128 v[44:47], v128 offset:64
    ds_read_b128 v[16:19], v128 offset:43424
    ds_read_b128 v[48:51], v128 offset:128
    ds_read_b128 v[20:23], v128 offset:43488
    ds_read_b128 v[52:55], v128 offset:192
    s_lshl_b32 s9, s7, 2
    s_add_u32 s9, s9, 153616
    v_mov_b32 v112, s9
    v_mov_b32 v113, s8
    ds_read_b128 v[24:27], v128 offset:43552
    ds_read_b128 v[56:59], v128 offset:256
    ds_read_b128 v[28:31], v128 offset:43616
    ds_read_b128 v[60:63], v128 offset:320
    ds_read_b128 v[32:35], v128 offset:43680
    ds_read_b128 v[64:67], v128 offset:384
    ds_read_b128 v[36:39], v128 offset:43744
    ds_read_b128 v[68:71], v128 offset:448
    v_lshrrev_b32 v114, 1, v4
    v_lshlrev_b32 v114, 8, v114
    v_lshl_add_u32 v114, v3, 4, v114
    v_and_b32 v115, 1, v4
    v_lshl_add_u32 v114, v115, 3, v114
    v_add_u32 v114, s13, v114
    v_lshlrev_b32 v115, 5, v3
    v_lshl_add_u32 v115, v4, 3, v115
    v_add_u32 v115, s13, v115
    v_mov_b32 v116, s13
    s_waitcnt lgkmcnt(14)
    v_mfma_f32_16x16x32_f16 v[104:107], v[40:43], v[8:11], 0
    ds_read_b128 v[72:75], v128 offset:33792
    s_waitcnt lgkmcnt(13)
    v_mfma_f32_16x16x32_f16 v[104:107], v[44:47], v[12:15], v[104:107]
    ds_read_b128 v[76:79], v128 offset:33856
    s_waitcnt lgkmcnt(12)
    v_mfma_f32_16x16x32_f16 v[104:107], v[48:51], v[16:19], v[104:107]
    ds_read_b128 v[80:83], v128 offset:33920
    s_waitcnt lgkmcnt(11)
    v_mfma_f32_16x16x32_f16 v[104:107], v[52:55], v[20:23], v[104:107]
    ds_read_b128 v[84:87], v128 offset:33984
    s_waitcnt lgkmcnt(10)
    v_mfma_f32_16x16x32_f16 v[104:107], v[56:59], v[24:27], v[104:107]
    ds_read_b128 v[88:91], v128 offset:34048
    s_waitcnt lgkmcnt(9)
    v_mfma_f32_16x16x32_f16 v[104:107], v[60:63], v[28:31], v[104:107]
    ds_read_b128 v[92:95], v128 offset:34112
    s_waitcnt lgkmcnt(8)
    v_mfma_f32_16x16x32_f16 v[104:107], v[64:67], v[32:35], v[104:107]
    ds_read_b128 v[96:99], v128 offset:34176
    s_waitcnt lgkmcnt(7)
    v_mfma_f32_16x16x32_f16 v[104:107], v[68:71], v[36:39], v[104:107]
    ds_read_b128 v[100:103], v128 offset:34240
    s_waitcnt lgkmcnt(7)
    v_mfma_f32_16x16x32_f16 v[108:111], v[8:11], v[72:75], 0
    s_waitcnt lgkmcnt(6)
    v_mfma_f32_16x16x32_f16 v[108:111], v[12:15], v[76:79], v[108:111]
    s_waitcnt lgkmcnt(5)
    v_mfma_f32_16x16x32_f16 v[108:111], v[16:19], v[80:83], v[108:111]
    s_waitcnt lgkmcnt(4)
    v_mfma_f32_16x16x32_f16 v[108:111], v[20:23], v[84:87], v[108:111]
    s_waitcnt lgkmcnt(3)
    v_mfma_f32_16x16x32_f16 v[108:111], v[24:27], v[88:91], v[108:111]
    s_waitcnt lgkmcnt(2)
    v_mfma_f32_16x16x32_f16 v[108:111], v[28:31], v[92:95], v[108:111]
    s_waitcnt lgkmcnt(1)
    v_mfma_f32_16x16x32_f16 v[108:111], v[32:35], v[96:99], v[108:111]
    s_waitcnt lgkmcnt(0)
    v_mfma_f32_16x16x32_f16 v[108:111], v[36:39], v[100:103], v[108:111]
    ds_write_b32 v112, v113
    v_cvt_pk_f16_f32 v118, v104, v105
    v_cvt_pk_f16_f32 v119, v106, v107
    v_cvt_pk_f16_f32 v120, v105, v106
    v_cvt_pk_f16_f32 v121, v107, v107
    ds_write_b16 v114, v121 offset:1256
    ds_write_b64 v114, v[120:121] offset:32
    ds_write_b64 v114, v[118:119] offset:1248
    ds_write_b16 v114, v118 offset:30
    v_cvt_pk_f16_f32 v118, v108, v109
    v_cvt_pk_f16_f32 v119, v110, v111
    s_mov_b32 s10, 0x00ff00ff
    s_mov_b32 s11, 0x00ff00ff
    s_mov_b64 exec, s[10:11]
    ds_write_b64 v115, v[118:119] offset:2912
    s_mov_b64 exec, 0x100
    ds_write_b16 v116, v118 offset:28
    ds_write_b16 v116, v118 offset:1246
    s_mov_b64 exec, -1
    v_mov_b32 v127, 153600
    v_mov_b32 v126, 1
    s_lshl_b32 s8, s7, 2
    v_add_u32 v131, s8, v127
    s_mov_b64 exec, 1
    ds_add_u32 v131, v126 offset:80
    ds_add_u32 v127, v126 offset:76
    s_mov_b64 exec, -1
    v_mul_u32_u24 v124, 320, v4
    v_lshl_add_u32 v124, v3, 4, v124
    s_mul_i32 s8, s7, 20480
    v_add_u32 v124, s8, v124
    s_lshl_b32 s8, s3, 2
    s_add_u32 s8, s8, 153856
    v_mov_b32 v125, s8
    v_and_b32 v5, 1, v3
    v_mul_u32_u24 v5, 1216, v5
    v_sub_u32 v5, 1264, v5
    v_lshrrev_b32 v6, 1, v3
    v_lshl_add_u32 v5, v6, 2, v5
    v_lshlrev_b32 v6, 4, v4
    v_sub_u32 v5, v5, v6
    v_add_u32 v5, s13, v5
    v_add_u32 v7, 576, v5
    v_lshl_add_u32 v6, v3, 5, v6
    v_add_u32 v6, 3616, v6
    v_add_u32 v6, s13, v6
    s_mov_b32 s9, 0
SPN3:
    ds_read_b32 v128, v131 offset:80
    s_add_u32 s9, s9, 1
    s_waitcnt lgkmcnt(0)
    v_cmp_ne_u32 vcc, 2, v128
    s_cmp_ge_u32 s9, 0x40000
    s_cbranch_scc1 SPX3
    s_cbranch_vccnz SPN3
SPX3:
    ds_read2_b32 v[36:37], v5 offset0:115 offset1:114
    ds_read2_b32 v[38:39], v5 offset0:113 offset1:112
    ds_read2_b32 v[32:33], v5 offset0:99 offset1:98
    ds_read2_b32 v[34:35], v5 offset0:97 offset1:96
    ds_read2_b32 v[28:29], v5 offset0:83 offset1:82
    ds_read2_b32 v[30:31], v5 offset0:81 offset1:80
    ds_read2_b32 v[24:25], v5 offset0:67 offset1:66
    ds_read2_b32 v[26:27], v5 offset0:65 offset1:64
    ds_read2_b32 v[20:21], v5 offset0:51 offset1:50
    ds_read2_b32 v[22:23], v5 offset0:49 offset1:48
    ds_read2_b32 v[16:17], v5 offset0:35 offset1:34
    ds_read2_b32 v[18:19], v5 offset0:33 offset1:32
    ds_read2_b32 v[12:13], v5 offset0:19 offset1:18
    ds_read2_b32 v[14:15], v5 offset0:17 offset1:16
    ds_read2_b32 v[8:9], v5 offset0:3 offset1:2
    ds_read2_b32 v[10:11], v5 offset0:1 offset1:0
    ds_read2_b32 v[68:69], v7 offset0:99 offset1:98
    ds_read2_b32 v[70:71], v7 offset0:97 offset1:96
    ds_read2_b32 v[64:65], v7 offset0:83 offset1:82
    ds_read2_b32 v[66:67], v7 offset0:81 offset1:80
    ds_read2_b32 v[60:61], v7 offset0:67 offset1:66
    ds_read2_b32 v[62:63], v7 offset0:65 offset1:64
    ds_read2_b32 v[56:57], v7 offset0:51 offset1:50
    ds_read2_b32 v[58:59], v7 offset0:49 offset1:48
    ds_read2_b32 v[52:53], v7 offset0:35 offset1:34
    ds_read2_b32 v[54:55], v7 offset0:33 offset1:32
    ds_read2_b32 v[48:49], v7 offset0:19 offset1:18
    ds_read2_b32 v[50:51], v7 offset0:17 offset1:16
    ds_read2_b32 v[44:45], v7 offset0:3 offset1:2
    ds_read2_b32 v[46:47], v7 offset0:1 offset1:0
    ds_read2_b32 v[40:41], v5 offset0:131 offset1:130
    ds_read2_b32 v[42:43], v5 offset0:129 offset1:128
    ds_read2_b32 v[72:73], v7 offset0:115 offset1:114
    ds_read2_b32 v[74:75], v7 offset0:113 offset1:112
    s_mov_b32 s9, 0
SPN4:
    ds_read_b32 v128, v127 offset:76
    s_add_u32 s9, s9, 1
    s_waitcnt lgkmcnt(0)
    v_cmp_ne_u32 vcc, 12, v128
    s_cmp_ge_u32 s9, 0x40000
    s_cbranch_scc1 SPX4
    s_cbranch_vccz SPX4
    s_sleep 1
    s_branch SPN4
SPX4:
D_PASS:
    s_mov_b32 s9, 0
SPN5:
    ds_read_b32 v128, v127 offset:240
    s_add_u32 s9, s9, 1
    s_waitcnt lgkmcnt(0)
    v_and_b32 v128, 15, v128
    v_cmp_ne_u32 vcc, 2, v128
    s_cmp_ge_u32 s9, 0x40000
    s_cbranch_scc1 SPX5
    s_cbranch_vccz SPX5
    s_sleep 1
    s_branch SPN5
SPX5:
D_LOOP:
    ds_read_b128 v[80:83], v6 offset:0
    ds_read_b128 v[84:87], v6 offset:64
    ds_read_b128 v[88:91], v6 offset:128
    ds_read_b128 v[92:95], v6 offset:192
    ds_read_b128 v[96:99], v6 offset:256
    ds_read_b128 v[100:103], v6 offset:320
    ds_read_b128 v[104:107], v6 offset:384
    s_waitcnt lgkmcnt(6)
    v_mfma_f32_16x16x32_f16 v[108:111], v[36:39], v[80:83], 0
    v_mfma_f32_16x16x32_f16 v[112:115], v[68:71], v[80:83], 0
    ds_read_b128 v[76:79], v6 offset:448
    s_waitcnt lgkmcnt(6)
    v_mfma_f32_16x16x32_f16 v[108:111], v[32:35], v[84:87], v[108:111]
    v_mfma_f32_16x16x32_f16 v[112:115], v[64:67], v[84:87], v[112:115]
    ds_read_b128 v[80:83], v6 offset:512
    s_waitcnt lgkmcnt(6)
    v_mfma_f32_16x16x32_f16 v[108:111], v[28:31], v[88:91], v[108:111]
    v_mfma_f32_16x16x32_f16 v[112:115], v[60:63], v[88:91], v[112:115]
    ds_read_b128 v[84:87], v6 offset:576
    s_waitcnt lgkmcnt(6)
    v_mfma_f32_16x16x32_f16 v[108:111], v[24:27], v[92:95], v[108:111]
    v_mfma_f32_16x16x32_f16 v[112:115], v[56:59], v[92:95], v[112:115]
    ds_read_b128 v[88:91], v6 offset:640
    s_waitcnt lgkmcnt(6)
    v_mfma_f32_16x16x32_f16 v[108:111], v[20:23], v[96:99], v[108:111]
    v_mfma_f32_16x16x32_f16 v[112:115], v[52:55], v[96:99], v[112:115]
    ds_read_b128 v[92:95], v6 offset:704
    s_waitcnt lgkmcnt(6)
    v_mfma_f32_16x16x32_f16 v[108:111], v[16:19], v[100:103], v[108:111]
    v_mfma_f32_16x16x32_f16 v[112:115], v[48:51], v[100:103], v[112:115]
    ds_read_b128 v[96:99], v6 offset:768
    s_waitcnt lgkmcnt(6)
    v_mfma_f32_16x16x32_f16 v[108:111], v[12:15], v[104:107], v[108:111]
    v_mfma_f32_16x16x32_f16 v[112:115], v[44:47], v[104:107], v[112:115]
    ds_read_b128 v[100:103], v6 offset:832
    s_waitcnt lgkmcnt(6)
    v_mfma_f32_16x16x32_f16 v[108:111], v[8:11], v[76:79], v[108:111]
    v_mfma_f32_16x16x32_f16 v[112:115], v[40:43], v[76:79], v[112:115]
    v_mfma_f32_16x16x32_f16 v[116:119], v[72:75], v[76:79], 0
    ds_read_b128 v[104:107], v6 offset:896
    s_waitcnt lgkmcnt(6)
    v_mfma_f32_16x16x32_f16 v[112:115], v[36:39], v[80:83], v[112:115]
    v_mfma_f32_16x16x32_f16 v[116:119], v[68:71], v[80:83], v[116:119]
    ds_read_b128 v[76:79], v6 offset:960
    s_waitcnt lgkmcnt(6)
    v_mfma_f32_16x16x32_f16 v[112:115], v[32:35], v[84:87], v[112:115]
    v_mfma_f32_16x16x32_f16 v[116:119], v[64:67], v[84:87], v[116:119]
    ds_read_b128 v[80:83], v6 offset:1024
    s_waitcnt lgkmcnt(6)
    v_mfma_f32_16x16x32_f16 v[112:115], v[28:31], v[88:91], v[112:115]
    ds_write_b64 v124, v[108:109] offset:0
    v_mfma_f32_16x16x32_f16 v[116:119], v[60:63], v[88:91], v[116:119]
    ds_read_b128 v[84:87], v6 offset:1088
    s_waitcnt lgkmcnt(7)
    v_mfma_f32_16x16x32_f16 v[112:115], v[24:27], v[92:95], v[112:115]
    ds_write_b64 v124, v[110:111] offset:8
    v_mfma_f32_16x16x32_f16 v[116:119], v[56:59], v[92:95], v[116:119]
    ds_read_b128 v[88:91], v6 offset:1152
    s_waitcnt lgkmcnt(8)
    v_mfma_f32_16x16x32_f16 v[112:115], v[20:23], v[96:99], v[112:115]
    ds_write_b32 v125, v126 offset:0
    v_mfma_f32_16x16x32_f16 v[116:119], v[52:55], v[96:99], v[116:119]
    ds_read_b128 v[92:95], v6 offset:1216
    s_waitcnt lgkmcnt(9)
    v_mfma_f32_16x16x32_f16 v[112:115], v[16:19], v[100:103], v[112:115]
    v_mfma_f32_16x16x32_f16 v[116:119], v[48:51], v[100:103], v[116:119]
    ds_read_b128 v[96:99], v6 offset:1280
    s_waitcnt lgkmcnt(9)
    v_mfma_f32_16x16x32_f16 v[112:115], v[12:15], v[104:107], v[112:115]
    v_mfma_f32_16x16x32_f16 v[116:119], v[44:47], v[104:107], v[116:119]
    ds_read_b128 v[100:103], v6 offset:1344
    s_waitcnt lgkmcnt(9)
    v_mfma_f32_16x16x32_f16 v[112:115], v[8:11], v[76:79], v[112:115]
    v_mfma_f32_16x16x32_f16 v[116:119], v[40:43], v[76:79], v[116:119]
    v_mfma_f32_16x16x32_f16 v[120:123], v[72:75], v[76:79], 0
    ds_read_b128 v[104:107], v6 offset:1408
    s_waitcnt lgkmcnt(9)
    v_mfma_f32_16x16x32_f16 v[116:119], v[36:39], v[80:83], v[116:119]
    v_mfma_f32_16x16x32_f16 v[120:123], v[68:71], v[80:83], v[120:123]
    ds_read_b128 v[76:79], v6 offset:1472
    s_waitcnt lgkmcnt(8)
    v_mfma_f32_16x16x32_f16 v[116:119], v[32:35], v[84:87], v[116:119]
    v_mfma_f32_16x16x32_f16 v[120:123], v[64:67], v[84:87], v[120:123]
    ds_read_b128 v[80:83], v6 offset:1536
    s_waitcnt lgkmcnt(7)
    v_mfma_f32_16x16x32_f16 v[116:119], v[28:31], v[88:91], v[116:119]
    ds_write_b64 v124, v[112:113] offset:1280
    v_mfma_f32_16x16x32_f16 v[120:123], v[60:63], v[88:91], v[120:123]
    ds_read_b128 v[84:87], v6 offset:1600
    s_waitcnt lgkmcnt(7)
    v_mfma_f32_16x16x32_f16 v[116:119], v[24:27], v[92:95], v[116:119]
    ds_write_b64 v124, v[114:115] offset:1288
    v_mfma_f32_16x16x32_f16 v[120:123], v[56:59], v[92:95], v[120:123]
    ds_read_b128 v[88:91], v6 offset:1664
    s_waitcnt lgkmcnt(8)
    v_mfma_f32_16x16x32_f16 v[116:119], v[20:23], v[96:99], v[116:119]
    ds_write_b32 v125, v126 offset:32
    v_mfma_f32_16x16x32_f16 v[120:123], v[52:55], v[96:99], v[120:123]
    ds_read_b128 v[92:95], v6 offset:1728
    s_waitcnt lgkmcnt(9)
    v_mfma_f32_16x16x32_f16 v[116:119], v[16:19], v[100:103], v[116:119]
    v_mfma_f32_16x16x32_f16 v[120:123], v[48:51], v[100:103], v[120:123]
    ds_read_b128 v[96:99], v6 offset:1792
    s_waitcnt lgkmcnt(9)
    v_mfma_f32_16x16x32_f16 v[116:119], v[12:15], v[104:107], v[116:119]
    v_mfma_f32_16x16x32_f16 v[120:123], v[44:47], v[104:107], v[120:123]
    ds_read_b128 v[100:103], v6 offset:1856
    s_waitcnt lgkmcnt(9)
    v_mfma_f32_16x16x32_f16 v[116:119], v[8:11], v[76:79], v[116:119]
    v_mfma_f32_16x16x32_f16 v[120:123], v[40:43], v[76:79], v[120:123]
    v_mfma_f32_16x16x32_f16 v[108:111], v[72:75], v[76:79], 0
    ds_read_b128 v[104:107], v6 offset:1920
    s_waitcnt lgkmcnt(9)
    v_mfma_f32_16x16x32_f16 v[120:123], v[36:39], v[80:83], v[120:123]
    v_mfma_f32_16x16x32_f16 v[108:111], v[68:71], v[80:83], v[108:111]
    ds_read_b128 v[76:79], v6 offset:1984
    s_waitcnt lgkmcnt(8)
    v_mfma_f32_16x16x32_f16 v[120:123], v[32:35], v[84:87], v[120:123]
    v_mfma_f32_16x16x32_f16 v[108:111], v[64:67], v[84:87], v[108:111]
    s_waitcnt lgkmcnt(6)
    v_mfma_f32_16x16x32_f16 v[120:123], v[28:31], v[88:91], v[120:123]
    ds_write_b64 v124, v[116:117] offset:2560
    v_mfma_f32_16x16x32_f16 v[108:111], v[60:63], v[88:91], v[108:111]
    s_waitcnt lgkmcnt(5)
    v_mfma_f32_16x16x32_f16 v[120:123], v[24:27], v[92:95], v[120:123]
    ds_write_b64 v124, v[118:119] offset:2568
    v_mfma_f32_16x16x32_f16 v[108:111], v[56:59], v[92:95], v[108:111]
    s_waitcnt lgkmcnt(5)
    v_mfma_f32_16x16x32_f16 v[120:123], v[20:23], v[96:99], v[120:123]
    ds_write_b32 v125, v126 offset:64
    v_mfma_f32_16x16x32_f16 v[108:111], v[52:55], v[96:99], v[108:111]
    s_waitcnt lgkmcnt(5)
    v_mfma_f32_16x16x32_f16 v[120:123], v[16:19], v[100:103], v[120:123]
    v_mfma_f32_16x16x32_f16 v[108:111], v[48:51], v[100:103], v[108:111]
    s_waitcnt lgkmcnt(4)
    v_mfma_f32_16x16x32_f16 v[120:123], v[12:15], v[104:107], v[120:123]
    v_mfma_f32_16x16x32_f16 v[108:111], v[44:47], v[104:107], v[108:111]
    s_waitcnt lgkmcnt(3)
    v_mfma_f32_16x16x32_f16 v[120:123], v[8:11], v[76:79], v[120:123]
    v_mfma_f32_16x16x32_f16 v[108:111], v[40:43], v[76:79], v[108:111]
    v_mfma_f32_16x16x32_f16 v[112:115], v[72:75], v[76:79], 0
    s_nop 7
    ds_write_b64 v124, v[120:121] offset:3840
    ds_write_b64 v124, v[122:123] offset:3848
    ds_write_b32 v125, v126 offset:96
    s_mov_b32 s9, 0
SPN6:
    ds_read_b32 v128, v127 offset:240
    s_add_u32 s9, s9, 1
    s_waitcnt lgkmcnt(0)
    v_and_b32 v128, 0xffff, v128
    v_cmp_ne_u32 vcc, 34, v128
    s_cmp_ge_u32 s9, 0x40000
    s_cbranch_scc1 SPX6
    s_cbranch_vccz SPX6
    s_sleep 1
    s_branch SPN6
SPX6:
    ds_read_b32 v128, v127 offset:240
    s_waitcnt lgkmcnt(0)
    v_cmp_ne_u32 vcc, 34, v128
    s_nop 0
    s_cbranch_vccnz D_REDO
    ds_read_b128 v[80:83], v6 offset:2048
    ds_read_b128 v[84:87], v6 offset:2112
    ds_read_b128 v[88:91], v6 offset:2176
    ds_read_b128 v[92:95], v6 offset:2240
    ds_read_b128 v[96:99], v6 offset:2304
    ds_read_b128 v[100:103], v6 offset:2368
    ds_read_b128 v[104:107], v6 offset:2432
    s_waitcnt lgkmcnt(6)
    v_mfma_f32_16x16x32_f16 v[108:111], v[36:39], v[80:83], v[108:111]
    v_mfma_f32_16x16x32_f16 v[112:115], v[68:71], v[80:83], v[112:115]
    ds_read_b128 v[76:79], v6 offset:2496
    s_waitcnt lgkmcnt(6)
    v_mfma_f32_16x16x32_f16 v[108:111], v[32:35], v[84:87], v[108:111]
    v_mfma_f32_16x16x32_f16 v[112:115], v[64:67], v[84:87], v[112:115]
    ds_read_b128 v[80:83], v6 offset:2560
    s_waitcnt lgkmcnt(6)
    v_mfma_f32_16x16x32_f16 v[108:111], v[28:31], v[88:91], v[108:111]
    v_mfma_f32_16x16x32_f16 v[112:115], v[60:63], v[88:91], v[112:115]
    ds_read_b128 v[84:87], v6 offset:2624
    s_waitcnt lgkmcnt(6)
    v_mfma_f32_16x16x32_f16 v[108:111], v[24:27], v[92:95], v[108:111]
    v_mfma_f32_16x16x32_f16 v[112:115], v[56:59], v[92:95], v[112:115]
    ds_read_b128 v[88:91], v6 offset:2688
    s_waitcnt lgkmcnt(6)
    v_mfma_f32_16x16x32_f16 v[108:111], v[20:23], v[96:99], v[108:111]
    v_mfma_f32_16x16x32_f16 v[112:115], v[52:55], v[96:99], v[112:115]
    ds_read_b128 v[92:95], v6 offset:2752
    s_waitcnt lgkmcnt(6)
    v_mfma_f32_16x16x32_f16 v[108:111], v[16:19], v[100:103], v[108:111]
    v_mfma_f32_16x16x32_f16 v[112:115], v[48:51], v[100:103], v[112:115]
    ds_read_b128 v[96:99], v6 offset:2816
    s_waitcnt lgkmcnt(6)
    v_mfma_f32_16x16x32_f16 v[108:111], v[12:15], v[104:107], v[108:111]
    v_mfma_f32_16x16x32_f16 v[112:115], v[44:47], v[104:107], v[112:115]
    ds_read_b128 v[100:103], v6 offset:2880
    s_waitcnt lgkmcnt(6)
    v_mfma_f32_16x16x32_f16 v[108:111], v[8:11], v[76:79], v[108:111]
    v_mfma_f32_16x16x32_f16 v[112:115], v[40:43], v[76:79], v[112:115]
    v_mfma_f32_16x16x32_f16 v[116:119], v[72:75], v[76:79], 0
    ds_read_b128 v[104:107], v6 offset:2944
    s_waitcnt lgkmcnt(6)
    v_mfma_f32_16x16x32_f16 v[112:115], v[36:39], v[80:83], v[112:115]
    v_mfma_f32_16x16x32_f16 v[116:119], v[68:71], v[80:83], v[116:119]
    ds_read_b128 v[76:79], v6 offset:3008
    s_waitcnt lgkmcnt(6)
    v_mfma_f32_16x16x32_f16 v[112:115], v[32:35], v[84:87], v[112:115]
    v_mfma_f32_16x16x32_f16 v[116:119], v[64:67], v[84:87], v[116:119]
    ds_read_b128 v[80:83], v6 offset:3072
    s_waitcnt lgkmcnt(6)
    v_mfma_f32_16x16x32_f16 v[112:115], v[28:31], v[88:91], v[112:115]
    ds_write_b64 v124, v[108:109] offset:5120
    v_mfma_f32_16x16x32_f16 v[116:119], v[60:63], v[88:91], v[116:119]
    ds_read_b128 v[84:87], v6 offset:3136
    s_waitcnt lgkmcnt(7)
    v_mfma_f32_16x16x32_f16 v[112:115], v[24:27], v[92:95], v[112:115]
    ds_write_b64 v124, v[110:111] offset:5128
    v_mfma_f32_16x16x32_f16 v[116:119], v[56:59], v[92:95], v[116:119]
    ds_read_b128 v[88:91], v6 offset:3200
    s_waitcnt lgkmcnt(8)
    v_mfma_f32_16x16x32_f16 v[112:115], v[20:23], v[96:99], v[112:115]
    ds_write_b32 v125, v126 offset:128
    v_mfma_f32_16x16x32_f16 v[116:119], v[52:55], v[96:99], v[116:119]
    ds_read_b128 v[92:95], v6 offset:3264
    s_waitcnt lgkmcnt(9)
    v_mfma_f32_16x16x32_f16 v[112:115], v[16:19], v[100:103], v[112:115]
    v_mfma_f32_16x16x32_f16 v[116:119], v[48:51], v[100:103], v[116:119]
    ds_read_b128 v[96:99], v6 offset:3328
    s_waitcnt lgkmcnt(9)
    v_mfma_f32_16x16x32_f16 v[112:115], v[12:15], v[104:107], v[112:115]
    v_mfma_f32_16x16x32_f16 v[116:119], v[44:47], v[104:107], v[116:119]
    ds_read_b128 v[100:103], v6 offset:3392
    s_waitcnt lgkmcnt(9)
    v_mfma_f32_16x16x32_f16 v[112:115], v[8:11], v[76:79], v[112:115]
    v_mfma_f32_16x16x32_f16 v[116:119], v[40:43], v[76:79], v[116:119]
    v_mfma_f32_16x16x32_f16 v[120:123], v[72:75], v[76:79], 0
    ds_read_b128 v[104:107], v6 offset:3456
    s_waitcnt lgkmcnt(9)
    v_mfma_f32_16x16x32_f16 v[116:119], v[36:39], v[80:83], v[116:119]
    v_mfma_f32_16x16x32_f16 v[120:123], v[68:71], v[80:83], v[120:123]
    ds_read_b128 v[76:79], v6 offset:3520
    s_waitcnt lgkmcnt(8)
    v_mfma_f32_16x16x32_f16 v[116:119], v[32:35], v[84:87], v[116:119]
    v_mfma_f32_16x16x32_f16 v[120:123], v[64:67], v[84:87], v[120:123]
    ds_read_b128 v[80:83], v6 offset:3584
    s_waitcnt lgkmcnt(7)
    v_mfma_f32_16x16x32_f16 v[116:119], v[28:31], v[88:91], v[116:119]
    ds_write_b64 v124, v[112:113] offset:6400
    v_mfma_f32_16x16x32_f16 v[120:123], v[60:63], v[88:91], v[120:123]
    ds_read_b128 v[84:87], v6 offset:3648
    s_waitcnt lgkmcnt(7)
    v_mfma_f32_16x16x32_f16 v[116:119], v[24:27], v[92:95], v[116:119]
    ds_write_b64 v124, v[114:115] offset:6408
    v_mfma_f32_16x16x32_f16 v[120:123], v[56:59], v[92:95], v[120:123]
    ds_read_b128 v[88:91], v6 offset:3712
    s_waitcnt lgkmcnt(8)
    v_mfma_f32_16x16x32_f16 v[116:119], v[20:23], v[96:99], v[116:119]
    ds_write_b32 v125, v126 offset:160
    v_mfma_f32_16x16x32_f16 v[120:123], v[52:55], v[96:99], v[120:123]
    ds_read_b128 v[92:95], v6 offset:3776
    s_waitcnt lgkmcnt(9)
    v_mfma_f32_16x16x32_f16 v[116:119], v[16:19], v[100:103], v[116:119]
    v_mfma_f32_16x16x32_f16 v[120:123], v[48:51], v[100:103], v[120:123]
    ds_read_b128 v[96:99], v6 offset:3840
    s_waitcnt lgkmcnt(9)
    v_mfma_f32_16x16x32_f16 v[116:119], v[12:15], v[104:107], v[116:119]
    v_mfma_f32_16x16x32_f16 v[120:123], v[44:47], v[104:107], v[120:123]
    ds_read_b128 v[100:103], v6 offset:3904
    s_waitcnt lgkmcnt(9)
    v_mfma_f32_16x16x32_f16 v[116:119], v[8:11], v[76:79], v[116:119]
    v_mfma_f32_16x16x32_f16 v[120:123], v[40:43], v[76:79], v[120:123]
    ds_read_b128 v[104:107], v6 offset:3968
    s_waitcnt lgkmcnt(9)
    v_mfma_f32_16x16x32_f16 v[120:123], v[36:39], v[80:83], v[120:123]
    ds_read_b128 v[76:79], v6 offset:4032
    s_waitcnt lgkmcnt(8)
    v_mfma_f32_16x16x32_f16 v[120:123], v[32:35], v[84:87], v[120:123]
    s_waitcnt lgkmcnt(6)
    v_mfma_f32_16x16x32_f16 v[120:123], v[28:31], v[88:91], v[120:123]
    s_waitcnt lgkmcnt(4)
    v_mfma_f32_16x16x32_f16 v[120:123], v[24:27], v[92:95], v[120:123]
    s_waitcnt lgkmcnt(3)
    v_mfma_f32_16x16x32_f16 v[120:123], v[20:23], v[96:99], v[120:123]
    ds_write_b64 v124, v[116:117] offset:7680
    s_waitcnt lgkmcnt(3)
    v_mfma_f32_16x16x32_f16 v[120:123], v[16:19], v[100:103], v[120:123]
    ds_write_b64 v124, v[118:119] offset:7688
    s_waitcnt lgkmcnt(3)
    v_mfma_f32_16x16x32_f16 v[120:123], v[12:15], v[104:107], v[120:123]
    ds_write_b32 v125, v126 offset:192
    s_waitcnt lgkmcnt(3)
    v_mfma_f32_16x16x32_f16 v[120:123], v[8:11], v[76:79], v[120:123]
    s_nop 7
    ds_write_b64 v124, v[120:121] offset:8960
    ds_write_b64 v124, v[122:123] offset:8968
    ds_write_b32 v125, v126 offset:224
    s_waitcnt lgkmcnt(0)
    s_endpgm
D_REDO:
    s_barrier
    s_barrier
    s_branch D_PASS
CK_T1:
    ds_read_b128 v[8:11], v128 offset:43296
    ds_read_b128 v[40:43], v128 offset:16896
    ds_read_b128 v[12:15], v128 offset:43360
    ds_read_b128 v[44:47], v128 offset:16960
    ds_read_b128 v[16:19], v128 offset:43424
    ds_read_b128 v[48:51], v128 offset:17024
    ds_read_b128 v[20:23], v128 offset:43488
    ds_read_b128 v[52:55], v128 offset:17088
    ds_read_b128 v[24:27], v128 offset:43552
    ds_read_b128 v[56:59], v128 offset:17152
    ds_read_b128 v[28:31], v128 offset:43616
    ds_read_b128 v[60:63], v128 offset:17216
    ds_read_b128 v[32:35], v128 offset:43680
    ds_read_b128 v[64:67], v128 offset:17280
    ds_read_b128 v[36:39], v128 offset:43744
    ds_read_b128 v[68:71], v128 offset:17344
    v_lshlrev_b32 v114, 8, v4
    v_lshl_add_u32 v114, v3, 4, v114
    v_add_u32 v114, s13, v114
    v_lshlrev_b32 v115, 7, v4
    v_lshl_add_u32 v115, v3, 2, v115
    v_add_u32 v115, s13, v115
    s_waitcnt lgkmcnt(14)
    v_mfma_f32_16x16x32_f16 v[104:107], v[40:43], v[8:11], 0
    s_waitcnt lgkmcnt(12)
    v_mfma_f32_16x16x32_f16 v[104:107], v[44:47], v[12:15], v[104:107]
    s_waitcnt lgkmcnt(10)
    v_mfma_f32_16x16x32_f16 v[104:107], v[48:51], v[16:19], v[104:107]
    s_waitcnt lgkmcnt(8)
    v_mfma_f32_16x16x32_f16 v[104:107], v[52:55], v[20:23], v[104:107]
    s_waitcnt lgkmcnt(6)
    v_mfma_f32_16x16x32_f16 v[104:107], v[56:59], v[24:27], v[104:107]
    s_waitcnt lgkmcnt(4)
    v_mfma_f32_16x16x32_f16 v[104:107], v[60:63], v[28:31], v[104:107]
    s_waitcnt lgkmcnt(2)
    v_mfma_f32_16x16x32_f16 v[104:107], v[64:67], v[32:35], v[104:107]
    s_waitcnt lgkmcnt(0)
    v_mfma_f32_16x16x32_f16 v[104:107], v[68:71], v[36:39], v[104:107]
    s_nop 7
    v_cvt_pk_f16_f32 v116, v104, v105
    v_cvt_pk_f16_f32 v117, v105, v105
    v_cvt_pk_f16_f32 v118, v106, v107
    v_cvt_pk_f16_f32 v119, v107, v107
    v_cvt_pk_f16_f32 v120, v105, v106
    s_mov_b32 exec_hi, 0
    ds_write_b16 v114, v119 offset:560
    v_add_u32 v121, 1728, v114
    ds_write_b128 v114, v[116:119] offset:544
    ds_write2_b32 v121, v119, v119 offset0:11 offset1:12
    ds_write2_b32 v121, v117, v120 offset0:9 offset1:10
    ds_write_b16 v121, v116 offset:34
    s_not_b64 exec, exec
    ds_write_b32 v115, v116 offset:2208
    ds_write_b32 v115, v118 offset:2272
    s_mov_b64 exec, -1
    v_mov_b32 v167, 153600
    v_mov_b32 v166, 1
    s_lshl_b32 s8, s7, 2
    v_add_u32 v131, s8, v167
    s_mov_b64 exec, 1
    ds_add_u32 v131, v166 offset:80
    ds_add_u32 v167, v166 offset:76
    s_mov_b64 exec, -1
    v_mul_u32_u24 v164, 320, v4
    v_lshl_add_u32 v164, v3, 4, v164
    s_mul_i32 s8, s7, 20480
    v_add_u32 v164, s8, v164
    s_lshl_b32 s8, s3, 2
    s_add_u32 s8, s8, 153856
    v_mov_b32 v165, s8
    v_lshlrev_b32 v5, 2, v4
    v_sub_u32 v5, v3, v5
    v_lshl_add_u32 v7, v5, 2, s13
    v_lshl_add_u32 v5, v5, 3, s13
    v_add_u32 v7, 2848, v7
    v_mov_b32 v6, s13
    s_mov_b32 s9, 0
SPN7:
    ds_read_b32 v128, v131 offset:80
    s_add_u32 s9, s9, 1
    s_waitcnt lgkmcnt(0)
    v_cmp_ne_u32 vcc, 2, v128
    s_cmp_ge_u32 s9, 0x40000
    s_cbranch_scc1 SPX7
    s_cbranch_vccz SPX7
    s_sleep 1
    s_branch SPN7
SPX7:
    ds_read_b32 v130, v6 offset:2716
    ds_read_b64 v[8:9], v5 offset:2464
    ds_read_b64 v[10:11], v5 offset:2456
    ds_read_b64 v[12:13], v5 offset:2448
    ds_read_b64 v[14:15], v5 offset:2440
    ds_read_b64 v[16:17], v5 offset:2592
    ds_read_b64 v[18:19], v5 offset:2584
    ds_read_b64 v[20:21], v5 offset:2576
    ds_read_b64 v[22:23], v5 offset:2568
    ds_read_b64 v[24:25], v5 offset:2720
    ds_read_b64 v[26:27], v5 offset:2712
    ds_read_b64 v[28:29], v5 offset:2704
    ds_read_b64 v[30:31], v5 offset:2696
    ds_read2_b32 v[32:33], v7 offset0:16 offset1:15
    ds_read2_b32 v[34:35], v7 offset0:14 offset1:13
    ds_read2_b32 v[36:37], v7 offset0:32 offset1:31
    ds_read2_b32 v[38:39], v7 offset0:30 offset1:29
    ds_read2_b32 v[40:41], v7 offset0:48 offset1:47
    ds_read2_b32 v[42:43], v7 offset0:46 offset1:45
    ds_read2_b32 v[44:45], v7 offset0:64 offset1:63
    ds_read2_b32 v[46:47], v7 offset0:62 offset1:61
    v_lshlrev_b32 v6, 4, v4
    v_lshl_add_u32 v6, v3, 5, v6
    v_add_u32 v6, 4048, v6
    v_add_u32 v6, s13, v6
    v_lshlrev_b32 v5, 4, v2
    v_add_u32 v5, 154112, v5
    s_mov_b32 s9, 0
SPN8:
    ds_read_b32 v128, v167 offset:76
    s_add_u32 s9, s9, 1
    s_waitcnt lgkmcnt(0)
    v_cmp_ne_u32 vcc, 12, v128
    s_cmp_ge_u32 s9, 0x40000
    s_cbranch_scc1 SPX8
    s_cbranch_vccz SPX8
    s_sleep 1
    s_branch SPN8
SPX8:
    ds_read_b128 v[140:143], v5 offset:0
    ds_read_b128 v[144:147], v5 offset:1024
    ds_read_b128 v[148:151], v5 offset:2048
    ds_read_b128 v[152:155], v5 offset:3072
    ds_read_b128 v[156:159], v5 offset:4096
Z_PASS:
    ds_write_b128 v164, v[124:127] offset:10240
    ds_write_b32 v165, v166 offset:0
    ds_write_b128 v164, v[124:127] offset:11520
    ds_write_b32 v165, v166 offset:32
    s_mov_b32 s8, 0x07060706
    s_mov_b32 s9, 0
SPN9:
    ds_read_b32 v128, v167 offset:240
    s_add_u32 s9, s9, 1
    s_waitcnt lgkmcnt(0)
    v_and_b32 v128, 15, v128
    v_cmp_ne_u32 vcc, 2, v128
    s_cmp_ge_u32 s9, 0x40000
    s_cbranch_scc1 SPX9
    s_cbranch_vccz SPX9
    s_sleep 1
    s_branch SPN9
SPX9:
    v_perm_b32 v130, v130, v130, s8
Z_LOOP:
    ds_read_b128 v[48:51], v6 offset:16
    ds_read_b128 v[52:55], v6 offset:0
    ds_read_b128 v[56:59], v6 offset:528
    ds_read_b128 v[60:63], v6 offset:512
    v_and_b32 v156, v130, v156
    v_and_b32 v157, v130, v157
    v_and_b32 v158, v130, v158
    v_and_b32 v159, v130, v159
    s_waitcnt lgkmcnt(2)
    v_mfma_f32_16x16x32_f16 v[64:67], v[48:51], v[140:143], 0
    v_mfma_f32_16x16x32_f16 v[68:71], v[48:51], v[144:147], 0
    v_mfma_f32_16x16x32_f16 v[72:75], v[52:55], v[140:143], 0
    v_mfma_f32_16x16x32_f16 v[76:79], v[52:55], v[144:147], 0
    v_mfma_f32_16x16x32_f16 v[80:83], v[48:51], v[148:151], 0
    v_mfma_f32_16x16x32_f16 v[84:87], v[52:55], v[152:155], 0
    s_nop 3
    v_cvt_pk_f16_f32 v88, v64, v68
    v_cvt_pk_f16_f32 v90, v65, v69
    v_cvt_pk_f16_f32 v92, v66, v70
    v_cvt_pk_f16_f32 v94, v67, v71
    v_cvt_pk_f16_f32 v89, v72, v76
    v_cvt_pk_f16_f32 v91, v73, v77
    v_cvt_pk_f16_f32 v93, v74, v78
    v_cvt_pk_f16_f32 v95, v75, v79
    v_cvt_pk_f16_f32 v96, v80, v84
    v_cvt_pk_f16_f32 v97, v81, v85
    v_cvt_pk_f16_f32 v98, v82, v86
    v_cvt_pk_f16_f32 v99, v83, v87
    s_waitcnt lgkmcnt(0)
    v_mfma_f32_16x16x32_f16 v[64:67], v[56:59], v[140:143], 0
    v_mfma_f32_16x16x32_f16 v[68:71], v[56:59], v[144:147], 0
    v_mfma_f32_16x16x32_f16 v[72:75], v[60:63], v[140:143], 0
    v_mfma_f32_16x16x32_f16 v[76:79], v[60:63], v[144:147], 0
    v_mfma_f32_16x16x32_f16 v[80:83], v[56:59], v[148:151], 0
    v_mfma_f32_16x16x32_f16 v[84:87], v[60:63], v[152:155], 0
    v_mfma_f32_16x16x32_f16 v[108:111], v[156:159], v[48:51], 0
    ds_read_b128 v[48:51], v6 offset:1040
    ds_read_b128 v[52:55], v6 offset:1024
    v_mfma_f32_16x16x32_f16 v[100:103], v[88:91], v[8:11], 0
    v_mfma_f32_16x16x32_f16 v[100:103], v[92:95], v[12:15], v[100:103]
    v_cvt_pk_f16_f32 v132, v64, v68
    v_cvt_pk_f16_f32 v134, v65, v69
    v_mfma_f32_16x16x32_f16 v[104:107], v[88:91], v[16:19], 0
    v_cvt_pk_f16_f32 v136, v66, v70
    v_cvt_pk_f16_f32 v138, v67, v71
    v_mfma_f32_16x16x32_f16 v[104:107], v[92:95], v[20:23], v[104:107]
    v_cvt_pk_f16_f32 v133, v72, v76
    v_cvt_pk_f16_f32 v135, v73, v77
    v_mfma_f32_16x16x32_f16 v[108:111], v[88:91], v[24:27], v[108:111]
    v_cvt_pk_f16_f32 v137, v74, v78
    v_cvt_pk_f16_f32 v139, v75, v79
    v_mfma_f32_16x16x32_f16 v[108:111], v[92:95], v[28:31], v[108:111]
    v_cvt_pk_f16_f32 v160, v80, v84
    v_cvt_pk_f16_f32 v161, v81, v85
    v_mfma_f32_16x16x32_f16 v[108:111], v[96:99], v[32:35], v[108:111]
    v_cvt_pk_f16_f32 v162, v82, v86
    v_cvt_pk_f16_f32 v163, v83, v87
    v_mfma_f32_16x16x32_f16 v[112:115], v[96:99], v[36:39], 0
    v_mfma_f32_16x16x32_f16 v[116:119], v[96:99], v[40:43], 0
    v_mfma_f32_16x16x32_f16 v[120:123], v[96:99], v[44:47], 0
    s_waitcnt lgkmcnt(0)
    v_mfma_f32_16x16x32_f16 v[64:67], v[48:51], v[140:143], 0
    v_mfma_f32_16x16x32_f16 v[68:71], v[48:51], v[144:147], 0
    ds_write_b64 v164, v[100:101] offset:12800
    v_mfma_f32_16x16x32_f16 v[72:75], v[52:55], v[140:143], 0
    ds_write_b64 v164, v[102:103] offset:12808
    v_mfma_f32_16x16x32_f16 v[76:79], v[52:55], v[144:147], 0
    ds_write_b32 v165, v166 offset:64
    v_mfma_f32_16x16x32_f16 v[80:83], v[48:51], v[148:151], 0
    v_mfma_f32_16x16x32_f16 v[84:87], v[52:55], v[152:155], 0
    v_mfma_f32_16x16x32_f16 v[112:115], v[156:159], v[56:59], v[112:115]
    ds_read_b128 v[56:59], v6 offset:1552
    ds_read_b128 v[60:63], v6 offset:1536
    v_mfma_f32_16x16x32_f16 v[104:107], v[132:135], v[8:11], v[104:107]
    v_mfma_f32_16x16x32_f16 v[104:107], v[136:139], v[12:15], v[104:107]
    v_cvt_pk_f16_f32 v88, v64, v68
    v_cvt_pk_f16_f32 v90, v65, v69
    v_mfma_f32_16x16x32_f16 v[108:111], v[132:135], v[16:19], v[108:111]
    v_cvt_pk_f16_f32 v92, v66, v70
    v_cvt_pk_f16_f32 v94, v67, v71
    v_mfma_f32_16x16x32_f16 v[108:111], v[136:139], v[20:23], v[108:111]
    v_cvt_pk_f16_f32 v89, v72, v76
    v_cvt_pk_f16_f32 v91, v73, v77
    v_mfma_f32_16x16x32_f16 v[112:115], v[132:135], v[24:27], v[112:115]
    v_cvt_pk_f16_f32 v93, v74, v78
    v_cvt_pk_f16_f32 v95, v75, v79
    v_mfma_f32_16x16x32_f16 v[112:115], v[136:139], v[28:31], v[112:115]
    v_cvt_pk_f16_f32 v96, v80, v84
    v_cvt_pk_f16_f32 v97, v81, v85
    v_mfma_f32_16x16x32_f16 v[112:115], v[160:163], v[32:35], v[112:115]
    v_cvt_pk_f16_f32 v98, v82, v86
    v_cvt_pk_f16_f32 v99, v83, v87
    v_mfma_f32_16x16x32_f16 v[116:119], v[160:163], v[36:39], v[116:119]
    v_mfma_f32_16x16x32_f16 v[120:123], v[160:163], v[40:43], v[120:123]
    s_waitcnt lgkmcnt(0)
    v_mfma_f32_16x16x32_f16 v[64:67], v[56:59], v[140:143], 0
    v_mfma_f32_16x16x32_f16 v[68:71], v[56:59], v[144:147], 0
    ds_write_b64 v164, v[104:105] offset:14080
    v_mfma_f32_16x16x32_f16 v[72:75], v[60:63], v[140:143], 0
    ds_write_b64 v164, v[106:107] offset:14088
    v_mfma_f32_16x16x32_f16 v[76:79], v[60:63], v[144:147], 0
    ds_write_b32 v165, v166 offset:96
    v_mfma_f32_16x16x32_f16 v[80:83], v[56:59], v[148:151], 0
    v_mfma_f32_16x16x32_f16 v[84:87], v[60:63], v[152:155], 0
    v_mfma_f32_16x16x32_f16 v[116:119], v[156:159], v[48:51], v[116:119]
    v_mfma_f32_16x16x32_f16 v[108:111], v[88:91], v[8:11], v[108:111]
    v_mfma_f32_16x16x32_f16 v[108:111], v[92:95], v[12:15], v[108:111]
    v_mfma_f32_16x16x32_f16 v[112:115], v[88:91], v[16:19], v[112:115]
    v_cvt_pk_f16_f32 v132, v64, v68
    v_cvt_pk_f16_f32 v134, v65, v69
    v_mfma_f32_16x16x32_f16 v[112:115], v[92:95], v[20:23], v[112:115]
    v_cvt_pk_f16_f32 v136, v66, v70
    v_cvt_pk_f16_f32 v138, v67, v71
    v_mfma_f32_16x16x32_f16 v[116:119], v[88:91], v[24:27], v[116:119]
    v_cvt_pk_f16_f32 v133, v72, v76
    v_cvt_pk_f16_f32 v135, v73, v77
    v_mfma_f32_16x16x32_f16 v[116:119], v[92:95], v[28:31], v[116:119]
    v_cvt_pk_f16_f32 v137, v74, v78
    v_cvt_pk_f16_f32 v139, v75, v79
    v_mfma_f32_16x16x32_f16 v[116:119], v[96:99], v[32:35], v[116:119]
    v_cvt_pk_f16_f32 v160, v80, v84
    v_cvt_pk_f16_f32 v161, v81, v85
    v_mfma_f32_16x16x32_f16 v[120:123], v[96:99], v[36:39], v[120:123]
    v_cvt_pk_f16_f32 v162, v82, v86
    v_cvt_pk_f16_f32 v163, v83, v87
    s_nop 1
    v_mfma_f32_16x16x32_f16 v[120:123], v[156:159], v[56:59], v[120:123]
    ds_write_b64 v164, v[108:109] offset:15360
    v_mfma_f32_16x16x32_f16 v[112:115], v[132:135], v[8:11], v[112:115]
    ds_write_b64 v164, v[110:111] offset:15368
    v_mfma_f32_16x16x32_f16 v[112:115], v[136:139], v[12:15], v[112:115]
    ds_write_b32 v165, v166 offset:128
    v_mfma_f32_16x16x32_f16 v[116:119], v[132:135], v[16:19], v[116:119]
    v_mfma_f32_16x16x32_f16 v[116:119], v[136:139], v[20:23], v[116:119]
    v_mfma_f32_16x16x32_f16 v[120:123], v[132:135], v[24:27], v[120:123]
    v_mfma_f32_16x16x32_f16 v[120:123], v[136:139], v[28:31], v[120:123]
    v_mfma_f32_16x16x32_f16 v[120:123], v[160:163], v[32:35], v[120:123]
    s_mov_b32 s9, 0
SPN10:
    ds_read_b32 v128, v167 offset:240
    s_add_u32 s9, s9, 1
    s_waitcnt lgkmcnt(0)
    v_and_b32 v128, 0xffff, v128
    v_cmp_ne_u32 vcc, 34, v128
    s_cmp_ge_u32 s9, 0x40000
    s_cbranch_scc1 SPX10
    s_cbranch_vccz SPX10
    s_sleep 1
    s_branch SPN10
SPX10:
    ds_read_b32 v128, v167 offset:240
    s_waitcnt lgkmcnt(0)
    v_cmp_ne_u32 vcc, 34, v128
    s_nop 0
    s_cbranch_vccnz Z_REDO
    s_cmp_lg_u32 s3, 4
    s_cbranch_scc1 Z_NOSEL
    v_and_b32 v126, 4, v2
    v_add_u32 v126, v126, v4
    s_lshl_b32 s9, s4, 8
    v_lshl_add_u32 v126, v126, 3, s9
    global_load_dwordx2 v[124:125], v126, s[50:51] offset:256 sc1
    s_lshl_b32 s9, s4, 7
    v_mov_b32 v126, s9
    global_load_dword v127, v126, s[50:51] offset:2304 sc1
Z_NOSEL:
    ds_read_b128 v[48:51], v6 offset:2064
    ds_read_b128 v[52:55], v6 offset:2048
    ds_read_b128 v[56:59], v6 offset:2576
    ds_read_b128 v[60:63], v6 offset:2560
    ds_write_b64 v164, v[112:113] offset:16640
    ds_write_b64 v164, v[114:115] offset:16648
    ds_write_b32 v165, v166 offset:160
    s_waitcnt lgkmcnt(5)
    v_mfma_f32_16x16x32_f16 v[64:67], v[48:51], v[140:143], 0
    v_mfma_f32_16x16x32_f16 v[68:71], v[48:51], v[144:147], 0
    v_mfma_f32_16x16x32_f16 v[72:75], v[52:55], v[140:143], 0
    v_mfma_f32_16x16x32_f16 v[76:79], v[52:55], v[144:147], 0
    s_nop 5
    v_cvt_pk_f16_f32 v88, v64, v68
    v_cvt_pk_f16_f32 v90, v65, v69
    v_cvt_pk_f16_f32 v92, v66, v70
    v_cvt_pk_f16_f32 v94, v67, v71
    v_cvt_pk_f16_f32 v89, v72, v76
    v_cvt_pk_f16_f32 v91, v73, v77
    v_cvt_pk_f16_f32 v93, v74, v78
    v_cvt_pk_f16_f32 v95, v75, v79
    s_waitcnt lgkmcnt(3)
    v_mfma_f32_16x16x32_f16 v[64:67], v[56:59], v[140:143], 0
    v_mfma_f32_16x16x32_f16 v[68:71], v[56:59], v[144:147], 0
    v_mfma_f32_16x16x32_f16 v[72:75], v[60:63], v[140:143], 0
    v_mfma_f32_16x16x32_f16 v[76:79], v[60:63], v[144:147], 0
    v_mfma_f32_16x16x32_f16 v[116:119], v[88:91], v[8:11], v[116:119]
    v_mfma_f32_16x16x32_f16 v[116:119], v[92:95], v[12:15], v[116:119]
    v_mfma_f32_16x16x32_f16 v[120:123], v[88:91], v[16:19], v[120:123]
    v_mfma_f32_16x16x32_f16 v[120:123], v[92:95], v[20:23], v[120:123]
    s_nop 1
    v_cvt_pk_f16_f32 v132, v64, v68
    v_cvt_pk_f16_f32 v134, v65, v69
    v_cvt_pk_f16_f32 v136, v66, v70
    v_cvt_pk_f16_f32 v138, v67, v71
    v_cvt_pk_f16_f32 v133, v72, v76
    v_cvt_pk_f16_f32 v135, v73, v77
    v_cvt_pk_f16_f32 v137, v74, v78
    v_cvt_pk_f16_f32 v139, v75, v79
    ds_write_b64 v164, v[116:117] offset:17920
    ds_write_b64 v164, v[118:119] offset:17928
    v_mfma_f32_16x16x32_f16 v[120:123], v[132:135], v[8:11], v[120:123]
    v_mfma_f32_16x16x32_f16 v[120:123], v[136:139], v[12:15], v[120:123]
    ds_write_b32 v165, v166 offset:192
    s_nop 6
    ds_write_b64 v164, v[120:121] offset:19200
    ds_write_b64 v164, v[122:123] offset:19208
    ds_write_b32 v165, v166 offset:224
    s_setprio 0
    s_cmp_eq_u32 s3, 4
    s_cbranch_scc1 FINAL
    s_waitcnt lgkmcnt(0)
    s_endpgm
Z_REDO:
    s_barrier
    s_barrier
    s_branch Z_PASS
CU_C3A:
    s_cmp_eq_u32 s4, 3
    s_cselect_b32 s8, 18, 3
    s_cmp_ge_u32 s101, s8
    s_cbranch_scc1 CU_C3B
    s_sub_u32 s14, 3, s4
    s_and_b32 s14, s14, 7
    s_and_b32 s8, s101, 1
    s_lshl_b32 s8, s8, 3
    s_lshr_b32 s9, s101, 1
    s_cmp_eq_u32 s4, 3
    s_cselect_b32 s14, s8, s14
    s_cselect_b32 s9, s9, s101
    s_add_u32 s9, s9, 2
    s_min_u32 s9, s9, 17
    s_mul_i32 s9, s9, 9
    s_add_u32 s14, s14, s9
    v_mul_u32_u24 v140, 9216, v2
    s_mul_i32 s8, s4, 1152
    v_add_u32 v140, s8, v140
    s_mul_i32 s8, s14, 7282
    s_lshr_b32 s8, s8, 16
    s_mul_i32 s9, s8, 9
    s_sub_u32 s9, s14, s9
    s_lshl_b32 s9, s9, 7
    s_bitcmp1_b32 s8, 0
    s_cselect_b32 s12, s40, s38
    s_cselect_b32 s13, s41, s39
    s_lshr_b32 s8, s8, 1
    s_add_u32 s8, s8, 0
    s_mul_i32 s8, s8, 589824
    s_add_u32 s8, s8, s9
    v_add_u32 v148, s8, v140
    global_load_dword v149, v148, s[12:13]
    s_lshl_b32 s9, s6, 3
    s_branch CU_C3B
CU_C3:
    s_cmp_eq_u32 s4, 3
    s_cselect_b32 s8, 18, 3
    s_add_u32 s10, s10, s8
    s_sub_u32 s14, 3, s4
    s_and_b32 s14, s14, 7
    s_and_b32 s8, s10, 1
    s_lshl_b32 s8, s8, 3
    s_lshr_b32 s9, s10, 1
    s_cmp_eq_u32 s4, 3
    s_cselect_b32 s14, s8, s14
    s_cselect_b32 s9, s9, s10
    s_add_u32 s9, s9, 2
    s_min_u32 s9, s9, 17
    s_mul_i32 s9, s9, 9
    s_add_u32 s14, s14, s9
    v_mul_u32_u24 v140, 9216, v2
    s_mul_i32 s8, s4, 1152
    v_add_u32 v140, s8, v140
    s_mul_i32 s8, s14, 7282
    s_lshr_b32 s8, s8, 16
    s_mul_i32 s9, s8, 9
    s_sub_u32 s9, s14, s9
    s_lshl_b32 s9, s9, 7
    s_bitcmp1_b32 s8, 0
    s_cselect_b32 s12, s40, s38
    s_cselect_b32 s13, s41, s39
    s_lshr_b32 s8, s8, 1
    s_add_u32 s8, s8, 0
    s_mul_i32 s8, s8, 589824
    s_add_u32 s8, s8, s9
    v_add_u32 v148, s8, v140
    global_load_dword v149, v148, s[12:13]
    s_lshl_b32 s9, s6, 3
    s_branch CU_C3X
CU_MID:
    s_min_u32 s13, s7, 2
    s_mov_b32 s12, 0
SPN11:
    ds_read_b32 v56, v57 offset:64
    s_add_u32 s12, s12, 1
    s_waitcnt lgkmcnt(0)
    v_cmp_gt_u32 vcc, s13, v56
    s_cmp_ge_u32 s12, 0x40000
    s_cbranch_scc1 SPX11
    s_cbranch_vccz SPX11
    s_sleep 2
    s_branch SPN11
SPX11:
    s_branch CU_LD
CU_PRE:
    v_mov_b32 v139, 1
    v_lshlrev_b32 v74, 3, v4
    v_sub_u32 v74, v74, v3
    v_and_b32 v74, 0xffff, v74
    v_lshl_or_b32 v74, v74, 16, v74
    v_mov_b32 v75, 0x3c003c00
    s_mul_i32 s8, s7, 0x20002
    s_add_u32 s8, s8, 0xfff0fff1
    v_pk_add_u16 v76, v74, s8
    v_pk_add_u16 v80, v76, 2 op_sel_hi:[1,0]
    v_pk_ashrrev_i16 v80, 15, v80 op_sel_hi:[0,1]
    v_pk_add_u16 v81, v76, 3 op_sel_hi:[1,0]
    v_pk_ashrrev_i16 v81, 15, v81 op_sel_hi:[0,1]
    v_pk_add_u16 v82, v76, 4 op_sel_hi:[1,0]
    v_pk_ashrrev_i16 v82, 15, v82 op_sel_hi:[0,1]
    v_pk_add_u16 v83, v76, 5 op_sel_hi:[1,0]
    v_pk_ashrrev_i16 v83, 15, v83 op_sel_hi:[0,1]
    v_pk_add_u16 v84, v76, 10 op_sel_hi:[1,0]
    v_pk_ashrrev_i16 v84, 15, v84 op_sel_hi:[0,1]
    v_pk_add_u16 v85, v76, 11 op_sel_hi:[1,0]
    v_pk_ashrrev_i16 v85, 15, v85 op_sel_hi:[0,1]
    v_pk_add_u16 v86, v76, 12 op_sel_hi:[1,0]
    v_pk_ashrrev_i16 v86, 15, v86 op_sel_hi:[0,1]
    s_lshl_b32 s8, s7, 2
    s_add_u32 s8, s8, 154112
    v_lshl_add_u32 v74, v2, 4, s8
    v_bitop3_b32 v88, v80, v83, v75 bitop3:0x28
    ds_write_b32 v74, v88 offset:0
    v_bitop3_b32 v89, v83, v84, v75 bitop3:0x28
    ds_write_b32 v74, v89 offset:1024
    v_bitop3_b32 v90, v82, v85, v75 bitop3:0x28
    ds_write_b32 v74, v90 offset:2048
    v_bitop3_b32 v91, v81, v86, v75 bitop3:0x28
    ds_write_b32 v74, v91 offset:3072
    v_xor_b32 v92, v80, v82
    ds_write_b32 v74, v92 offset:4096
    s_mov_b64 exec, 1
    ds_add_u32 v57, v139 offset:76
    s_mov_b64 exec, -1
    s_mov_b32 s72, s15
    v_lshrrev_b32 v158, 2, v2
    v_mul_u32_u24 v158, 128, v158
    v_and_b32 v137, 3, v2
    v_lshl_add_u32 v158, v137, 4, v158
    v_lshrrev_b32 v138, 1, v2
    v_mul_u32_u24 v138, 128, v138
    v_and_b32 v137, 1, v2
    v_lshl_add_u32 v138, v137, 4, v138
    v_add_u32 v138, 10304, v138
    s_mul_i32 s8, s15, 2048
    s_add_u32 s8, s8, 20480
    v_add_u32 v158, s8, v158
    v_add_u32 v137, 12288, v158
    v_add_u32 v138, 20480, v138
    s_cmp_eq_u32 s7, 1
    s_cselect_b64 vcc, -1, 0
    v_cndmask_b32 v138, v137, v138, vcc
    v_and_b32 v146, 3, v2
    v_mul_u32_u24 v159, 320, v146
    v_lshl_add_u32 v146, v146, 2, v57
    v_lshrrev_b32 v136, 2, v2
    v_lshl_add_u32 v159, v136, 4, v159
    s_mul_i32 s8, s72, 1280
    v_add_u32 v159, s8, v159
    v_add_u32 v136, 40960, v159
    v_and_b32 v141, 7, v2
    s_lshl_b32 s8, s72, 5
    s_add_u32 s8, s8, 153856
    v_lshl_add_u32 v141, v141, 2, s8
    s_lshl_b32 s8, s72, 10
    v_lshl_add_u32 v147, v2, 4, s8
    v_lshlrev_b32 v142, 1, v147
    v_add_u32 v147, 98304, v147
    v_add_u32 v142, 81920, v142
    s_lshl_b32 s8, s72, 9
    s_add_u32 s8, s8, 124928
    v_lshl_add_u32 v58, v2, 3, s8
    s_mov_b32 s73, 0x45800000
    s_mov_b32 s74, 2
    s_waitcnt lgkmcnt(0)
    v_lshlrev_b32 v154, 16, s52
    v_mov_b32 v155, s52
    v_lshlrev_b32 v156, 16, s53
    v_mov_b32 v157, s53
    v_and_b32 v155, 0xffff0000, v155
    v_and_b32 v157, 0xffff0000, v157
    v_add_f32 v154, -1.0, v154
    v_add_f32 v155, -1.0, v155
    v_add_f32 v156, -1.0, v156
    v_add_f32 v157, -1.0, v157
    s_waitcnt vmcnt(0)
    s_branch CU_PREX
CU_MAIN:
    s_mov_b64 exec, 1
    ds_add_u32 v57, v139 offset:64
    s_mov_b64 exec, -1
    s_setprio 3
    s_mov_b32 s75, s7
    s_cmp_lg_u32 s7, 0
    s_cbranch_scc1 CU_PASS
    s_waitcnt vmcnt(7)
    v_lshlrev_b32 v24, 16, v8
    v_and_b32 v28, 0xffff0000, v8
    v_lshlrev_b32 v32, 16, v9
    v_and_b32 v36, 0xffff0000, v9
    s_waitcnt vmcnt(6)
    v_lshlrev_b32 v25, 16, v10
    v_and_b32 v29, 0xffff0000, v10
    v_lshlrev_b32 v33, 16, v11
    v_and_b32 v37, 0xffff0000, v11
    s_waitcnt vmcnt(5)
    v_lshlrev_b32 v26, 16, v12
    v_and_b32 v30, 0xffff0000, v12
    v_lshlrev_b32 v34, 16, v13
    v_and_b32 v38, 0xffff0000, v13
    s_waitcnt vmcnt(4)
    v_lshlrev_b32 v27, 16, v14
    v_and_b32 v31, 0xffff0000, v14
    v_lshlrev_b32 v35, 16, v15
    v_and_b32 v39, 0xffff0000, v15
    v_max3_f32 v78, |v24|, |v25|, 0
    v_max3_f32 v79, |v28|, |v29|, 0
    v_max3_f32 v80, |v32|, |v33|, 0
    v_max3_f32 v81, |v36|, |v37|, 0
    v_max3_f32 v78, |v26|, |v27|, v78
    v_max3_f32 v79, |v30|, |v31|, v79
    v_max3_f32 v80, |v34|, |v35|, v80
    v_max3_f32 v81, |v38|, |v39|, v81
    v_max_u32_dpp v78, v78, v78 row_ror:4 row_mask:0xf bank_mask:0xf
    v_max_u32_dpp v79, v79, v79 row_ror:4 row_mask:0xf bank_mask:0xf
    v_max_u32_dpp v80, v80, v80 row_ror:4 row_mask:0xf bank_mask:0xf
    v_max_u32_dpp v81, v81, v81 row_ror:4 row_mask:0xf bank_mask:0xf
    v_max_u32_dpp v61, v78, v78 row_ror:8 row_mask:0xf bank_mask:0x1
    s_nop 1
    v_max_u32_dpp v61, v79, v79 row_ror:8 row_mask:0xf bank_mask:0x2
    s_nop 1
    v_max_u32_dpp v61, v80, v80 row_ror:8 row_mask:0xf bank_mask:0x4
    s_nop 1
    v_max_u32_dpp v61, v81, v81 row_ror:8 row_mask:0xf bank_mask:0x8
    s_nop 1
    v_max_u32_dpp v61, v61, v61 quad_perm:[1,0,3,2] row_mask:0xf bank_mask:0xf
    s_nop 1
    v_max_u32_dpp v61, v61, v61 quad_perm:[2,3,0,1] row_mask:0xf bank_mask:0xf
    v_and_b32 v60, 12, v3
    v_add_u32 v60, v60, v57
    s_mov_b32 exec_lo, 0x11111111
    s_mov_b32 exec_hi, 0x11111111
    ds_max_u32 v60, v61 offset:0
    s_mov_b64 exec, -1
    s_mov_b64 exec, 1
    ds_add_u32 v57, v139 offset:68
    s_mov_b64 exec, -1
CU_PASS:
    s_mov_b32 s12, 0
SPN12:
    ds_read_b32 v60, v57 offset:68
    s_add_u32 s12, s12, 1
    s_waitcnt lgkmcnt(0)
    v_cmp_eq_u32 vcc, 0, v60
    s_cmp_ge_u32 s12, 0x40000
    s_cbranch_scc1 SPX12
    s_cbranch_vccz SPX12
    s_sleep 2
    s_branch SPN12
SPX12:
    ds_read_b32 v62, v146 offset:0
    s_waitcnt lgkmcnt(0)
    v_lshrrev_b32 v62, 23, v62
    v_sub_u32 v62, 260, v62
    v_min_i32 v62, 253, v62
    v_lshlrev_b32 v64, 23, v62
    s_nop 1
    v_mov_b32_dpp v150, v64 quad_perm:[0,0,0,0] row_mask:0xf bank_mask:0xf
    v_mov_b32_dpp v151, v64 quad_perm:[1,1,1,1] row_mask:0xf bank_mask:0xf
    v_mov_b32_dpp v152, v64 quad_perm:[2,2,2,2] row_mask:0xf bank_mask:0xf
    v_mov_b32_dpp v153, v64 quad_perm:[3,3,3,3] row_mask:0xf bank_mask:0xf
    s_cmp_eq_u32 s75, 0
    s_cbranch_scc1 CU_CV0
    s_waitcnt vmcnt(7)
    v_lshlrev_b32 v24, 16, v8
    v_and_b32 v28, 0xffff0000, v8
    v_lshlrev_b32 v32, 16, v9
    v_and_b32 v36, 0xffff0000, v9
    s_waitcnt vmcnt(6)
    v_lshlrev_b32 v25, 16, v10
    v_and_b32 v29, 0xffff0000, v10
    v_lshlrev_b32 v33, 16, v11
    v_and_b32 v37, 0xffff0000, v11
    s_waitcnt vmcnt(5)
    v_lshlrev_b32 v26, 16, v12
    v_and_b32 v30, 0xffff0000, v12
    v_lshlrev_b32 v34, 16, v13
    v_and_b32 v38, 0xffff0000, v13
    s_waitcnt vmcnt(4)
    v_lshlrev_b32 v27, 16, v14
    v_and_b32 v31, 0xffff0000, v14
    v_lshlrev_b32 v35, 16, v15
    v_and_b32 v39, 0xffff0000, v15
CU_CV0:
    v_mul_f32 v66, v24, v150
    v_mul_f32 v67, v25, v150
    v_mul_f32 v68, v26, v150
    v_mul_f32 v69, v27, v150
    v_max3_f32 v65, |v66|, |v67|, 0
    v_cvt_pk_f16_f32 v70, v67, v66
    v_max3_f32 v65, |v68|, |v69|, v65
    v_cvt_pk_f16_f32 v71, v69, v68
    ds_write_b64 v58, v[70:71] offset:0
    v_mul_f32 v72, v28, v151
    v_mul_f32 v73, v29, v151
    v_mul_f32 v74, v30, v151
    v_mul_f32 v75, v31, v151
    v_max3_f32 v65, |v72|, |v73|, v65
    v_cvt_pk_f16_f32 v76, v73, v72
    v_max3_f32 v65, |v74|, |v75|, v65
    v_cvt_pk_f16_f32 v77, v75, v74
    ds_write_b64 v58, v[76:77] offset:8192
    v_mul_f32 v66, v32, v152
    v_mul_f32 v67, v33, v152
    v_mul_f32 v68, v34, v152
    v_mul_f32 v69, v35, v152
    v_max3_f32 v65, |v66|, |v67|, v65
    v_cvt_pk_f16_f32 v70, v67, v66
    v_max3_f32 v65, |v68|, |v69|, v65
    v_cvt_pk_f16_f32 v71, v69, v68
    ds_write_b64 v58, v[70:71] offset:16384
    v_mul_f32 v72, v36, v153
    v_mul_f32 v73, v37, v153
    v_mul_f32 v74, v38, v153
    v_mul_f32 v75, v39, v153
    v_max3_f32 v65, |v72|, |v73|, v65
    v_cvt_pk_f16_f32 v76, v73, v72
    v_max3_f32 v65, |v74|, |v75|, v65
    v_cvt_pk_f16_f32 v77, v75, v74
    ds_write_b64 v58, v[76:77] offset:24576
    s_waitcnt vmcnt(3)
    v_lshlrev_b32 v40, 16, v16
    v_and_b32 v44, 0xffff0000, v16
    v_lshlrev_b32 v48, 16, v17
    v_and_b32 v52, 0xffff0000, v17
    s_waitcnt vmcnt(2)
    v_lshlrev_b32 v41, 16, v18
    v_and_b32 v45, 0xffff0000, v18
    v_lshlrev_b32 v49, 16, v19
    v_and_b32 v53, 0xffff0000, v19
    s_waitcnt vmcnt(1)
    v_lshlrev_b32 v42, 16, v20
    v_and_b32 v46, 0xffff0000, v20
    v_lshlrev_b32 v50, 16, v21
    v_and_b32 v54, 0xffff0000, v21
    s_waitcnt vmcnt(0)
    v_lshlrev_b32 v43, 16, v22
    v_and_b32 v47, 0xffff0000, v22
    v_lshlrev_b32 v51, 16, v23
    v_and_b32 v55, 0xffff0000, v23
    v_mul_f32 v66, v40, v150
    v_mul_f32 v67, v41, v150
    v_mul_f32 v68, v42, v150
    v_mul_f32 v69, v43, v150
    v_max3_f32 v65, |v66|, |v67|, v65
    v_cvt_pk_f16_f32 v70, v67, v66
    v_max3_f32 v65, |v68|, |v69|, v65
    v_cvt_pk_f16_f32 v71, v69, v68
    ds_write_b64 v58, v[70:71] offset:1024
    v_mul_f32 v72, v44, v151
    v_mul_f32 v73, v45, v151
    v_mul_f32 v74, v46, v151
    v_mul_f32 v75, v47, v151
    v_max3_f32 v65, |v72|, |v73|, v65
    v_cvt_pk_f16_f32 v76, v73, v72
    v_max3_f32 v65, |v74|, |v75|, v65
    v_cvt_pk_f16_f32 v77, v75, v74
    ds_write_b64 v58, v[76:77] offset:9216
    v_mul_f32 v66, v48, v152
    v_mul_f32 v67, v49, v152
    v_mul_f32 v68, v50, v152
    v_mul_f32 v69, v51, v152
    v_max3_f32 v65, |v66|, |v67|, v65
    v_cvt_pk_f16_f32 v70, v67, v66
    v_max3_f32 v65, |v68|, |v69|, v65
    v_cvt_pk_f16_f32 v71, v69, v68
    ds_write_b64 v58, v[70:71] offset:17408
    v_mul_f32 v72, v52, v153
    v_mul_f32 v73, v53, v153
    v_mul_f32 v74, v54, v153
    v_mul_f32 v75, v55, v153
    v_max3_f32 v65, |v72|, |v73|, v65
    v_cvt_pk_f16_f32 v76, v73, v72
    v_max3_f32 v65, |v74|, |v75|, v65
    v_cvt_pk_f16_f32 v77, v75, v74
    ds_write_b64 v58, v[76:77] offset:25600
    v_cmp_lt_f32 vcc, s73, v65
    s_cmp_eq_u64 vcc, 0
    s_cselect_b32 s8, 0, 0x10000
    s_cmp_lt_u32 s7, 2
    s_cselect_b32 s9, 1, 16
    s_or_b32 s8, s8, s9
    v_mov_b32 v148, s8
    s_mov_b64 exec, 1
    ds_add_u32 v57, v148 offset:240
    s_mov_b64 exec, -1
    s_setprio 3
    s_cmp_ge_u32 s7, s74
    s_cbranch_scc1 E_NOG
    s_mov_b32 s12, 0
SPN13:
    ds_read_b32 v60, v57 offset:64
    s_add_u32 s12, s12, 1
    s_waitcnt lgkmcnt(0)
    v_cmp_gt_u32 vcc, 4, v60
    s_cmp_ge_u32 s12, 0x40000
    s_cbranch_scc1 SPX13
    s_cbranch_vccz SPX13
    s_sleep 1
    s_branch SPN13
SPX13:
    global_load_dwordx2 v[144:145], v59, s[48:49] sc1
    global_load_dwordx4 v[128:131], v158, s[50:51] sc1
    v_add_u32 v137, 4096, v158
    global_load_dwordx4 v[132:135], v137, s[50:51] sc1
    v_add_u32 v137, 8192, v158
    global_load_dwordx4 v[160:163], v137, s[50:51] sc1
    global_load_dwordx4 v[164:167], v138, s[50:51] sc1
    s_add_u32 s15, s7, 0
    s_cmp_ge_u32 s15, 4
    s_cbranch_scc1 CPF_DE0
    s_mul_i32 s14, s15, 18
    s_add_u32 s14, s14, s101
    v_mul_u32_u24 v140, 9216, v2
    s_mul_i32 s8, s4, 1152
    v_add_u32 v140, s8, v140
    s_mul_i32 s8, s14, 7282
    s_lshr_b32 s8, s8, 16
    s_mul_i32 s9, s8, 9
    s_sub_u32 s9, s14, s9
    s_lshl_b32 s9, s9, 7
    s_bitcmp1_b32 s8, 0
    s_cselect_b32 s12, s40, s38
    s_cselect_b32 s13, s41, s39
    s_lshr_b32 s8, s8, 1
    s_add_u32 s8, s8, 5
    s_mul_i32 s8, s8, 589824
    s_add_u32 s8, s8, s9
    v_add_u32 v148, s8, v140
    global_load_dword v149, v148, s[12:13]
    s_branch CPF_XE0
CPF_DE0:
    s_sub_u32 s14, s15, 4
    s_mul_i32 s14, s14, 18
    s_add_u32 s14, s14, s101
    s_min_u32 s14, s14, 80
    s_mul_i32 s8, s4, 81
    s_add_u32 s8, s8, 80
    s_sub_u32 s8, s8, s14
    s_lshl_b32 s8, s8, 13
    v_lshl_add_u32 v148, v2, 7, s8
    global_load_dword v149, v148, s[42:43]
CPF_XE0:
    s_add_u32 s15, s7, 2
    s_cmp_ge_u32 s15, 4
    s_cbranch_scc1 CPF_DE1
    s_mul_i32 s14, s15, 18
    s_add_u32 s14, s14, s101
    v_mul_u32_u24 v140, 9216, v2
    s_mul_i32 s8, s4, 1152
    v_add_u32 v140, s8, v140
    s_mul_i32 s8, s14, 7282
    s_lshr_b32 s8, s8, 16
    s_mul_i32 s9, s8, 9
    s_sub_u32 s9, s14, s9
    s_lshl_b32 s9, s9, 7
    s_bitcmp1_b32 s8, 0
    s_cselect_b32 s12, s40, s38
    s_cselect_b32 s13, s41, s39
    s_lshr_b32 s8, s8, 1
    s_add_u32 s8, s8, 5
    s_mul_i32 s8, s8, 589824
    s_add_u32 s8, s8, s9
    v_add_u32 v148, s8, v140
    global_load_dword v149, v148, s[12:13]
    s_branch CPF_XE1
CPF_DE1:
    s_sub_u32 s14, s15, 4
    s_mul_i32 s14, s14, 18
    s_add_u32 s14, s14, s101
    s_min_u32 s14, s14, 80
    s_mul_i32 s8, s4, 81
    s_add_u32 s8, s8, 80
    s_sub_u32 s8, s8, s14
    s_lshl_b32 s8, s8, 13
    v_lshl_add_u32 v148, v2, 7, s8
    global_load_dword v149, v148, s[42:43]
CPF_XE1:
    s_add_u32 s15, s7, 4
    s_cmp_ge_u32 s15, 4
    s_cbranch_scc1 CPF_DE2
    s_mul_i32 s14, s15, 18
    s_add_u32 s14, s14, s101
    v_mul_u32_u24 v140, 9216, v2
    s_mul_i32 s8, s4, 1152
    v_add_u32 v140, s8, v140
    s_mul_i32 s8, s14, 7282
    s_lshr_b32 s8, s8, 16
    s_mul_i32 s9, s8, 9
    s_sub_u32 s9, s14, s9
    s_lshl_b32 s9, s9, 7
    s_bitcmp1_b32 s8, 0
    s_cselect_b32 s12, s40, s38
    s_cselect_b32 s13, s41, s39
    s_lshr_b32 s8, s8, 1
    s_add_u32 s8, s8, 5
    s_mul_i32 s8, s8, 589824
    s_add_u32 s8, s8, s9
    v_add_u32 v148, s8, v140
    global_load_dword v149, v148, s[12:13]
    s_branch CPF_XE2
CPF_DE2:
    s_sub_u32 s14, s15, 4
    s_mul_i32 s14, s14, 18
    s_add_u32 s14, s14, s101
    s_min_u32 s14, s14, 80
    s_mul_i32 s8, s4, 81
    s_add_u32 s8, s8, 80
    s_sub_u32 s8, s8, s14
    s_lshl_b32 s8, s8, 13
    v_lshl_add_u32 v148, v2, 7, s8
    global_load_dword v149, v148, s[42:43]
CPF_XE2:
E_NOG:
    v_mul_f32 v64, v24, v154
    v_mul_f32 v65, v25, v154
    v_mul_f32 v66, v26, v154
    v_mul_f32 v67, v27, v154
    v_mul_f32 v68, v28, v155
    v_mul_f32 v69, v29, v155
    v_mul_f32 v70, v30, v155
    v_mul_f32 v71, v31, v155
    v_mul_f32 v72, v32, v156
    v_mul_f32 v73, v33, v156
    v_mul_f32 v74, v34, v156
    v_mul_f32 v75, v35, v156
    v_mul_f32 v76, v36, v157
    v_mul_f32 v77, v37, v157
    v_mul_f32 v78, v38, v157
    v_mul_f32 v79, v39, v157
    v_mul_f32 v80, v40, v154
    v_mul_f32 v81, v41, v154
    v_mul_f32 v82, v42, v154
    v_mul_f32 v83, v43, v154
    v_mul_f32 v84, v44, v155
    v_mul_f32 v85, v45, v155
    v_mul_f32 v86, v46, v155
    v_mul_f32 v87, v47, v155
    v_mul_f32 v88, v48, v156
    v_mul_f32 v89, v49, v156
    v_mul_f32 v90, v50, v156
    v_mul_f32 v91, v51, v156
    v_mul_f32 v92, v52, v157
    v_mul_f32 v93, v53, v157
    v_mul_f32 v94, v54, v157
    v_mul_f32 v95, v55, v157
    s_cmp_lt_u32 s7, 2
    s_cbranch_scc1 E_T0
    s_mov_b32 s12, 0
SPN14:
    ds_read_b32 v60, v57 offset:240
    s_add_u32 s12, s12, 1
    s_waitcnt lgkmcnt(0)
    v_and_b32 v60, 0xffff, v60
    v_cmp_ne_u32 vcc, 34, v60
    s_cmp_ge_u32 s12, 0x40000
    s_cbranch_scc1 SPX14
    s_cbranch_vccz SPX14
    s_sleep 1
    s_branch SPN14
SPX14:
    ds_read_b32 v60, v57 offset:240
    s_waitcnt lgkmcnt(0)
    v_cmp_ne_u32 vcc, 34, v60
    s_nop 0
    s_cbranch_vccnz CU_REDO
    s_branch E_GATES
E_T0:
    s_mov_b32 s12, 0
SPN15:
    ds_read_b32 v60, v141 offset:0
    s_add_u32 s12, s12, 1
    s_waitcnt lgkmcnt(0)
    v_cmp_eq_u32 vcc, 0, v60
    s_cmp_ge_u32 s12, 0x40000
    s_cbranch_scc1 SPX15
    s_cbranch_vccz SPX15
    s_sleep 1
    s_branch SPN15
SPX15:
    ds_read_b32 v63, v146 offset:16
    ds_read_b128 v[96:99], v159 offset:0
    ds_read_b128 v[112:115], v159 offset:10240
    ds_read_b128 v[100:103], v159 offset:20480
    ds_read_b128 v[116:119], v159 offset:30720
    ds_read_b128 v[104:107], v136 offset:0
    ds_read_b128 v[120:123], v136 offset:10240
    ds_read_b128 v[108:111], v136 offset:20480
    ds_read_b128 v[124:127], v136 offset:30720
    s_waitcnt lgkmcnt(8)
    v_add_u32 v62, v62, v63
    v_sub_u32 v62, 381, v62
    v_max_i32 v62, 0, v62
    v_min_i32 v62, 254, v62
    v_lshlrev_b32 v62, 23, v62
    s_nop 1
    v_mov_b32_dpp v150, v62 quad_perm:[0,0,0,0] row_mask:0xf bank_mask:0xf
    v_mov_b32_dpp v151, v62 quad_perm:[1,1,1,1] row_mask:0xf bank_mask:0xf
    v_mov_b32_dpp v152, v62 quad_perm:[2,2,2,2] row_mask:0xf bank_mask:0xf
    v_mov_b32_dpp v153, v62 quad_perm:[3,3,3,3] row_mask:0xf bank_mask:0xf
    s_waitcnt lgkmcnt(6)
    v_add_f32 v96, v96, v112
    v_fma_f32 v96, v96, v150, v64
    v_add_f32 v97, v97, v113
    v_fma_f32 v97, v97, v150, v65
    v_add_f32 v98, v98, v114
    v_fma_f32 v98, v98, v150, v66
    v_add_f32 v99, v99, v115
    v_fma_f32 v99, v99, v150, v67
    s_waitcnt lgkmcnt(4)
    v_add_f32 v100, v100, v116
    v_fma_f32 v100, v100, v151, v68
    v_add_f32 v101, v101, v117
    v_fma_f32 v101, v101, v151, v69
    v_add_f32 v102, v102, v118
    v_fma_f32 v102, v102, v151, v70
    v_add_f32 v103, v103, v119
    v_fma_f32 v103, v103, v151, v71
    s_waitcnt lgkmcnt(2)
    v_add_f32 v104, v104, v120
    v_fma_f32 v104, v104, v152, v72
    v_add_f32 v105, v105, v121
    v_fma_f32 v105, v105, v152, v73
    v_add_f32 v106, v106, v122
    v_fma_f32 v106, v106, v152, v74
    v_add_f32 v107, v107, v123
    v_fma_f32 v107, v107, v152, v75
    s_waitcnt lgkmcnt(0)
    v_add_f32 v108, v108, v124
    v_fma_f32 v108, v108, v153, v76
    v_add_f32 v109, v109, v125
    v_fma_f32 v109, v109, v153, v77
    v_add_f32 v110, v110, v126
    v_fma_f32 v110, v110, v153, v78
    v_add_f32 v111, v111, v127
    v_fma_f32 v111, v111, v153, v79
    s_cmp_ge_u32 s7, 2
    s_cbranch_scc1 E_OUT0
E_GATES:
    s_cmp_lt_u32 s7, s74
    s_cbranch_scc1 E_G1
    s_mov_b32 s12, 0
SPN16:
    ds_read_b32 v60, v57 offset:116
    s_add_u32 s12, s12, 1
    s_waitcnt lgkmcnt(0)
    v_cmp_ne_u32 vcc, 2, v60
    s_cmp_ge_u32 s12, 0x40000
    s_cbranch_scc1 SPX16
    s_cbranch_vccz SPX16
    s_sleep 1
    s_branch SPN16
SPX16:
    ds_read_b128 v[128:131], v147
    ds_read_b128 v[132:135], v147 offset:2048
    s_waitcnt lgkmcnt(0)
    s_branch E_GX
E_G1:
    s_mov_b32 s12, 0
    s_waitcnt vmcnt(3)
    s_branch E_GCHK
E_GPOLL:
    global_load_dwordx2 v[144:145], v59, s[48:49] sc1
    global_load_dwordx4 v[128:131], v158, s[50:51] sc1
    v_add_u32 v137, 4096, v158
    global_load_dwordx4 v[132:135], v137, s[50:51] sc1
    v_add_u32 v137, 8192, v158
    global_load_dwordx4 v[160:163], v137, s[50:51] sc1
    global_load_dwordx4 v[164:167], v138, s[50:51] sc1
    s_add_u32 s12, s12, 1
    s_waitcnt vmcnt(0)
E_GCHK:
    v_xor_b32 v61, 1, v145
    v_bitop3_b32 v61, v61, v128, v144 bitop3:0xf6
    v_bitop3_b32 v61, v61, v129, v144 bitop3:0xf6
    v_bitop3_b32 v61, v61, v130, v144 bitop3:0xf6
    v_bitop3_b32 v61, v61, v131, v144 bitop3:0xf6
    v_bitop3_b32 v61, v61, v132, v144 bitop3:0xf6
    v_bitop3_b32 v61, v61, v133, v144 bitop3:0xf6
    v_bitop3_b32 v61, v61, v134, v144 bitop3:0xf6
    v_bitop3_b32 v61, v61, v135, v144 bitop3:0xf6
    v_bitop3_b32 v61, v61, v160, v144 bitop3:0xf6
    v_bitop3_b32 v61, v61, v161, v144 bitop3:0xf6
    v_bitop3_b32 v61, v61, v162, v144 bitop3:0xf6
    v_bitop3_b32 v61, v61, v163, v144 bitop3:0xf6
    v_bitop3_b32 v61, v61, v164, v144 bitop3:0xf6
    v_bitop3_b32 v61, v61, v165, v144 bitop3:0xf6
    v_bitop3_b32 v61, v61, v166, v144 bitop3:0xf6
    v_bitop3_b32 v61, v61, v167, v144 bitop3:0xf6
    v_and_b32 v61, 0xffff, v61
    v_cmp_ne_u32 vcc, 0, v61
    s_cmp_ge_u32 s12, 16384
    s_cbranch_scc1 E_GOK
    s_cbranch_vccnz E_GPOLL
E_GOK:
    ds_write_b128 v147, v[160:163] offset:4096
    ds_write_b128 v147, v[164:167] offset:6144
    ds_write_b128 v147, v[128:131] offset:0
    ds_write_b128 v147, v[132:135] offset:2048
    ds_write_b32 v57, v144 offset:120
    s_mov_b64 exec, 1
    ds_add_u32 v57, v139 offset:116
    s_mov_b64 exec, -1
E_GX:
    ds_write_b128 v142, v[8:11] offset:0
    ds_write_b128 v142, v[12:15] offset:16
    ds_write_b128 v142, v[16:19] offset:4096
    ds_write_b128 v142, v[20:23] offset:4112
    s_mov_b64 exec, 1
    ds_add_u32 v57, v139 offset:244
    s_mov_b64 exec, -1
    v_and_b32 v128, 0xffff0000, v128
    v_and_b32 v129, 0xffff0000, v129
    v_and_b32 v130, 0xffff0000, v130
    v_and_b32 v131, 0xffff0000, v131
    s_cmp_ge_u32 s7, 2
    s_cbranch_scc1 E_T0
E_OUT0:
    v_fma_f32 v96, v96, v128, v24
    v_fma_f32 v100, v100, v128, v28
    v_fma_f32 v104, v104, v128, v32
    v_fma_f32 v108, v108, v128, v36
    v_cvt_pk_bf16_f32 v112, v96, v100
    v_cvt_pk_bf16_f32 v113, v104, v108
    global_store_dwordx2 v5, v[112:113], s[46:47] offset:0
    v_fma_f32 v97, v97, v129, v25
    v_fma_f32 v101, v101, v129, v29
    v_fma_f32 v105, v105, v129, v33
    v_fma_f32 v109, v109, v129, v37
    v_cvt_pk_bf16_f32 v114, v97, v101
    v_cvt_pk_bf16_f32 v115, v105, v109
    global_store_dwordx2 v5, v[114:115], s[46:47] offset:1152
    v_fma_f32 v98, v98, v130, v26
    v_fma_f32 v102, v102, v130, v30
    v_fma_f32 v106, v106, v130, v34
    v_fma_f32 v110, v110, v130, v38
    v_cvt_pk_bf16_f32 v116, v98, v102
    v_cvt_pk_bf16_f32 v117, v106, v110
    global_store_dwordx2 v5, v[116:117], s[46:47] offset:2304
    v_fma_f32 v99, v99, v131, v27
    v_fma_f32 v103, v103, v131, v31
    v_fma_f32 v107, v107, v131, v35
    v_fma_f32 v111, v111, v131, v39
    v_cvt_pk_bf16_f32 v118, v99, v103
    v_cvt_pk_bf16_f32 v119, v107, v111
    global_store_dwordx2 v5, v[118:119], s[46:47] offset:3456
    v_and_b32 v132, 0xffff0000, v132
    v_and_b32 v133, 0xffff0000, v133
    v_and_b32 v134, 0xffff0000, v134
    v_and_b32 v135, 0xffff0000, v135
    s_mov_b32 s12, 0
SPN17:
    ds_read_b32 v60, v141 offset:64
    s_add_u32 s12, s12, 1
    s_waitcnt lgkmcnt(0)
    v_cmp_eq_u32 vcc, 0, v60
    s_cmp_ge_u32 s12, 0x40000
    s_cbranch_scc1 SPX17
    s_cbranch_vccz SPX17
    s_sleep 1
    s_branch SPN17
SPX17:
    ds_read_b128 v[96:99], v159 offset:2560
    ds_read_b128 v[112:115], v159 offset:12800
    ds_read_b128 v[100:103], v159 offset:23040
    ds_read_b128 v[116:119], v159 offset:33280
    ds_read_b128 v[104:107], v136 offset:2560
    ds_read_b128 v[120:123], v136 offset:12800
    ds_read_b128 v[108:111], v136 offset:23040
    ds_read_b128 v[124:127], v136 offset:33280
    s_waitcnt lgkmcnt(6)
    v_add_f32 v96, v96, v112
    v_fma_f32 v96, v96, v150, v80
    v_add_f32 v97, v97, v113
    v_fma_f32 v97, v97, v150, v81
    v_add_f32 v98, v98, v114
    v_fma_f32 v98, v98, v150, v82
    v_add_f32 v99, v99, v115
    v_fma_f32 v99, v99, v150, v83
    s_waitcnt lgkmcnt(4)
    v_add_f32 v100, v100, v116
    v_fma_f32 v100, v100, v151, v84
    v_add_f32 v101, v101, v117
    v_fma_f32 v101, v101, v151, v85
    v_add_f32 v102, v102, v118
    v_fma_f32 v102, v102, v151, v86
    v_add_f32 v103, v103, v119
    v_fma_f32 v103, v103, v151, v87
    s_waitcnt lgkmcnt(2)
    v_add_f32 v104, v104, v120
    v_fma_f32 v104, v104, v152, v88
    v_add_f32 v105, v105, v121
    v_fma_f32 v105, v105, v152, v89
    v_add_f32 v106, v106, v122
    v_fma_f32 v106, v106, v152, v90
    v_add_f32 v107, v107, v123
    v_fma_f32 v107, v107, v152, v91
    s_waitcnt lgkmcnt(0)
    v_add_f32 v108, v108, v124
    v_fma_f32 v108, v108, v153, v92
    v_add_f32 v109, v109, v125
    v_fma_f32 v109, v109, v153, v93
    v_add_f32 v110, v110, v126
    v_fma_f32 v110, v110, v153, v94
    v_add_f32 v111, v111, v127
    v_fma_f32 v111, v111, v153, v95
    v_fma_f32 v96, v96, v132, v40
    v_fma_f32 v100, v100, v132, v44
    v_fma_f32 v104, v104, v132, v48
    v_fma_f32 v108, v108, v132, v52
    v_cvt_pk_bf16_f32 v112, v96, v100
    v_cvt_pk_bf16_f32 v113, v104, v108
    global_store_dwordx2 v6, v[112:113], s[46:47] offset:0
    v_fma_f32 v97, v97, v133, v41
    v_fma_f32 v101, v101, v133, v45
    v_fma_f32 v105, v105, v133, v49
    v_fma_f32 v109, v109, v133, v53
    v_cvt_pk_bf16_f32 v114, v97, v101
    v_cvt_pk_bf16_f32 v115, v105, v109
    global_store_dwordx2 v6, v[114:115], s[46:47] offset:1152
    v_fma_f32 v98, v98, v134, v42
    v_fma_f32 v102, v102, v134, v46
    v_fma_f32 v106, v106, v134, v50
    v_fma_f32 v110, v110, v134, v54
    v_cvt_pk_bf16_f32 v116, v98, v102
    v_cvt_pk_bf16_f32 v117, v106, v110
    global_store_dwordx2 v6, v[116:117], s[46:47] offset:2304
    v_fma_f32 v99, v99, v135, v43
    v_fma_f32 v103, v103, v135, v47
    v_fma_f32 v107, v107, v135, v51
    v_fma_f32 v111, v111, v135, v55
    v_cvt_pk_bf16_f32 v118, v99, v103
    v_cvt_pk_bf16_f32 v119, v107, v111
    global_store_dwordx2 v6, v[118:119], s[46:47] offset:3456
    s_mov_b32 s12, 0
SPN18:
    ds_read_b32 v60, v57 offset:240
    s_add_u32 s12, s12, 1
    s_waitcnt lgkmcnt(0)
    v_and_b32 v60, 0xffff, v60
    v_cmp_ne_u32 vcc, 34, v60
    s_cmp_ge_u32 s12, 0x40000
    s_cbranch_scc1 SPX18
    s_cbranch_vccz SPX18
    s_sleep 1
    s_branch SPN18
SPX18:
    ds_read_b32 v60, v57 offset:240
    s_waitcnt lgkmcnt(0)
    v_cmp_ne_u32 vcc, 34, v60
    s_nop 0
    s_cbranch_vccnz CU_REDO
    s_waitcnt vmcnt(0)
    s_endpgm
CU_REDO:
    s_waitcnt vmcnt(0)
    s_barrier
    v_lshlrev_b32 v24, 16, v8
    v_and_b32 v28, 0xffff0000, v8
    v_lshlrev_b32 v32, 16, v9
    v_and_b32 v36, 0xffff0000, v9
    v_lshlrev_b32 v25, 16, v10
    v_and_b32 v29, 0xffff0000, v10
    v_lshlrev_b32 v33, 16, v11
    v_and_b32 v37, 0xffff0000, v11
    v_lshlrev_b32 v26, 16, v12
    v_and_b32 v30, 0xffff0000, v12
    v_lshlrev_b32 v34, 16, v13
    v_and_b32 v38, 0xffff0000, v13
    v_lshlrev_b32 v27, 16, v14
    v_and_b32 v31, 0xffff0000, v14
    v_lshlrev_b32 v35, 16, v15
    v_and_b32 v39, 0xffff0000, v15
    v_max3_f32 v78, |v24|, |v25|, 0
    v_max3_f32 v79, |v28|, |v29|, 0
    v_max3_f32 v80, |v32|, |v33|, 0
    v_max3_f32 v81, |v36|, |v37|, 0
    v_max3_f32 v78, |v26|, |v27|, v78
    v_max3_f32 v79, |v30|, |v31|, v79
    v_max3_f32 v80, |v34|, |v35|, v80
    v_max3_f32 v81, |v38|, |v39|, v81
    v_lshlrev_b32 v40, 16, v16
    v_and_b32 v44, 0xffff0000, v16
    v_lshlrev_b32 v48, 16, v17
    v_and_b32 v52, 0xffff0000, v17
    v_lshlrev_b32 v41, 16, v18
    v_and_b32 v45, 0xffff0000, v18
    v_lshlrev_b32 v49, 16, v19
    v_and_b32 v53, 0xffff0000, v19
    v_lshlrev_b32 v42, 16, v20
    v_and_b32 v46, 0xffff0000, v20
    v_lshlrev_b32 v50, 16, v21
    v_and_b32 v54, 0xffff0000, v21
    v_lshlrev_b32 v43, 16, v22
    v_and_b32 v47, 0xffff0000, v22
    v_lshlrev_b32 v51, 16, v23
    v_and_b32 v55, 0xffff0000, v23
    v_max3_f32 v78, |v40|, |v41|, v78
    v_max3_f32 v79, |v44|, |v45|, v79
    v_max3_f32 v80, |v48|, |v49|, v80
    v_max3_f32 v81, |v52|, |v53|, v81
    v_max3_f32 v78, |v42|, |v43|, v78
    v_max3_f32 v79, |v46|, |v47|, v79
    v_max3_f32 v80, |v50|, |v51|, v80
    v_max3_f32 v81, |v54|, |v55|, v81
    v_max_u32_dpp v78, v78, v78 row_ror:4 row_mask:0xf bank_mask:0xf
    v_max_u32_dpp v79, v79, v79 row_ror:4 row_mask:0xf bank_mask:0xf
    v_max_u32_dpp v80, v80, v80 row_ror:4 row_mask:0xf bank_mask:0xf
    v_max_u32_dpp v81, v81, v81 row_ror:4 row_mask:0xf bank_mask:0xf
    v_max_u32_dpp v61, v78, v78 row_ror:8 row_mask:0xf bank_mask:0x1
    s_nop 1
    v_max_u32_dpp v61, v79, v79 row_ror:8 row_mask:0xf bank_mask:0x2
    s_nop 1
    v_max_u32_dpp v61, v80, v80 row_ror:8 row_mask:0xf bank_mask:0x4
    s_nop 1
    v_max_u32_dpp v61, v81, v81 row_ror:8 row_mask:0xf bank_mask:0x8
    s_nop 1
    v_max_u32_dpp v61, v61, v61 quad_perm:[1,0,3,2] row_mask:0xf bank_mask:0xf
    s_nop 1
    v_max_u32_dpp v61, v61, v61 quad_perm:[2,3,0,1] row_mask:0xf bank_mask:0xf
    v_and_b32 v60, 12, v3
    v_add_u32 v60, v60, v57
    s_mov_b32 exec_lo, 0x11111111
    s_mov_b32 exec_hi, 0x11111111
    ds_max_u32 v60, v61 offset:0
    s_mov_b64 exec, -1
    v_lshl_add_u32 v60, v2, 2, v57
    v_mov_b32 v61, 0
    ds_write_b32 v60, v61 offset:256
    ds_write_b32 v57, v61 offset:240
    ds_write_b32 v57, v61 offset:244
    s_mov_b32 s73, 0x7f800000
    s_mov_b32 s74, 0
    s_waitcnt lgkmcnt(0)
    s_barrier
    s_branch CU_PASS
FINAL:
    v_and_b32 v5, 7, v2
    v_lshlrev_b32 v5, 2, v5
    s_lshl_b32 s10, s6, 3
    s_load_dwordx2 s[52:53], s[32:33], s10
    s_mov_b32 s12, 0
SPN19:
    ds_read_b32 v42, v167 offset:244
    s_add_u32 s12, s12, 1
    s_waitcnt lgkmcnt(0)
    v_cmp_ne_u32 vcc, 4, v42
    s_cmp_ge_u32 s12, 0x40000
    s_cbranch_scc1 SPX19
    s_cbranch_vccz SPX19
    s_sleep 1
    s_branch SPN19
SPX19:
    ds_read_b32 v42, v167 offset:120
    s_waitcnt lgkmcnt(0)
    v_and_b32 v6, 4, v2
    v_add_u32 v6, v6, v4
    s_lshl_b32 s9, s4, 8
    v_lshl_add_u32 v6, v6, 3, s9
    v_and_b32 v7, 4, v2
    v_add_u32 v7, v7, v4
    s_lshl_b32 s9, s4, 10
    s_add_u32 s9, s9, 48896
    v_lshl_add_u32 v7, v7, 7, s9
    s_mov_b32 s12, 0
    s_waitcnt vmcnt(0)
    v_mov_b32 v8, v124
    v_mov_b32 v9, v125
    s_branch SPC_F
SP_F:
    s_add_u32 s12, s12, 1
    s_and_b32 s9, s12, 7
    s_cselect_b64 s[14:15], 0, -1
    v_cndmask_b32 v10, v6, v7, s[14:15]
    global_load_dwordx2 v[8:9], v10, s[50:51] offset:256 sc1
    s_waitcnt vmcnt(0)
SPC_F:
    v_cmp_ne_u32 vcc, v9, v42
    s_cmp_ge_u32 s12, 16384
    s_cbranch_scc1 SPX_F
    s_cbranch_vccz SPX_F
    s_mov_b64 exec, vcc
    s_sleep 2
    s_branch SP_F
SPX_F:
    s_mov_b64 exec, -1
    v_and_b32 v9, 0xff, v42
    v_not_b32 v10, v8
    v_and_b32 v10, 0x7ff, v10
    v_and_b32 v23, 3, v2
    v_mul_u32_u24 v11, 1152, v10
    v_lshl_add_u32 v11, v23, 1, v11
    v_add_u32 v11, s10, v11
    v_lshlrev_b32 v14, 3, v10
    v_lshl_add_u32 v14, v23, 1, v14
    v_add_u32 v14, 81920, v14
    ds_read_u16 v24, v14
    v_lshlrev_b32 v14, 2, v10
    v_add_u32 v14, 98304, v14
    ds_read_b32 v15, v14
    v_lshrrev_b32 v16, 8, v10
    v_mul_u32_u24 v16, 1280, v16
    v_and_b32 v17, 0xf0, v10
    v_add_u32 v16, v16, v17
    v_bfe_u32 v17, v10, 2, 2
    v_mul_u32_u24 v17, 320, v17
    v_add_u32 v16, v16, v17
    v_and_b32 v17, 3, v10
    v_lshl_add_u32 v16, v17, 2, v16
    v_mul_u32_u24 v17, 20480, v23
    v_add_u32 v16, v16, v17
    v_add_u32 v18, 154080, v5
    v_lshl_add_u32 v19, v23, 2, v167
    ds_read2_b32 v[36:37], v19 offset0:0 offset1:4
    v_and_b32 v20, 0xffff0000, v8
    v_not_b32 v21, v20
    v_ashrrev_i32 v21, 31, v21
    v_and_b32 v21, 0x7fff0000, v21
    v_or_b32 v21, 0x80000000, v21
    v_xor_b32 v20, v20, v21
    v_mul_f32 v21, 0xbfb8aa3b, v20
    v_exp_f32 v21, v21
    s_nop 0
    v_add_f32 v21, 1.0, v21
    v_rcp_f32 v21, v21
    s_nop 0
    v_cvt_pk_bf16_f32 v20, v21, v21
    v_and_b32 v20, 0xffff0000, v20
    s_waitcnt lgkmcnt(0)
    v_and_b32 v15, 0xffff0000, v15
    v_sub_f32 v21, 1.0, v15
    v_cvt_pk_bf16_f32 v21, v21, v21
    v_and_b32 v21, 0xffff0000, v21
    v_lshlrev_b32 v24, 16, v24
    v_lshrrev_b32 v36, 23, v36
    v_sub_u32 v36, 260, v36
    v_min_i32 v36, 253, v36
    v_add_u32 v36, v36, v37
    v_sub_u32 v36, 381, v36
    v_max_i32 v36, 0, v36
    v_min_i32 v36, 254, v36
    v_lshlrev_b32 v36, 23, v36
    v_lshlrev_b32 v25, 4, v23
    v_lshrrev_b64 v[26:27], v25, s[52:53]
    v_lshlrev_b32 v26, 16, v26
    v_mul_f32 v26, v26, v24
    v_cvt_pk_bf16_f32 v26, 0, v26
    s_mul_i32 s8, s6, 1152
    s_add_u32 s8, s8, 352256
    s_mov_b32 s12, 0
SPN20:
    ds_read_b32 v22, v18 offset:0
    s_add_u32 s12, s12, 1
    s_waitcnt lgkmcnt(0)
    v_cmp_eq_u32 vcc, 0, v22
    s_cmp_ge_u32 s12, 0x40000
    s_cbranch_scc1 SPX20
    s_cbranch_vccz SPX20
    s_sleep 1
    s_branch SPN20
SPX20:
    ds_read_b32 v28, v16
    ds_read_b32 v29, v16 offset:10240
    v_lshl_add_u32 v22, v2, 4, s8
    s_mov_b32 s72, 0x00ff00ff
    s_mov_b32 s73, 0x00ff00ff
    s_waitcnt lgkmcnt(0)
    v_add_f32 v28, v28, v29
    v_cvt_pk_bf16_f32 v28, 0, v28
    v_fma_f32 v28, v28, v36, v26
    v_cvt_pk_bf16_f32 v28, 0, v28
    v_mul_f32 v28, v28, v15
    v_cvt_pk_bf16_f32 v28, 0, v28
    v_min_u32 v33, 4, v2
    s_lshl_b32 s11, s4, 7
    v_lshl_add_u32 v33, v33, 2, s11
    s_mov_b32 s12, 0
FN_R:
    global_load_dword v34, v33, s[50:51] offset:2304 sc1
    s_add_u32 s12, s12, 1
    s_waitcnt vmcnt(0)
    v_cmp_ne_u32 vcc, v34, v42
    s_cmp_ge_u32 s12, 64
    s_cbranch_scc1 FN_RX
    s_cbranch_vccz FN_RX
    s_sleep 2
    s_branch FN_R
FN_RX:
    s_mov_b32 s12, 0
FN_P:
    global_load_dwordx4 v[48:51], v22, s[50:51] sc1
    s_add_u32 s12, s12, 1
    s_waitcnt vmcnt(0)
    v_xor_b32 v48, v48, v9
    v_xor_b32 v49, v49, v9
    v_xor_b32 v50, v50, v9
    v_xor_b32 v51, v51, v9
    v_or3_b32 v32, v48, v49, v50
    v_or_b32 v32, v32, v51
    v_and_b32 v32, 0xff, v32
    v_cmp_ne_u32 vcc, 0, v32
    s_cmp_ge_u32 s12, 65536
    s_cbranch_scc1 FN_POK
    s_cbranch_vccz FN_POK
    s_mov_b64 exec, vcc
    s_branch FN_P
FN_POK:
    s_mov_b64 exec, -1
    v_permlane32_swap_b32 v48, v50
    v_permlane32_swap_b32 v49, v51
    v_add_f32 v48, v48, v50
    v_add_f32 v49, v49, v51
    s_nop 1
    v_permlane16_swap_b32 v48, v49
    v_add_f32 v48, v48, v49
    s_nop 1
    v_add_f32_dpp v48, v48, v48 row_ror:8 row_mask:0xf bank_mask:0xf
    v_cvt_pk_bf16_f32 v48, 0, v48
    v_mul_f32 v48, v48, v20
    v_cvt_pk_bf16_f32 v48, 0, v48
    v_add_f32 v48, v48, v24
    v_cvt_pk_bf16_f32 v48, 0, v48
    v_mul_f32 v48, v48, v21
    v_cvt_pk_bf16_f32 v48, 0, v48
    v_add_f32 v48, v48, v28
    v_cvt_pk_bf16_f32 v48, 0, v48
    s_barrier
    s_mov_b64 exec, s[72:73]
    global_store_short_d16_hi v11, v48, s[46:47]
    s_endpgm
W_END:
    s_endpgm
K_END:
    s_endpgm
CODE_END:
.section .rodata,"a"
.p2align 6
.amdhsa_kernel k1_kernel
  .amdhsa_next_free_vgpr 168
  .amdhsa_next_free_sgpr 102
  .amdhsa_accum_offset 168
  .amdhsa_group_segment_fixed_size 0
  .amdhsa_kernarg_size 144
  .amdhsa_user_sgpr_count 2
  .amdhsa_user_sgpr_kernarg_segment_ptr 1
  .amdhsa_system_sgpr_workgroup_id_x 1
.end_amdhsa_kernel
```

```asm
; @launch kernel=k1_kernel grid=(256,1,1) block=(768,1,1) lds=163840
.amdgcn_target "amdgcn-amd-amdhsa--gfx950"
.text
.p2align 8
.globl k1_kernel
.type k1_kernel,@function
k1_kernel:
    s_cmp_ge_u32 s2, 256
    s_cbranch_scc1 K_END
    s_load_dwordx16 s[16:31], s[0:1], 0
    s_load_dwordx16 s[32:47], s[0:1], 64
    s_load_dwordx4 s[48:51], s[0:1], 128
    v_lshrrev_b32 v1, 6, v0
    v_and_b32 v2, 63, v0
    v_readfirstlane_b32 s3, v1
    v_and_b32 v3, 15, v2
    v_lshrrev_b32 v4, 4, v2
    s_and_b32 s4, s2, 7
    s_lshr_b32 s5, s2, 3
    s_cmp_lg_u32 s3, 0
    s_cbranch_scc1 K_NOCPF
    s_getpc_b64 s[8:9]
    s_and_b32 s8, s8, 0xffffff00
    v_and_b32 v5, 7, v2
    v_lshl_add_u32 v5, s5, 3, v5
    v_lshlrev_b32 v5, 7, v5
    v_min_u32 v5, CODE_END-k1_kernel-4, v5
    global_load_dword v167, v5, s[8:9]
K_NOCPF:
    s_cmp_lt_u32 s2, 112
    s_cbranch_scc1 K_NC
    s_sub_u32 s101, s5, 14
    s_mul_i32 s6, s4, 18
    s_add_u32 s6, s6, s101
    s_cmp_lt_u32 s3, 8
    s_cbranch_scc1 CK_PRO
CU_PRO:
    s_sub_u32 s7, s3, 8
    s_lshl_b32 s8, s101, 2
    s_add_u32 s8, s8, s7
    s_mul_i32 s10, s8, 57
    s_lshr_b32 s10, s10, 9
    s_mul_i32 s11, s10, 9
    s_sub_u32 s11, s8, s11
    s_sub_u32 s8, s8, s10
    s_mul_i32 s8, s8, 36864
    s_lshl_b32 s9, s4, 7
    s_add_u32 s8, s8, s9
    v_lshrrev_b32 v5, 1, v2
    v_mul_u32_u24 v5, 1152, v5
    v_and_b32 v6, 1, v2
    v_lshl_add_u32 v5, v6, 7, v5
    v_add_u32 v7, s8, v5
    s_and_b32 s15, s7, 2
    s_add_u32 s15, s15, s7
    s_mul_i32 s8, s15, 294912
    s_lshl_b32 s9, s6, 3
    s_add_u32 s8, s8, s9
    v_mul_u32_u24 v5, 4608, v2
    v_add_u32 v5, s8, v5
    v_add_u32 v6, 589824, v5
    v_mov_b32 v58, 0
    v_mov_b32 v59, 0
    v_mov_b32 v57, 153600
    v_lshl_add_u32 v56, v2, 3, v57
    ds_write_b64 v56, v[58:59]
    s_waitcnt lgkmcnt(0)
    s_barrier
    s_cmp_eq_u32 s7, 3
    s_cbranch_scc1 CU_C3A
CU_C3B:
    global_load_dword v60, v59, s[30:31]
    s_load_dwordx2 s[52:53], s[32:33], s9
    s_branch CU_PRE
CU_PREX:
    s_cmp_eq_u32 s11, 8
    s_cbranch_scc1 CU_C3
    global_load_dword v60, v7, s[16:17]
CU_C3X:
    s_cmp_ge_u32 s7, 2
    s_cbranch_scc1 CU_MID
CU_LD:
    global_load_dwordx2 v[8:9], v5, s[16:17] offset:0 sc1
    global_load_dwordx2 v[10:11], v5, s[16:17] offset:1152 sc1
    global_load_dwordx2 v[12:13], v5, s[16:17] offset:2304 sc1
    global_load_dwordx2 v[14:15], v5, s[16:17] offset:3456 sc1
    global_load_dwordx2 v[16:17], v6, s[16:17] offset:0 sc1
    global_load_dwordx2 v[18:19], v6, s[16:17] offset:1152 sc1
    global_load_dwordx2 v[20:21], v6, s[16:17] offset:2304 sc1
    global_load_dwordx2 v[22:23], v6, s[16:17] offset:3456 sc1
    s_branch CU_MAIN
CK_PRO:
    s_and_b32 s7, s3, 3
    s_lshr_b32 s12, s3, 2
    s_lshl_b32 s8, s6, 2
    s_add_u32 s8, s8, s7
    s_lshl_b32 s9, s8, 8
    v_lshl_add_u32 v6, v2, 2, s9
    s_lshl_b32 s8, s8, 1
    v_mov_b32 v7, s8
    v_mov_b32 v18, 0
    s_waitcnt lgkmcnt(0)
    global_load_short_d16_hi v18, v7, s[30:31]
    global_load_dword v28, v6, s[18:19]
    global_load_dword v29, v6, s[20:21]
    global_load_dword v30, v6, s[22:23]
    global_load_dword v31, v6, s[24:25]
    global_load_dword v32, v6, s[26:27]
    global_load_dword v33, v6, s[28:29]
    s_barrier
    s_branch CK_MAIN
K_NC:
    s_lshl_b32 s6, s2, 4
    s_lshl_b32 s7, s3, 2
    s_sub_u32 s7, s7, 32
    s_cmp_ge_u32 s3, 8
    s_cbranch_scc1 RT_PRO
    s_cmp_lt_u32 s2, 72
    s_cbranch_scc1 F_PRO
    s_cmp_lt_u32 s3, 6
    s_cbranch_scc1 HELPER
    s_cmp_lt_u32 s2, 80
    s_cbranch_scc1 HELPER
    s_add_u32 s7, s7, 24
    s_lshr_b32 s6, s6, 1
    s_add_u32 s6, s6, 1136
RT_PRO:
    s_add_u32 s6, s6, s7
    v_add_u32 v5, s6, v4
    v_lshlrev_b32 v6, 4, v3
    v_lshlrev_b32 v7, 3, v3
    v_mul_u32_u24 v9, 1152, v5
    v_add_u32 v8, v9, v6
    v_add_u32 v9, v9, v7
    v_mov_b32 v10, 0
    v_lshlrev_b32 v11, 2, v2
    v_add_u32 v12, 163520, v11
    ds_write_b32 v12, v10
    v_and_b32 v11, 0x7c, v11
    v_lshlrev_b32 v12, 4, v2
    s_mul_i32 s13, s7, 640
    s_add_u32 s13, s13, 147456
    s_mov_b32 m0, s13
    s_waitcnt lgkmcnt(0)
    s_load_dword s12, s[50:51], 0
    global_load_lds_dwordx4 v12, s[36:37]
    global_load_lds_dword v11, s[36:37] offset:1024
    s_add_u32 m0, s13, 1280
    v_add_u32 v6, s13, v6
    global_load_lds_dwordx4 v12, s[44:45]
    global_load_lds_dword v11, s[44:45] offset:1024
    global_load_dwordx4 v[16:19], v8, s[16:17] offset:0
    global_load_dwordx4 v[20:23], v8, s[16:17] offset:256
    global_load_dwordx4 v[24:27], v8, s[16:17] offset:512
    global_load_dwordx4 v[28:31], v8, s[16:17] offset:768
    global_load_dwordx2 v[32:33], v9, s[16:17] offset:1024
    s_barrier
    s_branch RT_MAIN
F_PRO:
    s_mul_i32 s6, s4, 9
    s_add_u32 s6, s6, s5
    v_lshrrev_b32 v6, 3, v2
    v_and_b32 v7, 2, v6
    v_mad_u32_u24 v7, v7, 3, v6
    v_mul_u32_u24 v5, 9216, v7
    v_and_b32 v7, 6, v6
    v_xor_b32 v7, v7, v2
    v_and_b32 v7, 7, v7
    v_lshl_add_u32 v5, v7, 4, v5
    s_and_b32 s8, s3, 1
    s_lshr_b32 s9, s3, 1
    s_lshl_b32 s9, s9, 3
    s_add_u32 s8, s8, s9
    s_mul_i32 s14, s8, 18432
    s_lshl_b32 s8, s6, 7
    s_add_u32 s14, s14, s8
    s_lshl_b32 s15, s3, 10
    s_mov_b32 s54, 5308416
    s_mov_b32 s55, 0x20000
    s_mov_b32 s58, 5308416
    s_mov_b32 s59, 0x20000
    s_waitcnt lgkmcnt(0)
    s_mov_b64 s[52:53], s[38:39]
    s_mov_b64 s[56:57], s[40:41]
    s_barrier
    s_branch F_MAIN
HELPER:
    v_lshrrev_b32 v6, 3, v2
    v_and_b32 v7, 2, v6
    v_mad_u32_u24 v7, v7, 3, v6
    v_mul_u32_u24 v5, 1152, v7
    v_and_b32 v7, 6, v6
    v_xor_b32 v7, v7, v2
    v_and_b32 v7, 7, v7
    v_lshl_add_u32 v5, v7, 4, v5
    s_lshl_b32 s8, s5, 1
    s_sub_u32 s8, s8, 20
    s_cmp_lt_u32 s2, 80
    s_cselect_b32 s8, 8, s8
    s_cselect_b32 s70, 8, 6
    s_cselect_b32 s69, 2, 4
    s_cselect_b32 s67, 1, 0
    s_cselect_b32 s71, 1, 2
    s_mul_i32 s71, s71, 72
    s_lshl_b32 s8, s8, 7
    s_mul_i32 s14, s4, 663552
    s_add_u32 s14, s14, s8
    s_mov_b32 s6, s3
    s_waitcnt lgkmcnt(0)
    s_mov_b32 s60, s42
    s_mov_b32 s61, s43
    s_mov_b32 s62, 5308416
    s_mov_b32 s63, 0x20000
    s_barrier
    s_branch DN_LOAD
RT_MAIN:
    s_mul_i32 s6, s2, 256
    s_add_u32 s6, s6, 4096
    v_lshl_add_u32 v5, v2, 2, s6
    s_cmp_lt_u32 s2, 80
    s_cselect_b32 s8, 15, 23
    v_and_b32 v14, 31, v2
    v_min_u32 v14, s8, v14
    v_and_or_b32 v14, v2, 32, v14
    s_mov_b32 s8, 163520
    v_lshl_add_u32 v14, v14, 2, s8
    v_add_u32 v13, s7, v4
    v_lshl_add_u32 v13, v13, 2, s8
    s_mov_b32 s8, 0xffff
    s_mov_b32 s10, 0x00010001
    s_mov_b32 s11, 0x00010001
    v_mov_b32 v12, 163456
    s_waitcnt lgkmcnt(0)
    s_add_u32 s12, s12, 1
    v_mov_b32 v11, s12
    ds_write_b64 v12, v[10:11]
    v_add_u32 v7, s13, v7
    s_waitcnt vmcnt(5)
    ds_read_b128 v[52:55], v6 offset:1280
    ds_read_b128 v[56:59], v6 offset:1536
    ds_read_b128 v[60:63], v6 offset:1792
    ds_read_b128 v[64:67], v6 offset:2048
    ds_read_b64 v[68:69], v7 offset:2304
    ds_read_b128 v[34:37], v6 offset:0
    ds_read_b128 v[38:41], v6 offset:256
    ds_read_b128 v[42:45], v6 offset:512
    ds_read_b128 v[46:49], v6 offset:768
    ds_read_b64 v[50:51], v7 offset:1024
    v_mov_b32 v8, 0x3f803f80
    s_waitcnt lgkmcnt(5)
    v_and_b32 v84, 0xffff, v52
    v_and_b32 v52, 0xffff0000, v52
    v_and_b32 v85, 0xffff, v53
    v_and_b32 v53, 0xffff0000, v53
    v_and_b32 v86, 0xffff, v54
    v_and_b32 v54, 0xffff0000, v54
    v_and_b32 v87, 0xffff, v55
    v_and_b32 v55, 0xffff0000, v55
    v_and_b32 v88, 0xffff, v56
    v_and_b32 v56, 0xffff0000, v56
    v_and_b32 v89, 0xffff, v57
    v_and_b32 v57, 0xffff0000, v57
    v_and_b32 v90, 0xffff, v58
    v_and_b32 v58, 0xffff0000, v58
    v_and_b32 v91, 0xffff, v59
    v_and_b32 v59, 0xffff0000, v59
    v_and_b32 v92, 0xffff, v60
    v_and_b32 v60, 0xffff0000, v60
    v_and_b32 v93, 0xffff, v61
    v_and_b32 v61, 0xffff0000, v61
    v_and_b32 v94, 0xffff, v62
    v_and_b32 v62, 0xffff0000, v62
    v_and_b32 v95, 0xffff, v63
    v_and_b32 v63, 0xffff0000, v63
    v_and_b32 v96, 0xffff, v64
    v_and_b32 v64, 0xffff0000, v64
    v_and_b32 v97, 0xffff, v65
    v_and_b32 v65, 0xffff0000, v65
    v_and_b32 v98, 0xffff, v66
    v_and_b32 v66, 0xffff0000, v66
    v_and_b32 v99, 0xffff, v67
    v_and_b32 v67, 0xffff0000, v67
    v_and_b32 v100, 0xffff, v68
    v_and_b32 v68, 0xffff0000, v68
    v_and_b32 v101, 0xffff, v69
    v_and_b32 v69, 0xffff0000, v69
    s_waitcnt lgkmcnt(0)
    s_waitcnt vmcnt(4)
    v_dot2_f32_bf16 v70, v16, v84, 0
    v_dot2_f32_bf16 v71, v16, v52, 0
    v_dot2_f32_bf16 v72, v17, v85, 0
    v_dot2_f32_bf16 v73, v17, v53, 0
    v_dot2_f32_bf16 v74, v18, v86, 0
    v_dot2_f32_bf16 v75, v18, v54, 0
    v_dot2_f32_bf16 v76, v19, v87, 0
    v_dot2_f32_bf16 v77, v19, v55, 0
    v_dot2_f32_bf16 v12, v16, v34, 0
    v_dot2_f32_bf16 v12, v17, v35, v12
    v_dot2_f32_bf16 v12, v18, v36, v12
    v_dot2_f32_bf16 v12, v19, v37, v12
    v_cvt_pk_bf16_f32 v70, v70, v71
    v_cvt_pk_bf16_f32 v72, v72, v73
    v_cvt_pk_bf16_f32 v74, v74, v75
    v_cvt_pk_bf16_f32 v76, v76, v77
    v_dot2_f32_bf16 v15, v70, v8, 0
    v_dot2_f32_bf16 v15, v72, v8, v15
    v_dot2_f32_bf16 v15, v74, v8, v15
    v_dot2_f32_bf16 v15, v76, v8, v15
    s_waitcnt vmcnt(3)
    v_dot2_f32_bf16 v70, v20, v88, 0
    v_dot2_f32_bf16 v71, v20, v56, 0
    v_dot2_f32_bf16 v72, v21, v89, 0
    v_dot2_f32_bf16 v73, v21, v57, 0
    v_dot2_f32_bf16 v74, v22, v90, 0
    v_dot2_f32_bf16 v75, v22, v58, 0
    v_dot2_f32_bf16 v76, v23, v91, 0
    v_dot2_f32_bf16 v77, v23, v59, 0
    v_dot2_f32_bf16 v12, v20, v38, v12
    v_dot2_f32_bf16 v12, v21, v39, v12
    v_dot2_f32_bf16 v12, v22, v40, v12
    v_dot2_f32_bf16 v12, v23, v41, v12
    v_cvt_pk_bf16_f32 v70, v70, v71
    v_cvt_pk_bf16_f32 v72, v72, v73
    v_cvt_pk_bf16_f32 v74, v74, v75
    v_cvt_pk_bf16_f32 v76, v76, v77
    v_dot2_f32_bf16 v15, v70, v8, v15
    v_dot2_f32_bf16 v15, v72, v8, v15
    v_dot2_f32_bf16 v15, v74, v8, v15
    v_dot2_f32_bf16 v15, v76, v8, v15
    s_waitcnt vmcnt(2)
    v_dot2_f32_bf16 v70, v24, v92, 0
    v_dot2_f32_bf16 v71, v24, v60, 0
    v_dot2_f32_bf16 v72, v25, v93, 0
    v_dot2_f32_bf16 v73, v25, v61, 0
    v_dot2_f32_bf16 v74, v26, v94, 0
    v_dot2_f32_bf16 v75, v26, v62, 0
    v_dot2_f32_bf16 v76, v27, v95, 0
    v_dot2_f32_bf16 v77, v27, v63, 0
    v_dot2_f32_bf16 v12, v24, v42, v12
    v_dot2_f32_bf16 v12, v25, v43, v12
    v_dot2_f32_bf16 v12, v26, v44, v12
    v_dot2_f32_bf16 v12, v27, v45, v12
    v_cvt_pk_bf16_f32 v70, v70, v71
    v_cvt_pk_bf16_f32 v72, v72, v73
    v_cvt_pk_bf16_f32 v74, v74, v75
    v_cvt_pk_bf16_f32 v76, v76, v77
    v_dot2_f32_bf16 v15, v70, v8, v15
    v_dot2_f32_bf16 v15, v72, v8, v15
    v_dot2_f32_bf16 v15, v74, v8, v15
    v_dot2_f32_bf16 v15, v76, v8, v15
    s_waitcnt vmcnt(1)
    v_dot2_f32_bf16 v70, v28, v96, 0
    v_dot2_f32_bf16 v71, v28, v64, 0
    v_dot2_f32_bf16 v72, v29, v97, 0
    v_dot2_f32_bf16 v73, v29, v65, 0
    v_dot2_f32_bf16 v74, v30, v98, 0
    v_dot2_f32_bf16 v75, v30, v66, 0
    v_dot2_f32_bf16 v76, v31, v99, 0
    v_dot2_f32_bf16 v77, v31, v67, 0
    v_dot2_f32_bf16 v12, v28, v46, v12
    v_dot2_f32_bf16 v12, v29, v47, v12
    v_dot2_f32_bf16 v12, v30, v48, v12
    v_dot2_f32_bf16 v12, v31, v49, v12
    v_cvt_pk_bf16_f32 v70, v70, v71
    v_cvt_pk_bf16_f32 v72, v72, v73
    v_cvt_pk_bf16_f32 v74, v74, v75
    v_cvt_pk_bf16_f32 v76, v76, v77
    v_dot2_f32_bf16 v15, v70, v8, v15
    v_dot2_f32_bf16 v15, v72, v8, v15
    v_dot2_f32_bf16 v15, v74, v8, v15
    v_dot2_f32_bf16 v15, v76, v8, v15
    s_waitcnt vmcnt(0)
    v_dot2_f32_bf16 v70, v32, v100, 0
    v_dot2_f32_bf16 v71, v32, v68, 0
    v_dot2_f32_bf16 v72, v33, v101, 0
    v_dot2_f32_bf16 v73, v33, v69, 0
    v_dot2_f32_bf16 v12, v32, v50, v12
    v_dot2_f32_bf16 v12, v33, v51, v12
    v_cvt_pk_bf16_f32 v70, v70, v71
    v_cvt_pk_bf16_f32 v72, v72, v73
    v_dot2_f32_bf16 v15, v70, v8, v15
    v_dot2_f32_bf16 v15, v72, v8, v15
    s_nop 0
    s_nop 1
    v_add_f32_dpp v15, v15, v15 row_ror:8 row_mask:0xf bank_mask:0xf
    v_add_f32_dpp v12, v12, v12 row_ror:8 row_mask:0xf bank_mask:0xf
    s_nop 0
    v_add_f32_dpp v15, v15, v15 row_ror:4 row_mask:0xf bank_mask:0xf
    v_add_f32_dpp v12, v12, v12 row_ror:4 row_mask:0xf bank_mask:0xf
    s_nop 0
    v_add_f32_dpp v15, v15, v15 row_ror:2 row_mask:0xf bank_mask:0xf
    v_add_f32_dpp v12, v12, v12 row_ror:2 row_mask:0xf bank_mask:0xf
    s_nop 0
    v_add_f32_dpp v15, v15, v15 row_ror:1 row_mask:0xf bank_mask:0xf
    v_add_f32_dpp v12, v12, v12 row_ror:1 row_mask:0xf bank_mask:0xf
    s_nop 0
    v_cvt_pk_bf16_f32 v15, 0, v15
    v_mul_f32 v15, 0xbfb8aa3b, v15
    v_exp_f32 v15, v15
    v_cvt_pk_bf16_f32 v12, v12, v12
    v_add_f32 v15, 1.0, v15
    v_rcp_f32 v15, v15
    v_ashrrev_i32 v9, 31, v12
    v_cvt_pk_bf16_f32 v15, 1.0, v15
    v_or_b32 v9, 0x80000000, v9
    v_bitop3_b32 v12, v12, v9, 1 bitop3:0xbe
    s_mov_b64 exec, s[10:11]
    ds_write2_b32 v13, v12, v15 offset0:0 offset1:32
    s_mov_b64 exec, -1
    s_cmp_lg_u32 s7, 0
    s_cbranch_scc1 RT_X
    s_mov_b32 s9, 0
SPN1:
    ds_read_b32 v12, v14 offset:0
    s_add_u32 s9, s9, 1
    s_waitcnt lgkmcnt(0)
    v_cmp_eq_u32 vcc, 0, v12
    s_cmp_ge_u32 s9, 0x40000
    s_cbranch_scc1 SPX1
    s_cbranch_vccnz SPN1
SPX1:
    v_bfi_b32 v12, s8, v11, v12
    global_store_dword v5, v12, s[50:51] sc1
    s_cmp_lg_u32 s2, 0
    s_cbranch_scc1 RT_X
    v_mov_b32 v8, v11
    v_mov_b32 v9, 1
    global_store_dwordx2 v10, v[8:9], s[48:49] sc1
RT_X:
    s_barrier
RT_TAIL:
    s_cmp_ge_u32 s2, 80
    s_cbranch_scc1 DN_JOIN
    s_cmp_lt_u32 s2, 72
    s_cbranch_scc1 RT_CTL
    s_barrier
    s_branch DN_JOIN
RT_CTL:
    s_cmp_lg_u32 s3, 8
    s_cbranch_scc1 W_END
    v_mov_b32 v14, v11
    s_mul_i32 s8, s4, 9
    s_add_u32 s8, s8, s5
    s_lshl_b32 s8, s8, 12
    s_add_u32 s8, s8, 57344
    v_lshl_add_u32 v23, v3, 7, s8
    global_load_dword v24, v23, s[50:51] sc1
    v_mov_b32 v21, 163456
    v_mov_b32 v22, 16
    s_mov_b32 s64, s16
    s_mov_b32 s65, s17
    s_mov_b32 s66, 2359296
    s_mov_b32 s67, 0x20000
    v_lshlrev_b32 v19, 4, v2
    v_lshlrev_b32 v20, 2, v2
    s_lshl_b32 s13, s4, 10
    s_add_u32 s13, s13, 40960
    s_add_u32 s7, s13, 1024
    s_sleep 16
RT_SC:
    s_load_dwordx16 s[16:31], s[50:51], s13
    s_add_u32 s13, s13, 64
    s_waitcnt lgkmcnt(0)
    s_xor_b32 s8, s17, s12
    s_xor_b32 s9, s19, s12
    s_or_b32 s8, s8, s9
    s_xor_b32 s9, s21, s12
    s_or_b32 s8, s8, s9
    s_xor_b32 s9, s23, s12
    s_or_b32 s8, s8, s9
    s_xor_b32 s9, s25, s12
    s_or_b32 s8, s8, s9
    s_xor_b32 s9, s27, s12
    s_or_b32 s8, s8, s9
    s_xor_b32 s9, s29, s12
    s_or_b32 s8, s8, s9
    s_xor_b32 s9, s31, s12
    s_or_b32 s8, s8, s9
    s_cbranch_scc0 RT_SCOK
    s_sleep 2
    s_cmp_lt_u32 s13, s7
    s_cbranch_scc1 RT_SC
    v_and_b32 v6, 7, v2
    s_lshl_b32 s9, s4, 8
    v_lshl_add_u32 v6, v6, 3, s9
    v_and_b32 v7, 7, v2
    s_lshl_b32 s9, s4, 10
    s_add_u32 s9, s9, 48896
    v_lshl_add_u32 v7, v7, 7, s9
    s_mov_b32 s12, 0
SP_C:
    s_add_u32 s12, s12, 1
    s_and_b32 s9, s12, 7
    s_cselect_b64 s[14:15], 0, -1
    v_cndmask_b32 v10, v6, v7, s[14:15]
    global_load_dwordx2 v[8:9], v10, s[50:51] offset:256 sc1
    s_waitcnt vmcnt(0)
SPC_C:
    v_cmp_ne_u32 vcc, v9, v14
    s_cmp_ge_u32 s12, 16384
    s_cbranch_scc1 SPX_C
    s_cbranch_vccz SPX_C
    s_mov_b64 exec, vcc
    s_sleep 2
    s_branch SP_C
SPX_C:
    s_mov_b64 exec, -1
    v_readlane_b32 s16, v8, 0
    v_readlane_b32 s18, v8, 1
    v_readlane_b32 s20, v8, 2
    v_readlane_b32 s22, v8, 3
    v_readlane_b32 s24, v8, 4
    v_readlane_b32 s26, v8, 5
    v_readlane_b32 s28, v8, 6
    v_readlane_b32 s30, v8, 7
RT_SCOK:
    s_mov_b32 m0, 147456
    s_andn2_b32 s76, 0x7ff, s16
    s_mul_i32 s76, s76, 1152
    s_andn2_b32 s77, 0x7ff, s18
    s_mul_i32 s77, s77, 1152
    s_andn2_b32 s78, 0x7ff, s20
    s_mul_i32 s78, s78, 1152
    s_andn2_b32 s79, 0x7ff, s22
    s_mul_i32 s79, s79, 1152
    s_andn2_b32 s80, 0x7ff, s24
    s_mul_i32 s80, s80, 1152
    s_andn2_b32 s81, 0x7ff, s26
    s_mul_i32 s81, s81, 1152
    s_andn2_b32 s82, 0x7ff, s28
    s_mul_i32 s82, s82, 1152
    s_andn2_b32 s83, 0x7ff, s30
    s_mul_i32 s83, s83, 1152
    buffer_load_dwordx4 v19, s[64:67], s76 offen lds
    buffer_load_dword v20, s[64:67], s76 offen offset:1024 lds
    s_add_u32 m0, m0, 1344
    s_nop 0
    buffer_load_dwordx4 v19, s[64:67], s77 offen lds
    buffer_load_dword v20, s[64:67], s77 offen offset:1024 lds
    s_add_u32 m0, m0, 1344
    s_nop 0
    buffer_load_dwordx4 v19, s[64:67], s78 offen lds
    buffer_load_dword v20, s[64:67], s78 offen offset:1024 lds
    s_add_u32 m0, m0, 1344
    s_nop 0
    buffer_load_dwordx4 v19, s[64:67], s79 offen lds
    buffer_load_dword v20, s[64:67], s79 offen offset:1024 lds
    s_add_u32 m0, m0, 1344
    s_nop 0
    buffer_load_dwordx4 v19, s[64:67], s80 offen lds
    buffer_load_dword v20, s[64:67], s80 offen offset:1024 lds
    s_add_u32 m0, m0, 1344
    s_nop 0
    buffer_load_dwordx4 v19, s[64:67], s81 offen lds
    buffer_load_dword v20, s[64:67], s81 offen offset:1024 lds
    s_add_u32 m0, m0, 1344
    s_nop 0
    buffer_load_dwordx4 v19, s[64:67], s82 offen lds
    buffer_load_dword v20, s[64:67], s82 offen offset:1024 lds
    s_add_u32 m0, m0, 1344
    s_nop 0
    buffer_load_dwordx4 v19, s[64:67], s83 offen lds
    buffer_load_dword v20, s[64:67], s83 offen offset:1024 lds
    s_add_u32 m0, m0, 1344
    s_nop 0
    s_waitcnt vmcnt(0)
    s_mov_b64 exec, 1
    ds_add_u32 v21, v22 offset:164
    s_mov_b64 exec, -1
    s_barrier
    s_endpgm
DN_LOAD:
    v_mov_b32 v55, 49152
    s_mov_b64 s[80:81], 0
    s_lshr_b32 s8, s6, 3
    s_lshl_b32 s8, s8, s67
    s_and_b32 s9, s6, 7
    s_lshl_b32 s12, s8, 3
    s_add_u32 s12, s12, s9
    s_lshl_b32 m0, s12, 10
    s_mul_i32 s9, s9, 9216
    s_bitcmp1_b32 s6, 0
    s_cselect_b32 s12, 6912, 0
    s_sub_u32 s9, s9, s12
    s_bitcmp1_b32 s8, 0
    s_cselect_b32 s12, 36736, 0
    s_mul_i32 s8, s8, 36864
    s_sub_u32 s8, s8, s12
    s_add_u32 s8, s8, s9
    s_add_u32 s8, s8, s14
    buffer_load_dwordx4 v5, s[60:63], s8 offen  lds
    s_add_u32 s6, s6, s70
    s_waitcnt vmcnt(0)
    s_mov_b32 s13, 0
DN_L1:
    s_lshr_b32 s8, s6, 3
    s_lshl_b32 s8, s8, s67
    s_and_b32 s9, s6, 7
    s_lshl_b32 s12, s8, 3
    s_add_u32 s12, s12, s9
    s_lshl_b32 m0, s12, 10
    s_mul_i32 s9, s9, 9216
    s_bitcmp1_b32 s6, 0
    s_cselect_b32 s12, 6912, 0
    s_sub_u32 s9, s9, s12
    s_bitcmp1_b32 s8, 0
    s_cselect_b32 s12, 36736, 0
    s_mul_i32 s8, s8, 36864
    s_sub_u32 s8, s8, s12
    s_add_u32 s8, s8, s9
    s_add_u32 s8, s8, s14
    buffer_load_dwordx4 v5, s[60:63], s8 offen  lds
    s_add_u32 s6, s6, s70
    s_add_u32 s13, s13, 1
    s_cmp_lt_u32 s13, s69
    s_cbranch_scc1 DN_L1
    s_cmp_lt_u32 s2, 80
    s_cbranch_scc1 SEL_MAIN
    s_barrier
DN_L2:
    s_cmp_ge_u32 s6, s71
    s_cbranch_scc1 DN_LX
    s_waitcnt vmcnt(5)
    s_lshr_b32 s8, s6, 3
    s_lshl_b32 s8, s8, s67
    s_and_b32 s9, s6, 7
    s_lshl_b32 s12, s8, 3
    s_add_u32 s12, s12, s9
    s_lshl_b32 m0, s12, 10
    s_mul_i32 s9, s9, 9216
    s_bitcmp1_b32 s6, 0
    s_cselect_b32 s12, 6912, 0
    s_sub_u32 s9, s9, s12
    s_bitcmp1_b32 s8, 0
    s_cselect_b32 s12, 36736, 0
    s_mul_i32 s8, s8, 36864
    s_sub_u32 s8, s8, s12
    s_add_u32 s8, s8, s9
    s_add_u32 s8, s8, s14
    buffer_load_dwordx4 v5, s[60:63], s8 offen  lds
    s_add_u32 s6, s6, s70
    s_branch DN_L2
DN_LX:
    v_mov_b32 v21, 163456
    v_mov_b32 v22, 1
    s_cmp_lt_u32 s2, 80
    s_cbranch_scc1 DN_LS
    s_waitcnt vmcnt(5)
    s_branch DN_LP
DN_LS:
    s_waitcnt vmcnt(2)
    s_mov_b64 exec, s[80:81]
    s_cbranch_execz DN_NOB
    global_store_dwordx2 v55, v[48:49], s[50:51] sc1
DN_NOB:
    s_mov_b64 exec, -1
DN_LP:
    s_mov_b64 exec, 1
    ds_add_u32 v21, v22 offset:160
    s_mov_b64 exec, -1
DN_JOIN:
    v_mov_b32 v21, 163456
    ds_read_b32 v14, v21 offset:4
    v_and_b32 v18, 1, v4
    v_bfe_u32 v6, v2, 2, 2
    v_lshl_add_u32 v18, v18, 2, v6
    v_lshrrev_b32 v19, 1, v18
    v_lshlrev_b32 v18, 7, v18
    v_and_b32 v7, 3, v2
    v_lshl_add_u32 v18, v7, 3, v18
    v_lshrrev_b32 v6, 1, v4
    v_lshl_add_u32 v18, v6, 11, v18
    s_and_b32 s9, s3, 3
    v_xor_b32 v19, s9, v19
    v_lshl_add_u32 v18, v19, 5, v18
    s_lshr_b32 s8, s3, 2
    s_lshl_b32 s8, s8, 13
    v_add_u32 v8, s8, v18
    v_add_u32 v9, 49152, v8
    v_add_u32 v10, 98304, v8
    v_lshrrev_b32 v11, 1, v3
    v_mul_u32_u24 v11, 1344, v11
    v_lshl_add_u32 v11, v4, 5, v11
    v_and_b32 v22, 1, v2
    v_lshl_add_u32 v11, v22, 4, v11
    v_add_u32 v11, 147456, v11
    v_mul_u32_u24 v22, 0xaaaa, v22
    v_add_u32 v22, 0x4444, v22
    v_mov_b32 v132, 0
    v_mov_b32 v133, 0
    v_mov_b32 v134, 0
    v_mov_b32 v135, 0
    v_lshrrev_b32 v12, 2, v3
    v_mul_u32_u24 v17, 2688, v12
    v_mul_u32_u24 v12, 1152, v12
    v_lshl_add_u32 v12, v7, 4, v12
    v_lshl_add_u32 v12, v6, 6, v12
    s_lshl_b32 s8, s5, 3
    s_sub_u32 s8, s8, 80
    s_cmp_lt_u32 s2, 80
    s_cselect_b32 s8, 32, s8
    s_cselect_b32 s13, 4, 8
    s_cselect_b32 s15, 8, 6
    s_add_u32 s8, s8, s3
    s_mul_i32 s8, s8, 4608
    s_lshl_b32 s9, s4, 7
    s_add_u32 s8, s8, s9
    s_add_u32 s8, s8, 352256
    v_add_u32 v12, s8, v12
    s_sub_u32 s9, s3, 3
    s_mul_i32 s8, s4, 9
    s_add_u32 s8, s8, s9
    s_lshl_b32 s8, s8, 12
    s_add_u32 s8, s8, 57344
    v_lshl_add_u32 v16, v2, 5, s8
    v_lshl_add_u32 v17, v4, 5, v17
    v_lshl_add_u32 v17, v7, 3, v17
    s_lshl_b32 s9, s9, 7
    s_add_u32 s9, s9, 147456
    v_add_u32 v17, s9, v17
    s_mov_b32 s10, 0xffff
    s_mov_b32 s11, 0xffff
    s_movk_i32 s78, 0xff
    s_mov_b32 s76, 0x07060302
    s_cmp_ge_u32 s3, s13
    s_cbranch_scc1 DN_NOF
    s_mov_b32 s9, 0
SPN2:
    ds_read_b32 v23, v21 offset:160
    s_add_u32 s9, s9, 1
    s_waitcnt lgkmcnt(0)
    v_cmp_ne_u32 vcc, s15, v23
    s_cmp_ge_u32 s9, 0x40000
    s_cbranch_scc1 SPX2
    s_cbranch_vccz SPX2
    s_sleep 2
    s_branch SPN2
SPX2:
    ds_read_b64_tr_b16 v[24:25], v8 offset:0
    ds_read_b64_tr_b16 v[26:27], v8 offset:1024
    ds_read_b64_tr_b16 v[28:29], v8 offset:4096
    ds_read_b64_tr_b16 v[30:31], v8 offset:5120
    ds_read_b64_tr_b16 v[32:33], v8 offset:16384
    ds_read_b64_tr_b16 v[34:35], v8 offset:17408
    ds_read_b64_tr_b16 v[36:37], v8 offset:20480
    ds_read_b64_tr_b16 v[38:39], v8 offset:21504
    ds_read_b64_tr_b16 v[40:41], v8 offset:32768
    ds_read_b64_tr_b16 v[42:43], v8 offset:33792
    ds_read_b64_tr_b16 v[44:45], v8 offset:36864
    ds_read_b64_tr_b16 v[46:47], v8 offset:37888
    ds_read_b64_tr_b16 v[48:49], v9 offset:0
    ds_read_b64_tr_b16 v[50:51], v9 offset:1024
    ds_read_b64_tr_b16 v[52:53], v9 offset:4096
    ds_read_b64_tr_b16 v[54:55], v9 offset:5120
    ds_read_b64_tr_b16 v[56:57], v9 offset:16384
    ds_read_b64_tr_b16 v[58:59], v9 offset:17408
    ds_read_b64_tr_b16 v[60:61], v9 offset:20480
    ds_read_b64_tr_b16 v[62:63], v9 offset:21504
    ds_read_b64_tr_b16 v[64:65], v9 offset:32768
    ds_read_b64_tr_b16 v[66:67], v9 offset:33792
    ds_read_b64_tr_b16 v[68:69], v9 offset:36864
    ds_read_b64_tr_b16 v[70:71], v9 offset:37888
    ds_read_b64_tr_b16 v[72:73], v10 offset:0
    ds_read_b64_tr_b16 v[74:75], v10 offset:1024
    ds_read_b64_tr_b16 v[76:77], v10 offset:4096
    ds_read_b64_tr_b16 v[78:79], v10 offset:5120
DN_NOF:
    s_waitcnt vmcnt(0) lgkmcnt(0)
    s_barrier
    s_cmp_ge_u32 s3, s13
    s_cbranch_scc1 DN_NOF2
    ds_read_b64_tr_b16 v[80:81], v10 offset:16384
    ds_read_b64_tr_b16 v[82:83], v10 offset:17408
    ds_read_b64_tr_b16 v[84:85], v10 offset:20480
    ds_read_b64_tr_b16 v[86:87], v10 offset:21504
    ds_read_b64_tr_b16 v[88:89], v10 offset:32768
    ds_read_b64_tr_b16 v[90:91], v10 offset:33792
    ds_read_b64_tr_b16 v[92:93], v10 offset:36864
    ds_read_b64_tr_b16 v[94:95], v10 offset:37888
DN_NOF2:
    s_cmp_lt_u32 s3, 3
    s_cbranch_scc1 DN_W
    s_mov_b32 s12, 0
DN_POLL:
    s_add_u32 s12, s12, 1
    s_and_b32 s8, s12, 15
    s_cselect_b32 s8, 0, 2048
    v_add_u32 v20, s8, v16
    global_load_dwordx4 v[96:99], v20, s[50:51] sc1
    global_load_dwordx4 v[100:103], v20, s[50:51] offset:16 sc1
    s_waitcnt vmcnt(0)
    v_xor_b32 v20, v96, v14
    v_bitop3_b32 v20, v20, v97, v14 bitop3:0xf6
    v_bitop3_b32 v20, v20, v98, v14 bitop3:0xf6
    v_bitop3_b32 v20, v20, v99, v14 bitop3:0xf6
    v_bitop3_b32 v20, v20, v100, v14 bitop3:0xf6
    v_bitop3_b32 v20, v20, v101, v14 bitop3:0xf6
    v_bitop3_b32 v20, v20, v102, v14 bitop3:0xf6
    v_bitop3_b32 v20, v20, v103, v14 bitop3:0xf6
    v_and_b32 v20, 0xffff, v20
    v_cmp_ne_u32 vcc, 0, v20
    s_cmp_ge_u32 s12, 65536
    s_cbranch_scc1 DN_GOT
    s_cbranch_vccnz DN_POLL
DN_GOT:
    v_perm_b32 v104, v98, v96, s76
    v_perm_b32 v105, v102, v100, s76
    v_perm_b32 v106, v99, v97, s76
    v_perm_b32 v107, v103, v101, s76
    ds_write_b64 v17, v[104:105]
    ds_write_b64 v17, v[106:107] offset:1344
DN_W:
    s_waitcnt lgkmcnt(0)
    s_barrier
    s_cmp_ge_u32 s3, s13
    s_cbranch_scc1 W_END
    ds_read_b128 v[96:99], v11 offset:0
    ds_read_b128 v[100:103], v11 offset:128
    ds_read_b128 v[104:107], v11 offset:256
    ds_read_b128 v[108:111], v11 offset:384
    ds_read_b128 v[112:115], v11 offset:512
    ds_read_b128 v[116:119], v11 offset:640
    ds_read_b128 v[120:123], v11 offset:768
    ds_read_b128 v[124:127], v11 offset:896
    ds_read_b128 v[128:131], v11 offset:1024
    s_waitcnt lgkmcnt(8)
    v_smfmac_f32_16x16x64_bf16 v[132:135], v[96:99], v[24:31], v22
    s_waitcnt lgkmcnt(7)
    v_smfmac_f32_16x16x64_bf16 v[132:135], v[100:103], v[32:39], v22
    s_waitcnt lgkmcnt(6)
    v_smfmac_f32_16x16x64_bf16 v[132:135], v[104:107], v[40:47], v22
    s_waitcnt lgkmcnt(5)
    v_smfmac_f32_16x16x64_bf16 v[132:135], v[108:111], v[48:55], v22
    s_waitcnt lgkmcnt(4)
    v_smfmac_f32_16x16x64_bf16 v[132:135], v[112:115], v[56:63], v22
    s_waitcnt lgkmcnt(3)
    v_smfmac_f32_16x16x64_bf16 v[132:135], v[116:119], v[64:71], v22
    s_waitcnt lgkmcnt(2)
    v_smfmac_f32_16x16x64_bf16 v[132:135], v[120:123], v[72:79], v22
    s_waitcnt lgkmcnt(1)
    v_smfmac_f32_16x16x64_bf16 v[132:135], v[124:127], v[80:87], v22
    s_waitcnt lgkmcnt(0)
    v_smfmac_f32_16x16x64_bf16 v[132:135], v[128:131], v[88:95], v22
    s_nop 7
    v_add_f32 v136, v132, v133
    v_add_f32 v137, v134, v135
    v_bfi_b32 v138, s78, v14, v136
    v_bfi_b32 v139, s78, v14, v137
    v_bfi_b32 v136, s78, v14, v136
    v_bfi_b32 v137, s78, v14, v137
    s_nop 0
    v_permlane16_swap_b32 v136, v138
    v_permlane16_swap_b32 v137, v139
    s_mov_b64 exec, s[10:11]
    global_store_dwordx4 v12, v[136:139], s[50:51] sc1
    s_cmp_lg_u32 s3, 3
    s_cbranch_scc1 DN_NOHINT
    s_lshl_b32 s8, s4, 7
    s_lshl_b32 s9, s5, 2
    s_add_u32 s8, s8, s9
    v_mov_b32 v20, s8
    global_store_dword v20, v14, s[50:51] offset:2268
    s_cmp_lg_u32 s2, 72
    s_cbranch_scc1 DN_NOHINT
    v_mov_b32 v20, 0
    global_store_dword v20, v14, s[50:51] sc1
DN_NOHINT:
    s_endpgm
F_MAIN:
    v_and_b32 v7, 7, v2
    s_add_u32 m0, s15, 0
    s_add_u32 s8, s14, 0
    buffer_load_dwordx4 v5, s[52:55], s8 offen  lds
    s_add_u32 m0, s15, 73728
    s_add_u32 s8, s14, 0
    buffer_load_dwordx4 v5, s[56:59], s8 offen  lds
    s_and_b32 s12, s3, 3
    v_and_b32 v18, 1, v4
    v_bfe_u32 v6, v2, 2, 2
    v_lshl_add_u32 v18, v18, 2, v6
    v_lshrrev_b32 v6, 1, v18
    v_xor_b32 v6, s12, v6
    v_lshlrev_b32 v18, 7, v18
    v_lshl_add_u32 v18, v6, 5, v18
    v_and_b32 v6, 3, v2
    v_lshl_add_u32 v18, v6, 3, v18
    v_lshrrev_b32 v6, 1, v4
    v_lshl_add_u32 v18, v6, 11, v18
    v_add_u32 v6, 73728, v18
    v_add_u32 v0, 40960, v18
    v_add_u32 v1, 40960, v6
    v_lshrrev_b32 v8, 1, v3
    v_mul_u32_u24 v8, 1344, v8
    v_lshl_add_u32 v8, v4, 5, v8
    v_and_b32 v9, 1, v2
    v_lshl_add_u32 v8, v9, 4, v8
    v_add_u32 v8, 147456, v8
    v_mul_u32_u24 v9, 0xaaaa, v9
    v_add_u32 v9, 0x4444, v9
    s_lshl_b32 s8, s6, 12
    s_lshl_b32 s9, s3, 9
    s_add_u32 s8, s8, s9
    s_add_u32 s8, s8, 57344
    v_lshl_add_u32 v11, v2, 3, s8
    s_mov_b32 s76, 0xffff
    v_mov_b32 v21, 163456
    v_mov_b32 v22, 1
    s_mov_b32 s10, 0xff00ff00
    s_mov_b32 s11, 0xff00ff00
    s_waitcnt vmcnt(0)
    s_add_u32 m0, s15, 8192
    s_add_u32 s8, s14, 589824
    buffer_load_dwordx4 v5, s[52:55], s8 offen  lds
    s_add_u32 m0, s15, 81920
    s_add_u32 s8, s14, 589824
    buffer_load_dwordx4 v5, s[56:59], s8 offen  lds
    s_add_u32 m0, s15, 16384
    s_add_u32 s8, s14, 1179648
    buffer_load_dwordx4 v5, s[52:55], s8 offen  lds
    v_mov_b32 v160, 0
    v_mov_b32 v161, 0
    v_mov_b32 v162, 0
    v_mov_b32 v163, 0
    v_mov_b32 v164, 0
    v_mov_b32 v165, 0
    v_mov_b32 v166, 0
    v_mov_b32 v167, 0
    s_barrier
    ds_read_b32 v14, v21 offset:4
    s_add_u32 m0, s15, 90112
    s_add_u32 s8, s14, 1179648
    buffer_load_dwordx4 v5, s[56:59], s8 offen  lds
    s_waitcnt vmcnt(3)
    s_add_u32 m0, s15, 24576
    s_add_u32 s8, s14, 1769472
    buffer_load_dwordx4 v5, s[52:55], s8 offen  lds
    s_waitcnt vmcnt(3)
    s_add_u32 m0, s15, 98304
    s_add_u32 s8, s14, 1769472
    buffer_load_dwordx4 v5, s[56:59], s8 offen  lds
    s_waitcnt vmcnt(3)
    s_add_u32 m0, s15, 32768
    s_add_u32 s8, s14, 2359296
    buffer_load_dwordx4 v5, s[52:55], s8 offen  lds
    s_waitcnt vmcnt(3)
    s_add_u32 m0, s15, 106496
    s_add_u32 s8, s14, 2359296
    buffer_load_dwordx4 v5, s[56:59], s8 offen  lds
    s_waitcnt vmcnt(3)
    s_add_u32 m0, s15, 40960
    s_add_u32 s8, s14, 2949120
    buffer_load_dwordx4 v5, s[52:55], s8 offen  lds
    s_waitcnt vmcnt(3)
    s_add_u32 m0, s15, 114688
    s_add_u32 s8, s14, 2949120
    buffer_load_dwordx4 v5, s[56:59], s8 offen  lds
    s_waitcnt vmcnt(3)
    s_add_u32 m0, s15, 49152
    s_add_u32 s8, s14, 3538944
    buffer_load_dwordx4 v5, s[52:55], s8 offen  lds
    s_waitcnt vmcnt(3)
    s_add_u32 m0, s15, 122880
    s_add_u32 s8, s14, 3538944
    buffer_load_dwordx4 v5, s[56:59], s8 offen  lds
    s_waitcnt vmcnt(3)
    s_add_u32 m0, s15, 57344
    s_add_u32 s8, s14, 4128768
    buffer_load_dwordx4 v5, s[52:55], s8 offen  lds
    s_waitcnt vmcnt(3)
    s_add_u32 m0, s15, 131072
    s_add_u32 s8, s14, 4128768
    buffer_load_dwordx4 v5, s[56:59], s8 offen  lds
    s_waitcnt vmcnt(3)
    s_add_u32 m0, s15, 65536
    s_add_u32 s8, s14, 4718592
    buffer_load_dwordx4 v5, s[52:55], s8 offen  lds
    s_waitcnt vmcnt(3)
    s_add_u32 m0, s15, 139264
    s_add_u32 s8, s14, 4718592
    buffer_load_dwordx4 v5, s[56:59], s8 offen  lds
    s_waitcnt vmcnt(4)
    s_mov_b64 exec, 1
    ds_add_u32 v21, v22 offset:160
    s_mov_b64 exec, -1
    s_cmp_ge_u32 s3, 4
    s_cbranch_scc1 F_LD
    s_mov_b32 s9, 0
SPN3:
    ds_read_b32 v23, v21 offset:160
    s_add_u32 s9, s9, 1
    s_waitcnt lgkmcnt(0)
    v_cmp_ne_u32 vcc, 8, v23
    s_cmp_ge_u32 s9, 0x40000
    s_cbranch_scc1 SPX3
    s_cbranch_vccnz SPN3
SPX3:
    ds_read_b64_tr_b16 v[24:25], v18 offset:0
    ds_read_b64_tr_b16 v[26:27], v18 offset:1024
    ds_read_b64_tr_b16 v[28:29], v18 offset:4096
    ds_read_b64_tr_b16 v[30:31], v18 offset:5120
    ds_read_b64_tr_b16 v[32:33], v6 offset:0
    ds_read_b64_tr_b16 v[34:35], v6 offset:1024
    ds_read_b64_tr_b16 v[36:37], v6 offset:4096
    ds_read_b64_tr_b16 v[38:39], v6 offset:5120
    ds_read_b64_tr_b16 v[40:41], v18 offset:8192
    ds_read_b64_tr_b16 v[42:43], v18 offset:9216
    ds_read_b64_tr_b16 v[44:45], v18 offset:12288
    ds_read_b64_tr_b16 v[46:47], v18 offset:13312
    ds_read_b64_tr_b16 v[48:49], v6 offset:8192
    ds_read_b64_tr_b16 v[50:51], v6 offset:9216
    ds_read_b64_tr_b16 v[52:53], v6 offset:12288
    ds_read_b64_tr_b16 v[54:55], v6 offset:13312
    ds_read_b64_tr_b16 v[56:57], v18 offset:16384
    ds_read_b64_tr_b16 v[58:59], v18 offset:17408
    ds_read_b64_tr_b16 v[60:61], v18 offset:20480
    ds_read_b64_tr_b16 v[62:63], v18 offset:21504
    ds_read_b64_tr_b16 v[64:65], v6 offset:16384
    ds_read_b64_tr_b16 v[66:67], v6 offset:17408
    ds_read_b64_tr_b16 v[68:69], v6 offset:20480
    ds_read_b64_tr_b16 v[70:71], v6 offset:21504
    ds_read_b64_tr_b16 v[72:73], v18 offset:24576
    ds_read_b64_tr_b16 v[74:75], v18 offset:25600
    ds_read_b64_tr_b16 v[76:77], v18 offset:28672
    ds_read_b64_tr_b16 v[78:79], v18 offset:29696
    ds_read_b64_tr_b16 v[80:81], v6 offset:24576
    ds_read_b64_tr_b16 v[82:83], v6 offset:25600
    ds_read_b64_tr_b16 v[84:85], v6 offset:28672
    ds_read_b64_tr_b16 v[86:87], v6 offset:29696
    ds_read_b64_tr_b16 v[88:89], v18 offset:32768
    ds_read_b64_tr_b16 v[90:91], v18 offset:33792
    ds_read_b64_tr_b16 v[92:93], v18 offset:36864
    ds_read_b64_tr_b16 v[94:95], v18 offset:37888
    ds_read_b64_tr_b16 v[96:97], v6 offset:32768
    ds_read_b64_tr_b16 v[98:99], v6 offset:33792
    ds_read_b64_tr_b16 v[100:101], v6 offset:36864
    ds_read_b64_tr_b16 v[102:103], v6 offset:37888
    ds_read_b64_tr_b16 v[104:105], v0 offset:0
    ds_read_b64_tr_b16 v[106:107], v0 offset:1024
    ds_read_b64_tr_b16 v[108:109], v0 offset:4096
    ds_read_b64_tr_b16 v[110:111], v0 offset:5120
    ds_read_b64_tr_b16 v[112:113], v1 offset:0
    ds_read_b64_tr_b16 v[114:115], v1 offset:1024
    ds_read_b64_tr_b16 v[116:117], v1 offset:4096
    ds_read_b64_tr_b16 v[118:119], v1 offset:5120
    ds_read_b64_tr_b16 v[120:121], v0 offset:8192
    ds_read_b64_tr_b16 v[122:123], v0 offset:9216
    ds_read_b64_tr_b16 v[124:125], v0 offset:12288
    ds_read_b64_tr_b16 v[126:127], v0 offset:13312
    ds_read_b64_tr_b16 v[128:129], v1 offset:8192
    ds_read_b64_tr_b16 v[130:131], v1 offset:9216
    ds_read_b64_tr_b16 v[132:133], v1 offset:12288
    ds_read_b64_tr_b16 v[134:135], v1 offset:13312
    s_mov_b32 s9, 0
SPN4:
    ds_read_b32 v23, v21 offset:164
    s_add_u32 s9, s9, 1
    s_waitcnt lgkmcnt(0)
    v_cmp_eq_u32 vcc, 0, v23
    s_cmp_ge_u32 s9, 0x40000
    s_cbranch_scc1 SPX4
    s_cbranch_vccnz SPN4
SPX4:
    ds_read_b128 v[136:139], v8 offset:0
    ds_read_b128 v[140:143], v8 offset:128
    ds_read_b128 v[144:147], v8 offset:256
    ds_read_b128 v[148:151], v8 offset:384
    ds_read_b128 v[152:155], v8 offset:512
    ds_read_b128 v[156:159], v8 offset:640
    s_waitcnt lgkmcnt(5)
    v_smfmac_f32_16x16x64_bf16 v[160:163], v[136:139], v[24:31], v9
    v_smfmac_f32_16x16x64_bf16 v[164:167], v[136:139], v[32:39], v9
    s_waitcnt lgkmcnt(4)
    v_smfmac_f32_16x16x64_bf16 v[160:163], v[140:143], v[40:47], v9
    v_smfmac_f32_16x16x64_bf16 v[164:167], v[140:143], v[48:55], v9
    ds_read_b128 v[136:139], v8 offset:768
    s_waitcnt lgkmcnt(4)
    v_smfmac_f32_16x16x64_bf16 v[160:163], v[144:147], v[56:63], v9
    v_smfmac_f32_16x16x64_bf16 v[164:167], v[144:147], v[64:71], v9
    ds_read_b128 v[140:143], v8 offset:896
    s_waitcnt lgkmcnt(4)
    v_smfmac_f32_16x16x64_bf16 v[160:163], v[148:151], v[72:79], v9
    v_smfmac_f32_16x16x64_bf16 v[164:167], v[148:151], v[80:87], v9
    ds_read_b128 v[144:147], v8 offset:1024
    s_waitcnt lgkmcnt(4)
    v_smfmac_f32_16x16x64_bf16 v[160:163], v[152:155], v[88:95], v9
    v_smfmac_f32_16x16x64_bf16 v[164:167], v[152:155], v[96:103], v9
    s_waitcnt lgkmcnt(3)
    v_smfmac_f32_16x16x64_bf16 v[160:163], v[156:159], v[104:111], v9
    v_smfmac_f32_16x16x64_bf16 v[164:167], v[156:159], v[112:119], v9
    s_waitcnt lgkmcnt(2)
    v_smfmac_f32_16x16x64_bf16 v[160:163], v[136:139], v[120:127], v9
    v_smfmac_f32_16x16x64_bf16 v[164:167], v[136:139], v[128:135], v9
F_LD:
    s_waitcnt vmcnt(0)
    s_barrier
    s_cmp_ge_u32 s3, 4
    s_cbranch_scc1 W_END
    ds_read_b64_tr_b16 v[24:25], v0 offset:16384
    ds_read_b64_tr_b16 v[26:27], v0 offset:17408
    ds_read_b64_tr_b16 v[28:29], v0 offset:20480
    ds_read_b64_tr_b16 v[30:31], v0 offset:21504
    ds_read_b64_tr_b16 v[32:33], v1 offset:16384
    ds_read_b64_tr_b16 v[34:35], v1 offset:17408
    ds_read_b64_tr_b16 v[36:37], v1 offset:20480
    ds_read_b64_tr_b16 v[38:39], v1 offset:21504
    ds_read_b64_tr_b16 v[40:41], v0 offset:24576
    ds_read_b64_tr_b16 v[42:43], v0 offset:25600
    ds_read_b64_tr_b16 v[44:45], v0 offset:28672
    ds_read_b64_tr_b16 v[46:47], v0 offset:29696
    ds_read_b64_tr_b16 v[48:49], v1 offset:24576
    ds_read_b64_tr_b16 v[50:51], v1 offset:25600
    ds_read_b64_tr_b16 v[52:53], v1 offset:28672
    ds_read_b64_tr_b16 v[54:55], v1 offset:29696
    s_waitcnt lgkmcnt(12)
    v_smfmac_f32_16x16x64_bf16 v[160:163], v[140:143], v[24:31], v9
    s_waitcnt lgkmcnt(8)
    v_smfmac_f32_16x16x64_bf16 v[164:167], v[140:143], v[32:39], v9
    s_waitcnt lgkmcnt(4)
    v_smfmac_f32_16x16x64_bf16 v[160:163], v[144:147], v[40:47], v9
    s_waitcnt lgkmcnt(0)
    v_smfmac_f32_16x16x64_bf16 v[164:167], v[144:147], v[48:55], v9
    s_nop 6
    v_add_f32 v24, v160, v161
    v_add_f32 v25, v162, v163
    v_add_f32 v26, v164, v165
    v_add_f32 v27, v166, v167
    v_cvt_pk_bf16_f32 v24, 0, v24
    v_cvt_pk_bf16_f32 v25, 0, v25
    v_cvt_pk_bf16_f32 v26, 0, v26
    v_cvt_pk_bf16_f32 v27, 0, v27
    v_mul_f32 v28, 0xbfb8aa3b, v24
    v_mul_f32 v29, 0xbfb8aa3b, v25
    v_exp_f32 v28, v28
    v_exp_f32 v29, v29
    v_add_f32 v28, 1.0, v28
    v_add_f32 v29, 1.0, v29
    v_rcp_f32 v28, v28
    v_rcp_f32 v29, v29
    v_mul_f32 v24, v24, v28
    v_mul_f32 v25, v25, v29
    v_cvt_pk_bf16_f32 v24, 0, v24
    v_cvt_pk_bf16_f32 v25, 0, v25
    v_mul_f32 v24, v24, v26
    v_mul_f32 v25, v25, v27
    v_cvt_pk_bf16_f32 v24, 0, v24
    v_cvt_pk_bf16_f32 v25, 0, v25
    v_bfi_b32 v24, s76, v14, v24
    v_bfi_b32 v25, s76, v14, v25
    global_store_dwordx2 v11, v[24:25], s[50:51]
    global_store_dwordx2 v11, v[24:25], s[50:51] offset:2048 sc1
    s_endpgm
SEL_MAIN:
    v_min_u32 v19, 8, v2
    v_lshlrev_b32 v19, 7, v19
    v_lshlrev_b32 v20, 2, v2
    v_lshrrev_b32 v24, 2, v2
    v_mul_u32_u24 v24, 256, v24
    v_and_b32 v37, 3, v2
    v_lshl_add_u32 v24, v37, 4, v24
    v_lshrrev_b32 v36, 1, v2
    v_mul_u32_u24 v36, 256, v36
    v_and_b32 v37, 1, v2
    v_lshl_add_u32 v36, v37, 4, v36
    v_add_u32 v36, 20544, v36
    s_mul_i32 s8, s3, 4096
    v_add_u32 v24, s8, v24
    s_cmp_eq_u32 s3, 7
    s_cselect_b64 vcc, -1, 0
    v_cndmask_b32 v24, v24, v36, vcc
    v_add_u32 v24, 4096, v24
    s_lshl_b32 s8, s3, 8
    s_sub_u32 s8, 0xfff, s8
    v_sub_u32 v32, s8, v20
    v_subrev_u32 v33, 1, v32
    v_subrev_u32 v34, 2, v32
    v_subrev_u32 v35, 3, v32
    v_mov_b32 v21, 163456
    s_lshl_b32 s8, s3, 5
    s_add_u32 s8, s8, 163200
    v_lshl_add_u32 v25, v4, 3, s8
    s_mov_b32 s74, 0x01010101
    s_mov_b32 s75, 0x01010101
    s_lshl_b32 s9, s4, 10
    s_add_u32 s9, s9, 40960
    v_lshl_add_u32 v53, v2, 4, s9
    global_load_dword v54, v53, s[50:51] sc1
    v_lshrrev_b32 v52, 3, v2
    v_lshl_add_u32 v52, v52, 6, s9
    v_and_b32 v27, 28, v20
    v_add_u32 v27, s8, v27
    v_add_u32 v26, 163200, v20
    s_mov_b32 s76, 0xffff
    s_mov_b32 s10, 0x00010001
    s_mov_b32 s11, 0x00010001
    s_barrier
    ds_read_b32 v14, v21 offset:4
    s_mov_b32 s7, 0
    s_waitcnt lgkmcnt(0)
    s_waitcnt vmcnt(0)
F_POLL:
    global_load_dwordx4 v[28:31], v24, s[50:51] sc1
    s_add_u32 s7, s7, 1
    s_waitcnt vmcnt(0)
    v_xor_b32 v36, v28, v14
    v_bitop3_b32 v36, v36, v29, v14 bitop3:0xf6
    v_bitop3_b32 v36, v36, v30, v14 bitop3:0xf6
    v_bitop3_b32 v36, v36, v31, v14 bitop3:0xf6
    v_and_b32 v36, 0xffff, v36
    v_cmp_ne_u32 vcc, 0, v36
    s_cmp_ge_u32 s7, 16384
    s_cbranch_scc1 F_GOT
    s_cbranch_vccz F_GOT
    s_mov_b64 exec, vcc
    s_sleep 4
    s_branch F_POLL
F_GOT:
    s_mov_b64 exec, -1
    v_bfi_b32 v28, s76, v32, v28
    v_bfi_b32 v29, s76, v33, v29
    v_bfi_b32 v30, s76, v34, v30
    v_bfi_b32 v31, s76, v35, v31
    v_max_u32 v36, v28, v29
    v_min_u32 v37, v28, v29
    v_max3_u32 v40, v36, v30, v31
    v_med3_u32 v41, v36, v30, v31
    v_med3_u32 v42, v37, v30, v31
    v_max_u32 v41, v41, v37
    v_min_u32 v42, v42, v36
    v_max_u32_dpp v44, v40, v40 row_ror:8 row_mask:0xf bank_mask:0xf
    s_nop 1
    v_max_u32_dpp v44, v44, v44 row_ror:4 row_mask:0xf bank_mask:0xf
    s_nop 1
    v_max_u32_dpp v44, v44, v44 row_ror:2 row_mask:0xf bank_mask:0xf
    s_nop 1
    v_max_u32_dpp v44, v44, v44 row_ror:1 row_mask:0xf bank_mask:0xf
    v_cmp_eq_u32 vcc, v40, v44
    s_nop 1
    v_cndmask_b32 v40, v40, v41, vcc
    v_cndmask_b32 v41, v41, v42, vcc
    s_nop 0
    v_max_u32_dpp v45, v40, v40 row_ror:8 row_mask:0xf bank_mask:0xf
    s_nop 1
    v_max_u32_dpp v45, v45, v45 row_ror:4 row_mask:0xf bank_mask:0xf
    s_nop 1
    v_max_u32_dpp v45, v45, v45 row_ror:2 row_mask:0xf bank_mask:0xf
    s_nop 1
    v_max_u32_dpp v45, v45, v45 row_ror:1 row_mask:0xf bank_mask:0xf
    v_cmp_eq_u32 vcc, v40, v45
    s_nop 1
    v_cndmask_b32 v40, v40, v41, vcc
    s_nop 1
    v_max_u32_dpp v46, v40, v40 row_ror:8 row_mask:0xf bank_mask:0xf
    s_nop 1
    v_max_u32_dpp v46, v46, v46 row_ror:4 row_mask:0xf bank_mask:0xf
    s_nop 1
    v_max_u32_dpp v46, v46, v46 row_ror:2 row_mask:0xf bank_mask:0xf
    s_nop 1
    v_max_u32_dpp v46, v46, v46 row_ror:1 row_mask:0xf bank_mask:0xf
    s_mov_b64 exec, s[10:11]
    ds_write_b64 v25, v[44:45]
    ds_max_u32 v21, v46
    s_mov_b64 exec, -1
    v_readlane_b32 s77, v44, 0
    v_readlane_b32 s78, v45, 0
    v_readlane_b32 s79, v44, 16
    v_readlane_b32 s80, v45, 16
    v_readlane_b32 s81, v44, 32
    v_readlane_b32 s82, v45, 32
    v_readlane_b32 s83, v44, 48
    v_readlane_b32 s100, v45, 48
    ds_read_b32 v48, v27
    v_mov_b32 v49, v14
    s_lshl_b32 s72, s4, 8
    s_lshl_b32 s73, s4, 10
    s_add_u32 s73, s73, 49152
    s_waitcnt lgkmcnt(0)
    s_barrier
    ds_read_b32 v36, v26
    ds_read_b32 v37, v21
    v_not_b32 v50, v48
    v_and_b32 v50, 0x7ff, v50
    v_mul_u32_u24 v50, 1152, v50
    s_waitcnt lgkmcnt(0)
    v_cmp_gt_u32 vcc, v36, v37
    v_cmp_lt_u32 s[18:19], s77, v36
    v_cmp_lt_u32 s[20:21], s78, v36
    v_cmp_lt_u32 s[22:23], s79, v36
    v_cmp_lt_u32 s[24:25], s80, v36
    v_cmp_lt_u32 s[26:27], s81, v36
    v_cmp_lt_u32 s[28:29], s82, v36
    v_cmp_lt_u32 s[30:31], s83, v36
    v_cmp_lt_u32 s[34:35], s100, v36
    s_bcnt1_i32_b64 s8, vcc
    s_mov_b64 s[80:81], 0
    s_cmp_lt_u32 s8, 8
    s_cbranch_scc1 F_SLOW
    s_bcnt1_i32_b64 s18, s[18:19]
    s_lshl_b64 exec, s[74:75], 0
    v_mov_b32 v37, s18
    s_bcnt1_i32_b64 s20, s[20:21]
    s_lshl_b64 exec, s[74:75], 1
    v_mov_b32 v37, s20
    s_bcnt1_i32_b64 s22, s[22:23]
    s_lshl_b64 exec, s[74:75], 2
    v_mov_b32 v37, s22
    s_bcnt1_i32_b64 s24, s[24:25]
    s_lshl_b64 exec, s[74:75], 3
    v_mov_b32 v37, s24
    s_bcnt1_i32_b64 s26, s[26:27]
    s_lshl_b64 exec, s[74:75], 4
    v_mov_b32 v37, s26
    s_bcnt1_i32_b64 s28, s[28:29]
    s_lshl_b64 exec, s[74:75], 5
    v_mov_b32 v37, s28
    s_bcnt1_i32_b64 s30, s[30:31]
    s_lshl_b64 exec, s[74:75], 6
    v_mov_b32 v37, s30
    s_bcnt1_i32_b64 s34, s[34:35]
    s_lshl_b64 exec, s[74:75], 7
    v_mov_b32 v37, s34
    s_mov_b64 exec, -1
    v_cmp_gt_u32 vcc, 8, v37
    v_lshl_add_u32 v52, v37, 3, v52
    v_lshl_add_u32 v55, v37, 7, s73
    v_lshl_add_u32 v37, v37, 3, s72
    s_and_b64 exec, vcc, exec
    s_cbranch_execz F_REST
    global_store_dwordx2 v52, v[48:49], s[50:51]
    global_store_dwordx2 v52, v[48:49], s[50:51] offset:512
    s_and_b64 exec, vcc, 0xff
    global_store_dwordx2 v37, v[48:49], s[50:51] offset:256
    global_load_dword v51, v50, s[16:17] offset:0
    global_load_dword v51, v50, s[16:17] offset:128
    global_load_dword v51, v50, s[16:17] offset:256
    global_load_dword v51, v50, s[16:17] offset:384
    global_load_dword v51, v50, s[16:17] offset:512
    global_load_dword v51, v50, s[16:17] offset:640
    global_load_dword v51, v50, s[16:17] offset:768
    global_load_dword v51, v50, s[16:17] offset:896
    global_load_dword v51, v50, s[16:17] offset:1024
    s_mov_b64 s[80:81], exec
F_REST:
    s_mov_b64 exec, -1
    s_branch DN_L2
F_SLOW:
    v_lshrrev_b32 v24, 2, v2
    v_mul_u32_u24 v24, 256, v24
    v_and_b32 v27, 3, v2
    v_lshl_add_u32 v24, v27, 4, v24
    v_lshrrev_b32 v26, 1, v2
    v_mul_u32_u24 v26, 256, v26
    v_and_b32 v27, 1, v2
    v_lshl_add_u32 v26, v27, 4, v26
    v_add_u32 v26, 20544, v26
    v_add_u32 v24, 4096, v24
    v_add_u32 v26, 4096, v26
    global_load_dwordx4 v[28:31], v24, s[50:51] sc1
    v_add_u32 v24, 4096, v24
    global_load_dwordx4 v[32:35], v24, s[50:51] sc1
    v_add_u32 v24, 4096, v24
    global_load_dwordx4 v[36:39], v24, s[50:51] sc1
    v_add_u32 v24, 4096, v24
    global_load_dwordx4 v[40:43], v24, s[50:51] sc1
    v_add_u32 v24, 4096, v24
    global_load_dwordx4 v[44:47], v24, s[50:51] sc1
    v_add_u32 v24, 4096, v24
    global_load_dwordx4 v[48:51], v24, s[50:51] sc1
    v_add_u32 v24, 4096, v24
    global_load_dwordx4 v[52:55], v24, s[50:51] sc1
    v_add_u32 v24, 4096, v24
    global_load_dwordx4 v[56:59], v26, s[50:51] sc1
    v_add_u32 v24, 4096, v24
    v_sub_u32 v24, 0xfff, v20
    s_waitcnt vmcnt(0)
    v_subrev_u32 v25, 0, v24
    v_bfi_b32 v28, s76, v25, v28
    v_subrev_u32 v25, 1, v24
    v_bfi_b32 v29, s76, v25, v29
    v_subrev_u32 v25, 2, v24
    v_bfi_b32 v30, s76, v25, v30
    v_subrev_u32 v25, 3, v24
    v_bfi_b32 v31, s76, v25, v31
    v_subrev_u32 v25, 256, v24
    v_bfi_b32 v32, s76, v25, v32
    v_subrev_u32 v25, 257, v24
    v_bfi_b32 v33, s76, v25, v33
    v_subrev_u32 v25, 258, v24
    v_bfi_b32 v34, s76, v25, v34
    v_subrev_u32 v25, 259, v24
    v_bfi_b32 v35, s76, v25, v35
    v_subrev_u32 v25, 512, v24
    v_bfi_b32 v36, s76, v25, v36
    v_subrev_u32 v25, 513, v24
    v_bfi_b32 v37, s76, v25, v37
    v_subrev_u32 v25, 514, v24
    v_bfi_b32 v38, s76, v25, v38
    v_subrev_u32 v25, 515, v24
    v_bfi_b32 v39, s76, v25, v39
    v_subrev_u32 v25, 768, v24
    v_bfi_b32 v40, s76, v25, v40
    v_subrev_u32 v25, 769, v24
    v_bfi_b32 v41, s76, v25, v41
    v_subrev_u32 v25, 770, v24
    v_bfi_b32 v42, s76, v25, v42
    v_subrev_u32 v25, 771, v24
    v_bfi_b32 v43, s76, v25, v43
    v_subrev_u32 v25, 1024, v24
    v_bfi_b32 v44, s76, v25, v44
    v_subrev_u32 v25, 1025, v24
    v_bfi_b32 v45, s76, v25, v45
    v_subrev_u32 v25, 1026, v24
    v_bfi_b32 v46, s76, v25, v46
    v_subrev_u32 v25, 1027, v24
    v_bfi_b32 v47, s76, v25, v47
    v_subrev_u32 v25, 1280, v24
    v_bfi_b32 v48, s76, v25, v48
    v_subrev_u32 v25, 1281, v24
    v_bfi_b32 v49, s76, v25, v49
    v_subrev_u32 v25, 1282, v24
    v_bfi_b32 v50, s76, v25, v50
    v_subrev_u32 v25, 1283, v24
    v_bfi_b32 v51, s76, v25, v51
    v_subrev_u32 v25, 1536, v24
    v_bfi_b32 v52, s76, v25, v52
    v_subrev_u32 v25, 1537, v24
    v_bfi_b32 v53, s76, v25, v53
    v_subrev_u32 v25, 1538, v24
    v_bfi_b32 v54, s76, v25, v54
    v_subrev_u32 v25, 1539, v24
    v_bfi_b32 v55, s76, v25, v55
    v_subrev_u32 v25, 1792, v24
    v_bfi_b32 v56, s76, v25, v56
    v_subrev_u32 v25, 1793, v24
    v_bfi_b32 v57, s76, v25, v57
    v_subrev_u32 v25, 1794, v24
    v_bfi_b32 v58, s76, v25, v58
    v_subrev_u32 v25, 1795, v24
    v_bfi_b32 v59, s76, v25, v59
    s_mov_b32 s77, 0
    s_mov_b32 s7, 0
F_SLOOP:
    v_subrev_u32 v60, s77, v28
    v_subrev_u32 v61, s77, v29
    v_subrev_u32 v62, s77, v30
    v_subrev_u32 v63, s77, v31
    v_subrev_u32 v64, s77, v32
    v_subrev_u32 v65, s77, v33
    v_subrev_u32 v66, s77, v34
    v_subrev_u32 v67, s77, v35
    v_subrev_u32 v68, s77, v36
    v_subrev_u32 v69, s77, v37
    v_subrev_u32 v70, s77, v38
    v_subrev_u32 v71, s77, v39
    v_subrev_u32 v72, s77, v40
    v_subrev_u32 v73, s77, v41
    v_subrev_u32 v74, s77, v42
    v_subrev_u32 v75, s77, v43
    v_subrev_u32 v76, s77, v44
    v_subrev_u32 v77, s77, v45
    v_subrev_u32 v78, s77, v46
    v_subrev_u32 v79, s77, v47
    v_subrev_u32 v80, s77, v48
    v_subrev_u32 v81, s77, v49
    v_subrev_u32 v82, s77, v50
    v_subrev_u32 v83, s77, v51
    v_subrev_u32 v84, s77, v52
    v_subrev_u32 v85, s77, v53
    v_subrev_u32 v86, s77, v54
    v_subrev_u32 v87, s77, v55
    v_subrev_u32 v88, s77, v56
    v_subrev_u32 v89, s77, v57
    v_subrev_u32 v90, s77, v58
    v_subrev_u32 v91, s77, v59
    v_max_u32 v60, v60, v61
    v_max3_u32 v60, v60, v62, v63
    v_max3_u32 v60, v60, v64, v65
    v_max3_u32 v60, v60, v66, v67
    v_max3_u32 v60, v60, v68, v69
    v_max3_u32 v60, v60, v70, v71
    v_max3_u32 v60, v60, v72, v73
    v_max3_u32 v60, v60, v74, v75
    v_max3_u32 v60, v60, v76, v77
    v_max3_u32 v60, v60, v78, v79
    v_max3_u32 v60, v60, v80, v81
    v_max3_u32 v60, v60, v82, v83
    v_max3_u32 v60, v60, v84, v85
    v_max3_u32 v60, v60, v86, v87
    v_max3_u32 v60, v60, v88, v89
    v_max3_u32 v60, v60, v90, v91
    s_nop 1
    v_max_u32_dpp v60, v60, v60 row_shr:1 row_mask:0xf bank_mask:0xf
    s_nop 1
    v_max_u32_dpp v60, v60, v60 row_shr:2 row_mask:0xf bank_mask:0xf
    s_nop 1
    v_max_u32_dpp v60, v60, v60 row_shr:4 row_mask:0xf bank_mask:0xf
    s_nop 1
    v_max_u32_dpp v60, v60, v60 row_shr:8 row_mask:0xf bank_mask:0xf
    s_nop 1
    v_max_u32_dpp v60, v60, v60 row_bcast:15 row_mask:0xa bank_mask:0xf
    s_nop 1
    v_max_u32_dpp v60, v60, v60 row_bcast:31 row_mask:0xc bank_mask:0xf
    s_nop 0
    v_readlane_b32 s8, v60, 63
    s_add_u32 s77, s77, s8
    s_add_u32 s7, s7, 1
    s_cmp_le_u32 s7, s3
    s_cbranch_scc1 F_SLOOP
    s_mov_b64 exec, 1
    v_mov_b32 v48, s77
    v_mov_b32 v49, v14
    s_lshl_b32 s8, s3, 3
    s_add_u32 s8, s8, s72
    v_mov_b32 v50, s8
    global_store_dwordx2 v50, v[48:49], s[50:51] offset:256
    s_lshl_b32 s8, s3, 7
    s_add_u32 s8, s8, s73
    v_mov_b32 v50, s8
    global_store_dwordx2 v50, v[48:49], s[50:51] sc1
    s_branch F_REST
CK_MAIN:
    s_mul_i32 s13, s7, 8192
    s_add_u32 s13, s13, 120832
    s_lshr_b32 s14, s7, 1
    s_mul_i32 s14, s14, 60192
    s_and_b32 s8, s7, 1
    s_lshl_b32 s8, s8, 9
    s_add_u32 s14, s14, s8
    s_lshl_b32 s8, s12, 8
    s_add_u32 m0, s14, s8
    v_mov_b32 v124, 0
    v_mov_b32 v125, 0
    v_mov_b32 v126, 0
    v_mov_b32 v127, 0
    s_lshl_b32 s8, s12, 11
    s_add_u32 s8, s8, s13
    v_lshl_add_u32 v20, v2, 4, s8
    ds_write_b128 v20, v[124:127]
    ds_write_b128 v20, v[124:127] offset:1024
    v_mul_u32_u24 v128, 1056, v3
    v_lshl_add_u32 v128, v4, 4, v128
    v_add_u32 v128, s14, v128
    s_lshl_b32 s8, s3, 2
    s_add_u32 s9, s8, 153632
    v_mov_b32 v129, s9
    s_xor_b32 s8, s8, 16
    s_add_u32 s9, s8, 153632
    v_mov_b32 v130, s9
    v_mov_b32 v21, 0x3c00
    ds_write_addtid_b32 v21 offset:43296
    v_mov_b32 v22, 0x3fb8aa3b
    v_mov_b32 v23, 0x32a57060
    v_mov_b32 v24, 0x3fb8aa3b
    v_mov_b32 v25, 0x3e22f983
    s_mov_b32 s15, 0x7fff7fff
    s_cmp_eq_u32 s12, 0
    s_mov_b32 s73, 0x01000c0c
    s_cselect_b32 s73, s73, 0x03020c0c
    s_waitcnt vmcnt(6)
    v_mul_f32 v19, v18, v22
    v_fma_f32 v22, v18, v22, -v19
    v_exp_f32 v19, v19
    v_fma_f32 v22, v18, v23, v22
    v_mul_f32 v22, 0x3f317218, v22
    v_fma_f32 v19, v19, v22, v19
    v_cvt_pk_bf16_f32 v19, v19, v19
    v_and_b32 v18, 0xffff0000, v19
    v_pk_mul_f32 v[24:25], v[24:25], v[18:19] op_sel_hi:[1,0]
    s_waitcnt vmcnt(0)
    v_and_b32 v14, s15, v30
    v_and_b32 v15, s15, v31
    v_and_b32 v16, s15, v32
    v_and_b32 v17, s15, v33
    v_perm_b32 v8, v28, v28, s73
    v_perm_b32 v9, v29, v29, s73
    v_perm_b32 v10, v30, v30, s73
    v_perm_b32 v11, v31, v31, s73
    v_perm_b32 v12, v32, v32, s73
    v_perm_b32 v13, v33, v33, s73
    v_pk_max_u16 v14, v14, v15
    v_pk_max_u16 v16, v16, v17
    v_lshlrev_b32 v15, 16, v14
    v_lshlrev_b32 v17, 16, v16
    v_pk_mul_f32 v[14:15], v[14:15], v[16:17]
    v_pk_mul_f32 v[8:9], v[8:9], v[24:25]
    v_max_f32 v14, v14, v15
    v_pk_mul_f32 v[10:11], v[10:11], v[18:19] op_sel_hi:[1,0]
    v_mul_f32 v14, v14, v18
    v_pk_mul_f32 v[66:67], v[12:13], v[10:11] op_sel:[1,1] op_sel_hi:[1,0]
    v_pk_fma_f32 v[56:57], v[12:13], v[10:11], v[66:67] op_sel:[0,0,0] op_sel_hi:[0,1,1] neg_lo:[0,0,1]
    v_max_u32_dpp v14, v14, v14 row_shr:1 row_mask:0xf bank_mask:0xf
    v_mul_f32 v60, 0x41000000, v8
    v_mul_f32 v61, 0xc1000000, v9
    v_max_u32_dpp v14, v14, v14 row_shr:2 row_mask:0xf bank_mask:0xf
    v_mul_f32 v62, 0x43000000, v8
    v_mul_f32 v63, 0x43000000, v9
    v_max_u32_dpp v14, v14, v14 row_shr:4 row_mask:0xf bank_mask:0xf
    v_fract_f32 v59, v9
    v_fract_f32 v61, v61
    v_max_u32_dpp v14, v14, v14 row_shr:8 row_mask:0xf bank_mask:0xf
    v_fract_f32 v63, v63
    v_exp_f32 v20, v8
    v_max_u32_dpp v14, v14, v14 row_bcast:15 row_mask:0xa bank_mask:0xf
    v_exp_f32 v22, v60
    v_exp_f32 v26, v62
    v_max_u32_dpp v14, v14, v14 row_bcast:31 row_mask:0xc bank_mask:0xf
    v_cos_f32 v60, v61
    v_readlane_b32 s8, v14, 63
    v_sin_f32 v61, v61
    v_cos_f32 v58, v59
    v_sin_f32 v59, v59
    v_cos_f32 v62, v63
    v_sin_f32 v63, v63
    s_lshr_b32 s8, s8, 23
    s_sub_i32 s8, 258, s8
    s_max_i32 s8, s8, 1
    s_min_i32 s8, s8, 253
    s_lshl_b32 s10, s8, 23
    v_pk_mul_f32 v[60:61], v[60:61], v[22:23] op_sel_hi:[1,0]
    v_pk_mul_f32 v[58:59], v[58:59], v[20:21] op_sel_hi:[1,0]
    v_pk_mul_f32 v[62:63], v[62:63], v[26:27] op_sel_hi:[1,0]
    v_pk_mul_f32 v[56:57], v[56:57], s[10:11] op_sel_hi:[1,0]
    v_cvt_pk_f16_f32 v70, v60, v61
    ds_write_addtid_b32 v70 offset:44352
    v_cvt_pk_f16_f32 v71, v56, v57
    ds_write_addtid_b32 v71 offset:42240
    v_pk_mul_f32 v[66:67], v[56:57], v[58:59] op_sel:[1,1] op_sel_hi:[1,0]
    v_pk_fma_f32 v[40:41], v[56:57], v[58:59], v[66:67] op_sel:[0,0,0] op_sel_hi:[0,1,1] neg_lo:[0,0,1]
    v_cvt_pk_f16_f32 v72, v40, v41
    ds_write_addtid_b32 v72 offset:0
    v_pk_mul_f32 v[66:67], v[40:41], v[58:59] op_sel:[1,1] op_sel_hi:[1,0]
    v_pk_fma_f32 v[42:43], v[40:41], v[58:59], v[66:67] op_sel:[0,0,0] op_sel_hi:[0,1,1] neg_lo:[0,0,1]
    v_cvt_pk_f16_f32 v73, v42, v43
    ds_write_addtid_b32 v73 offset:1056
    v_pk_mul_f32 v[66:67], v[42:43], v[58:59] op_sel:[1,1] op_sel_hi:[1,0]
    v_pk_fma_f32 v[44:45], v[42:43], v[58:59], v[66:67] op_sel:[0,0,0] op_sel_hi:[0,1,1] neg_lo:[0,0,1]
    v_cvt_pk_f16_f32 v70, v44, v45
    ds_write_addtid_b32 v70 offset:2112
    v_pk_mul_f32 v[66:67], v[44:45], v[58:59] op_sel:[1,1] op_sel_hi:[1,0]
    v_pk_fma_f32 v[46:47], v[44:45], v[58:59], v[66:67] op_sel:[0,0,0] op_sel_hi:[0,1,1] neg_lo:[0,0,1]
    v_cvt_pk_f16_f32 v71, v46, v47
    ds_write_addtid_b32 v71 offset:3168
    v_pk_mul_f32 v[66:67], v[46:47], v[58:59] op_sel:[1,1] op_sel_hi:[1,0]
    v_pk_fma_f32 v[48:49], v[46:47], v[58:59], v[66:67] op_sel:[0,0,0] op_sel_hi:[0,1,1] neg_lo:[0,0,1]
    v_cvt_pk_f16_f32 v72, v48, v49
    ds_write_addtid_b32 v72 offset:4224
    v_pk_mul_f32 v[66:67], v[48:49], v[58:59] op_sel:[1,1] op_sel_hi:[1,0]
    v_pk_fma_f32 v[50:51], v[48:49], v[58:59], v[66:67] op_sel:[0,0,0] op_sel_hi:[0,1,1] neg_lo:[0,0,1]
    v_cvt_pk_f16_f32 v73, v50, v51
    ds_write_addtid_b32 v73 offset:5280
    v_pk_mul_f32 v[66:67], v[50:51], v[58:59] op_sel:[1,1] op_sel_hi:[1,0]
    v_pk_fma_f32 v[52:53], v[50:51], v[58:59], v[66:67] op_sel:[0,0,0] op_sel_hi:[0,1,1] neg_lo:[0,0,1]
    v_cvt_pk_f16_f32 v70, v52, v53
    ds_write_addtid_b32 v70 offset:6336
    v_pk_mul_f32 v[66:67], v[52:53], v[58:59] op_sel:[1,1] op_sel_hi:[1,0]
    v_pk_fma_f32 v[54:55], v[52:53], v[58:59], v[66:67] op_sel:[0,0,0] op_sel_hi:[0,1,1] neg_lo:[0,0,1]
    v_cvt_pk_f16_f32 v71, v54, v55
    ds_write_addtid_b32 v71 offset:7392
    v_pk_mul_f32 v[66:67], v[40:41], v[62:63] op_sel:[1,1] op_sel_hi:[1,0]
    v_pk_fma_f32 v[40:41], v[40:41], v[62:63], v[66:67] op_sel:[0,0,0] op_sel_hi:[0,1,1] neg_lo:[0,0,1]
    v_cvt_pk_f16_f32 v72, v40, v41
    ds_write_addtid_b32 v72 offset:8448
    v_pk_mul_f32 v[66:67], v[42:43], v[62:63] op_sel:[1,1] op_sel_hi:[1,0]
    v_pk_fma_f32 v[42:43], v[42:43], v[62:63], v[66:67] op_sel:[0,0,0] op_sel_hi:[0,1,1] neg_lo:[0,0,1]
    v_cvt_pk_f16_f32 v73, v42, v43
    ds_write_addtid_b32 v73 offset:9504
    v_pk_mul_f32 v[66:67], v[44:45], v[62:63] op_sel:[1,1] op_sel_hi:[1,0]
    v_pk_fma_f32 v[44:45], v[44:45], v[62:63], v[66:67] op_sel:[0,0,0] op_sel_hi:[0,1,1] neg_lo:[0,0,1]
    v_cvt_pk_f16_f32 v70, v44, v45
    ds_write_addtid_b32 v70 offset:10560
    v_pk_mul_f32 v[66:67], v[46:47], v[62:63] op_sel:[1,1] op_sel_hi:[1,0]
    v_pk_fma_f32 v[46:47], v[46:47], v[62:63], v[66:67] op_sel:[0,0,0] op_sel_hi:[0,1,1] neg_lo:[0,0,1]
    v_cvt_pk_f16_f32 v71, v46, v47
    ds_write_addtid_b32 v71 offset:11616
    v_pk_mul_f32 v[66:67], v[48:49], v[62:63] op_sel:[1,1] op_sel_hi:[1,0]
    v_pk_fma_f32 v[48:49], v[48:49], v[62:63], v[66:67] op_sel:[0,0,0] op_sel_hi:[0,1,1] neg_lo:[0,0,1]
    v_cvt_pk_f16_f32 v72, v48, v49
    ds_write_addtid_b32 v72 offset:12672
    v_pk_mul_f32 v[66:67], v[50:51], v[62:63] op_sel:[1,1] op_sel_hi:[1,0]
    v_pk_fma_f32 v[50:51], v[50:51], v[62:63], v[66:67] op_sel:[0,0,0] op_sel_hi:[0,1,1] neg_lo:[0,0,1]
    v_cvt_pk_f16_f32 v73, v50, v51
    ds_write_addtid_b32 v73 offset:13728
    v_pk_mul_f32 v[66:67], v[52:53], v[62:63] op_sel:[1,1] op_sel_hi:[1,0]
    v_pk_fma_f32 v[52:53], v[52:53], v[62:63], v[66:67] op_sel:[0,0,0] op_sel_hi:[0,1,1] neg_lo:[0,0,1]
    v_cvt_pk_f16_f32 v70, v52, v53
    ds_write_addtid_b32 v70 offset:14784
    v_pk_mul_f32 v[66:67], v[54:55], v[62:63] op_sel:[1,1] op_sel_hi:[1,0]
    v_pk_fma_f32 v[54:55], v[54:55], v[62:63], v[66:67] op_sel:[0,0,0] op_sel_hi:[0,1,1] neg_lo:[0,0,1]
    v_cvt_pk_f16_f32 v71, v54, v55
    ds_write_addtid_b32 v71 offset:15840
    v_pk_mul_f32 v[66:67], v[42:43], v[62:63] op_sel:[1,1] op_sel_hi:[1,0]
    v_pk_fma_f32 v[42:43], v[42:43], v[62:63], v[66:67] op_sel:[0,0,0] op_sel_hi:[0,1,1] neg_lo:[0,0,1]
    v_cvt_pk_f16_f32 v72, v42, v43
    ds_write_addtid_b32 v72 offset:16896
    v_pk_mul_f32 v[66:67], v[46:47], v[62:63] op_sel:[1,1] op_sel_hi:[1,0]
    v_pk_fma_f32 v[46:47], v[46:47], v[62:63], v[66:67] op_sel:[0,0,0] op_sel_hi:[0,1,1] neg_lo:[0,0,1]
    v_cvt_pk_f16_f32 v73, v46, v47
    ds_write_addtid_b32 v73 offset:17952
    v_pk_mul_f32 v[66:67], v[50:51], v[62:63] op_sel:[1,1] op_sel_hi:[1,0]
    v_pk_fma_f32 v[50:51], v[50:51], v[62:63], v[66:67] op_sel:[0,0,0] op_sel_hi:[0,1,1] neg_lo:[0,0,1]
    v_cvt_pk_f16_f32 v70, v50, v51
    ds_write_addtid_b32 v70 offset:19008
    v_pk_mul_f32 v[66:67], v[54:55], v[62:63] op_sel:[1,1] op_sel_hi:[1,0]
    v_pk_fma_f32 v[54:55], v[54:55], v[62:63], v[66:67] op_sel:[0,0,0] op_sel_hi:[0,1,1] neg_lo:[0,0,1]
    v_cvt_pk_f16_f32 v71, v54, v55
    ds_write_addtid_b32 v71 offset:20064
    v_pk_mul_f32 v[66:67], v[42:43], v[62:63] op_sel:[1,1] op_sel_hi:[1,0]
    v_pk_fma_f32 v[42:43], v[42:43], v[62:63], v[66:67] op_sel:[0,0,0] op_sel_hi:[0,1,1] neg_lo:[0,0,1]
    v_cvt_pk_f16_f32 v72, v42, v43
    ds_write_addtid_b32 v72 offset:21120
    v_pk_mul_f32 v[66:67], v[46:47], v[62:63] op_sel:[1,1] op_sel_hi:[1,0]
    v_pk_fma_f32 v[46:47], v[46:47], v[62:63], v[66:67] op_sel:[0,0,0] op_sel_hi:[0,1,1] neg_lo:[0,0,1]
    v_cvt_pk_f16_f32 v73, v46, v47
    ds_write_addtid_b32 v73 offset:22176
    v_pk_mul_f32 v[66:67], v[50:51], v[62:63] op_sel:[1,1] op_sel_hi:[1,0]
    v_pk_fma_f32 v[50:51], v[50:51], v[62:63], v[66:67] op_sel:[0,0,0] op_sel_hi:[0,1,1] neg_lo:[0,0,1]
    v_cvt_pk_f16_f32 v70, v50, v51
    ds_write_addtid_b32 v70 offset:23232
    v_pk_mul_f32 v[66:67], v[54:55], v[62:63] op_sel:[1,1] op_sel_hi:[1,0]
    v_pk_fma_f32 v[54:55], v[54:55], v[62:63], v[66:67] op_sel:[0,0,0] op_sel_hi:[0,1,1] neg_lo:[0,0,1]
    v_cvt_pk_f16_f32 v71, v54, v55
    ds_write_addtid_b32 v71 offset:24288
    v_pk_mul_f32 v[66:67], v[46:47], v[62:63] op_sel:[1,1] op_sel_hi:[1,0]
    v_pk_fma_f32 v[46:47], v[46:47], v[62:63], v[66:67] op_sel:[0,0,0] op_sel_hi:[0,1,1] neg_lo:[0,0,1]
    v_cvt_pk_f16_f32 v72, v46, v47
    ds_write_addtid_b32 v72 offset:25344
    v_pk_mul_f32 v[66:67], v[54:55], v[62:63] op_sel:[1,1] op_sel_hi:[1,0]
    v_pk_fma_f32 v[54:55], v[54:55], v[62:63], v[66:67] op_sel:[0,0,0] op_sel_hi:[0,1,1] neg_lo:[0,0,1]
    v_cvt_pk_f16_f32 v73, v54, v55
    ds_write_addtid_b32 v73 offset:26400
    v_pk_mul_f32 v[66:67], v[46:47], v[62:63] op_sel:[1,1] op_sel_hi:[1,0]
    v_pk_fma_f32 v[46:47], v[46:47], v[62:63], v[66:67] op_sel:[0,0,0] op_sel_hi:[0,1,1] neg_lo:[0,0,1]
    v_cvt_pk_f16_f32 v70, v46, v47
    ds_write_addtid_b32 v70 offset:27456
    v_pk_mul_f32 v[66:67], v[54:55], v[62:63] op_sel:[1,1] op_sel_hi:[1,0]
    v_pk_fma_f32 v[54:55], v[54:55], v[62:63], v[66:67] op_sel:[0,0,0] op_sel_hi:[0,1,1] neg_lo:[0,0,1]
    v_cvt_pk_f16_f32 v71, v54, v55
    ds_write_addtid_b32 v71 offset:28512
    v_pk_mul_f32 v[66:67], v[46:47], v[62:63] op_sel:[1,1] op_sel_hi:[1,0]
    v_pk_fma_f32 v[46:47], v[46:47], v[62:63], v[66:67] op_sel:[0,0,0] op_sel_hi:[0,1,1] neg_lo:[0,0,1]
    v_cvt_pk_f16_f32 v72, v46, v47
    ds_write_addtid_b32 v72 offset:29568
    v_pk_mul_f32 v[66:67], v[54:55], v[62:63] op_sel:[1,1] op_sel_hi:[1,0]
    v_pk_fma_f32 v[54:55], v[54:55], v[62:63], v[66:67] op_sel:[0,0,0] op_sel_hi:[0,1,1] neg_lo:[0,0,1]
    v_cvt_pk_f16_f32 v73, v54, v55
    ds_write_addtid_b32 v73 offset:30624
    v_pk_mul_f32 v[66:67], v[46:47], v[62:63] op_sel:[1,1] op_sel_hi:[1,0]
    v_pk_fma_f32 v[46:47], v[46:47], v[62:63], v[66:67] op_sel:[0,0,0] op_sel_hi:[0,1,1] neg_lo:[0,0,1]
    v_cvt_pk_f16_f32 v70, v46, v47
    ds_write_addtid_b32 v70 offset:31680
    v_pk_mul_f32 v[66:67], v[54:55], v[62:63] op_sel:[1,1] op_sel_hi:[1,0]
    v_pk_fma_f32 v[54:55], v[54:55], v[62:63], v[66:67] op_sel:[0,0,0] op_sel_hi:[0,1,1] neg_lo:[0,0,1]
    v_cvt_pk_f16_f32 v71, v54, v55
    ds_write_addtid_b32 v71 offset:32736
    v_pk_mul_f32 v[66:67], v[54:55], v[62:63] op_sel:[1,1] op_sel_hi:[1,0]
    v_pk_fma_f32 v[54:55], v[54:55], v[62:63], v[66:67] op_sel:[0,0,0] op_sel_hi:[0,1,1] neg_lo:[0,0,1]
    v_cvt_pk_f16_f32 v72, v54, v55
    ds_write_addtid_b32 v72 offset:33792
    v_pk_mul_f32 v[66:67], v[54:55], v[62:63] op_sel:[1,1] op_sel_hi:[1,0]
    v_pk_fma_f32 v[54:55], v[54:55], v[62:63], v[66:67] op_sel:[0,0,0] op_sel_hi:[0,1,1] neg_lo:[0,0,1]
    v_cvt_pk_f16_f32 v73, v54, v55
    ds_write_addtid_b32 v73 offset:34848
    v_pk_mul_f32 v[66:67], v[54:55], v[62:63] op_sel:[1,1] op_sel_hi:[1,0]
    v_pk_fma_f32 v[54:55], v[54:55], v[62:63], v[66:67] op_sel:[0,0,0] op_sel_hi:[0,1,1] neg_lo:[0,0,1]
    v_cvt_pk_f16_f32 v70, v54, v55
    ds_write_addtid_b32 v70 offset:35904
    v_pk_mul_f32 v[66:67], v[54:55], v[62:63] op_sel:[1,1] op_sel_hi:[1,0]
    v_pk_fma_f32 v[54:55], v[54:55], v[62:63], v[66:67] op_sel:[0,0,0] op_sel_hi:[0,1,1] neg_lo:[0,0,1]
    v_cvt_pk_f16_f32 v71, v54, v55
    ds_write_addtid_b32 v71 offset:36960
    v_pk_mul_f32 v[66:67], v[54:55], v[62:63] op_sel:[1,1] op_sel_hi:[1,0]
    v_pk_fma_f32 v[54:55], v[54:55], v[62:63], v[66:67] op_sel:[0,0,0] op_sel_hi:[0,1,1] neg_lo:[0,0,1]
    v_cvt_pk_f16_f32 v72, v54, v55
    ds_write_addtid_b32 v72 offset:38016
    v_pk_mul_f32 v[66:67], v[54:55], v[62:63] op_sel:[1,1] op_sel_hi:[1,0]
    v_pk_fma_f32 v[54:55], v[54:55], v[62:63], v[66:67] op_sel:[0,0,0] op_sel_hi:[0,1,1] neg_lo:[0,0,1]
    v_cvt_pk_f16_f32 v73, v54, v55
    ds_write_addtid_b32 v73 offset:39072
    v_pk_mul_f32 v[66:67], v[54:55], v[62:63] op_sel:[1,1] op_sel_hi:[1,0]
    v_pk_fma_f32 v[54:55], v[54:55], v[62:63], v[66:67] op_sel:[0,0,0] op_sel_hi:[0,1,1] neg_lo:[0,0,1]
    v_cvt_pk_f16_f32 v70, v54, v55
    ds_write_addtid_b32 v70 offset:40128
    v_pk_mul_f32 v[66:67], v[54:55], v[62:63] op_sel:[1,1] op_sel_hi:[1,0]
    v_pk_fma_f32 v[54:55], v[54:55], v[62:63], v[66:67] op_sel:[0,0,0] op_sel_hi:[0,1,1] neg_lo:[0,0,1]
    v_cvt_pk_f16_f32 v71, v54, v55
    ds_write_addtid_b32 v71 offset:41184
    v_pk_mul_f32 v[66:67], v[60:61], v[60:61] op_sel:[1,1] op_sel_hi:[1,0]
    v_pk_fma_f32 v[64:65], v[60:61], v[60:61], v[66:67] op_sel:[0,0,0] op_sel_hi:[0,1,1] neg_lo:[0,0,1]
    v_cvt_pk_f16_f32 v72, v64, v65
    ds_write_addtid_b32 v72 offset:45408
    v_pk_mul_f32 v[66:67], v[64:65], v[60:61] op_sel:[1,1] op_sel_hi:[1,0]
    v_pk_fma_f32 v[64:65], v[64:65], v[60:61], v[66:67] op_sel:[0,0,0] op_sel_hi:[0,1,1] neg_lo:[0,0,1]
    v_cvt_pk_f16_f32 v73, v64, v65
    ds_write_addtid_b32 v73 offset:46464
    v_pk_mul_f32 v[66:67], v[64:65], v[60:61] op_sel:[1,1] op_sel_hi:[1,0]
    v_pk_fma_f32 v[64:65], v[64:65], v[60:61], v[66:67] op_sel:[0,0,0] op_sel_hi:[0,1,1] neg_lo:[0,0,1]
    v_cvt_pk_f16_f32 v70, v64, v65
    ds_write_addtid_b32 v70 offset:47520
    v_pk_mul_f32 v[66:67], v[64:65], v[60:61] op_sel:[1,1] op_sel_hi:[1,0]
    v_pk_fma_f32 v[64:65], v[64:65], v[60:61], v[66:67] op_sel:[0,0,0] op_sel_hi:[0,1,1] neg_lo:[0,0,1]
    v_cvt_pk_f16_f32 v71, v64, v65
    ds_write_addtid_b32 v71 offset:48576
    v_pk_mul_f32 v[66:67], v[64:65], v[60:61] op_sel:[1,1] op_sel_hi:[1,0]
    v_pk_fma_f32 v[64:65], v[64:65], v[60:61], v[66:67] op_sel:[0,0,0] op_sel_hi:[0,1,1] neg_lo:[0,0,1]
    v_cvt_pk_f16_f32 v72, v64, v65
    ds_write_addtid_b32 v72 offset:49632
    v_pk_mul_f32 v[66:67], v[64:65], v[60:61] op_sel:[1,1] op_sel_hi:[1,0]
    v_pk_fma_f32 v[64:65], v[64:65], v[60:61], v[66:67] op_sel:[0,0,0] op_sel_hi:[0,1,1] neg_lo:[0,0,1]
    v_cvt_pk_f16_f32 v73, v64, v65
    ds_write_addtid_b32 v73 offset:50688
    v_pk_mul_f32 v[66:67], v[64:65], v[60:61] op_sel:[1,1] op_sel_hi:[1,0]
    v_pk_fma_f32 v[64:65], v[64:65], v[60:61], v[66:67] op_sel:[0,0,0] op_sel_hi:[0,1,1] neg_lo:[0,0,1]
    v_cvt_pk_f16_f32 v70, v64, v65
    ds_write_addtid_b32 v70 offset:51744
    v_pk_mul_f32 v[66:67], v[64:65], v[60:61] op_sel:[1,1] op_sel_hi:[1,0]
    v_pk_fma_f32 v[64:65], v[64:65], v[60:61], v[66:67] op_sel:[0,0,0] op_sel_hi:[0,1,1] neg_lo:[0,0,1]
    v_cvt_pk_f16_f32 v71, v64, v65
    ds_write_addtid_b32 v71 offset:52800
    v_pk_mul_f32 v[66:67], v[64:65], v[60:61] op_sel:[1,1] op_sel_hi:[1,0]
    v_pk_fma_f32 v[64:65], v[64:65], v[60:61], v[66:67] op_sel:[0,0,0] op_sel_hi:[0,1,1] neg_lo:[0,0,1]
    v_cvt_pk_f16_f32 v72, v64, v65
    ds_write_addtid_b32 v72 offset:53856
    v_pk_mul_f32 v[66:67], v[64:65], v[60:61] op_sel:[1,1] op_sel_hi:[1,0]
    v_pk_fma_f32 v[64:65], v[64:65], v[60:61], v[66:67] op_sel:[0,0,0] op_sel_hi:[0,1,1] neg_lo:[0,0,1]
    v_cvt_pk_f16_f32 v73, v64, v65
    ds_write_addtid_b32 v73 offset:54912
    v_pk_mul_f32 v[66:67], v[64:65], v[60:61] op_sel:[1,1] op_sel_hi:[1,0]
    v_pk_fma_f32 v[64:65], v[64:65], v[60:61], v[66:67] op_sel:[0,0,0] op_sel_hi:[0,1,1] neg_lo:[0,0,1]
    v_cvt_pk_f16_f32 v70, v64, v65
    ds_write_addtid_b32 v70 offset:55968
    v_pk_mul_f32 v[66:67], v[64:65], v[60:61] op_sel:[1,1] op_sel_hi:[1,0]
    v_pk_fma_f32 v[64:65], v[64:65], v[60:61], v[66:67] op_sel:[0,0,0] op_sel_hi:[0,1,1] neg_lo:[0,0,1]
    v_cvt_pk_f16_f32 v71, v64, v65
    ds_write_addtid_b32 v71 offset:57024
    v_pk_mul_f32 v[66:67], v[64:65], v[60:61] op_sel:[1,1] op_sel_hi:[1,0]
    v_pk_fma_f32 v[64:65], v[64:65], v[60:61], v[66:67] op_sel:[0,0,0] op_sel_hi:[0,1,1] neg_lo:[0,0,1]
    v_cvt_pk_f16_f32 v72, v64, v65
    ds_write_addtid_b32 v72 offset:58080
    v_pk_mul_f32 v[66:67], v[64:65], v[60:61] op_sel:[1,1] op_sel_hi:[1,0]
    v_pk_fma_f32 v[64:65], v[64:65], v[60:61], v[66:67] op_sel:[0,0,0] op_sel_hi:[0,1,1] neg_lo:[0,0,1]
    v_cvt_pk_f16_f32 v73, v64, v65
    ds_write_addtid_b32 v73 offset:59136
CK_SKIP:
    ds_write_b32 v129, v129
    s_mov_b32 s9, 0
CK_PAIR:
    ds_read_b32 v8, v130
    s_add_u32 s9, s9, 1
    s_waitcnt lgkmcnt(0)
    v_cmp_eq_u32 vcc, 0, v8
    s_cmp_ge_u32 s9, 0x40000
    s_cbranch_scc1 CK_PAIRED
    s_cbranch_vccnz CK_PAIR
CK_PAIRED:
    s_sub_u32 s8, 254, s8
    s_lshl_b32 s15, s8, 23
    s_cmp_eq_u32 s12, 0
    s_cbranch_scc0 CK_T1
    ds_read_b128 v[8:11], v128 offset:43296
    ds_read_b128 v[40:43], v128 offset:0
    ds_read_b128 v[12:15], v128 offset:43360
    ds_read_b128 v[44:47], v128 offset:64
    ds_read_b128 v[16:19], v128 offset:43424
    ds_read_b128 v[48:51], v128 offset:128
    ds_read_b128 v[20:23], v128 offset:43488
    ds_read_b128 v[52:55], v128 offset:192
    ds_read_b128 v[24:27], v128 offset:43552
    ds_read_b128 v[56:59], v128 offset:256
    ds_read_b128 v[28:31], v128 offset:43616
    ds_read_b128 v[60:63], v128 offset:320
    ds_read_b128 v[32:35], v128 offset:43680
    ds_read_b128 v[64:67], v128 offset:384
    ds_read_b128 v[36:39], v128 offset:43744
    ds_read_b128 v[68:71], v128 offset:448
    v_lshrrev_b32 v114, 1, v4
    v_lshlrev_b32 v114, 8, v114
    v_lshl_add_u32 v114, v3, 4, v114
    v_and_b32 v115, 1, v4
    v_lshl_add_u32 v114, v115, 3, v114
    v_add_u32 v114, s13, v114
    v_lshlrev_b32 v115, 5, v3
    v_lshl_add_u32 v115, v4, 3, v115
    v_add_u32 v115, s13, v115
    v_mov_b32 v116, s13
    s_waitcnt lgkmcnt(14)
    v_mfma_f32_16x16x32_f16 v[104:107], v[40:43], v[8:11], 0
    ds_read_b128 v[72:75], v128 offset:33792
    s_waitcnt lgkmcnt(13)
    v_mfma_f32_16x16x32_f16 v[104:107], v[44:47], v[12:15], v[104:107]
    ds_read_b128 v[76:79], v128 offset:33856
    s_waitcnt lgkmcnt(12)
    v_mfma_f32_16x16x32_f16 v[104:107], v[48:51], v[16:19], v[104:107]
    ds_read_b128 v[80:83], v128 offset:33920
    s_waitcnt lgkmcnt(11)
    v_mfma_f32_16x16x32_f16 v[104:107], v[52:55], v[20:23], v[104:107]
    ds_read_b128 v[84:87], v128 offset:33984
    s_waitcnt lgkmcnt(10)
    v_mfma_f32_16x16x32_f16 v[104:107], v[56:59], v[24:27], v[104:107]
    ds_read_b128 v[88:91], v128 offset:34048
    s_waitcnt lgkmcnt(9)
    v_mfma_f32_16x16x32_f16 v[104:107], v[60:63], v[28:31], v[104:107]
    ds_read_b128 v[92:95], v128 offset:34112
    s_waitcnt lgkmcnt(8)
    v_mfma_f32_16x16x32_f16 v[104:107], v[64:67], v[32:35], v[104:107]
    ds_read_b128 v[96:99], v128 offset:34176
    s_waitcnt lgkmcnt(7)
    v_mfma_f32_16x16x32_f16 v[104:107], v[68:71], v[36:39], v[104:107]
    ds_read_b128 v[100:103], v128 offset:34240
    s_waitcnt lgkmcnt(7)
    v_mfma_f32_16x16x32_f16 v[108:111], v[8:11], v[72:75], 0
    s_waitcnt lgkmcnt(6)
    v_mfma_f32_16x16x32_f16 v[108:111], v[12:15], v[76:79], v[108:111]
    s_waitcnt lgkmcnt(5)
    v_mfma_f32_16x16x32_f16 v[108:111], v[16:19], v[80:83], v[108:111]
    s_waitcnt lgkmcnt(4)
    v_mfma_f32_16x16x32_f16 v[108:111], v[20:23], v[84:87], v[108:111]
    s_waitcnt lgkmcnt(3)
    v_mfma_f32_16x16x32_f16 v[108:111], v[24:27], v[88:91], v[108:111]
    s_waitcnt lgkmcnt(2)
    v_mfma_f32_16x16x32_f16 v[108:111], v[28:31], v[92:95], v[108:111]
    s_waitcnt lgkmcnt(1)
    v_mfma_f32_16x16x32_f16 v[108:111], v[32:35], v[96:99], v[108:111]
    s_waitcnt lgkmcnt(0)
    v_mfma_f32_16x16x32_f16 v[108:111], v[36:39], v[100:103], v[108:111]
    v_mul_f32 v104, s15, v104
    v_mul_f32 v105, s15, v105
    v_mul_f32 v106, s15, v106
    v_mul_f32 v107, s15, v107
    v_cvt_pk_bf16_f32 v118, v104, v105
    v_cvt_pk_bf16_f32 v119, v106, v107
    v_cvt_pk_bf16_f32 v120, v105, v106
    v_cvt_pk_bf16_f32 v121, v107, v107
    ds_write_b16 v114, v121 offset:1256
    ds_write_b64 v114, v[120:121] offset:32
    ds_write_b64 v114, v[118:119] offset:1248
    ds_write_b16 v114, v118 offset:30
    v_mul_f32 v108, s15, v108
    v_mul_f32 v109, s15, v109
    v_mul_f32 v110, s15, v110
    v_mul_f32 v111, s15, v111
    v_cvt_pk_bf16_f32 v118, v108, v109
    v_cvt_pk_bf16_f32 v119, v110, v111
    s_mov_b32 s10, 0x00ff00ff
    s_mov_b32 s11, 0x00ff00ff
    s_mov_b64 exec, s[10:11]
    ds_write_b64 v115, v[118:119] offset:2912
    s_mov_b64 exec, 0x100
    ds_write_b16 v116, v118 offset:28
    ds_write_b16 v116, v118 offset:1246
    s_mov_b64 exec, -1
    v_mov_b32 v127, 153600
    v_mov_b32 v126, 1
    s_lshl_b32 s8, s7, 2
    v_add_u32 v131, s8, v127
    s_mov_b64 exec, 1
    ds_add_u32 v131, v126 offset:80
    ds_add_u32 v127, v126 offset:76
    s_mov_b64 exec, -1
    v_mul_u32_u24 v124, 320, v4
    v_lshl_add_u32 v124, v3, 4, v124
    s_mul_i32 s8, s7, 20480
    v_add_u32 v124, s8, v124
    s_lshl_b32 s8, s3, 2
    s_add_u32 s8, s8, 153856
    v_mov_b32 v125, s8
    v_and_b32 v5, 1, v3
    v_mul_u32_u24 v5, 1216, v5
    v_sub_u32 v5, 1264, v5
    v_lshrrev_b32 v6, 1, v3
    v_lshl_add_u32 v5, v6, 2, v5
    v_lshlrev_b32 v6, 4, v4
    v_sub_u32 v5, v5, v6
    v_add_u32 v5, s13, v5
    v_add_u32 v7, 576, v5
    v_lshl_add_u32 v6, v3, 5, v6
    v_add_u32 v6, 3616, v6
    v_add_u32 v6, s13, v6
    s_mov_b32 s9, 0
SPN5:
    ds_read_b32 v128, v131 offset:80
    s_add_u32 s9, s9, 1
    s_waitcnt lgkmcnt(0)
    v_cmp_ne_u32 vcc, 2, v128
    s_cmp_ge_u32 s9, 0x40000
    s_cbranch_scc1 SPX5
    s_cbranch_vccnz SPN5
SPX5:
    ds_read2_b32 v[36:37], v5 offset0:115 offset1:114
    ds_read2_b32 v[38:39], v5 offset0:113 offset1:112
    ds_read2_b32 v[32:33], v5 offset0:99 offset1:98
    ds_read2_b32 v[34:35], v5 offset0:97 offset1:96
    ds_read2_b32 v[28:29], v5 offset0:83 offset1:82
    ds_read2_b32 v[30:31], v5 offset0:81 offset1:80
    ds_read2_b32 v[24:25], v5 offset0:67 offset1:66
    ds_read2_b32 v[26:27], v5 offset0:65 offset1:64
    ds_read2_b32 v[20:21], v5 offset0:51 offset1:50
    ds_read2_b32 v[22:23], v5 offset0:49 offset1:48
    ds_read2_b32 v[16:17], v5 offset0:35 offset1:34
    ds_read2_b32 v[18:19], v5 offset0:33 offset1:32
    ds_read2_b32 v[12:13], v5 offset0:19 offset1:18
    ds_read2_b32 v[14:15], v5 offset0:17 offset1:16
    ds_read2_b32 v[8:9], v5 offset0:3 offset1:2
    ds_read2_b32 v[10:11], v5 offset0:1 offset1:0
    ds_read2_b32 v[68:69], v7 offset0:99 offset1:98
    ds_read2_b32 v[70:71], v7 offset0:97 offset1:96
    ds_read2_b32 v[64:65], v7 offset0:83 offset1:82
    ds_read2_b32 v[66:67], v7 offset0:81 offset1:80
    ds_read2_b32 v[60:61], v7 offset0:67 offset1:66
    ds_read2_b32 v[62:63], v7 offset0:65 offset1:64
    ds_read2_b32 v[56:57], v7 offset0:51 offset1:50
    ds_read2_b32 v[58:59], v7 offset0:49 offset1:48
    ds_read2_b32 v[52:53], v7 offset0:35 offset1:34
    ds_read2_b32 v[54:55], v7 offset0:33 offset1:32
    ds_read2_b32 v[48:49], v7 offset0:19 offset1:18
    ds_read2_b32 v[50:51], v7 offset0:17 offset1:16
    ds_read2_b32 v[44:45], v7 offset0:3 offset1:2
    ds_read2_b32 v[46:47], v7 offset0:1 offset1:0
    ds_read2_b32 v[40:41], v5 offset0:131 offset1:130
    ds_read2_b32 v[42:43], v5 offset0:129 offset1:128
    ds_read2_b32 v[72:73], v7 offset0:115 offset1:114
    ds_read2_b32 v[74:75], v7 offset0:113 offset1:112
    s_mov_b32 s9, 0
SPN6:
    ds_read_b32 v128, v127 offset:76
    s_add_u32 s9, s9, 1
    s_waitcnt lgkmcnt(0)
    v_cmp_ne_u32 vcc, 12, v128
    s_cmp_ge_u32 s9, 0x40000
    s_cbranch_scc1 SPX6
    s_cbranch_vccz SPX6
    s_sleep 1
    s_branch SPN6
SPX6:
D_PASS:
    s_mov_b32 s9, 0
SPN7:
    ds_read_b32 v128, v127 offset:240
    s_add_u32 s9, s9, 1
    s_waitcnt lgkmcnt(0)
    v_and_b32 v128, 15, v128
    v_cmp_ne_u32 vcc, 2, v128
    s_cmp_ge_u32 s9, 0x40000
    s_cbranch_scc1 SPX7
    s_cbranch_vccz SPX7
    s_sleep 1
    s_branch SPN7
SPX7:
D_LOOP:
    ds_read_b128 v[80:83], v6 offset:0
    ds_read_b128 v[84:87], v6 offset:64
    ds_read_b128 v[88:91], v6 offset:128
    ds_read_b128 v[92:95], v6 offset:192
    ds_read_b128 v[96:99], v6 offset:256
    ds_read_b128 v[100:103], v6 offset:320
    ds_read_b128 v[104:107], v6 offset:384
    s_waitcnt lgkmcnt(6)
    v_mfma_f32_16x16x32_bf16 v[108:111], v[36:39], v[80:83], 0
    v_mfma_f32_16x16x32_bf16 v[112:115], v[68:71], v[80:83], 0
    ds_read_b128 v[76:79], v6 offset:448
    s_waitcnt lgkmcnt(6)
    v_mfma_f32_16x16x32_bf16 v[108:111], v[32:35], v[84:87], v[108:111]
    v_mfma_f32_16x16x32_bf16 v[112:115], v[64:67], v[84:87], v[112:115]
    ds_read_b128 v[80:83], v6 offset:512
    s_waitcnt lgkmcnt(6)
    v_mfma_f32_16x16x32_bf16 v[108:111], v[28:31], v[88:91], v[108:111]
    v_mfma_f32_16x16x32_bf16 v[112:115], v[60:63], v[88:91], v[112:115]
    ds_read_b128 v[84:87], v6 offset:576
    s_waitcnt lgkmcnt(6)
    v_mfma_f32_16x16x32_bf16 v[108:111], v[24:27], v[92:95], v[108:111]
    v_mfma_f32_16x16x32_bf16 v[112:115], v[56:59], v[92:95], v[112:115]
    ds_read_b128 v[88:91], v6 offset:640
    s_waitcnt lgkmcnt(6)
    v_mfma_f32_16x16x32_bf16 v[108:111], v[20:23], v[96:99], v[108:111]
    v_mfma_f32_16x16x32_bf16 v[112:115], v[52:55], v[96:99], v[112:115]
    ds_read_b128 v[92:95], v6 offset:704
    s_waitcnt lgkmcnt(6)
    v_mfma_f32_16x16x32_bf16 v[108:111], v[16:19], v[100:103], v[108:111]
    v_mfma_f32_16x16x32_bf16 v[112:115], v[48:51], v[100:103], v[112:115]
    ds_read_b128 v[96:99], v6 offset:768
    s_waitcnt lgkmcnt(6)
    v_mfma_f32_16x16x32_bf16 v[108:111], v[12:15], v[104:107], v[108:111]
    v_mfma_f32_16x16x32_bf16 v[112:115], v[44:47], v[104:107], v[112:115]
    ds_read_b128 v[100:103], v6 offset:832
    s_waitcnt lgkmcnt(6)
    v_mfma_f32_16x16x32_bf16 v[108:111], v[8:11], v[76:79], v[108:111]
    v_mfma_f32_16x16x32_bf16 v[112:115], v[40:43], v[76:79], v[112:115]
    v_mfma_f32_16x16x32_bf16 v[116:119], v[72:75], v[76:79], 0
    ds_read_b128 v[104:107], v6 offset:896
    s_waitcnt lgkmcnt(6)
    v_mfma_f32_16x16x32_bf16 v[112:115], v[36:39], v[80:83], v[112:115]
    v_mfma_f32_16x16x32_bf16 v[116:119], v[68:71], v[80:83], v[116:119]
    ds_read_b128 v[76:79], v6 offset:960
    s_waitcnt lgkmcnt(6)
    v_mfma_f32_16x16x32_bf16 v[112:115], v[32:35], v[84:87], v[112:115]
    v_mfma_f32_16x16x32_bf16 v[116:119], v[64:67], v[84:87], v[116:119]
    ds_read_b128 v[80:83], v6 offset:1024
    s_waitcnt lgkmcnt(6)
    v_mfma_f32_16x16x32_bf16 v[112:115], v[28:31], v[88:91], v[112:115]
    ds_write_b64 v124, v[108:109] offset:0
    v_mfma_f32_16x16x32_bf16 v[116:119], v[60:63], v[88:91], v[116:119]
    ds_read_b128 v[84:87], v6 offset:1088
    s_waitcnt lgkmcnt(7)
    v_mfma_f32_16x16x32_bf16 v[112:115], v[24:27], v[92:95], v[112:115]
    ds_write_b64 v124, v[110:111] offset:8
    v_mfma_f32_16x16x32_bf16 v[116:119], v[56:59], v[92:95], v[116:119]
    ds_read_b128 v[88:91], v6 offset:1152
    s_waitcnt lgkmcnt(8)
    v_mfma_f32_16x16x32_bf16 v[112:115], v[20:23], v[96:99], v[112:115]
    ds_write_b32 v125, v126 offset:0
    v_mfma_f32_16x16x32_bf16 v[116:119], v[52:55], v[96:99], v[116:119]
    ds_read_b128 v[92:95], v6 offset:1216
    s_waitcnt lgkmcnt(9)
    v_mfma_f32_16x16x32_bf16 v[112:115], v[16:19], v[100:103], v[112:115]
    v_mfma_f32_16x16x32_bf16 v[116:119], v[48:51], v[100:103], v[116:119]
    ds_read_b128 v[96:99], v6 offset:1280
    s_waitcnt lgkmcnt(9)
    v_mfma_f32_16x16x32_bf16 v[112:115], v[12:15], v[104:107], v[112:115]
    v_mfma_f32_16x16x32_bf16 v[116:119], v[44:47], v[104:107], v[116:119]
    ds_read_b128 v[100:103], v6 offset:1344
    s_waitcnt lgkmcnt(9)
    v_mfma_f32_16x16x32_bf16 v[112:115], v[8:11], v[76:79], v[112:115]
    v_mfma_f32_16x16x32_bf16 v[116:119], v[40:43], v[76:79], v[116:119]
    v_mfma_f32_16x16x32_bf16 v[120:123], v[72:75], v[76:79], 0
    ds_read_b128 v[104:107], v6 offset:1408
    s_waitcnt lgkmcnt(9)
    v_mfma_f32_16x16x32_bf16 v[116:119], v[36:39], v[80:83], v[116:119]
    v_mfma_f32_16x16x32_bf16 v[120:123], v[68:71], v[80:83], v[120:123]
    ds_read_b128 v[76:79], v6 offset:1472
    s_waitcnt lgkmcnt(8)
    v_mfma_f32_16x16x32_bf16 v[116:119], v[32:35], v[84:87], v[116:119]
    v_mfma_f32_16x16x32_bf16 v[120:123], v[64:67], v[84:87], v[120:123]
    ds_read_b128 v[80:83], v6 offset:1536
    s_waitcnt lgkmcnt(7)
    v_mfma_f32_16x16x32_bf16 v[116:119], v[28:31], v[88:91], v[116:119]
    ds_write_b64 v124, v[112:113] offset:1280
    v_mfma_f32_16x16x32_bf16 v[120:123], v[60:63], v[88:91], v[120:123]
    ds_read_b128 v[84:87], v6 offset:1600
    s_waitcnt lgkmcnt(7)
    v_mfma_f32_16x16x32_bf16 v[116:119], v[24:27], v[92:95], v[116:119]
    ds_write_b64 v124, v[114:115] offset:1288
    v_mfma_f32_16x16x32_bf16 v[120:123], v[56:59], v[92:95], v[120:123]
    ds_read_b128 v[88:91], v6 offset:1664
    s_waitcnt lgkmcnt(8)
    v_mfma_f32_16x16x32_bf16 v[116:119], v[20:23], v[96:99], v[116:119]
    ds_write_b32 v125, v126 offset:32
    v_mfma_f32_16x16x32_bf16 v[120:123], v[52:55], v[96:99], v[120:123]
    ds_read_b128 v[92:95], v6 offset:1728
    s_waitcnt lgkmcnt(9)
    v_mfma_f32_16x16x32_bf16 v[116:119], v[16:19], v[100:103], v[116:119]
    v_mfma_f32_16x16x32_bf16 v[120:123], v[48:51], v[100:103], v[120:123]
    ds_read_b128 v[96:99], v6 offset:1792
    s_waitcnt lgkmcnt(9)
    v_mfma_f32_16x16x32_bf16 v[116:119], v[12:15], v[104:107], v[116:119]
    v_mfma_f32_16x16x32_bf16 v[120:123], v[44:47], v[104:107], v[120:123]
    ds_read_b128 v[100:103], v6 offset:1856
    s_waitcnt lgkmcnt(9)
    v_mfma_f32_16x16x32_bf16 v[116:119], v[8:11], v[76:79], v[116:119]
    v_mfma_f32_16x16x32_bf16 v[120:123], v[40:43], v[76:79], v[120:123]
    v_mfma_f32_16x16x32_bf16 v[108:111], v[72:75], v[76:79], 0
    ds_read_b128 v[104:107], v6 offset:1920
    s_waitcnt lgkmcnt(9)
    v_mfma_f32_16x16x32_bf16 v[120:123], v[36:39], v[80:83], v[120:123]
    v_mfma_f32_16x16x32_bf16 v[108:111], v[68:71], v[80:83], v[108:111]
    ds_read_b128 v[76:79], v6 offset:1984
    s_waitcnt lgkmcnt(8)
    v_mfma_f32_16x16x32_bf16 v[120:123], v[32:35], v[84:87], v[120:123]
    v_mfma_f32_16x16x32_bf16 v[108:111], v[64:67], v[84:87], v[108:111]
    s_waitcnt lgkmcnt(6)
    v_mfma_f32_16x16x32_bf16 v[120:123], v[28:31], v[88:91], v[120:123]
    ds_write_b64 v124, v[116:117] offset:2560
    v_mfma_f32_16x16x32_bf16 v[108:111], v[60:63], v[88:91], v[108:111]
    s_waitcnt lgkmcnt(5)
    v_mfma_f32_16x16x32_bf16 v[120:123], v[24:27], v[92:95], v[120:123]
    ds_write_b64 v124, v[118:119] offset:2568
    v_mfma_f32_16x16x32_bf16 v[108:111], v[56:59], v[92:95], v[108:111]
    s_waitcnt lgkmcnt(5)
    v_mfma_f32_16x16x32_bf16 v[120:123], v[20:23], v[96:99], v[120:123]
    ds_write_b32 v125, v126 offset:64
    v_mfma_f32_16x16x32_bf16 v[108:111], v[52:55], v[96:99], v[108:111]
    s_waitcnt lgkmcnt(5)
    v_mfma_f32_16x16x32_bf16 v[120:123], v[16:19], v[100:103], v[120:123]
    v_mfma_f32_16x16x32_bf16 v[108:111], v[48:51], v[100:103], v[108:111]
    s_waitcnt lgkmcnt(4)
    v_mfma_f32_16x16x32_bf16 v[120:123], v[12:15], v[104:107], v[120:123]
    v_mfma_f32_16x16x32_bf16 v[108:111], v[44:47], v[104:107], v[108:111]
    s_waitcnt lgkmcnt(3)
    v_mfma_f32_16x16x32_bf16 v[120:123], v[8:11], v[76:79], v[120:123]
    v_mfma_f32_16x16x32_bf16 v[108:111], v[40:43], v[76:79], v[108:111]
    v_mfma_f32_16x16x32_bf16 v[112:115], v[72:75], v[76:79], 0
    s_nop 7
    ds_write_b64 v124, v[120:121] offset:3840
    ds_write_b64 v124, v[122:123] offset:3848
    ds_write_b32 v125, v126 offset:96
    s_mov_b32 s9, 0
SPN8:
    ds_read_b32 v128, v127 offset:240
    s_add_u32 s9, s9, 1
    s_waitcnt lgkmcnt(0)
    v_cmp_ne_u32 vcc, 34, v128
    s_cmp_ge_u32 s9, 0x40000
    s_cbranch_scc1 SPX8
    s_cbranch_vccz SPX8
    s_sleep 1
    s_branch SPN8
SPX8:
    ds_read_b128 v[80:83], v6 offset:2048
    ds_read_b128 v[84:87], v6 offset:2112
    ds_read_b128 v[88:91], v6 offset:2176
    ds_read_b128 v[92:95], v6 offset:2240
    ds_read_b128 v[96:99], v6 offset:2304
    ds_read_b128 v[100:103], v6 offset:2368
    ds_read_b128 v[104:107], v6 offset:2432
    s_waitcnt lgkmcnt(6)
    v_mfma_f32_16x16x32_bf16 v[108:111], v[36:39], v[80:83], v[108:111]
    v_mfma_f32_16x16x32_bf16 v[112:115], v[68:71], v[80:83], v[112:115]
    ds_read_b128 v[76:79], v6 offset:2496
    s_waitcnt lgkmcnt(6)
    v_mfma_f32_16x16x32_bf16 v[108:111], v[32:35], v[84:87], v[108:111]
    v_mfma_f32_16x16x32_bf16 v[112:115], v[64:67], v[84:87], v[112:115]
    ds_read_b128 v[80:83], v6 offset:2560
    s_waitcnt lgkmcnt(6)
    v_mfma_f32_16x16x32_bf16 v[108:111], v[28:31], v[88:91], v[108:111]
    v_mfma_f32_16x16x32_bf16 v[112:115], v[60:63], v[88:91], v[112:115]
    ds_read_b128 v[84:87], v6 offset:2624
    s_waitcnt lgkmcnt(6)
    v_mfma_f32_16x16x32_bf16 v[108:111], v[24:27], v[92:95], v[108:111]
    v_mfma_f32_16x16x32_bf16 v[112:115], v[56:59], v[92:95], v[112:115]
    ds_read_b128 v[88:91], v6 offset:2688
    s_waitcnt lgkmcnt(6)
    v_mfma_f32_16x16x32_bf16 v[108:111], v[20:23], v[96:99], v[108:111]
    v_mfma_f32_16x16x32_bf16 v[112:115], v[52:55], v[96:99], v[112:115]
    ds_read_b128 v[92:95], v6 offset:2752
    s_waitcnt lgkmcnt(6)
    v_mfma_f32_16x16x32_bf16 v[108:111], v[16:19], v[100:103], v[108:111]
    v_mfma_f32_16x16x32_bf16 v[112:115], v[48:51], v[100:103], v[112:115]
    ds_read_b128 v[96:99], v6 offset:2816
    s_waitcnt lgkmcnt(6)
    v_mfma_f32_16x16x32_bf16 v[108:111], v[12:15], v[104:107], v[108:111]
    v_mfma_f32_16x16x32_bf16 v[112:115], v[44:47], v[104:107], v[112:115]
    ds_read_b128 v[100:103], v6 offset:2880
    s_waitcnt lgkmcnt(6)
    v_mfma_f32_16x16x32_bf16 v[108:111], v[8:11], v[76:79], v[108:111]
    v_mfma_f32_16x16x32_bf16 v[112:115], v[40:43], v[76:79], v[112:115]
    v_mfma_f32_16x16x32_bf16 v[116:119], v[72:75], v[76:79], 0
    ds_read_b128 v[104:107], v6 offset:2944
    s_waitcnt lgkmcnt(6)
    v_mfma_f32_16x16x32_bf16 v[112:115], v[36:39], v[80:83], v[112:115]
    v_mfma_f32_16x16x32_bf16 v[116:119], v[68:71], v[80:83], v[116:119]
    ds_read_b128 v[76:79], v6 offset:3008
    s_waitcnt lgkmcnt(6)
    v_mfma_f32_16x16x32_bf16 v[112:115], v[32:35], v[84:87], v[112:115]
    v_mfma_f32_16x16x32_bf16 v[116:119], v[64:67], v[84:87], v[116:119]
    ds_read_b128 v[80:83], v6 offset:3072
    s_waitcnt lgkmcnt(6)
    v_mfma_f32_16x16x32_bf16 v[112:115], v[28:31], v[88:91], v[112:115]
    ds_write_b64 v124, v[108:109] offset:5120
    v_mfma_f32_16x16x32_bf16 v[116:119], v[60:63], v[88:91], v[116:119]
    ds_read_b128 v[84:87], v6 offset:3136
    s_waitcnt lgkmcnt(7)
    v_mfma_f32_16x16x32_bf16 v[112:115], v[24:27], v[92:95], v[112:115]
    ds_write_b64 v124, v[110:111] offset:5128
    v_mfma_f32_16x16x32_bf16 v[116:119], v[56:59], v[92:95], v[116:119]
    ds_read_b128 v[88:91], v6 offset:3200
    s_waitcnt lgkmcnt(8)
    v_mfma_f32_16x16x32_bf16 v[112:115], v[20:23], v[96:99], v[112:115]
    ds_write_b32 v125, v126 offset:128
    v_mfma_f32_16x16x32_bf16 v[116:119], v[52:55], v[96:99], v[116:119]
    ds_read_b128 v[92:95], v6 offset:3264
    s_waitcnt lgkmcnt(9)
    v_mfma_f32_16x16x32_bf16 v[112:115], v[16:19], v[100:103], v[112:115]
    v_mfma_f32_16x16x32_bf16 v[116:119], v[48:51], v[100:103], v[116:119]
    ds_read_b128 v[96:99], v6 offset:3328
    s_waitcnt lgkmcnt(9)
    v_mfma_f32_16x16x32_bf16 v[112:115], v[12:15], v[104:107], v[112:115]
    v_mfma_f32_16x16x32_bf16 v[116:119], v[44:47], v[104:107], v[116:119]
    ds_read_b128 v[100:103], v6 offset:3392
    s_waitcnt lgkmcnt(9)
    v_mfma_f32_16x16x32_bf16 v[112:115], v[8:11], v[76:79], v[112:115]
    v_mfma_f32_16x16x32_bf16 v[116:119], v[40:43], v[76:79], v[116:119]
    v_mfma_f32_16x16x32_bf16 v[120:123], v[72:75], v[76:79], 0
    ds_read_b128 v[104:107], v6 offset:3456
    s_waitcnt lgkmcnt(9)
    v_mfma_f32_16x16x32_bf16 v[116:119], v[36:39], v[80:83], v[116:119]
    v_mfma_f32_16x16x32_bf16 v[120:123], v[68:71], v[80:83], v[120:123]
    ds_read_b128 v[76:79], v6 offset:3520
    s_waitcnt lgkmcnt(8)
    v_mfma_f32_16x16x32_bf16 v[116:119], v[32:35], v[84:87], v[116:119]
    v_mfma_f32_16x16x32_bf16 v[120:123], v[64:67], v[84:87], v[120:123]
    ds_read_b128 v[80:83], v6 offset:3584
    s_waitcnt lgkmcnt(7)
    v_mfma_f32_16x16x32_bf16 v[116:119], v[28:31], v[88:91], v[116:119]
    ds_write_b64 v124, v[112:113] offset:6400
    v_mfma_f32_16x16x32_bf16 v[120:123], v[60:63], v[88:91], v[120:123]
    ds_read_b128 v[84:87], v6 offset:3648
    s_waitcnt lgkmcnt(7)
    v_mfma_f32_16x16x32_bf16 v[116:119], v[24:27], v[92:95], v[116:119]
    ds_write_b64 v124, v[114:115] offset:6408
    v_mfma_f32_16x16x32_bf16 v[120:123], v[56:59], v[92:95], v[120:123]
    ds_read_b128 v[88:91], v6 offset:3712
    s_waitcnt lgkmcnt(8)
    v_mfma_f32_16x16x32_bf16 v[116:119], v[20:23], v[96:99], v[116:119]
    ds_write_b32 v125, v126 offset:160
    v_mfma_f32_16x16x32_bf16 v[120:123], v[52:55], v[96:99], v[120:123]
    ds_read_b128 v[92:95], v6 offset:3776
    s_waitcnt lgkmcnt(9)
    v_mfma_f32_16x16x32_bf16 v[116:119], v[16:19], v[100:103], v[116:119]
    v_mfma_f32_16x16x32_bf16 v[120:123], v[48:51], v[100:103], v[120:123]
    ds_read_b128 v[96:99], v6 offset:3840
    s_waitcnt lgkmcnt(9)
    v_mfma_f32_16x16x32_bf16 v[116:119], v[12:15], v[104:107], v[116:119]
    v_mfma_f32_16x16x32_bf16 v[120:123], v[44:47], v[104:107], v[120:123]
    ds_read_b128 v[100:103], v6 offset:3904
    s_waitcnt lgkmcnt(9)
    v_mfma_f32_16x16x32_bf16 v[116:119], v[8:11], v[76:79], v[116:119]
    v_mfma_f32_16x16x32_bf16 v[120:123], v[40:43], v[76:79], v[120:123]
    ds_read_b128 v[104:107], v6 offset:3968
    s_waitcnt lgkmcnt(9)
    v_mfma_f32_16x16x32_bf16 v[120:123], v[36:39], v[80:83], v[120:123]
    ds_read_b128 v[76:79], v6 offset:4032
    s_waitcnt lgkmcnt(8)
    v_mfma_f32_16x16x32_bf16 v[120:123], v[32:35], v[84:87], v[120:123]
    s_waitcnt lgkmcnt(6)
    v_mfma_f32_16x16x32_bf16 v[120:123], v[28:31], v[88:91], v[120:123]
    s_waitcnt lgkmcnt(4)
    v_mfma_f32_16x16x32_bf16 v[120:123], v[24:27], v[92:95], v[120:123]
    s_waitcnt lgkmcnt(3)
    v_mfma_f32_16x16x32_bf16 v[120:123], v[20:23], v[96:99], v[120:123]
    ds_write_b64 v124, v[116:117] offset:7680
    s_waitcnt lgkmcnt(3)
    v_mfma_f32_16x16x32_bf16 v[120:123], v[16:19], v[100:103], v[120:123]
    ds_write_b64 v124, v[118:119] offset:7688
    s_waitcnt lgkmcnt(3)
    v_mfma_f32_16x16x32_bf16 v[120:123], v[12:15], v[104:107], v[120:123]
    ds_write_b32 v125, v126 offset:192
    s_waitcnt lgkmcnt(3)
    v_mfma_f32_16x16x32_bf16 v[120:123], v[8:11], v[76:79], v[120:123]
    s_nop 7
    ds_write_b64 v124, v[120:121] offset:8960
    ds_write_b64 v124, v[122:123] offset:8968
    ds_write_b32 v125, v126 offset:224
    s_waitcnt lgkmcnt(0)
    s_endpgm
CK_T1:
    ds_read_b128 v[8:11], v128 offset:43296
    ds_read_b128 v[40:43], v128 offset:16896
    ds_read_b128 v[12:15], v128 offset:43360
    ds_read_b128 v[44:47], v128 offset:16960
    ds_read_b128 v[16:19], v128 offset:43424
    ds_read_b128 v[48:51], v128 offset:17024
    ds_read_b128 v[20:23], v128 offset:43488
    ds_read_b128 v[52:55], v128 offset:17088
    ds_read_b128 v[24:27], v128 offset:43552
    ds_read_b128 v[56:59], v128 offset:17152
    ds_read_b128 v[28:31], v128 offset:43616
    ds_read_b128 v[60:63], v128 offset:17216
    ds_read_b128 v[32:35], v128 offset:43680
    ds_read_b128 v[64:67], v128 offset:17280
    ds_read_b128 v[36:39], v128 offset:43744
    ds_read_b128 v[68:71], v128 offset:17344
    v_lshlrev_b32 v114, 8, v4
    v_lshl_add_u32 v114, v3, 4, v114
    v_add_u32 v114, s13, v114
    v_lshlrev_b32 v115, 7, v4
    v_lshl_add_u32 v115, v3, 2, v115
    v_add_u32 v115, s13, v115
    s_waitcnt lgkmcnt(14)
    v_mfma_f32_16x16x32_f16 v[104:107], v[40:43], v[8:11], 0
    s_waitcnt lgkmcnt(12)
    v_mfma_f32_16x16x32_f16 v[104:107], v[44:47], v[12:15], v[104:107]
    s_waitcnt lgkmcnt(10)
    v_mfma_f32_16x16x32_f16 v[104:107], v[48:51], v[16:19], v[104:107]
    s_waitcnt lgkmcnt(8)
    v_mfma_f32_16x16x32_f16 v[104:107], v[52:55], v[20:23], v[104:107]
    s_waitcnt lgkmcnt(6)
    v_mfma_f32_16x16x32_f16 v[104:107], v[56:59], v[24:27], v[104:107]
    s_waitcnt lgkmcnt(4)
    v_mfma_f32_16x16x32_f16 v[104:107], v[60:63], v[28:31], v[104:107]
    s_waitcnt lgkmcnt(2)
    v_mfma_f32_16x16x32_f16 v[104:107], v[64:67], v[32:35], v[104:107]
    s_waitcnt lgkmcnt(0)
    v_mfma_f32_16x16x32_f16 v[104:107], v[68:71], v[36:39], v[104:107]
    s_nop 7
    v_mul_f32 v104, s15, v104
    v_mul_f32 v105, s15, v105
    v_mul_f32 v106, s15, v106
    v_mul_f32 v107, s15, v107
    v_cvt_pk_bf16_f32 v116, v104, v105
    v_cvt_pk_bf16_f32 v117, v105, v105
    v_cvt_pk_bf16_f32 v118, v106, v107
    v_cvt_pk_bf16_f32 v119, v107, v107
    v_cvt_pk_bf16_f32 v120, v105, v106
    s_mov_b32 exec_hi, 0
    ds_write_b16 v114, v119 offset:560
    v_add_u32 v121, 1728, v114
    ds_write_b128 v114, v[116:119] offset:544
    ds_write2_b32 v121, v119, v119 offset0:11 offset1:12
    ds_write2_b32 v121, v117, v120 offset0:9 offset1:10
    ds_write_b16 v121, v116 offset:34
    s_not_b64 exec, exec
    ds_write_b32 v115, v116 offset:2208
    ds_write_b32 v115, v118 offset:2272
    s_mov_b64 exec, -1
    v_mov_b32 v167, 153600
    v_mov_b32 v166, 1
    s_lshl_b32 s8, s7, 2
    v_add_u32 v131, s8, v167
    s_mov_b64 exec, 1
    ds_add_u32 v131, v166 offset:80
    ds_add_u32 v167, v166 offset:76
    s_mov_b64 exec, -1
    v_mul_u32_u24 v164, 320, v4
    v_lshl_add_u32 v164, v3, 4, v164
    s_mul_i32 s8, s7, 20480
    v_add_u32 v164, s8, v164
    s_lshl_b32 s8, s3, 2
    s_add_u32 s8, s8, 153856
    v_mov_b32 v165, s8
    v_lshlrev_b32 v5, 2, v4
    v_sub_u32 v5, v3, v5
    v_lshl_add_u32 v7, v5, 2, s13
    v_lshl_add_u32 v5, v5, 3, s13
    v_add_u32 v7, 2848, v7
    v_mov_b32 v6, s13
    s_mov_b32 s9, 0
SPN9:
    ds_read_b32 v128, v131 offset:80
    s_add_u32 s9, s9, 1
    s_waitcnt lgkmcnt(0)
    v_cmp_ne_u32 vcc, 2, v128
    s_cmp_ge_u32 s9, 0x40000
    s_cbranch_scc1 SPX9
    s_cbranch_vccz SPX9
    s_sleep 1
    s_branch SPN9
SPX9:
    ds_read_b32 v130, v6 offset:2716
    ds_read_b64 v[8:9], v5 offset:2464
    ds_read_b64 v[10:11], v5 offset:2456
    ds_read_b64 v[12:13], v5 offset:2448
    ds_read_b64 v[14:15], v5 offset:2440
    ds_read_b64 v[16:17], v5 offset:2592
    ds_read_b64 v[18:19], v5 offset:2584
    ds_read_b64 v[20:21], v5 offset:2576
    ds_read_b64 v[22:23], v5 offset:2568
    ds_read_b64 v[24:25], v5 offset:2720
    ds_read_b64 v[26:27], v5 offset:2712
    ds_read_b64 v[28:29], v5 offset:2704
    ds_read_b64 v[30:31], v5 offset:2696
    ds_read2_b32 v[32:33], v7 offset0:16 offset1:15
    ds_read2_b32 v[34:35], v7 offset0:14 offset1:13
    ds_read2_b32 v[36:37], v7 offset0:32 offset1:31
    ds_read2_b32 v[38:39], v7 offset0:30 offset1:29
    ds_read2_b32 v[40:41], v7 offset0:48 offset1:47
    ds_read2_b32 v[42:43], v7 offset0:46 offset1:45
    ds_read2_b32 v[44:45], v7 offset0:64 offset1:63
    ds_read2_b32 v[46:47], v7 offset0:62 offset1:61
    v_lshlrev_b32 v6, 4, v4
    v_lshl_add_u32 v6, v3, 5, v6
    v_add_u32 v6, 4048, v6
    v_add_u32 v6, s13, v6
    v_lshlrev_b32 v5, 4, v2
    v_add_u32 v5, 154112, v5
    s_mov_b32 s9, 0
SPN10:
    ds_read_b32 v128, v167 offset:76
    s_add_u32 s9, s9, 1
    s_waitcnt lgkmcnt(0)
    v_cmp_ne_u32 vcc, 12, v128
    s_cmp_ge_u32 s9, 0x40000
    s_cbranch_scc1 SPX10
    s_cbranch_vccz SPX10
    s_sleep 1
    s_branch SPN10
SPX10:
    ds_read_b128 v[140:143], v5 offset:0
    ds_read_b128 v[144:147], v5 offset:1024
    ds_read_b128 v[148:151], v5 offset:2048
    ds_read_b128 v[152:155], v5 offset:3072
    ds_read_b128 v[156:159], v5 offset:4096
Z_PASS:
    ds_write_b128 v164, v[124:127] offset:10240
    ds_write_b32 v165, v166 offset:0
    ds_write_b128 v164, v[124:127] offset:11520
    ds_write_b32 v165, v166 offset:32
    s_mov_b32 s8, 0x07060706
    s_mov_b32 s9, 0
SPN11:
    ds_read_b32 v128, v167 offset:240
    s_add_u32 s9, s9, 1
    s_waitcnt lgkmcnt(0)
    v_and_b32 v128, 15, v128
    v_cmp_ne_u32 vcc, 2, v128
    s_cmp_ge_u32 s9, 0x40000
    s_cbranch_scc1 SPX11
    s_cbranch_vccz SPX11
    s_sleep 1
    s_branch SPN11
SPX11:
    v_perm_b32 v130, v130, v130, s8
Z_LOOP:
    ds_read_b128 v[48:51], v6 offset:16
    ds_read_b128 v[52:55], v6 offset:0
    ds_read_b128 v[56:59], v6 offset:528
    ds_read_b128 v[60:63], v6 offset:512
    v_and_b32 v156, v130, v156
    v_and_b32 v157, v130, v157
    v_and_b32 v158, v130, v158
    v_and_b32 v159, v130, v159
    s_waitcnt lgkmcnt(2)
    v_mfma_f32_16x16x32_bf16 v[64:67], v[48:51], v[140:143], 0
    v_mfma_f32_16x16x32_bf16 v[68:71], v[48:51], v[144:147], 0
    v_mfma_f32_16x16x32_bf16 v[72:75], v[52:55], v[140:143], 0
    v_mfma_f32_16x16x32_bf16 v[76:79], v[52:55], v[144:147], 0
    v_mfma_f32_16x16x32_bf16 v[80:83], v[48:51], v[148:151], 0
    v_mfma_f32_16x16x32_bf16 v[84:87], v[52:55], v[152:155], 0
    s_nop 3
    v_cvt_pk_bf16_f32 v88, v64, v68
    v_cvt_pk_bf16_f32 v90, v65, v69
    v_cvt_pk_bf16_f32 v92, v66, v70
    v_cvt_pk_bf16_f32 v94, v67, v71
    v_cvt_pk_bf16_f32 v89, v72, v76
    v_cvt_pk_bf16_f32 v91, v73, v77
    v_cvt_pk_bf16_f32 v93, v74, v78
    v_cvt_pk_bf16_f32 v95, v75, v79
    v_cvt_pk_bf16_f32 v96, v80, v84
    v_cvt_pk_bf16_f32 v97, v81, v85
    v_cvt_pk_bf16_f32 v98, v82, v86
    v_cvt_pk_bf16_f32 v99, v83, v87
    s_waitcnt lgkmcnt(0)
    v_mfma_f32_16x16x32_bf16 v[64:67], v[56:59], v[140:143], 0
    v_mfma_f32_16x16x32_bf16 v[68:71], v[56:59], v[144:147], 0
    v_mfma_f32_16x16x32_bf16 v[72:75], v[60:63], v[140:143], 0
    v_mfma_f32_16x16x32_bf16 v[76:79], v[60:63], v[144:147], 0
    v_mfma_f32_16x16x32_bf16 v[80:83], v[56:59], v[148:151], 0
    v_mfma_f32_16x16x32_bf16 v[84:87], v[60:63], v[152:155], 0
    v_mfma_f32_16x16x32_bf16 v[108:111], v[156:159], v[48:51], 0
    ds_read_b128 v[48:51], v6 offset:1040
    ds_read_b128 v[52:55], v6 offset:1024
    v_mfma_f32_16x16x32_bf16 v[100:103], v[88:91], v[8:11], 0
    v_mfma_f32_16x16x32_bf16 v[100:103], v[92:95], v[12:15], v[100:103]
    v_cvt_pk_bf16_f32 v132, v64, v68
    v_cvt_pk_bf16_f32 v134, v65, v69
    v_mfma_f32_16x16x32_bf16 v[104:107], v[88:91], v[16:19], 0
    v_cvt_pk_bf16_f32 v136, v66, v70
    v_cvt_pk_bf16_f32 v138, v67, v71
    v_mfma_f32_16x16x32_bf16 v[104:107], v[92:95], v[20:23], v[104:107]
    v_cvt_pk_bf16_f32 v133, v72, v76
    v_cvt_pk_bf16_f32 v135, v73, v77
    v_mfma_f32_16x16x32_bf16 v[108:111], v[88:91], v[24:27], v[108:111]
    v_cvt_pk_bf16_f32 v137, v74, v78
    v_cvt_pk_bf16_f32 v139, v75, v79
    v_mfma_f32_16x16x32_bf16 v[108:111], v[92:95], v[28:31], v[108:111]
    v_cvt_pk_bf16_f32 v160, v80, v84
    v_cvt_pk_bf16_f32 v161, v81, v85
    v_mfma_f32_16x16x32_bf16 v[108:111], v[96:99], v[32:35], v[108:111]
    v_cvt_pk_bf16_f32 v162, v82, v86
    v_cvt_pk_bf16_f32 v163, v83, v87
    v_mfma_f32_16x16x32_bf16 v[112:115], v[96:99], v[36:39], 0
    v_mfma_f32_16x16x32_bf16 v[116:119], v[96:99], v[40:43], 0
    v_mfma_f32_16x16x32_bf16 v[120:123], v[96:99], v[44:47], 0
    s_waitcnt lgkmcnt(0)
    v_mfma_f32_16x16x32_bf16 v[64:67], v[48:51], v[140:143], 0
    v_mfma_f32_16x16x32_bf16 v[68:71], v[48:51], v[144:147], 0
    ds_write_b64 v164, v[100:101] offset:12800
    v_mfma_f32_16x16x32_bf16 v[72:75], v[52:55], v[140:143], 0
    ds_write_b64 v164, v[102:103] offset:12808
    v_mfma_f32_16x16x32_bf16 v[76:79], v[52:55], v[144:147], 0
    ds_write_b32 v165, v166 offset:64
    v_mfma_f32_16x16x32_bf16 v[80:83], v[48:51], v[148:151], 0
    v_mfma_f32_16x16x32_bf16 v[84:87], v[52:55], v[152:155], 0
    v_mfma_f32_16x16x32_bf16 v[112:115], v[156:159], v[56:59], v[112:115]
    ds_read_b128 v[56:59], v6 offset:1552
    ds_read_b128 v[60:63], v6 offset:1536
    v_mfma_f32_16x16x32_bf16 v[104:107], v[132:135], v[8:11], v[104:107]
    v_mfma_f32_16x16x32_bf16 v[104:107], v[136:139], v[12:15], v[104:107]
    v_cvt_pk_bf16_f32 v88, v64, v68
    v_cvt_pk_bf16_f32 v90, v65, v69
    v_mfma_f32_16x16x32_bf16 v[108:111], v[132:135], v[16:19], v[108:111]
    v_cvt_pk_bf16_f32 v92, v66, v70
    v_cvt_pk_bf16_f32 v94, v67, v71
    v_mfma_f32_16x16x32_bf16 v[108:111], v[136:139], v[20:23], v[108:111]
    v_cvt_pk_bf16_f32 v89, v72, v76
    v_cvt_pk_bf16_f32 v91, v73, v77
    v_mfma_f32_16x16x32_bf16 v[112:115], v[132:135], v[24:27], v[112:115]
    v_cvt_pk_bf16_f32 v93, v74, v78
    v_cvt_pk_bf16_f32 v95, v75, v79
    v_mfma_f32_16x16x32_bf16 v[112:115], v[136:139], v[28:31], v[112:115]
    v_cvt_pk_bf16_f32 v96, v80, v84
    v_cvt_pk_bf16_f32 v97, v81, v85
    v_mfma_f32_16x16x32_bf16 v[112:115], v[160:163], v[32:35], v[112:115]
    v_cvt_pk_bf16_f32 v98, v82, v86
    v_cvt_pk_bf16_f32 v99, v83, v87
    v_mfma_f32_16x16x32_bf16 v[116:119], v[160:163], v[36:39], v[116:119]
    v_mfma_f32_16x16x32_bf16 v[120:123], v[160:163], v[40:43], v[120:123]
    s_waitcnt lgkmcnt(0)
    v_mfma_f32_16x16x32_bf16 v[64:67], v[56:59], v[140:143], 0
    v_mfma_f32_16x16x32_bf16 v[68:71], v[56:59], v[144:147], 0
    ds_write_b64 v164, v[104:105] offset:14080
    v_mfma_f32_16x16x32_bf16 v[72:75], v[60:63], v[140:143], 0
    ds_write_b64 v164, v[106:107] offset:14088
    v_mfma_f32_16x16x32_bf16 v[76:79], v[60:63], v[144:147], 0
    ds_write_b32 v165, v166 offset:96
    v_mfma_f32_16x16x32_bf16 v[80:83], v[56:59], v[148:151], 0
    v_mfma_f32_16x16x32_bf16 v[84:87], v[60:63], v[152:155], 0
    v_mfma_f32_16x16x32_bf16 v[116:119], v[156:159], v[48:51], v[116:119]
    v_mfma_f32_16x16x32_bf16 v[108:111], v[88:91], v[8:11], v[108:111]
    v_mfma_f32_16x16x32_bf16 v[108:111], v[92:95], v[12:15], v[108:111]
    v_mfma_f32_16x16x32_bf16 v[112:115], v[88:91], v[16:19], v[112:115]
    v_cvt_pk_bf16_f32 v132, v64, v68
    v_cvt_pk_bf16_f32 v134, v65, v69
    v_mfma_f32_16x16x32_bf16 v[112:115], v[92:95], v[20:23], v[112:115]
    v_cvt_pk_bf16_f32 v136, v66, v70
    v_cvt_pk_bf16_f32 v138, v67, v71
    v_mfma_f32_16x16x32_bf16 v[116:119], v[88:91], v[24:27], v[116:119]
    v_cvt_pk_bf16_f32 v133, v72, v76
    v_cvt_pk_bf16_f32 v135, v73, v77
    v_mfma_f32_16x16x32_bf16 v[116:119], v[92:95], v[28:31], v[116:119]
    v_cvt_pk_bf16_f32 v137, v74, v78
    v_cvt_pk_bf16_f32 v139, v75, v79
    v_mfma_f32_16x16x32_bf16 v[116:119], v[96:99], v[32:35], v[116:119]
    v_cvt_pk_bf16_f32 v160, v80, v84
    v_cvt_pk_bf16_f32 v161, v81, v85
    v_mfma_f32_16x16x32_bf16 v[120:123], v[96:99], v[36:39], v[120:123]
    v_cvt_pk_bf16_f32 v162, v82, v86
    v_cvt_pk_bf16_f32 v163, v83, v87
    s_nop 1
    v_mfma_f32_16x16x32_bf16 v[120:123], v[156:159], v[56:59], v[120:123]
    ds_write_b64 v164, v[108:109] offset:15360
    v_mfma_f32_16x16x32_bf16 v[112:115], v[132:135], v[8:11], v[112:115]
    ds_write_b64 v164, v[110:111] offset:15368
    v_mfma_f32_16x16x32_bf16 v[112:115], v[136:139], v[12:15], v[112:115]
    ds_write_b32 v165, v166 offset:128
    v_mfma_f32_16x16x32_bf16 v[116:119], v[132:135], v[16:19], v[116:119]
    v_mfma_f32_16x16x32_bf16 v[116:119], v[136:139], v[20:23], v[116:119]
    v_mfma_f32_16x16x32_bf16 v[120:123], v[132:135], v[24:27], v[120:123]
    v_mfma_f32_16x16x32_bf16 v[120:123], v[136:139], v[28:31], v[120:123]
    v_mfma_f32_16x16x32_bf16 v[120:123], v[160:163], v[32:35], v[120:123]
    s_mov_b32 s9, 0
SPN12:
    ds_read_b32 v128, v167 offset:240
    s_add_u32 s9, s9, 1
    s_waitcnt lgkmcnt(0)
    v_cmp_ne_u32 vcc, 34, v128
    s_cmp_ge_u32 s9, 0x40000
    s_cbranch_scc1 SPX12
    s_cbranch_vccz SPX12
    s_sleep 1
    s_branch SPN12
SPX12:
    s_cmp_lg_u32 s3, 4
    s_cbranch_scc1 Z_NOSEL
    v_and_b32 v126, 4, v2
    v_add_u32 v126, v126, v4
    s_lshl_b32 s9, s4, 8
    v_lshl_add_u32 v126, v126, 3, s9
    global_load_dwordx2 v[124:125], v126, s[50:51] offset:256 sc1
    s_lshl_b32 s9, s4, 7
    v_mov_b32 v126, s9
    global_load_dword v127, v126, s[50:51] offset:2304 sc1
Z_NOSEL:
    ds_read_b128 v[48:51], v6 offset:2064
    ds_read_b128 v[52:55], v6 offset:2048
    ds_read_b128 v[56:59], v6 offset:2576
    ds_read_b128 v[60:63], v6 offset:2560
    ds_write_b64 v164, v[112:113] offset:16640
    ds_write_b64 v164, v[114:115] offset:16648
    ds_write_b32 v165, v166 offset:160
    s_waitcnt lgkmcnt(5)
    v_mfma_f32_16x16x32_bf16 v[64:67], v[48:51], v[140:143], 0
    v_mfma_f32_16x16x32_bf16 v[68:71], v[48:51], v[144:147], 0
    v_mfma_f32_16x16x32_bf16 v[72:75], v[52:55], v[140:143], 0
    v_mfma_f32_16x16x32_bf16 v[76:79], v[52:55], v[144:147], 0
    s_nop 5
    v_cvt_pk_bf16_f32 v88, v64, v68
    v_cvt_pk_bf16_f32 v90, v65, v69
    v_cvt_pk_bf16_f32 v92, v66, v70
    v_cvt_pk_bf16_f32 v94, v67, v71
    v_cvt_pk_bf16_f32 v89, v72, v76
    v_cvt_pk_bf16_f32 v91, v73, v77
    v_cvt_pk_bf16_f32 v93, v74, v78
    v_cvt_pk_bf16_f32 v95, v75, v79
    s_waitcnt lgkmcnt(3)
    v_mfma_f32_16x16x32_bf16 v[64:67], v[56:59], v[140:143], 0
    v_mfma_f32_16x16x32_bf16 v[68:71], v[56:59], v[144:147], 0
    v_mfma_f32_16x16x32_bf16 v[72:75], v[60:63], v[140:143], 0
    v_mfma_f32_16x16x32_bf16 v[76:79], v[60:63], v[144:147], 0
    v_mfma_f32_16x16x32_bf16 v[116:119], v[88:91], v[8:11], v[116:119]
    v_mfma_f32_16x16x32_bf16 v[116:119], v[92:95], v[12:15], v[116:119]
    v_mfma_f32_16x16x32_bf16 v[120:123], v[88:91], v[16:19], v[120:123]
    v_mfma_f32_16x16x32_bf16 v[120:123], v[92:95], v[20:23], v[120:123]
    s_nop 1
    v_cvt_pk_bf16_f32 v132, v64, v68
    v_cvt_pk_bf16_f32 v134, v65, v69
    v_cvt_pk_bf16_f32 v136, v66, v70
    v_cvt_pk_bf16_f32 v138, v67, v71
    v_cvt_pk_bf16_f32 v133, v72, v76
    v_cvt_pk_bf16_f32 v135, v73, v77
    v_cvt_pk_bf16_f32 v137, v74, v78
    v_cvt_pk_bf16_f32 v139, v75, v79
    ds_write_b64 v164, v[116:117] offset:17920
    ds_write_b64 v164, v[118:119] offset:17928
    v_mfma_f32_16x16x32_bf16 v[120:123], v[132:135], v[8:11], v[120:123]
    v_mfma_f32_16x16x32_bf16 v[120:123], v[136:139], v[12:15], v[120:123]
    ds_write_b32 v165, v166 offset:192
    s_nop 6
    ds_write_b64 v164, v[120:121] offset:19200
    ds_write_b64 v164, v[122:123] offset:19208
    ds_write_b32 v165, v166 offset:224
    s_setprio 0
    s_cmp_eq_u32 s3, 4
    s_cbranch_scc1 FINAL
    s_waitcnt lgkmcnt(0)
    s_endpgm
CU_C3A:
    s_cmp_eq_u32 s4, 3
    s_cselect_b32 s8, 18, 3
    s_cmp_ge_u32 s101, s8
    s_cbranch_scc1 CU_C3B
    s_sub_u32 s14, 3, s4
    s_and_b32 s14, s14, 7
    s_and_b32 s8, s101, 1
    s_lshl_b32 s8, s8, 3
    s_lshr_b32 s9, s101, 1
    s_cmp_eq_u32 s4, 3
    s_cselect_b32 s14, s8, s14
    s_cselect_b32 s9, s9, s101
    s_add_u32 s9, s9, 2
    s_min_u32 s9, s9, 17
    s_mul_i32 s9, s9, 9
    s_add_u32 s14, s14, s9
    v_mul_u32_u24 v140, 9216, v2
    s_mul_i32 s8, s4, 1152
    v_add_u32 v140, s8, v140
    s_mul_i32 s8, s14, 7282
    s_lshr_b32 s8, s8, 16
    s_mul_i32 s9, s8, 9
    s_sub_u32 s9, s14, s9
    s_lshl_b32 s9, s9, 7
    s_bitcmp1_b32 s8, 0
    s_cselect_b32 s12, s40, s38
    s_cselect_b32 s13, s41, s39
    s_lshr_b32 s8, s8, 1
    s_add_u32 s8, s8, 0
    s_mul_i32 s8, s8, 589824
    s_add_u32 s8, s8, s9
    v_add_u32 v148, s8, v140
    global_load_dword v149, v148, s[12:13]
    s_lshl_b32 s9, s6, 3
    s_branch CU_C3B
CU_C3:
    s_cmp_eq_u32 s4, 3
    s_cselect_b32 s8, 18, 3
    s_add_u32 s10, s10, s8
    s_sub_u32 s14, 3, s4
    s_and_b32 s14, s14, 7
    s_and_b32 s8, s10, 1
    s_lshl_b32 s8, s8, 3
    s_lshr_b32 s9, s10, 1
    s_cmp_eq_u32 s4, 3
    s_cselect_b32 s14, s8, s14
    s_cselect_b32 s9, s9, s10
    s_add_u32 s9, s9, 2
    s_min_u32 s9, s9, 17
    s_mul_i32 s9, s9, 9
    s_add_u32 s14, s14, s9
    v_mul_u32_u24 v140, 9216, v2
    s_mul_i32 s8, s4, 1152
    v_add_u32 v140, s8, v140
    s_mul_i32 s8, s14, 7282
    s_lshr_b32 s8, s8, 16
    s_mul_i32 s9, s8, 9
    s_sub_u32 s9, s14, s9
    s_lshl_b32 s9, s9, 7
    s_bitcmp1_b32 s8, 0
    s_cselect_b32 s12, s40, s38
    s_cselect_b32 s13, s41, s39
    s_lshr_b32 s8, s8, 1
    s_add_u32 s8, s8, 0
    s_mul_i32 s8, s8, 589824
    s_add_u32 s8, s8, s9
    v_add_u32 v148, s8, v140
    global_load_dword v149, v148, s[12:13]
    s_lshl_b32 s9, s6, 3
    s_branch CU_C3X
CU_MID:
    s_min_u32 s13, s7, 2
    s_mov_b32 s12, 0
SPN13:
    ds_read_b32 v56, v57 offset:64
    s_add_u32 s12, s12, 1
    s_waitcnt lgkmcnt(0)
    v_cmp_gt_u32 vcc, s13, v56
    s_cmp_ge_u32 s12, 0x40000
    s_cbranch_scc1 SPX13
    s_cbranch_vccz SPX13
    s_sleep 2
    s_branch SPN13
SPX13:
    s_branch CU_LD
CU_PRE:
    v_mov_b32 v139, 1
    v_lshlrev_b32 v74, 3, v4
    v_sub_u32 v74, v74, v3
    v_and_b32 v74, 0xffff, v74
    v_lshl_or_b32 v74, v74, 16, v74
    v_mov_b32 v75, 0x3f803f80
    s_mul_i32 s8, s7, 0x20002
    s_add_u32 s8, s8, 0xfff0fff1
    v_pk_add_u16 v76, v74, s8
    v_pk_add_u16 v80, v76, 2 op_sel_hi:[1,0]
    v_pk_ashrrev_i16 v80, 15, v80 op_sel_hi:[0,1]
    v_pk_add_u16 v81, v76, 3 op_sel_hi:[1,0]
    v_pk_ashrrev_i16 v81, 15, v81 op_sel_hi:[0,1]
    v_pk_add_u16 v82, v76, 4 op_sel_hi:[1,0]
    v_pk_ashrrev_i16 v82, 15, v82 op_sel_hi:[0,1]
    v_pk_add_u16 v83, v76, 5 op_sel_hi:[1,0]
    v_pk_ashrrev_i16 v83, 15, v83 op_sel_hi:[0,1]
    v_pk_add_u16 v84, v76, 10 op_sel_hi:[1,0]
    v_pk_ashrrev_i16 v84, 15, v84 op_sel_hi:[0,1]
    v_pk_add_u16 v85, v76, 11 op_sel_hi:[1,0]
    v_pk_ashrrev_i16 v85, 15, v85 op_sel_hi:[0,1]
    v_pk_add_u16 v86, v76, 12 op_sel_hi:[1,0]
    v_pk_ashrrev_i16 v86, 15, v86 op_sel_hi:[0,1]
    s_lshl_b32 s8, s7, 2
    s_add_u32 s8, s8, 154112
    v_lshl_add_u32 v74, v2, 4, s8
    v_bitop3_b32 v88, v80, v83, v75 bitop3:0x28
    ds_write_b32 v74, v88 offset:0
    v_bitop3_b32 v89, v83, v84, v75 bitop3:0x28
    ds_write_b32 v74, v89 offset:1024
    v_bitop3_b32 v90, v82, v85, v75 bitop3:0x28
    ds_write_b32 v74, v90 offset:2048
    v_bitop3_b32 v91, v81, v86, v75 bitop3:0x28
    ds_write_b32 v74, v91 offset:3072
    v_xor_b32 v92, v80, v82
    ds_write_b32 v74, v92 offset:4096
    s_mov_b64 exec, 1
    ds_add_u32 v57, v139 offset:76
    s_mov_b64 exec, -1
    s_mov_b32 s72, s15
    v_lshrrev_b32 v158, 2, v2
    v_mul_u32_u24 v158, 256, v158
    v_and_b32 v137, 3, v2
    v_lshl_add_u32 v158, v137, 4, v158
    v_lshrrev_b32 v138, 1, v2
    v_mul_u32_u24 v138, 256, v138
    v_and_b32 v137, 1, v2
    v_lshl_add_u32 v138, v137, 4, v138
    v_add_u32 v138, 20544, v138
    s_mul_i32 s8, s15, 4096
    s_add_u32 s8, s8, 4224
    v_add_u32 v158, s8, v158
    v_add_u32 v137, 24576, v158
    v_add_u32 v138, 4224, v138
    s_cmp_eq_u32 s7, 1
    s_cselect_b64 vcc, -1, 0
    v_cndmask_b32 v138, v137, v138, vcc
    v_and_b32 v146, 3, v2
    v_mul_u32_u24 v159, 320, v146
    v_lshl_add_u32 v146, v146, 2, v57
    v_lshrrev_b32 v136, 2, v2
    v_lshl_add_u32 v159, v136, 4, v159
    s_mul_i32 s8, s72, 1280
    v_add_u32 v159, s8, v159
    v_add_u32 v136, 40960, v159
    v_and_b32 v141, 7, v2
    s_lshl_b32 s8, s72, 5
    s_add_u32 s8, s8, 153856
    v_lshl_add_u32 v141, v141, 2, s8
    s_lshl_b32 s8, s72, 10
    v_lshl_add_u32 v147, v2, 4, s8
    v_lshlrev_b32 v142, 1, v147
    v_add_u32 v147, 98304, v147
    v_add_u32 v142, 81920, v142
    s_lshl_b32 s8, s72, 9
    s_add_u32 s8, s8, 124928
    v_lshl_add_u32 v58, v2, 3, s8
    s_mov_b32 s74, 0x05040100
    s_mov_b32 s75, 0x07060302
    s_cmp_lt_u32 s7, 2
    s_cselect_b32 s8, 1, 16
    v_mov_b32 v143, s8
    s_waitcnt lgkmcnt(0)
    v_lshlrev_b32 v154, 16, s52
    v_mov_b32 v155, s52
    v_lshlrev_b32 v156, 16, s53
    v_mov_b32 v157, s53
    v_and_b32 v155, 0xffff0000, v155
    v_and_b32 v157, 0xffff0000, v157
    v_add_f32 v154, -1.0, v154
    v_add_f32 v155, -1.0, v155
    v_add_f32 v156, -1.0, v156
    v_add_f32 v157, -1.0, v157
    s_waitcnt vmcnt(0)
    s_branch CU_PREX
CU_MAIN:
    s_mov_b64 exec, 1
    ds_add_u32 v57, v139 offset:64
    s_mov_b64 exec, -1
    s_setprio 3
    s_waitcnt vmcnt(6)
    v_perm_b32 v64, v8, v10, s74
    v_perm_b32 v66, v8, v10, s75
    v_perm_b32 v68, v9, v11, s74
    v_perm_b32 v70, v9, v11, s75
    s_waitcnt vmcnt(4)
    v_perm_b32 v65, v12, v14, s74
    v_perm_b32 v67, v12, v14, s75
    v_perm_b32 v69, v13, v15, s74
    v_perm_b32 v71, v13, v15, s75
    ds_write_b64 v58, v[64:65] offset:0
    ds_write_b64 v58, v[66:67] offset:8192
    ds_write_b64 v58, v[68:69] offset:16384
    ds_write_b64 v58, v[70:71] offset:24576
    s_waitcnt vmcnt(2)
    v_perm_b32 v72, v16, v18, s74
    v_perm_b32 v74, v16, v18, s75
    v_perm_b32 v76, v17, v19, s74
    v_perm_b32 v78, v17, v19, s75
    s_waitcnt vmcnt(0)
    v_perm_b32 v73, v20, v22, s74
    v_perm_b32 v75, v20, v22, s75
    v_perm_b32 v77, v21, v23, s74
    v_perm_b32 v79, v21, v23, s75
    ds_write_b64 v58, v[72:73] offset:1024
    ds_write_b64 v58, v[74:75] offset:9216
    ds_write_b64 v58, v[76:77] offset:17408
    ds_write_b64 v58, v[78:79] offset:25600
    s_mov_b64 exec, 1
    ds_add_u32 v57, v143 offset:240
    s_mov_b64 exec, -1
    s_setprio 3
    s_cmp_ge_u32 s7, 2
    s_cbranch_scc1 E_NOG
    s_mov_b32 s12, 0
SPN14:
    ds_read_b32 v60, v57 offset:64
    s_add_u32 s12, s12, 1
    s_waitcnt lgkmcnt(0)
    v_cmp_gt_u32 vcc, 4, v60
    s_cmp_ge_u32 s12, 0x40000
    s_cbranch_scc1 SPX14
    s_cbranch_vccz SPX14
    s_sleep 1
    s_branch SPN14
SPX14:
    global_load_dwordx2 v[144:145], v59, s[48:49] sc1
    global_load_dwordx4 v[128:131], v158, s[50:51] sc1
    v_add_u32 v137, 8192, v158
    global_load_dwordx4 v[132:135], v137, s[50:51] sc1
    v_add_u32 v137, 16384, v158
    global_load_dwordx4 v[160:163], v137, s[50:51] sc1
    global_load_dwordx4 v[164:167], v138, s[50:51] sc1
    s_add_u32 s15, s7, 0
    s_cmp_ge_u32 s15, 4
    s_cbranch_scc1 CPF_DE0
    s_mul_i32 s14, s15, 18
    s_add_u32 s14, s14, s101
    v_mul_u32_u24 v140, 9216, v2
    s_mul_i32 s8, s4, 1152
    v_add_u32 v140, s8, v140
    s_mul_i32 s8, s14, 7282
    s_lshr_b32 s8, s8, 16
    s_mul_i32 s9, s8, 9
    s_sub_u32 s9, s14, s9
    s_lshl_b32 s9, s9, 7
    s_bitcmp1_b32 s8, 0
    s_cselect_b32 s12, s40, s38
    s_cselect_b32 s13, s41, s39
    s_lshr_b32 s8, s8, 1
    s_add_u32 s8, s8, 5
    s_mul_i32 s8, s8, 589824
    s_add_u32 s8, s8, s9
    v_add_u32 v148, s8, v140
    global_load_dword v149, v148, s[12:13]
    s_branch CPF_XE0
CPF_DE0:
    s_sub_u32 s14, s15, 4
    s_mul_i32 s14, s14, 18
    s_add_u32 s14, s14, s101
    s_min_u32 s14, s14, 80
    s_mul_i32 s8, s4, 81
    s_add_u32 s8, s8, 80
    s_sub_u32 s8, s8, s14
    s_lshl_b32 s8, s8, 13
    v_lshl_add_u32 v148, v2, 7, s8
    global_load_dword v149, v148, s[42:43]
CPF_XE0:
    s_add_u32 s15, s7, 2
    s_cmp_ge_u32 s15, 4
    s_cbranch_scc1 CPF_DE1
    s_mul_i32 s14, s15, 18
    s_add_u32 s14, s14, s101
    v_mul_u32_u24 v140, 9216, v2
    s_mul_i32 s8, s4, 1152
    v_add_u32 v140, s8, v140
    s_mul_i32 s8, s14, 7282
    s_lshr_b32 s8, s8, 16
    s_mul_i32 s9, s8, 9
    s_sub_u32 s9, s14, s9
    s_lshl_b32 s9, s9, 7
    s_bitcmp1_b32 s8, 0
    s_cselect_b32 s12, s40, s38
    s_cselect_b32 s13, s41, s39
    s_lshr_b32 s8, s8, 1
    s_add_u32 s8, s8, 5
    s_mul_i32 s8, s8, 589824
    s_add_u32 s8, s8, s9
    v_add_u32 v148, s8, v140
    global_load_dword v149, v148, s[12:13]
    s_branch CPF_XE1
CPF_DE1:
    s_sub_u32 s14, s15, 4
    s_mul_i32 s14, s14, 18
    s_add_u32 s14, s14, s101
    s_min_u32 s14, s14, 80
    s_mul_i32 s8, s4, 81
    s_add_u32 s8, s8, 80
    s_sub_u32 s8, s8, s14
    s_lshl_b32 s8, s8, 13
    v_lshl_add_u32 v148, v2, 7, s8
    global_load_dword v149, v148, s[42:43]
CPF_XE1:
    s_add_u32 s15, s7, 4
    s_cmp_ge_u32 s15, 4
    s_cbranch_scc1 CPF_DE2
    s_mul_i32 s14, s15, 18
    s_add_u32 s14, s14, s101
    v_mul_u32_u24 v140, 9216, v2
    s_mul_i32 s8, s4, 1152
    v_add_u32 v140, s8, v140
    s_mul_i32 s8, s14, 7282
    s_lshr_b32 s8, s8, 16
    s_mul_i32 s9, s8, 9
    s_sub_u32 s9, s14, s9
    s_lshl_b32 s9, s9, 7
    s_bitcmp1_b32 s8, 0
    s_cselect_b32 s12, s40, s38
    s_cselect_b32 s13, s41, s39
    s_lshr_b32 s8, s8, 1
    s_add_u32 s8, s8, 5
    s_mul_i32 s8, s8, 589824
    s_add_u32 s8, s8, s9
    v_add_u32 v148, s8, v140
    global_load_dword v149, v148, s[12:13]
    s_branch CPF_XE2
CPF_DE2:
    s_sub_u32 s14, s15, 4
    s_mul_i32 s14, s14, 18
    s_add_u32 s14, s14, s101
    s_min_u32 s14, s14, 80
    s_mul_i32 s8, s4, 81
    s_add_u32 s8, s8, 80
    s_sub_u32 s8, s8, s14
    s_lshl_b32 s8, s8, 13
    v_lshl_add_u32 v148, v2, 7, s8
    global_load_dword v149, v148, s[42:43]
CPF_XE2:
E_NOG:
    v_lshlrev_b32 v24, 16, v8
    v_and_b32 v28, 0xffff0000, v8
    v_lshlrev_b32 v32, 16, v9
    v_and_b32 v36, 0xffff0000, v9
    v_lshlrev_b32 v25, 16, v10
    v_and_b32 v29, 0xffff0000, v10
    v_lshlrev_b32 v33, 16, v11
    v_and_b32 v37, 0xffff0000, v11
    v_lshlrev_b32 v26, 16, v12
    v_and_b32 v30, 0xffff0000, v12
    v_lshlrev_b32 v34, 16, v13
    v_and_b32 v38, 0xffff0000, v13
    v_lshlrev_b32 v27, 16, v14
    v_and_b32 v31, 0xffff0000, v14
    v_lshlrev_b32 v35, 16, v15
    v_and_b32 v39, 0xffff0000, v15
    v_lshlrev_b32 v40, 16, v16
    v_and_b32 v44, 0xffff0000, v16
    v_lshlrev_b32 v48, 16, v17
    v_and_b32 v52, 0xffff0000, v17
    v_lshlrev_b32 v41, 16, v18
    v_and_b32 v45, 0xffff0000, v18
    v_lshlrev_b32 v49, 16, v19
    v_and_b32 v53, 0xffff0000, v19
    v_lshlrev_b32 v42, 16, v20
    v_and_b32 v46, 0xffff0000, v20
    v_lshlrev_b32 v50, 16, v21
    v_and_b32 v54, 0xffff0000, v21
    v_lshlrev_b32 v43, 16, v22
    v_and_b32 v47, 0xffff0000, v22
    v_lshlrev_b32 v51, 16, v23
    v_and_b32 v55, 0xffff0000, v23
    s_cmp_ge_u32 s7, 2
    s_cbranch_scc1 E_GATES
E_T0:
    s_mov_b32 s12, 0
SPN15:
    ds_read_b32 v60, v141 offset:0
    s_add_u32 s12, s12, 1
    s_waitcnt lgkmcnt(0)
    v_cmp_eq_u32 vcc, 0, v60
    s_cmp_ge_u32 s12, 0x40000
    s_cbranch_scc1 SPX15
    s_cbranch_vccz SPX15
    s_sleep 1
    s_branch SPN15
SPX15:
    ds_read_b128 v[96:99], v159 offset:0
    ds_read_b128 v[112:115], v159 offset:10240
    ds_read_b128 v[100:103], v159 offset:20480
    ds_read_b128 v[116:119], v159 offset:30720
    ds_read_b128 v[104:107], v136 offset:0
    ds_read_b128 v[120:123], v136 offset:10240
    ds_read_b128 v[108:111], v136 offset:20480
    ds_read_b128 v[124:127], v136 offset:30720
    s_waitcnt lgkmcnt(6)
    v_add_f32 v96, v96, v112
    v_fmac_f32 v96, v24, v154
    v_add_f32 v97, v97, v113
    v_fmac_f32 v97, v25, v154
    v_add_f32 v98, v98, v114
    v_fmac_f32 v98, v26, v154
    v_add_f32 v99, v99, v115
    v_fmac_f32 v99, v27, v154
    s_waitcnt lgkmcnt(4)
    v_add_f32 v100, v100, v116
    v_fmac_f32 v100, v28, v155
    v_add_f32 v101, v101, v117
    v_fmac_f32 v101, v29, v155
    v_add_f32 v102, v102, v118
    v_fmac_f32 v102, v30, v155
    v_add_f32 v103, v103, v119
    v_fmac_f32 v103, v31, v155
    s_waitcnt lgkmcnt(2)
    v_add_f32 v104, v104, v120
    v_fmac_f32 v104, v32, v156
    v_add_f32 v105, v105, v121
    v_fmac_f32 v105, v33, v156
    v_add_f32 v106, v106, v122
    v_fmac_f32 v106, v34, v156
    v_add_f32 v107, v107, v123
    v_fmac_f32 v107, v35, v156
    s_waitcnt lgkmcnt(0)
    v_add_f32 v108, v108, v124
    v_fmac_f32 v108, v36, v157
    v_add_f32 v109, v109, v125
    v_fmac_f32 v109, v37, v157
    v_add_f32 v110, v110, v126
    v_fmac_f32 v110, v38, v157
    v_add_f32 v111, v111, v127
    v_fmac_f32 v111, v39, v157
    s_cmp_ge_u32 s7, 2
    s_cbranch_scc1 E_OUT0
E_GATES:
    s_cmp_lt_u32 s7, 2
    s_cbranch_scc1 E_G1
    s_mov_b32 s12, 0
SPN16:
    ds_read_b32 v60, v57 offset:116
    s_add_u32 s12, s12, 1
    s_waitcnt lgkmcnt(0)
    v_cmp_ne_u32 vcc, 2, v60
    s_cmp_ge_u32 s12, 0x40000
    s_cbranch_scc1 SPX16
    s_cbranch_vccz SPX16
    s_sleep 1
    s_branch SPN16
SPX16:
    ds_read_b128 v[128:131], v147
    ds_read_b128 v[132:135], v147 offset:2048
    s_waitcnt lgkmcnt(0)
    s_branch E_GX
E_G1:
    s_mov_b32 s12, 0
    s_waitcnt vmcnt(3)
    s_branch E_GCHK
E_GPOLL:
    global_load_dwordx2 v[144:145], v59, s[48:49] sc1
    global_load_dwordx4 v[128:131], v158, s[50:51] sc1
    v_add_u32 v137, 8192, v158
    global_load_dwordx4 v[132:135], v137, s[50:51] sc1
    v_add_u32 v137, 16384, v158
    global_load_dwordx4 v[160:163], v137, s[50:51] sc1
    global_load_dwordx4 v[164:167], v138, s[50:51] sc1
    s_add_u32 s12, s12, 1
    s_waitcnt vmcnt(0)
E_GCHK:
    v_xor_b32 v61, 1, v145
    v_bitop3_b32 v61, v61, v128, v144 bitop3:0xf6
    v_bitop3_b32 v61, v61, v129, v144 bitop3:0xf6
    v_bitop3_b32 v61, v61, v130, v144 bitop3:0xf6
    v_bitop3_b32 v61, v61, v131, v144 bitop3:0xf6
    v_bitop3_b32 v61, v61, v132, v144 bitop3:0xf6
    v_bitop3_b32 v61, v61, v133, v144 bitop3:0xf6
    v_bitop3_b32 v61, v61, v134, v144 bitop3:0xf6
    v_bitop3_b32 v61, v61, v135, v144 bitop3:0xf6
    v_bitop3_b32 v61, v61, v160, v144 bitop3:0xf6
    v_bitop3_b32 v61, v61, v161, v144 bitop3:0xf6
    v_bitop3_b32 v61, v61, v162, v144 bitop3:0xf6
    v_bitop3_b32 v61, v61, v163, v144 bitop3:0xf6
    v_bitop3_b32 v61, v61, v164, v144 bitop3:0xf6
    v_bitop3_b32 v61, v61, v165, v144 bitop3:0xf6
    v_bitop3_b32 v61, v61, v166, v144 bitop3:0xf6
    v_bitop3_b32 v61, v61, v167, v144 bitop3:0xf6
    v_and_b32 v61, 0xffff, v61
    v_cmp_ne_u32 vcc, 0, v61
    s_cmp_ge_u32 s12, 16384
    s_cbranch_scc1 E_GOK
    s_cbranch_vccnz E_GPOLL
E_GOK:
    ds_write_b128 v147, v[160:163] offset:4096
    ds_write_b128 v147, v[164:167] offset:6144
    ds_write_b128 v147, v[128:131] offset:0
    ds_write_b128 v147, v[132:135] offset:2048
    ds_write_b32 v57, v144 offset:120
    s_mov_b64 exec, 1
    ds_add_u32 v57, v139 offset:116
    s_mov_b64 exec, -1
E_GX:
    ds_write_b128 v142, v[8:11] offset:0
    ds_write_b128 v142, v[12:15] offset:16
    ds_write_b128 v142, v[16:19] offset:4096
    ds_write_b128 v142, v[20:23] offset:4112
    s_mov_b64 exec, 1
    ds_add_u32 v57, v139 offset:244
    s_mov_b64 exec, -1
    v_and_b32 v128, 0xffff0000, v128
    v_and_b32 v129, 0xffff0000, v129
    v_and_b32 v130, 0xffff0000, v130
    v_and_b32 v131, 0xffff0000, v131
    s_cmp_ge_u32 s7, 2
    s_cbranch_scc1 E_T0
E_OUT0:
    v_fma_f32 v96, v96, v128, v24
    v_fma_f32 v100, v100, v128, v28
    v_fma_f32 v104, v104, v128, v32
    v_fma_f32 v108, v108, v128, v36
    v_cvt_pk_bf16_f32 v112, v96, v100
    v_cvt_pk_bf16_f32 v113, v104, v108
    global_store_dwordx2 v5, v[112:113], s[46:47] offset:0
    v_fma_f32 v97, v97, v129, v25
    v_fma_f32 v101, v101, v129, v29
    v_fma_f32 v105, v105, v129, v33
    v_fma_f32 v109, v109, v129, v37
    v_cvt_pk_bf16_f32 v114, v97, v101
    v_cvt_pk_bf16_f32 v115, v105, v109
    global_store_dwordx2 v5, v[114:115], s[46:47] offset:1152
    v_fma_f32 v98, v98, v130, v26
    v_fma_f32 v102, v102, v130, v30
    v_fma_f32 v106, v106, v130, v34
    v_fma_f32 v110, v110, v130, v38
    v_cvt_pk_bf16_f32 v116, v98, v102
    v_cvt_pk_bf16_f32 v117, v106, v110
    global_store_dwordx2 v5, v[116:117], s[46:47] offset:2304
    v_fma_f32 v99, v99, v131, v27
    v_fma_f32 v103, v103, v131, v31
    v_fma_f32 v107, v107, v131, v35
    v_fma_f32 v111, v111, v131, v39
    v_cvt_pk_bf16_f32 v118, v99, v103
    v_cvt_pk_bf16_f32 v119, v107, v111
    global_store_dwordx2 v5, v[118:119], s[46:47] offset:3456
    v_and_b32 v132, 0xffff0000, v132
    v_and_b32 v133, 0xffff0000, v133
    v_and_b32 v134, 0xffff0000, v134
    v_and_b32 v135, 0xffff0000, v135
    s_mov_b32 s12, 0
SPN17:
    ds_read_b32 v60, v141 offset:64
    s_add_u32 s12, s12, 1
    s_waitcnt lgkmcnt(0)
    v_cmp_eq_u32 vcc, 0, v60
    s_cmp_ge_u32 s12, 0x40000
    s_cbranch_scc1 SPX17
    s_cbranch_vccz SPX17
    s_sleep 1
    s_branch SPN17
SPX17:
    ds_read_b128 v[96:99], v159 offset:2560
    ds_read_b128 v[112:115], v159 offset:12800
    ds_read_b128 v[100:103], v159 offset:23040
    ds_read_b128 v[116:119], v159 offset:33280
    ds_read_b128 v[104:107], v136 offset:2560
    ds_read_b128 v[120:123], v136 offset:12800
    ds_read_b128 v[108:111], v136 offset:23040
    ds_read_b128 v[124:127], v136 offset:33280
    s_waitcnt lgkmcnt(6)
    v_add_f32 v96, v96, v112
    v_fmac_f32 v96, v40, v154
    v_add_f32 v97, v97, v113
    v_fmac_f32 v97, v41, v154
    v_add_f32 v98, v98, v114
    v_fmac_f32 v98, v42, v154
    v_add_f32 v99, v99, v115
    v_fmac_f32 v99, v43, v154
    s_waitcnt lgkmcnt(4)
    v_add_f32 v100, v100, v116
    v_fmac_f32 v100, v44, v155
    v_add_f32 v101, v101, v117
    v_fmac_f32 v101, v45, v155
    v_add_f32 v102, v102, v118
    v_fmac_f32 v102, v46, v155
    v_add_f32 v103, v103, v119
    v_fmac_f32 v103, v47, v155
    s_waitcnt lgkmcnt(2)
    v_add_f32 v104, v104, v120
    v_fmac_f32 v104, v48, v156
    v_add_f32 v105, v105, v121
    v_fmac_f32 v105, v49, v156
    v_add_f32 v106, v106, v122
    v_fmac_f32 v106, v50, v156
    v_add_f32 v107, v107, v123
    v_fmac_f32 v107, v51, v156
    s_waitcnt lgkmcnt(0)
    v_add_f32 v108, v108, v124
    v_fmac_f32 v108, v52, v157
    v_add_f32 v109, v109, v125
    v_fmac_f32 v109, v53, v157
    v_add_f32 v110, v110, v126
    v_fmac_f32 v110, v54, v157
    v_add_f32 v111, v111, v127
    v_fmac_f32 v111, v55, v157
    v_fma_f32 v96, v96, v132, v40
    v_fma_f32 v100, v100, v132, v44
    v_fma_f32 v104, v104, v132, v48
    v_fma_f32 v108, v108, v132, v52
    v_cvt_pk_bf16_f32 v112, v96, v100
    v_cvt_pk_bf16_f32 v113, v104, v108
    global_store_dwordx2 v6, v[112:113], s[46:47] offset:0
    v_fma_f32 v97, v97, v133, v41
    v_fma_f32 v101, v101, v133, v45
    v_fma_f32 v105, v105, v133, v49
    v_fma_f32 v109, v109, v133, v53
    v_cvt_pk_bf16_f32 v114, v97, v101
    v_cvt_pk_bf16_f32 v115, v105, v109
    global_store_dwordx2 v6, v[114:115], s[46:47] offset:1152
    v_fma_f32 v98, v98, v134, v42
    v_fma_f32 v102, v102, v134, v46
    v_fma_f32 v106, v106, v134, v50
    v_fma_f32 v110, v110, v134, v54
    v_cvt_pk_bf16_f32 v116, v98, v102
    v_cvt_pk_bf16_f32 v117, v106, v110
    global_store_dwordx2 v6, v[116:117], s[46:47] offset:2304
    v_fma_f32 v99, v99, v135, v43
    v_fma_f32 v103, v103, v135, v47
    v_fma_f32 v107, v107, v135, v51
    v_fma_f32 v111, v111, v135, v55
    v_cvt_pk_bf16_f32 v118, v99, v103
    v_cvt_pk_bf16_f32 v119, v107, v111
    global_store_dwordx2 v6, v[118:119], s[46:47] offset:3456
    s_waitcnt vmcnt(0)
    s_endpgm
FINAL:
    v_and_b32 v5, 7, v2
    v_lshlrev_b32 v5, 2, v5
    s_lshl_b32 s10, s6, 3
    s_load_dwordx2 s[52:53], s[32:33], s10
    s_mov_b32 s12, 0
SPN18:
    ds_read_b32 v42, v167 offset:244
    s_add_u32 s12, s12, 1
    s_waitcnt lgkmcnt(0)
    v_cmp_ne_u32 vcc, 4, v42
    s_cmp_ge_u32 s12, 0x40000
    s_cbranch_scc1 SPX18
    s_cbranch_vccz SPX18
    s_sleep 1
    s_branch SPN18
SPX18:
    ds_read_b32 v42, v167 offset:120
    s_waitcnt lgkmcnt(0)
    v_and_b32 v6, 4, v2
    v_add_u32 v6, v6, v4
    s_lshl_b32 s9, s4, 8
    v_lshl_add_u32 v6, v6, 3, s9
    v_and_b32 v7, 4, v2
    v_add_u32 v7, v7, v4
    s_lshl_b32 s9, s4, 10
    s_add_u32 s9, s9, 48896
    v_lshl_add_u32 v7, v7, 7, s9
    s_mov_b32 s12, 0
    s_waitcnt vmcnt(0)
    v_mov_b32 v8, v124
    v_mov_b32 v9, v125
    s_branch SPC_F
SP_F:
    s_add_u32 s12, s12, 1
    s_and_b32 s9, s12, 7
    s_cselect_b64 s[14:15], 0, -1
    v_cndmask_b32 v10, v6, v7, s[14:15]
    global_load_dwordx2 v[8:9], v10, s[50:51] offset:256 sc1
    s_waitcnt vmcnt(0)
SPC_F:
    v_cmp_ne_u32 vcc, v9, v42
    s_cmp_ge_u32 s12, 16384
    s_cbranch_scc1 SPX_F
    s_cbranch_vccz SPX_F
    s_mov_b64 exec, vcc
    s_sleep 2
    s_branch SP_F
SPX_F:
    s_mov_b64 exec, -1
    v_and_b32 v9, 0xff, v42
    v_not_b32 v10, v8
    v_and_b32 v10, 0x7ff, v10
    v_and_b32 v23, 3, v2
    v_mul_u32_u24 v11, 1152, v10
    v_lshl_add_u32 v11, v23, 1, v11
    v_add_u32 v11, s10, v11
    v_lshlrev_b32 v14, 3, v10
    v_lshl_add_u32 v14, v23, 1, v14
    v_add_u32 v14, 81920, v14
    ds_read_u16 v24, v14
    v_lshlrev_b32 v14, 2, v10
    v_add_u32 v14, 98304, v14
    ds_read_b32 v15, v14
    v_lshrrev_b32 v16, 8, v10
    v_mul_u32_u24 v16, 1280, v16
    v_and_b32 v17, 0xf0, v10
    v_add_u32 v16, v16, v17
    v_bfe_u32 v17, v10, 2, 2
    v_mul_u32_u24 v17, 320, v17
    v_add_u32 v16, v16, v17
    v_and_b32 v17, 3, v10
    v_lshl_add_u32 v16, v17, 2, v16
    v_mul_u32_u24 v17, 20480, v23
    v_add_u32 v16, v16, v17
    v_add_u32 v18, 154080, v5
    v_and_b32 v20, 0xffff0000, v8
    v_not_b32 v21, v20
    v_ashrrev_i32 v21, 31, v21
    v_and_b32 v21, 0x7fff0000, v21
    v_or_b32 v21, 0x80000000, v21
    v_xor_b32 v20, v20, v21
    v_mul_f32 v21, 0xbfb8aa3b, v20
    v_exp_f32 v21, v21
    s_nop 0
    v_add_f32 v21, 1.0, v21
    v_rcp_f32 v21, v21
    s_nop 0
    v_cvt_pk_bf16_f32 v20, v21, v21
    v_and_b32 v20, 0xffff0000, v20
    s_waitcnt lgkmcnt(0)
    v_and_b32 v15, 0xffff0000, v15
    v_sub_f32 v21, 1.0, v15
    v_cvt_pk_bf16_f32 v21, v21, v21
    v_and_b32 v21, 0xffff0000, v21
    v_lshlrev_b32 v24, 16, v24
    v_lshlrev_b32 v25, 4, v23
    v_lshrrev_b64 v[26:27], v25, s[52:53]
    v_lshlrev_b32 v26, 16, v26
    v_mul_f32 v26, v26, v24
    v_cvt_pk_bf16_f32 v26, 0, v26
    s_mul_i32 s8, s6, 1152
    s_add_u32 s8, s8, 352256
    s_mov_b32 s12, 0
SPN19:
    ds_read_b32 v22, v18 offset:0
    s_add_u32 s12, s12, 1
    s_waitcnt lgkmcnt(0)
    v_cmp_eq_u32 vcc, 0, v22
    s_cmp_ge_u32 s12, 0x40000
    s_cbranch_scc1 SPX19
    s_cbranch_vccz SPX19
    s_sleep 1
    s_branch SPN19
SPX19:
    ds_read_b32 v28, v16
    ds_read_b32 v29, v16 offset:10240
    v_lshl_add_u32 v22, v2, 4, s8
    s_mov_b32 s72, 0x00ff00ff
    s_mov_b32 s73, 0x00ff00ff
    s_waitcnt lgkmcnt(0)
    v_add_f32 v28, v28, v29
    v_cvt_pk_bf16_f32 v28, 0, v28
    v_add_f32 v28, v28, v26
    v_cvt_pk_bf16_f32 v28, 0, v28
    v_mul_f32 v28, v28, v15
    v_cvt_pk_bf16_f32 v28, 0, v28
    v_min_u32 v33, 4, v2
    s_lshl_b32 s11, s4, 7
    v_lshl_add_u32 v33, v33, 2, s11
    s_mov_b32 s12, 0
FN_R:
    global_load_dword v34, v33, s[50:51] offset:2304 sc1
    s_add_u32 s12, s12, 1
    s_waitcnt vmcnt(0)
    v_cmp_ne_u32 vcc, v34, v42
    s_cmp_ge_u32 s12, 64
    s_cbranch_scc1 FN_RX
    s_cbranch_vccz FN_RX
    s_sleep 2
    s_branch FN_R
FN_RX:
    s_mov_b32 s12, 0
FN_P:
    global_load_dwordx4 v[48:51], v22, s[50:51] sc1
    s_add_u32 s12, s12, 1
    s_waitcnt vmcnt(0)
    v_xor_b32 v48, v48, v9
    v_xor_b32 v49, v49, v9
    v_xor_b32 v50, v50, v9
    v_xor_b32 v51, v51, v9
    v_or3_b32 v32, v48, v49, v50
    v_or_b32 v32, v32, v51
    v_and_b32 v32, 0xff, v32
    v_cmp_ne_u32 vcc, 0, v32
    s_cmp_ge_u32 s12, 65536
    s_cbranch_scc1 FN_POK
    s_cbranch_vccz FN_POK
    s_mov_b64 exec, vcc
    s_branch FN_P
FN_POK:
    s_mov_b64 exec, -1
    v_permlane32_swap_b32 v48, v50
    v_permlane32_swap_b32 v49, v51
    v_add_f32 v48, v48, v50
    v_add_f32 v49, v49, v51
    s_nop 1
    v_permlane16_swap_b32 v48, v49
    v_add_f32 v48, v48, v49
    s_nop 1
    v_add_f32_dpp v48, v48, v48 row_ror:8 row_mask:0xf bank_mask:0xf
    v_cvt_pk_bf16_f32 v48, 0, v48
    v_mul_f32 v48, v48, v20
    v_cvt_pk_bf16_f32 v48, 0, v48
    v_add_f32 v48, v48, v24
    v_cvt_pk_bf16_f32 v48, 0, v48
    v_mul_f32 v48, v48, v21
    v_cvt_pk_bf16_f32 v48, 0, v48
    v_add_f32 v48, v48, v28
    v_cvt_pk_bf16_f32 v48, 0, v48
    s_barrier
    s_mov_b64 exec, s[72:73]
    global_store_short_d16_hi v11, v48, s[46:47]
    s_endpgm
W_END:
    s_endpgm
K_END:
    s_endpgm
CODE_END:
.section .rodata,"a"
.p2align 6
.amdhsa_kernel k1_kernel
  .amdhsa_next_free_vgpr 168
  .amdhsa_next_free_sgpr 102
  .amdhsa_accum_offset 168
  .amdhsa_group_segment_fixed_size 0
  .amdhsa_kernarg_size 144
  .amdhsa_user_sgpr_count 2
  .amdhsa_user_sgpr_kernarg_segment_ptr 1
  .amdhsa_system_sgpr_workgroup_id_x 1
.end_amdhsa_kernel
```

```asm
; @launch kernel=k1_kernel grid=(256,1,1) block=(768,1,1) lds=163840
.amdgcn_target "amdgcn-amd-amdhsa--gfx950"
.text
.p2align 8
.globl k1_kernel
.type k1_kernel,@function
k1_kernel:
    s_cmp_ge_u32 s2, 256
    s_cbranch_scc1 K_END
    s_load_dwordx16 s[16:31], s[0:1], 0
    s_load_dwordx16 s[32:47], s[0:1], 64
    s_load_dwordx4 s[48:51], s[0:1], 128
    v_lshrrev_b32 v1, 6, v0
    v_and_b32 v2, 63, v0
    v_readfirstlane_b32 s3, v1
    v_and_b32 v3, 15, v2
    v_lshrrev_b32 v4, 4, v2
    s_and_b32 s4, s2, 7
    s_lshr_b32 s5, s2, 3
    s_cmp_lg_u32 s3, 0
    s_cbranch_scc1 K_NOCPF
    s_getpc_b64 s[8:9]
    s_and_b32 s8, s8, 0xffffff00
    v_and_b32 v5, 7, v2
    v_lshl_add_u32 v5, s5, 3, v5
    v_lshlrev_b32 v5, 7, v5
    v_min_u32 v5, CODE_END-k1_kernel-4, v5
    global_load_dword v167, v5, s[8:9]
K_NOCPF:
    s_cmp_lt_u32 s2, 112
    s_cbranch_scc1 K_NC
    s_sub_u32 s101, s5, 14
    s_mul_i32 s6, s4, 18
    s_add_u32 s6, s6, s101
    s_cmp_lt_u32 s3, 8
    s_cbranch_scc1 CK_PRO
CU_PRO:
    s_sub_u32 s7, s3, 8
    s_lshl_b32 s8, s101, 2
    s_add_u32 s8, s8, s7
    s_mul_i32 s10, s8, 57
    s_lshr_b32 s10, s10, 9
    s_mul_i32 s11, s10, 9
    s_sub_u32 s11, s8, s11
    s_sub_u32 s8, s8, s10
    s_mul_i32 s8, s8, 36864
    s_lshl_b32 s9, s4, 7
    s_add_u32 s8, s8, s9
    v_lshrrev_b32 v5, 1, v2
    v_mul_u32_u24 v5, 1152, v5
    v_and_b32 v6, 1, v2
    v_lshl_add_u32 v5, v6, 7, v5
    v_add_u32 v7, s8, v5
    s_and_b32 s15, s7, 2
    s_add_u32 s15, s15, s7
    s_mul_i32 s8, s15, 294912
    s_lshl_b32 s9, s6, 3
    s_add_u32 s8, s8, s9
    v_mul_u32_u24 v5, 4608, v2
    v_add_u32 v5, s8, v5
    v_add_u32 v6, 589824, v5
    v_mov_b32 v58, 0
    v_mov_b32 v59, 0
    v_mov_b32 v57, 153600
    v_lshl_add_u32 v56, v2, 3, v57
    ds_write_b64 v56, v[58:59]
    s_waitcnt lgkmcnt(0)
    s_barrier
    s_cmp_eq_u32 s7, 3
    s_cbranch_scc1 CU_C3A
CU_C3B:
    global_load_dword v60, v59, s[30:31]
    s_load_dwordx2 s[52:53], s[32:33], s9
    s_branch CU_PRE
CU_PREX:
    s_cmp_eq_u32 s11, 8
    s_cbranch_scc1 CU_C3
    global_load_dword v60, v7, s[16:17]
CU_C3X:
    s_cmp_ge_u32 s7, 2
    s_cbranch_scc1 CU_MID
CU_LD:
    global_load_dwordx2 v[8:9], v5, s[16:17] offset:0 sc1
    global_load_dwordx2 v[10:11], v5, s[16:17] offset:1152 sc1
    global_load_dwordx2 v[12:13], v5, s[16:17] offset:2304 sc1
    global_load_dwordx2 v[14:15], v5, s[16:17] offset:3456 sc1
    global_load_dwordx2 v[16:17], v6, s[16:17] offset:0 sc1
    global_load_dwordx2 v[18:19], v6, s[16:17] offset:1152 sc1
    global_load_dwordx2 v[20:21], v6, s[16:17] offset:2304 sc1
    global_load_dwordx2 v[22:23], v6, s[16:17] offset:3456 sc1
    s_branch CU_MAIN
CK_PRO:
    s_and_b32 s7, s3, 3
    s_lshr_b32 s12, s3, 2
    s_lshl_b32 s8, s6, 2
    s_add_u32 s8, s8, s7
    s_lshl_b32 s9, s8, 8
    v_lshl_add_u32 v6, v2, 2, s9
    s_lshl_b32 s8, s8, 1
    v_mov_b32 v7, s8
    v_mov_b32 v18, 0
    s_waitcnt lgkmcnt(0)
    global_load_short_d16_hi v18, v7, s[30:31]
    global_load_dword v28, v6, s[18:19]
    global_load_dword v29, v6, s[20:21]
    global_load_dword v30, v6, s[22:23]
    global_load_dword v31, v6, s[24:25]
    global_load_dword v32, v6, s[26:27]
    global_load_dword v33, v6, s[28:29]
    s_barrier
    s_branch CK_MAIN
K_NC:
    s_lshl_b32 s6, s2, 4
    s_lshl_b32 s7, s3, 2
    s_sub_u32 s7, s7, 32
    s_cmp_ge_u32 s3, 8
    s_cbranch_scc1 RT_PRO
    s_cmp_lt_u32 s2, 72
    s_cbranch_scc1 F_PRO
    s_cmp_lt_u32 s3, 6
    s_cbranch_scc1 HELPER
    s_cmp_lt_u32 s2, 80
    s_cbranch_scc1 HELPER
    s_add_u32 s7, s7, 24
    s_lshr_b32 s6, s6, 1
    s_add_u32 s6, s6, 1136
RT_PRO:
    s_add_u32 s6, s6, s7
    v_add_u32 v5, s6, v4
    v_lshlrev_b32 v6, 4, v3
    v_lshlrev_b32 v7, 3, v3
    v_mul_u32_u24 v9, 1152, v5
    v_add_u32 v8, v9, v6
    v_add_u32 v9, v9, v7
    v_mov_b32 v10, 0
    v_lshlrev_b32 v11, 2, v2
    v_add_u32 v12, 163520, v11
    ds_write_b32 v12, v10
    v_and_b32 v11, 0x7c, v11
    v_lshlrev_b32 v12, 4, v2
    s_mul_i32 s13, s7, 640
    s_add_u32 s13, s13, 147456
    s_mov_b32 m0, s13
    s_waitcnt lgkmcnt(0)
    s_load_dword s12, s[50:51], 0
    global_load_lds_dwordx4 v12, s[36:37]
    global_load_lds_dword v11, s[36:37] offset:1024
    s_add_u32 m0, s13, 1280
    v_add_u32 v6, s13, v6
    global_load_lds_dwordx4 v12, s[44:45]
    global_load_lds_dword v11, s[44:45] offset:1024
    global_load_dwordx4 v[16:19], v8, s[16:17] offset:0
    global_load_dwordx4 v[20:23], v8, s[16:17] offset:256
    global_load_dwordx4 v[24:27], v8, s[16:17] offset:512
    global_load_dwordx4 v[28:31], v8, s[16:17] offset:768
    global_load_dwordx2 v[32:33], v9, s[16:17] offset:1024
    s_barrier
    s_branch RT_MAIN
F_PRO:
    s_mul_i32 s6, s4, 9
    s_add_u32 s6, s6, s5
    v_lshrrev_b32 v6, 3, v2
    v_and_b32 v7, 2, v6
    v_mad_u32_u24 v7, v7, 3, v6
    v_mul_u32_u24 v5, 9216, v7
    v_and_b32 v7, 6, v6
    v_xor_b32 v7, v7, v2
    v_and_b32 v7, 7, v7
    v_lshl_add_u32 v5, v7, 4, v5
    s_and_b32 s8, s3, 1
    s_lshr_b32 s9, s3, 1
    s_lshl_b32 s9, s9, 3
    s_add_u32 s8, s8, s9
    s_mul_i32 s14, s8, 18432
    s_lshl_b32 s8, s6, 7
    s_add_u32 s14, s14, s8
    s_lshl_b32 s15, s3, 10
    s_mov_b32 s54, 5308416
    s_mov_b32 s55, 0x20000
    s_mov_b32 s58, 5308416
    s_mov_b32 s59, 0x20000
    s_waitcnt lgkmcnt(0)
    s_mov_b64 s[52:53], s[38:39]
    s_mov_b64 s[56:57], s[40:41]
    s_barrier
    s_branch F_MAIN
HELPER:
    v_lshrrev_b32 v6, 3, v2
    v_and_b32 v7, 2, v6
    v_mad_u32_u24 v7, v7, 3, v6
    v_mul_u32_u24 v5, 1152, v7
    v_and_b32 v7, 6, v6
    v_xor_b32 v7, v7, v2
    v_and_b32 v7, 7, v7
    v_lshl_add_u32 v5, v7, 4, v5
    s_lshl_b32 s8, s5, 1
    s_sub_u32 s8, s8, 20
    s_cmp_lt_u32 s2, 80
    s_cselect_b32 s8, 8, s8
    s_cselect_b32 s70, 8, 6
    s_cselect_b32 s69, 2, 4
    s_cselect_b32 s67, 1, 0
    s_cselect_b32 s71, 1, 2
    s_mul_i32 s71, s71, 72
    s_lshl_b32 s8, s8, 7
    s_mul_i32 s14, s4, 663552
    s_add_u32 s14, s14, s8
    s_mov_b32 s6, s3
    s_waitcnt lgkmcnt(0)
    s_mov_b32 s60, s42
    s_mov_b32 s61, s43
    s_mov_b32 s62, 5308416
    s_mov_b32 s63, 0x20000
    s_barrier
    s_branch DN_LOAD
RT_MAIN:
    s_mul_i32 s6, s2, 256
    s_add_u32 s6, s6, 4096
    v_lshl_add_u32 v5, v2, 2, s6
    s_cmp_lt_u32 s2, 80
    s_cselect_b32 s8, 15, 23
    v_and_b32 v14, 31, v2
    v_min_u32 v14, s8, v14
    v_and_or_b32 v14, v2, 32, v14
    s_mov_b32 s8, 163520
    v_lshl_add_u32 v14, v14, 2, s8
    v_add_u32 v13, s7, v4
    v_lshl_add_u32 v13, v13, 2, s8
    s_mov_b32 s8, 0xffff
    s_mov_b32 s10, 0x00010001
    s_mov_b32 s11, 0x00010001
    v_mov_b32 v12, 163456
    s_waitcnt lgkmcnt(0)
    s_add_u32 s12, s12, 1
    v_mov_b32 v11, s12
    ds_write_b64 v12, v[10:11]
    v_add_u32 v7, s13, v7
    s_waitcnt vmcnt(5)
    ds_read_b128 v[52:55], v6 offset:1280
    ds_read_b128 v[56:59], v6 offset:1536
    ds_read_b128 v[60:63], v6 offset:1792
    ds_read_b128 v[64:67], v6 offset:2048
    ds_read_b64 v[68:69], v7 offset:2304
    ds_read_b128 v[34:37], v6 offset:0
    ds_read_b128 v[38:41], v6 offset:256
    ds_read_b128 v[42:45], v6 offset:512
    ds_read_b128 v[46:49], v6 offset:768
    ds_read_b64 v[50:51], v7 offset:1024
    v_mov_b32 v8, 0x3f803f80
    s_waitcnt lgkmcnt(5)
    v_and_b32 v84, 0xffff, v52
    v_and_b32 v52, 0xffff0000, v52
    v_and_b32 v85, 0xffff, v53
    v_and_b32 v53, 0xffff0000, v53
    v_and_b32 v86, 0xffff, v54
    v_and_b32 v54, 0xffff0000, v54
    v_and_b32 v87, 0xffff, v55
    v_and_b32 v55, 0xffff0000, v55
    v_and_b32 v88, 0xffff, v56
    v_and_b32 v56, 0xffff0000, v56
    v_and_b32 v89, 0xffff, v57
    v_and_b32 v57, 0xffff0000, v57
    v_and_b32 v90, 0xffff, v58
    v_and_b32 v58, 0xffff0000, v58
    v_and_b32 v91, 0xffff, v59
    v_and_b32 v59, 0xffff0000, v59
    v_and_b32 v92, 0xffff, v60
    v_and_b32 v60, 0xffff0000, v60
    v_and_b32 v93, 0xffff, v61
    v_and_b32 v61, 0xffff0000, v61
    v_and_b32 v94, 0xffff, v62
    v_and_b32 v62, 0xffff0000, v62
    v_and_b32 v95, 0xffff, v63
    v_and_b32 v63, 0xffff0000, v63
    v_and_b32 v96, 0xffff, v64
    v_and_b32 v64, 0xffff0000, v64
    v_and_b32 v97, 0xffff, v65
    v_and_b32 v65, 0xffff0000, v65
    v_and_b32 v98, 0xffff, v66
    v_and_b32 v66, 0xffff0000, v66
    v_and_b32 v99, 0xffff, v67
    v_and_b32 v67, 0xffff0000, v67
    v_and_b32 v100, 0xffff, v68
    v_and_b32 v68, 0xffff0000, v68
    v_and_b32 v101, 0xffff, v69
    v_and_b32 v69, 0xffff0000, v69
    s_waitcnt lgkmcnt(0)
    s_waitcnt vmcnt(4)
    v_dot2_f32_bf16 v70, v16, v84, 0
    v_dot2_f32_bf16 v71, v16, v52, 0
    v_dot2_f32_bf16 v72, v17, v85, 0
    v_dot2_f32_bf16 v73, v17, v53, 0
    v_dot2_f32_bf16 v74, v18, v86, 0
    v_dot2_f32_bf16 v75, v18, v54, 0
    v_dot2_f32_bf16 v76, v19, v87, 0
    v_dot2_f32_bf16 v77, v19, v55, 0
    v_dot2_f32_bf16 v12, v16, v34, 0
    v_dot2_f32_bf16 v12, v17, v35, v12
    v_dot2_f32_bf16 v12, v18, v36, v12
    v_dot2_f32_bf16 v12, v19, v37, v12
    v_cvt_pk_bf16_f32 v70, v70, v71
    v_cvt_pk_bf16_f32 v72, v72, v73
    v_cvt_pk_bf16_f32 v74, v74, v75
    v_cvt_pk_bf16_f32 v76, v76, v77
    v_dot2_f32_bf16 v15, v70, v8, 0
    v_dot2_f32_bf16 v15, v72, v8, v15
    v_dot2_f32_bf16 v15, v74, v8, v15
    v_dot2_f32_bf16 v15, v76, v8, v15
    s_waitcnt vmcnt(3)
    v_dot2_f32_bf16 v70, v20, v88, 0
    v_dot2_f32_bf16 v71, v20, v56, 0
    v_dot2_f32_bf16 v72, v21, v89, 0
    v_dot2_f32_bf16 v73, v21, v57, 0
    v_dot2_f32_bf16 v74, v22, v90, 0
    v_dot2_f32_bf16 v75, v22, v58, 0
    v_dot2_f32_bf16 v76, v23, v91, 0
    v_dot2_f32_bf16 v77, v23, v59, 0
    v_dot2_f32_bf16 v12, v20, v38, v12
    v_dot2_f32_bf16 v12, v21, v39, v12
    v_dot2_f32_bf16 v12, v22, v40, v12
    v_dot2_f32_bf16 v12, v23, v41, v12
    v_cvt_pk_bf16_f32 v70, v70, v71
    v_cvt_pk_bf16_f32 v72, v72, v73
    v_cvt_pk_bf16_f32 v74, v74, v75
    v_cvt_pk_bf16_f32 v76, v76, v77
    v_dot2_f32_bf16 v15, v70, v8, v15
    v_dot2_f32_bf16 v15, v72, v8, v15
    v_dot2_f32_bf16 v15, v74, v8, v15
    v_dot2_f32_bf16 v15, v76, v8, v15
    s_waitcnt vmcnt(2)
    v_dot2_f32_bf16 v70, v24, v92, 0
    v_dot2_f32_bf16 v71, v24, v60, 0
    v_dot2_f32_bf16 v72, v25, v93, 0
    v_dot2_f32_bf16 v73, v25, v61, 0
    v_dot2_f32_bf16 v74, v26, v94, 0
    v_dot2_f32_bf16 v75, v26, v62, 0
    v_dot2_f32_bf16 v76, v27, v95, 0
    v_dot2_f32_bf16 v77, v27, v63, 0
    v_dot2_f32_bf16 v12, v24, v42, v12
    v_dot2_f32_bf16 v12, v25, v43, v12
    v_dot2_f32_bf16 v12, v26, v44, v12
    v_dot2_f32_bf16 v12, v27, v45, v12
    v_cvt_pk_bf16_f32 v70, v70, v71
    v_cvt_pk_bf16_f32 v72, v72, v73
    v_cvt_pk_bf16_f32 v74, v74, v75
    v_cvt_pk_bf16_f32 v76, v76, v77
    v_dot2_f32_bf16 v15, v70, v8, v15
    v_dot2_f32_bf16 v15, v72, v8, v15
    v_dot2_f32_bf16 v15, v74, v8, v15
    v_dot2_f32_bf16 v15, v76, v8, v15
    s_waitcnt vmcnt(1)
    v_dot2_f32_bf16 v70, v28, v96, 0
    v_dot2_f32_bf16 v71, v28, v64, 0
    v_dot2_f32_bf16 v72, v29, v97, 0
    v_dot2_f32_bf16 v73, v29, v65, 0
    v_dot2_f32_bf16 v74, v30, v98, 0
    v_dot2_f32_bf16 v75, v30, v66, 0
    v_dot2_f32_bf16 v76, v31, v99, 0
    v_dot2_f32_bf16 v77, v31, v67, 0
    v_dot2_f32_bf16 v12, v28, v46, v12
    v_dot2_f32_bf16 v12, v29, v47, v12
    v_dot2_f32_bf16 v12, v30, v48, v12
    v_dot2_f32_bf16 v12, v31, v49, v12
    v_cvt_pk_bf16_f32 v70, v70, v71
    v_cvt_pk_bf16_f32 v72, v72, v73
    v_cvt_pk_bf16_f32 v74, v74, v75
    v_cvt_pk_bf16_f32 v76, v76, v77
    v_dot2_f32_bf16 v15, v70, v8, v15
    v_dot2_f32_bf16 v15, v72, v8, v15
    v_dot2_f32_bf16 v15, v74, v8, v15
    v_dot2_f32_bf16 v15, v76, v8, v15
    s_waitcnt vmcnt(0)
    v_dot2_f32_bf16 v70, v32, v100, 0
    v_dot2_f32_bf16 v71, v32, v68, 0
    v_dot2_f32_bf16 v72, v33, v101, 0
    v_dot2_f32_bf16 v73, v33, v69, 0
    v_dot2_f32_bf16 v12, v32, v50, v12
    v_dot2_f32_bf16 v12, v33, v51, v12
    v_cvt_pk_bf16_f32 v70, v70, v71
    v_cvt_pk_bf16_f32 v72, v72, v73
    v_dot2_f32_bf16 v15, v70, v8, v15
    v_dot2_f32_bf16 v15, v72, v8, v15
    s_nop 0
    s_nop 1
    v_add_f32_dpp v15, v15, v15 row_ror:8 row_mask:0xf bank_mask:0xf
    v_add_f32_dpp v12, v12, v12 row_ror:8 row_mask:0xf bank_mask:0xf
    s_nop 0
    v_add_f32_dpp v15, v15, v15 row_ror:4 row_mask:0xf bank_mask:0xf
    v_add_f32_dpp v12, v12, v12 row_ror:4 row_mask:0xf bank_mask:0xf
    s_nop 0
    v_add_f32_dpp v15, v15, v15 row_ror:2 row_mask:0xf bank_mask:0xf
    v_add_f32_dpp v12, v12, v12 row_ror:2 row_mask:0xf bank_mask:0xf
    s_nop 0
    v_add_f32_dpp v15, v15, v15 row_ror:1 row_mask:0xf bank_mask:0xf
    v_add_f32_dpp v12, v12, v12 row_ror:1 row_mask:0xf bank_mask:0xf
    s_nop 0
    v_cvt_pk_bf16_f32 v15, 0, v15
    v_mul_f32 v15, 0xbfb8aa3b, v15
    v_exp_f32 v15, v15
    v_cvt_pk_bf16_f32 v12, v12, v12
    v_add_f32 v15, 1.0, v15
    v_rcp_f32 v15, v15
    v_ashrrev_i32 v9, 31, v12
    v_cvt_pk_bf16_f32 v15, 1.0, v15
    v_or_b32 v9, 0x80000000, v9
    v_bitop3_b32 v12, v12, v9, 1 bitop3:0xbe
    s_mov_b64 exec, s[10:11]
    ds_write2_b32 v13, v12, v15 offset0:0 offset1:32
    s_mov_b64 exec, -1
    s_cmp_lg_u32 s7, 0
    s_cbranch_scc1 RT_X
    s_mov_b32 s9, 0
SPN1:
    ds_read_b32 v12, v14 offset:0
    s_add_u32 s9, s9, 1
    s_waitcnt lgkmcnt(0)
    v_cmp_eq_u32 vcc, 0, v12
    s_cmp_ge_u32 s9, 0x40000
    s_cbranch_scc1 SPX1
    s_cbranch_vccnz SPN1
SPX1:
    v_bfi_b32 v12, s8, v11, v12
    global_store_dword v5, v12, s[50:51] sc1
    s_cmp_lg_u32 s2, 0
    s_cbranch_scc1 RT_X
    v_mov_b32 v8, v11
    v_mov_b32 v9, 1
    global_store_dwordx2 v10, v[8:9], s[48:49] sc1
RT_X:
    s_barrier
RT_TAIL:
    s_cmp_ge_u32 s2, 80
    s_cbranch_scc1 DN_JOIN
    s_cmp_lt_u32 s2, 72
    s_cbranch_scc1 RT_CTL
    s_barrier
    s_branch DN_JOIN
RT_CTL:
    s_cmp_lg_u32 s3, 8
    s_cbranch_scc1 W_END
    v_mov_b32 v14, v11
    s_mul_i32 s8, s4, 9
    s_add_u32 s8, s8, s5
    s_lshl_b32 s8, s8, 12
    s_add_u32 s8, s8, 57344
    v_lshl_add_u32 v23, v3, 7, s8
    global_load_dword v24, v23, s[50:51] sc1
    v_mov_b32 v21, 163456
    v_mov_b32 v22, 16
    s_mov_b32 s64, s16
    s_mov_b32 s65, s17
    s_mov_b32 s66, 2359296
    s_mov_b32 s67, 0x20000
    v_lshlrev_b32 v19, 4, v2
    v_lshlrev_b32 v20, 2, v2
    s_lshl_b32 s13, s4, 10
    s_add_u32 s13, s13, 40960
    s_add_u32 s7, s13, 1024
    s_sleep 16
RT_SC:
    s_load_dwordx16 s[16:31], s[50:51], s13
    s_add_u32 s13, s13, 64
    s_waitcnt lgkmcnt(0)
    s_xor_b32 s8, s17, s12
    s_xor_b32 s9, s19, s12
    s_or_b32 s8, s8, s9
    s_xor_b32 s9, s21, s12
    s_or_b32 s8, s8, s9
    s_xor_b32 s9, s23, s12
    s_or_b32 s8, s8, s9
    s_xor_b32 s9, s25, s12
    s_or_b32 s8, s8, s9
    s_xor_b32 s9, s27, s12
    s_or_b32 s8, s8, s9
    s_xor_b32 s9, s29, s12
    s_or_b32 s8, s8, s9
    s_xor_b32 s9, s31, s12
    s_or_b32 s8, s8, s9
    s_cbranch_scc0 RT_SCOK
    s_sleep 2
    s_cmp_lt_u32 s13, s7
    s_cbranch_scc1 RT_SC
    v_and_b32 v6, 7, v2
    s_lshl_b32 s9, s4, 8
    v_lshl_add_u32 v6, v6, 3, s9
    v_and_b32 v7, 7, v2
    s_lshl_b32 s9, s4, 10
    s_add_u32 s9, s9, 48896
    v_lshl_add_u32 v7, v7, 7, s9
    s_mov_b32 s12, 0
SP_C:
    s_add_u32 s12, s12, 1
    s_and_b32 s9, s12, 7
    s_cselect_b64 s[14:15], 0, -1
    v_cndmask_b32 v10, v6, v7, s[14:15]
    global_load_dwordx2 v[8:9], v10, s[50:51] offset:256 sc1
    s_waitcnt vmcnt(0)
SPC_C:
    v_cmp_ne_u32 vcc, v9, v14
    s_cmp_ge_u32 s12, 16384
    s_cbranch_scc1 SPX_C
    s_cbranch_vccz SPX_C
    s_mov_b64 exec, vcc
    s_sleep 2
    s_branch SP_C
SPX_C:
    s_mov_b64 exec, -1
    v_readlane_b32 s16, v8, 0
    v_readlane_b32 s18, v8, 1
    v_readlane_b32 s20, v8, 2
    v_readlane_b32 s22, v8, 3
    v_readlane_b32 s24, v8, 4
    v_readlane_b32 s26, v8, 5
    v_readlane_b32 s28, v8, 6
    v_readlane_b32 s30, v8, 7
RT_SCOK:
    s_mov_b32 m0, 147456
    s_andn2_b32 s76, 0x7ff, s16
    s_mul_i32 s76, s76, 1152
    s_andn2_b32 s77, 0x7ff, s18
    s_mul_i32 s77, s77, 1152
    s_andn2_b32 s78, 0x7ff, s20
    s_mul_i32 s78, s78, 1152
    s_andn2_b32 s79, 0x7ff, s22
    s_mul_i32 s79, s79, 1152
    s_andn2_b32 s80, 0x7ff, s24
    s_mul_i32 s80, s80, 1152
    s_andn2_b32 s81, 0x7ff, s26
    s_mul_i32 s81, s81, 1152
    s_andn2_b32 s82, 0x7ff, s28
    s_mul_i32 s82, s82, 1152
    s_andn2_b32 s83, 0x7ff, s30
    s_mul_i32 s83, s83, 1152
    buffer_load_dwordx4 v19, s[64:67], s76 offen lds
    buffer_load_dword v20, s[64:67], s76 offen offset:1024 lds
    s_add_u32 m0, m0, 1344
    s_nop 0
    buffer_load_dwordx4 v19, s[64:67], s77 offen lds
    buffer_load_dword v20, s[64:67], s77 offen offset:1024 lds
    s_add_u32 m0, m0, 1344
    s_nop 0
    buffer_load_dwordx4 v19, s[64:67], s78 offen lds
    buffer_load_dword v20, s[64:67], s78 offen offset:1024 lds
    s_add_u32 m0, m0, 1344
    s_nop 0
    buffer_load_dwordx4 v19, s[64:67], s79 offen lds
    buffer_load_dword v20, s[64:67], s79 offen offset:1024 lds
    s_add_u32 m0, m0, 1344
    s_nop 0
    buffer_load_dwordx4 v19, s[64:67], s80 offen lds
    buffer_load_dword v20, s[64:67], s80 offen offset:1024 lds
    s_add_u32 m0, m0, 1344
    s_nop 0
    buffer_load_dwordx4 v19, s[64:67], s81 offen lds
    buffer_load_dword v20, s[64:67], s81 offen offset:1024 lds
    s_add_u32 m0, m0, 1344
    s_nop 0
    buffer_load_dwordx4 v19, s[64:67], s82 offen lds
    buffer_load_dword v20, s[64:67], s82 offen offset:1024 lds
    s_add_u32 m0, m0, 1344
    s_nop 0
    buffer_load_dwordx4 v19, s[64:67], s83 offen lds
    buffer_load_dword v20, s[64:67], s83 offen offset:1024 lds
    s_add_u32 m0, m0, 1344
    s_nop 0
    s_waitcnt vmcnt(0)
    s_mov_b64 exec, 1
    ds_add_u32 v21, v22 offset:164
    s_mov_b64 exec, -1
    s_barrier
    s_endpgm
DN_LOAD:
    v_mov_b32 v55, 49152
    s_mov_b64 s[80:81], 0
    s_cmp_lg_u32 s3, 0
    s_cbranch_scc1 DN_NOT
    v_min_u32 v8, 8, v2
    v_mul_u32_u24 v8, 73728, v8
    v_add_u32 v8, 72576, v8
    buffer_load_dword v9, v8, s[60:63], s14 offen
DN_NOT:
    s_cmp_ge_u32 s2, 80
    s_cbranch_scc1 DN_SA
DN_SAL:
    s_lshr_b32 s8, s6, 3
    s_lshl_b32 s8, s8, s67
    s_and_b32 s9, s6, 7
    s_lshl_b32 s12, s8, 3
    s_add_u32 s12, s12, s9
    s_lshl_b32 m0, s12, 10
    s_mul_i32 s9, s9, 9216
    s_bitcmp1_b32 s6, 0
    s_cselect_b32 s12, 6912, 0
    s_sub_u32 s9, s9, s12
    s_bitcmp1_b32 s8, 0
    s_cselect_b32 s12, 36736, 0
    s_mul_i32 s8, s8, 36864
    s_sub_u32 s8, s8, s12
    s_add_u32 s8, s8, s9
    s_add_u32 s8, s8, s14
    buffer_load_dwordx4 v5, s[60:63], s8 offen  lds
    s_add_u32 s6, s6, s70
    s_cmp_lt_u32 s6, 8
    s_cbranch_scc1 DN_SAL
DN_SA:
    s_lshr_b32 s8, s6, 3
    s_lshl_b32 s8, s8, s67
    s_and_b32 s9, s6, 7
    s_lshl_b32 s12, s8, 3
    s_add_u32 s12, s12, s9
    s_lshl_b32 m0, s12, 10
    s_mul_i32 s9, s9, 9216
    s_bitcmp1_b32 s6, 0
    s_cselect_b32 s12, 6912, 0
    s_sub_u32 s9, s9, s12
    s_bitcmp1_b32 s8, 0
    s_cselect_b32 s12, 36736, 0
    s_mul_i32 s8, s8, 36864
    s_sub_u32 s8, s8, s12
    s_add_u32 s8, s8, s9
    s_add_u32 s8, s8, s14
    buffer_load_dwordx4 v5, s[60:63], s8 offen  lds
    s_add_u32 s6, s6, s70
    s_waitcnt vmcnt(0)
    s_mov_b32 s13, 0
DN_L1:
    s_lshr_b32 s8, s6, 3
    s_lshl_b32 s8, s8, s67
    s_and_b32 s9, s6, 7
    s_lshl_b32 s12, s8, 3
    s_add_u32 s12, s12, s9
    s_lshl_b32 m0, s12, 10
    s_mul_i32 s9, s9, 9216
    s_bitcmp1_b32 s6, 0
    s_cselect_b32 s12, 6912, 0
    s_sub_u32 s9, s9, s12
    s_bitcmp1_b32 s8, 0
    s_cselect_b32 s12, 36736, 0
    s_mul_i32 s8, s8, 36864
    s_sub_u32 s8, s8, s12
    s_add_u32 s8, s8, s9
    s_add_u32 s8, s8, s14
    buffer_load_dwordx4 v5, s[60:63], s8 offen  lds
    s_add_u32 s6, s6, s70
    s_add_u32 s13, s13, 1
    s_cmp_lt_u32 s13, s69
    s_cbranch_scc1 DN_L1
    s_cmp_lt_u32 s2, 80
    s_cbranch_scc1 SEL_MAIN
    s_barrier
DN_L2:
    s_cmp_ge_u32 s6, s71
    s_cbranch_scc1 DN_LX
    s_waitcnt vmcnt(5)
    s_lshr_b32 s8, s6, 3
    s_lshl_b32 s8, s8, s67
    s_and_b32 s9, s6, 7
    s_lshl_b32 s12, s8, 3
    s_add_u32 s12, s12, s9
    s_lshl_b32 m0, s12, 10
    s_mul_i32 s9, s9, 9216
    s_bitcmp1_b32 s6, 0
    s_cselect_b32 s12, 6912, 0
    s_sub_u32 s9, s9, s12
    s_bitcmp1_b32 s8, 0
    s_cselect_b32 s12, 36736, 0
    s_mul_i32 s8, s8, 36864
    s_sub_u32 s8, s8, s12
    s_add_u32 s8, s8, s9
    s_add_u32 s8, s8, s14
    buffer_load_dwordx4 v5, s[60:63], s8 offen  lds
    s_add_u32 s6, s6, s70
    s_branch DN_L2
DN_LX:
DN_JOIN:
    v_mov_b32 v21, 163456
    ds_read_b32 v14, v21 offset:4
    v_and_b32 v18, 1, v4
    v_bfe_u32 v6, v2, 2, 2
    v_lshl_add_u32 v18, v18, 2, v6
    v_lshrrev_b32 v19, 1, v18
    v_lshlrev_b32 v18, 7, v18
    v_and_b32 v7, 3, v2
    v_lshl_add_u32 v18, v7, 3, v18
    v_lshrrev_b32 v6, 1, v4
    v_lshl_add_u32 v18, v6, 11, v18
    s_and_b32 s9, s3, 3
    v_xor_b32 v19, s9, v19
    v_lshl_add_u32 v18, v19, 5, v18
    s_lshr_b32 s8, s3, 2
    s_lshl_b32 s8, s8, 13
    v_add_u32 v8, s8, v18
    v_add_u32 v9, 49152, v8
    v_add_u32 v10, 98304, v8
    v_lshrrev_b32 v11, 1, v3
    v_mul_u32_u24 v11, 1344, v11
    v_lshl_add_u32 v11, v4, 5, v11
    v_and_b32 v22, 1, v2
    v_lshl_add_u32 v11, v22, 4, v11
    v_add_u32 v11, 147456, v11
    v_mul_u32_u24 v22, 0xaaaa, v22
    v_add_u32 v22, 0x4444, v22
    v_mov_b32 v132, 0
    v_mov_b32 v133, 0
    v_mov_b32 v134, 0
    v_mov_b32 v135, 0
    v_lshrrev_b32 v12, 2, v3
    v_mul_u32_u24 v17, 2688, v12
    v_mul_u32_u24 v12, 1152, v12
    v_lshl_add_u32 v12, v7, 4, v12
    v_lshl_add_u32 v12, v6, 6, v12
    s_lshl_b32 s8, s5, 3
    s_sub_u32 s8, s8, 80
    s_cmp_lt_u32 s2, 80
    s_cselect_b32 s8, 32, s8
    s_cselect_b32 s13, 4, 8
    s_cselect_b32 s15, 8, 6
    s_add_u32 s8, s8, s3
    s_mul_i32 s8, s8, 4608
    s_lshl_b32 s9, s4, 7
    s_add_u32 s8, s8, s9
    s_add_u32 s8, s8, 352256
    v_add_u32 v12, s8, v12
    s_sub_u32 s9, s3, 3
    s_mul_i32 s8, s4, 9
    s_add_u32 s8, s8, s9
    s_lshl_b32 s8, s8, 12
    s_add_u32 s8, s8, 57344
    v_lshl_add_u32 v16, v2, 5, s8
    v_lshl_add_u32 v17, v4, 5, v17
    v_lshl_add_u32 v17, v7, 3, v17
    s_lshl_b32 s9, s9, 7
    s_add_u32 s9, s9, 147456
    v_add_u32 v17, s9, v17
    s_mov_b32 s10, 0xffff
    s_mov_b32 s11, 0xffff
    s_movk_i32 s78, 0xff
    s_mov_b32 s76, 0x07060302
    s_cmp_ge_u32 s3, s15
    s_cbranch_scc1 DN_NL
    v_mov_b32 v23, 1
    s_cmp_lt_u32 s2, 80
    s_cbranch_scc1 DN_LS
    s_waitcnt vmcnt(5)
    s_branch DN_LP
DN_LS:
    s_waitcnt vmcnt(2)
DN_LP:
    s_mov_b64 exec, 1
    ds_add_u32 v21, v23 offset:160
    s_mov_b64 exec, -1
DN_NL:
    s_cmp_ge_u32 s3, s13
    s_cbranch_scc1 DN_NOF
    s_mov_b32 s9, 0
SPN2:
    ds_read_b32 v23, v21 offset:160
    s_add_u32 s9, s9, 1
    s_waitcnt lgkmcnt(0)
    v_cmp_ne_u32 vcc, s15, v23
    s_cmp_ge_u32 s9, 0x40000
    s_cbranch_scc1 SPX2
    s_cbranch_vccz SPX2
    s_sleep 2
    s_branch SPN2
SPX2:
    ds_read_b64_tr_b16 v[24:25], v8 offset:0
    ds_read_b64_tr_b16 v[26:27], v8 offset:1024
    ds_read_b64_tr_b16 v[28:29], v8 offset:4096
    ds_read_b64_tr_b16 v[30:31], v8 offset:5120
    ds_read_b64_tr_b16 v[32:33], v8 offset:16384
    ds_read_b64_tr_b16 v[34:35], v8 offset:17408
    ds_read_b64_tr_b16 v[36:37], v8 offset:20480
    ds_read_b64_tr_b16 v[38:39], v8 offset:21504
    ds_read_b64_tr_b16 v[40:41], v8 offset:32768
    ds_read_b64_tr_b16 v[42:43], v8 offset:33792
    ds_read_b64_tr_b16 v[44:45], v8 offset:36864
    ds_read_b64_tr_b16 v[46:47], v8 offset:37888
    ds_read_b64_tr_b16 v[48:49], v9 offset:0
    ds_read_b64_tr_b16 v[50:51], v9 offset:1024
    ds_read_b64_tr_b16 v[52:53], v9 offset:4096
    ds_read_b64_tr_b16 v[54:55], v9 offset:5120
    ds_read_b64_tr_b16 v[56:57], v9 offset:16384
    ds_read_b64_tr_b16 v[58:59], v9 offset:17408
    ds_read_b64_tr_b16 v[60:61], v9 offset:20480
    ds_read_b64_tr_b16 v[62:63], v9 offset:21504
    ds_read_b64_tr_b16 v[64:65], v9 offset:32768
    ds_read_b64_tr_b16 v[66:67], v9 offset:33792
    ds_read_b64_tr_b16 v[68:69], v9 offset:36864
    ds_read_b64_tr_b16 v[70:71], v9 offset:37888
    ds_read_b64_tr_b16 v[72:73], v10 offset:0
    ds_read_b64_tr_b16 v[74:75], v10 offset:1024
    ds_read_b64_tr_b16 v[76:77], v10 offset:4096
    ds_read_b64_tr_b16 v[78:79], v10 offset:5120
DN_NOF:
    s_waitcnt vmcnt(0) lgkmcnt(0)
    s_barrier
    s_cmp_ge_u32 s3, s13
    s_cbranch_scc1 DN_NOF2
    ds_read_b64_tr_b16 v[80:81], v10 offset:16384
    ds_read_b64_tr_b16 v[82:83], v10 offset:17408
    ds_read_b64_tr_b16 v[84:85], v10 offset:20480
    ds_read_b64_tr_b16 v[86:87], v10 offset:21504
    ds_read_b64_tr_b16 v[88:89], v10 offset:32768
    ds_read_b64_tr_b16 v[90:91], v10 offset:33792
    ds_read_b64_tr_b16 v[92:93], v10 offset:36864
    ds_read_b64_tr_b16 v[94:95], v10 offset:37888
DN_NOF2:
    s_cmp_lt_u32 s3, 3
    s_cbranch_scc1 DN_W
    s_mov_b32 s12, 0
DN_POLL:
    s_add_u32 s12, s12, 1
    s_and_b32 s8, s12, 63
    s_cselect_b32 s8, 0, 2048
    v_add_u32 v20, s8, v16
    global_load_dwordx4 v[96:99], v20, s[50:51] sc1
    global_load_dwordx4 v[100:103], v20, s[50:51] offset:16 sc1
    s_waitcnt vmcnt(0)
    v_xor_b32 v20, v96, v14
    v_bitop3_b32 v20, v20, v97, v14 bitop3:0xf6
    v_bitop3_b32 v20, v20, v98, v14 bitop3:0xf6
    v_bitop3_b32 v20, v20, v99, v14 bitop3:0xf6
    v_bitop3_b32 v20, v20, v100, v14 bitop3:0xf6
    v_bitop3_b32 v20, v20, v101, v14 bitop3:0xf6
    v_bitop3_b32 v20, v20, v102, v14 bitop3:0xf6
    v_bitop3_b32 v20, v20, v103, v14 bitop3:0xf6
    v_and_b32 v20, 0xffff, v20
    v_cmp_ne_u32 vcc, 0, v20
    s_cmp_ge_u32 s12, 65536
    s_cbranch_scc1 DN_GOT
    s_cbranch_vccnz DN_POLL
DN_GOT:
    v_perm_b32 v104, v98, v96, s76
    v_perm_b32 v105, v102, v100, s76
    v_perm_b32 v106, v99, v97, s76
    v_perm_b32 v107, v103, v101, s76
    ds_write_b64 v17, v[104:105]
    ds_write_b64 v17, v[106:107] offset:1344
DN_W:
    s_waitcnt lgkmcnt(0)
    s_barrier
    s_cmp_ge_u32 s3, s13
    s_cbranch_scc1 W_END
    ds_read_b128 v[96:99], v11 offset:0
    ds_read_b128 v[100:103], v11 offset:128
    ds_read_b128 v[104:107], v11 offset:256
    ds_read_b128 v[108:111], v11 offset:384
    ds_read_b128 v[112:115], v11 offset:512
    ds_read_b128 v[116:119], v11 offset:640
    ds_read_b128 v[120:123], v11 offset:768
    ds_read_b128 v[124:127], v11 offset:896
    ds_read_b128 v[128:131], v11 offset:1024
    s_waitcnt lgkmcnt(8)
    v_smfmac_f32_16x16x64_bf16 v[132:135], v[96:99], v[24:31], v22
    s_waitcnt lgkmcnt(7)
    v_smfmac_f32_16x16x64_bf16 v[132:135], v[100:103], v[32:39], v22
    s_waitcnt lgkmcnt(6)
    v_smfmac_f32_16x16x64_bf16 v[132:135], v[104:107], v[40:47], v22
    s_waitcnt lgkmcnt(5)
    v_smfmac_f32_16x16x64_bf16 v[132:135], v[108:111], v[48:55], v22
    s_waitcnt lgkmcnt(4)
    v_smfmac_f32_16x16x64_bf16 v[132:135], v[112:115], v[56:63], v22
    s_waitcnt lgkmcnt(3)
    v_smfmac_f32_16x16x64_bf16 v[132:135], v[116:119], v[64:71], v22
    s_waitcnt lgkmcnt(2)
    v_smfmac_f32_16x16x64_bf16 v[132:135], v[120:123], v[72:79], v22
    s_waitcnt lgkmcnt(1)
    v_smfmac_f32_16x16x64_bf16 v[132:135], v[124:127], v[80:87], v22
    s_waitcnt lgkmcnt(0)
    v_smfmac_f32_16x16x64_bf16 v[132:135], v[128:131], v[88:95], v22
    s_nop 7
    v_add_f32 v136, v132, v133
    v_add_f32 v137, v134, v135
    v_bfi_b32 v138, s78, v14, v136
    v_bfi_b32 v139, s78, v14, v137
    v_bfi_b32 v136, s78, v14, v136
    v_bfi_b32 v137, s78, v14, v137
    s_nop 0
    v_permlane16_swap_b32 v136, v138
    v_permlane16_swap_b32 v137, v139
    s_mov_b64 exec, s[10:11]
    global_store_dwordx4 v12, v[136:139], s[50:51] sc1
    s_cmp_lg_u32 s3, 3
    s_cbranch_scc1 DN_NOHINT
    s_lshl_b32 s8, s4, 7
    s_lshl_b32 s9, s5, 2
    s_add_u32 s8, s8, s9
    v_mov_b32 v20, s8
    global_store_dword v20, v14, s[50:51] offset:2268
    s_cmp_lg_u32 s2, 72
    s_cbranch_scc1 DN_NOHINT
    v_mov_b32 v20, 0
    global_store_dword v20, v14, s[50:51] sc1
DN_NOHINT:
    s_endpgm
F_MAIN:
    v_and_b32 v7, 7, v2
    s_add_u32 m0, s15, 0
    s_add_u32 s8, s14, 0
    buffer_load_dwordx4 v5, s[52:55], s8 offen  lds
    s_add_u32 m0, s15, 73728
    s_add_u32 s8, s14, 0
    buffer_load_dwordx4 v5, s[56:59], s8 offen  lds
    s_and_b32 s12, s3, 3
    v_and_b32 v18, 1, v4
    v_bfe_u32 v6, v2, 2, 2
    v_lshl_add_u32 v18, v18, 2, v6
    v_lshrrev_b32 v6, 1, v18
    v_xor_b32 v6, s12, v6
    v_lshlrev_b32 v18, 7, v18
    v_lshl_add_u32 v18, v6, 5, v18
    v_and_b32 v6, 3, v2
    v_lshl_add_u32 v18, v6, 3, v18
    v_lshrrev_b32 v6, 1, v4
    v_lshl_add_u32 v18, v6, 11, v18
    v_add_u32 v6, 73728, v18
    v_add_u32 v0, 40960, v18
    v_add_u32 v1, 40960, v6
    v_lshrrev_b32 v8, 1, v3
    v_mul_u32_u24 v8, 1344, v8
    v_lshl_add_u32 v8, v4, 5, v8
    v_and_b32 v9, 1, v2
    v_lshl_add_u32 v8, v9, 4, v8
    v_add_u32 v8, 147456, v8
    v_mul_u32_u24 v9, 0xaaaa, v9
    v_add_u32 v9, 0x4444, v9
    s_lshl_b32 s8, s6, 12
    s_lshl_b32 s9, s3, 9
    s_add_u32 s8, s8, s9
    s_add_u32 s8, s8, 57344
    v_lshl_add_u32 v11, v2, 3, s8
    s_mov_b32 s76, 0xffff
    v_mov_b32 v21, 163456
    v_mov_b32 v22, 1
    s_mov_b32 s10, 0xff00ff00
    s_mov_b32 s11, 0xff00ff00
    s_waitcnt vmcnt(0)
    s_add_u32 m0, s15, 8192
    s_add_u32 s8, s14, 589824
    buffer_load_dwordx4 v5, s[52:55], s8 offen  lds
    s_add_u32 m0, s15, 81920
    s_add_u32 s8, s14, 589824
    buffer_load_dwordx4 v5, s[56:59], s8 offen  lds
    s_add_u32 m0, s15, 16384
    s_add_u32 s8, s14, 1179648
    buffer_load_dwordx4 v5, s[52:55], s8 offen  lds
    v_mov_b32 v160, 0
    v_mov_b32 v161, 0
    v_mov_b32 v162, 0
    v_mov_b32 v163, 0
    v_mov_b32 v164, 0
    v_mov_b32 v165, 0
    v_mov_b32 v166, 0
    v_mov_b32 v167, 0
    s_barrier
    ds_read_b32 v14, v21 offset:4
    s_add_u32 m0, s15, 90112
    s_add_u32 s8, s14, 1179648
    buffer_load_dwordx4 v5, s[56:59], s8 offen  lds
    s_waitcnt vmcnt(3)
    s_add_u32 m0, s15, 24576
    s_add_u32 s8, s14, 1769472
    buffer_load_dwordx4 v5, s[52:55], s8 offen  lds
    s_waitcnt vmcnt(3)
    s_add_u32 m0, s15, 98304
    s_add_u32 s8, s14, 1769472
    buffer_load_dwordx4 v5, s[56:59], s8 offen  lds
    s_waitcnt vmcnt(3)
    s_add_u32 m0, s15, 32768
    s_add_u32 s8, s14, 2359296
    buffer_load_dwordx4 v5, s[52:55], s8 offen  lds
    s_waitcnt vmcnt(3)
    s_add_u32 m0, s15, 106496
    s_add_u32 s8, s14, 2359296
    buffer_load_dwordx4 v5, s[56:59], s8 offen  lds
    s_waitcnt vmcnt(3)
    s_add_u32 m0, s15, 40960
    s_add_u32 s8, s14, 2949120
    buffer_load_dwordx4 v5, s[52:55], s8 offen  lds
    s_waitcnt vmcnt(3)
    s_add_u32 m0, s15, 114688
    s_add_u32 s8, s14, 2949120
    buffer_load_dwordx4 v5, s[56:59], s8 offen  lds
    s_waitcnt vmcnt(3)
    s_add_u32 m0, s15, 49152
    s_add_u32 s8, s14, 3538944
    buffer_load_dwordx4 v5, s[52:55], s8 offen  lds
    s_waitcnt vmcnt(3)
    s_add_u32 m0, s15, 122880
    s_add_u32 s8, s14, 3538944
    buffer_load_dwordx4 v5, s[56:59], s8 offen  lds
    s_waitcnt vmcnt(3)
    s_add_u32 m0, s15, 57344
    s_add_u32 s8, s14, 4128768
    buffer_load_dwordx4 v5, s[52:55], s8 offen  lds
    s_waitcnt vmcnt(3)
    s_add_u32 m0, s15, 131072
    s_add_u32 s8, s14, 4128768
    buffer_load_dwordx4 v5, s[56:59], s8 offen  lds
    s_waitcnt vmcnt(3)
    s_add_u32 m0, s15, 65536
    s_add_u32 s8, s14, 4718592
    buffer_load_dwordx4 v5, s[52:55], s8 offen  lds
    s_waitcnt vmcnt(3)
    s_add_u32 m0, s15, 139264
    s_add_u32 s8, s14, 4718592
    buffer_load_dwordx4 v5, s[56:59], s8 offen  lds
    s_waitcnt vmcnt(4)
    s_mov_b64 exec, 1
    ds_add_u32 v21, v22 offset:160
    s_mov_b64 exec, -1
    s_cmp_ge_u32 s3, 4
    s_cbranch_scc1 F_LD
    s_mov_b32 s9, 0
SPN3:
    ds_read_b32 v23, v21 offset:160
    s_add_u32 s9, s9, 1
    s_waitcnt lgkmcnt(0)
    v_cmp_ne_u32 vcc, 8, v23
    s_cmp_ge_u32 s9, 0x40000
    s_cbranch_scc1 SPX3
    s_cbranch_vccnz SPN3
SPX3:
    ds_read_b64_tr_b16 v[24:25], v18 offset:0
    ds_read_b64_tr_b16 v[26:27], v18 offset:1024
    ds_read_b64_tr_b16 v[28:29], v18 offset:4096
    ds_read_b64_tr_b16 v[30:31], v18 offset:5120
    ds_read_b64_tr_b16 v[32:33], v6 offset:0
    ds_read_b64_tr_b16 v[34:35], v6 offset:1024
    ds_read_b64_tr_b16 v[36:37], v6 offset:4096
    ds_read_b64_tr_b16 v[38:39], v6 offset:5120
    ds_read_b64_tr_b16 v[40:41], v18 offset:8192
    ds_read_b64_tr_b16 v[42:43], v18 offset:9216
    ds_read_b64_tr_b16 v[44:45], v18 offset:12288
    ds_read_b64_tr_b16 v[46:47], v18 offset:13312
    ds_read_b64_tr_b16 v[48:49], v6 offset:8192
    ds_read_b64_tr_b16 v[50:51], v6 offset:9216
    ds_read_b64_tr_b16 v[52:53], v6 offset:12288
    ds_read_b64_tr_b16 v[54:55], v6 offset:13312
    ds_read_b64_tr_b16 v[56:57], v18 offset:16384
    ds_read_b64_tr_b16 v[58:59], v18 offset:17408
    ds_read_b64_tr_b16 v[60:61], v18 offset:20480
    ds_read_b64_tr_b16 v[62:63], v18 offset:21504
    ds_read_b64_tr_b16 v[64:65], v6 offset:16384
    ds_read_b64_tr_b16 v[66:67], v6 offset:17408
    ds_read_b64_tr_b16 v[68:69], v6 offset:20480
    ds_read_b64_tr_b16 v[70:71], v6 offset:21504
    ds_read_b64_tr_b16 v[72:73], v18 offset:24576
    ds_read_b64_tr_b16 v[74:75], v18 offset:25600
    ds_read_b64_tr_b16 v[76:77], v18 offset:28672
    ds_read_b64_tr_b16 v[78:79], v18 offset:29696
    ds_read_b64_tr_b16 v[80:81], v6 offset:24576
    ds_read_b64_tr_b16 v[82:83], v6 offset:25600
    ds_read_b64_tr_b16 v[84:85], v6 offset:28672
    ds_read_b64_tr_b16 v[86:87], v6 offset:29696
    ds_read_b64_tr_b16 v[88:89], v18 offset:32768
    ds_read_b64_tr_b16 v[90:91], v18 offset:33792
    ds_read_b64_tr_b16 v[92:93], v18 offset:36864
    ds_read_b64_tr_b16 v[94:95], v18 offset:37888
    ds_read_b64_tr_b16 v[96:97], v6 offset:32768
    ds_read_b64_tr_b16 v[98:99], v6 offset:33792
    ds_read_b64_tr_b16 v[100:101], v6 offset:36864
    ds_read_b64_tr_b16 v[102:103], v6 offset:37888
    ds_read_b64_tr_b16 v[104:105], v0 offset:0
    ds_read_b64_tr_b16 v[106:107], v0 offset:1024
    ds_read_b64_tr_b16 v[108:109], v0 offset:4096
    ds_read_b64_tr_b16 v[110:111], v0 offset:5120
    ds_read_b64_tr_b16 v[112:113], v1 offset:0
    ds_read_b64_tr_b16 v[114:115], v1 offset:1024
    ds_read_b64_tr_b16 v[116:117], v1 offset:4096
    ds_read_b64_tr_b16 v[118:119], v1 offset:5120
    ds_read_b64_tr_b16 v[120:121], v0 offset:8192
    ds_read_b64_tr_b16 v[122:123], v0 offset:9216
    ds_read_b64_tr_b16 v[124:125], v0 offset:12288
    ds_read_b64_tr_b16 v[126:127], v0 offset:13312
    ds_read_b64_tr_b16 v[128:129], v1 offset:8192
    ds_read_b64_tr_b16 v[130:131], v1 offset:9216
    ds_read_b64_tr_b16 v[132:133], v1 offset:12288
    ds_read_b64_tr_b16 v[134:135], v1 offset:13312
    s_mov_b32 s9, 0
SPN4:
    ds_read_b32 v23, v21 offset:164
    s_add_u32 s9, s9, 1
    s_waitcnt lgkmcnt(0)
    v_cmp_eq_u32 vcc, 0, v23
    s_cmp_ge_u32 s9, 0x40000
    s_cbranch_scc1 SPX4
    s_cbranch_vccnz SPN4
SPX4:
    ds_read_b128 v[136:139], v8 offset:0
    ds_read_b128 v[140:143], v8 offset:128
    ds_read_b128 v[144:147], v8 offset:256
    ds_read_b128 v[148:151], v8 offset:384
    ds_read_b128 v[152:155], v8 offset:512
    ds_read_b128 v[156:159], v8 offset:640
    s_waitcnt lgkmcnt(5)
    v_smfmac_f32_16x16x64_bf16 v[160:163], v[136:139], v[24:31], v9
    v_smfmac_f32_16x16x64_bf16 v[164:167], v[136:139], v[32:39], v9
    s_waitcnt lgkmcnt(4)
    v_smfmac_f32_16x16x64_bf16 v[160:163], v[140:143], v[40:47], v9
    v_smfmac_f32_16x16x64_bf16 v[164:167], v[140:143], v[48:55], v9
    ds_read_b128 v[136:139], v8 offset:768
    s_waitcnt lgkmcnt(4)
    v_smfmac_f32_16x16x64_bf16 v[160:163], v[144:147], v[56:63], v9
    v_smfmac_f32_16x16x64_bf16 v[164:167], v[144:147], v[64:71], v9
    ds_read_b128 v[140:143], v8 offset:896
    s_waitcnt lgkmcnt(4)
    v_smfmac_f32_16x16x64_bf16 v[160:163], v[148:151], v[72:79], v9
    v_smfmac_f32_16x16x64_bf16 v[164:167], v[148:151], v[80:87], v9
    ds_read_b128 v[144:147], v8 offset:1024
    s_waitcnt lgkmcnt(4)
    v_smfmac_f32_16x16x64_bf16 v[160:163], v[152:155], v[88:95], v9
    v_smfmac_f32_16x16x64_bf16 v[164:167], v[152:155], v[96:103], v9
    s_waitcnt lgkmcnt(3)
    v_smfmac_f32_16x16x64_bf16 v[160:163], v[156:159], v[104:111], v9
    v_smfmac_f32_16x16x64_bf16 v[164:167], v[156:159], v[112:119], v9
    s_waitcnt lgkmcnt(2)
    v_smfmac_f32_16x16x64_bf16 v[160:163], v[136:139], v[120:127], v9
    v_smfmac_f32_16x16x64_bf16 v[164:167], v[136:139], v[128:135], v9
F_LD:
    s_waitcnt vmcnt(0)
    s_barrier
    s_cmp_ge_u32 s3, 4
    s_cbranch_scc1 W_END
    ds_read_b64_tr_b16 v[24:25], v0 offset:16384
    ds_read_b64_tr_b16 v[26:27], v0 offset:17408
    ds_read_b64_tr_b16 v[28:29], v0 offset:20480
    ds_read_b64_tr_b16 v[30:31], v0 offset:21504
    ds_read_b64_tr_b16 v[32:33], v1 offset:16384
    ds_read_b64_tr_b16 v[34:35], v1 offset:17408
    ds_read_b64_tr_b16 v[36:37], v1 offset:20480
    ds_read_b64_tr_b16 v[38:39], v1 offset:21504
    ds_read_b64_tr_b16 v[40:41], v0 offset:24576
    ds_read_b64_tr_b16 v[42:43], v0 offset:25600
    ds_read_b64_tr_b16 v[44:45], v0 offset:28672
    ds_read_b64_tr_b16 v[46:47], v0 offset:29696
    ds_read_b64_tr_b16 v[48:49], v1 offset:24576
    ds_read_b64_tr_b16 v[50:51], v1 offset:25600
    ds_read_b64_tr_b16 v[52:53], v1 offset:28672
    ds_read_b64_tr_b16 v[54:55], v1 offset:29696
    s_waitcnt lgkmcnt(12)
    v_smfmac_f32_16x16x64_bf16 v[160:163], v[140:143], v[24:31], v9
    s_waitcnt lgkmcnt(8)
    v_smfmac_f32_16x16x64_bf16 v[164:167], v[140:143], v[32:39], v9
    s_waitcnt lgkmcnt(4)
    v_smfmac_f32_16x16x64_bf16 v[160:163], v[144:147], v[40:47], v9
    s_waitcnt lgkmcnt(0)
    v_smfmac_f32_16x16x64_bf16 v[164:167], v[144:147], v[48:55], v9
    s_nop 6
    v_add_f32 v24, v160, v161
    v_add_f32 v25, v162, v163
    v_add_f32 v26, v164, v165
    v_add_f32 v27, v166, v167
    v_cvt_pk_bf16_f32 v24, 0, v24
    v_cvt_pk_bf16_f32 v25, 0, v25
    v_cvt_pk_bf16_f32 v26, 0, v26
    v_cvt_pk_bf16_f32 v27, 0, v27
    v_mul_f32 v28, 0xbfb8aa3b, v24
    v_mul_f32 v29, 0xbfb8aa3b, v25
    v_exp_f32 v28, v28
    v_exp_f32 v29, v29
    v_add_f32 v28, 1.0, v28
    v_add_f32 v29, 1.0, v29
    v_rcp_f32 v28, v28
    v_rcp_f32 v29, v29
    v_mul_f32 v24, v24, v28
    v_mul_f32 v25, v25, v29
    v_cvt_pk_bf16_f32 v24, 0, v24
    v_cvt_pk_bf16_f32 v25, 0, v25
    v_mul_f32 v24, v24, v26
    v_mul_f32 v25, v25, v27
    v_cvt_pk_bf16_f32 v24, 0, v24
    v_cvt_pk_bf16_f32 v25, 0, v25
    v_bfi_b32 v24, s76, v14, v24
    v_bfi_b32 v25, s76, v14, v25
    global_store_dwordx2 v11, v[24:25], s[50:51]
    global_store_dwordx2 v11, v[24:25], s[50:51] offset:2048 sc1
    s_endpgm
SEL_MAIN:
    v_min_u32 v19, 8, v2
    v_lshlrev_b32 v19, 7, v19
    v_lshlrev_b32 v20, 2, v2
    v_lshrrev_b32 v24, 2, v2
    v_mul_u32_u24 v24, 256, v24
    v_and_b32 v37, 3, v2
    v_lshl_add_u32 v24, v37, 4, v24
    v_lshrrev_b32 v36, 1, v2
    v_mul_u32_u24 v36, 256, v36
    v_and_b32 v37, 1, v2
    v_lshl_add_u32 v36, v37, 4, v36
    v_add_u32 v36, 20544, v36
    s_mul_i32 s8, s3, 4096
    v_add_u32 v24, s8, v24
    s_cmp_eq_u32 s3, 7
    s_cselect_b64 vcc, -1, 0
    v_cndmask_b32 v24, v24, v36, vcc
    v_add_u32 v24, 4096, v24
    s_lshl_b32 s8, s3, 8
    s_sub_u32 s8, 0xfff, s8
    v_sub_u32 v32, s8, v20
    v_subrev_u32 v33, 1, v32
    v_subrev_u32 v34, 2, v32
    v_subrev_u32 v35, 3, v32
    v_mov_b32 v21, 163456
    s_lshl_b32 s8, s3, 5
    s_add_u32 s8, s8, 163200
    v_lshl_add_u32 v25, v4, 3, s8
    s_mov_b32 s74, 0x01010101
    s_mov_b32 s75, 0x01010101
    s_lshl_b32 s9, s4, 10
    s_add_u32 s9, s9, 40960
    v_lshl_add_u32 v53, v2, 4, s9
    global_load_dword v54, v53, s[50:51] sc1
    v_lshrrev_b32 v52, 3, v2
    v_lshl_add_u32 v52, v52, 6, s9
    v_and_b32 v27, 28, v20
    v_add_u32 v27, s8, v27
    v_add_u32 v26, 163200, v20
    s_mov_b32 s76, 0xffff
    s_mov_b32 s10, 0x00010001
    s_mov_b32 s11, 0x00010001
    s_barrier
    ds_read_b32 v14, v21 offset:4
    s_mov_b32 s7, 0
    s_waitcnt lgkmcnt(0)
    s_waitcnt vmcnt(0)
F_POLL:
    global_load_dwordx4 v[28:31], v24, s[50:51] sc1
    s_add_u32 s7, s7, 1
    s_waitcnt vmcnt(0)
    v_xor_b32 v36, v28, v14
    v_bitop3_b32 v36, v36, v29, v14 bitop3:0xf6
    v_bitop3_b32 v36, v36, v30, v14 bitop3:0xf6
    v_bitop3_b32 v36, v36, v31, v14 bitop3:0xf6
    v_and_b32 v36, 0xffff, v36
    v_cmp_ne_u32 vcc, 0, v36
    s_cmp_ge_u32 s7, 16384
    s_cbranch_scc1 F_GOT
    s_cbranch_vccz F_GOT
    s_mov_b64 exec, vcc
    s_sleep 4
    s_branch F_POLL
F_GOT:
    s_mov_b64 exec, -1
    global_load_dword v56, v24, s[50:51] offset:128 sc1
    v_bfi_b32 v28, s76, v32, v28
    v_bfi_b32 v29, s76, v33, v29
    v_bfi_b32 v30, s76, v34, v30
    v_bfi_b32 v31, s76, v35, v31
    v_max_u32 v36, v28, v29
    v_min_u32 v37, v28, v29
    v_max3_u32 v40, v36, v30, v31
    v_med3_u32 v41, v36, v30, v31
    v_med3_u32 v42, v37, v30, v31
    v_max_u32 v41, v41, v37
    v_min_u32 v42, v42, v36
    v_max_u32_dpp v44, v40, v40 row_ror:8 row_mask:0xf bank_mask:0xf
    s_nop 1
    v_max_u32_dpp v44, v44, v44 row_ror:4 row_mask:0xf bank_mask:0xf
    s_nop 1
    v_max_u32_dpp v44, v44, v44 row_ror:2 row_mask:0xf bank_mask:0xf
    s_nop 1
    v_max_u32_dpp v44, v44, v44 row_ror:1 row_mask:0xf bank_mask:0xf
    v_cmp_eq_u32 vcc, v40, v44
    s_nop 1
    v_cndmask_b32 v40, v40, v41, vcc
    v_cndmask_b32 v41, v41, v42, vcc
    s_nop 0
    v_max_u32_dpp v45, v40, v40 row_ror:8 row_mask:0xf bank_mask:0xf
    s_nop 1
    v_max_u32_dpp v45, v45, v45 row_ror:4 row_mask:0xf bank_mask:0xf
    s_nop 1
    v_max_u32_dpp v45, v45, v45 row_ror:2 row_mask:0xf bank_mask:0xf
    s_nop 1
    v_max_u32_dpp v45, v45, v45 row_ror:1 row_mask:0xf bank_mask:0xf
    v_cmp_eq_u32 vcc, v40, v45
    s_nop 1
    v_cndmask_b32 v40, v40, v41, vcc
    s_nop 1
    v_max_u32_dpp v46, v40, v40 row_ror:8 row_mask:0xf bank_mask:0xf
    s_nop 1
    v_max_u32_dpp v46, v46, v46 row_ror:4 row_mask:0xf bank_mask:0xf
    s_nop 1
    v_max_u32_dpp v46, v46, v46 row_ror:2 row_mask:0xf bank_mask:0xf
    s_nop 1
    v_max_u32_dpp v46, v46, v46 row_ror:1 row_mask:0xf bank_mask:0xf
    s_mov_b64 exec, s[10:11]
    ds_write_b64 v25, v[44:45]
    ds_max_u32 v21, v46
    s_mov_b64 exec, -1
    v_readlane_b32 s77, v44, 0
    v_readlane_b32 s78, v45, 0
    v_readlane_b32 s79, v44, 16
    v_readlane_b32 s80, v45, 16
    v_readlane_b32 s81, v44, 32
    v_readlane_b32 s82, v45, 32
    v_readlane_b32 s83, v44, 48
    v_readlane_b32 s100, v45, 48
    ds_read_b32 v48, v27
    v_mov_b32 v49, v14
    s_lshl_b32 s72, s4, 8
    s_lshl_b32 s73, s4, 10
    s_add_u32 s73, s73, 49152
    s_waitcnt lgkmcnt(0)
    s_barrier
    ds_read_b32 v36, v26
    ds_read_b32 v37, v21
    v_not_b32 v50, v48
    v_and_b32 v50, 0x7ff, v50
    v_mul_u32_u24 v50, 1152, v50
    s_waitcnt lgkmcnt(0)
    v_cmp_gt_u32 vcc, v36, v37
    v_cmp_lt_u32 s[18:19], s77, v36
    v_cmp_lt_u32 s[20:21], s78, v36
    v_cmp_lt_u32 s[22:23], s79, v36
    v_cmp_lt_u32 s[24:25], s80, v36
    v_cmp_lt_u32 s[26:27], s81, v36
    v_cmp_lt_u32 s[28:29], s82, v36
    v_cmp_lt_u32 s[30:31], s83, v36
    v_cmp_lt_u32 s[34:35], s100, v36
    s_bcnt1_i32_b64 s8, vcc
    s_mov_b64 s[80:81], 0
    s_cmp_lt_u32 s8, 8
    s_cbranch_scc1 F_SLOW
    s_bcnt1_i32_b64 s18, s[18:19]
    s_lshl_b64 exec, s[74:75], 0
    v_mov_b32 v37, s18
    s_bcnt1_i32_b64 s20, s[20:21]
    s_lshl_b64 exec, s[74:75], 1
    v_mov_b32 v37, s20
    s_bcnt1_i32_b64 s22, s[22:23]
    s_lshl_b64 exec, s[74:75], 2
    v_mov_b32 v37, s22
    s_bcnt1_i32_b64 s24, s[24:25]
    s_lshl_b64 exec, s[74:75], 3
    v_mov_b32 v37, s24
    s_bcnt1_i32_b64 s26, s[26:27]
    s_lshl_b64 exec, s[74:75], 4
    v_mov_b32 v37, s26
    s_bcnt1_i32_b64 s28, s[28:29]
    s_lshl_b64 exec, s[74:75], 5
    v_mov_b32 v37, s28
    s_bcnt1_i32_b64 s30, s[30:31]
    s_lshl_b64 exec, s[74:75], 6
    v_mov_b32 v37, s30
    s_bcnt1_i32_b64 s34, s[34:35]
    s_lshl_b64 exec, s[74:75], 7
    v_mov_b32 v37, s34
    s_mov_b64 exec, -1
    v_cmp_gt_u32 vcc, 8, v37
    v_lshl_add_u32 v52, v37, 3, v52
    v_lshl_add_u32 v55, v37, 7, s73
    v_lshl_add_u32 v37, v37, 3, s72
    s_and_b64 exec, vcc, exec
    s_cbranch_execz F_REST
    global_store_dwordx2 v52, v[48:49], s[50:51]
    global_store_dwordx2 v52, v[48:49], s[50:51] offset:512
    s_and_b64 exec, vcc, 0xff
    global_store_dwordx2 v37, v[48:49], s[50:51] offset:256
    global_load_dword v51, v50, s[16:17] offset:0
    global_load_dword v51, v50, s[16:17] offset:128
    global_load_dword v51, v50, s[16:17] offset:256
    global_load_dword v51, v50, s[16:17] offset:384
    global_load_dword v51, v50, s[16:17] offset:512
    global_load_dword v51, v50, s[16:17] offset:640
    global_load_dword v51, v50, s[16:17] offset:768
    global_load_dword v51, v50, s[16:17] offset:896
    global_load_dword v51, v50, s[16:17] offset:1024
    global_store_dwordx2 v55, v[48:49], s[50:51] sc1
F_REST:
    s_mov_b64 exec, -1
    s_branch DN_L2
F_SLOW:
    v_lshrrev_b32 v24, 2, v2
    v_mul_u32_u24 v24, 256, v24
    v_and_b32 v27, 3, v2
    v_lshl_add_u32 v24, v27, 4, v24
    v_lshrrev_b32 v26, 1, v2
    v_mul_u32_u24 v26, 256, v26
    v_and_b32 v27, 1, v2
    v_lshl_add_u32 v26, v27, 4, v26
    v_add_u32 v26, 20544, v26
    v_add_u32 v24, 4096, v24
    v_add_u32 v26, 4096, v26
    global_load_dwordx4 v[28:31], v24, s[50:51] sc1
    v_add_u32 v24, 4096, v24
    global_load_dwordx4 v[32:35], v24, s[50:51] sc1
    v_add_u32 v24, 4096, v24
    global_load_dwordx4 v[36:39], v24, s[50:51] sc1
    v_add_u32 v24, 4096, v24
    global_load_dwordx4 v[40:43], v24, s[50:51] sc1
    v_add_u32 v24, 4096, v24
    global_load_dwordx4 v[44:47], v24, s[50:51] sc1
    v_add_u32 v24, 4096, v24
    global_load_dwordx4 v[48:51], v24, s[50:51] sc1
    v_add_u32 v24, 4096, v24
    global_load_dwordx4 v[52:55], v24, s[50:51] sc1
    v_add_u32 v24, 4096, v24
    global_load_dwordx4 v[56:59], v26, s[50:51] sc1
    v_add_u32 v24, 4096, v24
    v_sub_u32 v24, 0xfff, v20
    s_waitcnt vmcnt(0)
    v_subrev_u32 v25, 0, v24
    v_bfi_b32 v28, s76, v25, v28
    v_subrev_u32 v25, 1, v24
    v_bfi_b32 v29, s76, v25, v29
    v_subrev_u32 v25, 2, v24
    v_bfi_b32 v30, s76, v25, v30
    v_subrev_u32 v25, 3, v24
    v_bfi_b32 v31, s76, v25, v31
    v_subrev_u32 v25, 256, v24
    v_bfi_b32 v32, s76, v25, v32
    v_subrev_u32 v25, 257, v24
    v_bfi_b32 v33, s76, v25, v33
    v_subrev_u32 v25, 258, v24
    v_bfi_b32 v34, s76, v25, v34
    v_subrev_u32 v25, 259, v24
    v_bfi_b32 v35, s76, v25, v35
    v_subrev_u32 v25, 512, v24
    v_bfi_b32 v36, s76, v25, v36
    v_subrev_u32 v25, 513, v24
    v_bfi_b32 v37, s76, v25, v37
    v_subrev_u32 v25, 514, v24
    v_bfi_b32 v38, s76, v25, v38
    v_subrev_u32 v25, 515, v24
    v_bfi_b32 v39, s76, v25, v39
    v_subrev_u32 v25, 768, v24
    v_bfi_b32 v40, s76, v25, v40
    v_subrev_u32 v25, 769, v24
    v_bfi_b32 v41, s76, v25, v41
    v_subrev_u32 v25, 770, v24
    v_bfi_b32 v42, s76, v25, v42
    v_subrev_u32 v25, 771, v24
    v_bfi_b32 v43, s76, v25, v43
    v_subrev_u32 v25, 1024, v24
    v_bfi_b32 v44, s76, v25, v44
    v_subrev_u32 v25, 1025, v24
    v_bfi_b32 v45, s76, v25, v45
    v_subrev_u32 v25, 1026, v24
    v_bfi_b32 v46, s76, v25, v46
    v_subrev_u32 v25, 1027, v24
    v_bfi_b32 v47, s76, v25, v47
    v_subrev_u32 v25, 1280, v24
    v_bfi_b32 v48, s76, v25, v48
    v_subrev_u32 v25, 1281, v24
    v_bfi_b32 v49, s76, v25, v49
    v_subrev_u32 v25, 1282, v24
    v_bfi_b32 v50, s76, v25, v50
    v_subrev_u32 v25, 1283, v24
    v_bfi_b32 v51, s76, v25, v51
    v_subrev_u32 v25, 1536, v24
    v_bfi_b32 v52, s76, v25, v52
    v_subrev_u32 v25, 1537, v24
    v_bfi_b32 v53, s76, v25, v53
    v_subrev_u32 v25, 1538, v24
    v_bfi_b32 v54, s76, v25, v54
    v_subrev_u32 v25, 1539, v24
    v_bfi_b32 v55, s76, v25, v55
    v_subrev_u32 v25, 1792, v24
    v_bfi_b32 v56, s76, v25, v56
    v_subrev_u32 v25, 1793, v24
    v_bfi_b32 v57, s76, v25, v57
    v_subrev_u32 v25, 1794, v24
    v_bfi_b32 v58, s76, v25, v58
    v_subrev_u32 v25, 1795, v24
    v_bfi_b32 v59, s76, v25, v59
    s_mov_b32 s77, 0
    s_mov_b32 s7, 0
F_SLOOP:
    v_subrev_u32 v60, s77, v28
    v_subrev_u32 v61, s77, v29
    v_subrev_u32 v62, s77, v30
    v_subrev_u32 v63, s77, v31
    v_subrev_u32 v64, s77, v32
    v_subrev_u32 v65, s77, v33
    v_subrev_u32 v66, s77, v34
    v_subrev_u32 v67, s77, v35
    v_subrev_u32 v68, s77, v36
    v_subrev_u32 v69, s77, v37
    v_subrev_u32 v70, s77, v38
    v_subrev_u32 v71, s77, v39
    v_subrev_u32 v72, s77, v40
    v_subrev_u32 v73, s77, v41
    v_subrev_u32 v74, s77, v42
    v_subrev_u32 v75, s77, v43
    v_subrev_u32 v76, s77, v44
    v_subrev_u32 v77, s77, v45
    v_subrev_u32 v78, s77, v46
    v_subrev_u32 v79, s77, v47
    v_subrev_u32 v80, s77, v48
    v_subrev_u32 v81, s77, v49
    v_subrev_u32 v82, s77, v50
    v_subrev_u32 v83, s77, v51
    v_subrev_u32 v84, s77, v52
    v_subrev_u32 v85, s77, v53
    v_subrev_u32 v86, s77, v54
    v_subrev_u32 v87, s77, v55
    v_subrev_u32 v88, s77, v56
    v_subrev_u32 v89, s77, v57
    v_subrev_u32 v90, s77, v58
    v_subrev_u32 v91, s77, v59
    v_max_u32 v60, v60, v61
    v_max3_u32 v60, v60, v62, v63
    v_max3_u32 v60, v60, v64, v65
    v_max3_u32 v60, v60, v66, v67
    v_max3_u32 v60, v60, v68, v69
    v_max3_u32 v60, v60, v70, v71
    v_max3_u32 v60, v60, v72, v73
    v_max3_u32 v60, v60, v74, v75
    v_max3_u32 v60, v60, v76, v77
    v_max3_u32 v60, v60, v78, v79
    v_max3_u32 v60, v60, v80, v81
    v_max3_u32 v60, v60, v82, v83
    v_max3_u32 v60, v60, v84, v85
    v_max3_u32 v60, v60, v86, v87
    v_max3_u32 v60, v60, v88, v89
    v_max3_u32 v60, v60, v90, v91
    s_nop 1
    v_max_u32_dpp v60, v60, v60 row_shr:1 row_mask:0xf bank_mask:0xf
    s_nop 1
    v_max_u32_dpp v60, v60, v60 row_shr:2 row_mask:0xf bank_mask:0xf
    s_nop 1
    v_max_u32_dpp v60, v60, v60 row_shr:4 row_mask:0xf bank_mask:0xf
    s_nop 1
    v_max_u32_dpp v60, v60, v60 row_shr:8 row_mask:0xf bank_mask:0xf
    s_nop 1
    v_max_u32_dpp v60, v60, v60 row_bcast:15 row_mask:0xa bank_mask:0xf
    s_nop 1
    v_max_u32_dpp v60, v60, v60 row_bcast:31 row_mask:0xc bank_mask:0xf
    s_nop 0
    v_readlane_b32 s8, v60, 63
    s_add_u32 s77, s77, s8
    s_add_u32 s7, s7, 1
    s_cmp_le_u32 s7, s3
    s_cbranch_scc1 F_SLOOP
    s_mov_b64 exec, 1
    v_mov_b32 v48, s77
    v_mov_b32 v49, v14
    s_lshl_b32 s8, s3, 3
    s_add_u32 s8, s8, s72
    v_mov_b32 v50, s8
    global_store_dwordx2 v50, v[48:49], s[50:51] offset:256
    s_lshl_b32 s8, s3, 7
    s_add_u32 s8, s8, s73
    v_mov_b32 v50, s8
    global_store_dwordx2 v50, v[48:49], s[50:51] sc1
    s_branch F_REST
CK_MAIN:
    s_mul_i32 s13, s7, 8192
    s_add_u32 s13, s13, 120832
    s_lshr_b32 s14, s7, 1
    s_mul_i32 s14, s14, 60192
    s_and_b32 s8, s7, 1
    s_lshl_b32 s8, s8, 9
    s_add_u32 s14, s14, s8
    s_lshl_b32 s8, s12, 8
    s_add_u32 m0, s14, s8
    v_mov_b32 v124, 0
    v_mov_b32 v125, 0
    v_mov_b32 v126, 0
    v_mov_b32 v127, 0
    s_lshl_b32 s8, s12, 11
    s_add_u32 s8, s8, s13
    v_lshl_add_u32 v20, v2, 4, s8
    ds_write_b128 v20, v[124:127]
    ds_write_b128 v20, v[124:127] offset:1024
    v_mul_u32_u24 v128, 1056, v3
    v_lshl_add_u32 v128, v4, 4, v128
    v_add_u32 v128, s14, v128
    s_lshl_b32 s8, s3, 2
    s_add_u32 s9, s8, 153632
    v_mov_b32 v129, s9
    s_xor_b32 s8, s8, 16
    s_add_u32 s9, s8, 153632
    v_mov_b32 v130, s9
    v_mov_b32 v21, 0x3c00
    ds_write_addtid_b32 v21 offset:43296
    v_mov_b32 v22, 0x3fb8aa3b
    v_mov_b32 v23, 0x32a57060
    v_mov_b32 v24, 0x3fb8aa3b
    v_mov_b32 v25, 0x3e22f983
    s_mov_b32 s15, 0x7fff7fff
    s_cmp_eq_u32 s12, 0
    s_mov_b32 s73, 0x01000c0c
    s_cselect_b32 s73, s73, 0x03020c0c
    s_waitcnt vmcnt(6)
    v_mul_f32 v19, v18, v22
    v_fma_f32 v22, v18, v22, -v19
    v_exp_f32 v19, v19
    v_fma_f32 v22, v18, v23, v22
    v_mul_f32 v22, 0x3f317218, v22
    v_fma_f32 v19, v19, v22, v19
    v_cvt_pk_bf16_f32 v19, v19, v19
    v_and_b32 v18, 0xffff0000, v19
    v_pk_mul_f32 v[24:25], v[24:25], v[18:19] op_sel_hi:[1,0]
    s_waitcnt vmcnt(0)
    v_and_b32 v14, s15, v30
    v_and_b32 v15, s15, v31
    v_and_b32 v16, s15, v32
    v_and_b32 v17, s15, v33
    v_perm_b32 v8, v28, v28, s73
    v_perm_b32 v9, v29, v29, s73
    v_perm_b32 v10, v30, v30, s73
    v_perm_b32 v11, v31, v31, s73
    v_perm_b32 v12, v32, v32, s73
    v_perm_b32 v13, v33, v33, s73
    v_pk_max_u16 v14, v14, v15
    v_pk_max_u16 v16, v16, v17
    v_lshlrev_b32 v15, 16, v14
    v_lshlrev_b32 v17, 16, v16
    v_pk_mul_f32 v[14:15], v[14:15], v[16:17]
    v_pk_mul_f32 v[8:9], v[8:9], v[24:25]
    v_max_f32 v14, v14, v15
    v_pk_mul_f32 v[10:11], v[10:11], v[18:19] op_sel_hi:[1,0]
    v_mul_f32 v14, v14, v18
    v_pk_mul_f32 v[66:67], v[12:13], v[10:11] op_sel:[1,1] op_sel_hi:[1,0]
    v_pk_fma_f32 v[56:57], v[12:13], v[10:11], v[66:67] op_sel:[0,0,0] op_sel_hi:[0,1,1] neg_lo:[0,0,1]
    v_max_u32_dpp v14, v14, v14 row_shr:1 row_mask:0xf bank_mask:0xf
    v_mul_f32 v60, 0x41000000, v8
    v_mul_f32 v61, 0xc1000000, v9
    v_max_u32_dpp v14, v14, v14 row_shr:2 row_mask:0xf bank_mask:0xf
    v_mul_f32 v62, 0x43000000, v8
    v_mul_f32 v63, 0x43000000, v9
    v_max_u32_dpp v14, v14, v14 row_shr:4 row_mask:0xf bank_mask:0xf
    v_fract_f32 v59, v9
    v_fract_f32 v61, v61
    v_max_u32_dpp v14, v14, v14 row_shr:8 row_mask:0xf bank_mask:0xf
    v_fract_f32 v63, v63
    v_exp_f32 v20, v8
    v_max_u32_dpp v14, v14, v14 row_bcast:15 row_mask:0xa bank_mask:0xf
    v_exp_f32 v22, v60
    v_exp_f32 v26, v62
    v_max_u32_dpp v14, v14, v14 row_bcast:31 row_mask:0xc bank_mask:0xf
    v_cos_f32 v60, v61
    v_readlane_b32 s8, v14, 63
    v_sin_f32 v61, v61
    v_cos_f32 v58, v59
    v_sin_f32 v59, v59
    v_cos_f32 v62, v63
    v_sin_f32 v63, v63
    s_lshr_b32 s8, s8, 23
    s_sub_i32 s8, 258, s8
    s_max_i32 s8, s8, 1
    s_min_i32 s8, s8, 253
    s_lshl_b32 s10, s8, 23
    v_pk_mul_f32 v[60:61], v[60:61], v[22:23] op_sel_hi:[1,0]
    v_pk_mul_f32 v[58:59], v[58:59], v[20:21] op_sel_hi:[1,0]
    v_pk_mul_f32 v[62:63], v[62:63], v[26:27] op_sel_hi:[1,0]
    v_pk_mul_f32 v[56:57], v[56:57], s[10:11] op_sel_hi:[1,0]
    v_cvt_pk_f16_f32 v70, v60, v61
    ds_write_addtid_b32 v70 offset:44352
    v_cvt_pk_f16_f32 v71, v56, v57
    ds_write_addtid_b32 v71 offset:42240
    v_pk_mul_f32 v[66:67], v[56:57], v[58:59] op_sel:[1,1] op_sel_hi:[1,0]
    v_pk_fma_f32 v[40:41], v[56:57], v[58:59], v[66:67] op_sel:[0,0,0] op_sel_hi:[0,1,1] neg_lo:[0,0,1]
    v_cvt_pk_f16_f32 v72, v40, v41
    ds_write_addtid_b32 v72 offset:0
    v_pk_mul_f32 v[66:67], v[40:41], v[58:59] op_sel:[1,1] op_sel_hi:[1,0]
    v_pk_fma_f32 v[42:43], v[40:41], v[58:59], v[66:67] op_sel:[0,0,0] op_sel_hi:[0,1,1] neg_lo:[0,0,1]
    v_cvt_pk_f16_f32 v73, v42, v43
    ds_write_addtid_b32 v73 offset:1056
    v_pk_mul_f32 v[66:67], v[42:43], v[58:59] op_sel:[1,1] op_sel_hi:[1,0]
    v_pk_fma_f32 v[44:45], v[42:43], v[58:59], v[66:67] op_sel:[0,0,0] op_sel_hi:[0,1,1] neg_lo:[0,0,1]
    v_cvt_pk_f16_f32 v70, v44, v45
    ds_write_addtid_b32 v70 offset:2112
    v_pk_mul_f32 v[66:67], v[44:45], v[58:59] op_sel:[1,1] op_sel_hi:[1,0]
    v_pk_fma_f32 v[46:47], v[44:45], v[58:59], v[66:67] op_sel:[0,0,0] op_sel_hi:[0,1,1] neg_lo:[0,0,1]
    v_cvt_pk_f16_f32 v71, v46, v47
    ds_write_addtid_b32 v71 offset:3168
    v_pk_mul_f32 v[66:67], v[46:47], v[58:59] op_sel:[1,1] op_sel_hi:[1,0]
    v_pk_fma_f32 v[48:49], v[46:47], v[58:59], v[66:67] op_sel:[0,0,0] op_sel_hi:[0,1,1] neg_lo:[0,0,1]
    v_cvt_pk_f16_f32 v72, v48, v49
    ds_write_addtid_b32 v72 offset:4224
    v_pk_mul_f32 v[66:67], v[48:49], v[58:59] op_sel:[1,1] op_sel_hi:[1,0]
    v_pk_fma_f32 v[50:51], v[48:49], v[58:59], v[66:67] op_sel:[0,0,0] op_sel_hi:[0,1,1] neg_lo:[0,0,1]
    v_cvt_pk_f16_f32 v73, v50, v51
    ds_write_addtid_b32 v73 offset:5280
    v_pk_mul_f32 v[66:67], v[50:51], v[58:59] op_sel:[1,1] op_sel_hi:[1,0]
    v_pk_fma_f32 v[52:53], v[50:51], v[58:59], v[66:67] op_sel:[0,0,0] op_sel_hi:[0,1,1] neg_lo:[0,0,1]
    v_cvt_pk_f16_f32 v70, v52, v53
    ds_write_addtid_b32 v70 offset:6336
    v_pk_mul_f32 v[66:67], v[52:53], v[58:59] op_sel:[1,1] op_sel_hi:[1,0]
    v_pk_fma_f32 v[54:55], v[52:53], v[58:59], v[66:67] op_sel:[0,0,0] op_sel_hi:[0,1,1] neg_lo:[0,0,1]
    v_cvt_pk_f16_f32 v71, v54, v55
    ds_write_addtid_b32 v71 offset:7392
    v_pk_mul_f32 v[66:67], v[40:41], v[62:63] op_sel:[1,1] op_sel_hi:[1,0]
    v_pk_fma_f32 v[40:41], v[40:41], v[62:63], v[66:67] op_sel:[0,0,0] op_sel_hi:[0,1,1] neg_lo:[0,0,1]
    v_cvt_pk_f16_f32 v72, v40, v41
    ds_write_addtid_b32 v72 offset:8448
    v_pk_mul_f32 v[66:67], v[42:43], v[62:63] op_sel:[1,1] op_sel_hi:[1,0]
    v_pk_fma_f32 v[42:43], v[42:43], v[62:63], v[66:67] op_sel:[0,0,0] op_sel_hi:[0,1,1] neg_lo:[0,0,1]
    v_cvt_pk_f16_f32 v73, v42, v43
    ds_write_addtid_b32 v73 offset:9504
    v_pk_mul_f32 v[66:67], v[44:45], v[62:63] op_sel:[1,1] op_sel_hi:[1,0]
    v_pk_fma_f32 v[44:45], v[44:45], v[62:63], v[66:67] op_sel:[0,0,0] op_sel_hi:[0,1,1] neg_lo:[0,0,1]
    v_cvt_pk_f16_f32 v70, v44, v45
    ds_write_addtid_b32 v70 offset:10560
    v_pk_mul_f32 v[66:67], v[46:47], v[62:63] op_sel:[1,1] op_sel_hi:[1,0]
    v_pk_fma_f32 v[46:47], v[46:47], v[62:63], v[66:67] op_sel:[0,0,0] op_sel_hi:[0,1,1] neg_lo:[0,0,1]
    v_cvt_pk_f16_f32 v71, v46, v47
    ds_write_addtid_b32 v71 offset:11616
    v_pk_mul_f32 v[66:67], v[48:49], v[62:63] op_sel:[1,1] op_sel_hi:[1,0]
    v_pk_fma_f32 v[48:49], v[48:49], v[62:63], v[66:67] op_sel:[0,0,0] op_sel_hi:[0,1,1] neg_lo:[0,0,1]
    v_cvt_pk_f16_f32 v72, v48, v49
    ds_write_addtid_b32 v72 offset:12672
    v_pk_mul_f32 v[66:67], v[50:51], v[62:63] op_sel:[1,1] op_sel_hi:[1,0]
    v_pk_fma_f32 v[50:51], v[50:51], v[62:63], v[66:67] op_sel:[0,0,0] op_sel_hi:[0,1,1] neg_lo:[0,0,1]
    v_cvt_pk_f16_f32 v73, v50, v51
    ds_write_addtid_b32 v73 offset:13728
    v_pk_mul_f32 v[66:67], v[52:53], v[62:63] op_sel:[1,1] op_sel_hi:[1,0]
    v_pk_fma_f32 v[52:53], v[52:53], v[62:63], v[66:67] op_sel:[0,0,0] op_sel_hi:[0,1,1] neg_lo:[0,0,1]
    v_cvt_pk_f16_f32 v70, v52, v53
    ds_write_addtid_b32 v70 offset:14784
    v_pk_mul_f32 v[66:67], v[54:55], v[62:63] op_sel:[1,1] op_sel_hi:[1,0]
    v_pk_fma_f32 v[54:55], v[54:55], v[62:63], v[66:67] op_sel:[0,0,0] op_sel_hi:[0,1,1] neg_lo:[0,0,1]
    v_cvt_pk_f16_f32 v71, v54, v55
    ds_write_addtid_b32 v71 offset:15840
    v_pk_mul_f32 v[66:67], v[42:43], v[62:63] op_sel:[1,1] op_sel_hi:[1,0]
    v_pk_fma_f32 v[42:43], v[42:43], v[62:63], v[66:67] op_sel:[0,0,0] op_sel_hi:[0,1,1] neg_lo:[0,0,1]
    v_cvt_pk_f16_f32 v72, v42, v43
    ds_write_addtid_b32 v72 offset:16896
    v_pk_mul_f32 v[66:67], v[46:47], v[62:63] op_sel:[1,1] op_sel_hi:[1,0]
    v_pk_fma_f32 v[46:47], v[46:47], v[62:63], v[66:67] op_sel:[0,0,0] op_sel_hi:[0,1,1] neg_lo:[0,0,1]
    v_cvt_pk_f16_f32 v73, v46, v47
    ds_write_addtid_b32 v73 offset:17952
    v_pk_mul_f32 v[66:67], v[50:51], v[62:63] op_sel:[1,1] op_sel_hi:[1,0]
    v_pk_fma_f32 v[50:51], v[50:51], v[62:63], v[66:67] op_sel:[0,0,0] op_sel_hi:[0,1,1] neg_lo:[0,0,1]
    v_cvt_pk_f16_f32 v70, v50, v51
    ds_write_addtid_b32 v70 offset:19008
    v_pk_mul_f32 v[66:67], v[54:55], v[62:63] op_sel:[1,1] op_sel_hi:[1,0]
    v_pk_fma_f32 v[54:55], v[54:55], v[62:63], v[66:67] op_sel:[0,0,0] op_sel_hi:[0,1,1] neg_lo:[0,0,1]
    v_cvt_pk_f16_f32 v71, v54, v55
    ds_write_addtid_b32 v71 offset:20064
    v_pk_mul_f32 v[66:67], v[42:43], v[62:63] op_sel:[1,1] op_sel_hi:[1,0]
    v_pk_fma_f32 v[42:43], v[42:43], v[62:63], v[66:67] op_sel:[0,0,0] op_sel_hi:[0,1,1] neg_lo:[0,0,1]
    v_cvt_pk_f16_f32 v72, v42, v43
    ds_write_addtid_b32 v72 offset:21120
    v_pk_mul_f32 v[66:67], v[46:47], v[62:63] op_sel:[1,1] op_sel_hi:[1,0]
    v_pk_fma_f32 v[46:47], v[46:47], v[62:63], v[66:67] op_sel:[0,0,0] op_sel_hi:[0,1,1] neg_lo:[0,0,1]
    v_cvt_pk_f16_f32 v73, v46, v47
    ds_write_addtid_b32 v73 offset:22176
    v_pk_mul_f32 v[66:67], v[50:51], v[62:63] op_sel:[1,1] op_sel_hi:[1,0]
    v_pk_fma_f32 v[50:51], v[50:51], v[62:63], v[66:67] op_sel:[0,0,0] op_sel_hi:[0,1,1] neg_lo:[0,0,1]
    v_cvt_pk_f16_f32 v70, v50, v51
    ds_write_addtid_b32 v70 offset:23232
    v_pk_mul_f32 v[66:67], v[54:55], v[62:63] op_sel:[1,1] op_sel_hi:[1,0]
    v_pk_fma_f32 v[54:55], v[54:55], v[62:63], v[66:67] op_sel:[0,0,0] op_sel_hi:[0,1,1] neg_lo:[0,0,1]
    v_cvt_pk_f16_f32 v71, v54, v55
    ds_write_addtid_b32 v71 offset:24288
    v_pk_mul_f32 v[66:67], v[46:47], v[62:63] op_sel:[1,1] op_sel_hi:[1,0]
    v_pk_fma_f32 v[46:47], v[46:47], v[62:63], v[66:67] op_sel:[0,0,0] op_sel_hi:[0,1,1] neg_lo:[0,0,1]
    v_cvt_pk_f16_f32 v72, v46, v47
    ds_write_addtid_b32 v72 offset:25344
    v_pk_mul_f32 v[66:67], v[54:55], v[62:63] op_sel:[1,1] op_sel_hi:[1,0]
    v_pk_fma_f32 v[54:55], v[54:55], v[62:63], v[66:67] op_sel:[0,0,0] op_sel_hi:[0,1,1] neg_lo:[0,0,1]
    v_cvt_pk_f16_f32 v73, v54, v55
    ds_write_addtid_b32 v73 offset:26400
    v_pk_mul_f32 v[66:67], v[46:47], v[62:63] op_sel:[1,1] op_sel_hi:[1,0]
    v_pk_fma_f32 v[46:47], v[46:47], v[62:63], v[66:67] op_sel:[0,0,0] op_sel_hi:[0,1,1] neg_lo:[0,0,1]
    v_cvt_pk_f16_f32 v70, v46, v47
    ds_write_addtid_b32 v70 offset:27456
    v_pk_mul_f32 v[66:67], v[54:55], v[62:63] op_sel:[1,1] op_sel_hi:[1,0]
    v_pk_fma_f32 v[54:55], v[54:55], v[62:63], v[66:67] op_sel:[0,0,0] op_sel_hi:[0,1,1] neg_lo:[0,0,1]
    v_cvt_pk_f16_f32 v71, v54, v55
    ds_write_addtid_b32 v71 offset:28512
    v_pk_mul_f32 v[66:67], v[46:47], v[62:63] op_sel:[1,1] op_sel_hi:[1,0]
    v_pk_fma_f32 v[46:47], v[46:47], v[62:63], v[66:67] op_sel:[0,0,0] op_sel_hi:[0,1,1] neg_lo:[0,0,1]
    v_cvt_pk_f16_f32 v72, v46, v47
    ds_write_addtid_b32 v72 offset:29568
    v_pk_mul_f32 v[66:67], v[54:55], v[62:63] op_sel:[1,1] op_sel_hi:[1,0]
    v_pk_fma_f32 v[54:55], v[54:55], v[62:63], v[66:67] op_sel:[0,0,0] op_sel_hi:[0,1,1] neg_lo:[0,0,1]
    v_cvt_pk_f16_f32 v73, v54, v55
    ds_write_addtid_b32 v73 offset:30624
    v_pk_mul_f32 v[66:67], v[46:47], v[62:63] op_sel:[1,1] op_sel_hi:[1,0]
    v_pk_fma_f32 v[46:47], v[46:47], v[62:63], v[66:67] op_sel:[0,0,0] op_sel_hi:[0,1,1] neg_lo:[0,0,1]
    v_cvt_pk_f16_f32 v70, v46, v47
    ds_write_addtid_b32 v70 offset:31680
    v_pk_mul_f32 v[66:67], v[54:55], v[62:63] op_sel:[1,1] op_sel_hi:[1,0]
    v_pk_fma_f32 v[54:55], v[54:55], v[62:63], v[66:67] op_sel:[0,0,0] op_sel_hi:[0,1,1] neg_lo:[0,0,1]
    v_cvt_pk_f16_f32 v71, v54, v55
    ds_write_addtid_b32 v71 offset:32736
    v_pk_mul_f32 v[66:67], v[54:55], v[62:63] op_sel:[1,1] op_sel_hi:[1,0]
    v_pk_fma_f32 v[54:55], v[54:55], v[62:63], v[66:67] op_sel:[0,0,0] op_sel_hi:[0,1,1] neg_lo:[0,0,1]
    v_cvt_pk_f16_f32 v72, v54, v55
    ds_write_addtid_b32 v72 offset:33792
    v_pk_mul_f32 v[66:67], v[54:55], v[62:63] op_sel:[1,1] op_sel_hi:[1,0]
    v_pk_fma_f32 v[54:55], v[54:55], v[62:63], v[66:67] op_sel:[0,0,0] op_sel_hi:[0,1,1] neg_lo:[0,0,1]
    v_cvt_pk_f16_f32 v73, v54, v55
    ds_write_addtid_b32 v73 offset:34848
    v_pk_mul_f32 v[66:67], v[54:55], v[62:63] op_sel:[1,1] op_sel_hi:[1,0]
    v_pk_fma_f32 v[54:55], v[54:55], v[62:63], v[66:67] op_sel:[0,0,0] op_sel_hi:[0,1,1] neg_lo:[0,0,1]
    v_cvt_pk_f16_f32 v70, v54, v55
    ds_write_addtid_b32 v70 offset:35904
    v_pk_mul_f32 v[66:67], v[54:55], v[62:63] op_sel:[1,1] op_sel_hi:[1,0]
    v_pk_fma_f32 v[54:55], v[54:55], v[62:63], v[66:67] op_sel:[0,0,0] op_sel_hi:[0,1,1] neg_lo:[0,0,1]
    v_cvt_pk_f16_f32 v71, v54, v55
    ds_write_addtid_b32 v71 offset:36960
    v_pk_mul_f32 v[66:67], v[54:55], v[62:63] op_sel:[1,1] op_sel_hi:[1,0]
    v_pk_fma_f32 v[54:55], v[54:55], v[62:63], v[66:67] op_sel:[0,0,0] op_sel_hi:[0,1,1] neg_lo:[0,0,1]
    v_cvt_pk_f16_f32 v72, v54, v55
    ds_write_addtid_b32 v72 offset:38016
    v_pk_mul_f32 v[66:67], v[54:55], v[62:63] op_sel:[1,1] op_sel_hi:[1,0]
    v_pk_fma_f32 v[54:55], v[54:55], v[62:63], v[66:67] op_sel:[0,0,0] op_sel_hi:[0,1,1] neg_lo:[0,0,1]
    v_cvt_pk_f16_f32 v73, v54, v55
    ds_write_addtid_b32 v73 offset:39072
    v_pk_mul_f32 v[66:67], v[54:55], v[62:63] op_sel:[1,1] op_sel_hi:[1,0]
    v_pk_fma_f32 v[54:55], v[54:55], v[62:63], v[66:67] op_sel:[0,0,0] op_sel_hi:[0,1,1] neg_lo:[0,0,1]
    v_cvt_pk_f16_f32 v70, v54, v55
    ds_write_addtid_b32 v70 offset:40128
    v_pk_mul_f32 v[66:67], v[54:55], v[62:63] op_sel:[1,1] op_sel_hi:[1,0]
    v_pk_fma_f32 v[54:55], v[54:55], v[62:63], v[66:67] op_sel:[0,0,0] op_sel_hi:[0,1,1] neg_lo:[0,0,1]
    v_cvt_pk_f16_f32 v71, v54, v55
    ds_write_addtid_b32 v71 offset:41184
    v_pk_mul_f32 v[66:67], v[60:61], v[60:61] op_sel:[1,1] op_sel_hi:[1,0]
    v_pk_fma_f32 v[64:65], v[60:61], v[60:61], v[66:67] op_sel:[0,0,0] op_sel_hi:[0,1,1] neg_lo:[0,0,1]
    v_cvt_pk_f16_f32 v72, v64, v65
    ds_write_addtid_b32 v72 offset:45408
    v_pk_mul_f32 v[66:67], v[64:65], v[60:61] op_sel:[1,1] op_sel_hi:[1,0]
    v_pk_fma_f32 v[64:65], v[64:65], v[60:61], v[66:67] op_sel:[0,0,0] op_sel_hi:[0,1,1] neg_lo:[0,0,1]
    v_cvt_pk_f16_f32 v73, v64, v65
    ds_write_addtid_b32 v73 offset:46464
    v_pk_mul_f32 v[66:67], v[64:65], v[60:61] op_sel:[1,1] op_sel_hi:[1,0]
    v_pk_fma_f32 v[64:65], v[64:65], v[60:61], v[66:67] op_sel:[0,0,0] op_sel_hi:[0,1,1] neg_lo:[0,0,1]
    v_cvt_pk_f16_f32 v70, v64, v65
    ds_write_addtid_b32 v70 offset:47520
    v_pk_mul_f32 v[66:67], v[64:65], v[60:61] op_sel:[1,1] op_sel_hi:[1,0]
    v_pk_fma_f32 v[64:65], v[64:65], v[60:61], v[66:67] op_sel:[0,0,0] op_sel_hi:[0,1,1] neg_lo:[0,0,1]
    v_cvt_pk_f16_f32 v71, v64, v65
    ds_write_addtid_b32 v71 offset:48576
    v_pk_mul_f32 v[66:67], v[64:65], v[60:61] op_sel:[1,1] op_sel_hi:[1,0]
    v_pk_fma_f32 v[64:65], v[64:65], v[60:61], v[66:67] op_sel:[0,0,0] op_sel_hi:[0,1,1] neg_lo:[0,0,1]
    v_cvt_pk_f16_f32 v72, v64, v65
    ds_write_addtid_b32 v72 offset:49632
    v_pk_mul_f32 v[66:67], v[64:65], v[60:61] op_sel:[1,1] op_sel_hi:[1,0]
    v_pk_fma_f32 v[64:65], v[64:65], v[60:61], v[66:67] op_sel:[0,0,0] op_sel_hi:[0,1,1] neg_lo:[0,0,1]
    v_cvt_pk_f16_f32 v73, v64, v65
    ds_write_addtid_b32 v73 offset:50688
    v_pk_mul_f32 v[66:67], v[64:65], v[60:61] op_sel:[1,1] op_sel_hi:[1,0]
    v_pk_fma_f32 v[64:65], v[64:65], v[60:61], v[66:67] op_sel:[0,0,0] op_sel_hi:[0,1,1] neg_lo:[0,0,1]
    v_cvt_pk_f16_f32 v70, v64, v65
    ds_write_addtid_b32 v70 offset:51744
    v_pk_mul_f32 v[66:67], v[64:65], v[60:61] op_sel:[1,1] op_sel_hi:[1,0]
    v_pk_fma_f32 v[64:65], v[64:65], v[60:61], v[66:67] op_sel:[0,0,0] op_sel_hi:[0,1,1] neg_lo:[0,0,1]
    v_cvt_pk_f16_f32 v71, v64, v65
    ds_write_addtid_b32 v71 offset:52800
    v_pk_mul_f32 v[66:67], v[64:65], v[60:61] op_sel:[1,1] op_sel_hi:[1,0]
    v_pk_fma_f32 v[64:65], v[64:65], v[60:61], v[66:67] op_sel:[0,0,0] op_sel_hi:[0,1,1] neg_lo:[0,0,1]
    v_cvt_pk_f16_f32 v72, v64, v65
    ds_write_addtid_b32 v72 offset:53856
    v_pk_mul_f32 v[66:67], v[64:65], v[60:61] op_sel:[1,1] op_sel_hi:[1,0]
    v_pk_fma_f32 v[64:65], v[64:65], v[60:61], v[66:67] op_sel:[0,0,0] op_sel_hi:[0,1,1] neg_lo:[0,0,1]
    v_cvt_pk_f16_f32 v73, v64, v65
    ds_write_addtid_b32 v73 offset:54912
    v_pk_mul_f32 v[66:67], v[64:65], v[60:61] op_sel:[1,1] op_sel_hi:[1,0]
    v_pk_fma_f32 v[64:65], v[64:65], v[60:61], v[66:67] op_sel:[0,0,0] op_sel_hi:[0,1,1] neg_lo:[0,0,1]
    v_cvt_pk_f16_f32 v70, v64, v65
    ds_write_addtid_b32 v70 offset:55968
    v_pk_mul_f32 v[66:67], v[64:65], v[60:61] op_sel:[1,1] op_sel_hi:[1,0]
    v_pk_fma_f32 v[64:65], v[64:65], v[60:61], v[66:67] op_sel:[0,0,0] op_sel_hi:[0,1,1] neg_lo:[0,0,1]
    v_cvt_pk_f16_f32 v71, v64, v65
    ds_write_addtid_b32 v71 offset:57024
    v_pk_mul_f32 v[66:67], v[64:65], v[60:61] op_sel:[1,1] op_sel_hi:[1,0]
    v_pk_fma_f32 v[64:65], v[64:65], v[60:61], v[66:67] op_sel:[0,0,0] op_sel_hi:[0,1,1] neg_lo:[0,0,1]
    v_cvt_pk_f16_f32 v72, v64, v65
    ds_write_addtid_b32 v72 offset:58080
    v_pk_mul_f32 v[66:67], v[64:65], v[60:61] op_sel:[1,1] op_sel_hi:[1,0]
    v_pk_fma_f32 v[64:65], v[64:65], v[60:61], v[66:67] op_sel:[0,0,0] op_sel_hi:[0,1,1] neg_lo:[0,0,1]
    v_cvt_pk_f16_f32 v73, v64, v65
    ds_write_addtid_b32 v73 offset:59136
CK_SKIP:
    ds_write_b32 v129, v129
    s_mov_b32 s9, 0
CK_PAIR:
    ds_read_b32 v8, v130
    s_add_u32 s9, s9, 1
    s_waitcnt lgkmcnt(0)
    v_cmp_eq_u32 vcc, 0, v8
    s_cmp_ge_u32 s9, 0x40000
    s_cbranch_scc1 CK_PAIRED
    s_cbranch_vccnz CK_PAIR
CK_PAIRED:
    s_sub_u32 s8, 254, s8
    s_lshl_b32 s15, s8, 23
    s_cmp_eq_u32 s12, 0
    s_cbranch_scc0 CK_T1
    ds_read_b128 v[8:11], v128 offset:43296
    ds_read_b128 v[40:43], v128 offset:0
    ds_read_b128 v[12:15], v128 offset:43360
    ds_read_b128 v[44:47], v128 offset:64
    ds_read_b128 v[16:19], v128 offset:43424
    ds_read_b128 v[48:51], v128 offset:128
    ds_read_b128 v[20:23], v128 offset:43488
    ds_read_b128 v[52:55], v128 offset:192
    ds_read_b128 v[24:27], v128 offset:43552
    ds_read_b128 v[56:59], v128 offset:256
    ds_read_b128 v[28:31], v128 offset:43616
    ds_read_b128 v[60:63], v128 offset:320
    ds_read_b128 v[32:35], v128 offset:43680
    ds_read_b128 v[64:67], v128 offset:384
    ds_read_b128 v[36:39], v128 offset:43744
    ds_read_b128 v[68:71], v128 offset:448
    v_lshrrev_b32 v114, 1, v4
    v_lshlrev_b32 v114, 8, v114
    v_lshl_add_u32 v114, v3, 4, v114
    v_and_b32 v115, 1, v4
    v_lshl_add_u32 v114, v115, 3, v114
    v_add_u32 v114, s13, v114
    v_lshlrev_b32 v115, 5, v3
    v_lshl_add_u32 v115, v4, 3, v115
    v_add_u32 v115, s13, v115
    v_mov_b32 v116, s13
    s_waitcnt lgkmcnt(14)
    v_mfma_f32_16x16x32_f16 v[104:107], v[40:43], v[8:11], 0
    ds_read_b128 v[72:75], v128 offset:33792
    s_waitcnt lgkmcnt(13)
    v_mfma_f32_16x16x32_f16 v[104:107], v[44:47], v[12:15], v[104:107]
    ds_read_b128 v[76:79], v128 offset:33856
    s_waitcnt lgkmcnt(12)
    v_mfma_f32_16x16x32_f16 v[104:107], v[48:51], v[16:19], v[104:107]
    ds_read_b128 v[80:83], v128 offset:33920
    s_waitcnt lgkmcnt(11)
    v_mfma_f32_16x16x32_f16 v[104:107], v[52:55], v[20:23], v[104:107]
    ds_read_b128 v[84:87], v128 offset:33984
    s_waitcnt lgkmcnt(10)
    v_mfma_f32_16x16x32_f16 v[104:107], v[56:59], v[24:27], v[104:107]
    ds_read_b128 v[88:91], v128 offset:34048
    s_waitcnt lgkmcnt(9)
    v_mfma_f32_16x16x32_f16 v[104:107], v[60:63], v[28:31], v[104:107]
    ds_read_b128 v[92:95], v128 offset:34112
    s_waitcnt lgkmcnt(8)
    v_mfma_f32_16x16x32_f16 v[104:107], v[64:67], v[32:35], v[104:107]
    ds_read_b128 v[96:99], v128 offset:34176
    s_waitcnt lgkmcnt(7)
    v_mfma_f32_16x16x32_f16 v[104:107], v[68:71], v[36:39], v[104:107]
    ds_read_b128 v[100:103], v128 offset:34240
    s_waitcnt lgkmcnt(7)
    v_mfma_f32_16x16x32_f16 v[108:111], v[8:11], v[72:75], 0
    s_waitcnt lgkmcnt(6)
    v_mfma_f32_16x16x32_f16 v[108:111], v[12:15], v[76:79], v[108:111]
    s_waitcnt lgkmcnt(5)
    v_mfma_f32_16x16x32_f16 v[108:111], v[16:19], v[80:83], v[108:111]
    s_waitcnt lgkmcnt(4)
    v_mfma_f32_16x16x32_f16 v[108:111], v[20:23], v[84:87], v[108:111]
    s_waitcnt lgkmcnt(3)
    v_mfma_f32_16x16x32_f16 v[108:111], v[24:27], v[88:91], v[108:111]
    s_waitcnt lgkmcnt(2)
    v_mfma_f32_16x16x32_f16 v[108:111], v[28:31], v[92:95], v[108:111]
    s_waitcnt lgkmcnt(1)
    v_mfma_f32_16x16x32_f16 v[108:111], v[32:35], v[96:99], v[108:111]
    s_waitcnt lgkmcnt(0)
    v_mfma_f32_16x16x32_f16 v[108:111], v[36:39], v[100:103], v[108:111]
    v_mul_f32 v104, s15, v104
    v_mul_f32 v105, s15, v105
    v_mul_f32 v106, s15, v106
    v_mul_f32 v107, s15, v107
    v_cvt_pk_bf16_f32 v118, v104, v105
    v_cvt_pk_bf16_f32 v119, v106, v107
    v_cvt_pk_bf16_f32 v120, v105, v106
    v_cvt_pk_bf16_f32 v121, v107, v107
    ds_write_b16 v114, v121 offset:1256
    ds_write_b64 v114, v[120:121] offset:32
    ds_write_b64 v114, v[118:119] offset:1248
    ds_write_b16 v114, v118 offset:30
    v_mul_f32 v108, s15, v108
    v_mul_f32 v109, s15, v109
    v_mul_f32 v110, s15, v110
    v_mul_f32 v111, s15, v111
    v_cvt_pk_bf16_f32 v118, v108, v109
    v_cvt_pk_bf16_f32 v119, v110, v111
    s_mov_b32 s10, 0x00ff00ff
    s_mov_b32 s11, 0x00ff00ff
    s_mov_b64 exec, s[10:11]
    ds_write_b64 v115, v[118:119] offset:2912
    s_mov_b64 exec, 0x100
    ds_write_b16 v116, v118 offset:28
    ds_write_b16 v116, v118 offset:1246
    s_mov_b64 exec, -1
    v_mov_b32 v127, 153600
    v_mov_b32 v126, 1
    s_lshl_b32 s8, s7, 2
    v_add_u32 v131, s8, v127
    s_mov_b64 exec, 1
    ds_add_u32 v131, v126 offset:80
    ds_add_u32 v127, v126 offset:76
    s_mov_b64 exec, -1
    v_mul_u32_u24 v124, 320, v4
    v_lshl_add_u32 v124, v3, 4, v124
    s_mul_i32 s8, s7, 20480
    v_add_u32 v124, s8, v124
    s_lshl_b32 s8, s3, 2
    s_add_u32 s8, s8, 153856
    v_mov_b32 v125, s8
    v_and_b32 v5, 1, v3
    v_mul_u32_u24 v5, 1216, v5
    v_sub_u32 v5, 1264, v5
    v_lshrrev_b32 v6, 1, v3
    v_lshl_add_u32 v5, v6, 2, v5
    v_lshlrev_b32 v6, 4, v4
    v_sub_u32 v5, v5, v6
    v_add_u32 v5, s13, v5
    v_add_u32 v7, 576, v5
    v_lshl_add_u32 v6, v3, 5, v6
    v_add_u32 v6, 3616, v6
    v_add_u32 v6, s13, v6
    s_mov_b32 s9, 0
SPN5:
    ds_read_b32 v128, v131 offset:80
    s_add_u32 s9, s9, 1
    s_waitcnt lgkmcnt(0)
    v_cmp_ne_u32 vcc, 2, v128
    s_cmp_ge_u32 s9, 0x40000
    s_cbranch_scc1 SPX5
    s_cbranch_vccnz SPN5
SPX5:
    ds_read2_b32 v[36:37], v5 offset0:115 offset1:114
    ds_read2_b32 v[38:39], v5 offset0:113 offset1:112
    ds_read2_b32 v[32:33], v5 offset0:99 offset1:98
    ds_read2_b32 v[34:35], v5 offset0:97 offset1:96
    ds_read2_b32 v[28:29], v5 offset0:83 offset1:82
    ds_read2_b32 v[30:31], v5 offset0:81 offset1:80
    ds_read2_b32 v[24:25], v5 offset0:67 offset1:66
    ds_read2_b32 v[26:27], v5 offset0:65 offset1:64
    ds_read2_b32 v[20:21], v5 offset0:51 offset1:50
    ds_read2_b32 v[22:23], v5 offset0:49 offset1:48
    ds_read2_b32 v[16:17], v5 offset0:35 offset1:34
    ds_read2_b32 v[18:19], v5 offset0:33 offset1:32
    ds_read2_b32 v[12:13], v5 offset0:19 offset1:18
    ds_read2_b32 v[14:15], v5 offset0:17 offset1:16
    ds_read2_b32 v[8:9], v5 offset0:3 offset1:2
    ds_read2_b32 v[10:11], v5 offset0:1 offset1:0
    ds_read2_b32 v[68:69], v7 offset0:99 offset1:98
    ds_read2_b32 v[70:71], v7 offset0:97 offset1:96
    ds_read2_b32 v[64:65], v7 offset0:83 offset1:82
    ds_read2_b32 v[66:67], v7 offset0:81 offset1:80
    ds_read2_b32 v[60:61], v7 offset0:67 offset1:66
    ds_read2_b32 v[62:63], v7 offset0:65 offset1:64
    ds_read2_b32 v[56:57], v7 offset0:51 offset1:50
    ds_read2_b32 v[58:59], v7 offset0:49 offset1:48
    ds_read2_b32 v[52:53], v7 offset0:35 offset1:34
    ds_read2_b32 v[54:55], v7 offset0:33 offset1:32
    ds_read2_b32 v[48:49], v7 offset0:19 offset1:18
    ds_read2_b32 v[50:51], v7 offset0:17 offset1:16
    ds_read2_b32 v[44:45], v7 offset0:3 offset1:2
    ds_read2_b32 v[46:47], v7 offset0:1 offset1:0
    ds_read2_b32 v[40:41], v5 offset0:131 offset1:130
    ds_read2_b32 v[42:43], v5 offset0:129 offset1:128
    ds_read2_b32 v[72:73], v7 offset0:115 offset1:114
    ds_read2_b32 v[74:75], v7 offset0:113 offset1:112
    s_mov_b32 s9, 0
SPN6:
    ds_read_b32 v128, v127 offset:76
    s_add_u32 s9, s9, 1
    s_waitcnt lgkmcnt(0)
    v_cmp_ne_u32 vcc, 12, v128
    s_cmp_ge_u32 s9, 0x40000
    s_cbranch_scc1 SPX6
    s_cbranch_vccz SPX6
    s_sleep 1
    s_branch SPN6
SPX6:
D_PASS:
    s_mov_b32 s9, 0
SPN7:
    ds_read_b32 v128, v127 offset:240
    s_add_u32 s9, s9, 1
    s_waitcnt lgkmcnt(0)
    v_and_b32 v128, 15, v128
    v_cmp_ne_u32 vcc, 2, v128
    s_cmp_ge_u32 s9, 0x40000
    s_cbranch_scc1 SPX7
    s_cbranch_vccz SPX7
    s_sleep 1
    s_branch SPN7
SPX7:
D_LOOP:
    ds_read_b128 v[80:83], v6 offset:0
    ds_read_b128 v[84:87], v6 offset:64
    ds_read_b128 v[88:91], v6 offset:128
    ds_read_b128 v[92:95], v6 offset:192
    ds_read_b128 v[96:99], v6 offset:256
    ds_read_b128 v[100:103], v6 offset:320
    ds_read_b128 v[104:107], v6 offset:384
    s_waitcnt lgkmcnt(6)
    v_mfma_f32_16x16x32_bf16 v[108:111], v[36:39], v[80:83], 0
    v_mfma_f32_16x16x32_bf16 v[112:115], v[68:71], v[80:83], 0
    ds_read_b128 v[76:79], v6 offset:448
    s_waitcnt lgkmcnt(6)
    v_mfma_f32_16x16x32_bf16 v[108:111], v[32:35], v[84:87], v[108:111]
    v_mfma_f32_16x16x32_bf16 v[112:115], v[64:67], v[84:87], v[112:115]
    ds_read_b128 v[80:83], v6 offset:512
    s_waitcnt lgkmcnt(6)
    v_mfma_f32_16x16x32_bf16 v[108:111], v[28:31], v[88:91], v[108:111]
    v_mfma_f32_16x16x32_bf16 v[112:115], v[60:63], v[88:91], v[112:115]
    ds_read_b128 v[84:87], v6 offset:576
    s_waitcnt lgkmcnt(6)
    v_mfma_f32_16x16x32_bf16 v[108:111], v[24:27], v[92:95], v[108:111]
    v_mfma_f32_16x16x32_bf16 v[112:115], v[56:59], v[92:95], v[112:115]
    ds_read_b128 v[88:91], v6 offset:640
    s_waitcnt lgkmcnt(6)
    v_mfma_f32_16x16x32_bf16 v[108:111], v[20:23], v[96:99], v[108:111]
    v_mfma_f32_16x16x32_bf16 v[112:115], v[52:55], v[96:99], v[112:115]
    ds_read_b128 v[92:95], v6 offset:704
    s_waitcnt lgkmcnt(6)
    v_mfma_f32_16x16x32_bf16 v[108:111], v[16:19], v[100:103], v[108:111]
    v_mfma_f32_16x16x32_bf16 v[112:115], v[48:51], v[100:103], v[112:115]
    ds_read_b128 v[96:99], v6 offset:768
    s_waitcnt lgkmcnt(6)
    v_mfma_f32_16x16x32_bf16 v[108:111], v[12:15], v[104:107], v[108:111]
    v_mfma_f32_16x16x32_bf16 v[112:115], v[44:47], v[104:107], v[112:115]
    ds_read_b128 v[100:103], v6 offset:832
    s_waitcnt lgkmcnt(6)
    v_mfma_f32_16x16x32_bf16 v[108:111], v[8:11], v[76:79], v[108:111]
    v_mfma_f32_16x16x32_bf16 v[112:115], v[40:43], v[76:79], v[112:115]
    v_mfma_f32_16x16x32_bf16 v[116:119], v[72:75], v[76:79], 0
    ds_read_b128 v[104:107], v6 offset:896
    s_waitcnt lgkmcnt(6)
    v_mfma_f32_16x16x32_bf16 v[112:115], v[36:39], v[80:83], v[112:115]
    v_mfma_f32_16x16x32_bf16 v[116:119], v[68:71], v[80:83], v[116:119]
    ds_read_b128 v[76:79], v6 offset:960
    s_waitcnt lgkmcnt(6)
    v_mfma_f32_16x16x32_bf16 v[112:115], v[32:35], v[84:87], v[112:115]
    v_mfma_f32_16x16x32_bf16 v[116:119], v[64:67], v[84:87], v[116:119]
    ds_read_b128 v[80:83], v6 offset:1024
    s_waitcnt lgkmcnt(6)
    v_mfma_f32_16x16x32_bf16 v[112:115], v[28:31], v[88:91], v[112:115]
    ds_write_b64 v124, v[108:109] offset:0
    v_mfma_f32_16x16x32_bf16 v[116:119], v[60:63], v[88:91], v[116:119]
    ds_read_b128 v[84:87], v6 offset:1088
    s_waitcnt lgkmcnt(7)
    v_mfma_f32_16x16x32_bf16 v[112:115], v[24:27], v[92:95], v[112:115]
    ds_write_b64 v124, v[110:111] offset:8
    v_mfma_f32_16x16x32_bf16 v[116:119], v[56:59], v[92:95], v[116:119]
    ds_read_b128 v[88:91], v6 offset:1152
    s_waitcnt lgkmcnt(8)
    v_mfma_f32_16x16x32_bf16 v[112:115], v[20:23], v[96:99], v[112:115]
    ds_write_b32 v125, v126 offset:0
    v_mfma_f32_16x16x32_bf16 v[116:119], v[52:55], v[96:99], v[116:119]
    ds_read_b128 v[92:95], v6 offset:1216
    s_waitcnt lgkmcnt(9)
    v_mfma_f32_16x16x32_bf16 v[112:115], v[16:19], v[100:103], v[112:115]
    v_mfma_f32_16x16x32_bf16 v[116:119], v[48:51], v[100:103], v[116:119]
    ds_read_b128 v[96:99], v6 offset:1280
    s_waitcnt lgkmcnt(9)
    v_mfma_f32_16x16x32_bf16 v[112:115], v[12:15], v[104:107], v[112:115]
    v_mfma_f32_16x16x32_bf16 v[116:119], v[44:47], v[104:107], v[116:119]
    ds_read_b128 v[100:103], v6 offset:1344
    s_waitcnt lgkmcnt(9)
    v_mfma_f32_16x16x32_bf16 v[112:115], v[8:11], v[76:79], v[112:115]
    v_mfma_f32_16x16x32_bf16 v[116:119], v[40:43], v[76:79], v[116:119]
    v_mfma_f32_16x16x32_bf16 v[120:123], v[72:75], v[76:79], 0
    ds_read_b128 v[104:107], v6 offset:1408
    s_waitcnt lgkmcnt(9)
    v_mfma_f32_16x16x32_bf16 v[116:119], v[36:39], v[80:83], v[116:119]
    v_mfma_f32_16x16x32_bf16 v[120:123], v[68:71], v[80:83], v[120:123]
    ds_read_b128 v[76:79], v6 offset:1472
    s_waitcnt lgkmcnt(8)
    v_mfma_f32_16x16x32_bf16 v[116:119], v[32:35], v[84:87], v[116:119]
    v_mfma_f32_16x16x32_bf16 v[120:123], v[64:67], v[84:87], v[120:123]
    ds_read_b128 v[80:83], v6 offset:1536
    s_waitcnt lgkmcnt(7)
    v_mfma_f32_16x16x32_bf16 v[116:119], v[28:31], v[88:91], v[116:119]
    ds_write_b64 v124, v[112:113] offset:1280
    v_mfma_f32_16x16x32_bf16 v[120:123], v[60:63], v[88:91], v[120:123]
    ds_read_b128 v[84:87], v6 offset:1600
    s_waitcnt lgkmcnt(7)
    v_mfma_f32_16x16x32_bf16 v[116:119], v[24:27], v[92:95], v[116:119]
    ds_write_b64 v124, v[114:115] offset:1288
    v_mfma_f32_16x16x32_bf16 v[120:123], v[56:59], v[92:95], v[120:123]
    ds_read_b128 v[88:91], v6 offset:1664
    s_waitcnt lgkmcnt(8)
    v_mfma_f32_16x16x32_bf16 v[116:119], v[20:23], v[96:99], v[116:119]
    ds_write_b32 v125, v126 offset:32
    v_mfma_f32_16x16x32_bf16 v[120:123], v[52:55], v[96:99], v[120:123]
    ds_read_b128 v[92:95], v6 offset:1728
    s_waitcnt lgkmcnt(9)
    v_mfma_f32_16x16x32_bf16 v[116:119], v[16:19], v[100:103], v[116:119]
    v_mfma_f32_16x16x32_bf16 v[120:123], v[48:51], v[100:103], v[120:123]
    ds_read_b128 v[96:99], v6 offset:1792
    s_waitcnt lgkmcnt(9)
    v_mfma_f32_16x16x32_bf16 v[116:119], v[12:15], v[104:107], v[116:119]
    v_mfma_f32_16x16x32_bf16 v[120:123], v[44:47], v[104:107], v[120:123]
    ds_read_b128 v[100:103], v6 offset:1856
    s_waitcnt lgkmcnt(9)
    v_mfma_f32_16x16x32_bf16 v[116:119], v[8:11], v[76:79], v[116:119]
    v_mfma_f32_16x16x32_bf16 v[120:123], v[40:43], v[76:79], v[120:123]
    v_mfma_f32_16x16x32_bf16 v[108:111], v[72:75], v[76:79], 0
    ds_read_b128 v[104:107], v6 offset:1920
    s_waitcnt lgkmcnt(9)
    v_mfma_f32_16x16x32_bf16 v[120:123], v[36:39], v[80:83], v[120:123]
    v_mfma_f32_16x16x32_bf16 v[108:111], v[68:71], v[80:83], v[108:111]
    ds_read_b128 v[76:79], v6 offset:1984
    s_waitcnt lgkmcnt(8)
    v_mfma_f32_16x16x32_bf16 v[120:123], v[32:35], v[84:87], v[120:123]
    v_mfma_f32_16x16x32_bf16 v[108:111], v[64:67], v[84:87], v[108:111]
    s_waitcnt lgkmcnt(6)
    v_mfma_f32_16x16x32_bf16 v[120:123], v[28:31], v[88:91], v[120:123]
    ds_write_b64 v124, v[116:117] offset:2560
    v_mfma_f32_16x16x32_bf16 v[108:111], v[60:63], v[88:91], v[108:111]
    s_waitcnt lgkmcnt(5)
    v_mfma_f32_16x16x32_bf16 v[120:123], v[24:27], v[92:95], v[120:123]
    ds_write_b64 v124, v[118:119] offset:2568
    v_mfma_f32_16x16x32_bf16 v[108:111], v[56:59], v[92:95], v[108:111]
    s_waitcnt lgkmcnt(5)
    v_mfma_f32_16x16x32_bf16 v[120:123], v[20:23], v[96:99], v[120:123]
    ds_write_b32 v125, v126 offset:64
    v_mfma_f32_16x16x32_bf16 v[108:111], v[52:55], v[96:99], v[108:111]
    s_waitcnt lgkmcnt(5)
    v_mfma_f32_16x16x32_bf16 v[120:123], v[16:19], v[100:103], v[120:123]
    v_mfma_f32_16x16x32_bf16 v[108:111], v[48:51], v[100:103], v[108:111]
    s_waitcnt lgkmcnt(4)
    v_mfma_f32_16x16x32_bf16 v[120:123], v[12:15], v[104:107], v[120:123]
    v_mfma_f32_16x16x32_bf16 v[108:111], v[44:47], v[104:107], v[108:111]
    s_waitcnt lgkmcnt(3)
    v_mfma_f32_16x16x32_bf16 v[120:123], v[8:11], v[76:79], v[120:123]
    v_mfma_f32_16x16x32_bf16 v[108:111], v[40:43], v[76:79], v[108:111]
    v_mfma_f32_16x16x32_bf16 v[112:115], v[72:75], v[76:79], 0
    s_nop 7
    ds_write_b64 v124, v[120:121] offset:3840
    ds_write_b64 v124, v[122:123] offset:3848
    ds_write_b32 v125, v126 offset:96
    s_mov_b32 s9, 0
SPN8:
    ds_read_b32 v128, v127 offset:240
    s_add_u32 s9, s9, 1
    s_waitcnt lgkmcnt(0)
    v_cmp_ne_u32 vcc, 34, v128
    s_cmp_ge_u32 s9, 0x40000
    s_cbranch_scc1 SPX8
    s_cbranch_vccz SPX8
    s_sleep 1
    s_branch SPN8
SPX8:
    ds_read_b128 v[80:83], v6 offset:2048
    ds_read_b128 v[84:87], v6 offset:2112
    ds_read_b128 v[88:91], v6 offset:2176
    ds_read_b128 v[92:95], v6 offset:2240
    ds_read_b128 v[96:99], v6 offset:2304
    ds_read_b128 v[100:103], v6 offset:2368
    ds_read_b128 v[104:107], v6 offset:2432
    s_waitcnt lgkmcnt(6)
    v_mfma_f32_16x16x32_bf16 v[108:111], v[36:39], v[80:83], v[108:111]
    v_mfma_f32_16x16x32_bf16 v[112:115], v[68:71], v[80:83], v[112:115]
    ds_read_b128 v[76:79], v6 offset:2496
    s_waitcnt lgkmcnt(6)
    v_mfma_f32_16x16x32_bf16 v[108:111], v[32:35], v[84:87], v[108:111]
    v_mfma_f32_16x16x32_bf16 v[112:115], v[64:67], v[84:87], v[112:115]
    ds_read_b128 v[80:83], v6 offset:2560
    s_waitcnt lgkmcnt(6)
    v_mfma_f32_16x16x32_bf16 v[108:111], v[28:31], v[88:91], v[108:111]
    v_mfma_f32_16x16x32_bf16 v[112:115], v[60:63], v[88:91], v[112:115]
    ds_read_b128 v[84:87], v6 offset:2624
    s_waitcnt lgkmcnt(6)
    v_mfma_f32_16x16x32_bf16 v[108:111], v[24:27], v[92:95], v[108:111]
    v_mfma_f32_16x16x32_bf16 v[112:115], v[56:59], v[92:95], v[112:115]
    ds_read_b128 v[88:91], v6 offset:2688
    s_waitcnt lgkmcnt(6)
    v_mfma_f32_16x16x32_bf16 v[108:111], v[20:23], v[96:99], v[108:111]
    v_mfma_f32_16x16x32_bf16 v[112:115], v[52:55], v[96:99], v[112:115]
    ds_read_b128 v[92:95], v6 offset:2752
    s_waitcnt lgkmcnt(6)
    v_mfma_f32_16x16x32_bf16 v[108:111], v[16:19], v[100:103], v[108:111]
    v_mfma_f32_16x16x32_bf16 v[112:115], v[48:51], v[100:103], v[112:115]
    ds_read_b128 v[96:99], v6 offset:2816
    s_waitcnt lgkmcnt(6)
    v_mfma_f32_16x16x32_bf16 v[108:111], v[12:15], v[104:107], v[108:111]
    v_mfma_f32_16x16x32_bf16 v[112:115], v[44:47], v[104:107], v[112:115]
    ds_read_b128 v[100:103], v6 offset:2880
    s_waitcnt lgkmcnt(6)
    v_mfma_f32_16x16x32_bf16 v[108:111], v[8:11], v[76:79], v[108:111]
    v_mfma_f32_16x16x32_bf16 v[112:115], v[40:43], v[76:79], v[112:115]
    v_mfma_f32_16x16x32_bf16 v[116:119], v[72:75], v[76:79], 0
    ds_read_b128 v[104:107], v6 offset:2944
    s_waitcnt lgkmcnt(6)
    v_mfma_f32_16x16x32_bf16 v[112:115], v[36:39], v[80:83], v[112:115]
    v_mfma_f32_16x16x32_bf16 v[116:119], v[68:71], v[80:83], v[116:119]
    ds_read_b128 v[76:79], v6 offset:3008
    s_waitcnt lgkmcnt(6)
    v_mfma_f32_16x16x32_bf16 v[112:115], v[32:35], v[84:87], v[112:115]
    v_mfma_f32_16x16x32_bf16 v[116:119], v[64:67], v[84:87], v[116:119]
    ds_read_b128 v[80:83], v6 offset:3072
    s_waitcnt lgkmcnt(6)
    v_mfma_f32_16x16x32_bf16 v[112:115], v[28:31], v[88:91], v[112:115]
    ds_write_b64 v124, v[108:109] offset:5120
    v_mfma_f32_16x16x32_bf16 v[116:119], v[60:63], v[88:91], v[116:119]
    ds_read_b128 v[84:87], v6 offset:3136
    s_waitcnt lgkmcnt(7)
    v_mfma_f32_16x16x32_bf16 v[112:115], v[24:27], v[92:95], v[112:115]
    ds_write_b64 v124, v[110:111] offset:5128
    v_mfma_f32_16x16x32_bf16 v[116:119], v[56:59], v[92:95], v[116:119]
    ds_read_b128 v[88:91], v6 offset:3200
    s_waitcnt lgkmcnt(8)
    v_mfma_f32_16x16x32_bf16 v[112:115], v[20:23], v[96:99], v[112:115]
    ds_write_b32 v125, v126 offset:128
    v_mfma_f32_16x16x32_bf16 v[116:119], v[52:55], v[96:99], v[116:119]
    ds_read_b128 v[92:95], v6 offset:3264
    s_waitcnt lgkmcnt(9)
    v_mfma_f32_16x16x32_bf16 v[112:115], v[16:19], v[100:103], v[112:115]
    v_mfma_f32_16x16x32_bf16 v[116:119], v[48:51], v[100:103], v[116:119]
    ds_read_b128 v[96:99], v6 offset:3328
    s_waitcnt lgkmcnt(9)
    v_mfma_f32_16x16x32_bf16 v[112:115], v[12:15], v[104:107], v[112:115]
    v_mfma_f32_16x16x32_bf16 v[116:119], v[44:47], v[104:107], v[116:119]
    ds_read_b128 v[100:103], v6 offset:3392
    s_waitcnt lgkmcnt(9)
    v_mfma_f32_16x16x32_bf16 v[112:115], v[8:11], v[76:79], v[112:115]
    v_mfma_f32_16x16x32_bf16 v[116:119], v[40:43], v[76:79], v[116:119]
    v_mfma_f32_16x16x32_bf16 v[120:123], v[72:75], v[76:79], 0
    ds_read_b128 v[104:107], v6 offset:3456
    s_waitcnt lgkmcnt(9)
    v_mfma_f32_16x16x32_bf16 v[116:119], v[36:39], v[80:83], v[116:119]
    v_mfma_f32_16x16x32_bf16 v[120:123], v[68:71], v[80:83], v[120:123]
    ds_read_b128 v[76:79], v6 offset:3520
    s_waitcnt lgkmcnt(8)
    v_mfma_f32_16x16x32_bf16 v[116:119], v[32:35], v[84:87], v[116:119]
    v_mfma_f32_16x16x32_bf16 v[120:123], v[64:67], v[84:87], v[120:123]
    ds_read_b128 v[80:83], v6 offset:3584
    s_waitcnt lgkmcnt(7)
    v_mfma_f32_16x16x32_bf16 v[116:119], v[28:31], v[88:91], v[116:119]
    ds_write_b64 v124, v[112:113] offset:6400
    v_mfma_f32_16x16x32_bf16 v[120:123], v[60:63], v[88:91], v[120:123]
    ds_read_b128 v[84:87], v6 offset:3648
    s_waitcnt lgkmcnt(7)
    v_mfma_f32_16x16x32_bf16 v[116:119], v[24:27], v[92:95], v[116:119]
    ds_write_b64 v124, v[114:115] offset:6408
    v_mfma_f32_16x16x32_bf16 v[120:123], v[56:59], v[92:95], v[120:123]
    ds_read_b128 v[88:91], v6 offset:3712
    s_waitcnt lgkmcnt(8)
    v_mfma_f32_16x16x32_bf16 v[116:119], v[20:23], v[96:99], v[116:119]
    ds_write_b32 v125, v126 offset:160
    v_mfma_f32_16x16x32_bf16 v[120:123], v[52:55], v[96:99], v[120:123]
    ds_read_b128 v[92:95], v6 offset:3776
    s_waitcnt lgkmcnt(9)
    v_mfma_f32_16x16x32_bf16 v[116:119], v[16:19], v[100:103], v[116:119]
    v_mfma_f32_16x16x32_bf16 v[120:123], v[48:51], v[100:103], v[120:123]
    ds_read_b128 v[96:99], v6 offset:3840
    s_waitcnt lgkmcnt(9)
    v_mfma_f32_16x16x32_bf16 v[116:119], v[12:15], v[104:107], v[116:119]
    v_mfma_f32_16x16x32_bf16 v[120:123], v[44:47], v[104:107], v[120:123]
    ds_read_b128 v[100:103], v6 offset:3904
    s_waitcnt lgkmcnt(9)
    v_mfma_f32_16x16x32_bf16 v[116:119], v[8:11], v[76:79], v[116:119]
    v_mfma_f32_16x16x32_bf16 v[120:123], v[40:43], v[76:79], v[120:123]
    ds_read_b128 v[104:107], v6 offset:3968
    s_waitcnt lgkmcnt(9)
    v_mfma_f32_16x16x32_bf16 v[120:123], v[36:39], v[80:83], v[120:123]
    ds_read_b128 v[76:79], v6 offset:4032
    s_waitcnt lgkmcnt(8)
    v_mfma_f32_16x16x32_bf16 v[120:123], v[32:35], v[84:87], v[120:123]
    s_waitcnt lgkmcnt(6)
    v_mfma_f32_16x16x32_bf16 v[120:123], v[28:31], v[88:91], v[120:123]
    s_waitcnt lgkmcnt(4)
    v_mfma_f32_16x16x32_bf16 v[120:123], v[24:27], v[92:95], v[120:123]
    s_waitcnt lgkmcnt(3)
    v_mfma_f32_16x16x32_bf16 v[120:123], v[20:23], v[96:99], v[120:123]
    ds_write_b64 v124, v[116:117] offset:7680
    s_waitcnt lgkmcnt(3)
    v_mfma_f32_16x16x32_bf16 v[120:123], v[16:19], v[100:103], v[120:123]
    ds_write_b64 v124, v[118:119] offset:7688
    s_waitcnt lgkmcnt(3)
    v_mfma_f32_16x16x32_bf16 v[120:123], v[12:15], v[104:107], v[120:123]
    ds_write_b32 v125, v126 offset:192
    s_waitcnt lgkmcnt(3)
    v_mfma_f32_16x16x32_bf16 v[120:123], v[8:11], v[76:79], v[120:123]
    s_nop 7
    ds_write_b64 v124, v[120:121] offset:8960
    ds_write_b64 v124, v[122:123] offset:8968
    ds_write_b32 v125, v126 offset:224
    s_waitcnt lgkmcnt(0)
    s_endpgm
CK_T1:
    ds_read_b128 v[8:11], v128 offset:43296
    ds_read_b128 v[40:43], v128 offset:16896
    ds_read_b128 v[12:15], v128 offset:43360
    ds_read_b128 v[44:47], v128 offset:16960
    ds_read_b128 v[16:19], v128 offset:43424
    ds_read_b128 v[48:51], v128 offset:17024
    ds_read_b128 v[20:23], v128 offset:43488
    ds_read_b128 v[52:55], v128 offset:17088
    ds_read_b128 v[24:27], v128 offset:43552
    ds_read_b128 v[56:59], v128 offset:17152
    ds_read_b128 v[28:31], v128 offset:43616
    ds_read_b128 v[60:63], v128 offset:17216
    ds_read_b128 v[32:35], v128 offset:43680
    ds_read_b128 v[64:67], v128 offset:17280
    ds_read_b128 v[36:39], v128 offset:43744
    ds_read_b128 v[68:71], v128 offset:17344
    v_lshlrev_b32 v114, 8, v4
    v_lshl_add_u32 v114, v3, 4, v114
    v_add_u32 v114, s13, v114
    v_lshlrev_b32 v115, 7, v4
    v_lshl_add_u32 v115, v3, 2, v115
    v_add_u32 v115, s13, v115
    s_waitcnt lgkmcnt(14)
    v_mfma_f32_16x16x32_f16 v[104:107], v[40:43], v[8:11], 0
    s_waitcnt lgkmcnt(12)
    v_mfma_f32_16x16x32_f16 v[104:107], v[44:47], v[12:15], v[104:107]
    s_waitcnt lgkmcnt(10)
    v_mfma_f32_16x16x32_f16 v[104:107], v[48:51], v[16:19], v[104:107]
    s_waitcnt lgkmcnt(8)
    v_mfma_f32_16x16x32_f16 v[104:107], v[52:55], v[20:23], v[104:107]
    s_waitcnt lgkmcnt(6)
    v_mfma_f32_16x16x32_f16 v[104:107], v[56:59], v[24:27], v[104:107]
    s_waitcnt lgkmcnt(4)
    v_mfma_f32_16x16x32_f16 v[104:107], v[60:63], v[28:31], v[104:107]
    s_waitcnt lgkmcnt(2)
    v_mfma_f32_16x16x32_f16 v[104:107], v[64:67], v[32:35], v[104:107]
    s_waitcnt lgkmcnt(0)
    v_mfma_f32_16x16x32_f16 v[104:107], v[68:71], v[36:39], v[104:107]
    s_nop 7
    v_mul_f32 v104, s15, v104
    v_mul_f32 v105, s15, v105
    v_mul_f32 v106, s15, v106
    v_mul_f32 v107, s15, v107
    v_cvt_pk_bf16_f32 v116, v104, v105
    v_cvt_pk_bf16_f32 v117, v105, v105
    v_cvt_pk_bf16_f32 v118, v106, v107
    v_cvt_pk_bf16_f32 v119, v107, v107
    v_cvt_pk_bf16_f32 v120, v105, v106
    s_mov_b32 exec_hi, 0
    ds_write_b16 v114, v119 offset:560
    v_add_u32 v121, 1728, v114
    ds_write_b128 v114, v[116:119] offset:544
    ds_write2_b32 v121, v119, v119 offset0:11 offset1:12
    ds_write2_b32 v121, v117, v120 offset0:9 offset1:10
    ds_write_b16 v121, v116 offset:34
    s_not_b64 exec, exec
    ds_write_b32 v115, v116 offset:2208
    ds_write_b32 v115, v118 offset:2272
    s_mov_b64 exec, -1
    v_mov_b32 v167, 153600
    v_mov_b32 v166, 1
    s_lshl_b32 s8, s7, 2
    v_add_u32 v131, s8, v167
    s_mov_b64 exec, 1
    ds_add_u32 v131, v166 offset:80
    ds_add_u32 v167, v166 offset:76
    s_mov_b64 exec, -1
    v_mul_u32_u24 v164, 320, v4
    v_lshl_add_u32 v164, v3, 4, v164
    s_mul_i32 s8, s7, 20480
    v_add_u32 v164, s8, v164
    s_lshl_b32 s8, s3, 2
    s_add_u32 s8, s8, 153856
    v_mov_b32 v165, s8
    v_lshlrev_b32 v5, 2, v4
    v_sub_u32 v5, v3, v5
    v_lshl_add_u32 v7, v5, 2, s13
    v_lshl_add_u32 v5, v5, 3, s13
    v_add_u32 v7, 2848, v7
    v_mov_b32 v6, s13
    s_mov_b32 s9, 0
SPN9:
    ds_read_b32 v128, v131 offset:80
    s_add_u32 s9, s9, 1
    s_waitcnt lgkmcnt(0)
    v_cmp_ne_u32 vcc, 2, v128
    s_cmp_ge_u32 s9, 0x40000
    s_cbranch_scc1 SPX9
    s_cbranch_vccz SPX9
    s_sleep 1
    s_branch SPN9
SPX9:
    ds_read_b32 v130, v6 offset:2716
    ds_read_b64 v[8:9], v5 offset:2464
    ds_read_b64 v[10:11], v5 offset:2456
    ds_read_b64 v[12:13], v5 offset:2448
    ds_read_b64 v[14:15], v5 offset:2440
    ds_read_b64 v[16:17], v5 offset:2592
    ds_read_b64 v[18:19], v5 offset:2584
    ds_read_b64 v[20:21], v5 offset:2576
    ds_read_b64 v[22:23], v5 offset:2568
    ds_read_b64 v[24:25], v5 offset:2720
    ds_read_b64 v[26:27], v5 offset:2712
    ds_read_b64 v[28:29], v5 offset:2704
    ds_read_b64 v[30:31], v5 offset:2696
    ds_read2_b32 v[32:33], v7 offset0:16 offset1:15
    ds_read2_b32 v[34:35], v7 offset0:14 offset1:13
    ds_read2_b32 v[36:37], v7 offset0:32 offset1:31
    ds_read2_b32 v[38:39], v7 offset0:30 offset1:29
    ds_read2_b32 v[40:41], v7 offset0:48 offset1:47
    ds_read2_b32 v[42:43], v7 offset0:46 offset1:45
    ds_read2_b32 v[44:45], v7 offset0:64 offset1:63
    ds_read2_b32 v[46:47], v7 offset0:62 offset1:61
    v_lshlrev_b32 v6, 4, v4
    v_lshl_add_u32 v6, v3, 5, v6
    v_add_u32 v6, 4048, v6
    v_add_u32 v6, s13, v6
    v_lshlrev_b32 v5, 4, v2
    v_add_u32 v5, 154112, v5
    s_mov_b32 s9, 0
SPN10:
    ds_read_b32 v128, v167 offset:76
    s_add_u32 s9, s9, 1
    s_waitcnt lgkmcnt(0)
    v_cmp_ne_u32 vcc, 12, v128
    s_cmp_ge_u32 s9, 0x40000
    s_cbranch_scc1 SPX10
    s_cbranch_vccz SPX10
    s_sleep 1
    s_branch SPN10
SPX10:
    ds_read_b128 v[140:143], v5 offset:0
    ds_read_b128 v[144:147], v5 offset:1024
    ds_read_b128 v[148:151], v5 offset:2048
    ds_read_b128 v[152:155], v5 offset:3072
    ds_read_b128 v[156:159], v5 offset:4096
Z_PASS:
    ds_write_b128 v164, v[124:127] offset:10240
    ds_write_b32 v165, v166 offset:0
    ds_write_b128 v164, v[124:127] offset:11520
    ds_write_b32 v165, v166 offset:32
    s_mov_b32 s8, 0x07060706
    s_mov_b32 s9, 0
SPN11:
    ds_read_b32 v128, v167 offset:240
    s_add_u32 s9, s9, 1
    s_waitcnt lgkmcnt(0)
    v_and_b32 v128, 15, v128
    v_cmp_ne_u32 vcc, 2, v128
    s_cmp_ge_u32 s9, 0x40000
    s_cbranch_scc1 SPX11
    s_cbranch_vccz SPX11
    s_sleep 1
    s_branch SPN11
SPX11:
    v_perm_b32 v130, v130, v130, s8
Z_LOOP:
    ds_read_b128 v[48:51], v6 offset:16
    ds_read_b128 v[52:55], v6 offset:0
    ds_read_b128 v[56:59], v6 offset:528
    ds_read_b128 v[60:63], v6 offset:512
    v_and_b32 v156, v130, v156
    v_and_b32 v157, v130, v157
    v_and_b32 v158, v130, v158
    v_and_b32 v159, v130, v159
    s_waitcnt lgkmcnt(2)
    v_mfma_f32_16x16x32_bf16 v[64:67], v[48:51], v[140:143], 0
    v_mfma_f32_16x16x32_bf16 v[68:71], v[48:51], v[144:147], 0
    v_mfma_f32_16x16x32_bf16 v[72:75], v[52:55], v[140:143], 0
    v_mfma_f32_16x16x32_bf16 v[76:79], v[52:55], v[144:147], 0
    v_mfma_f32_16x16x32_bf16 v[80:83], v[48:51], v[148:151], 0
    v_mfma_f32_16x16x32_bf16 v[84:87], v[52:55], v[152:155], 0
    s_nop 3
    v_cvt_pk_bf16_f32 v88, v64, v68
    v_cvt_pk_bf16_f32 v90, v65, v69
    v_cvt_pk_bf16_f32 v92, v66, v70
    v_cvt_pk_bf16_f32 v94, v67, v71
    v_cvt_pk_bf16_f32 v89, v72, v76
    v_cvt_pk_bf16_f32 v91, v73, v77
    v_cvt_pk_bf16_f32 v93, v74, v78
    v_cvt_pk_bf16_f32 v95, v75, v79
    v_cvt_pk_bf16_f32 v96, v80, v84
    v_cvt_pk_bf16_f32 v97, v81, v85
    v_cvt_pk_bf16_f32 v98, v82, v86
    v_cvt_pk_bf16_f32 v99, v83, v87
    s_waitcnt lgkmcnt(0)
    v_mfma_f32_16x16x32_bf16 v[64:67], v[56:59], v[140:143], 0
    v_mfma_f32_16x16x32_bf16 v[68:71], v[56:59], v[144:147], 0
    v_mfma_f32_16x16x32_bf16 v[72:75], v[60:63], v[140:143], 0
    v_mfma_f32_16x16x32_bf16 v[76:79], v[60:63], v[144:147], 0
    v_mfma_f32_16x16x32_bf16 v[80:83], v[56:59], v[148:151], 0
    v_mfma_f32_16x16x32_bf16 v[84:87], v[60:63], v[152:155], 0
    v_mfma_f32_16x16x32_bf16 v[108:111], v[156:159], v[48:51], 0
    ds_read_b128 v[48:51], v6 offset:1040
    ds_read_b128 v[52:55], v6 offset:1024
    v_mfma_f32_16x16x32_bf16 v[100:103], v[88:91], v[8:11], 0
    v_mfma_f32_16x16x32_bf16 v[100:103], v[92:95], v[12:15], v[100:103]
    v_cvt_pk_bf16_f32 v132, v64, v68
    v_cvt_pk_bf16_f32 v134, v65, v69
    v_mfma_f32_16x16x32_bf16 v[104:107], v[88:91], v[16:19], 0
    v_cvt_pk_bf16_f32 v136, v66, v70
    v_cvt_pk_bf16_f32 v138, v67, v71
    v_mfma_f32_16x16x32_bf16 v[104:107], v[92:95], v[20:23], v[104:107]
    v_cvt_pk_bf16_f32 v133, v72, v76
    v_cvt_pk_bf16_f32 v135, v73, v77
    v_mfma_f32_16x16x32_bf16 v[108:111], v[88:91], v[24:27], v[108:111]
    v_cvt_pk_bf16_f32 v137, v74, v78
    v_cvt_pk_bf16_f32 v139, v75, v79
    v_mfma_f32_16x16x32_bf16 v[108:111], v[92:95], v[28:31], v[108:111]
    v_cvt_pk_bf16_f32 v160, v80, v84
    v_cvt_pk_bf16_f32 v161, v81, v85
    v_mfma_f32_16x16x32_bf16 v[108:111], v[96:99], v[32:35], v[108:111]
    v_cvt_pk_bf16_f32 v162, v82, v86
    v_cvt_pk_bf16_f32 v163, v83, v87
    v_mfma_f32_16x16x32_bf16 v[112:115], v[96:99], v[36:39], 0
    v_mfma_f32_16x16x32_bf16 v[116:119], v[96:99], v[40:43], 0
    v_mfma_f32_16x16x32_bf16 v[120:123], v[96:99], v[44:47], 0
    s_waitcnt lgkmcnt(0)
    v_mfma_f32_16x16x32_bf16 v[64:67], v[48:51], v[140:143], 0
    v_mfma_f32_16x16x32_bf16 v[68:71], v[48:51], v[144:147], 0
    ds_write_b64 v164, v[100:101] offset:12800
    v_mfma_f32_16x16x32_bf16 v[72:75], v[52:55], v[140:143], 0
    ds_write_b64 v164, v[102:103] offset:12808
    v_mfma_f32_16x16x32_bf16 v[76:79], v[52:55], v[144:147], 0
    ds_write_b32 v165, v166 offset:64
    v_mfma_f32_16x16x32_bf16 v[80:83], v[48:51], v[148:151], 0
    v_mfma_f32_16x16x32_bf16 v[84:87], v[52:55], v[152:155], 0
    v_mfma_f32_16x16x32_bf16 v[112:115], v[156:159], v[56:59], v[112:115]
    ds_read_b128 v[56:59], v6 offset:1552
    ds_read_b128 v[60:63], v6 offset:1536
    v_mfma_f32_16x16x32_bf16 v[104:107], v[132:135], v[8:11], v[104:107]
    v_mfma_f32_16x16x32_bf16 v[104:107], v[136:139], v[12:15], v[104:107]
    v_cvt_pk_bf16_f32 v88, v64, v68
    v_cvt_pk_bf16_f32 v90, v65, v69
    v_mfma_f32_16x16x32_bf16 v[108:111], v[132:135], v[16:19], v[108:111]
    v_cvt_pk_bf16_f32 v92, v66, v70
    v_cvt_pk_bf16_f32 v94, v67, v71
    v_mfma_f32_16x16x32_bf16 v[108:111], v[136:139], v[20:23], v[108:111]
    v_cvt_pk_bf16_f32 v89, v72, v76
    v_cvt_pk_bf16_f32 v91, v73, v77
    v_mfma_f32_16x16x32_bf16 v[112:115], v[132:135], v[24:27], v[112:115]
    v_cvt_pk_bf16_f32 v93, v74, v78
    v_cvt_pk_bf16_f32 v95, v75, v79
    v_mfma_f32_16x16x32_bf16 v[112:115], v[136:139], v[28:31], v[112:115]
    v_cvt_pk_bf16_f32 v96, v80, v84
    v_cvt_pk_bf16_f32 v97, v81, v85
    v_mfma_f32_16x16x32_bf16 v[112:115], v[160:163], v[32:35], v[112:115]
    v_cvt_pk_bf16_f32 v98, v82, v86
    v_cvt_pk_bf16_f32 v99, v83, v87
    v_mfma_f32_16x16x32_bf16 v[116:119], v[160:163], v[36:39], v[116:119]
    v_mfma_f32_16x16x32_bf16 v[120:123], v[160:163], v[40:43], v[120:123]
    s_waitcnt lgkmcnt(0)
    v_mfma_f32_16x16x32_bf16 v[64:67], v[56:59], v[140:143], 0
    v_mfma_f32_16x16x32_bf16 v[68:71], v[56:59], v[144:147], 0
    ds_write_b64 v164, v[104:105] offset:14080
    v_mfma_f32_16x16x32_bf16 v[72:75], v[60:63], v[140:143], 0
    ds_write_b64 v164, v[106:107] offset:14088
    v_mfma_f32_16x16x32_bf16 v[76:79], v[60:63], v[144:147], 0
    ds_write_b32 v165, v166 offset:96
    v_mfma_f32_16x16x32_bf16 v[80:83], v[56:59], v[148:151], 0
    v_mfma_f32_16x16x32_bf16 v[84:87], v[60:63], v[152:155], 0
    v_mfma_f32_16x16x32_bf16 v[116:119], v[156:159], v[48:51], v[116:119]
    v_mfma_f32_16x16x32_bf16 v[108:111], v[88:91], v[8:11], v[108:111]
    v_mfma_f32_16x16x32_bf16 v[108:111], v[92:95], v[12:15], v[108:111]
    v_mfma_f32_16x16x32_bf16 v[112:115], v[88:91], v[16:19], v[112:115]
    v_cvt_pk_bf16_f32 v132, v64, v68
    v_cvt_pk_bf16_f32 v134, v65, v69
    v_mfma_f32_16x16x32_bf16 v[112:115], v[92:95], v[20:23], v[112:115]
    v_cvt_pk_bf16_f32 v136, v66, v70
    v_cvt_pk_bf16_f32 v138, v67, v71
    v_mfma_f32_16x16x32_bf16 v[116:119], v[88:91], v[24:27], v[116:119]
    v_cvt_pk_bf16_f32 v133, v72, v76
    v_cvt_pk_bf16_f32 v135, v73, v77
    v_mfma_f32_16x16x32_bf16 v[116:119], v[92:95], v[28:31], v[116:119]
    v_cvt_pk_bf16_f32 v137, v74, v78
    v_cvt_pk_bf16_f32 v139, v75, v79
    v_mfma_f32_16x16x32_bf16 v[116:119], v[96:99], v[32:35], v[116:119]
    v_cvt_pk_bf16_f32 v160, v80, v84
    v_cvt_pk_bf16_f32 v161, v81, v85
    v_mfma_f32_16x16x32_bf16 v[120:123], v[96:99], v[36:39], v[120:123]
    v_cvt_pk_bf16_f32 v162, v82, v86
    v_cvt_pk_bf16_f32 v163, v83, v87
    s_nop 1
    v_mfma_f32_16x16x32_bf16 v[120:123], v[156:159], v[56:59], v[120:123]
    ds_write_b64 v164, v[108:109] offset:15360
    v_mfma_f32_16x16x32_bf16 v[112:115], v[132:135], v[8:11], v[112:115]
    ds_write_b64 v164, v[110:111] offset:15368
    v_mfma_f32_16x16x32_bf16 v[112:115], v[136:139], v[12:15], v[112:115]
    ds_write_b32 v165, v166 offset:128
    v_mfma_f32_16x16x32_bf16 v[116:119], v[132:135], v[16:19], v[116:119]
    v_mfma_f32_16x16x32_bf16 v[116:119], v[136:139], v[20:23], v[116:119]
    v_mfma_f32_16x16x32_bf16 v[120:123], v[132:135], v[24:27], v[120:123]
    v_mfma_f32_16x16x32_bf16 v[120:123], v[136:139], v[28:31], v[120:123]
    v_mfma_f32_16x16x32_bf16 v[120:123], v[160:163], v[32:35], v[120:123]
    s_mov_b32 s9, 0
SPN12:
    ds_read_b32 v128, v167 offset:240
    s_add_u32 s9, s9, 1
    s_waitcnt lgkmcnt(0)
    v_cmp_ne_u32 vcc, 34, v128
    s_cmp_ge_u32 s9, 0x40000
    s_cbranch_scc1 SPX12
    s_cbranch_vccz SPX12
    s_sleep 1
    s_branch SPN12
SPX12:
    s_cmp_lg_u32 s3, 4
    s_cbranch_scc1 Z_NOSEL
    v_and_b32 v126, 4, v2
    v_add_u32 v126, v126, v4
    s_lshl_b32 s9, s4, 8
    v_lshl_add_u32 v126, v126, 3, s9
    global_load_dwordx2 v[124:125], v126, s[50:51] offset:256 sc1
    s_lshl_b32 s9, s4, 7
    v_mov_b32 v126, s9
    global_load_dword v127, v126, s[50:51] offset:2304 sc1
Z_NOSEL:
    ds_read_b128 v[48:51], v6 offset:2064
    ds_read_b128 v[52:55], v6 offset:2048
    ds_read_b128 v[56:59], v6 offset:2576
    ds_read_b128 v[60:63], v6 offset:2560
    ds_write_b64 v164, v[112:113] offset:16640
    ds_write_b64 v164, v[114:115] offset:16648
    ds_write_b32 v165, v166 offset:160
    s_waitcnt lgkmcnt(5)
    v_mfma_f32_16x16x32_bf16 v[64:67], v[48:51], v[140:143], 0
    v_mfma_f32_16x16x32_bf16 v[68:71], v[48:51], v[144:147], 0
    v_mfma_f32_16x16x32_bf16 v[72:75], v[52:55], v[140:143], 0
    v_mfma_f32_16x16x32_bf16 v[76:79], v[52:55], v[144:147], 0
    s_nop 5
    v_cvt_pk_bf16_f32 v88, v64, v68
    v_cvt_pk_bf16_f32 v90, v65, v69
    v_cvt_pk_bf16_f32 v92, v66, v70
    v_cvt_pk_bf16_f32 v94, v67, v71
    v_cvt_pk_bf16_f32 v89, v72, v76
    v_cvt_pk_bf16_f32 v91, v73, v77
    v_cvt_pk_bf16_f32 v93, v74, v78
    v_cvt_pk_bf16_f32 v95, v75, v79
    s_waitcnt lgkmcnt(3)
    v_mfma_f32_16x16x32_bf16 v[64:67], v[56:59], v[140:143], 0
    v_mfma_f32_16x16x32_bf16 v[68:71], v[56:59], v[144:147], 0
    v_mfma_f32_16x16x32_bf16 v[72:75], v[60:63], v[140:143], 0
    v_mfma_f32_16x16x32_bf16 v[76:79], v[60:63], v[144:147], 0
    v_mfma_f32_16x16x32_bf16 v[116:119], v[88:91], v[8:11], v[116:119]
    v_mfma_f32_16x16x32_bf16 v[116:119], v[92:95], v[12:15], v[116:119]
    v_mfma_f32_16x16x32_bf16 v[120:123], v[88:91], v[16:19], v[120:123]
    v_mfma_f32_16x16x32_bf16 v[120:123], v[92:95], v[20:23], v[120:123]
    s_nop 1
    v_cvt_pk_bf16_f32 v132, v64, v68
    v_cvt_pk_bf16_f32 v134, v65, v69
    v_cvt_pk_bf16_f32 v136, v66, v70
    v_cvt_pk_bf16_f32 v138, v67, v71
    v_cvt_pk_bf16_f32 v133, v72, v76
    v_cvt_pk_bf16_f32 v135, v73, v77
    v_cvt_pk_bf16_f32 v137, v74, v78
    v_cvt_pk_bf16_f32 v139, v75, v79
    ds_write_b64 v164, v[116:117] offset:17920
    ds_write_b64 v164, v[118:119] offset:17928
    v_mfma_f32_16x16x32_bf16 v[120:123], v[132:135], v[8:11], v[120:123]
    v_mfma_f32_16x16x32_bf16 v[120:123], v[136:139], v[12:15], v[120:123]
    ds_write_b32 v165, v166 offset:192
    s_nop 6
    ds_write_b64 v164, v[120:121] offset:19200
    ds_write_b64 v164, v[122:123] offset:19208
    ds_write_b32 v165, v166 offset:224
    s_setprio 0
    s_cmp_eq_u32 s3, 4
    s_cbranch_scc1 FINAL
    s_waitcnt lgkmcnt(0)
    s_endpgm
CU_C3A:
    s_cmp_eq_u32 s4, 3
    s_cselect_b32 s8, 18, 6
    s_cmp_ge_u32 s101, s8
    s_cbranch_scc1 CU_C3B
    s_sub_u32 s14, 3, s4
    s_and_b32 s14, s14, 7
    s_and_b32 s8, s101, 1
    s_lshl_b32 s8, s8, 3
    s_lshr_b32 s9, s101, 1
    s_cmp_eq_u32 s4, 3
    s_cselect_b32 s14, s8, s14
    s_cselect_b32 s9, s9, s101
    s_add_u32 s9, s9, 4
    s_min_u32 s9, s9, 17
    s_mul_i32 s9, s9, 9
    s_add_u32 s14, s14, s9
    v_mul_u32_u24 v140, 9216, v2
    s_mul_i32 s8, s4, 1152
    v_add_u32 v140, s8, v140
    s_mul_i32 s8, s14, 7282
    s_lshr_b32 s8, s8, 16
    s_mul_i32 s9, s8, 9
    s_sub_u32 s9, s14, s9
    s_lshl_b32 s9, s9, 7
    s_bitcmp1_b32 s8, 0
    s_cselect_b32 s12, s40, s38
    s_cselect_b32 s13, s41, s39
    s_lshr_b32 s8, s8, 1
    s_add_u32 s8, s8, 0
    s_mul_i32 s8, s8, 589824
    s_add_u32 s8, s8, s9
    v_add_u32 v148, s8, v140
    global_load_dword v149, v148, s[12:13]
    s_lshl_b32 s9, s6, 3
    s_branch CU_C3B
CU_C3:
    s_cmp_eq_u32 s4, 3
    s_cselect_b32 s8, 18, 6
    s_add_u32 s10, s10, s8
    s_sub_u32 s14, 3, s4
    s_and_b32 s14, s14, 7
    s_and_b32 s8, s10, 1
    s_lshl_b32 s8, s8, 3
    s_lshr_b32 s9, s10, 1
    s_cmp_eq_u32 s4, 3
    s_cselect_b32 s14, s8, s14
    s_cselect_b32 s9, s9, s10
    s_add_u32 s9, s9, 4
    s_min_u32 s9, s9, 17
    s_mul_i32 s9, s9, 9
    s_add_u32 s14, s14, s9
    v_mul_u32_u24 v140, 9216, v2
    s_mul_i32 s8, s4, 1152
    v_add_u32 v140, s8, v140
    s_mul_i32 s8, s14, 7282
    s_lshr_b32 s8, s8, 16
    s_mul_i32 s9, s8, 9
    s_sub_u32 s9, s14, s9
    s_lshl_b32 s9, s9, 7
    s_bitcmp1_b32 s8, 0
    s_cselect_b32 s12, s40, s38
    s_cselect_b32 s13, s41, s39
    s_lshr_b32 s8, s8, 1
    s_add_u32 s8, s8, 0
    s_mul_i32 s8, s8, 589824
    s_add_u32 s8, s8, s9
    v_add_u32 v148, s8, v140
    global_load_dword v149, v148, s[12:13]
    s_lshl_b32 s9, s6, 3
    s_branch CU_C3X
CU_MID:
    s_min_u32 s13, s7, 2
    s_mov_b32 s12, 0
SPN13:
    ds_read_b32 v56, v57 offset:64
    s_add_u32 s12, s12, 1
    s_waitcnt lgkmcnt(0)
    v_cmp_gt_u32 vcc, s13, v56
    s_cmp_ge_u32 s12, 0x40000
    s_cbranch_scc1 SPX13
    s_cbranch_vccz SPX13
    s_sleep 2
    s_branch SPN13
SPX13:
    s_branch CU_LD
CU_PRE:
    v_mov_b32 v139, 1
    v_lshlrev_b32 v74, 3, v4
    v_sub_u32 v74, v74, v3
    v_and_b32 v74, 0xffff, v74
    v_lshl_or_b32 v74, v74, 16, v74
    v_mov_b32 v75, 0x3f803f80
    s_mul_i32 s8, s7, 0x20002
    s_add_u32 s8, s8, 0xfff0fff1
    v_pk_add_u16 v76, v74, s8
    v_pk_add_u16 v80, v76, 2 op_sel_hi:[1,0]
    v_pk_ashrrev_i16 v80, 15, v80 op_sel_hi:[0,1]
    v_pk_add_u16 v81, v76, 3 op_sel_hi:[1,0]
    v_pk_ashrrev_i16 v81, 15, v81 op_sel_hi:[0,1]
    v_pk_add_u16 v82, v76, 4 op_sel_hi:[1,0]
    v_pk_ashrrev_i16 v82, 15, v82 op_sel_hi:[0,1]
    v_pk_add_u16 v83, v76, 5 op_sel_hi:[1,0]
    v_pk_ashrrev_i16 v83, 15, v83 op_sel_hi:[0,1]
    v_pk_add_u16 v84, v76, 10 op_sel_hi:[1,0]
    v_pk_ashrrev_i16 v84, 15, v84 op_sel_hi:[0,1]
    v_pk_add_u16 v85, v76, 11 op_sel_hi:[1,0]
    v_pk_ashrrev_i16 v85, 15, v85 op_sel_hi:[0,1]
    v_pk_add_u16 v86, v76, 12 op_sel_hi:[1,0]
    v_pk_ashrrev_i16 v86, 15, v86 op_sel_hi:[0,1]
    s_lshl_b32 s8, s7, 2
    s_add_u32 s8, s8, 154112
    v_lshl_add_u32 v74, v2, 4, s8
    v_bitop3_b32 v88, v80, v83, v75 bitop3:0x28
    ds_write_b32 v74, v88 offset:0
    v_bitop3_b32 v89, v83, v84, v75 bitop3:0x28
    ds_write_b32 v74, v89 offset:1024
    v_bitop3_b32 v90, v82, v85, v75 bitop3:0x28
    ds_write_b32 v74, v90 offset:2048
    v_bitop3_b32 v91, v81, v86, v75 bitop3:0x28
    ds_write_b32 v74, v91 offset:3072
    v_xor_b32 v92, v80, v82
    ds_write_b32 v74, v92 offset:4096
    s_mov_b64 exec, 1
    ds_add_u32 v57, v139 offset:76
    s_mov_b64 exec, -1
    s_mov_b32 s72, s15
    v_lshrrev_b32 v158, 2, v2
    v_mul_u32_u24 v158, 256, v158
    v_and_b32 v137, 3, v2
    v_lshl_add_u32 v158, v137, 4, v158
    v_lshrrev_b32 v138, 1, v2
    v_mul_u32_u24 v138, 256, v138
    v_and_b32 v137, 1, v2
    v_lshl_add_u32 v138, v137, 4, v138
    v_add_u32 v138, 20544, v138
    s_mul_i32 s8, s15, 4096
    s_add_u32 s8, s8, 4224
    v_add_u32 v158, s8, v158
    v_add_u32 v137, 24576, v158
    v_add_u32 v138, 4224, v138
    s_cmp_eq_u32 s7, 1
    s_cselect_b64 vcc, -1, 0
    v_cndmask_b32 v138, v137, v138, vcc
    v_and_b32 v146, 3, v2
    v_mul_u32_u24 v159, 320, v146
    v_lshl_add_u32 v146, v146, 2, v57
    v_lshrrev_b32 v136, 2, v2
    v_lshl_add_u32 v159, v136, 4, v159
    s_mul_i32 s8, s72, 1280
    v_add_u32 v159, s8, v159
    v_add_u32 v136, 40960, v159
    v_and_b32 v141, 7, v2
    s_lshl_b32 s8, s72, 5
    s_add_u32 s8, s8, 153856
    v_lshl_add_u32 v141, v141, 2, s8
    s_lshl_b32 s8, s72, 10
    v_lshl_add_u32 v147, v2, 4, s8
    v_lshlrev_b32 v142, 1, v147
    v_add_u32 v147, 98304, v147
    v_add_u32 v142, 81920, v142
    s_lshl_b32 s8, s72, 9
    s_add_u32 s8, s8, 124928
    v_lshl_add_u32 v58, v2, 3, s8
    s_mov_b32 s74, 0x05040100
    s_mov_b32 s75, 0x07060302
    s_cmp_lt_u32 s7, 2
    s_cselect_b32 s8, 1, 16
    v_mov_b32 v143, s8
    s_waitcnt lgkmcnt(0)
    v_lshlrev_b32 v154, 16, s52
    v_mov_b32 v155, s52
    v_lshlrev_b32 v156, 16, s53
    v_mov_b32 v157, s53
    v_and_b32 v155, 0xffff0000, v155
    v_and_b32 v157, 0xffff0000, v157
    v_add_f32 v154, -1.0, v154
    v_add_f32 v155, -1.0, v155
    v_add_f32 v156, -1.0, v156
    v_add_f32 v157, -1.0, v157
    s_waitcnt vmcnt(0)
    s_branch CU_PREX
CU_MAIN:
    s_mov_b64 exec, 1
    ds_add_u32 v57, v139 offset:64
    s_mov_b64 exec, -1
    s_setprio 3
    s_waitcnt vmcnt(6)
    v_perm_b32 v64, v8, v10, s74
    v_perm_b32 v66, v8, v10, s75
    v_perm_b32 v68, v9, v11, s74
    v_perm_b32 v70, v9, v11, s75
    s_waitcnt vmcnt(4)
    v_perm_b32 v65, v12, v14, s74
    v_perm_b32 v67, v12, v14, s75
    v_perm_b32 v69, v13, v15, s74
    v_perm_b32 v71, v13, v15, s75
    ds_write_b64 v58, v[64:65] offset:0
    ds_write_b64 v58, v[66:67] offset:8192
    ds_write_b64 v58, v[68:69] offset:16384
    ds_write_b64 v58, v[70:71] offset:24576
    s_waitcnt vmcnt(2)
    v_perm_b32 v72, v16, v18, s74
    v_perm_b32 v74, v16, v18, s75
    v_perm_b32 v76, v17, v19, s74
    v_perm_b32 v78, v17, v19, s75
    s_waitcnt vmcnt(0)
    v_perm_b32 v73, v20, v22, s74
    v_perm_b32 v75, v20, v22, s75
    v_perm_b32 v77, v21, v23, s74
    v_perm_b32 v79, v21, v23, s75
    ds_write_b64 v58, v[72:73] offset:1024
    ds_write_b64 v58, v[74:75] offset:9216
    ds_write_b64 v58, v[76:77] offset:17408
    ds_write_b64 v58, v[78:79] offset:25600
    s_mov_b64 exec, 1
    ds_add_u32 v57, v143 offset:240
    s_mov_b64 exec, -1
    s_setprio 3
    s_cmp_ge_u32 s7, 2
    s_cbranch_scc1 E_NOG
    s_mov_b32 s12, 0
SPN14:
    ds_read_b32 v60, v57 offset:64
    s_add_u32 s12, s12, 1
    s_waitcnt lgkmcnt(0)
    v_cmp_gt_u32 vcc, 4, v60
    s_cmp_ge_u32 s12, 0x40000
    s_cbranch_scc1 SPX14
    s_cbranch_vccz SPX14
    s_sleep 1
    s_branch SPN14
SPX14:
    global_load_dwordx2 v[144:145], v59, s[48:49] sc1
    global_load_dwordx4 v[128:131], v158, s[50:51] sc1
    v_add_u32 v137, 8192, v158
    global_load_dwordx4 v[132:135], v137, s[50:51] sc1
    v_add_u32 v137, 16384, v158
    global_load_dwordx4 v[160:163], v137, s[50:51] sc1
    global_load_dwordx4 v[164:167], v138, s[50:51] sc1
    s_add_u32 s15, s7, 0
    s_cmp_ge_u32 s15, 4
    s_cbranch_scc1 CPF_DE0
    s_mul_i32 s14, s15, 18
    s_add_u32 s14, s14, s101
    v_mul_u32_u24 v140, 9216, v2
    s_mul_i32 s8, s4, 1152
    v_add_u32 v140, s8, v140
    s_mul_i32 s8, s14, 7282
    s_lshr_b32 s8, s8, 16
    s_mul_i32 s9, s8, 9
    s_sub_u32 s9, s14, s9
    s_lshl_b32 s9, s9, 7
    s_bitcmp1_b32 s8, 0
    s_cselect_b32 s12, s40, s38
    s_cselect_b32 s13, s41, s39
    s_lshr_b32 s8, s8, 1
    s_add_u32 s8, s8, 5
    s_mul_i32 s8, s8, 589824
    s_add_u32 s8, s8, s9
    v_add_u32 v148, s8, v140
    global_load_dword v149, v148, s[12:13]
    s_branch CPF_XE0
CPF_DE0:
    s_sub_u32 s14, s15, 4
    s_mul_i32 s14, s14, 18
    s_add_u32 s14, s14, s101
    s_min_u32 s14, s14, 80
    s_mul_i32 s8, s4, 81
    s_add_u32 s8, s8, 80
    s_sub_u32 s8, s8, s14
    s_lshl_b32 s8, s8, 13
    v_lshl_add_u32 v148, v2, 7, s8
    global_load_dword v149, v148, s[42:43]
CPF_XE0:
    s_add_u32 s15, s7, 2
    s_cmp_ge_u32 s15, 4
    s_cbranch_scc1 CPF_DE1
    s_mul_i32 s14, s15, 18
    s_add_u32 s14, s14, s101
    v_mul_u32_u24 v140, 9216, v2
    s_mul_i32 s8, s4, 1152
    v_add_u32 v140, s8, v140
    s_mul_i32 s8, s14, 7282
    s_lshr_b32 s8, s8, 16
    s_mul_i32 s9, s8, 9
    s_sub_u32 s9, s14, s9
    s_lshl_b32 s9, s9, 7
    s_bitcmp1_b32 s8, 0
    s_cselect_b32 s12, s40, s38
    s_cselect_b32 s13, s41, s39
    s_lshr_b32 s8, s8, 1
    s_add_u32 s8, s8, 5
    s_mul_i32 s8, s8, 589824
    s_add_u32 s8, s8, s9
    v_add_u32 v148, s8, v140
    global_load_dword v149, v148, s[12:13]
    s_branch CPF_XE1
CPF_DE1:
    s_sub_u32 s14, s15, 4
    s_mul_i32 s14, s14, 18
    s_add_u32 s14, s14, s101
    s_min_u32 s14, s14, 80
    s_mul_i32 s8, s4, 81
    s_add_u32 s8, s8, 80
    s_sub_u32 s8, s8, s14
    s_lshl_b32 s8, s8, 13
    v_lshl_add_u32 v148, v2, 7, s8
    global_load_dword v149, v148, s[42:43]
CPF_XE1:
    s_add_u32 s15, s7, 4
    s_cmp_ge_u32 s15, 4
    s_cbranch_scc1 CPF_DE2
    s_mul_i32 s14, s15, 18
    s_add_u32 s14, s14, s101
    v_mul_u32_u24 v140, 9216, v2
    s_mul_i32 s8, s4, 1152
    v_add_u32 v140, s8, v140
    s_mul_i32 s8, s14, 7282
    s_lshr_b32 s8, s8, 16
    s_mul_i32 s9, s8, 9
    s_sub_u32 s9, s14, s9
    s_lshl_b32 s9, s9, 7
    s_bitcmp1_b32 s8, 0
    s_cselect_b32 s12, s40, s38
    s_cselect_b32 s13, s41, s39
    s_lshr_b32 s8, s8, 1
    s_add_u32 s8, s8, 5
    s_mul_i32 s8, s8, 589824
    s_add_u32 s8, s8, s9
    v_add_u32 v148, s8, v140
    global_load_dword v149, v148, s[12:13]
    s_branch CPF_XE2
CPF_DE2:
    s_sub_u32 s14, s15, 4
    s_mul_i32 s14, s14, 18
    s_add_u32 s14, s14, s101
    s_min_u32 s14, s14, 80
    s_mul_i32 s8, s4, 81
    s_add_u32 s8, s8, 80
    s_sub_u32 s8, s8, s14
    s_lshl_b32 s8, s8, 13
    v_lshl_add_u32 v148, v2, 7, s8
    global_load_dword v149, v148, s[42:43]
CPF_XE2:
E_NOG:
    v_lshlrev_b32 v24, 16, v8
    v_and_b32 v28, 0xffff0000, v8
    v_lshlrev_b32 v32, 16, v9
    v_and_b32 v36, 0xffff0000, v9
    v_lshlrev_b32 v25, 16, v10
    v_and_b32 v29, 0xffff0000, v10
    v_lshlrev_b32 v33, 16, v11
    v_and_b32 v37, 0xffff0000, v11
    v_lshlrev_b32 v26, 16, v12
    v_and_b32 v30, 0xffff0000, v12
    v_lshlrev_b32 v34, 16, v13
    v_and_b32 v38, 0xffff0000, v13
    v_lshlrev_b32 v27, 16, v14
    v_and_b32 v31, 0xffff0000, v14
    v_lshlrev_b32 v35, 16, v15
    v_and_b32 v39, 0xffff0000, v15
    v_lshlrev_b32 v40, 16, v16
    v_and_b32 v44, 0xffff0000, v16
    v_lshlrev_b32 v48, 16, v17
    v_and_b32 v52, 0xffff0000, v17
    v_lshlrev_b32 v41, 16, v18
    v_and_b32 v45, 0xffff0000, v18
    v_lshlrev_b32 v49, 16, v19
    v_and_b32 v53, 0xffff0000, v19
    v_lshlrev_b32 v42, 16, v20
    v_and_b32 v46, 0xffff0000, v20
    v_lshlrev_b32 v50, 16, v21
    v_and_b32 v54, 0xffff0000, v21
    v_lshlrev_b32 v43, 16, v22
    v_and_b32 v47, 0xffff0000, v22
    v_lshlrev_b32 v51, 16, v23
    v_and_b32 v55, 0xffff0000, v23
    s_cmp_ge_u32 s7, 2
    s_cbranch_scc1 E_GATES
E_T0:
    s_mov_b32 s12, 0
SPN15:
    ds_read_b32 v60, v141 offset:0
    s_add_u32 s12, s12, 1
    s_waitcnt lgkmcnt(0)
    v_cmp_eq_u32 vcc, 0, v60
    s_cmp_ge_u32 s12, 0x40000
    s_cbranch_scc1 SPX15
    s_cbranch_vccz SPX15
    s_sleep 1
    s_branch SPN15
SPX15:
    ds_read_b128 v[96:99], v159 offset:0
    ds_read_b128 v[112:115], v159 offset:10240
    ds_read_b128 v[100:103], v159 offset:20480
    ds_read_b128 v[116:119], v159 offset:30720
    ds_read_b128 v[104:107], v136 offset:0
    ds_read_b128 v[120:123], v136 offset:10240
    ds_read_b128 v[108:111], v136 offset:20480
    ds_read_b128 v[124:127], v136 offset:30720
    s_waitcnt lgkmcnt(6)
    v_add_f32 v96, v96, v112
    v_fmac_f32 v96, v24, v154
    v_add_f32 v97, v97, v113
    v_fmac_f32 v97, v25, v154
    v_add_f32 v98, v98, v114
    v_fmac_f32 v98, v26, v154
    v_add_f32 v99, v99, v115
    v_fmac_f32 v99, v27, v154
    s_waitcnt lgkmcnt(4)
    v_add_f32 v100, v100, v116
    v_fmac_f32 v100, v28, v155
    v_add_f32 v101, v101, v117
    v_fmac_f32 v101, v29, v155
    v_add_f32 v102, v102, v118
    v_fmac_f32 v102, v30, v155
    v_add_f32 v103, v103, v119
    v_fmac_f32 v103, v31, v155
    s_waitcnt lgkmcnt(2)
    v_add_f32 v104, v104, v120
    v_fmac_f32 v104, v32, v156
    v_add_f32 v105, v105, v121
    v_fmac_f32 v105, v33, v156
    v_add_f32 v106, v106, v122
    v_fmac_f32 v106, v34, v156
    v_add_f32 v107, v107, v123
    v_fmac_f32 v107, v35, v156
    s_waitcnt lgkmcnt(0)
    v_add_f32 v108, v108, v124
    v_fmac_f32 v108, v36, v157
    v_add_f32 v109, v109, v125
    v_fmac_f32 v109, v37, v157
    v_add_f32 v110, v110, v126
    v_fmac_f32 v110, v38, v157
    v_add_f32 v111, v111, v127
    v_fmac_f32 v111, v39, v157
    s_cmp_ge_u32 s7, 2
    s_cbranch_scc1 E_OUT0
E_GATES:
    s_cmp_lt_u32 s7, 2
    s_cbranch_scc1 E_G1
    s_mov_b32 s12, 0
SPN16:
    ds_read_b32 v60, v57 offset:116
    s_add_u32 s12, s12, 1
    s_waitcnt lgkmcnt(0)
    v_cmp_ne_u32 vcc, 2, v60
    s_cmp_ge_u32 s12, 0x40000
    s_cbranch_scc1 SPX16
    s_cbranch_vccz SPX16
    s_sleep 1
    s_branch SPN16
SPX16:
    ds_read_b128 v[128:131], v147
    ds_read_b128 v[132:135], v147 offset:2048
    s_waitcnt lgkmcnt(0)
    s_branch E_GX
E_G1:
    s_mov_b32 s12, 0
    s_waitcnt vmcnt(3)
    s_branch E_GCHK
E_GPOLL:
    global_load_dwordx2 v[144:145], v59, s[48:49] sc1
    global_load_dwordx4 v[128:131], v158, s[50:51] sc1
    v_add_u32 v137, 8192, v158
    global_load_dwordx4 v[132:135], v137, s[50:51] sc1
    v_add_u32 v137, 16384, v158
    global_load_dwordx4 v[160:163], v137, s[50:51] sc1
    global_load_dwordx4 v[164:167], v138, s[50:51] sc1
    s_add_u32 s12, s12, 1
    s_waitcnt vmcnt(0)
E_GCHK:
    v_xor_b32 v61, 1, v145
    v_bitop3_b32 v61, v61, v128, v144 bitop3:0xf6
    v_bitop3_b32 v61, v61, v129, v144 bitop3:0xf6
    v_bitop3_b32 v61, v61, v130, v144 bitop3:0xf6
    v_bitop3_b32 v61, v61, v131, v144 bitop3:0xf6
    v_bitop3_b32 v61, v61, v132, v144 bitop3:0xf6
    v_bitop3_b32 v61, v61, v133, v144 bitop3:0xf6
    v_bitop3_b32 v61, v61, v134, v144 bitop3:0xf6
    v_bitop3_b32 v61, v61, v135, v144 bitop3:0xf6
    v_bitop3_b32 v61, v61, v160, v144 bitop3:0xf6
    v_bitop3_b32 v61, v61, v161, v144 bitop3:0xf6
    v_bitop3_b32 v61, v61, v162, v144 bitop3:0xf6
    v_bitop3_b32 v61, v61, v163, v144 bitop3:0xf6
    v_bitop3_b32 v61, v61, v164, v144 bitop3:0xf6
    v_bitop3_b32 v61, v61, v165, v144 bitop3:0xf6
    v_bitop3_b32 v61, v61, v166, v144 bitop3:0xf6
    v_bitop3_b32 v61, v61, v167, v144 bitop3:0xf6
    v_and_b32 v61, 0xffff, v61
    v_cmp_ne_u32 vcc, 0, v61
    s_cmp_ge_u32 s12, 16384
    s_cbranch_scc1 E_GOK
    s_cbranch_vccnz E_GPOLL
E_GOK:
    ds_write_b128 v147, v[160:163] offset:4096
    ds_write_b128 v147, v[164:167] offset:6144
    ds_write_b128 v147, v[128:131] offset:0
    ds_write_b128 v147, v[132:135] offset:2048
    ds_write_b32 v57, v144 offset:120
    s_mov_b64 exec, 1
    ds_add_u32 v57, v139 offset:116
    s_mov_b64 exec, -1
E_GX:
    ds_write_b128 v142, v[8:11] offset:0
    ds_write_b128 v142, v[12:15] offset:16
    ds_write_b128 v142, v[16:19] offset:4096
    ds_write_b128 v142, v[20:23] offset:4112
    s_mov_b64 exec, 1
    ds_add_u32 v57, v139 offset:244
    s_mov_b64 exec, -1
    v_and_b32 v128, 0xffff0000, v128
    v_and_b32 v129, 0xffff0000, v129
    v_and_b32 v130, 0xffff0000, v130
    v_and_b32 v131, 0xffff0000, v131
    s_cmp_ge_u32 s7, 2
    s_cbranch_scc1 E_T0
E_OUT0:
    v_fma_f32 v96, v96, v128, v24
    v_fma_f32 v100, v100, v128, v28
    v_fma_f32 v104, v104, v128, v32
    v_fma_f32 v108, v108, v128, v36
    v_cvt_pk_bf16_f32 v112, v96, v100
    v_cvt_pk_bf16_f32 v113, v104, v108
    global_store_dwordx2 v5, v[112:113], s[46:47] offset:0
    v_fma_f32 v97, v97, v129, v25
    v_fma_f32 v101, v101, v129, v29
    v_fma_f32 v105, v105, v129, v33
    v_fma_f32 v109, v109, v129, v37
    v_cvt_pk_bf16_f32 v114, v97, v101
    v_cvt_pk_bf16_f32 v115, v105, v109
    global_store_dwordx2 v5, v[114:115], s[46:47] offset:1152
    v_fma_f32 v98, v98, v130, v26
    v_fma_f32 v102, v102, v130, v30
    v_fma_f32 v106, v106, v130, v34
    v_fma_f32 v110, v110, v130, v38
    v_cvt_pk_bf16_f32 v116, v98, v102
    v_cvt_pk_bf16_f32 v117, v106, v110
    global_store_dwordx2 v5, v[116:117], s[46:47] offset:2304
    v_fma_f32 v99, v99, v131, v27
    v_fma_f32 v103, v103, v131, v31
    v_fma_f32 v107, v107, v131, v35
    v_fma_f32 v111, v111, v131, v39
    v_cvt_pk_bf16_f32 v118, v99, v103
    v_cvt_pk_bf16_f32 v119, v107, v111
    global_store_dwordx2 v5, v[118:119], s[46:47] offset:3456
    v_and_b32 v132, 0xffff0000, v132
    v_and_b32 v133, 0xffff0000, v133
    v_and_b32 v134, 0xffff0000, v134
    v_and_b32 v135, 0xffff0000, v135
    s_mov_b32 s12, 0
SPN17:
    ds_read_b32 v60, v141 offset:64
    s_add_u32 s12, s12, 1
    s_waitcnt lgkmcnt(0)
    v_cmp_eq_u32 vcc, 0, v60
    s_cmp_ge_u32 s12, 0x40000
    s_cbranch_scc1 SPX17
    s_cbranch_vccz SPX17
    s_sleep 1
    s_branch SPN17
SPX17:
    ds_read_b128 v[96:99], v159 offset:2560
    ds_read_b128 v[112:115], v159 offset:12800
    ds_read_b128 v[100:103], v159 offset:23040
    ds_read_b128 v[116:119], v159 offset:33280
    ds_read_b128 v[104:107], v136 offset:2560
    ds_read_b128 v[120:123], v136 offset:12800
    ds_read_b128 v[108:111], v136 offset:23040
    ds_read_b128 v[124:127], v136 offset:33280
    s_waitcnt lgkmcnt(6)
    v_add_f32 v96, v96, v112
    v_fmac_f32 v96, v40, v154
    v_add_f32 v97, v97, v113
    v_fmac_f32 v97, v41, v154
    v_add_f32 v98, v98, v114
    v_fmac_f32 v98, v42, v154
    v_add_f32 v99, v99, v115
    v_fmac_f32 v99, v43, v154
    s_waitcnt lgkmcnt(4)
    v_add_f32 v100, v100, v116
    v_fmac_f32 v100, v44, v155
    v_add_f32 v101, v101, v117
    v_fmac_f32 v101, v45, v155
    v_add_f32 v102, v102, v118
    v_fmac_f32 v102, v46, v155
    v_add_f32 v103, v103, v119
    v_fmac_f32 v103, v47, v155
    s_waitcnt lgkmcnt(2)
    v_add_f32 v104, v104, v120
    v_fmac_f32 v104, v48, v156
    v_add_f32 v105, v105, v121
    v_fmac_f32 v105, v49, v156
    v_add_f32 v106, v106, v122
    v_fmac_f32 v106, v50, v156
    v_add_f32 v107, v107, v123
    v_fmac_f32 v107, v51, v156
    s_waitcnt lgkmcnt(0)
    v_add_f32 v108, v108, v124
    v_fmac_f32 v108, v52, v157
    v_add_f32 v109, v109, v125
    v_fmac_f32 v109, v53, v157
    v_add_f32 v110, v110, v126
    v_fmac_f32 v110, v54, v157
    v_add_f32 v111, v111, v127
    v_fmac_f32 v111, v55, v157
    v_fma_f32 v96, v96, v132, v40
    v_fma_f32 v100, v100, v132, v44
    v_fma_f32 v104, v104, v132, v48
    v_fma_f32 v108, v108, v132, v52
    v_cvt_pk_bf16_f32 v112, v96, v100
    v_cvt_pk_bf16_f32 v113, v104, v108
    global_store_dwordx2 v6, v[112:113], s[46:47] offset:0
    v_fma_f32 v97, v97, v133, v41
    v_fma_f32 v101, v101, v133, v45
    v_fma_f32 v105, v105, v133, v49
    v_fma_f32 v109, v109, v133, v53
    v_cvt_pk_bf16_f32 v114, v97, v101
    v_cvt_pk_bf16_f32 v115, v105, v109
    global_store_dwordx2 v6, v[114:115], s[46:47] offset:1152
    v_fma_f32 v98, v98, v134, v42
    v_fma_f32 v102, v102, v134, v46
    v_fma_f32 v106, v106, v134, v50
    v_fma_f32 v110, v110, v134, v54
    v_cvt_pk_bf16_f32 v116, v98, v102
    v_cvt_pk_bf16_f32 v117, v106, v110
    global_store_dwordx2 v6, v[116:117], s[46:47] offset:2304
    v_fma_f32 v99, v99, v135, v43
    v_fma_f32 v103, v103, v135, v47
    v_fma_f32 v107, v107, v135, v51
    v_fma_f32 v111, v111, v135, v55
    v_cvt_pk_bf16_f32 v118, v99, v103
    v_cvt_pk_bf16_f32 v119, v107, v111
    global_store_dwordx2 v6, v[118:119], s[46:47] offset:3456
    s_waitcnt vmcnt(0)
    s_endpgm
FINAL:
    v_and_b32 v5, 7, v2
    v_lshlrev_b32 v5, 2, v5
    s_lshl_b32 s10, s6, 3
    s_load_dwordx2 s[52:53], s[32:33], s10
    s_mov_b32 s12, 0
SPN18:
    ds_read_b32 v42, v167 offset:244
    s_add_u32 s12, s12, 1
    s_waitcnt lgkmcnt(0)
    v_cmp_ne_u32 vcc, 4, v42
    s_cmp_ge_u32 s12, 0x40000
    s_cbranch_scc1 SPX18
    s_cbranch_vccz SPX18
    s_sleep 1
    s_branch SPN18
SPX18:
    ds_read_b32 v42, v167 offset:120
    s_waitcnt lgkmcnt(0)
    v_and_b32 v6, 4, v2
    v_add_u32 v6, v6, v4
    s_lshl_b32 s9, s4, 8
    v_lshl_add_u32 v6, v6, 3, s9
    v_and_b32 v7, 4, v2
    v_add_u32 v7, v7, v4
    s_lshl_b32 s9, s4, 10
    s_add_u32 s9, s9, 48896
    v_lshl_add_u32 v7, v7, 7, s9
    s_mov_b32 s12, 0
    s_waitcnt vmcnt(0)
    v_mov_b32 v8, v124
    v_mov_b32 v9, v125
    s_branch SPC_F
SP_F:
    s_add_u32 s12, s12, 1
    s_and_b32 s9, s12, 7
    s_cselect_b64 s[14:15], 0, -1
    v_cndmask_b32 v10, v6, v7, s[14:15]
    global_load_dwordx2 v[8:9], v10, s[50:51] offset:256 sc1
    s_waitcnt vmcnt(0)
SPC_F:
    v_cmp_ne_u32 vcc, v9, v42
    s_cmp_ge_u32 s12, 16384
    s_cbranch_scc1 SPX_F
    s_cbranch_vccz SPX_F
    s_mov_b64 exec, vcc
    s_sleep 2
    s_branch SP_F
SPX_F:
    s_mov_b64 exec, -1
    v_and_b32 v9, 0xff, v42
    v_not_b32 v10, v8
    v_and_b32 v10, 0x7ff, v10
    v_and_b32 v23, 3, v2
    v_mul_u32_u24 v11, 1152, v10
    v_lshl_add_u32 v11, v23, 1, v11
    v_add_u32 v11, s10, v11
    v_lshlrev_b32 v14, 3, v10
    v_lshl_add_u32 v14, v23, 1, v14
    v_add_u32 v14, 81920, v14
    ds_read_u16 v24, v14
    v_lshlrev_b32 v14, 2, v10
    v_add_u32 v14, 98304, v14
    ds_read_b32 v15, v14
    v_lshrrev_b32 v16, 8, v10
    v_mul_u32_u24 v16, 1280, v16
    v_and_b32 v17, 0xf0, v10
    v_add_u32 v16, v16, v17
    v_bfe_u32 v17, v10, 2, 2
    v_mul_u32_u24 v17, 320, v17
    v_add_u32 v16, v16, v17
    v_and_b32 v17, 3, v10
    v_lshl_add_u32 v16, v17, 2, v16
    v_mul_u32_u24 v17, 20480, v23
    v_add_u32 v16, v16, v17
    v_add_u32 v18, 154080, v5
    v_and_b32 v20, 0xffff0000, v8
    v_not_b32 v21, v20
    v_ashrrev_i32 v21, 31, v21
    v_and_b32 v21, 0x7fff0000, v21
    v_or_b32 v21, 0x80000000, v21
    v_xor_b32 v20, v20, v21
    v_mul_f32 v21, 0xbfb8aa3b, v20
    v_exp_f32 v21, v21
    s_nop 0
    v_add_f32 v21, 1.0, v21
    v_rcp_f32 v21, v21
    s_nop 0
    v_cvt_pk_bf16_f32 v20, v21, v21
    v_and_b32 v20, 0xffff0000, v20
    s_waitcnt lgkmcnt(0)
    v_and_b32 v15, 0xffff0000, v15
    v_sub_f32 v21, 1.0, v15
    v_cvt_pk_bf16_f32 v21, v21, v21
    v_and_b32 v21, 0xffff0000, v21
    v_lshlrev_b32 v24, 16, v24
    v_lshlrev_b32 v25, 4, v23
    v_lshrrev_b64 v[26:27], v25, s[52:53]
    v_lshlrev_b32 v26, 16, v26
    v_mul_f32 v26, v26, v24
    v_cvt_pk_bf16_f32 v26, 0, v26
    s_mul_i32 s8, s6, 1152
    s_add_u32 s8, s8, 352256
    s_mov_b32 s12, 0
SPN19:
    ds_read_b32 v22, v18 offset:0
    s_add_u32 s12, s12, 1
    s_waitcnt lgkmcnt(0)
    v_cmp_eq_u32 vcc, 0, v22
    s_cmp_ge_u32 s12, 0x40000
    s_cbranch_scc1 SPX19
    s_cbranch_vccz SPX19
    s_sleep 1
    s_branch SPN19
SPX19:
    ds_read_b32 v28, v16
    ds_read_b32 v29, v16 offset:10240
    v_lshl_add_u32 v22, v2, 4, s8
    s_mov_b32 s72, 0x00ff00ff
    s_mov_b32 s73, 0x00ff00ff
    s_waitcnt lgkmcnt(0)
    v_add_f32 v28, v28, v29
    v_cvt_pk_bf16_f32 v28, 0, v28
    v_add_f32 v28, v28, v26
    v_cvt_pk_bf16_f32 v28, 0, v28
    v_mul_f32 v28, v28, v15
    v_cvt_pk_bf16_f32 v28, 0, v28
    v_min_u32 v33, 4, v2
    s_lshl_b32 s11, s4, 7
    v_lshl_add_u32 v33, v33, 2, s11
    s_mov_b32 s12, 0
FN_R:
    global_load_dword v34, v33, s[50:51] offset:2304 sc1
    s_add_u32 s12, s12, 1
    s_waitcnt vmcnt(0)
    v_cmp_ne_u32 vcc, v34, v42
    s_cmp_ge_u32 s12, 64
    s_cbranch_scc1 FN_RX
    s_cbranch_vccz FN_RX
    s_sleep 2
    s_branch FN_R
FN_RX:
    s_mov_b32 s12, 0
FN_P:
    global_load_dwordx4 v[48:51], v22, s[50:51] sc1
    s_add_u32 s12, s12, 1
    s_waitcnt vmcnt(0)
    v_xor_b32 v48, v48, v9
    v_xor_b32 v49, v49, v9
    v_xor_b32 v50, v50, v9
    v_xor_b32 v51, v51, v9
    v_or3_b32 v32, v48, v49, v50
    v_or_b32 v32, v32, v51
    v_and_b32 v32, 0xff, v32
    v_cmp_ne_u32 vcc, 0, v32
    s_cmp_ge_u32 s12, 65536
    s_cbranch_scc1 FN_POK
    s_cbranch_vccz FN_POK
    s_mov_b64 exec, vcc
    s_branch FN_P
FN_POK:
    s_mov_b64 exec, -1
    v_permlane32_swap_b32 v48, v50
    v_permlane32_swap_b32 v49, v51
    v_add_f32 v48, v48, v50
    v_add_f32 v49, v49, v51
    s_nop 1
    v_permlane16_swap_b32 v48, v49
    v_add_f32 v48, v48, v49
    s_nop 1
    v_add_f32_dpp v48, v48, v48 row_ror:8 row_mask:0xf bank_mask:0xf
    v_cvt_pk_bf16_f32 v48, 0, v48
    v_mul_f32 v48, v48, v20
    v_cvt_pk_bf16_f32 v48, 0, v48
    v_add_f32 v48, v48, v24
    v_cvt_pk_bf16_f32 v48, 0, v48
    v_mul_f32 v48, v48, v21
    v_cvt_pk_bf16_f32 v48, 0, v48
    v_add_f32 v48, v48, v28
    v_cvt_pk_bf16_f32 v48, 0, v48
    s_barrier
    s_mov_b64 exec, s[72:73]
    global_store_short_d16_hi v11, v48, s[46:47]
    s_endpgm
W_END:
    s_endpgm
K_END:
    s_endpgm
CODE_END:
.section .rodata,"a"
.p2align 6
.amdhsa_kernel k1_kernel
  .amdhsa_next_free_vgpr 168
  .amdhsa_next_free_sgpr 102
  .amdhsa_accum_offset 168
  .amdhsa_group_segment_fixed_size 0
  .amdhsa_kernarg_size 144
  .amdhsa_user_sgpr_count 2
  .amdhsa_user_sgpr_kernarg_segment_ptr 1
  .amdhsa_system_sgpr_workgroup_id_x 1
.end_amdhsa_kernel
```

```asm
; @launch kernel=k1_kernel grid=(256,1,1) block=(768,1,1) lds=163840
.amdgcn_target "amdgcn-amd-amdhsa--gfx950"
.text
.p2align 8
.globl k1_kernel
.type k1_kernel,@function
k1_kernel:
    s_cmp_ge_u32 s2, 256
    s_cbranch_scc1 K_END
    s_load_dwordx16 s[16:31], s[0:1], 0
    s_load_dwordx16 s[32:47], s[0:1], 64
    s_load_dwordx4 s[48:51], s[0:1], 128
    v_lshrrev_b32 v1, 6, v0
    v_and_b32 v2, 63, v0
    v_readfirstlane_b32 s3, v1
    v_and_b32 v3, 15, v2
    v_lshrrev_b32 v4, 4, v2
    s_and_b32 s4, s2, 7
    s_lshr_b32 s5, s2, 3
    s_cmp_lg_u32 s3, 0
    s_cbranch_scc1 K_NOCPF
    s_getpc_b64 s[8:9]
    s_and_b32 s8, s8, 0xffffff00
    v_and_b32 v5, 7, v2
    v_lshl_add_u32 v5, s5, 3, v5
    v_lshlrev_b32 v5, 7, v5
    v_min_u32 v5, CODE_END-k1_kernel-4, v5
    global_load_dword v167, v5, s[8:9]
K_NOCPF:
    s_cmp_lt_u32 s2, 112
    s_cbranch_scc1 K_NC
    s_sub_u32 s101, s5, 14
    s_cmp_lt_u32 s101, 16
    s_cselect_b32 s6, 4, 1
    s_cselect_b32 s8, 0, 112
    s_lshl_b32 s6, s4, s6
    s_add_u32 s6, s6, s8
    s_add_u32 s6, s6, s101
    s_cmp_lt_u32 s3, 8
    s_cbranch_scc1 CK_PRO
CU_PRO:
    s_sub_u32 s7, s3, 8
    s_lshl_b32 s8, s101, 2
    s_add_u32 s8, s8, s7
    s_mul_i32 s10, s8, 57
    s_lshr_b32 s10, s10, 9
    s_mul_i32 s11, s10, 9
    s_sub_u32 s11, s8, s11
    s_sub_u32 s8, s8, s10
    s_mul_i32 s8, s8, 36864
    s_lshl_b32 s9, s4, 7
    s_add_u32 s8, s8, s9
    v_lshrrev_b32 v5, 1, v2
    v_mul_u32_u24 v5, 1152, v5
    v_and_b32 v6, 1, v2
    s_sub_u32 s9, 1024, s9
    v_mad_u32_u24 v5, v6, s9, v5
    v_add_u32 v7, s8, v5
    s_and_b32 s15, s7, 2
    s_add_u32 s15, s15, s7
    s_mul_i32 s8, s15, 294912
    s_lshl_b32 s9, s6, 3
    s_add_u32 s8, s8, s9
    v_mul_u32_u24 v5, 4608, v2
    v_add_u32 v5, s8, v5
    v_add_u32 v6, 589824, v5
    v_mov_b32 v58, 0
    v_mov_b32 v59, 0
    v_mov_b32 v57, 153600
    v_lshl_add_u32 v56, v2, 3, v57
    ds_write_b64 v56, v[58:59]
    s_waitcnt lgkmcnt(0)
    s_barrier
    s_cmp_eq_u32 s7, 3
    s_cbranch_scc1 CU_C3A
CU_C3B:
    global_load_dword v60, v59, s[30:31]
    s_load_dwordx2 s[52:53], s[32:33], s9
    s_branch CU_PRE
CU_PREX:
    s_cmp_eq_u32 s11, 8
    s_cbranch_scc1 CU_C3
    global_load_dword v60, v7, s[16:17]
CU_C3X:
    s_cmp_ge_u32 s7, 2
    s_cbranch_scc1 CU_MID
CU_LD:
    global_load_dwordx2 v[8:9], v5, s[16:17] offset:0 sc1
    global_load_dwordx2 v[10:11], v5, s[16:17] offset:1152 sc1
    global_load_dwordx2 v[12:13], v5, s[16:17] offset:2304 sc1
    global_load_dwordx2 v[14:15], v5, s[16:17] offset:3456 sc1
    global_load_dwordx2 v[16:17], v6, s[16:17] offset:0 sc1
    global_load_dwordx2 v[18:19], v6, s[16:17] offset:1152 sc1
    global_load_dwordx2 v[20:21], v6, s[16:17] offset:2304 sc1
    global_load_dwordx2 v[22:23], v6, s[16:17] offset:3456 sc1
    s_branch CU_MAIN
CK_PRO:
    s_and_b32 s7, s3, 3
    s_lshr_b32 s12, s3, 2
    s_lshl_b32 s8, s6, 2
    s_add_u32 s8, s8, s7
    s_lshl_b32 s9, s8, 8
    v_lshl_add_u32 v6, v2, 2, s9
    s_lshl_b32 s8, s8, 1
    v_mov_b32 v7, s8
    v_mov_b32 v18, 0
    s_waitcnt lgkmcnt(0)
    global_load_short_d16_hi v18, v7, s[30:31]
    global_load_dword v28, v6, s[18:19]
    global_load_dword v29, v6, s[20:21]
    global_load_dword v30, v6, s[22:23]
    global_load_dword v31, v6, s[24:25]
    global_load_dword v32, v6, s[26:27]
    global_load_dword v33, v6, s[28:29]
    s_barrier
    s_branch CK_MAIN
K_NC:
    s_lshl_b32 s6, s2, 4
    s_lshl_b32 s7, s3, 2
    s_sub_u32 s7, s7, 32
    s_cmp_ge_u32 s3, 8
    s_cbranch_scc1 RT_PRO
    s_cmp_lt_u32 s2, 72
    s_cbranch_scc1 F_PRO
    s_cmp_lt_u32 s3, 6
    s_cbranch_scc1 HELPER
    s_cmp_lt_u32 s2, 80
    s_cbranch_scc1 HELPER
    s_add_u32 s7, s7, 24
    s_lshr_b32 s6, s6, 1
    s_add_u32 s6, s6, 1136
RT_PRO:
    s_add_u32 s6, s6, s7
    v_add_u32 v5, s6, v4
    v_lshlrev_b32 v6, 4, v3
    v_lshlrev_b32 v7, 3, v3
    v_mul_u32_u24 v9, 1152, v5
    v_add_u32 v8, v9, v6
    v_add_u32 v9, v9, v7
    v_mov_b32 v10, 0
    v_lshlrev_b32 v11, 2, v2
    v_add_u32 v12, 163520, v11
    ds_write_b32 v12, v10
    v_and_b32 v11, 0x7c, v11
    v_lshlrev_b32 v12, 4, v2
    s_mul_i32 s13, s7, 640
    s_add_u32 s13, s13, 147456
    s_mov_b32 m0, s13
    s_waitcnt lgkmcnt(0)
    s_load_dword s12, s[50:51], 0
    global_load_lds_dwordx4 v12, s[36:37]
    global_load_lds_dword v11, s[36:37] offset:1024
    s_add_u32 m0, s13, 1280
    v_add_u32 v6, s13, v6
    global_load_lds_dwordx4 v12, s[44:45]
    global_load_lds_dword v11, s[44:45] offset:1024
    global_load_dwordx4 v[16:19], v8, s[16:17] offset:0
    global_load_dwordx4 v[20:23], v8, s[16:17] offset:256
    global_load_dwordx4 v[24:27], v8, s[16:17] offset:512
    global_load_dwordx4 v[28:31], v8, s[16:17] offset:768
    global_load_dwordx2 v[32:33], v9, s[16:17] offset:1024
    s_barrier
    s_branch RT_MAIN
F_PRO:
    s_mul_i32 s6, s4, 9
    s_add_u32 s6, s6, s5
    v_lshrrev_b32 v6, 3, v2
    v_and_b32 v7, 2, v6
    v_mad_u32_u24 v7, v7, 3, v6
    v_mul_u32_u24 v5, 9216, v7
    v_and_b32 v7, 6, v6
    v_xor_b32 v7, v7, v2
    v_and_b32 v7, 7, v7
    v_lshl_add_u32 v5, v7, 4, v5
    s_and_b32 s8, s3, 1
    s_lshr_b32 s9, s3, 1
    s_lshl_b32 s9, s9, 3
    s_add_u32 s8, s8, s9
    s_mul_i32 s14, s8, 18432
    s_lshl_b32 s8, s6, 7
    s_add_u32 s14, s14, s8
    s_lshl_b32 s15, s3, 10
    s_mov_b32 s54, 5308416
    s_mov_b32 s55, 0x20000
    s_mov_b32 s58, 5308416
    s_mov_b32 s59, 0x20000
    s_waitcnt lgkmcnt(0)
    s_mov_b64 s[52:53], s[38:39]
    s_mov_b64 s[56:57], s[40:41]
    s_barrier
    s_branch F_MAIN
HELPER:
    v_lshrrev_b32 v6, 3, v2
    v_and_b32 v7, 2, v6
    v_mad_u32_u24 v7, v7, 3, v6
    v_mul_u32_u24 v5, 1152, v7
    v_and_b32 v7, 6, v6
    v_xor_b32 v7, v7, v2
    v_and_b32 v7, 7, v7
    v_lshl_add_u32 v5, v7, 4, v5
    s_lshl_b32 s8, s5, 1
    s_sub_u32 s8, s8, 20
    s_cmp_lt_u32 s2, 80
    s_cselect_b32 s8, 8, s8
    s_cselect_b32 s70, 8, 6
    s_cselect_b32 s69, 2, 4
    s_cselect_b32 s67, 1, 0
    s_cselect_b32 s71, 1, 2
    s_mul_i32 s71, s71, 72
    s_lshl_b32 s8, s8, 7
    s_mul_i32 s14, s4, 663552
    s_add_u32 s14, s14, s8
    s_mov_b32 s6, s3
    s_waitcnt lgkmcnt(0)
    s_mov_b32 s60, s42
    s_mov_b32 s61, s43
    s_mov_b32 s62, 5308416
    s_mov_b32 s63, 0x20000
    s_barrier
    s_branch DN_LOAD
RT_MAIN:
    s_mul_i32 s6, s2, 256
    s_add_u32 s6, s6, 4096
    v_lshl_add_u32 v5, v2, 2, s6
    s_cmp_lt_u32 s2, 80
    s_cselect_b32 s8, 15, 23
    v_and_b32 v14, 31, v2
    v_min_u32 v14, s8, v14
    v_and_or_b32 v14, v2, 32, v14
    s_mov_b32 s8, 163520
    v_lshl_add_u32 v14, v14, 2, s8
    v_add_u32 v13, s7, v4
    v_lshl_add_u32 v13, v13, 2, s8
    s_mov_b32 s8, 0xffff
    s_mov_b32 s10, 0x00010001
    s_mov_b32 s11, 0x00010001
    v_mov_b32 v12, 163456
    s_waitcnt lgkmcnt(0)
    s_add_u32 s12, s12, 1
    v_mov_b32 v11, s12
    ds_write_b64 v12, v[10:11]
    v_add_u32 v7, s13, v7
    s_waitcnt vmcnt(5)
    ds_read_b128 v[52:55], v6 offset:1280
    ds_read_b128 v[56:59], v6 offset:1536
    ds_read_b128 v[60:63], v6 offset:1792
    ds_read_b128 v[64:67], v6 offset:2048
    ds_read_b64 v[68:69], v7 offset:2304
    ds_read_b128 v[34:37], v6 offset:0
    ds_read_b128 v[38:41], v6 offset:256
    ds_read_b128 v[42:45], v6 offset:512
    ds_read_b128 v[46:49], v6 offset:768
    ds_read_b64 v[50:51], v7 offset:1024
    v_mov_b32 v8, 0x3f803f80
    s_waitcnt lgkmcnt(5)
    v_and_b32 v84, 0xffff, v52
    v_and_b32 v52, 0xffff0000, v52
    v_and_b32 v85, 0xffff, v53
    v_and_b32 v53, 0xffff0000, v53
    v_and_b32 v86, 0xffff, v54
    v_and_b32 v54, 0xffff0000, v54
    v_and_b32 v87, 0xffff, v55
    v_and_b32 v55, 0xffff0000, v55
    v_and_b32 v88, 0xffff, v56
    v_and_b32 v56, 0xffff0000, v56
    v_and_b32 v89, 0xffff, v57
    v_and_b32 v57, 0xffff0000, v57
    v_and_b32 v90, 0xffff, v58
    v_and_b32 v58, 0xffff0000, v58
    v_and_b32 v91, 0xffff, v59
    v_and_b32 v59, 0xffff0000, v59
    v_and_b32 v92, 0xffff, v60
    v_and_b32 v60, 0xffff0000, v60
    v_and_b32 v93, 0xffff, v61
    v_and_b32 v61, 0xffff0000, v61
    v_and_b32 v94, 0xffff, v62
    v_and_b32 v62, 0xffff0000, v62
    v_and_b32 v95, 0xffff, v63
    v_and_b32 v63, 0xffff0000, v63
    v_and_b32 v96, 0xffff, v64
    v_and_b32 v64, 0xffff0000, v64
    v_and_b32 v97, 0xffff, v65
    v_and_b32 v65, 0xffff0000, v65
    v_and_b32 v98, 0xffff, v66
    v_and_b32 v66, 0xffff0000, v66
    v_and_b32 v99, 0xffff, v67
    v_and_b32 v67, 0xffff0000, v67
    v_and_b32 v100, 0xffff, v68
    v_and_b32 v68, 0xffff0000, v68
    v_and_b32 v101, 0xffff, v69
    v_and_b32 v69, 0xffff0000, v69
    s_waitcnt lgkmcnt(0)
    s_waitcnt vmcnt(4)
    v_dot2_f32_bf16 v70, v16, v84, 0
    v_dot2_f32_bf16 v71, v16, v52, 0
    v_dot2_f32_bf16 v72, v17, v85, 0
    v_dot2_f32_bf16 v73, v17, v53, 0
    v_dot2_f32_bf16 v74, v18, v86, 0
    v_dot2_f32_bf16 v75, v18, v54, 0
    v_dot2_f32_bf16 v76, v19, v87, 0
    v_dot2_f32_bf16 v77, v19, v55, 0
    v_dot2_f32_bf16 v12, v16, v34, 0
    v_dot2_f32_bf16 v12, v17, v35, v12
    v_dot2_f32_bf16 v12, v18, v36, v12
    v_dot2_f32_bf16 v12, v19, v37, v12
    v_cvt_pk_bf16_f32 v70, v70, v71
    v_cvt_pk_bf16_f32 v72, v72, v73
    v_cvt_pk_bf16_f32 v74, v74, v75
    v_cvt_pk_bf16_f32 v76, v76, v77
    v_dot2_f32_bf16 v15, v70, v8, 0
    v_dot2_f32_bf16 v15, v72, v8, v15
    v_dot2_f32_bf16 v15, v74, v8, v15
    v_dot2_f32_bf16 v15, v76, v8, v15
    s_waitcnt vmcnt(3)
    v_dot2_f32_bf16 v70, v20, v88, 0
    v_dot2_f32_bf16 v71, v20, v56, 0
    v_dot2_f32_bf16 v72, v21, v89, 0
    v_dot2_f32_bf16 v73, v21, v57, 0
    v_dot2_f32_bf16 v74, v22, v90, 0
    v_dot2_f32_bf16 v75, v22, v58, 0
    v_dot2_f32_bf16 v76, v23, v91, 0
    v_dot2_f32_bf16 v77, v23, v59, 0
    v_dot2_f32_bf16 v12, v20, v38, v12
    v_dot2_f32_bf16 v12, v21, v39, v12
    v_dot2_f32_bf16 v12, v22, v40, v12
    v_dot2_f32_bf16 v12, v23, v41, v12
    v_cvt_pk_bf16_f32 v70, v70, v71
    v_cvt_pk_bf16_f32 v72, v72, v73
    v_cvt_pk_bf16_f32 v74, v74, v75
    v_cvt_pk_bf16_f32 v76, v76, v77
    v_dot2_f32_bf16 v15, v70, v8, v15
    v_dot2_f32_bf16 v15, v72, v8, v15
    v_dot2_f32_bf16 v15, v74, v8, v15
    v_dot2_f32_bf16 v15, v76, v8, v15
    s_waitcnt vmcnt(2)
    v_dot2_f32_bf16 v70, v24, v92, 0
    v_dot2_f32_bf16 v71, v24, v60, 0
    v_dot2_f32_bf16 v72, v25, v93, 0
    v_dot2_f32_bf16 v73, v25, v61, 0
    v_dot2_f32_bf16 v74, v26, v94, 0
    v_dot2_f32_bf16 v75, v26, v62, 0
    v_dot2_f32_bf16 v76, v27, v95, 0
    v_dot2_f32_bf16 v77, v27, v63, 0
    v_dot2_f32_bf16 v12, v24, v42, v12
    v_dot2_f32_bf16 v12, v25, v43, v12
    v_dot2_f32_bf16 v12, v26, v44, v12
    v_dot2_f32_bf16 v12, v27, v45, v12
    v_cvt_pk_bf16_f32 v70, v70, v71
    v_cvt_pk_bf16_f32 v72, v72, v73
    v_cvt_pk_bf16_f32 v74, v74, v75
    v_cvt_pk_bf16_f32 v76, v76, v77
    v_dot2_f32_bf16 v15, v70, v8, v15
    v_dot2_f32_bf16 v15, v72, v8, v15
    v_dot2_f32_bf16 v15, v74, v8, v15
    v_dot2_f32_bf16 v15, v76, v8, v15
    s_waitcnt vmcnt(1)
    v_dot2_f32_bf16 v70, v28, v96, 0
    v_dot2_f32_bf16 v71, v28, v64, 0
    v_dot2_f32_bf16 v72, v29, v97, 0
    v_dot2_f32_bf16 v73, v29, v65, 0
    v_dot2_f32_bf16 v74, v30, v98, 0
    v_dot2_f32_bf16 v75, v30, v66, 0
    v_dot2_f32_bf16 v76, v31, v99, 0
    v_dot2_f32_bf16 v77, v31, v67, 0
    v_dot2_f32_bf16 v12, v28, v46, v12
    v_dot2_f32_bf16 v12, v29, v47, v12
    v_dot2_f32_bf16 v12, v30, v48, v12
    v_dot2_f32_bf16 v12, v31, v49, v12
    v_cvt_pk_bf16_f32 v70, v70, v71
    v_cvt_pk_bf16_f32 v72, v72, v73
    v_cvt_pk_bf16_f32 v74, v74, v75
    v_cvt_pk_bf16_f32 v76, v76, v77
    v_dot2_f32_bf16 v15, v70, v8, v15
    v_dot2_f32_bf16 v15, v72, v8, v15
    v_dot2_f32_bf16 v15, v74, v8, v15
    v_dot2_f32_bf16 v15, v76, v8, v15
    s_waitcnt vmcnt(0)
    v_dot2_f32_bf16 v70, v32, v100, 0
    v_dot2_f32_bf16 v71, v32, v68, 0
    v_dot2_f32_bf16 v72, v33, v101, 0
    v_dot2_f32_bf16 v73, v33, v69, 0
    v_dot2_f32_bf16 v12, v32, v50, v12
    v_dot2_f32_bf16 v12, v33, v51, v12
    v_cvt_pk_bf16_f32 v70, v70, v71
    v_cvt_pk_bf16_f32 v72, v72, v73
    v_dot2_f32_bf16 v15, v70, v8, v15
    v_dot2_f32_bf16 v15, v72, v8, v15
    s_nop 0
    s_nop 1
    v_add_f32_dpp v15, v15, v15 row_ror:8 row_mask:0xf bank_mask:0xf
    v_add_f32_dpp v12, v12, v12 row_ror:8 row_mask:0xf bank_mask:0xf
    s_nop 0
    v_add_f32_dpp v15, v15, v15 row_ror:4 row_mask:0xf bank_mask:0xf
    v_add_f32_dpp v12, v12, v12 row_ror:4 row_mask:0xf bank_mask:0xf
    s_nop 0
    v_add_f32_dpp v15, v15, v15 row_ror:2 row_mask:0xf bank_mask:0xf
    v_add_f32_dpp v12, v12, v12 row_ror:2 row_mask:0xf bank_mask:0xf
    s_nop 0
    v_add_f32_dpp v15, v15, v15 row_ror:1 row_mask:0xf bank_mask:0xf
    v_add_f32_dpp v12, v12, v12 row_ror:1 row_mask:0xf bank_mask:0xf
    s_nop 0
    v_cvt_pk_bf16_f32 v15, 0, v15
    v_mul_f32 v15, 0xbfb8aa3b, v15
    v_exp_f32 v15, v15
    v_cvt_pk_bf16_f32 v12, v12, v12
    v_add_f32 v15, 1.0, v15
    v_rcp_f32 v15, v15
    v_ashrrev_i32 v9, 31, v12
    v_cvt_pk_bf16_f32 v15, 1.0, v15
    v_or_b32 v9, 0x80000000, v9
    v_bitop3_b32 v12, v12, v9, 1 bitop3:0xbe
    s_mov_b64 exec, s[10:11]
    ds_write2_b32 v13, v12, v15 offset0:0 offset1:32
    s_mov_b64 exec, -1
    s_cmp_lg_u32 s7, 0
    s_cbranch_scc1 RT_X
    s_mov_b32 s9, 0
SPN1:
    ds_read_b32 v12, v14 offset:0
    s_add_u32 s9, s9, 1
    s_waitcnt lgkmcnt(0)
    v_cmp_eq_u32 vcc, 0, v12
    s_cmp_ge_u32 s9, 0x40000
    s_cbranch_scc1 SPX1
    s_cbranch_vccnz SPN1
SPX1:
    v_bfi_b32 v12, s8, v11, v12
    global_store_dword v5, v12, s[50:51] sc1
    s_cmp_lg_u32 s2, 0
    s_cbranch_scc1 RT_X
    v_mov_b32 v8, v11
    v_mov_b32 v9, 1
    global_store_dwordx2 v10, v[8:9], s[48:49] sc1
RT_X:
    s_barrier
RT_TAIL:
    s_cmp_ge_u32 s2, 80
    s_cbranch_scc1 DN_JOIN
    s_cmp_lt_u32 s2, 72
    s_cbranch_scc1 RT_CTL
    s_barrier
    s_branch DN_JOIN
RT_CTL:
    s_cmp_lg_u32 s3, 8
    s_cbranch_scc1 W_END
    v_mov_b32 v14, v11
    s_mul_i32 s8, s4, 9
    s_add_u32 s8, s8, s5
    s_lshl_b32 s8, s8, 12
    s_add_u32 s8, s8, 57344
    v_lshl_add_u32 v23, v3, 7, s8
    global_load_dword v24, v23, s[50:51] sc1
    v_mov_b32 v21, 163456
    v_mov_b32 v22, 16
    s_mov_b32 s64, s16
    s_mov_b32 s65, s17
    s_mov_b32 s66, 2359296
    s_mov_b32 s67, 0x20000
    v_lshlrev_b32 v19, 4, v2
    v_lshlrev_b32 v20, 2, v2
    s_lshl_b32 s13, s4, 10
    s_add_u32 s13, s13, 40960
    s_add_u32 s7, s13, 1024
    s_sleep 16
RT_SC:
    s_load_dwordx16 s[16:31], s[50:51], s13
    s_add_u32 s13, s13, 64
    s_waitcnt lgkmcnt(0)
    s_xor_b32 s8, s17, s12
    s_xor_b32 s9, s19, s12
    s_or_b32 s8, s8, s9
    s_xor_b32 s9, s21, s12
    s_or_b32 s8, s8, s9
    s_xor_b32 s9, s23, s12
    s_or_b32 s8, s8, s9
    s_xor_b32 s9, s25, s12
    s_or_b32 s8, s8, s9
    s_xor_b32 s9, s27, s12
    s_or_b32 s8, s8, s9
    s_xor_b32 s9, s29, s12
    s_or_b32 s8, s8, s9
    s_xor_b32 s9, s31, s12
    s_or_b32 s8, s8, s9
    s_cbranch_scc0 RT_SCOK
    s_sleep 2
    s_cmp_lt_u32 s13, s7
    s_cbranch_scc1 RT_SC
    v_and_b32 v6, 7, v2
    s_lshl_b32 s9, s4, 8
    v_lshl_add_u32 v6, v6, 3, s9
    v_and_b32 v7, 7, v2
    s_lshl_b32 s9, s4, 10
    s_add_u32 s9, s9, 48896
    v_lshl_add_u32 v7, v7, 7, s9
    s_mov_b32 s12, 0
SP_C:
    s_add_u32 s12, s12, 1
    s_and_b32 s9, s12, 7
    s_cselect_b64 s[14:15], 0, -1
    v_cndmask_b32 v10, v6, v7, s[14:15]
    global_load_dwordx2 v[8:9], v10, s[50:51] offset:256 sc1
    s_waitcnt vmcnt(0)
SPC_C:
    v_cmp_ne_u32 vcc, v9, v14
    s_cmp_ge_u32 s12, 16384
    s_cbranch_scc1 SPX_C
    s_cbranch_vccz SPX_C
    s_mov_b64 exec, vcc
    s_sleep 2
    s_branch SP_C
SPX_C:
    s_mov_b64 exec, -1
    v_readlane_b32 s16, v8, 0
    v_readlane_b32 s18, v8, 1
    v_readlane_b32 s20, v8, 2
    v_readlane_b32 s22, v8, 3
    v_readlane_b32 s24, v8, 4
    v_readlane_b32 s26, v8, 5
    v_readlane_b32 s28, v8, 6
    v_readlane_b32 s30, v8, 7
RT_SCOK:
    s_mov_b32 m0, 147456
    s_andn2_b32 s76, 0x7ff, s16
    s_mul_i32 s76, s76, 1152
    s_andn2_b32 s77, 0x7ff, s18
    s_mul_i32 s77, s77, 1152
    s_andn2_b32 s78, 0x7ff, s20
    s_mul_i32 s78, s78, 1152
    s_andn2_b32 s79, 0x7ff, s22
    s_mul_i32 s79, s79, 1152
    s_andn2_b32 s80, 0x7ff, s24
    s_mul_i32 s80, s80, 1152
    s_andn2_b32 s81, 0x7ff, s26
    s_mul_i32 s81, s81, 1152
    s_andn2_b32 s82, 0x7ff, s28
    s_mul_i32 s82, s82, 1152
    s_andn2_b32 s83, 0x7ff, s30
    s_mul_i32 s83, s83, 1152
    buffer_load_dwordx4 v19, s[64:67], s76 offen lds
    buffer_load_dword v20, s[64:67], s76 offen offset:1024 lds
    s_add_u32 m0, m0, 1344
    s_nop 0
    buffer_load_dwordx4 v19, s[64:67], s77 offen lds
    buffer_load_dword v20, s[64:67], s77 offen offset:1024 lds
    s_add_u32 m0, m0, 1344
    s_nop 0
    buffer_load_dwordx4 v19, s[64:67], s78 offen lds
    buffer_load_dword v20, s[64:67], s78 offen offset:1024 lds
    s_add_u32 m0, m0, 1344
    s_nop 0
    buffer_load_dwordx4 v19, s[64:67], s79 offen lds
    buffer_load_dword v20, s[64:67], s79 offen offset:1024 lds
    s_add_u32 m0, m0, 1344
    s_nop 0
    buffer_load_dwordx4 v19, s[64:67], s80 offen lds
    buffer_load_dword v20, s[64:67], s80 offen offset:1024 lds
    s_add_u32 m0, m0, 1344
    s_nop 0
    buffer_load_dwordx4 v19, s[64:67], s81 offen lds
    buffer_load_dword v20, s[64:67], s81 offen offset:1024 lds
    s_add_u32 m0, m0, 1344
    s_nop 0
    buffer_load_dwordx4 v19, s[64:67], s82 offen lds
    buffer_load_dword v20, s[64:67], s82 offen offset:1024 lds
    s_add_u32 m0, m0, 1344
    s_nop 0
    buffer_load_dwordx4 v19, s[64:67], s83 offen lds
    buffer_load_dword v20, s[64:67], s83 offen offset:1024 lds
    s_add_u32 m0, m0, 1344
    s_nop 0
    v_mov_b32 v28, s76
    v_mov_b32 v29, s77
    v_mov_b32 v30, s78
    v_mov_b32 v31, s79
    v_mov_b32 v32, s80
    v_mov_b32 v33, s81
    v_mov_b32 v34, s82
    v_mov_b32 v35, s83
    v_mov_b32 v23, 163200
    ds_write_b128 v23, v[28:31]
    ds_write_b128 v23, v[32:35] offset:16
    s_waitcnt vmcnt(0)
    s_mov_b64 exec, 1
    ds_add_u32 v21, v22 offset:164
    s_mov_b64 exec, -1
    s_waitcnt lgkmcnt(0)
    s_barrier
    s_endpgm
DN_LOAD:
    v_mov_b32 v55, 49152
    s_mov_b64 s[80:81], 0
    s_cmp_lg_u32 s3, 0
    s_cbranch_scc1 DN_NOT
    v_min_u32 v8, 8, v2
    v_mul_u32_u24 v8, 73728, v8
    v_add_u32 v8, 72576, v8
    buffer_load_dword v9, v8, s[60:63], s14 offen
DN_NOT:
    s_cmp_ge_u32 s2, 80
    s_cbranch_scc1 DN_SA
DN_SAL:
    s_lshr_b32 s8, s6, 3
    s_lshl_b32 s8, s8, s67
    s_and_b32 s9, s6, 7
    s_lshl_b32 s12, s8, 3
    s_add_u32 s12, s12, s9
    s_lshl_b32 m0, s12, 10
    s_mul_i32 s9, s9, 9216
    s_bitcmp1_b32 s6, 0
    s_cselect_b32 s12, 6912, 0
    s_sub_u32 s9, s9, s12
    s_bitcmp1_b32 s8, 0
    s_cselect_b32 s12, 36736, 0
    s_mul_i32 s8, s8, 36864
    s_sub_u32 s8, s8, s12
    s_add_u32 s8, s8, s9
    s_add_u32 s8, s8, s14
    buffer_load_dwordx4 v5, s[60:63], s8 offen  lds
    s_add_u32 s6, s6, s70
    s_cmp_lt_u32 s6, 8
    s_cbranch_scc1 DN_SAL
DN_SA:
    s_lshr_b32 s8, s6, 3
    s_lshl_b32 s8, s8, s67
    s_and_b32 s9, s6, 7
    s_lshl_b32 s12, s8, 3
    s_add_u32 s12, s12, s9
    s_lshl_b32 m0, s12, 10
    s_mul_i32 s9, s9, 9216
    s_bitcmp1_b32 s6, 0
    s_cselect_b32 s12, 6912, 0
    s_sub_u32 s9, s9, s12
    s_bitcmp1_b32 s8, 0
    s_cselect_b32 s12, 36736, 0
    s_mul_i32 s8, s8, 36864
    s_sub_u32 s8, s8, s12
    s_add_u32 s8, s8, s9
    s_add_u32 s8, s8, s14
    buffer_load_dwordx4 v5, s[60:63], s8 offen  lds
    s_add_u32 s6, s6, s70
    s_waitcnt vmcnt(0)
    s_mov_b32 s13, 0
DN_L1:
    s_lshr_b32 s8, s6, 3
    s_lshl_b32 s8, s8, s67
    s_and_b32 s9, s6, 7
    s_lshl_b32 s12, s8, 3
    s_add_u32 s12, s12, s9
    s_lshl_b32 m0, s12, 10
    s_mul_i32 s9, s9, 9216
    s_bitcmp1_b32 s6, 0
    s_cselect_b32 s12, 6912, 0
    s_sub_u32 s9, s9, s12
    s_bitcmp1_b32 s8, 0
    s_cselect_b32 s12, 36736, 0
    s_mul_i32 s8, s8, 36864
    s_sub_u32 s8, s8, s12
    s_add_u32 s8, s8, s9
    s_add_u32 s8, s8, s14
    buffer_load_dwordx4 v5, s[60:63], s8 offen  lds
    s_add_u32 s6, s6, s70
    s_add_u32 s13, s13, 1
    s_cmp_lt_u32 s13, s69
    s_cbranch_scc1 DN_L1
    s_cmp_lt_u32 s2, 80
    s_cbranch_scc1 SEL_MAIN
    s_barrier
DN_L2:
    s_cmp_ge_u32 s6, s71
    s_cbranch_scc1 DN_LX
    s_waitcnt vmcnt(5)
    s_lshr_b32 s8, s6, 3
    s_lshl_b32 s8, s8, s67
    s_and_b32 s9, s6, 7
    s_lshl_b32 s12, s8, 3
    s_add_u32 s12, s12, s9
    s_lshl_b32 m0, s12, 10
    s_mul_i32 s9, s9, 9216
    s_bitcmp1_b32 s6, 0
    s_cselect_b32 s12, 6912, 0
    s_sub_u32 s9, s9, s12
    s_bitcmp1_b32 s8, 0
    s_cselect_b32 s12, 36736, 0
    s_mul_i32 s8, s8, 36864
    s_sub_u32 s8, s8, s12
    s_add_u32 s8, s8, s9
    s_add_u32 s8, s8, s14
    buffer_load_dwordx4 v5, s[60:63], s8 offen  lds
    s_add_u32 s6, s6, s70
    s_branch DN_L2
DN_LX:
DN_JOIN:
    v_mov_b32 v21, 163456
    ds_read_b32 v14, v21 offset:4
    v_and_b32 v18, 1, v4
    v_bfe_u32 v6, v2, 2, 2
    v_lshl_add_u32 v18, v18, 2, v6
    v_lshrrev_b32 v19, 1, v18
    v_lshlrev_b32 v18, 7, v18
    v_and_b32 v7, 3, v2
    v_lshl_add_u32 v18, v7, 3, v18
    v_lshrrev_b32 v6, 1, v4
    v_lshl_add_u32 v18, v6, 11, v18
    s_and_b32 s9, s3, 3
    v_xor_b32 v19, s9, v19
    v_lshl_add_u32 v18, v19, 5, v18
    s_lshr_b32 s8, s3, 2
    s_lshl_b32 s8, s8, 13
    v_add_u32 v8, s8, v18
    v_add_u32 v9, 49152, v8
    v_add_u32 v10, 98304, v8
    v_lshrrev_b32 v11, 1, v3
    v_mul_u32_u24 v11, 1344, v11
    v_lshl_add_u32 v11, v4, 5, v11
    v_and_b32 v22, 1, v2
    v_lshl_add_u32 v11, v22, 4, v11
    v_add_u32 v11, 147456, v11
    v_mul_u32_u24 v22, 0xaaaa, v22
    v_add_u32 v22, 0x4444, v22
    v_mov_b32 v132, 0
    v_mov_b32 v133, 0
    v_mov_b32 v134, 0
    v_mov_b32 v135, 0
    v_lshrrev_b32 v12, 2, v3
    v_mul_u32_u24 v17, 2688, v12
    v_mul_u32_u24 v12, 1152, v12
    v_lshl_add_u32 v12, v7, 4, v12
    v_lshl_add_u32 v12, v6, 6, v12
    s_lshl_b32 s8, s5, 3
    s_sub_u32 s8, s8, 80
    s_cmp_lt_u32 s2, 80
    s_cselect_b32 s8, 32, s8
    s_cselect_b32 s13, 4, 8
    s_cselect_b32 s15, 8, 6
    s_add_u32 s8, s8, s3
    s_mul_i32 s8, s8, 4608
    s_lshl_b32 s9, s4, 7
    s_add_u32 s8, s8, s9
    s_add_u32 s8, s8, 352256
    v_add_u32 v12, s8, v12
    s_sub_u32 s9, s3, 3
    s_mul_i32 s8, s4, 9
    s_add_u32 s8, s8, s9
    s_lshl_b32 s8, s8, 12
    s_add_u32 s8, s8, 57344
    v_lshl_add_u32 v16, v2, 5, s8
    v_lshl_add_u32 v17, v4, 5, v17
    v_lshl_add_u32 v17, v7, 3, v17
    s_lshl_b32 s9, s9, 7
    s_add_u32 s9, s9, 147456
    v_add_u32 v17, s9, v17
    s_mov_b32 s10, 0xffff
    s_mov_b32 s11, 0xffff
    s_movk_i32 s78, 0xff
    s_mov_b32 s76, 0x07060302
    s_cmp_ge_u32 s3, s15
    s_cbranch_scc1 DN_NL
    v_mov_b32 v23, 1
    s_cmp_lt_u32 s2, 80
    s_cbranch_scc1 DN_LS
    s_waitcnt vmcnt(5)
    s_branch DN_LP
DN_LS:
    s_waitcnt vmcnt(2)
DN_LP:
    s_mov_b64 exec, 1
    ds_add_u32 v21, v23 offset:160
    s_mov_b64 exec, -1
DN_NL:
    s_cmp_ge_u32 s3, s13
    s_cbranch_scc1 DN_NOF
    s_mov_b32 s9, 0
SPN2:
    ds_read_b32 v23, v21 offset:160
    s_add_u32 s9, s9, 1
    s_waitcnt lgkmcnt(0)
    v_cmp_ne_u32 vcc, s15, v23
    s_cmp_ge_u32 s9, 0x40000
    s_cbranch_scc1 SPX2
    s_cbranch_vccz SPX2
    s_sleep 2
    s_branch SPN2
SPX2:
    ds_read_b64_tr_b16 v[24:25], v8 offset:0
    ds_read_b64_tr_b16 v[26:27], v8 offset:1024
    ds_read_b64_tr_b16 v[28:29], v8 offset:4096
    ds_read_b64_tr_b16 v[30:31], v8 offset:5120
    ds_read_b64_tr_b16 v[32:33], v8 offset:16384
    ds_read_b64_tr_b16 v[34:35], v8 offset:17408
    ds_read_b64_tr_b16 v[36:37], v8 offset:20480
    ds_read_b64_tr_b16 v[38:39], v8 offset:21504
    ds_read_b64_tr_b16 v[40:41], v8 offset:32768
    ds_read_b64_tr_b16 v[42:43], v8 offset:33792
    ds_read_b64_tr_b16 v[44:45], v8 offset:36864
    ds_read_b64_tr_b16 v[46:47], v8 offset:37888
    ds_read_b64_tr_b16 v[48:49], v9 offset:0
    ds_read_b64_tr_b16 v[50:51], v9 offset:1024
    ds_read_b64_tr_b16 v[52:53], v9 offset:4096
    ds_read_b64_tr_b16 v[54:55], v9 offset:5120
    ds_read_b64_tr_b16 v[56:57], v9 offset:16384
    ds_read_b64_tr_b16 v[58:59], v9 offset:17408
    ds_read_b64_tr_b16 v[60:61], v9 offset:20480
    ds_read_b64_tr_b16 v[62:63], v9 offset:21504
    ds_read_b64_tr_b16 v[64:65], v9 offset:32768
    ds_read_b64_tr_b16 v[66:67], v9 offset:33792
    ds_read_b64_tr_b16 v[68:69], v9 offset:36864
    ds_read_b64_tr_b16 v[70:71], v9 offset:37888
    ds_read_b64_tr_b16 v[72:73], v10 offset:0
    ds_read_b64_tr_b16 v[74:75], v10 offset:1024
    ds_read_b64_tr_b16 v[76:77], v10 offset:4096
    ds_read_b64_tr_b16 v[78:79], v10 offset:5120
DN_NOF:
    s_waitcnt vmcnt(0) lgkmcnt(0)
    s_barrier
    s_cmp_ge_u32 s3, s13
    s_cbranch_scc1 DN_NOF2
    ds_read_b64_tr_b16 v[80:81], v10 offset:16384
    ds_read_b64_tr_b16 v[82:83], v10 offset:17408
    ds_read_b64_tr_b16 v[84:85], v10 offset:20480
    ds_read_b64_tr_b16 v[86:87], v10 offset:21504
    ds_read_b64_tr_b16 v[88:89], v10 offset:32768
    ds_read_b64_tr_b16 v[90:91], v10 offset:33792
    ds_read_b64_tr_b16 v[92:93], v10 offset:36864
    ds_read_b64_tr_b16 v[94:95], v10 offset:37888
DN_NOF2:
    s_cmp_lt_u32 s3, 3
    s_cbranch_scc1 DN_W
    s_mov_b32 s12, 0
DN_POLL:
    s_add_u32 s12, s12, 1
    s_and_b32 s8, s12, 63
    s_cselect_b32 s8, 0, 2048
    v_add_u32 v20, s8, v16
    global_load_dwordx4 v[96:99], v20, s[50:51] sc1
    global_load_dwordx4 v[100:103], v20, s[50:51] offset:16 sc1
    s_waitcnt vmcnt(0)
    v_xor_b32 v20, v96, v14
    v_bitop3_b32 v20, v20, v97, v14 bitop3:0xf6
    v_bitop3_b32 v20, v20, v98, v14 bitop3:0xf6
    v_bitop3_b32 v20, v20, v99, v14 bitop3:0xf6
    v_bitop3_b32 v20, v20, v100, v14 bitop3:0xf6
    v_bitop3_b32 v20, v20, v101, v14 bitop3:0xf6
    v_bitop3_b32 v20, v20, v102, v14 bitop3:0xf6
    v_bitop3_b32 v20, v20, v103, v14 bitop3:0xf6
    v_and_b32 v20, 0xffff, v20
    v_cmp_ne_u32 vcc, 0, v20
    s_cmp_ge_u32 s12, 65536
    s_cbranch_scc1 DN_GOT
    s_cbranch_vccnz DN_POLL
DN_GOT:
    v_perm_b32 v104, v98, v96, s76
    v_perm_b32 v105, v102, v100, s76
    v_perm_b32 v106, v99, v97, s76
    v_perm_b32 v107, v103, v101, s76
    ds_write_b64 v17, v[104:105]
    ds_write_b64 v17, v[106:107] offset:1344
DN_W:
    s_waitcnt lgkmcnt(0)
    s_barrier
    s_cmp_ge_u32 s3, s13
    s_cbranch_scc1 W_END
    ds_read_b128 v[96:99], v11 offset:0
    ds_read_b128 v[100:103], v11 offset:128
    ds_read_b128 v[104:107], v11 offset:256
    ds_read_b128 v[108:111], v11 offset:384
    ds_read_b128 v[112:115], v11 offset:512
    ds_read_b128 v[116:119], v11 offset:640
    ds_read_b128 v[120:123], v11 offset:768
    ds_read_b128 v[124:127], v11 offset:896
    ds_read_b128 v[128:131], v11 offset:1024
    s_waitcnt lgkmcnt(8)
    v_smfmac_f32_16x16x64_bf16 v[132:135], v[96:99], v[24:31], v22
    s_waitcnt lgkmcnt(7)
    v_smfmac_f32_16x16x64_bf16 v[132:135], v[100:103], v[32:39], v22
    s_waitcnt lgkmcnt(6)
    v_smfmac_f32_16x16x64_bf16 v[132:135], v[104:107], v[40:47], v22
    s_waitcnt lgkmcnt(5)
    v_smfmac_f32_16x16x64_bf16 v[132:135], v[108:111], v[48:55], v22
    s_waitcnt lgkmcnt(4)
    v_smfmac_f32_16x16x64_bf16 v[132:135], v[112:115], v[56:63], v22
    s_waitcnt lgkmcnt(3)
    v_smfmac_f32_16x16x64_bf16 v[132:135], v[116:119], v[64:71], v22
    s_waitcnt lgkmcnt(2)
    v_smfmac_f32_16x16x64_bf16 v[132:135], v[120:123], v[72:79], v22
    s_waitcnt lgkmcnt(1)
    v_smfmac_f32_16x16x64_bf16 v[132:135], v[124:127], v[80:87], v22
    s_waitcnt lgkmcnt(0)
    v_smfmac_f32_16x16x64_bf16 v[132:135], v[128:131], v[88:95], v22
    s_nop 7
    v_add_f32 v136, v132, v133
    v_add_f32 v137, v134, v135
    v_bfi_b32 v138, s78, v14, v136
    v_bfi_b32 v139, s78, v14, v137
    v_bfi_b32 v136, s78, v14, v136
    v_bfi_b32 v137, s78, v14, v137
    s_nop 0
    v_permlane16_swap_b32 v136, v138
    v_permlane16_swap_b32 v137, v139
    s_mov_b64 exec, s[10:11]
    global_store_dwordx4 v12, v[136:139], s[50:51] sc1
    s_cmp_lg_u32 s3, 3
    s_cbranch_scc1 DN_NOHINT
    s_lshl_b32 s8, s4, 7
    s_lshl_b32 s9, s5, 2
    s_add_u32 s8, s8, s9
    v_mov_b32 v20, s8
    global_store_dword v20, v14, s[50:51] offset:2268
    s_cmp_lg_u32 s2, 72
    s_cbranch_scc1 DN_NOHINT
    v_mov_b32 v20, 0
    global_store_dword v20, v14, s[50:51] sc1
DN_NOHINT:
    s_endpgm
F_MAIN:
    v_and_b32 v7, 7, v2
    s_add_u32 m0, s15, 0
    s_add_u32 s8, s14, 0
    buffer_load_dwordx4 v5, s[52:55], s8 offen  lds
    s_add_u32 m0, s15, 73728
    s_add_u32 s8, s14, 0
    buffer_load_dwordx4 v5, s[56:59], s8 offen  lds
    s_and_b32 s12, s3, 3
    v_and_b32 v18, 1, v4
    v_bfe_u32 v6, v2, 2, 2
    v_lshl_add_u32 v18, v18, 2, v6
    v_lshrrev_b32 v6, 1, v18
    v_xor_b32 v6, s12, v6
    v_lshlrev_b32 v18, 7, v18
    v_lshl_add_u32 v18, v6, 5, v18
    v_and_b32 v6, 3, v2
    v_lshl_add_u32 v18, v6, 3, v18
    v_lshrrev_b32 v6, 1, v4
    v_lshl_add_u32 v18, v6, 11, v18
    v_add_u32 v6, 73728, v18
    v_add_u32 v0, 40960, v18
    v_add_u32 v1, 40960, v6
    v_lshrrev_b32 v8, 1, v3
    v_mul_u32_u24 v8, 1344, v8
    v_lshl_add_u32 v8, v4, 5, v8
    v_and_b32 v9, 1, v2
    v_lshl_add_u32 v8, v9, 4, v8
    v_add_u32 v8, 147456, v8
    v_mul_u32_u24 v9, 0xaaaa, v9
    v_add_u32 v9, 0x4444, v9
    s_lshl_b32 s8, s6, 12
    s_lshl_b32 s9, s3, 9
    s_add_u32 s8, s8, s9
    s_add_u32 s8, s8, 57344
    v_lshl_add_u32 v11, v2, 3, s8
    s_mov_b32 s76, 0xffff
    v_mov_b32 v21, 163456
    v_mov_b32 v22, 1
    s_mov_b32 s10, 0xff00ff00
    s_mov_b32 s11, 0xff00ff00
    s_waitcnt vmcnt(0)
    s_add_u32 m0, s15, 8192
    s_add_u32 s8, s14, 589824
    buffer_load_dwordx4 v5, s[52:55], s8 offen  lds
    s_add_u32 m0, s15, 81920
    s_add_u32 s8, s14, 589824
    buffer_load_dwordx4 v5, s[56:59], s8 offen  lds
    s_add_u32 m0, s15, 16384
    s_add_u32 s8, s14, 1179648
    buffer_load_dwordx4 v5, s[52:55], s8 offen  lds
    v_mov_b32 v160, 0
    v_mov_b32 v161, 0
    v_mov_b32 v162, 0
    v_mov_b32 v163, 0
    v_mov_b32 v164, 0
    v_mov_b32 v165, 0
    v_mov_b32 v166, 0
    v_mov_b32 v167, 0
    s_barrier
    ds_read_b32 v14, v21 offset:4
    s_add_u32 m0, s15, 90112
    s_add_u32 s8, s14, 1179648
    buffer_load_dwordx4 v5, s[56:59], s8 offen  lds
    s_waitcnt vmcnt(3)
    s_add_u32 m0, s15, 24576
    s_add_u32 s8, s14, 1769472
    buffer_load_dwordx4 v5, s[52:55], s8 offen  lds
    s_waitcnt vmcnt(3)
    s_add_u32 m0, s15, 98304
    s_add_u32 s8, s14, 1769472
    buffer_load_dwordx4 v5, s[56:59], s8 offen  lds
    s_waitcnt vmcnt(3)
    s_add_u32 m0, s15, 32768
    s_add_u32 s8, s14, 2359296
    buffer_load_dwordx4 v5, s[52:55], s8 offen  lds
    s_waitcnt vmcnt(3)
    s_add_u32 m0, s15, 106496
    s_add_u32 s8, s14, 2359296
    buffer_load_dwordx4 v5, s[56:59], s8 offen  lds
    s_waitcnt vmcnt(3)
    s_add_u32 m0, s15, 40960
    s_add_u32 s8, s14, 2949120
    buffer_load_dwordx4 v5, s[52:55], s8 offen  lds
    s_waitcnt vmcnt(3)
    s_add_u32 m0, s15, 114688
    s_add_u32 s8, s14, 2949120
    buffer_load_dwordx4 v5, s[56:59], s8 offen  lds
    s_waitcnt vmcnt(3)
    s_add_u32 m0, s15, 49152
    s_add_u32 s8, s14, 3538944
    buffer_load_dwordx4 v5, s[52:55], s8 offen  lds
    s_waitcnt vmcnt(3)
    s_add_u32 m0, s15, 122880
    s_add_u32 s8, s14, 3538944
    buffer_load_dwordx4 v5, s[56:59], s8 offen  lds
    s_waitcnt vmcnt(3)
    s_add_u32 m0, s15, 57344
    s_add_u32 s8, s14, 4128768
    buffer_load_dwordx4 v5, s[52:55], s8 offen  lds
    s_waitcnt vmcnt(3)
    s_add_u32 m0, s15, 131072
    s_add_u32 s8, s14, 4128768
    buffer_load_dwordx4 v5, s[56:59], s8 offen  lds
    s_waitcnt vmcnt(3)
    s_add_u32 m0, s15, 65536
    s_add_u32 s8, s14, 4718592
    buffer_load_dwordx4 v5, s[52:55], s8 offen  lds
    s_waitcnt vmcnt(3)
    s_add_u32 m0, s15, 139264
    s_add_u32 s8, s14, 4718592
    buffer_load_dwordx4 v5, s[56:59], s8 offen  lds
    s_waitcnt vmcnt(4)
    s_mov_b64 exec, 1
    ds_add_u32 v21, v22 offset:160
    s_mov_b64 exec, -1
    s_cmp_ge_u32 s3, 4
    s_cbranch_scc1 F_LD
    s_mov_b32 s9, 0
SPN3:
    ds_read_b32 v23, v21 offset:160
    s_add_u32 s9, s9, 1
    s_waitcnt lgkmcnt(0)
    v_cmp_ne_u32 vcc, 8, v23
    s_cmp_ge_u32 s9, 0x40000
    s_cbranch_scc1 SPX3
    s_cbranch_vccnz SPN3
SPX3:
    ds_read_b64_tr_b16 v[24:25], v18 offset:0
    ds_read_b64_tr_b16 v[26:27], v18 offset:1024
    ds_read_b64_tr_b16 v[28:29], v18 offset:4096
    ds_read_b64_tr_b16 v[30:31], v18 offset:5120
    ds_read_b64_tr_b16 v[32:33], v6 offset:0
    ds_read_b64_tr_b16 v[34:35], v6 offset:1024
    ds_read_b64_tr_b16 v[36:37], v6 offset:4096
    ds_read_b64_tr_b16 v[38:39], v6 offset:5120
    ds_read_b64_tr_b16 v[40:41], v18 offset:8192
    ds_read_b64_tr_b16 v[42:43], v18 offset:9216
    ds_read_b64_tr_b16 v[44:45], v18 offset:12288
    ds_read_b64_tr_b16 v[46:47], v18 offset:13312
    ds_read_b64_tr_b16 v[48:49], v6 offset:8192
    ds_read_b64_tr_b16 v[50:51], v6 offset:9216
    ds_read_b64_tr_b16 v[52:53], v6 offset:12288
    ds_read_b64_tr_b16 v[54:55], v6 offset:13312
    ds_read_b64_tr_b16 v[56:57], v18 offset:16384
    ds_read_b64_tr_b16 v[58:59], v18 offset:17408
    ds_read_b64_tr_b16 v[60:61], v18 offset:20480
    ds_read_b64_tr_b16 v[62:63], v18 offset:21504
    ds_read_b64_tr_b16 v[64:65], v6 offset:16384
    ds_read_b64_tr_b16 v[66:67], v6 offset:17408
    ds_read_b64_tr_b16 v[68:69], v6 offset:20480
    ds_read_b64_tr_b16 v[70:71], v6 offset:21504
    ds_read_b64_tr_b16 v[72:73], v18 offset:24576
    ds_read_b64_tr_b16 v[74:75], v18 offset:25600
    ds_read_b64_tr_b16 v[76:77], v18 offset:28672
    ds_read_b64_tr_b16 v[78:79], v18 offset:29696
    ds_read_b64_tr_b16 v[80:81], v6 offset:24576
    ds_read_b64_tr_b16 v[82:83], v6 offset:25600
    ds_read_b64_tr_b16 v[84:85], v6 offset:28672
    ds_read_b64_tr_b16 v[86:87], v6 offset:29696
    ds_read_b64_tr_b16 v[88:89], v18 offset:32768
    ds_read_b64_tr_b16 v[90:91], v18 offset:33792
    ds_read_b64_tr_b16 v[92:93], v18 offset:36864
    ds_read_b64_tr_b16 v[94:95], v18 offset:37888
    ds_read_b64_tr_b16 v[96:97], v6 offset:32768
    ds_read_b64_tr_b16 v[98:99], v6 offset:33792
    ds_read_b64_tr_b16 v[100:101], v6 offset:36864
    ds_read_b64_tr_b16 v[102:103], v6 offset:37888
    ds_read_b64_tr_b16 v[104:105], v0 offset:0
    ds_read_b64_tr_b16 v[106:107], v0 offset:1024
    ds_read_b64_tr_b16 v[108:109], v0 offset:4096
    ds_read_b64_tr_b16 v[110:111], v0 offset:5120
    ds_read_b64_tr_b16 v[112:113], v1 offset:0
    ds_read_b64_tr_b16 v[114:115], v1 offset:1024
    ds_read_b64_tr_b16 v[116:117], v1 offset:4096
    ds_read_b64_tr_b16 v[118:119], v1 offset:5120
    ds_read_b64_tr_b16 v[120:121], v0 offset:8192
    ds_read_b64_tr_b16 v[122:123], v0 offset:9216
    ds_read_b64_tr_b16 v[124:125], v0 offset:12288
    ds_read_b64_tr_b16 v[126:127], v0 offset:13312
    ds_read_b64_tr_b16 v[128:129], v1 offset:8192
    ds_read_b64_tr_b16 v[130:131], v1 offset:9216
    ds_read_b64_tr_b16 v[132:133], v1 offset:12288
    ds_read_b64_tr_b16 v[134:135], v1 offset:13312
    s_mov_b32 s9, 0
SPN4:
    ds_read_b32 v23, v21 offset:164
    s_add_u32 s9, s9, 1
    s_waitcnt lgkmcnt(0)
    v_cmp_eq_u32 vcc, 0, v23
    s_cmp_ge_u32 s9, 0x40000
    s_cbranch_scc1 SPX4
    s_cbranch_vccnz SPN4
SPX4:
    ds_read_b128 v[136:139], v8 offset:0
    ds_read_b128 v[140:143], v8 offset:128
    ds_read_b128 v[144:147], v8 offset:256
    ds_read_b128 v[148:151], v8 offset:384
    ds_read_b128 v[152:155], v8 offset:512
    ds_read_b128 v[156:159], v8 offset:640
    s_waitcnt lgkmcnt(5)
    v_smfmac_f32_16x16x64_bf16 v[160:163], v[136:139], v[24:31], v9
    v_smfmac_f32_16x16x64_bf16 v[164:167], v[136:139], v[32:39], v9
    s_waitcnt lgkmcnt(4)
    v_smfmac_f32_16x16x64_bf16 v[160:163], v[140:143], v[40:47], v9
    v_smfmac_f32_16x16x64_bf16 v[164:167], v[140:143], v[48:55], v9
    ds_read_b128 v[136:139], v8 offset:768
    s_waitcnt lgkmcnt(4)
    v_smfmac_f32_16x16x64_bf16 v[160:163], v[144:147], v[56:63], v9
    v_smfmac_f32_16x16x64_bf16 v[164:167], v[144:147], v[64:71], v9
    ds_read_b128 v[140:143], v8 offset:896
    s_waitcnt lgkmcnt(4)
    v_smfmac_f32_16x16x64_bf16 v[160:163], v[148:151], v[72:79], v9
    v_smfmac_f32_16x16x64_bf16 v[164:167], v[148:151], v[80:87], v9
    ds_read_b128 v[144:147], v8 offset:1024
    s_waitcnt lgkmcnt(4)
    v_smfmac_f32_16x16x64_bf16 v[160:163], v[152:155], v[88:95], v9
    v_smfmac_f32_16x16x64_bf16 v[164:167], v[152:155], v[96:103], v9
    s_waitcnt lgkmcnt(3)
    v_smfmac_f32_16x16x64_bf16 v[160:163], v[156:159], v[104:111], v9
    v_smfmac_f32_16x16x64_bf16 v[164:167], v[156:159], v[112:119], v9
    s_waitcnt lgkmcnt(2)
    v_smfmac_f32_16x16x64_bf16 v[160:163], v[136:139], v[120:127], v9
    v_smfmac_f32_16x16x64_bf16 v[164:167], v[136:139], v[128:135], v9
F_LD:
    s_waitcnt vmcnt(0)
    s_barrier
    s_cmp_ge_u32 s3, 4
    s_cbranch_scc1 RELAY
    ds_read_b64_tr_b16 v[24:25], v0 offset:16384
    ds_read_b64_tr_b16 v[26:27], v0 offset:17408
    ds_read_b64_tr_b16 v[28:29], v0 offset:20480
    ds_read_b64_tr_b16 v[30:31], v0 offset:21504
    ds_read_b64_tr_b16 v[32:33], v1 offset:16384
    ds_read_b64_tr_b16 v[34:35], v1 offset:17408
    ds_read_b64_tr_b16 v[36:37], v1 offset:20480
    ds_read_b64_tr_b16 v[38:39], v1 offset:21504
    ds_read_b64_tr_b16 v[40:41], v0 offset:24576
    ds_read_b64_tr_b16 v[42:43], v0 offset:25600
    ds_read_b64_tr_b16 v[44:45], v0 offset:28672
    ds_read_b64_tr_b16 v[46:47], v0 offset:29696
    ds_read_b64_tr_b16 v[48:49], v1 offset:24576
    ds_read_b64_tr_b16 v[50:51], v1 offset:25600
    ds_read_b64_tr_b16 v[52:53], v1 offset:28672
    ds_read_b64_tr_b16 v[54:55], v1 offset:29696
    s_waitcnt lgkmcnt(12)
    v_smfmac_f32_16x16x64_bf16 v[160:163], v[140:143], v[24:31], v9
    s_waitcnt lgkmcnt(8)
    v_smfmac_f32_16x16x64_bf16 v[164:167], v[140:143], v[32:39], v9
    s_waitcnt lgkmcnt(4)
    v_smfmac_f32_16x16x64_bf16 v[160:163], v[144:147], v[40:47], v9
    s_waitcnt lgkmcnt(0)
    v_smfmac_f32_16x16x64_bf16 v[164:167], v[144:147], v[48:55], v9
    s_nop 6
    v_add_f32 v24, v160, v161
    v_add_f32 v25, v162, v163
    v_add_f32 v26, v164, v165
    v_add_f32 v27, v166, v167
    v_cvt_pk_bf16_f32 v24, 0, v24
    v_cvt_pk_bf16_f32 v25, 0, v25
    v_cvt_pk_bf16_f32 v26, 0, v26
    v_cvt_pk_bf16_f32 v27, 0, v27
    v_mul_f32 v28, 0xbfb8aa3b, v24
    v_mul_f32 v29, 0xbfb8aa3b, v25
    v_exp_f32 v28, v28
    v_exp_f32 v29, v29
    v_add_f32 v28, 1.0, v28
    v_add_f32 v29, 1.0, v29
    v_rcp_f32 v28, v28
    v_rcp_f32 v29, v29
    v_mul_f32 v24, v24, v28
    v_mul_f32 v25, v25, v29
    v_cvt_pk_bf16_f32 v24, 0, v24
    v_cvt_pk_bf16_f32 v25, 0, v25
    v_mul_f32 v24, v24, v26
    v_mul_f32 v25, v25, v27
    v_cvt_pk_bf16_f32 v24, 0, v24
    v_cvt_pk_bf16_f32 v25, 0, v25
    v_bfi_b32 v24, s76, v14, v24
    v_bfi_b32 v25, s76, v14, v25
    global_store_dwordx2 v11, v[24:25], s[50:51]
    global_store_dwordx2 v11, v[24:25], s[50:51] offset:2048 sc1
RELAY:
    s_cmp_ge_u32 s2, 64
    s_cbranch_scc1 W_END
    v_mov_b32 v30, 163200
    ds_read_b128 v[32:35], v30
    ds_read_b128 v[36:39], v30 offset:16
    s_xor_b32 s12, s3, 4
    s_lshl_b32 s8, s12, 12
    s_lshl_b32 s9, s2, 6
    s_add_u32 s8, s8, s9
    s_add_u32 s8, s8, 1048576
    v_mul_u32_u24 v30, 32896, v3
    v_lshl_add_u32 v30, v4, 4, v30
    v_add_u32 v30, s8, v30
    s_lshl_b32 s8, s12, 8
    s_and_b32 s9, s2, 15
    s_lshl_b32 s9, s9, 4
    s_add_u32 s8, s8, s9
    s_lshr_b32 s9, s2, 4
    s_add_u32 s8, s8, s9
    v_lshl_add_u32 v31, v4, 2, s8
    v_mul_u32_u24 v31, 1152, v31
    s_mov_b64 s[72:73], -1
    s_waitcnt lgkmcnt(0)
    v_cmp_ne_u32 vcc, v31, v32
    s_and_b64 s[72:73], s[72:73], vcc
    v_cmp_ne_u32 vcc, v31, v33
    s_and_b64 s[72:73], s[72:73], vcc
    v_cmp_ne_u32 vcc, v31, v34
    s_and_b64 s[72:73], s[72:73], vcc
    v_cmp_ne_u32 vcc, v31, v35
    s_and_b64 s[72:73], s[72:73], vcc
    v_cmp_ne_u32 vcc, v31, v36
    s_and_b64 s[72:73], s[72:73], vcc
    v_cmp_ne_u32 vcc, v31, v37
    s_and_b64 s[72:73], s[72:73], vcc
    v_cmp_ne_u32 vcc, v31, v38
    s_and_b64 s[72:73], s[72:73], vcc
    v_cmp_ne_u32 vcc, v31, v39
    s_and_b64 s[72:73], s[72:73], vcc
    v_lshl_add_u32 v31, v3, 3, v31
    s_cmp_lt_u32 s12, 2
    s_cbranch_scc1 RL_GO
    s_cmp_lg_u32 s3, 3
    s_cbranch_scc1 RL_B
    s_lshl_b32 s8, s4, 7
    v_mov_b32 v40, s8
    s_mov_b32 s9, 0
RL_H:
    s_sleep 2
    global_load_dword v41, v40, s[50:51] offset:2308 sc1
    s_add_u32 s9, s9, 1
    s_waitcnt vmcnt(0)
    v_cmp_ne_u32 vcc, v41, v14
    s_cmp_ge_u32 s9, 64
    s_cbranch_scc1 RL_B
    s_cbranch_vccnz RL_H
RL_B:
    s_barrier
RL_GO:
    s_mov_b32 s9, 0
RL_P:
    global_load_dwordx4 v[44:47], v30, s[50:51] sc1
    s_add_u32 s9, s9, 1
    s_waitcnt vmcnt(0)
    v_xor_b32 v41, v44, v14
    v_bitop3_b32 v41, v41, v45, v14 bitop3:0xf6
    v_cmp_ne_u32 vcc, 0, v41
    s_cmp_ge_u32 s9, 16384
    s_cbranch_scc1 RL_X
    s_cbranch_vccz RL_X
    s_mov_b64 exec, vcc
    s_sleep 3
    s_branch RL_P
RL_X:
    s_mov_b64 exec, s[72:73]
    s_cbranch_execz W_END
    global_store_dwordx2 v31, v[46:47], s[46:47] offset:1024
    s_endpgm
SEL_MAIN:
    v_min_u32 v19, 8, v2
    v_lshlrev_b32 v19, 7, v19
    v_lshlrev_b32 v20, 2, v2
    v_lshrrev_b32 v24, 2, v2
    v_mul_u32_u24 v24, 256, v24
    v_and_b32 v37, 3, v2
    v_lshl_add_u32 v24, v37, 4, v24
    v_lshrrev_b32 v36, 1, v2
    v_mul_u32_u24 v36, 256, v36
    v_and_b32 v37, 1, v2
    v_lshl_add_u32 v36, v37, 4, v36
    v_add_u32 v36, 20544, v36
    s_mul_i32 s8, s3, 4096
    v_add_u32 v24, s8, v24
    s_cmp_eq_u32 s3, 7
    s_cselect_b64 vcc, -1, 0
    v_cndmask_b32 v24, v24, v36, vcc
    v_add_u32 v24, 4096, v24
    s_lshl_b32 s8, s3, 8
    s_sub_u32 s8, 0xfff, s8
    v_sub_u32 v32, s8, v20
    v_subrev_u32 v33, 1, v32
    v_subrev_u32 v34, 2, v32
    v_subrev_u32 v35, 3, v32
    v_mov_b32 v21, 163456
    s_lshl_b32 s8, s3, 5
    s_add_u32 s8, s8, 163200
    v_lshl_add_u32 v25, v4, 3, s8
    s_mov_b32 s74, 0x01010101
    s_mov_b32 s75, 0x01010101
    s_lshl_b32 s9, s4, 10
    s_add_u32 s9, s9, 40960
    v_lshl_add_u32 v53, v2, 4, s9
    global_load_dword v54, v53, s[50:51] sc1
    v_lshrrev_b32 v52, 3, v2
    v_lshl_add_u32 v52, v52, 6, s9
    v_and_b32 v27, 28, v20
    v_add_u32 v27, s8, v27
    v_add_u32 v26, 163200, v20
    s_mov_b32 s76, 0xffff
    s_mov_b32 s10, 0x00010001
    s_mov_b32 s11, 0x00010001
    s_barrier
    ds_read_b32 v14, v21 offset:4
    s_mov_b32 s7, 0
    s_waitcnt lgkmcnt(0)
    s_waitcnt vmcnt(0)
F_POLL:
    global_load_dwordx4 v[28:31], v24, s[50:51] sc1
    s_add_u32 s7, s7, 1
    s_waitcnt vmcnt(0)
    v_xor_b32 v36, v28, v14
    v_bitop3_b32 v36, v36, v29, v14 bitop3:0xf6
    v_bitop3_b32 v36, v36, v30, v14 bitop3:0xf6
    v_bitop3_b32 v36, v36, v31, v14 bitop3:0xf6
    v_and_b32 v36, 0xffff, v36
    v_cmp_ne_u32 vcc, 0, v36
    s_cmp_ge_u32 s7, 16384
    s_cbranch_scc1 F_GOT
    s_cbranch_vccz F_GOT
    s_mov_b64 exec, vcc
    s_sleep 4
    s_branch F_POLL
F_GOT:
    s_mov_b64 exec, -1
    global_load_dword v56, v24, s[50:51] offset:128 sc1
    v_bfi_b32 v28, s76, v32, v28
    v_bfi_b32 v29, s76, v33, v29
    v_bfi_b32 v30, s76, v34, v30
    v_bfi_b32 v31, s76, v35, v31
    v_max_u32 v36, v28, v29
    v_min_u32 v37, v28, v29
    v_max3_u32 v40, v36, v30, v31
    v_med3_u32 v41, v36, v30, v31
    v_med3_u32 v42, v37, v30, v31
    v_max_u32 v41, v41, v37
    v_min_u32 v42, v42, v36
    v_max_u32_dpp v44, v40, v40 row_ror:8 row_mask:0xf bank_mask:0xf
    s_nop 1
    v_max_u32_dpp v44, v44, v44 row_ror:4 row_mask:0xf bank_mask:0xf
    s_nop 1
    v_max_u32_dpp v44, v44, v44 row_ror:2 row_mask:0xf bank_mask:0xf
    s_nop 1
    v_max_u32_dpp v44, v44, v44 row_ror:1 row_mask:0xf bank_mask:0xf
    v_cmp_eq_u32 vcc, v40, v44
    s_nop 1
    v_cndmask_b32 v40, v40, v41, vcc
    v_cndmask_b32 v41, v41, v42, vcc
    s_nop 0
    v_max_u32_dpp v45, v40, v40 row_ror:8 row_mask:0xf bank_mask:0xf
    s_nop 1
    v_max_u32_dpp v45, v45, v45 row_ror:4 row_mask:0xf bank_mask:0xf
    s_nop 1
    v_max_u32_dpp v45, v45, v45 row_ror:2 row_mask:0xf bank_mask:0xf
    s_nop 1
    v_max_u32_dpp v45, v45, v45 row_ror:1 row_mask:0xf bank_mask:0xf
    v_cmp_eq_u32 vcc, v40, v45
    s_nop 1
    v_cndmask_b32 v40, v40, v41, vcc
    s_nop 1
    v_max_u32_dpp v46, v40, v40 row_ror:8 row_mask:0xf bank_mask:0xf
    s_nop 1
    v_max_u32_dpp v46, v46, v46 row_ror:4 row_mask:0xf bank_mask:0xf
    s_nop 1
    v_max_u32_dpp v46, v46, v46 row_ror:2 row_mask:0xf bank_mask:0xf
    s_nop 1
    v_max_u32_dpp v46, v46, v46 row_ror:1 row_mask:0xf bank_mask:0xf
    s_mov_b64 exec, s[10:11]
    ds_write_b64 v25, v[44:45]
    ds_max_u32 v21, v46
    s_mov_b64 exec, -1
    v_readlane_b32 s77, v44, 0
    v_readlane_b32 s78, v45, 0
    v_readlane_b32 s79, v44, 16
    v_readlane_b32 s80, v45, 16
    v_readlane_b32 s81, v44, 32
    v_readlane_b32 s82, v45, 32
    v_readlane_b32 s83, v44, 48
    v_readlane_b32 s100, v45, 48
    ds_read_b32 v48, v27
    v_mov_b32 v49, v14
    s_lshl_b32 s72, s4, 8
    s_lshl_b32 s73, s4, 10
    s_add_u32 s73, s73, 49152
    s_waitcnt lgkmcnt(0)
    s_barrier
    ds_read_b32 v36, v26
    ds_read_b32 v37, v21
    v_not_b32 v50, v48
    v_and_b32 v50, 0x7ff, v50
    v_mul_u32_u24 v50, 1152, v50
    s_waitcnt lgkmcnt(0)
    v_cmp_gt_u32 vcc, v36, v37
    v_cmp_lt_u32 s[18:19], s77, v36
    v_cmp_lt_u32 s[20:21], s78, v36
    v_cmp_lt_u32 s[22:23], s79, v36
    v_cmp_lt_u32 s[24:25], s80, v36
    v_cmp_lt_u32 s[26:27], s81, v36
    v_cmp_lt_u32 s[28:29], s82, v36
    v_cmp_lt_u32 s[30:31], s83, v36
    v_cmp_lt_u32 s[34:35], s100, v36
    s_bcnt1_i32_b64 s8, vcc
    s_mov_b64 s[80:81], 0
    s_cmp_lt_u32 s8, 8
    s_cbranch_scc1 F_SLOW
    s_bcnt1_i32_b64 s18, s[18:19]
    s_lshl_b64 exec, s[74:75], 0
    v_mov_b32 v37, s18
    s_bcnt1_i32_b64 s20, s[20:21]
    s_lshl_b64 exec, s[74:75], 1
    v_mov_b32 v37, s20
    s_bcnt1_i32_b64 s22, s[22:23]
    s_lshl_b64 exec, s[74:75], 2
    v_mov_b32 v37, s22
    s_bcnt1_i32_b64 s24, s[24:25]
    s_lshl_b64 exec, s[74:75], 3
    v_mov_b32 v37, s24
    s_bcnt1_i32_b64 s26, s[26:27]
    s_lshl_b64 exec, s[74:75], 4
    v_mov_b32 v37, s26
    s_bcnt1_i32_b64 s28, s[28:29]
    s_lshl_b64 exec, s[74:75], 5
    v_mov_b32 v37, s28
    s_bcnt1_i32_b64 s30, s[30:31]
    s_lshl_b64 exec, s[74:75], 6
    v_mov_b32 v37, s30
    s_bcnt1_i32_b64 s34, s[34:35]
    s_lshl_b64 exec, s[74:75], 7
    v_mov_b32 v37, s34
    s_mov_b64 exec, -1
    v_cmp_gt_u32 vcc, 8, v37
    v_lshl_add_u32 v52, v37, 3, v52
    v_lshl_add_u32 v55, v37, 7, s73
    v_lshl_add_u32 v37, v37, 3, s72
    s_and_b64 exec, vcc, exec
    s_cbranch_execz F_REST
    global_store_dwordx2 v52, v[48:49], s[50:51]
    global_store_dwordx2 v52, v[48:49], s[50:51] offset:512
    s_and_b64 exec, vcc, 0xff
    global_store_dwordx2 v37, v[48:49], s[50:51] offset:256
    global_load_dword v51, v50, s[16:17] offset:0
    global_load_dword v51, v50, s[16:17] offset:128
    global_load_dword v51, v50, s[16:17] offset:256
    global_load_dword v51, v50, s[16:17] offset:384
    global_load_dword v51, v50, s[16:17] offset:512
    global_load_dword v51, v50, s[16:17] offset:640
    global_load_dword v51, v50, s[16:17] offset:768
    global_load_dword v51, v50, s[16:17] offset:896
    global_load_dword v51, v50, s[16:17] offset:1024
    global_store_dwordx2 v55, v[48:49], s[50:51] sc1
F_REST:
    s_mov_b64 exec, -1
    s_branch DN_L2
F_SLOW:
    v_lshrrev_b32 v24, 2, v2
    v_mul_u32_u24 v24, 256, v24
    v_and_b32 v27, 3, v2
    v_lshl_add_u32 v24, v27, 4, v24
    v_lshrrev_b32 v26, 1, v2
    v_mul_u32_u24 v26, 256, v26
    v_and_b32 v27, 1, v2
    v_lshl_add_u32 v26, v27, 4, v26
    v_add_u32 v26, 20544, v26
    v_add_u32 v24, 4096, v24
    v_add_u32 v26, 4096, v26
    global_load_dwordx4 v[28:31], v24, s[50:51] sc1
    v_add_u32 v24, 4096, v24
    global_load_dwordx4 v[32:35], v24, s[50:51] sc1
    v_add_u32 v24, 4096, v24
    global_load_dwordx4 v[36:39], v24, s[50:51] sc1
    v_add_u32 v24, 4096, v24
    global_load_dwordx4 v[40:43], v24, s[50:51] sc1
    v_add_u32 v24, 4096, v24
    global_load_dwordx4 v[44:47], v24, s[50:51] sc1
    v_add_u32 v24, 4096, v24
    global_load_dwordx4 v[48:51], v24, s[50:51] sc1
    v_add_u32 v24, 4096, v24
    global_load_dwordx4 v[52:55], v24, s[50:51] sc1
    v_add_u32 v24, 4096, v24
    global_load_dwordx4 v[56:59], v26, s[50:51] sc1
    v_add_u32 v24, 4096, v24
    v_sub_u32 v24, 0xfff, v20
    s_waitcnt vmcnt(0)
    v_subrev_u32 v25, 0, v24
    v_bfi_b32 v28, s76, v25, v28
    v_subrev_u32 v25, 1, v24
    v_bfi_b32 v29, s76, v25, v29
    v_subrev_u32 v25, 2, v24
    v_bfi_b32 v30, s76, v25, v30
    v_subrev_u32 v25, 3, v24
    v_bfi_b32 v31, s76, v25, v31
    v_subrev_u32 v25, 256, v24
    v_bfi_b32 v32, s76, v25, v32
    v_subrev_u32 v25, 257, v24
    v_bfi_b32 v33, s76, v25, v33
    v_subrev_u32 v25, 258, v24
    v_bfi_b32 v34, s76, v25, v34
    v_subrev_u32 v25, 259, v24
    v_bfi_b32 v35, s76, v25, v35
    v_subrev_u32 v25, 512, v24
    v_bfi_b32 v36, s76, v25, v36
    v_subrev_u32 v25, 513, v24
    v_bfi_b32 v37, s76, v25, v37
    v_subrev_u32 v25, 514, v24
    v_bfi_b32 v38, s76, v25, v38
    v_subrev_u32 v25, 515, v24
    v_bfi_b32 v39, s76, v25, v39
    v_subrev_u32 v25, 768, v24
    v_bfi_b32 v40, s76, v25, v40
    v_subrev_u32 v25, 769, v24
    v_bfi_b32 v41, s76, v25, v41
    v_subrev_u32 v25, 770, v24
    v_bfi_b32 v42, s76, v25, v42
    v_subrev_u32 v25, 771, v24
    v_bfi_b32 v43, s76, v25, v43
    v_subrev_u32 v25, 1024, v24
    v_bfi_b32 v44, s76, v25, v44
    v_subrev_u32 v25, 1025, v24
    v_bfi_b32 v45, s76, v25, v45
    v_subrev_u32 v25, 1026, v24
    v_bfi_b32 v46, s76, v25, v46
    v_subrev_u32 v25, 1027, v24
    v_bfi_b32 v47, s76, v25, v47
    v_subrev_u32 v25, 1280, v24
    v_bfi_b32 v48, s76, v25, v48
    v_subrev_u32 v25, 1281, v24
    v_bfi_b32 v49, s76, v25, v49
    v_subrev_u32 v25, 1282, v24
    v_bfi_b32 v50, s76, v25, v50
    v_subrev_u32 v25, 1283, v24
    v_bfi_b32 v51, s76, v25, v51
    v_subrev_u32 v25, 1536, v24
    v_bfi_b32 v52, s76, v25, v52
    v_subrev_u32 v25, 1537, v24
    v_bfi_b32 v53, s76, v25, v53
    v_subrev_u32 v25, 1538, v24
    v_bfi_b32 v54, s76, v25, v54
    v_subrev_u32 v25, 1539, v24
    v_bfi_b32 v55, s76, v25, v55
    v_subrev_u32 v25, 1792, v24
    v_bfi_b32 v56, s76, v25, v56
    v_subrev_u32 v25, 1793, v24
    v_bfi_b32 v57, s76, v25, v57
    v_subrev_u32 v25, 1794, v24
    v_bfi_b32 v58, s76, v25, v58
    v_subrev_u32 v25, 1795, v24
    v_bfi_b32 v59, s76, v25, v59
    s_mov_b32 s77, 0
    s_mov_b32 s7, 0
F_SLOOP:
    v_subrev_u32 v60, s77, v28
    v_subrev_u32 v61, s77, v29
    v_subrev_u32 v62, s77, v30
    v_subrev_u32 v63, s77, v31
    v_subrev_u32 v64, s77, v32
    v_subrev_u32 v65, s77, v33
    v_subrev_u32 v66, s77, v34
    v_subrev_u32 v67, s77, v35
    v_subrev_u32 v68, s77, v36
    v_subrev_u32 v69, s77, v37
    v_subrev_u32 v70, s77, v38
    v_subrev_u32 v71, s77, v39
    v_subrev_u32 v72, s77, v40
    v_subrev_u32 v73, s77, v41
    v_subrev_u32 v74, s77, v42
    v_subrev_u32 v75, s77, v43
    v_subrev_u32 v76, s77, v44
    v_subrev_u32 v77, s77, v45
    v_subrev_u32 v78, s77, v46
    v_subrev_u32 v79, s77, v47
    v_subrev_u32 v80, s77, v48
    v_subrev_u32 v81, s77, v49
    v_subrev_u32 v82, s77, v50
    v_subrev_u32 v83, s77, v51
    v_subrev_u32 v84, s77, v52
    v_subrev_u32 v85, s77, v53
    v_subrev_u32 v86, s77, v54
    v_subrev_u32 v87, s77, v55
    v_subrev_u32 v88, s77, v56
    v_subrev_u32 v89, s77, v57
    v_subrev_u32 v90, s77, v58
    v_subrev_u32 v91, s77, v59
    v_max_u32 v60, v60, v61
    v_max3_u32 v60, v60, v62, v63
    v_max3_u32 v60, v60, v64, v65
    v_max3_u32 v60, v60, v66, v67
    v_max3_u32 v60, v60, v68, v69
    v_max3_u32 v60, v60, v70, v71
    v_max3_u32 v60, v60, v72, v73
    v_max3_u32 v60, v60, v74, v75
    v_max3_u32 v60, v60, v76, v77
    v_max3_u32 v60, v60, v78, v79
    v_max3_u32 v60, v60, v80, v81
    v_max3_u32 v60, v60, v82, v83
    v_max3_u32 v60, v60, v84, v85
    v_max3_u32 v60, v60, v86, v87
    v_max3_u32 v60, v60, v88, v89
    v_max3_u32 v60, v60, v90, v91
    s_nop 1
    v_max_u32_dpp v60, v60, v60 row_shr:1 row_mask:0xf bank_mask:0xf
    s_nop 1
    v_max_u32_dpp v60, v60, v60 row_shr:2 row_mask:0xf bank_mask:0xf
    s_nop 1
    v_max_u32_dpp v60, v60, v60 row_shr:4 row_mask:0xf bank_mask:0xf
    s_nop 1
    v_max_u32_dpp v60, v60, v60 row_shr:8 row_mask:0xf bank_mask:0xf
    s_nop 1
    v_max_u32_dpp v60, v60, v60 row_bcast:15 row_mask:0xa bank_mask:0xf
    s_nop 1
    v_max_u32_dpp v60, v60, v60 row_bcast:31 row_mask:0xc bank_mask:0xf
    s_nop 0
    v_readlane_b32 s8, v60, 63
    s_add_u32 s77, s77, s8
    s_add_u32 s7, s7, 1
    s_cmp_le_u32 s7, s3
    s_cbranch_scc1 F_SLOOP
    s_mov_b64 exec, 1
    v_mov_b32 v48, s77
    v_mov_b32 v49, v14
    s_lshl_b32 s8, s3, 3
    s_add_u32 s8, s8, s72
    v_mov_b32 v50, s8
    global_store_dwordx2 v50, v[48:49], s[50:51] offset:256
    s_lshl_b32 s8, s3, 7
    s_add_u32 s8, s8, s73
    v_mov_b32 v50, s8
    global_store_dwordx2 v50, v[48:49], s[50:51] sc1
    s_branch F_REST
CK_MAIN:
    s_mul_i32 s13, s7, 8192
    s_add_u32 s13, s13, 120832
    s_lshr_b32 s14, s7, 1
    s_mul_i32 s14, s14, 60192
    s_and_b32 s8, s7, 1
    s_lshl_b32 s8, s8, 9
    s_add_u32 s14, s14, s8
    s_lshl_b32 s8, s12, 8
    s_add_u32 m0, s14, s8
    v_mov_b32 v124, 0
    v_mov_b32 v125, 0
    v_mov_b32 v126, 0
    v_mov_b32 v127, 0
    s_lshl_b32 s8, s12, 11
    s_add_u32 s8, s8, s13
    v_lshl_add_u32 v20, v2, 4, s8
    ds_write_b128 v20, v[124:127]
    ds_write_b128 v20, v[124:127] offset:1024
    v_mul_u32_u24 v128, 1056, v3
    v_lshl_add_u32 v128, v4, 4, v128
    v_add_u32 v128, s14, v128
    s_lshl_b32 s8, s3, 2
    s_add_u32 s9, s8, 153632
    v_mov_b32 v129, s9
    s_xor_b32 s8, s8, 16
    s_add_u32 s9, s8, 153632
    v_mov_b32 v130, s9
    v_mov_b32 v21, 0x3c00
    ds_write_addtid_b32 v21 offset:43296
    v_mov_b32 v22, 0x3fb8aa3b
    v_mov_b32 v23, 0x32a57060
    v_mov_b32 v24, 0x3fb8aa3b
    v_mov_b32 v25, 0x3e22f983
    s_mov_b32 s15, 0x7fff7fff
    s_cmp_eq_u32 s12, 0
    s_mov_b32 s73, 0x01000c0c
    s_cselect_b32 s73, s73, 0x03020c0c
    s_waitcnt vmcnt(6)
    v_mul_f32 v19, v18, v22
    v_fma_f32 v22, v18, v22, -v19
    v_exp_f32 v19, v19
    v_fma_f32 v22, v18, v23, v22
    v_mul_f32 v22, 0x3f317218, v22
    v_fma_f32 v19, v19, v22, v19
    v_cvt_pk_bf16_f32 v19, v19, v19
    v_and_b32 v18, 0xffff0000, v19
    v_pk_mul_f32 v[24:25], v[24:25], v[18:19] op_sel_hi:[1,0]
    s_waitcnt vmcnt(0)
    v_and_b32 v14, s15, v30
    v_and_b32 v15, s15, v31
    v_and_b32 v16, s15, v32
    v_and_b32 v17, s15, v33
    v_perm_b32 v8, v28, v28, s73
    v_perm_b32 v9, v29, v29, s73
    v_perm_b32 v10, v30, v30, s73
    v_perm_b32 v11, v31, v31, s73
    v_perm_b32 v12, v32, v32, s73
    v_perm_b32 v13, v33, v33, s73
    v_pk_max_u16 v14, v14, v15
    v_pk_max_u16 v16, v16, v17
    v_lshlrev_b32 v15, 16, v14
    v_lshlrev_b32 v17, 16, v16
    v_pk_mul_f32 v[14:15], v[14:15], v[16:17]
    v_pk_mul_f32 v[8:9], v[8:9], v[24:25]
    v_max_f32 v14, v14, v15
    v_pk_mul_f32 v[10:11], v[10:11], v[18:19] op_sel_hi:[1,0]
    v_mul_f32 v14, v14, v18
    v_pk_mul_f32 v[66:67], v[12:13], v[10:11] op_sel:[1,1] op_sel_hi:[1,0]
    v_pk_fma_f32 v[56:57], v[12:13], v[10:11], v[66:67] op_sel:[0,0,0] op_sel_hi:[0,1,1] neg_lo:[0,0,1]
    v_max_u32_dpp v14, v14, v14 row_shr:1 row_mask:0xf bank_mask:0xf
    v_mul_f32 v60, 0x41000000, v8
    v_mul_f32 v61, 0xc1000000, v9
    v_max_u32_dpp v14, v14, v14 row_shr:2 row_mask:0xf bank_mask:0xf
    v_mul_f32 v62, 0x43000000, v8
    v_mul_f32 v63, 0x43000000, v9
    v_max_u32_dpp v14, v14, v14 row_shr:4 row_mask:0xf bank_mask:0xf
    v_fract_f32 v59, v9
    v_fract_f32 v61, v61
    v_max_u32_dpp v14, v14, v14 row_shr:8 row_mask:0xf bank_mask:0xf
    v_fract_f32 v63, v63
    v_exp_f32 v20, v8
    v_max_u32_dpp v14, v14, v14 row_bcast:15 row_mask:0xa bank_mask:0xf
    v_exp_f32 v22, v60
    v_exp_f32 v26, v62
    v_max_u32_dpp v14, v14, v14 row_bcast:31 row_mask:0xc bank_mask:0xf
    v_cos_f32 v60, v61
    v_readlane_b32 s8, v14, 63
    v_sin_f32 v61, v61
    v_cos_f32 v58, v59
    v_sin_f32 v59, v59
    v_cos_f32 v62, v63
    v_sin_f32 v63, v63
    s_lshr_b32 s8, s8, 23
    s_sub_i32 s8, 258, s8
    s_max_i32 s8, s8, 1
    s_min_i32 s8, s8, 253
    s_lshl_b32 s10, s8, 23
    v_pk_mul_f32 v[60:61], v[60:61], v[22:23] op_sel_hi:[1,0]
    v_pk_mul_f32 v[58:59], v[58:59], v[20:21] op_sel_hi:[1,0]
    v_pk_mul_f32 v[62:63], v[62:63], v[26:27] op_sel_hi:[1,0]
    v_pk_mul_f32 v[56:57], v[56:57], s[10:11] op_sel_hi:[1,0]
    v_cvt_pk_f16_f32 v70, v60, v61
    ds_write_addtid_b32 v70 offset:44352
    v_cvt_pk_f16_f32 v71, v56, v57
    ds_write_addtid_b32 v71 offset:42240
    v_pk_mul_f32 v[66:67], v[56:57], v[58:59] op_sel:[1,1] op_sel_hi:[1,0]
    v_pk_fma_f32 v[40:41], v[56:57], v[58:59], v[66:67] op_sel:[0,0,0] op_sel_hi:[0,1,1] neg_lo:[0,0,1]
    v_cvt_pk_f16_f32 v72, v40, v41
    ds_write_addtid_b32 v72 offset:0
    v_pk_mul_f32 v[66:67], v[40:41], v[58:59] op_sel:[1,1] op_sel_hi:[1,0]
    v_pk_fma_f32 v[42:43], v[40:41], v[58:59], v[66:67] op_sel:[0,0,0] op_sel_hi:[0,1,1] neg_lo:[0,0,1]
    v_cvt_pk_f16_f32 v73, v42, v43
    ds_write_addtid_b32 v73 offset:1056
    v_pk_mul_f32 v[66:67], v[42:43], v[58:59] op_sel:[1,1] op_sel_hi:[1,0]
    v_pk_fma_f32 v[44:45], v[42:43], v[58:59], v[66:67] op_sel:[0,0,0] op_sel_hi:[0,1,1] neg_lo:[0,0,1]
    v_cvt_pk_f16_f32 v70, v44, v45
    ds_write_addtid_b32 v70 offset:2112
    v_pk_mul_f32 v[66:67], v[44:45], v[58:59] op_sel:[1,1] op_sel_hi:[1,0]
    v_pk_fma_f32 v[46:47], v[44:45], v[58:59], v[66:67] op_sel:[0,0,0] op_sel_hi:[0,1,1] neg_lo:[0,0,1]
    v_cvt_pk_f16_f32 v71, v46, v47
    ds_write_addtid_b32 v71 offset:3168
    v_pk_mul_f32 v[66:67], v[46:47], v[58:59] op_sel:[1,1] op_sel_hi:[1,0]
    v_pk_fma_f32 v[48:49], v[46:47], v[58:59], v[66:67] op_sel:[0,0,0] op_sel_hi:[0,1,1] neg_lo:[0,0,1]
    v_cvt_pk_f16_f32 v72, v48, v49
    ds_write_addtid_b32 v72 offset:4224
    v_pk_mul_f32 v[66:67], v[48:49], v[58:59] op_sel:[1,1] op_sel_hi:[1,0]
    v_pk_fma_f32 v[50:51], v[48:49], v[58:59], v[66:67] op_sel:[0,0,0] op_sel_hi:[0,1,1] neg_lo:[0,0,1]
    v_cvt_pk_f16_f32 v73, v50, v51
    ds_write_addtid_b32 v73 offset:5280
    v_pk_mul_f32 v[66:67], v[50:51], v[58:59] op_sel:[1,1] op_sel_hi:[1,0]
    v_pk_fma_f32 v[52:53], v[50:51], v[58:59], v[66:67] op_sel:[0,0,0] op_sel_hi:[0,1,1] neg_lo:[0,0,1]
    v_cvt_pk_f16_f32 v70, v52, v53
    ds_write_addtid_b32 v70 offset:6336
    v_pk_mul_f32 v[66:67], v[52:53], v[58:59] op_sel:[1,1] op_sel_hi:[1,0]
    v_pk_fma_f32 v[54:55], v[52:53], v[58:59], v[66:67] op_sel:[0,0,0] op_sel_hi:[0,1,1] neg_lo:[0,0,1]
    v_cvt_pk_f16_f32 v71, v54, v55
    ds_write_addtid_b32 v71 offset:7392
    v_pk_mul_f32 v[66:67], v[40:41], v[62:63] op_sel:[1,1] op_sel_hi:[1,0]
    v_pk_fma_f32 v[40:41], v[40:41], v[62:63], v[66:67] op_sel:[0,0,0] op_sel_hi:[0,1,1] neg_lo:[0,0,1]
    v_cvt_pk_f16_f32 v72, v40, v41
    ds_write_addtid_b32 v72 offset:8448
    v_pk_mul_f32 v[66:67], v[42:43], v[62:63] op_sel:[1,1] op_sel_hi:[1,0]
    v_pk_fma_f32 v[42:43], v[42:43], v[62:63], v[66:67] op_sel:[0,0,0] op_sel_hi:[0,1,1] neg_lo:[0,0,1]
    v_cvt_pk_f16_f32 v73, v42, v43
    ds_write_addtid_b32 v73 offset:9504
    v_pk_mul_f32 v[66:67], v[44:45], v[62:63] op_sel:[1,1] op_sel_hi:[1,0]
    v_pk_fma_f32 v[44:45], v[44:45], v[62:63], v[66:67] op_sel:[0,0,0] op_sel_hi:[0,1,1] neg_lo:[0,0,1]
    v_cvt_pk_f16_f32 v70, v44, v45
    ds_write_addtid_b32 v70 offset:10560
    v_pk_mul_f32 v[66:67], v[46:47], v[62:63] op_sel:[1,1] op_sel_hi:[1,0]
    v_pk_fma_f32 v[46:47], v[46:47], v[62:63], v[66:67] op_sel:[0,0,0] op_sel_hi:[0,1,1] neg_lo:[0,0,1]
    v_cvt_pk_f16_f32 v71, v46, v47
    ds_write_addtid_b32 v71 offset:11616
    v_pk_mul_f32 v[66:67], v[48:49], v[62:63] op_sel:[1,1] op_sel_hi:[1,0]
    v_pk_fma_f32 v[48:49], v[48:49], v[62:63], v[66:67] op_sel:[0,0,0] op_sel_hi:[0,1,1] neg_lo:[0,0,1]
    v_cvt_pk_f16_f32 v72, v48, v49
    ds_write_addtid_b32 v72 offset:12672
    v_pk_mul_f32 v[66:67], v[50:51], v[62:63] op_sel:[1,1] op_sel_hi:[1,0]
    v_pk_fma_f32 v[50:51], v[50:51], v[62:63], v[66:67] op_sel:[0,0,0] op_sel_hi:[0,1,1] neg_lo:[0,0,1]
    v_cvt_pk_f16_f32 v73, v50, v51
    ds_write_addtid_b32 v73 offset:13728
    v_pk_mul_f32 v[66:67], v[52:53], v[62:63] op_sel:[1,1] op_sel_hi:[1,0]
    v_pk_fma_f32 v[52:53], v[52:53], v[62:63], v[66:67] op_sel:[0,0,0] op_sel_hi:[0,1,1] neg_lo:[0,0,1]
    v_cvt_pk_f16_f32 v70, v52, v53
    ds_write_addtid_b32 v70 offset:14784
    v_pk_mul_f32 v[66:67], v[54:55], v[62:63] op_sel:[1,1] op_sel_hi:[1,0]
    v_pk_fma_f32 v[54:55], v[54:55], v[62:63], v[66:67] op_sel:[0,0,0] op_sel_hi:[0,1,1] neg_lo:[0,0,1]
    v_cvt_pk_f16_f32 v71, v54, v55
    ds_write_addtid_b32 v71 offset:15840
    v_pk_mul_f32 v[66:67], v[42:43], v[62:63] op_sel:[1,1] op_sel_hi:[1,0]
    v_pk_fma_f32 v[42:43], v[42:43], v[62:63], v[66:67] op_sel:[0,0,0] op_sel_hi:[0,1,1] neg_lo:[0,0,1]
    v_cvt_pk_f16_f32 v72, v42, v43
    ds_write_addtid_b32 v72 offset:16896
    v_pk_mul_f32 v[66:67], v[46:47], v[62:63] op_sel:[1,1] op_sel_hi:[1,0]
    v_pk_fma_f32 v[46:47], v[46:47], v[62:63], v[66:67] op_sel:[0,0,0] op_sel_hi:[0,1,1] neg_lo:[0,0,1]
    v_cvt_pk_f16_f32 v73, v46, v47
    ds_write_addtid_b32 v73 offset:17952
    v_pk_mul_f32 v[66:67], v[50:51], v[62:63] op_sel:[1,1] op_sel_hi:[1,0]
    v_pk_fma_f32 v[50:51], v[50:51], v[62:63], v[66:67] op_sel:[0,0,0] op_sel_hi:[0,1,1] neg_lo:[0,0,1]
    v_cvt_pk_f16_f32 v70, v50, v51
    ds_write_addtid_b32 v70 offset:19008
    v_pk_mul_f32 v[66:67], v[54:55], v[62:63] op_sel:[1,1] op_sel_hi:[1,0]
    v_pk_fma_f32 v[54:55], v[54:55], v[62:63], v[66:67] op_sel:[0,0,0] op_sel_hi:[0,1,1] neg_lo:[0,0,1]
    v_cvt_pk_f16_f32 v71, v54, v55
    ds_write_addtid_b32 v71 offset:20064
    v_pk_mul_f32 v[66:67], v[42:43], v[62:63] op_sel:[1,1] op_sel_hi:[1,0]
    v_pk_fma_f32 v[42:43], v[42:43], v[62:63], v[66:67] op_sel:[0,0,0] op_sel_hi:[0,1,1] neg_lo:[0,0,1]
    v_cvt_pk_f16_f32 v72, v42, v43
    ds_write_addtid_b32 v72 offset:21120
    v_pk_mul_f32 v[66:67], v[46:47], v[62:63] op_sel:[1,1] op_sel_hi:[1,0]
    v_pk_fma_f32 v[46:47], v[46:47], v[62:63], v[66:67] op_sel:[0,0,0] op_sel_hi:[0,1,1] neg_lo:[0,0,1]
    v_cvt_pk_f16_f32 v73, v46, v47
    ds_write_addtid_b32 v73 offset:22176
    v_pk_mul_f32 v[66:67], v[50:51], v[62:63] op_sel:[1,1] op_sel_hi:[1,0]
    v_pk_fma_f32 v[50:51], v[50:51], v[62:63], v[66:67] op_sel:[0,0,0] op_sel_hi:[0,1,1] neg_lo:[0,0,1]
    v_cvt_pk_f16_f32 v70, v50, v51
    ds_write_addtid_b32 v70 offset:23232
    v_pk_mul_f32 v[66:67], v[54:55], v[62:63] op_sel:[1,1] op_sel_hi:[1,0]
    v_pk_fma_f32 v[54:55], v[54:55], v[62:63], v[66:67] op_sel:[0,0,0] op_sel_hi:[0,1,1] neg_lo:[0,0,1]
    v_cvt_pk_f16_f32 v71, v54, v55
    ds_write_addtid_b32 v71 offset:24288
    v_pk_mul_f32 v[66:67], v[46:47], v[62:63] op_sel:[1,1] op_sel_hi:[1,0]
    v_pk_fma_f32 v[46:47], v[46:47], v[62:63], v[66:67] op_sel:[0,0,0] op_sel_hi:[0,1,1] neg_lo:[0,0,1]
    v_cvt_pk_f16_f32 v72, v46, v47
    ds_write_addtid_b32 v72 offset:25344
    v_pk_mul_f32 v[66:67], v[54:55], v[62:63] op_sel:[1,1] op_sel_hi:[1,0]
    v_pk_fma_f32 v[54:55], v[54:55], v[62:63], v[66:67] op_sel:[0,0,0] op_sel_hi:[0,1,1] neg_lo:[0,0,1]
    v_cvt_pk_f16_f32 v73, v54, v55
    ds_write_addtid_b32 v73 offset:26400
    v_pk_mul_f32 v[66:67], v[46:47], v[62:63] op_sel:[1,1] op_sel_hi:[1,0]
    v_pk_fma_f32 v[46:47], v[46:47], v[62:63], v[66:67] op_sel:[0,0,0] op_sel_hi:[0,1,1] neg_lo:[0,0,1]
    v_cvt_pk_f16_f32 v70, v46, v47
    ds_write_addtid_b32 v70 offset:27456
    v_pk_mul_f32 v[66:67], v[54:55], v[62:63] op_sel:[1,1] op_sel_hi:[1,0]
    v_pk_fma_f32 v[54:55], v[54:55], v[62:63], v[66:67] op_sel:[0,0,0] op_sel_hi:[0,1,1] neg_lo:[0,0,1]
    v_cvt_pk_f16_f32 v71, v54, v55
    ds_write_addtid_b32 v71 offset:28512
    v_pk_mul_f32 v[66:67], v[46:47], v[62:63] op_sel:[1,1] op_sel_hi:[1,0]
    v_pk_fma_f32 v[46:47], v[46:47], v[62:63], v[66:67] op_sel:[0,0,0] op_sel_hi:[0,1,1] neg_lo:[0,0,1]
    v_cvt_pk_f16_f32 v72, v46, v47
    ds_write_addtid_b32 v72 offset:29568
    v_pk_mul_f32 v[66:67], v[54:55], v[62:63] op_sel:[1,1] op_sel_hi:[1,0]
    v_pk_fma_f32 v[54:55], v[54:55], v[62:63], v[66:67] op_sel:[0,0,0] op_sel_hi:[0,1,1] neg_lo:[0,0,1]
    v_cvt_pk_f16_f32 v73, v54, v55
    ds_write_addtid_b32 v73 offset:30624
    v_pk_mul_f32 v[66:67], v[46:47], v[62:63] op_sel:[1,1] op_sel_hi:[1,0]
    v_pk_fma_f32 v[46:47], v[46:47], v[62:63], v[66:67] op_sel:[0,0,0] op_sel_hi:[0,1,1] neg_lo:[0,0,1]
    v_cvt_pk_f16_f32 v70, v46, v47
    ds_write_addtid_b32 v70 offset:31680
    v_pk_mul_f32 v[66:67], v[54:55], v[62:63] op_sel:[1,1] op_sel_hi:[1,0]
    v_pk_fma_f32 v[54:55], v[54:55], v[62:63], v[66:67] op_sel:[0,0,0] op_sel_hi:[0,1,1] neg_lo:[0,0,1]
    v_cvt_pk_f16_f32 v71, v54, v55
    ds_write_addtid_b32 v71 offset:32736
    v_pk_mul_f32 v[66:67], v[54:55], v[62:63] op_sel:[1,1] op_sel_hi:[1,0]
    v_pk_fma_f32 v[54:55], v[54:55], v[62:63], v[66:67] op_sel:[0,0,0] op_sel_hi:[0,1,1] neg_lo:[0,0,1]
    v_cvt_pk_f16_f32 v72, v54, v55
    ds_write_addtid_b32 v72 offset:33792
    v_pk_mul_f32 v[66:67], v[54:55], v[62:63] op_sel:[1,1] op_sel_hi:[1,0]
    v_pk_fma_f32 v[54:55], v[54:55], v[62:63], v[66:67] op_sel:[0,0,0] op_sel_hi:[0,1,1] neg_lo:[0,0,1]
    v_cvt_pk_f16_f32 v73, v54, v55
    ds_write_addtid_b32 v73 offset:34848
    v_pk_mul_f32 v[66:67], v[54:55], v[62:63] op_sel:[1,1] op_sel_hi:[1,0]
    v_pk_fma_f32 v[54:55], v[54:55], v[62:63], v[66:67] op_sel:[0,0,0] op_sel_hi:[0,1,1] neg_lo:[0,0,1]
    v_cvt_pk_f16_f32 v70, v54, v55
    ds_write_addtid_b32 v70 offset:35904
    v_pk_mul_f32 v[66:67], v[54:55], v[62:63] op_sel:[1,1] op_sel_hi:[1,0]
    v_pk_fma_f32 v[54:55], v[54:55], v[62:63], v[66:67] op_sel:[0,0,0] op_sel_hi:[0,1,1] neg_lo:[0,0,1]
    v_cvt_pk_f16_f32 v71, v54, v55
    ds_write_addtid_b32 v71 offset:36960
    v_pk_mul_f32 v[66:67], v[54:55], v[62:63] op_sel:[1,1] op_sel_hi:[1,0]
    v_pk_fma_f32 v[54:55], v[54:55], v[62:63], v[66:67] op_sel:[0,0,0] op_sel_hi:[0,1,1] neg_lo:[0,0,1]
    v_cvt_pk_f16_f32 v72, v54, v55
    ds_write_addtid_b32 v72 offset:38016
    v_pk_mul_f32 v[66:67], v[54:55], v[62:63] op_sel:[1,1] op_sel_hi:[1,0]
    v_pk_fma_f32 v[54:55], v[54:55], v[62:63], v[66:67] op_sel:[0,0,0] op_sel_hi:[0,1,1] neg_lo:[0,0,1]
    v_cvt_pk_f16_f32 v73, v54, v55
    ds_write_addtid_b32 v73 offset:39072
    v_pk_mul_f32 v[66:67], v[54:55], v[62:63] op_sel:[1,1] op_sel_hi:[1,0]
    v_pk_fma_f32 v[54:55], v[54:55], v[62:63], v[66:67] op_sel:[0,0,0] op_sel_hi:[0,1,1] neg_lo:[0,0,1]
    v_cvt_pk_f16_f32 v70, v54, v55
    ds_write_addtid_b32 v70 offset:40128
    v_pk_mul_f32 v[66:67], v[54:55], v[62:63] op_sel:[1,1] op_sel_hi:[1,0]
    v_pk_fma_f32 v[54:55], v[54:55], v[62:63], v[66:67] op_sel:[0,0,0] op_sel_hi:[0,1,1] neg_lo:[0,0,1]
    v_cvt_pk_f16_f32 v71, v54, v55
    ds_write_addtid_b32 v71 offset:41184
    v_pk_mul_f32 v[66:67], v[60:61], v[60:61] op_sel:[1,1] op_sel_hi:[1,0]
    v_pk_fma_f32 v[64:65], v[60:61], v[60:61], v[66:67] op_sel:[0,0,0] op_sel_hi:[0,1,1] neg_lo:[0,0,1]
    v_cvt_pk_f16_f32 v72, v64, v65
    ds_write_addtid_b32 v72 offset:45408
    v_pk_mul_f32 v[66:67], v[64:65], v[60:61] op_sel:[1,1] op_sel_hi:[1,0]
    v_pk_fma_f32 v[64:65], v[64:65], v[60:61], v[66:67] op_sel:[0,0,0] op_sel_hi:[0,1,1] neg_lo:[0,0,1]
    v_cvt_pk_f16_f32 v73, v64, v65
    ds_write_addtid_b32 v73 offset:46464
    v_pk_mul_f32 v[66:67], v[64:65], v[60:61] op_sel:[1,1] op_sel_hi:[1,0]
    v_pk_fma_f32 v[64:65], v[64:65], v[60:61], v[66:67] op_sel:[0,0,0] op_sel_hi:[0,1,1] neg_lo:[0,0,1]
    v_cvt_pk_f16_f32 v70, v64, v65
    ds_write_addtid_b32 v70 offset:47520
    v_pk_mul_f32 v[66:67], v[64:65], v[60:61] op_sel:[1,1] op_sel_hi:[1,0]
    v_pk_fma_f32 v[64:65], v[64:65], v[60:61], v[66:67] op_sel:[0,0,0] op_sel_hi:[0,1,1] neg_lo:[0,0,1]
    v_cvt_pk_f16_f32 v71, v64, v65
    ds_write_addtid_b32 v71 offset:48576
    v_pk_mul_f32 v[66:67], v[64:65], v[60:61] op_sel:[1,1] op_sel_hi:[1,0]
    v_pk_fma_f32 v[64:65], v[64:65], v[60:61], v[66:67] op_sel:[0,0,0] op_sel_hi:[0,1,1] neg_lo:[0,0,1]
    v_cvt_pk_f16_f32 v72, v64, v65
    ds_write_addtid_b32 v72 offset:49632
    v_pk_mul_f32 v[66:67], v[64:65], v[60:61] op_sel:[1,1] op_sel_hi:[1,0]
    v_pk_fma_f32 v[64:65], v[64:65], v[60:61], v[66:67] op_sel:[0,0,0] op_sel_hi:[0,1,1] neg_lo:[0,0,1]
    v_cvt_pk_f16_f32 v73, v64, v65
    ds_write_addtid_b32 v73 offset:50688
    v_pk_mul_f32 v[66:67], v[64:65], v[60:61] op_sel:[1,1] op_sel_hi:[1,0]
    v_pk_fma_f32 v[64:65], v[64:65], v[60:61], v[66:67] op_sel:[0,0,0] op_sel_hi:[0,1,1] neg_lo:[0,0,1]
    v_cvt_pk_f16_f32 v70, v64, v65
    ds_write_addtid_b32 v70 offset:51744
    v_pk_mul_f32 v[66:67], v[64:65], v[60:61] op_sel:[1,1] op_sel_hi:[1,0]
    v_pk_fma_f32 v[64:65], v[64:65], v[60:61], v[66:67] op_sel:[0,0,0] op_sel_hi:[0,1,1] neg_lo:[0,0,1]
    v_cvt_pk_f16_f32 v71, v64, v65
    ds_write_addtid_b32 v71 offset:52800
    v_pk_mul_f32 v[66:67], v[64:65], v[60:61] op_sel:[1,1] op_sel_hi:[1,0]
    v_pk_fma_f32 v[64:65], v[64:65], v[60:61], v[66:67] op_sel:[0,0,0] op_sel_hi:[0,1,1] neg_lo:[0,0,1]
    v_cvt_pk_f16_f32 v72, v64, v65
    ds_write_addtid_b32 v72 offset:53856
    v_pk_mul_f32 v[66:67], v[64:65], v[60:61] op_sel:[1,1] op_sel_hi:[1,0]
    v_pk_fma_f32 v[64:65], v[64:65], v[60:61], v[66:67] op_sel:[0,0,0] op_sel_hi:[0,1,1] neg_lo:[0,0,1]
    v_cvt_pk_f16_f32 v73, v64, v65
    ds_write_addtid_b32 v73 offset:54912
    v_pk_mul_f32 v[66:67], v[64:65], v[60:61] op_sel:[1,1] op_sel_hi:[1,0]
    v_pk_fma_f32 v[64:65], v[64:65], v[60:61], v[66:67] op_sel:[0,0,0] op_sel_hi:[0,1,1] neg_lo:[0,0,1]
    v_cvt_pk_f16_f32 v70, v64, v65
    ds_write_addtid_b32 v70 offset:55968
    v_pk_mul_f32 v[66:67], v[64:65], v[60:61] op_sel:[1,1] op_sel_hi:[1,0]
    v_pk_fma_f32 v[64:65], v[64:65], v[60:61], v[66:67] op_sel:[0,0,0] op_sel_hi:[0,1,1] neg_lo:[0,0,1]
    v_cvt_pk_f16_f32 v71, v64, v65
    ds_write_addtid_b32 v71 offset:57024
    v_pk_mul_f32 v[66:67], v[64:65], v[60:61] op_sel:[1,1] op_sel_hi:[1,0]
    v_pk_fma_f32 v[64:65], v[64:65], v[60:61], v[66:67] op_sel:[0,0,0] op_sel_hi:[0,1,1] neg_lo:[0,0,1]
    v_cvt_pk_f16_f32 v72, v64, v65
    ds_write_addtid_b32 v72 offset:58080
    v_pk_mul_f32 v[66:67], v[64:65], v[60:61] op_sel:[1,1] op_sel_hi:[1,0]
    v_pk_fma_f32 v[64:65], v[64:65], v[60:61], v[66:67] op_sel:[0,0,0] op_sel_hi:[0,1,1] neg_lo:[0,0,1]
    v_cvt_pk_f16_f32 v73, v64, v65
    ds_write_addtid_b32 v73 offset:59136
CK_SKIP:
    ds_write_b32 v129, v129
    s_mov_b32 s9, 0
CK_PAIR:
    ds_read_b32 v8, v130
    s_add_u32 s9, s9, 1
    s_waitcnt lgkmcnt(0)
    v_cmp_eq_u32 vcc, 0, v8
    s_cmp_ge_u32 s9, 0x40000
    s_cbranch_scc1 CK_PAIRED
    s_cbranch_vccnz CK_PAIR
CK_PAIRED:
    s_sub_u32 s8, 254, s8
    s_lshl_b32 s15, s8, 23
    s_cmp_eq_u32 s12, 0
    s_cbranch_scc0 CK_T1
    ds_read_b128 v[8:11], v128 offset:43296
    ds_read_b128 v[40:43], v128 offset:0
    ds_read_b128 v[12:15], v128 offset:43360
    ds_read_b128 v[44:47], v128 offset:64
    ds_read_b128 v[16:19], v128 offset:43424
    ds_read_b128 v[48:51], v128 offset:128
    ds_read_b128 v[20:23], v128 offset:43488
    ds_read_b128 v[52:55], v128 offset:192
    ds_read_b128 v[24:27], v128 offset:43552
    ds_read_b128 v[56:59], v128 offset:256
    ds_read_b128 v[28:31], v128 offset:43616
    ds_read_b128 v[60:63], v128 offset:320
    ds_read_b128 v[32:35], v128 offset:43680
    ds_read_b128 v[64:67], v128 offset:384
    ds_read_b128 v[36:39], v128 offset:43744
    ds_read_b128 v[68:71], v128 offset:448
    v_lshrrev_b32 v114, 1, v4
    v_lshlrev_b32 v114, 8, v114
    v_lshl_add_u32 v114, v3, 4, v114
    v_and_b32 v115, 1, v4
    v_lshl_add_u32 v114, v115, 3, v114
    v_add_u32 v114, s13, v114
    v_lshlrev_b32 v115, 5, v3
    v_lshl_add_u32 v115, v4, 3, v115
    v_add_u32 v115, s13, v115
    v_mov_b32 v116, s13
    s_waitcnt lgkmcnt(14)
    v_mfma_f32_16x16x32_f16 v[104:107], v[40:43], v[8:11], 0
    ds_read_b128 v[72:75], v128 offset:33792
    s_waitcnt lgkmcnt(13)
    v_mfma_f32_16x16x32_f16 v[104:107], v[44:47], v[12:15], v[104:107]
    ds_read_b128 v[76:79], v128 offset:33856
    s_waitcnt lgkmcnt(12)
    v_mfma_f32_16x16x32_f16 v[104:107], v[48:51], v[16:19], v[104:107]
    ds_read_b128 v[80:83], v128 offset:33920
    s_waitcnt lgkmcnt(11)
    v_mfma_f32_16x16x32_f16 v[104:107], v[52:55], v[20:23], v[104:107]
    ds_read_b128 v[84:87], v128 offset:33984
    s_waitcnt lgkmcnt(10)
    v_mfma_f32_16x16x32_f16 v[104:107], v[56:59], v[24:27], v[104:107]
    ds_read_b128 v[88:91], v128 offset:34048
    s_waitcnt lgkmcnt(9)
    v_mfma_f32_16x16x32_f16 v[104:107], v[60:63], v[28:31], v[104:107]
    ds_read_b128 v[92:95], v128 offset:34112
    s_waitcnt lgkmcnt(8)
    v_mfma_f32_16x16x32_f16 v[104:107], v[64:67], v[32:35], v[104:107]
    ds_read_b128 v[96:99], v128 offset:34176
    s_waitcnt lgkmcnt(7)
    v_mfma_f32_16x16x32_f16 v[104:107], v[68:71], v[36:39], v[104:107]
    ds_read_b128 v[100:103], v128 offset:34240
    s_waitcnt lgkmcnt(7)
    v_mfma_f32_16x16x32_f16 v[108:111], v[8:11], v[72:75], 0
    s_waitcnt lgkmcnt(6)
    v_mfma_f32_16x16x32_f16 v[108:111], v[12:15], v[76:79], v[108:111]
    s_waitcnt lgkmcnt(5)
    v_mfma_f32_16x16x32_f16 v[108:111], v[16:19], v[80:83], v[108:111]
    s_waitcnt lgkmcnt(4)
    v_mfma_f32_16x16x32_f16 v[108:111], v[20:23], v[84:87], v[108:111]
    s_waitcnt lgkmcnt(3)
    v_mfma_f32_16x16x32_f16 v[108:111], v[24:27], v[88:91], v[108:111]
    s_waitcnt lgkmcnt(2)
    v_mfma_f32_16x16x32_f16 v[108:111], v[28:31], v[92:95], v[108:111]
    s_waitcnt lgkmcnt(1)
    v_mfma_f32_16x16x32_f16 v[108:111], v[32:35], v[96:99], v[108:111]
    s_waitcnt lgkmcnt(0)
    v_mfma_f32_16x16x32_f16 v[108:111], v[36:39], v[100:103], v[108:111]
    v_mul_f32 v104, s15, v104
    v_mul_f32 v105, s15, v105
    v_mul_f32 v106, s15, v106
    v_mul_f32 v107, s15, v107
    v_cvt_pk_bf16_f32 v118, v104, v105
    v_cvt_pk_bf16_f32 v119, v106, v107
    v_cvt_pk_bf16_f32 v120, v105, v106
    v_cvt_pk_bf16_f32 v121, v107, v107
    ds_write_b16 v114, v121 offset:1256
    ds_write_b64 v114, v[120:121] offset:32
    ds_write_b64 v114, v[118:119] offset:1248
    ds_write_b16 v114, v118 offset:30
    v_mul_f32 v108, s15, v108
    v_mul_f32 v109, s15, v109
    v_mul_f32 v110, s15, v110
    v_mul_f32 v111, s15, v111
    v_cvt_pk_bf16_f32 v118, v108, v109
    v_cvt_pk_bf16_f32 v119, v110, v111
    s_mov_b32 s10, 0x00ff00ff
    s_mov_b32 s11, 0x00ff00ff
    s_mov_b64 exec, s[10:11]
    ds_write_b64 v115, v[118:119] offset:2912
    s_mov_b64 exec, 0x100
    ds_write_b16 v116, v118 offset:28
    ds_write_b16 v116, v118 offset:1246
    s_mov_b64 exec, -1
    v_mov_b32 v127, 153600
    v_mov_b32 v126, 1
    s_lshl_b32 s8, s7, 2
    v_add_u32 v131, s8, v127
    s_mov_b64 exec, 1
    ds_add_u32 v131, v126 offset:80
    ds_add_u32 v127, v126 offset:76
    s_mov_b64 exec, -1
    v_mul_u32_u24 v124, 320, v4
    v_lshl_add_u32 v124, v3, 4, v124
    s_mul_i32 s8, s7, 20480
    v_add_u32 v124, s8, v124
    s_lshl_b32 s8, s3, 2
    s_add_u32 s8, s8, 153856
    v_mov_b32 v125, s8
    v_and_b32 v5, 1, v3
    v_mul_u32_u24 v5, 1216, v5
    v_sub_u32 v5, 1264, v5
    v_lshrrev_b32 v6, 1, v3
    v_lshl_add_u32 v5, v6, 2, v5
    v_lshlrev_b32 v6, 4, v4
    v_sub_u32 v5, v5, v6
    v_add_u32 v5, s13, v5
    v_add_u32 v7, 576, v5
    v_lshl_add_u32 v6, v3, 5, v6
    v_add_u32 v6, 3616, v6
    v_add_u32 v6, s13, v6
    s_mov_b32 s9, 0
SPN5:
    ds_read_b32 v128, v131 offset:80
    s_add_u32 s9, s9, 1
    s_waitcnt lgkmcnt(0)
    v_cmp_ne_u32 vcc, 2, v128
    s_cmp_ge_u32 s9, 0x40000
    s_cbranch_scc1 SPX5
    s_cbranch_vccnz SPN5
SPX5:
    ds_read2_b32 v[36:37], v5 offset0:115 offset1:114
    ds_read2_b32 v[38:39], v5 offset0:113 offset1:112
    ds_read2_b32 v[32:33], v5 offset0:99 offset1:98
    ds_read2_b32 v[34:35], v5 offset0:97 offset1:96
    ds_read2_b32 v[28:29], v5 offset0:83 offset1:82
    ds_read2_b32 v[30:31], v5 offset0:81 offset1:80
    ds_read2_b32 v[24:25], v5 offset0:67 offset1:66
    ds_read2_b32 v[26:27], v5 offset0:65 offset1:64
    ds_read2_b32 v[20:21], v5 offset0:51 offset1:50
    ds_read2_b32 v[22:23], v5 offset0:49 offset1:48
    ds_read2_b32 v[16:17], v5 offset0:35 offset1:34
    ds_read2_b32 v[18:19], v5 offset0:33 offset1:32
    ds_read2_b32 v[12:13], v5 offset0:19 offset1:18
    ds_read2_b32 v[14:15], v5 offset0:17 offset1:16
    ds_read2_b32 v[8:9], v5 offset0:3 offset1:2
    ds_read2_b32 v[10:11], v5 offset0:1 offset1:0
    ds_read2_b32 v[68:69], v7 offset0:99 offset1:98
    ds_read2_b32 v[70:71], v7 offset0:97 offset1:96
    ds_read2_b32 v[64:65], v7 offset0:83 offset1:82
    ds_read2_b32 v[66:67], v7 offset0:81 offset1:80
    ds_read2_b32 v[60:61], v7 offset0:67 offset1:66
    ds_read2_b32 v[62:63], v7 offset0:65 offset1:64
    ds_read2_b32 v[56:57], v7 offset0:51 offset1:50
    ds_read2_b32 v[58:59], v7 offset0:49 offset1:48
    ds_read2_b32 v[52:53], v7 offset0:35 offset1:34
    ds_read2_b32 v[54:55], v7 offset0:33 offset1:32
    ds_read2_b32 v[48:49], v7 offset0:19 offset1:18
    ds_read2_b32 v[50:51], v7 offset0:17 offset1:16
    ds_read2_b32 v[44:45], v7 offset0:3 offset1:2
    ds_read2_b32 v[46:47], v7 offset0:1 offset1:0
    ds_read2_b32 v[40:41], v5 offset0:131 offset1:130
    ds_read2_b32 v[42:43], v5 offset0:129 offset1:128
    ds_read2_b32 v[72:73], v7 offset0:115 offset1:114
    ds_read2_b32 v[74:75], v7 offset0:113 offset1:112
    s_mov_b32 s9, 0
SPN6:
    ds_read_b32 v128, v127 offset:76
    s_add_u32 s9, s9, 1
    s_waitcnt lgkmcnt(0)
    v_cmp_ne_u32 vcc, 12, v128
    s_cmp_ge_u32 s9, 0x40000
    s_cbranch_scc1 SPX6
    s_cbranch_vccz SPX6
    s_sleep 1
    s_branch SPN6
SPX6:
D_PASS:
    s_mov_b32 s9, 0
SPN7:
    ds_read_b32 v128, v127 offset:240
    s_add_u32 s9, s9, 1
    s_waitcnt lgkmcnt(0)
    v_and_b32 v128, 15, v128
    v_cmp_ne_u32 vcc, 2, v128
    s_cmp_ge_u32 s9, 0x40000
    s_cbranch_scc1 SPX7
    s_cbranch_vccz SPX7
    s_sleep 1
    s_branch SPN7
SPX7:
D_LOOP:
    ds_read_b128 v[80:83], v6 offset:0
    ds_read_b128 v[84:87], v6 offset:64
    ds_read_b128 v[88:91], v6 offset:128
    ds_read_b128 v[92:95], v6 offset:192
    ds_read_b128 v[96:99], v6 offset:256
    ds_read_b128 v[100:103], v6 offset:320
    ds_read_b128 v[104:107], v6 offset:384
    s_waitcnt lgkmcnt(6)
    v_mfma_f32_16x16x32_bf16 v[108:111], v[36:39], v[80:83], 0
    v_mfma_f32_16x16x32_bf16 v[112:115], v[68:71], v[80:83], 0
    ds_read_b128 v[76:79], v6 offset:448
    s_waitcnt lgkmcnt(6)
    v_mfma_f32_16x16x32_bf16 v[108:111], v[32:35], v[84:87], v[108:111]
    v_mfma_f32_16x16x32_bf16 v[112:115], v[64:67], v[84:87], v[112:115]
    ds_read_b128 v[80:83], v6 offset:512
    s_waitcnt lgkmcnt(6)
    v_mfma_f32_16x16x32_bf16 v[108:111], v[28:31], v[88:91], v[108:111]
    v_mfma_f32_16x16x32_bf16 v[112:115], v[60:63], v[88:91], v[112:115]
    ds_read_b128 v[84:87], v6 offset:576
    s_waitcnt lgkmcnt(6)
    v_mfma_f32_16x16x32_bf16 v[108:111], v[24:27], v[92:95], v[108:111]
    v_mfma_f32_16x16x32_bf16 v[112:115], v[56:59], v[92:95], v[112:115]
    ds_read_b128 v[88:91], v6 offset:640
    s_waitcnt lgkmcnt(6)
    v_mfma_f32_16x16x32_bf16 v[108:111], v[20:23], v[96:99], v[108:111]
    v_mfma_f32_16x16x32_bf16 v[112:115], v[52:55], v[96:99], v[112:115]
    ds_read_b128 v[92:95], v6 offset:704
    s_waitcnt lgkmcnt(6)
    v_mfma_f32_16x16x32_bf16 v[108:111], v[16:19], v[100:103], v[108:111]
    v_mfma_f32_16x16x32_bf16 v[112:115], v[48:51], v[100:103], v[112:115]
    ds_read_b128 v[96:99], v6 offset:768
    s_waitcnt lgkmcnt(6)
    v_mfma_f32_16x16x32_bf16 v[108:111], v[12:15], v[104:107], v[108:111]
    v_mfma_f32_16x16x32_bf16 v[112:115], v[44:47], v[104:107], v[112:115]
    ds_read_b128 v[100:103], v6 offset:832
    s_waitcnt lgkmcnt(6)
    v_mfma_f32_16x16x32_bf16 v[108:111], v[8:11], v[76:79], v[108:111]
    v_mfma_f32_16x16x32_bf16 v[112:115], v[40:43], v[76:79], v[112:115]
    v_mfma_f32_16x16x32_bf16 v[116:119], v[72:75], v[76:79], 0
    ds_read_b128 v[104:107], v6 offset:896
    s_waitcnt lgkmcnt(6)
    v_mfma_f32_16x16x32_bf16 v[112:115], v[36:39], v[80:83], v[112:115]
    v_mfma_f32_16x16x32_bf16 v[116:119], v[68:71], v[80:83], v[116:119]
    ds_read_b128 v[76:79], v6 offset:960
    s_waitcnt lgkmcnt(6)
    v_mfma_f32_16x16x32_bf16 v[112:115], v[32:35], v[84:87], v[112:115]
    v_mfma_f32_16x16x32_bf16 v[116:119], v[64:67], v[84:87], v[116:119]
    ds_read_b128 v[80:83], v6 offset:1024
    s_waitcnt lgkmcnt(6)
    v_mfma_f32_16x16x32_bf16 v[112:115], v[28:31], v[88:91], v[112:115]
    ds_write_b64 v124, v[108:109] offset:0
    v_mfma_f32_16x16x32_bf16 v[116:119], v[60:63], v[88:91], v[116:119]
    ds_read_b128 v[84:87], v6 offset:1088
    s_waitcnt lgkmcnt(7)
    v_mfma_f32_16x16x32_bf16 v[112:115], v[24:27], v[92:95], v[112:115]
    ds_write_b64 v124, v[110:111] offset:8
    v_mfma_f32_16x16x32_bf16 v[116:119], v[56:59], v[92:95], v[116:119]
    ds_read_b128 v[88:91], v6 offset:1152
    s_waitcnt lgkmcnt(8)
    v_mfma_f32_16x16x32_bf16 v[112:115], v[20:23], v[96:99], v[112:115]
    ds_write_b32 v125, v126 offset:0
    v_mfma_f32_16x16x32_bf16 v[116:119], v[52:55], v[96:99], v[116:119]
    ds_read_b128 v[92:95], v6 offset:1216
    s_waitcnt lgkmcnt(9)
    v_mfma_f32_16x16x32_bf16 v[112:115], v[16:19], v[100:103], v[112:115]
    v_mfma_f32_16x16x32_bf16 v[116:119], v[48:51], v[100:103], v[116:119]
    ds_read_b128 v[96:99], v6 offset:1280
    s_waitcnt lgkmcnt(9)
    v_mfma_f32_16x16x32_bf16 v[112:115], v[12:15], v[104:107], v[112:115]
    v_mfma_f32_16x16x32_bf16 v[116:119], v[44:47], v[104:107], v[116:119]
    ds_read_b128 v[100:103], v6 offset:1344
    s_waitcnt lgkmcnt(9)
    v_mfma_f32_16x16x32_bf16 v[112:115], v[8:11], v[76:79], v[112:115]
    v_mfma_f32_16x16x32_bf16 v[116:119], v[40:43], v[76:79], v[116:119]
    v_mfma_f32_16x16x32_bf16 v[120:123], v[72:75], v[76:79], 0
    ds_read_b128 v[104:107], v6 offset:1408
    s_waitcnt lgkmcnt(9)
    v_mfma_f32_16x16x32_bf16 v[116:119], v[36:39], v[80:83], v[116:119]
    v_mfma_f32_16x16x32_bf16 v[120:123], v[68:71], v[80:83], v[120:123]
    ds_read_b128 v[76:79], v6 offset:1472
    s_waitcnt lgkmcnt(8)
    v_mfma_f32_16x16x32_bf16 v[116:119], v[32:35], v[84:87], v[116:119]
    v_mfma_f32_16x16x32_bf16 v[120:123], v[64:67], v[84:87], v[120:123]
    ds_read_b128 v[80:83], v6 offset:1536
    s_waitcnt lgkmcnt(7)
    v_mfma_f32_16x16x32_bf16 v[116:119], v[28:31], v[88:91], v[116:119]
    ds_write_b64 v124, v[112:113] offset:1280
    v_mfma_f32_16x16x32_bf16 v[120:123], v[60:63], v[88:91], v[120:123]
    ds_read_b128 v[84:87], v6 offset:1600
    s_waitcnt lgkmcnt(7)
    v_mfma_f32_16x16x32_bf16 v[116:119], v[24:27], v[92:95], v[116:119]
    ds_write_b64 v124, v[114:115] offset:1288
    v_mfma_f32_16x16x32_bf16 v[120:123], v[56:59], v[92:95], v[120:123]
    ds_read_b128 v[88:91], v6 offset:1664
    s_waitcnt lgkmcnt(8)
    v_mfma_f32_16x16x32_bf16 v[116:119], v[20:23], v[96:99], v[116:119]
    ds_write_b32 v125, v126 offset:32
    v_mfma_f32_16x16x32_bf16 v[120:123], v[52:55], v[96:99], v[120:123]
    ds_read_b128 v[92:95], v6 offset:1728
    s_waitcnt lgkmcnt(9)
    v_mfma_f32_16x16x32_bf16 v[116:119], v[16:19], v[100:103], v[116:119]
    v_mfma_f32_16x16x32_bf16 v[120:123], v[48:51], v[100:103], v[120:123]
    ds_read_b128 v[96:99], v6 offset:1792
    s_waitcnt lgkmcnt(9)
    v_mfma_f32_16x16x32_bf16 v[116:119], v[12:15], v[104:107], v[116:119]
    v_mfma_f32_16x16x32_bf16 v[120:123], v[44:47], v[104:107], v[120:123]
    ds_read_b128 v[100:103], v6 offset:1856
    s_waitcnt lgkmcnt(9)
    v_mfma_f32_16x16x32_bf16 v[116:119], v[8:11], v[76:79], v[116:119]
    v_mfma_f32_16x16x32_bf16 v[120:123], v[40:43], v[76:79], v[120:123]
    v_mfma_f32_16x16x32_bf16 v[108:111], v[72:75], v[76:79], 0
    ds_read_b128 v[104:107], v6 offset:1920
    s_waitcnt lgkmcnt(9)
    v_mfma_f32_16x16x32_bf16 v[120:123], v[36:39], v[80:83], v[120:123]
    v_mfma_f32_16x16x32_bf16 v[108:111], v[68:71], v[80:83], v[108:111]
    ds_read_b128 v[76:79], v6 offset:1984
    s_waitcnt lgkmcnt(8)
    v_mfma_f32_16x16x32_bf16 v[120:123], v[32:35], v[84:87], v[120:123]
    v_mfma_f32_16x16x32_bf16 v[108:111], v[64:67], v[84:87], v[108:111]
    s_waitcnt lgkmcnt(6)
    v_mfma_f32_16x16x32_bf16 v[120:123], v[28:31], v[88:91], v[120:123]
    ds_write_b64 v124, v[116:117] offset:2560
    v_mfma_f32_16x16x32_bf16 v[108:111], v[60:63], v[88:91], v[108:111]
    s_waitcnt lgkmcnt(5)
    v_mfma_f32_16x16x32_bf16 v[120:123], v[24:27], v[92:95], v[120:123]
    ds_write_b64 v124, v[118:119] offset:2568
    v_mfma_f32_16x16x32_bf16 v[108:111], v[56:59], v[92:95], v[108:111]
    s_waitcnt lgkmcnt(5)
    v_mfma_f32_16x16x32_bf16 v[120:123], v[20:23], v[96:99], v[120:123]
    ds_write_b32 v125, v126 offset:64
    v_mfma_f32_16x16x32_bf16 v[108:111], v[52:55], v[96:99], v[108:111]
    s_waitcnt lgkmcnt(5)
    v_mfma_f32_16x16x32_bf16 v[120:123], v[16:19], v[100:103], v[120:123]
    v_mfma_f32_16x16x32_bf16 v[108:111], v[48:51], v[100:103], v[108:111]
    s_waitcnt lgkmcnt(4)
    v_mfma_f32_16x16x32_bf16 v[120:123], v[12:15], v[104:107], v[120:123]
    v_mfma_f32_16x16x32_bf16 v[108:111], v[44:47], v[104:107], v[108:111]
    s_waitcnt lgkmcnt(3)
    v_mfma_f32_16x16x32_bf16 v[120:123], v[8:11], v[76:79], v[120:123]
    v_mfma_f32_16x16x32_bf16 v[108:111], v[40:43], v[76:79], v[108:111]
    v_mfma_f32_16x16x32_bf16 v[112:115], v[72:75], v[76:79], 0
    s_nop 7
    ds_write_b64 v124, v[120:121] offset:3840
    ds_write_b64 v124, v[122:123] offset:3848
    ds_write_b32 v125, v126 offset:96
    s_mov_b32 s9, 0
SPN8:
    ds_read_b32 v128, v127 offset:240
    s_add_u32 s9, s9, 1
    s_waitcnt lgkmcnt(0)
    v_cmp_ne_u32 vcc, 34, v128
    s_cmp_ge_u32 s9, 0x40000
    s_cbranch_scc1 SPX8
    s_cbranch_vccz SPX8
    s_sleep 1
    s_branch SPN8
SPX8:
    ds_read_b128 v[80:83], v6 offset:2048
    ds_read_b128 v[84:87], v6 offset:2112
    ds_read_b128 v[88:91], v6 offset:2176
    ds_read_b128 v[92:95], v6 offset:2240
    ds_read_b128 v[96:99], v6 offset:2304
    ds_read_b128 v[100:103], v6 offset:2368
    ds_read_b128 v[104:107], v6 offset:2432
    s_waitcnt lgkmcnt(6)
    v_mfma_f32_16x16x32_bf16 v[108:111], v[36:39], v[80:83], v[108:111]
    v_mfma_f32_16x16x32_bf16 v[112:115], v[68:71], v[80:83], v[112:115]
    ds_read_b128 v[76:79], v6 offset:2496
    s_waitcnt lgkmcnt(6)
    v_mfma_f32_16x16x32_bf16 v[108:111], v[32:35], v[84:87], v[108:111]
    v_mfma_f32_16x16x32_bf16 v[112:115], v[64:67], v[84:87], v[112:115]
    ds_read_b128 v[80:83], v6 offset:2560
    s_waitcnt lgkmcnt(6)
    v_mfma_f32_16x16x32_bf16 v[108:111], v[28:31], v[88:91], v[108:111]
    v_mfma_f32_16x16x32_bf16 v[112:115], v[60:63], v[88:91], v[112:115]
    ds_read_b128 v[84:87], v6 offset:2624
    s_waitcnt lgkmcnt(6)
    v_mfma_f32_16x16x32_bf16 v[108:111], v[24:27], v[92:95], v[108:111]
    v_mfma_f32_16x16x32_bf16 v[112:115], v[56:59], v[92:95], v[112:115]
    ds_read_b128 v[88:91], v6 offset:2688
    s_waitcnt lgkmcnt(6)
    v_mfma_f32_16x16x32_bf16 v[108:111], v[20:23], v[96:99], v[108:111]
    v_mfma_f32_16x16x32_bf16 v[112:115], v[52:55], v[96:99], v[112:115]
    ds_read_b128 v[92:95], v6 offset:2752
    s_waitcnt lgkmcnt(6)
    v_mfma_f32_16x16x32_bf16 v[108:111], v[16:19], v[100:103], v[108:111]
    v_mfma_f32_16x16x32_bf16 v[112:115], v[48:51], v[100:103], v[112:115]
    ds_read_b128 v[96:99], v6 offset:2816
    s_waitcnt lgkmcnt(6)
    v_mfma_f32_16x16x32_bf16 v[108:111], v[12:15], v[104:107], v[108:111]
    v_mfma_f32_16x16x32_bf16 v[112:115], v[44:47], v[104:107], v[112:115]
    ds_read_b128 v[100:103], v6 offset:2880
    s_waitcnt lgkmcnt(6)
    v_mfma_f32_16x16x32_bf16 v[108:111], v[8:11], v[76:79], v[108:111]
    v_mfma_f32_16x16x32_bf16 v[112:115], v[40:43], v[76:79], v[112:115]
    v_mfma_f32_16x16x32_bf16 v[116:119], v[72:75], v[76:79], 0
    ds_read_b128 v[104:107], v6 offset:2944
    s_waitcnt lgkmcnt(6)
    v_mfma_f32_16x16x32_bf16 v[112:115], v[36:39], v[80:83], v[112:115]
    v_mfma_f32_16x16x32_bf16 v[116:119], v[68:71], v[80:83], v[116:119]
    ds_read_b128 v[76:79], v6 offset:3008
    s_waitcnt lgkmcnt(6)
    v_mfma_f32_16x16x32_bf16 v[112:115], v[32:35], v[84:87], v[112:115]
    v_mfma_f32_16x16x32_bf16 v[116:119], v[64:67], v[84:87], v[116:119]
    ds_read_b128 v[80:83], v6 offset:3072
    s_waitcnt lgkmcnt(6)
    v_mfma_f32_16x16x32_bf16 v[112:115], v[28:31], v[88:91], v[112:115]
    ds_write_b64 v124, v[108:109] offset:5120
    v_mfma_f32_16x16x32_bf16 v[116:119], v[60:63], v[88:91], v[116:119]
    ds_read_b128 v[84:87], v6 offset:3136
    s_waitcnt lgkmcnt(7)
    v_mfma_f32_16x16x32_bf16 v[112:115], v[24:27], v[92:95], v[112:115]
    ds_write_b64 v124, v[110:111] offset:5128
    v_mfma_f32_16x16x32_bf16 v[116:119], v[56:59], v[92:95], v[116:119]
    ds_read_b128 v[88:91], v6 offset:3200
    s_waitcnt lgkmcnt(8)
    v_mfma_f32_16x16x32_bf16 v[112:115], v[20:23], v[96:99], v[112:115]
    ds_write_b32 v125, v126 offset:128
    v_mfma_f32_16x16x32_bf16 v[116:119], v[52:55], v[96:99], v[116:119]
    ds_read_b128 v[92:95], v6 offset:3264
    s_waitcnt lgkmcnt(9)
    v_mfma_f32_16x16x32_bf16 v[112:115], v[16:19], v[100:103], v[112:115]
    v_mfma_f32_16x16x32_bf16 v[116:119], v[48:51], v[100:103], v[116:119]
    ds_read_b128 v[96:99], v6 offset:3328
    s_waitcnt lgkmcnt(9)
    v_mfma_f32_16x16x32_bf16 v[112:115], v[12:15], v[104:107], v[112:115]
    v_mfma_f32_16x16x32_bf16 v[116:119], v[44:47], v[104:107], v[116:119]
    ds_read_b128 v[100:103], v6 offset:3392
    s_waitcnt lgkmcnt(9)
    v_mfma_f32_16x16x32_bf16 v[112:115], v[8:11], v[76:79], v[112:115]
    v_mfma_f32_16x16x32_bf16 v[116:119], v[40:43], v[76:79], v[116:119]
    v_mfma_f32_16x16x32_bf16 v[120:123], v[72:75], v[76:79], 0
    ds_read_b128 v[104:107], v6 offset:3456
    s_waitcnt lgkmcnt(9)
    v_mfma_f32_16x16x32_bf16 v[116:119], v[36:39], v[80:83], v[116:119]
    v_mfma_f32_16x16x32_bf16 v[120:123], v[68:71], v[80:83], v[120:123]
    ds_read_b128 v[76:79], v6 offset:3520
    s_waitcnt lgkmcnt(8)
    v_mfma_f32_16x16x32_bf16 v[116:119], v[32:35], v[84:87], v[116:119]
    v_mfma_f32_16x16x32_bf16 v[120:123], v[64:67], v[84:87], v[120:123]
    ds_read_b128 v[80:83], v6 offset:3584
    s_waitcnt lgkmcnt(7)
    v_mfma_f32_16x16x32_bf16 v[116:119], v[28:31], v[88:91], v[116:119]
    ds_write_b64 v124, v[112:113] offset:6400
    v_mfma_f32_16x16x32_bf16 v[120:123], v[60:63], v[88:91], v[120:123]
    ds_read_b128 v[84:87], v6 offset:3648
    s_waitcnt lgkmcnt(7)
    v_mfma_f32_16x16x32_bf16 v[116:119], v[24:27], v[92:95], v[116:119]
    ds_write_b64 v124, v[114:115] offset:6408
    v_mfma_f32_16x16x32_bf16 v[120:123], v[56:59], v[92:95], v[120:123]
    ds_read_b128 v[88:91], v6 offset:3712
    s_waitcnt lgkmcnt(8)
    v_mfma_f32_16x16x32_bf16 v[116:119], v[20:23], v[96:99], v[116:119]
    ds_write_b32 v125, v126 offset:160
    v_mfma_f32_16x16x32_bf16 v[120:123], v[52:55], v[96:99], v[120:123]
    ds_read_b128 v[92:95], v6 offset:3776
    s_waitcnt lgkmcnt(9)
    v_mfma_f32_16x16x32_bf16 v[116:119], v[16:19], v[100:103], v[116:119]
    v_mfma_f32_16x16x32_bf16 v[120:123], v[48:51], v[100:103], v[120:123]
    ds_read_b128 v[96:99], v6 offset:3840
    s_waitcnt lgkmcnt(9)
    v_mfma_f32_16x16x32_bf16 v[116:119], v[12:15], v[104:107], v[116:119]
    v_mfma_f32_16x16x32_bf16 v[120:123], v[44:47], v[104:107], v[120:123]
    ds_read_b128 v[100:103], v6 offset:3904
    s_waitcnt lgkmcnt(9)
    v_mfma_f32_16x16x32_bf16 v[116:119], v[8:11], v[76:79], v[116:119]
    v_mfma_f32_16x16x32_bf16 v[120:123], v[40:43], v[76:79], v[120:123]
    ds_read_b128 v[104:107], v6 offset:3968
    s_waitcnt lgkmcnt(9)
    v_mfma_f32_16x16x32_bf16 v[120:123], v[36:39], v[80:83], v[120:123]
    ds_read_b128 v[76:79], v6 offset:4032
    s_waitcnt lgkmcnt(8)
    v_mfma_f32_16x16x32_bf16 v[120:123], v[32:35], v[84:87], v[120:123]
    s_waitcnt lgkmcnt(6)
    v_mfma_f32_16x16x32_bf16 v[120:123], v[28:31], v[88:91], v[120:123]
    s_waitcnt lgkmcnt(4)
    v_mfma_f32_16x16x32_bf16 v[120:123], v[24:27], v[92:95], v[120:123]
    s_waitcnt lgkmcnt(3)
    v_mfma_f32_16x16x32_bf16 v[120:123], v[20:23], v[96:99], v[120:123]
    ds_write_b64 v124, v[116:117] offset:7680
    s_waitcnt lgkmcnt(3)
    v_mfma_f32_16x16x32_bf16 v[120:123], v[16:19], v[100:103], v[120:123]
    ds_write_b64 v124, v[118:119] offset:7688
    s_waitcnt lgkmcnt(3)
    v_mfma_f32_16x16x32_bf16 v[120:123], v[12:15], v[104:107], v[120:123]
    ds_write_b32 v125, v126 offset:192
    s_waitcnt lgkmcnt(3)
    v_mfma_f32_16x16x32_bf16 v[120:123], v[8:11], v[76:79], v[120:123]
    s_nop 7
    ds_write_b64 v124, v[120:121] offset:8960
    ds_write_b64 v124, v[122:123] offset:8968
    ds_write_b32 v125, v126 offset:224
    s_waitcnt lgkmcnt(0)
    s_endpgm
CK_T1:
    ds_read_b128 v[8:11], v128 offset:43296
    ds_read_b128 v[40:43], v128 offset:16896
    ds_read_b128 v[12:15], v128 offset:43360
    ds_read_b128 v[44:47], v128 offset:16960
    ds_read_b128 v[16:19], v128 offset:43424
    ds_read_b128 v[48:51], v128 offset:17024
    ds_read_b128 v[20:23], v128 offset:43488
    ds_read_b128 v[52:55], v128 offset:17088
    ds_read_b128 v[24:27], v128 offset:43552
    ds_read_b128 v[56:59], v128 offset:17152
    ds_read_b128 v[28:31], v128 offset:43616
    ds_read_b128 v[60:63], v128 offset:17216
    ds_read_b128 v[32:35], v128 offset:43680
    ds_read_b128 v[64:67], v128 offset:17280
    ds_read_b128 v[36:39], v128 offset:43744
    ds_read_b128 v[68:71], v128 offset:17344
    v_lshlrev_b32 v114, 8, v4
    v_lshl_add_u32 v114, v3, 4, v114
    v_add_u32 v114, s13, v114
    v_lshlrev_b32 v115, 7, v4
    v_lshl_add_u32 v115, v3, 2, v115
    v_add_u32 v115, s13, v115
    s_waitcnt lgkmcnt(14)
    v_mfma_f32_16x16x32_f16 v[104:107], v[40:43], v[8:11], 0
    s_waitcnt lgkmcnt(12)
    v_mfma_f32_16x16x32_f16 v[104:107], v[44:47], v[12:15], v[104:107]
    s_waitcnt lgkmcnt(10)
    v_mfma_f32_16x16x32_f16 v[104:107], v[48:51], v[16:19], v[104:107]
    s_waitcnt lgkmcnt(8)
    v_mfma_f32_16x16x32_f16 v[104:107], v[52:55], v[20:23], v[104:107]
    s_waitcnt lgkmcnt(6)
    v_mfma_f32_16x16x32_f16 v[104:107], v[56:59], v[24:27], v[104:107]
    s_waitcnt lgkmcnt(4)
    v_mfma_f32_16x16x32_f16 v[104:107], v[60:63], v[28:31], v[104:107]
    s_waitcnt lgkmcnt(2)
    v_mfma_f32_16x16x32_f16 v[104:107], v[64:67], v[32:35], v[104:107]
    s_waitcnt lgkmcnt(0)
    v_mfma_f32_16x16x32_f16 v[104:107], v[68:71], v[36:39], v[104:107]
    s_nop 7
    v_mul_f32 v104, s15, v104
    v_mul_f32 v105, s15, v105
    v_mul_f32 v106, s15, v106
    v_mul_f32 v107, s15, v107
    v_cvt_pk_bf16_f32 v116, v104, v105
    v_cvt_pk_bf16_f32 v117, v105, v105
    v_cvt_pk_bf16_f32 v118, v106, v107
    v_cvt_pk_bf16_f32 v119, v107, v107
    v_cvt_pk_bf16_f32 v120, v105, v106
    s_mov_b32 exec_hi, 0
    ds_write_b16 v114, v119 offset:560
    v_add_u32 v121, 1728, v114
    ds_write_b128 v114, v[116:119] offset:544
    ds_write2_b32 v121, v119, v119 offset0:11 offset1:12
    ds_write2_b32 v121, v117, v120 offset0:9 offset1:10
    ds_write_b16 v121, v116 offset:34
    s_not_b64 exec, exec
    ds_write_b32 v115, v116 offset:2208
    ds_write_b32 v115, v118 offset:2272
    s_mov_b64 exec, -1
    v_mov_b32 v167, 153600
    v_mov_b32 v166, 1
    s_lshl_b32 s8, s7, 2
    v_add_u32 v131, s8, v167
    s_mov_b64 exec, 1
    ds_add_u32 v131, v166 offset:80
    ds_add_u32 v167, v166 offset:76
    s_mov_b64 exec, -1
    v_mul_u32_u24 v164, 320, v4
    v_lshl_add_u32 v164, v3, 4, v164
    s_mul_i32 s8, s7, 20480
    v_add_u32 v164, s8, v164
    s_lshl_b32 s8, s3, 2
    s_add_u32 s8, s8, 153856
    v_mov_b32 v165, s8
    v_lshlrev_b32 v5, 2, v4
    v_sub_u32 v5, v3, v5
    v_lshl_add_u32 v7, v5, 2, s13
    v_lshl_add_u32 v5, v5, 3, s13
    v_add_u32 v7, 2848, v7
    v_mov_b32 v6, s13
    s_mov_b32 s9, 0
SPN9:
    ds_read_b32 v128, v131 offset:80
    s_add_u32 s9, s9, 1
    s_waitcnt lgkmcnt(0)
    v_cmp_ne_u32 vcc, 2, v128
    s_cmp_ge_u32 s9, 0x40000
    s_cbranch_scc1 SPX9
    s_cbranch_vccz SPX9
    s_sleep 1
    s_branch SPN9
SPX9:
    ds_read_b32 v130, v6 offset:2716
    ds_read_b64 v[8:9], v5 offset:2464
    ds_read_b64 v[10:11], v5 offset:2456
    ds_read_b64 v[12:13], v5 offset:2448
    ds_read_b64 v[14:15], v5 offset:2440
    ds_read_b64 v[16:17], v5 offset:2592
    ds_read_b64 v[18:19], v5 offset:2584
    ds_read_b64 v[20:21], v5 offset:2576
    ds_read_b64 v[22:23], v5 offset:2568
    ds_read_b64 v[24:25], v5 offset:2720
    ds_read_b64 v[26:27], v5 offset:2712
    ds_read_b64 v[28:29], v5 offset:2704
    ds_read_b64 v[30:31], v5 offset:2696
    ds_read2_b32 v[32:33], v7 offset0:16 offset1:15
    ds_read2_b32 v[34:35], v7 offset0:14 offset1:13
    ds_read2_b32 v[36:37], v7 offset0:32 offset1:31
    ds_read2_b32 v[38:39], v7 offset0:30 offset1:29
    ds_read2_b32 v[40:41], v7 offset0:48 offset1:47
    ds_read2_b32 v[42:43], v7 offset0:46 offset1:45
    ds_read2_b32 v[44:45], v7 offset0:64 offset1:63
    ds_read2_b32 v[46:47], v7 offset0:62 offset1:61
    v_lshlrev_b32 v6, 4, v4
    v_lshl_add_u32 v6, v3, 5, v6
    v_add_u32 v6, 4048, v6
    v_add_u32 v6, s13, v6
    v_lshlrev_b32 v5, 4, v2
    v_add_u32 v5, 154112, v5
    s_mov_b32 s9, 0
SPN10:
    ds_read_b32 v128, v167 offset:76
    s_add_u32 s9, s9, 1
    s_waitcnt lgkmcnt(0)
    v_cmp_ne_u32 vcc, 12, v128
    s_cmp_ge_u32 s9, 0x40000
    s_cbranch_scc1 SPX10
    s_cbranch_vccz SPX10
    s_sleep 1
    s_branch SPN10
SPX10:
    ds_read_b128 v[140:143], v5 offset:0
    ds_read_b128 v[144:147], v5 offset:1024
    ds_read_b128 v[148:151], v5 offset:2048
    ds_read_b128 v[152:155], v5 offset:3072
    ds_read_b128 v[156:159], v5 offset:4096
Z_PASS:
    ds_write_b128 v164, v[124:127] offset:10240
    ds_write_b32 v165, v166 offset:0
    ds_write_b128 v164, v[124:127] offset:11520
    ds_write_b32 v165, v166 offset:32
    s_mov_b32 s8, 0x07060706
    s_mov_b32 s9, 0
SPN11:
    ds_read_b32 v128, v167 offset:240
    s_add_u32 s9, s9, 1
    s_waitcnt lgkmcnt(0)
    v_and_b32 v128, 15, v128
    v_cmp_ne_u32 vcc, 2, v128
    s_cmp_ge_u32 s9, 0x40000
    s_cbranch_scc1 SPX11
    s_cbranch_vccz SPX11
    s_sleep 1
    s_branch SPN11
SPX11:
    v_perm_b32 v130, v130, v130, s8
Z_LOOP:
    ds_read_b128 v[48:51], v6 offset:16
    ds_read_b128 v[52:55], v6 offset:0
    ds_read_b128 v[56:59], v6 offset:528
    ds_read_b128 v[60:63], v6 offset:512
    v_and_b32 v156, v130, v156
    v_and_b32 v157, v130, v157
    v_and_b32 v158, v130, v158
    v_and_b32 v159, v130, v159
    s_waitcnt lgkmcnt(2)
    v_mfma_f32_16x16x32_bf16 v[64:67], v[48:51], v[140:143], 0
    v_mfma_f32_16x16x32_bf16 v[68:71], v[48:51], v[144:147], 0
    v_mfma_f32_16x16x32_bf16 v[72:75], v[52:55], v[140:143], 0
    v_mfma_f32_16x16x32_bf16 v[76:79], v[52:55], v[144:147], 0
    v_mfma_f32_16x16x32_bf16 v[80:83], v[48:51], v[148:151], 0
    v_mfma_f32_16x16x32_bf16 v[84:87], v[52:55], v[152:155], 0
    s_nop 3
    v_cvt_pk_bf16_f32 v88, v64, v68
    v_cvt_pk_bf16_f32 v90, v65, v69
    v_cvt_pk_bf16_f32 v92, v66, v70
    v_cvt_pk_bf16_f32 v94, v67, v71
    v_cvt_pk_bf16_f32 v89, v72, v76
    v_cvt_pk_bf16_f32 v91, v73, v77
    v_cvt_pk_bf16_f32 v93, v74, v78
    v_cvt_pk_bf16_f32 v95, v75, v79
    v_cvt_pk_bf16_f32 v96, v80, v84
    v_cvt_pk_bf16_f32 v97, v81, v85
    v_cvt_pk_bf16_f32 v98, v82, v86
    v_cvt_pk_bf16_f32 v99, v83, v87
    s_waitcnt lgkmcnt(0)
    v_mfma_f32_16x16x32_bf16 v[64:67], v[56:59], v[140:143], 0
    v_mfma_f32_16x16x32_bf16 v[68:71], v[56:59], v[144:147], 0
    v_mfma_f32_16x16x32_bf16 v[72:75], v[60:63], v[140:143], 0
    v_mfma_f32_16x16x32_bf16 v[76:79], v[60:63], v[144:147], 0
    v_mfma_f32_16x16x32_bf16 v[80:83], v[56:59], v[148:151], 0
    v_mfma_f32_16x16x32_bf16 v[84:87], v[60:63], v[152:155], 0
    v_mfma_f32_16x16x32_bf16 v[108:111], v[156:159], v[48:51], 0
    ds_read_b128 v[48:51], v6 offset:1040
    ds_read_b128 v[52:55], v6 offset:1024
    v_mfma_f32_16x16x32_bf16 v[100:103], v[88:91], v[8:11], 0
    v_mfma_f32_16x16x32_bf16 v[100:103], v[92:95], v[12:15], v[100:103]
    v_cvt_pk_bf16_f32 v132, v64, v68
    v_cvt_pk_bf16_f32 v134, v65, v69
    v_mfma_f32_16x16x32_bf16 v[104:107], v[88:91], v[16:19], 0
    v_cvt_pk_bf16_f32 v136, v66, v70
    v_cvt_pk_bf16_f32 v138, v67, v71
    v_mfma_f32_16x16x32_bf16 v[104:107], v[92:95], v[20:23], v[104:107]
    v_cvt_pk_bf16_f32 v133, v72, v76
    v_cvt_pk_bf16_f32 v135, v73, v77
    v_mfma_f32_16x16x32_bf16 v[108:111], v[88:91], v[24:27], v[108:111]
    v_cvt_pk_bf16_f32 v137, v74, v78
    v_cvt_pk_bf16_f32 v139, v75, v79
    v_mfma_f32_16x16x32_bf16 v[108:111], v[92:95], v[28:31], v[108:111]
    v_cvt_pk_bf16_f32 v160, v80, v84
    v_cvt_pk_bf16_f32 v161, v81, v85
    v_mfma_f32_16x16x32_bf16 v[108:111], v[96:99], v[32:35], v[108:111]
    v_cvt_pk_bf16_f32 v162, v82, v86
    v_cvt_pk_bf16_f32 v163, v83, v87
    v_mfma_f32_16x16x32_bf16 v[112:115], v[96:99], v[36:39], 0
    v_mfma_f32_16x16x32_bf16 v[116:119], v[96:99], v[40:43], 0
    v_mfma_f32_16x16x32_bf16 v[120:123], v[96:99], v[44:47], 0
    s_waitcnt lgkmcnt(0)
    v_mfma_f32_16x16x32_bf16 v[64:67], v[48:51], v[140:143], 0
    v_mfma_f32_16x16x32_bf16 v[68:71], v[48:51], v[144:147], 0
    ds_write_b64 v164, v[100:101] offset:12800
    v_mfma_f32_16x16x32_bf16 v[72:75], v[52:55], v[140:143], 0
    ds_write_b64 v164, v[102:103] offset:12808
    v_mfma_f32_16x16x32_bf16 v[76:79], v[52:55], v[144:147], 0
    ds_write_b32 v165, v166 offset:64
    v_mfma_f32_16x16x32_bf16 v[80:83], v[48:51], v[148:151], 0
    v_mfma_f32_16x16x32_bf16 v[84:87], v[52:55], v[152:155], 0
    v_mfma_f32_16x16x32_bf16 v[112:115], v[156:159], v[56:59], v[112:115]
    ds_read_b128 v[56:59], v6 offset:1552
    ds_read_b128 v[60:63], v6 offset:1536
    v_mfma_f32_16x16x32_bf16 v[104:107], v[132:135], v[8:11], v[104:107]
    v_mfma_f32_16x16x32_bf16 v[104:107], v[136:139], v[12:15], v[104:107]
    v_cvt_pk_bf16_f32 v88, v64, v68
    v_cvt_pk_bf16_f32 v90, v65, v69
    v_mfma_f32_16x16x32_bf16 v[108:111], v[132:135], v[16:19], v[108:111]
    v_cvt_pk_bf16_f32 v92, v66, v70
    v_cvt_pk_bf16_f32 v94, v67, v71
    v_mfma_f32_16x16x32_bf16 v[108:111], v[136:139], v[20:23], v[108:111]
    v_cvt_pk_bf16_f32 v89, v72, v76
    v_cvt_pk_bf16_f32 v91, v73, v77
    v_mfma_f32_16x16x32_bf16 v[112:115], v[132:135], v[24:27], v[112:115]
    v_cvt_pk_bf16_f32 v93, v74, v78
    v_cvt_pk_bf16_f32 v95, v75, v79
    v_mfma_f32_16x16x32_bf16 v[112:115], v[136:139], v[28:31], v[112:115]
    v_cvt_pk_bf16_f32 v96, v80, v84
    v_cvt_pk_bf16_f32 v97, v81, v85
    v_mfma_f32_16x16x32_bf16 v[112:115], v[160:163], v[32:35], v[112:115]
    v_cvt_pk_bf16_f32 v98, v82, v86
    v_cvt_pk_bf16_f32 v99, v83, v87
    v_mfma_f32_16x16x32_bf16 v[116:119], v[160:163], v[36:39], v[116:119]
    v_mfma_f32_16x16x32_bf16 v[120:123], v[160:163], v[40:43], v[120:123]
    s_waitcnt lgkmcnt(0)
    v_mfma_f32_16x16x32_bf16 v[64:67], v[56:59], v[140:143], 0
    v_mfma_f32_16x16x32_bf16 v[68:71], v[56:59], v[144:147], 0
    ds_write_b64 v164, v[104:105] offset:14080
    v_mfma_f32_16x16x32_bf16 v[72:75], v[60:63], v[140:143], 0
    ds_write_b64 v164, v[106:107] offset:14088
    v_mfma_f32_16x16x32_bf16 v[76:79], v[60:63], v[144:147], 0
    ds_write_b32 v165, v166 offset:96
    v_mfma_f32_16x16x32_bf16 v[80:83], v[56:59], v[148:151], 0
    v_mfma_f32_16x16x32_bf16 v[84:87], v[60:63], v[152:155], 0
    v_mfma_f32_16x16x32_bf16 v[116:119], v[156:159], v[48:51], v[116:119]
    v_mfma_f32_16x16x32_bf16 v[108:111], v[88:91], v[8:11], v[108:111]
    v_mfma_f32_16x16x32_bf16 v[108:111], v[92:95], v[12:15], v[108:111]
    v_mfma_f32_16x16x32_bf16 v[112:115], v[88:91], v[16:19], v[112:115]
    v_cvt_pk_bf16_f32 v132, v64, v68
    v_cvt_pk_bf16_f32 v134, v65, v69
    v_mfma_f32_16x16x32_bf16 v[112:115], v[92:95], v[20:23], v[112:115]
    v_cvt_pk_bf16_f32 v136, v66, v70
    v_cvt_pk_bf16_f32 v138, v67, v71
    v_mfma_f32_16x16x32_bf16 v[116:119], v[88:91], v[24:27], v[116:119]
    v_cvt_pk_bf16_f32 v133, v72, v76
    v_cvt_pk_bf16_f32 v135, v73, v77
    v_mfma_f32_16x16x32_bf16 v[116:119], v[92:95], v[28:31], v[116:119]
    v_cvt_pk_bf16_f32 v137, v74, v78
    v_cvt_pk_bf16_f32 v139, v75, v79
    v_mfma_f32_16x16x32_bf16 v[116:119], v[96:99], v[32:35], v[116:119]
    v_cvt_pk_bf16_f32 v160, v80, v84
    v_cvt_pk_bf16_f32 v161, v81, v85
    v_mfma_f32_16x16x32_bf16 v[120:123], v[96:99], v[36:39], v[120:123]
    v_cvt_pk_bf16_f32 v162, v82, v86
    v_cvt_pk_bf16_f32 v163, v83, v87
    s_nop 1
    v_mfma_f32_16x16x32_bf16 v[120:123], v[156:159], v[56:59], v[120:123]
    ds_write_b64 v164, v[108:109] offset:15360
    v_mfma_f32_16x16x32_bf16 v[112:115], v[132:135], v[8:11], v[112:115]
    ds_write_b64 v164, v[110:111] offset:15368
    v_mfma_f32_16x16x32_bf16 v[112:115], v[136:139], v[12:15], v[112:115]
    ds_write_b32 v165, v166 offset:128
    v_mfma_f32_16x16x32_bf16 v[116:119], v[132:135], v[16:19], v[116:119]
    v_mfma_f32_16x16x32_bf16 v[116:119], v[136:139], v[20:23], v[116:119]
    v_mfma_f32_16x16x32_bf16 v[120:123], v[132:135], v[24:27], v[120:123]
    v_mfma_f32_16x16x32_bf16 v[120:123], v[136:139], v[28:31], v[120:123]
    v_mfma_f32_16x16x32_bf16 v[120:123], v[160:163], v[32:35], v[120:123]
    s_mov_b32 s9, 0
SPN12:
    ds_read_b32 v128, v167 offset:240
    s_add_u32 s9, s9, 1
    s_waitcnt lgkmcnt(0)
    v_cmp_ne_u32 vcc, 34, v128
    s_cmp_ge_u32 s9, 0x40000
    s_cbranch_scc1 SPX12
    s_cbranch_vccz SPX12
    s_sleep 1
    s_branch SPN12
SPX12:
    s_cmp_lg_u32 s3, 4
    s_cbranch_scc1 Z_NOSEL
    v_and_b32 v126, 4, v2
    v_add_u32 v126, v126, v4
    s_lshl_b32 s9, s4, 8
    v_lshl_add_u32 v126, v126, 3, s9
    global_load_dwordx2 v[124:125], v126, s[50:51] offset:256 sc1
    s_lshl_b32 s9, s4, 7
    v_mov_b32 v126, s9
    global_load_dword v127, v126, s[50:51] offset:2304 sc1
Z_NOSEL:
    ds_read_b128 v[48:51], v6 offset:2064
    ds_read_b128 v[52:55], v6 offset:2048
    ds_read_b128 v[56:59], v6 offset:2576
    ds_read_b128 v[60:63], v6 offset:2560
    ds_write_b64 v164, v[112:113] offset:16640
    ds_write_b64 v164, v[114:115] offset:16648
    ds_write_b32 v165, v166 offset:160
    s_waitcnt lgkmcnt(5)
    v_mfma_f32_16x16x32_bf16 v[64:67], v[48:51], v[140:143], 0
    v_mfma_f32_16x16x32_bf16 v[68:71], v[48:51], v[144:147], 0
    v_mfma_f32_16x16x32_bf16 v[72:75], v[52:55], v[140:143], 0
    v_mfma_f32_16x16x32_bf16 v[76:79], v[52:55], v[144:147], 0
    s_nop 5
    v_cvt_pk_bf16_f32 v88, v64, v68
    v_cvt_pk_bf16_f32 v90, v65, v69
    v_cvt_pk_bf16_f32 v92, v66, v70
    v_cvt_pk_bf16_f32 v94, v67, v71
    v_cvt_pk_bf16_f32 v89, v72, v76
    v_cvt_pk_bf16_f32 v91, v73, v77
    v_cvt_pk_bf16_f32 v93, v74, v78
    v_cvt_pk_bf16_f32 v95, v75, v79
    s_waitcnt lgkmcnt(3)
    v_mfma_f32_16x16x32_bf16 v[64:67], v[56:59], v[140:143], 0
    v_mfma_f32_16x16x32_bf16 v[68:71], v[56:59], v[144:147], 0
    v_mfma_f32_16x16x32_bf16 v[72:75], v[60:63], v[140:143], 0
    v_mfma_f32_16x16x32_bf16 v[76:79], v[60:63], v[144:147], 0
    v_mfma_f32_16x16x32_bf16 v[116:119], v[88:91], v[8:11], v[116:119]
    v_mfma_f32_16x16x32_bf16 v[116:119], v[92:95], v[12:15], v[116:119]
    v_mfma_f32_16x16x32_bf16 v[120:123], v[88:91], v[16:19], v[120:123]
    v_mfma_f32_16x16x32_bf16 v[120:123], v[92:95], v[20:23], v[120:123]
    s_nop 1
    v_cvt_pk_bf16_f32 v132, v64, v68
    v_cvt_pk_bf16_f32 v134, v65, v69
    v_cvt_pk_bf16_f32 v136, v66, v70
    v_cvt_pk_bf16_f32 v138, v67, v71
    v_cvt_pk_bf16_f32 v133, v72, v76
    v_cvt_pk_bf16_f32 v135, v73, v77
    v_cvt_pk_bf16_f32 v137, v74, v78
    v_cvt_pk_bf16_f32 v139, v75, v79
    ds_write_b64 v164, v[116:117] offset:17920
    ds_write_b64 v164, v[118:119] offset:17928
    v_mfma_f32_16x16x32_bf16 v[120:123], v[132:135], v[8:11], v[120:123]
    v_mfma_f32_16x16x32_bf16 v[120:123], v[136:139], v[12:15], v[120:123]
    ds_write_b32 v165, v166 offset:192
    s_nop 6
    ds_write_b64 v164, v[120:121] offset:19200
    ds_write_b64 v164, v[122:123] offset:19208
    ds_write_b32 v165, v166 offset:224
    s_setprio 0
    s_cmp_eq_u32 s3, 4
    s_cbranch_scc1 FINAL
    s_waitcnt lgkmcnt(0)
    s_endpgm
CU_C3A:
    s_cmp_eq_u32 s4, 3
    s_cselect_b32 s8, 18, 6
    s_cmp_ge_u32 s101, s8
    s_cbranch_scc1 CU_C3B
    s_sub_u32 s14, 3, s4
    s_and_b32 s14, s14, 7
    s_and_b32 s8, s101, 1
    s_lshl_b32 s8, s8, 3
    s_lshr_b32 s9, s101, 1
    s_cmp_eq_u32 s4, 3
    s_cselect_b32 s14, s8, s14
    s_cselect_b32 s9, s9, s101
    s_add_u32 s9, s9, 4
    s_min_u32 s9, s9, 17
    s_mul_i32 s9, s9, 9
    s_add_u32 s14, s14, s9
    v_mul_u32_u24 v140, 9216, v2
    s_mul_i32 s8, s4, 1152
    v_add_u32 v140, s8, v140
    s_mul_i32 s8, s14, 7282
    s_lshr_b32 s8, s8, 16
    s_mul_i32 s9, s8, 9
    s_sub_u32 s9, s14, s9
    s_lshl_b32 s9, s9, 7
    s_bitcmp1_b32 s8, 0
    s_cselect_b32 s12, s40, s38
    s_cselect_b32 s13, s41, s39
    s_lshr_b32 s8, s8, 1
    s_add_u32 s8, s8, 0
    s_mul_i32 s8, s8, 589824
    s_add_u32 s8, s8, s9
    v_add_u32 v148, s8, v140
    global_load_dword v149, v148, s[12:13]
    s_lshl_b32 s9, s6, 3
    s_branch CU_C3B
CU_C3:
    s_cmp_eq_u32 s4, 3
    s_cselect_b32 s8, 18, 6
    s_add_u32 s10, s10, s8
    s_sub_u32 s14, 3, s4
    s_and_b32 s14, s14, 7
    s_and_b32 s8, s10, 1
    s_lshl_b32 s8, s8, 3
    s_lshr_b32 s9, s10, 1
    s_cmp_eq_u32 s4, 3
    s_cselect_b32 s14, s8, s14
    s_cselect_b32 s9, s9, s10
    s_add_u32 s9, s9, 4
    s_min_u32 s9, s9, 17
    s_mul_i32 s9, s9, 9
    s_add_u32 s14, s14, s9
    v_mul_u32_u24 v140, 9216, v2
    s_mul_i32 s8, s4, 1152
    v_add_u32 v140, s8, v140
    s_mul_i32 s8, s14, 7282
    s_lshr_b32 s8, s8, 16
    s_mul_i32 s9, s8, 9
    s_sub_u32 s9, s14, s9
    s_lshl_b32 s9, s9, 7
    s_bitcmp1_b32 s8, 0
    s_cselect_b32 s12, s40, s38
    s_cselect_b32 s13, s41, s39
    s_lshr_b32 s8, s8, 1
    s_add_u32 s8, s8, 0
    s_mul_i32 s8, s8, 589824
    s_add_u32 s8, s8, s9
    v_add_u32 v148, s8, v140
    global_load_dword v149, v148, s[12:13]
    s_lshl_b32 s9, s6, 3
    s_branch CU_C3X
CU_MID:
    s_min_u32 s13, s7, 2
    s_mov_b32 s12, 0
SPN13:
    ds_read_b32 v56, v57 offset:64
    s_add_u32 s12, s12, 1
    s_waitcnt lgkmcnt(0)
    v_cmp_gt_u32 vcc, s13, v56
    s_cmp_ge_u32 s12, 0x40000
    s_cbranch_scc1 SPX13
    s_cbranch_vccz SPX13
    s_sleep 2
    s_branch SPN13
SPX13:
    s_branch CU_LD
CU_PRE:
    v_mov_b32 v139, 1
    v_lshlrev_b32 v74, 3, v4
    v_sub_u32 v74, v74, v3
    v_and_b32 v74, 0xffff, v74
    v_lshl_or_b32 v74, v74, 16, v74
    v_mov_b32 v75, 0x3f803f80
    s_mul_i32 s8, s7, 0x20002
    s_add_u32 s8, s8, 0xfff0fff1
    v_pk_add_u16 v76, v74, s8
    v_pk_add_u16 v80, v76, 2 op_sel_hi:[1,0]
    v_pk_ashrrev_i16 v80, 15, v80 op_sel_hi:[0,1]
    v_pk_add_u16 v81, v76, 3 op_sel_hi:[1,0]
    v_pk_ashrrev_i16 v81, 15, v81 op_sel_hi:[0,1]
    v_pk_add_u16 v82, v76, 4 op_sel_hi:[1,0]
    v_pk_ashrrev_i16 v82, 15, v82 op_sel_hi:[0,1]
    v_pk_add_u16 v83, v76, 5 op_sel_hi:[1,0]
    v_pk_ashrrev_i16 v83, 15, v83 op_sel_hi:[0,1]
    v_pk_add_u16 v84, v76, 10 op_sel_hi:[1,0]
    v_pk_ashrrev_i16 v84, 15, v84 op_sel_hi:[0,1]
    v_pk_add_u16 v85, v76, 11 op_sel_hi:[1,0]
    v_pk_ashrrev_i16 v85, 15, v85 op_sel_hi:[0,1]
    v_pk_add_u16 v86, v76, 12 op_sel_hi:[1,0]
    v_pk_ashrrev_i16 v86, 15, v86 op_sel_hi:[0,1]
    s_lshl_b32 s8, s7, 2
    s_add_u32 s8, s8, 154112
    v_lshl_add_u32 v74, v2, 4, s8
    v_bitop3_b32 v88, v80, v83, v75 bitop3:0x28
    ds_write_b32 v74, v88 offset:0
    v_bitop3_b32 v89, v83, v84, v75 bitop3:0x28
    ds_write_b32 v74, v89 offset:1024
    v_bitop3_b32 v90, v82, v85, v75 bitop3:0x28
    ds_write_b32 v74, v90 offset:2048
    v_bitop3_b32 v91, v81, v86, v75 bitop3:0x28
    ds_write_b32 v74, v91 offset:3072
    v_xor_b32 v92, v80, v82
    ds_write_b32 v74, v92 offset:4096
    s_mov_b64 exec, 1
    ds_add_u32 v57, v139 offset:76
    s_mov_b64 exec, -1
    s_mov_b32 s72, s15
    v_lshrrev_b32 v158, 2, v2
    v_mul_u32_u24 v158, 256, v158
    v_and_b32 v137, 3, v2
    v_lshl_add_u32 v158, v137, 4, v158
    v_lshrrev_b32 v138, 1, v2
    v_mul_u32_u24 v138, 256, v138
    v_and_b32 v137, 1, v2
    v_lshl_add_u32 v138, v137, 4, v138
    v_add_u32 v138, 20544, v138
    s_mul_i32 s8, s15, 4096
    s_add_u32 s8, s8, 4224
    v_add_u32 v158, s8, v158
    v_add_u32 v137, 24576, v158
    v_add_u32 v138, 4224, v138
    s_cmp_eq_u32 s7, 1
    s_cselect_b64 vcc, -1, 0
    v_cndmask_b32 v138, v137, v138, vcc
    v_and_b32 v146, 3, v2
    v_mul_u32_u24 v159, 320, v146
    v_lshl_add_u32 v146, v146, 2, v57
    v_lshrrev_b32 v136, 2, v2
    v_lshl_add_u32 v159, v136, 4, v159
    s_mul_i32 s8, s72, 1280
    v_add_u32 v159, s8, v159
    v_add_u32 v136, 40960, v159
    v_and_b32 v141, 7, v2
    s_lshl_b32 s8, s72, 5
    s_add_u32 s8, s8, 153856
    v_lshl_add_u32 v141, v141, 2, s8
    s_lshl_b32 s8, s72, 10
    v_lshl_add_u32 v147, v2, 4, s8
    v_lshlrev_b32 v142, 1, v147
    v_add_u32 v147, 98304, v147
    v_add_u32 v142, 81920, v142
    s_lshl_b32 s8, s72, 9
    s_add_u32 s8, s8, 124928
    v_lshl_add_u32 v58, v2, 3, s8
    s_mov_b32 s74, 0x05040100
    s_mov_b32 s75, 0x07060302
    s_cmp_lt_u32 s7, 2
    s_cselect_b32 s8, 1, 16
    v_mov_b32 v143, s8
    s_waitcnt lgkmcnt(0)
    v_lshlrev_b32 v154, 16, s52
    v_mov_b32 v155, s52
    v_lshlrev_b32 v156, 16, s53
    v_mov_b32 v157, s53
    v_and_b32 v155, 0xffff0000, v155
    v_and_b32 v157, 0xffff0000, v157
    v_add_f32 v154, -1.0, v154
    v_add_f32 v155, -1.0, v155
    v_add_f32 v156, -1.0, v156
    v_add_f32 v157, -1.0, v157
    s_waitcnt vmcnt(0)
    s_branch CU_PREX
CU_MAIN:
    s_mov_b64 exec, 1
    ds_add_u32 v57, v139 offset:64
    s_mov_b64 exec, -1
    s_setprio 3
    s_waitcnt vmcnt(6)
    v_perm_b32 v64, v8, v10, s74
    v_perm_b32 v66, v8, v10, s75
    v_perm_b32 v68, v9, v11, s74
    v_perm_b32 v70, v9, v11, s75
    s_waitcnt vmcnt(4)
    v_perm_b32 v65, v12, v14, s74
    v_perm_b32 v67, v12, v14, s75
    v_perm_b32 v69, v13, v15, s74
    v_perm_b32 v71, v13, v15, s75
    ds_write_b64 v58, v[64:65] offset:0
    ds_write_b64 v58, v[66:67] offset:8192
    ds_write_b64 v58, v[68:69] offset:16384
    ds_write_b64 v58, v[70:71] offset:24576
    s_waitcnt vmcnt(2)
    v_perm_b32 v72, v16, v18, s74
    v_perm_b32 v74, v16, v18, s75
    v_perm_b32 v76, v17, v19, s74
    v_perm_b32 v78, v17, v19, s75
    s_waitcnt vmcnt(0)
    v_perm_b32 v73, v20, v22, s74
    v_perm_b32 v75, v20, v22, s75
    v_perm_b32 v77, v21, v23, s74
    v_perm_b32 v79, v21, v23, s75
    ds_write_b64 v58, v[72:73] offset:1024
    ds_write_b64 v58, v[74:75] offset:9216
    ds_write_b64 v58, v[76:77] offset:17408
    ds_write_b64 v58, v[78:79] offset:25600
    s_mov_b64 exec, 1
    ds_add_u32 v57, v143 offset:240
    s_mov_b64 exec, -1
    s_setprio 3
    s_cmp_ge_u32 s7, 2
    s_cbranch_scc1 E_NOG
    s_mov_b32 s12, 0
SPN14:
    ds_read_b32 v60, v57 offset:64
    s_add_u32 s12, s12, 1
    s_waitcnt lgkmcnt(0)
    v_cmp_gt_u32 vcc, 4, v60
    s_cmp_ge_u32 s12, 0x40000
    s_cbranch_scc1 SPX14
    s_cbranch_vccz SPX14
    s_sleep 1
    s_branch SPN14
SPX14:
    global_load_dwordx2 v[144:145], v59, s[48:49] sc1
    global_load_dwordx4 v[128:131], v158, s[50:51] sc1
    v_add_u32 v137, 8192, v158
    global_load_dwordx4 v[132:135], v137, s[50:51] sc1
    v_add_u32 v137, 16384, v158
    global_load_dwordx4 v[160:163], v137, s[50:51] sc1
    global_load_dwordx4 v[164:167], v138, s[50:51] sc1
    s_add_u32 s15, s7, 0
    s_cmp_ge_u32 s15, 4
    s_cbranch_scc1 CPF_DE0
    s_mul_i32 s14, s15, 18
    s_add_u32 s14, s14, s101
    v_mul_u32_u24 v140, 9216, v2
    s_mul_i32 s8, s4, 1152
    v_add_u32 v140, s8, v140
    s_mul_i32 s8, s14, 7282
    s_lshr_b32 s8, s8, 16
    s_mul_i32 s9, s8, 9
    s_sub_u32 s9, s14, s9
    s_lshl_b32 s9, s9, 7
    s_bitcmp1_b32 s8, 0
    s_cselect_b32 s12, s40, s38
    s_cselect_b32 s13, s41, s39
    s_lshr_b32 s8, s8, 1
    s_add_u32 s8, s8, 5
    s_mul_i32 s8, s8, 589824
    s_add_u32 s8, s8, s9
    v_add_u32 v148, s8, v140
    global_load_dword v149, v148, s[12:13]
    s_branch CPF_XE0
CPF_DE0:
    s_sub_u32 s14, s15, 4
    s_mul_i32 s14, s14, 18
    s_add_u32 s14, s14, s101
    s_min_u32 s14, s14, 80
    s_mul_i32 s8, s4, 81
    s_add_u32 s8, s8, 80
    s_sub_u32 s8, s8, s14
    s_lshl_b32 s8, s8, 13
    v_lshl_add_u32 v148, v2, 7, s8
    global_load_dword v149, v148, s[42:43]
CPF_XE0:
    s_add_u32 s15, s7, 2
    s_cmp_ge_u32 s15, 4
    s_cbranch_scc1 CPF_DE1
    s_mul_i32 s14, s15, 18
    s_add_u32 s14, s14, s101
    v_mul_u32_u24 v140, 9216, v2
    s_mul_i32 s8, s4, 1152
    v_add_u32 v140, s8, v140
    s_mul_i32 s8, s14, 7282
    s_lshr_b32 s8, s8, 16
    s_mul_i32 s9, s8, 9
    s_sub_u32 s9, s14, s9
    s_lshl_b32 s9, s9, 7
    s_bitcmp1_b32 s8, 0
    s_cselect_b32 s12, s40, s38
    s_cselect_b32 s13, s41, s39
    s_lshr_b32 s8, s8, 1
    s_add_u32 s8, s8, 5
    s_mul_i32 s8, s8, 589824
    s_add_u32 s8, s8, s9
    v_add_u32 v148, s8, v140
    global_load_dword v149, v148, s[12:13]
    s_branch CPF_XE1
CPF_DE1:
    s_sub_u32 s14, s15, 4
    s_mul_i32 s14, s14, 18
    s_add_u32 s14, s14, s101
    s_min_u32 s14, s14, 80
    s_mul_i32 s8, s4, 81
    s_add_u32 s8, s8, 80
    s_sub_u32 s8, s8, s14
    s_lshl_b32 s8, s8, 13
    v_lshl_add_u32 v148, v2, 7, s8
    global_load_dword v149, v148, s[42:43]
CPF_XE1:
    s_add_u32 s15, s7, 4
    s_cmp_ge_u32 s15, 4
    s_cbranch_scc1 CPF_DE2
    s_mul_i32 s14, s15, 18
    s_add_u32 s14, s14, s101
    v_mul_u32_u24 v140, 9216, v2
    s_mul_i32 s8, s4, 1152
    v_add_u32 v140, s8, v140
    s_mul_i32 s8, s14, 7282
    s_lshr_b32 s8, s8, 16
    s_mul_i32 s9, s8, 9
    s_sub_u32 s9, s14, s9
    s_lshl_b32 s9, s9, 7
    s_bitcmp1_b32 s8, 0
    s_cselect_b32 s12, s40, s38
    s_cselect_b32 s13, s41, s39
    s_lshr_b32 s8, s8, 1
    s_add_u32 s8, s8, 5
    s_mul_i32 s8, s8, 589824
    s_add_u32 s8, s8, s9
    v_add_u32 v148, s8, v140
    global_load_dword v149, v148, s[12:13]
    s_branch CPF_XE2
CPF_DE2:
    s_sub_u32 s14, s15, 4
    s_mul_i32 s14, s14, 18
    s_add_u32 s14, s14, s101
    s_min_u32 s14, s14, 80
    s_mul_i32 s8, s4, 81
    s_add_u32 s8, s8, 80
    s_sub_u32 s8, s8, s14
    s_lshl_b32 s8, s8, 13
    v_lshl_add_u32 v148, v2, 7, s8
    global_load_dword v149, v148, s[42:43]
CPF_XE2:
E_NOG:
    v_lshlrev_b32 v24, 16, v8
    v_and_b32 v28, 0xffff0000, v8
    v_lshlrev_b32 v32, 16, v9
    v_and_b32 v36, 0xffff0000, v9
    v_lshlrev_b32 v25, 16, v10
    v_and_b32 v29, 0xffff0000, v10
    v_lshlrev_b32 v33, 16, v11
    v_and_b32 v37, 0xffff0000, v11
    v_lshlrev_b32 v26, 16, v12
    v_and_b32 v30, 0xffff0000, v12
    v_lshlrev_b32 v34, 16, v13
    v_and_b32 v38, 0xffff0000, v13
    v_lshlrev_b32 v27, 16, v14
    v_and_b32 v31, 0xffff0000, v14
    v_lshlrev_b32 v35, 16, v15
    v_and_b32 v39, 0xffff0000, v15
    v_lshlrev_b32 v40, 16, v16
    v_and_b32 v44, 0xffff0000, v16
    v_lshlrev_b32 v48, 16, v17
    v_and_b32 v52, 0xffff0000, v17
    v_lshlrev_b32 v41, 16, v18
    v_and_b32 v45, 0xffff0000, v18
    v_lshlrev_b32 v49, 16, v19
    v_and_b32 v53, 0xffff0000, v19
    v_lshlrev_b32 v42, 16, v20
    v_and_b32 v46, 0xffff0000, v20
    v_lshlrev_b32 v50, 16, v21
    v_and_b32 v54, 0xffff0000, v21
    v_lshlrev_b32 v43, 16, v22
    v_and_b32 v47, 0xffff0000, v22
    v_lshlrev_b32 v51, 16, v23
    v_and_b32 v55, 0xffff0000, v23
    s_cmp_ge_u32 s7, 2
    s_cbranch_scc1 E_GATES
E_T0:
    s_mov_b32 s12, 0
SPN15:
    ds_read_b32 v60, v141 offset:0
    s_add_u32 s12, s12, 1
    s_waitcnt lgkmcnt(0)
    v_cmp_eq_u32 vcc, 0, v60
    s_cmp_ge_u32 s12, 0x40000
    s_cbranch_scc1 SPX15
    s_cbranch_vccz SPX15
    s_sleep 1
    s_branch SPN15
SPX15:
    ds_read_b128 v[96:99], v159 offset:0
    ds_read_b128 v[112:115], v159 offset:10240
    ds_read_b128 v[100:103], v159 offset:20480
    ds_read_b128 v[116:119], v159 offset:30720
    ds_read_b128 v[104:107], v136 offset:0
    ds_read_b128 v[120:123], v136 offset:10240
    ds_read_b128 v[108:111], v136 offset:20480
    ds_read_b128 v[124:127], v136 offset:30720
    s_waitcnt lgkmcnt(6)
    v_add_f32 v96, v96, v112
    v_fmac_f32 v96, v24, v154
    v_add_f32 v97, v97, v113
    v_fmac_f32 v97, v25, v154
    v_add_f32 v98, v98, v114
    v_fmac_f32 v98, v26, v154
    v_add_f32 v99, v99, v115
    v_fmac_f32 v99, v27, v154
    s_waitcnt lgkmcnt(4)
    v_add_f32 v100, v100, v116
    v_fmac_f32 v100, v28, v155
    v_add_f32 v101, v101, v117
    v_fmac_f32 v101, v29, v155
    v_add_f32 v102, v102, v118
    v_fmac_f32 v102, v30, v155
    v_add_f32 v103, v103, v119
    v_fmac_f32 v103, v31, v155
    s_waitcnt lgkmcnt(2)
    v_add_f32 v104, v104, v120
    v_fmac_f32 v104, v32, v156
    v_add_f32 v105, v105, v121
    v_fmac_f32 v105, v33, v156
    v_add_f32 v106, v106, v122
    v_fmac_f32 v106, v34, v156
    v_add_f32 v107, v107, v123
    v_fmac_f32 v107, v35, v156
    s_waitcnt lgkmcnt(0)
    v_add_f32 v108, v108, v124
    v_fmac_f32 v108, v36, v157
    v_add_f32 v109, v109, v125
    v_fmac_f32 v109, v37, v157
    v_add_f32 v110, v110, v126
    v_fmac_f32 v110, v38, v157
    v_add_f32 v111, v111, v127
    v_fmac_f32 v111, v39, v157
    s_cmp_ge_u32 s7, 2
    s_cbranch_scc1 E_OUT0
E_GATES:
    s_cmp_lt_u32 s7, 2
    s_cbranch_scc1 E_G1
    s_mov_b32 s12, 0
SPN16:
    ds_read_b32 v60, v57 offset:116
    s_add_u32 s12, s12, 1
    s_waitcnt lgkmcnt(0)
    v_cmp_ne_u32 vcc, 2, v60
    s_cmp_ge_u32 s12, 0x40000
    s_cbranch_scc1 SPX16
    s_cbranch_vccz SPX16
    s_sleep 1
    s_branch SPN16
SPX16:
    ds_read_b128 v[128:131], v147
    ds_read_b128 v[132:135], v147 offset:2048
    ds_read_b32 v144, v57 offset:120
    s_waitcnt lgkmcnt(0)
    s_branch E_GX
E_G1:
    s_mov_b32 s12, 0
    s_waitcnt vmcnt(3)
    s_branch E_GCHK
E_GPOLL:
    global_load_dwordx2 v[144:145], v59, s[48:49] sc1
    global_load_dwordx4 v[128:131], v158, s[50:51] sc1
    v_add_u32 v137, 8192, v158
    global_load_dwordx4 v[132:135], v137, s[50:51] sc1
    v_add_u32 v137, 16384, v158
    global_load_dwordx4 v[160:163], v137, s[50:51] sc1
    global_load_dwordx4 v[164:167], v138, s[50:51] sc1
    s_add_u32 s12, s12, 1
    s_waitcnt vmcnt(0)
E_GCHK:
    v_xor_b32 v61, 1, v145
    v_bitop3_b32 v61, v61, v128, v144 bitop3:0xf6
    v_bitop3_b32 v61, v61, v129, v144 bitop3:0xf6
    v_bitop3_b32 v61, v61, v130, v144 bitop3:0xf6
    v_bitop3_b32 v61, v61, v131, v144 bitop3:0xf6
    v_bitop3_b32 v61, v61, v132, v144 bitop3:0xf6
    v_bitop3_b32 v61, v61, v133, v144 bitop3:0xf6
    v_bitop3_b32 v61, v61, v134, v144 bitop3:0xf6
    v_bitop3_b32 v61, v61, v135, v144 bitop3:0xf6
    v_bitop3_b32 v61, v61, v160, v144 bitop3:0xf6
    v_bitop3_b32 v61, v61, v161, v144 bitop3:0xf6
    v_bitop3_b32 v61, v61, v162, v144 bitop3:0xf6
    v_bitop3_b32 v61, v61, v163, v144 bitop3:0xf6
    v_bitop3_b32 v61, v61, v164, v144 bitop3:0xf6
    v_bitop3_b32 v61, v61, v165, v144 bitop3:0xf6
    v_bitop3_b32 v61, v61, v166, v144 bitop3:0xf6
    v_bitop3_b32 v61, v61, v167, v144 bitop3:0xf6
    v_and_b32 v61, 0xffff, v61
    v_cmp_ne_u32 vcc, 0, v61
    s_cmp_ge_u32 s12, 16384
    s_cbranch_scc1 E_GOK
    s_cbranch_vccnz E_GPOLL
E_GOK:
    ds_write_b128 v147, v[160:163] offset:4096
    ds_write_b128 v147, v[164:167] offset:6144
    ds_write_b128 v147, v[128:131] offset:0
    ds_write_b128 v147, v[132:135] offset:2048
    ds_write_b32 v57, v144 offset:120
    s_mov_b64 exec, 1
    ds_add_u32 v57, v139 offset:116
    s_mov_b64 exec, -1
E_GX:
    ds_write_b128 v142, v[8:11] offset:0
    ds_write_b128 v142, v[12:15] offset:16
    ds_write_b128 v142, v[16:19] offset:4096
    ds_write_b128 v142, v[20:23] offset:4112
    s_mov_b64 exec, 1
    ds_add_u32 v57, v139 offset:244
    s_mov_b64 exec, -1
    v_and_b32 v128, 0xffff0000, v128
    v_and_b32 v129, 0xffff0000, v129
    v_and_b32 v130, 0xffff0000, v130
    v_and_b32 v131, 0xffff0000, v131
    s_cmp_ge_u32 s7, 2
    s_cbranch_scc1 E_T0
E_OUT0:
    v_fma_f32 v96, v96, v128, v24
    v_fma_f32 v100, v100, v128, v28
    v_fma_f32 v104, v104, v128, v32
    v_fma_f32 v108, v108, v128, v36
    v_cvt_pk_bf16_f32 v114, v96, v100
    v_cvt_pk_bf16_f32 v115, v104, v108
    s_cmp_ge_u32 s101, 16
    s_cbranch_scc1 E_NS00
    global_store_dwordx2 v5, v[114:115], s[46:47] offset:0
E_NS00:
    v_fma_f32 v97, v97, v129, v25
    v_fma_f32 v101, v101, v129, v29
    v_fma_f32 v105, v105, v129, v33
    v_fma_f32 v109, v109, v129, v37
    v_cvt_pk_bf16_f32 v118, v97, v101
    v_cvt_pk_bf16_f32 v119, v105, v109
    s_cmp_ge_u32 s101, 16
    s_cbranch_scc1 E_NS01
    global_store_dwordx2 v5, v[118:119], s[46:47] offset:1152
E_NS01:
    v_fma_f32 v98, v98, v130, v26
    v_fma_f32 v102, v102, v130, v30
    v_fma_f32 v106, v106, v130, v34
    v_fma_f32 v110, v110, v130, v38
    v_cvt_pk_bf16_f32 v122, v98, v102
    v_cvt_pk_bf16_f32 v123, v106, v110
    s_cmp_ge_u32 s101, 16
    s_cbranch_scc1 E_NS02
    global_store_dwordx2 v5, v[122:123], s[46:47] offset:2304
E_NS02:
    v_fma_f32 v99, v99, v131, v27
    v_fma_f32 v103, v103, v131, v31
    v_fma_f32 v107, v107, v131, v35
    v_fma_f32 v111, v111, v131, v39
    v_cvt_pk_bf16_f32 v126, v99, v103
    v_cvt_pk_bf16_f32 v127, v107, v111
    s_cmp_ge_u32 s101, 16
    s_cbranch_scc1 E_NS03
    global_store_dwordx2 v5, v[126:127], s[46:47] offset:3456
E_NS03:
    s_cmp_lt_u32 s101, 16
    s_cbranch_scc1 E_WX0
    v_mov_b32 v112, v144
    v_mov_b32 v113, v144
    v_mov_b32 v116, v144
    v_mov_b32 v117, v144
    v_mov_b32 v120, v144
    v_mov_b32 v121, v144
    v_mov_b32 v124, v144
    v_mov_b32 v125, v144
    s_mul_i32 s8, s6, 32896
    s_lshl_b32 s9, s72, 12
    s_add_u32 s8, s8, s9
    s_add_u32 s8, s8, 4291805184
    v_lshl_add_u32 v60, v2, 4, s8
    global_store_dwordx4 v60, v[112:115], s[50:51] offset:0 sc1
    global_store_dwordx4 v60, v[116:119], s[50:51] offset:1024 sc1
    global_store_dwordx4 v60, v[120:123], s[50:51] offset:2048 sc1
    global_store_dwordx4 v60, v[124:127], s[50:51] offset:3072 sc1
E_WX0:
    v_and_b32 v132, 0xffff0000, v132
    v_and_b32 v133, 0xffff0000, v133
    v_and_b32 v134, 0xffff0000, v134
    v_and_b32 v135, 0xffff0000, v135
    s_mov_b32 s12, 0
SPN17:
    ds_read_b32 v60, v141 offset:64
    s_add_u32 s12, s12, 1
    s_waitcnt lgkmcnt(0)
    v_cmp_eq_u32 vcc, 0, v60
    s_cmp_ge_u32 s12, 0x40000
    s_cbranch_scc1 SPX17
    s_cbranch_vccz SPX17
    s_sleep 1
    s_branch SPN17
SPX17:
    ds_read_b128 v[96:99], v159 offset:2560
    ds_read_b128 v[112:115], v159 offset:12800
    ds_read_b128 v[100:103], v159 offset:23040
    ds_read_b128 v[116:119], v159 offset:33280
    ds_read_b128 v[104:107], v136 offset:2560
    ds_read_b128 v[120:123], v136 offset:12800
    ds_read_b128 v[108:111], v136 offset:23040
    ds_read_b128 v[124:127], v136 offset:33280
    s_waitcnt lgkmcnt(6)
    v_add_f32 v96, v96, v112
    v_fmac_f32 v96, v40, v154
    v_add_f32 v97, v97, v113
    v_fmac_f32 v97, v41, v154
    v_add_f32 v98, v98, v114
    v_fmac_f32 v98, v42, v154
    v_add_f32 v99, v99, v115
    v_fmac_f32 v99, v43, v154
    s_waitcnt lgkmcnt(4)
    v_add_f32 v100, v100, v116
    v_fmac_f32 v100, v44, v155
    v_add_f32 v101, v101, v117
    v_fmac_f32 v101, v45, v155
    v_add_f32 v102, v102, v118
    v_fmac_f32 v102, v46, v155
    v_add_f32 v103, v103, v119
    v_fmac_f32 v103, v47, v155
    s_waitcnt lgkmcnt(2)
    v_add_f32 v104, v104, v120
    v_fmac_f32 v104, v48, v156
    v_add_f32 v105, v105, v121
    v_fmac_f32 v105, v49, v156
    v_add_f32 v106, v106, v122
    v_fmac_f32 v106, v50, v156
    v_add_f32 v107, v107, v123
    v_fmac_f32 v107, v51, v156
    s_waitcnt lgkmcnt(0)
    v_add_f32 v108, v108, v124
    v_fmac_f32 v108, v52, v157
    v_add_f32 v109, v109, v125
    v_fmac_f32 v109, v53, v157
    v_add_f32 v110, v110, v126
    v_fmac_f32 v110, v54, v157
    v_add_f32 v111, v111, v127
    v_fmac_f32 v111, v55, v157
    v_fma_f32 v96, v96, v132, v40
    v_fma_f32 v100, v100, v132, v44
    v_fma_f32 v104, v104, v132, v48
    v_fma_f32 v108, v108, v132, v52
    v_cvt_pk_bf16_f32 v114, v96, v100
    v_cvt_pk_bf16_f32 v115, v104, v108
    s_cmp_ge_u32 s101, 16
    s_cbranch_scc1 E_NS10
    global_store_dwordx2 v6, v[114:115], s[46:47] offset:0
E_NS10:
    v_fma_f32 v97, v97, v133, v41
    v_fma_f32 v101, v101, v133, v45
    v_fma_f32 v105, v105, v133, v49
    v_fma_f32 v109, v109, v133, v53
    v_cvt_pk_bf16_f32 v118, v97, v101
    v_cvt_pk_bf16_f32 v119, v105, v109
    s_cmp_ge_u32 s101, 16
    s_cbranch_scc1 E_NS11
    global_store_dwordx2 v6, v[118:119], s[46:47] offset:1152
E_NS11:
    v_fma_f32 v98, v98, v134, v42
    v_fma_f32 v102, v102, v134, v46
    v_fma_f32 v106, v106, v134, v50
    v_fma_f32 v110, v110, v134, v54
    v_cvt_pk_bf16_f32 v122, v98, v102
    v_cvt_pk_bf16_f32 v123, v106, v110
    s_cmp_ge_u32 s101, 16
    s_cbranch_scc1 E_NS12
    global_store_dwordx2 v6, v[122:123], s[46:47] offset:2304
E_NS12:
    v_fma_f32 v99, v99, v135, v43
    v_fma_f32 v103, v103, v135, v47
    v_fma_f32 v107, v107, v135, v51
    v_fma_f32 v111, v111, v135, v55
    v_cvt_pk_bf16_f32 v126, v99, v103
    v_cvt_pk_bf16_f32 v127, v107, v111
    s_cmp_ge_u32 s101, 16
    s_cbranch_scc1 E_NS13
    global_store_dwordx2 v6, v[126:127], s[46:47] offset:3456
E_NS13:
    s_cmp_lt_u32 s101, 16
    s_cbranch_scc1 E_WX1
    v_mov_b32 v112, v144
    v_mov_b32 v113, v144
    v_mov_b32 v116, v144
    v_mov_b32 v117, v144
    v_mov_b32 v120, v144
    v_mov_b32 v121, v144
    v_mov_b32 v124, v144
    v_mov_b32 v125, v144
    s_mul_i32 s8, s6, 32896
    s_lshl_b32 s9, s72, 12
    s_add_u32 s8, s8, s9
    s_add_u32 s8, s8, 4291813376
    v_lshl_add_u32 v60, v2, 4, s8
    global_store_dwordx4 v60, v[112:115], s[50:51] offset:0 sc1
    global_store_dwordx4 v60, v[116:119], s[50:51] offset:1024 sc1
    global_store_dwordx4 v60, v[120:123], s[50:51] offset:2048 sc1
    global_store_dwordx4 v60, v[124:127], s[50:51] offset:3072 sc1
E_WX1:
    s_waitcnt vmcnt(0)
    s_endpgm
FINAL:
    v_and_b32 v5, 7, v2
    v_lshlrev_b32 v5, 2, v5
    s_lshl_b32 s10, s6, 3
    s_load_dwordx2 s[52:53], s[32:33], s10
    s_mov_b32 s12, 0
SPN18:
    ds_read_b32 v42, v167 offset:244
    s_add_u32 s12, s12, 1
    s_waitcnt lgkmcnt(0)
    v_cmp_ne_u32 vcc, 4, v42
    s_cmp_ge_u32 s12, 0x40000
    s_cbranch_scc1 SPX18
    s_cbranch_vccz SPX18
    s_sleep 1
    s_branch SPN18
SPX18:
    ds_read_b32 v42, v167 offset:120
    s_waitcnt lgkmcnt(0)
    v_and_b32 v6, 4, v2
    v_add_u32 v6, v6, v4
    s_lshl_b32 s9, s4, 8
    v_lshl_add_u32 v6, v6, 3, s9
    v_and_b32 v7, 4, v2
    v_add_u32 v7, v7, v4
    s_lshl_b32 s9, s4, 10
    s_add_u32 s9, s9, 48896
    v_lshl_add_u32 v7, v7, 7, s9
    s_mov_b32 s12, 0
    s_waitcnt vmcnt(0)
    v_mov_b32 v8, v124
    v_mov_b32 v9, v125
    s_branch SPC_F
SP_F:
    s_add_u32 s12, s12, 1
    s_and_b32 s9, s12, 7
    s_cselect_b64 s[14:15], 0, -1
    v_cndmask_b32 v10, v6, v7, s[14:15]
    global_load_dwordx2 v[8:9], v10, s[50:51] offset:256 sc1
    s_waitcnt vmcnt(0)
SPC_F:
    v_cmp_ne_u32 vcc, v9, v42
    s_cmp_ge_u32 s12, 16384
    s_cbranch_scc1 SPX_F
    s_cbranch_vccz SPX_F
    s_mov_b64 exec, vcc
    s_sleep 2
    s_branch SP_F
SPX_F:
    s_mov_b64 exec, -1
    v_and_b32 v9, 0xff, v42
    v_not_b32 v10, v8
    v_and_b32 v10, 0x7ff, v10
    v_and_b32 v23, 3, v2
    v_mul_u32_u24 v11, 1152, v10
    v_lshl_add_u32 v11, v23, 1, v11
    v_add_u32 v11, s10, v11
    v_lshlrev_b32 v14, 3, v10
    v_lshl_add_u32 v14, v23, 1, v14
    v_add_u32 v14, 81920, v14
    ds_read_u16 v24, v14
    v_lshlrev_b32 v14, 2, v10
    v_add_u32 v14, 98304, v14
    ds_read_b32 v15, v14
    v_lshrrev_b32 v16, 8, v10
    v_mul_u32_u24 v16, 1280, v16
    v_and_b32 v17, 0xf0, v10
    v_add_u32 v16, v16, v17
    v_bfe_u32 v17, v10, 2, 2
    v_mul_u32_u24 v17, 320, v17
    v_add_u32 v16, v16, v17
    v_and_b32 v17, 3, v10
    v_lshl_add_u32 v16, v17, 2, v16
    v_mul_u32_u24 v17, 20480, v23
    v_add_u32 v16, v16, v17
    v_add_u32 v18, 154080, v5
    v_and_b32 v20, 0xffff0000, v8
    v_not_b32 v21, v20
    v_ashrrev_i32 v21, 31, v21
    v_and_b32 v21, 0x7fff0000, v21
    v_or_b32 v21, 0x80000000, v21
    v_xor_b32 v20, v20, v21
    v_mul_f32 v21, 0xbfb8aa3b, v20
    v_exp_f32 v21, v21
    s_nop 0
    v_add_f32 v21, 1.0, v21
    v_rcp_f32 v21, v21
    s_nop 0
    v_cvt_pk_bf16_f32 v20, v21, v21
    v_and_b32 v20, 0xffff0000, v20
    s_waitcnt lgkmcnt(0)
    v_and_b32 v15, 0xffff0000, v15
    v_sub_f32 v21, 1.0, v15
    v_cvt_pk_bf16_f32 v21, v21, v21
    v_and_b32 v21, 0xffff0000, v21
    v_lshlrev_b32 v24, 16, v24
    v_lshlrev_b32 v25, 4, v23
    v_lshrrev_b64 v[26:27], v25, s[52:53]
    v_lshlrev_b32 v26, 16, v26
    v_mul_f32 v26, v26, v24
    v_cvt_pk_bf16_f32 v26, 0, v26
    s_mul_i32 s8, s6, 1152
    s_add_u32 s8, s8, 352256
    s_mov_b32 s12, 0
SPN19:
    ds_read_b32 v22, v18 offset:0
    s_add_u32 s12, s12, 1
    s_waitcnt lgkmcnt(0)
    v_cmp_eq_u32 vcc, 0, v22
    s_cmp_ge_u32 s12, 0x40000
    s_cbranch_scc1 SPX19
    s_cbranch_vccz SPX19
    s_sleep 1
    s_branch SPN19
SPX19:
    ds_read_b32 v28, v16
    ds_read_b32 v29, v16 offset:10240
    v_lshl_add_u32 v22, v2, 4, s8
    s_mov_b32 s72, 0x00ff00ff
    s_mov_b32 s73, 0x00ff00ff
    s_waitcnt lgkmcnt(0)
    v_add_f32 v28, v28, v29
    v_cvt_pk_bf16_f32 v28, 0, v28
    v_add_f32 v28, v28, v26
    v_cvt_pk_bf16_f32 v28, 0, v28
    v_mul_f32 v28, v28, v15
    v_cvt_pk_bf16_f32 v28, 0, v28
    v_min_u32 v33, 4, v2
    s_lshl_b32 s11, s4, 7
    v_lshl_add_u32 v33, v33, 2, s11
    s_mov_b32 s12, 0
FN_R:
    global_load_dword v34, v33, s[50:51] offset:2304 sc1
    s_add_u32 s12, s12, 1
    s_waitcnt vmcnt(0)
    v_cmp_ne_u32 vcc, v34, v42
    s_cmp_ge_u32 s12, 64
    s_cbranch_scc1 FN_RX
    s_cbranch_vccz FN_RX
    s_sleep 2
    s_branch FN_R
FN_RX:
    s_mov_b32 s12, 0
FN_P:
    global_load_dwordx4 v[48:51], v22, s[50:51] sc1
    s_add_u32 s12, s12, 1
    s_waitcnt vmcnt(0)
    v_xor_b32 v48, v48, v9
    v_xor_b32 v49, v49, v9
    v_xor_b32 v50, v50, v9
    v_xor_b32 v51, v51, v9
    v_or3_b32 v32, v48, v49, v50
    v_or_b32 v32, v32, v51
    v_and_b32 v32, 0xff, v32
    v_cmp_ne_u32 vcc, 0, v32
    s_cmp_ge_u32 s12, 65536
    s_cbranch_scc1 FN_POK
    s_cbranch_vccz FN_POK
    s_mov_b64 exec, vcc
    s_branch FN_P
FN_POK:
    s_mov_b64 exec, -1
    v_permlane32_swap_b32 v48, v50
    v_permlane32_swap_b32 v49, v51
    v_add_f32 v48, v48, v50
    v_add_f32 v49, v49, v51
    s_nop 1
    v_permlane16_swap_b32 v48, v49
    v_add_f32 v48, v48, v49
    s_nop 1
    v_add_f32_dpp v48, v48, v48 row_ror:8 row_mask:0xf bank_mask:0xf
    v_cvt_pk_bf16_f32 v48, 0, v48
    v_mul_f32 v48, v48, v20
    v_cvt_pk_bf16_f32 v48, 0, v48
    v_add_f32 v48, v48, v24
    v_cvt_pk_bf16_f32 v48, 0, v48
    v_mul_f32 v48, v48, v21
    v_cvt_pk_bf16_f32 v48, 0, v48
    v_add_f32 v48, v48, v28
    v_cvt_pk_bf16_f32 v48, 0, v48
    s_barrier
    s_mov_b64 exec, s[72:73]
    global_store_short_d16_hi v11, v48, s[46:47]
    s_endpgm
W_END:
    s_endpgm
K_END:
    s_endpgm
CODE_END:
.section .rodata,"a"
.p2align 6
.amdhsa_kernel k1_kernel
  .amdhsa_next_free_vgpr 168
  .amdhsa_next_free_sgpr 102
  .amdhsa_accum_offset 168
  .amdhsa_group_segment_fixed_size 0
  .amdhsa_kernarg_size 144
  .amdhsa_user_sgpr_count 2
  .amdhsa_user_sgpr_kernarg_segment_ptr 1
  .amdhsa_system_sgpr_workgroup_id_x 1
.end_amdhsa_kernel
```
